```python
import torch

def _softmax(x, axis=-1):
    return torch.softmax(x, dim=axis)

def _gelu(x):
    return torch.nn.functional.gelu(x, approximate='tanh')

def _silu(x):
    return torch.nn.functional.silu(x)

def _sigmoid(x):
    return torch.sigmoid(x)

def _layernorm(x, axis=-1, eps=1e-05):
    m = x.mean(dim=axis, keepdim=True)
    v = x.var(dim=axis, keepdim=True, unbiased=False)
    return (x - m) / torch.sqrt(v + eps)

def _scatter_add(tgt, idx, src, axis=0):
    return tgt.clone().index_add_(axis, idx, src)

def _segment_sum(src, seg, n):
    out = torch.zeros((n,) + src.shape[1:], dtype=src.dtype)
    return out.index_add_(0, seg, src)

def _pad(x, pw):
    flat = tuple((v for pair in reversed(pw) for v in pair))
    return torch.nn.functional.pad(x, flat)
kernel_name = 'interleave_layers__memory_aug_recurrent_mem_tr__linear_kernel_hedgehog__prompt'

def setup_inputs():

    _w = lambda a: (lambda t: t.to(torch.bfloat16) if t.is_floating_point() else t)(torch.as_tensor(a))

    def _A_setup():
        B, S, Dm = (1, 2048, 640)
        H, Dh = (32, 192)
        M, seg = (8, 32)
        seg = min(seg, S)
        S = S // seg * seg
        return {'x': _w((lambda *s: torch.randn(*s, dtype=torch.bfloat16) * 0.05)(B, S, Dm)), 'mem0': _w((lambda *s: torch.randn(*s, dtype=torch.bfloat16) * 0.8)(B, M, Dm)), 'Wq': _w((lambda *s: torch.randn(*s, dtype=torch.bfloat16) * 1.6)(Dm, H, Dh) * Dm ** (-0.5)), 'Wk': _w((lambda *s: torch.randn(*s, dtype=torch.bfloat16) * 1.6)(Dm, H, Dh) * Dm ** (-0.5)), 'Wv': _w((lambda *s: torch.randn(*s, dtype=torch.bfloat16) * 0.8)(Dm, H, Dh) * Dm ** (-0.5)), 'Wo': _w((lambda *s: torch.randn(*s, dtype=torch.bfloat16) * 0.8)(H, Dh, Dm) * (H * Dh) ** (-0.5)), 'seg_len': seg}
    _A_in = _A_setup()

    def _B_setup():
        B, S, D, H = (1, 2048, 640, 32)
        Dh = D // H
        return {'x': _w((lambda *s: torch.randn(*s, dtype=torch.bfloat16) * 0.05)(B, S, D)), 'wqkv': _w((lambda *s: torch.randn(*s, dtype=torch.bfloat16) * 0.4)(D, 3 * D)), 'w_phi': _w((lambda *s: torch.randn(*s, dtype=torch.bfloat16) * 0.4)(H, Dh, Dh) * Dh ** (-0.5)), 'wo': _w((lambda *s: torch.randn(*s, dtype=torch.bfloat16) * 0.05)(D, D))}
    _B_in = _B_setup()
    return {'A_x': _A_in['x'], 'A_mem0': _A_in['mem0'], 'A_Wq': _A_in['Wq'], 'A_Wk': _A_in['Wk'], 'A_Wv': _A_in['Wv'], 'A_Wo': _A_in['Wo'], 'A_seg_len': _A_in['seg_len'], 'B_x': _B_in['x'], 'B_wqkv': _B_in['wqkv'], 'B_w_phi': _B_in['w_phi'], 'B_wo': _B_in['wo']}

def reference(A_x, A_mem0, A_Wq, A_Wk, A_Wv, A_Wo, A_seg_len, B_x, B_wqkv, B_w_phi, B_wo):

    def _A_ref(x, mem0, Wq, Wk, Wv, Wo, seg_len):
        B, S, Dm = x.shape
        H, Dh = (Wq.shape[1], Wq.shape[2])
        M = mem0.shape[1]
        scale = Dh ** (-0.5)
        n_seg = S // seg_len
        L = M + seg_len
        idx = torch.arange(L)
        mask = (idx[:, None] < M) | (idx[:, None] >= idx[None, :])
        mem = mem0
        outs = []
        for s in range(n_seg):
            xs = x[:, s * seg_len:(s + 1) * seg_len, :].clone()
            h = torch.concatenate([mem, xs], axis=1)
            q = torch.einsum('btd,dhe->bhte', h, Wq)
            k = torch.einsum('btd,dhe->bhte', h, Wk)
            v = torch.einsum('btd,dhe->bhte', h, Wv)
            scores = torch.einsum('bhqe,bhke->bhqk', q, k) * scale
            scores = torch.where(mask[None, None], scores, -1000000000.0)
            p = _softmax(scores, axis=-1)
            o = torch.einsum('bhqk,bhke->bhqe', p, v)
            o = torch.einsum('bhte,hed->btd', o, Wo)
            mem = o[:, :M, :].clone()
            outs.append(o[:, M:, :])
        return torch.concatenate(outs, axis=1)

    def _B_ref(x, wqkv, w_phi, wo):
        B, S, D = x.shape
        H = 32
        Dh = D // H
        qkv = (lambda x, *d: x.permute(*d))((x @ wqkv).reshape(B, S, 3, H, Dh), 2, 0, 3, 1, 4)
        q, k, v = (qkv[0], qkv[1], qkv[2])
        pq = torch.einsum('bhsd,hdf->bhsf', q, w_phi)
        pk = torch.einsum('bhsd,hdf->bhsf', k, w_phi)
        phi_q = torch.concatenate([_softmax(pq, axis=-1), _softmax(-pq, axis=-1)], axis=-1)
        phi_k = torch.concatenate([_softmax(pk, axis=-1), _softmax(-pk, axis=-1)], axis=-1)
        kv = torch.einsum('bhsf,bhsd->bhfd', phi_k, v)
        z = torch.einsum('bhsf->bhf', phi_k)
        num = torch.einsum('bhqf,bhfd->bhqd', phi_q, kv)
        den = torch.einsum('bhqf,bhf->bhq', phi_q, z)[..., None] + 1e-06
        o = num / den
        return (lambda x, *d: x.permute(*d))(o, 0, 2, 1, 3).reshape(B, S, D) @ wo
    x = A_x
    x = x + _A_ref(_layernorm(x, axis=-1), A_mem0, A_Wq, A_Wk, A_Wv, A_Wo, A_seg_len)
    x = x + _B_ref(_layernorm(x, axis=-1), B_wqkv, B_w_phi, B_wo)
    x = x + _A_ref(_layernorm(x, axis=-1), A_mem0, A_Wq, A_Wk, A_Wv, A_Wo, A_seg_len)
    x = x + _B_ref(_layernorm(x, axis=-1), B_wqkv, B_w_phi, B_wo)
    return x
```

```asm
; @launch kernel=prep_kernel grid=(468,1,1) block=(256,1,1) lds=73728
; @launch kernel=mega0_kernel grid=(256,1,1) block=(256,1,1) lds=163840
; @launch kernel=b1_kernel grid=(256,1,1) block=(320,1,1) lds=153600
; @launch kernel=bred_kernel grid=(105,1,1) block=(256,1,1) lds=0
; @launch kernel=b2_kernel grid=(256,1,1) block=(320,1,1) lds=102400
; @launch kernel=mega1_kernel grid=(256,1,1) block=(256,1,1) lds=163840
; @launch kernel=b1_kernel grid=(256,1,1) block=(320,1,1) lds=153600
; @launch kernel=bred_kernel grid=(105,1,1) block=(256,1,1) lds=0
; @launch kernel=b2f_kernel grid=(256,1,1) block=(320,1,1) lds=102400
.amdgcn_target "amdgcn-amd-amdhsa--gfx950"
.text
.globl prep_kernel
.p2align 8
.type prep_kernel,@function
prep_kernel:
  s_load_dwordx2 s[4:5], s[0:1], 104
  s_mov_b32 s6, 0x10000000
  s_mov_b32 s7, 0x20000
  s_load_dwordx2 s[16:17], s[0:1], 32
  s_mov_b32 s18, 0x780000
  s_mov_b32 s19, 0x20000
  s_load_dwordx2 s[32:33], s[0:1], 40
  s_mov_b32 s34, 0x780000
  s_mov_b32 s35, 0x20000
  s_load_dwordx2 s[36:37], s[0:1], 0
  s_mov_b32 s38, 0x280000
  s_mov_b32 s39, 0x20000
  s_load_dwordx2 s[40:41], s[0:1], 8
  s_mov_b32 s42, 0x2800
  s_mov_b32 s43, 0x20000
  v_lshrrev_b32 v1, 6, v0
  s_nop 0
  v_readfirstlane_b32 s3, v1
  v_and_b32 v1, 63, v0
  s_waitcnt lgkmcnt(0)
  s_cmp_ge_u32 s2, 8
  s_cbranch_scc1 prep_noprobe
  s_cmp_ge_u32 s3, 2
  s_cbranch_scc1 prep_end
  s_add_u32 s20, s4, 63995903
  s_and_b32 s20, s20, 0xffe00000
  s_sub_u32 s20, s20, s4
  s_lshl_b32 s21, s3, 21
  s_add_u32 s20, s20, s21
  s_cmp_eq_u32 s3, 0
  s_cbranch_scc1 prep_pgo
  s_sleep 100
prep_pgo:
  s_lshl_b32 s21, s2, 7
  s_add_u32 s20, s20, s21
  s_add_u32 s20, s20, 1982464
  v_mov_b32 v2, 0
  s_mov_b64 exec, 1
  s_mov_b32 s24, -1
  s_mov_b32 s25, -1
  s_mov_b32 s26, 0
prep_ploop:
  s_memtime s[28:29]
  s_waitcnt lgkmcnt(0)
  buffer_store_dword v2, v2, s[4:7], s20 offen sc1
  s_waitcnt vmcnt(0)
  s_memtime s[30:31]
  s_waitcnt lgkmcnt(0)
  s_sub_u32 s30, s30, s28
  s_min_u32 s24, s24, s30
  s_add_u32 s20, s20, 8192
  s_memtime s[28:29]
  s_waitcnt lgkmcnt(0)
  buffer_store_dword v2, v2, s[4:7], s20 offen sc1
  s_waitcnt vmcnt(0)
  s_memtime s[30:31]
  s_waitcnt lgkmcnt(0)
  s_sub_u32 s30, s30, s28
  s_min_u32 s25, s25, s30
  s_sub_u32 s20, s20, 8192
  s_add_u32 s26, s26, 1
  s_cmp_lt_u32 s26, 4
  s_cbranch_scc1 prep_ploop
  s_getreg_b32 s26, hwreg(HW_REG_XCC_ID)
  s_bfe_u32 s26, s26, 0x10002
  s_cmp_lt_u32 s24, s25
  s_cselect_b32 s27, 1, 0
  s_xor_b32 s27, s27, s26
  v_mov_b32 v3, s27
  s_lshl_b32 s21, s3, 3
  s_add_u32 s21, s21, s2
  s_lshl_b32 s21, s21, 2
  s_add_u32 s21, s21, 94502912
  buffer_store_dword v3, v2, s[4:7], s21 offen
  s_endpgm
prep_noprobe:
  s_cmp_ge_u32 s2, 264
  s_cbranch_scc1 prep_nobmat
  s_sub_u32 s8, s2, 8
  s_and_b32 s9, s8, 31
  s_bfe_u32 s12, s8, 0x10005
  s_lshr_b32 s13, s8, 6
  s_mov_b32 s20, -1
  s_mov_b32 s21, 0x0fffffff
  s_lshl_b32 s14, s12, 2
  s_add_u32 s14, s14, s3
  s_mul_i32 s10, s9, 245760
  s_mul_i32 s11, s14, 160
  s_add_u32 s10, s10, s11
  s_mul_i32 s11, s3, 15360
  v_mul_u32_u24 v6, 6554, v1
  v_lshrrev_b32 v6, 16, v6
  v_mul_u32_u24 v4, 10, v6
  v_sub_u32 v4, v1, v4
  v_lshlrev_b32 v4, 4, v4
  v_mul_u32_u24 v6, 1280, v6
  v_add_u32 v4, v4, v6
  v_lshrrev_b32 v6, 4, v1
  v_mul_u32_u24 v6, 8, v6
  v_bfe_u32 v5, v1, 2, 2
  v_add_u32 v6, v6, v5
  v_mul_u32_u24 v6, 160, v6
  v_and_b32 v5, 3, v1
  v_lshl_add_u32 v5, v5, 3, v6
  v_add_u32 v5, s11, v5
  s_mov_b64 exec, s[20:21]
  s_add_u32 m0, s11, 0
  s_nop 0
  buffer_load_dwordx4 v4, s[32:35], s10 offen lds
  s_add_u32 s10, s10, 7680
  s_add_u32 m0, s11, 960
  s_nop 0
  buffer_load_dwordx4 v4, s[32:35], s10 offen lds
  s_add_u32 s10, s10, 7680
  s_add_u32 m0, s11, 1920
  s_nop 0
  buffer_load_dwordx4 v4, s[32:35], s10 offen lds
  s_add_u32 s10, s10, 7680
  s_add_u32 m0, s11, 2880
  s_nop 0
  buffer_load_dwordx4 v4, s[32:35], s10 offen lds
  s_add_u32 s10, s10, 7680
  s_add_u32 m0, s11, 3840
  s_nop 0
  buffer_load_dwordx4 v4, s[32:35], s10 offen lds
  s_add_u32 s10, s10, 7680
  s_add_u32 m0, s11, 4800
  s_nop 0
  buffer_load_dwordx4 v4, s[32:35], s10 offen lds
  s_add_u32 s10, s10, 7680
  s_add_u32 m0, s11, 5760
  s_nop 0
  buffer_load_dwordx4 v4, s[32:35], s10 offen lds
  s_add_u32 s10, s10, 7680
  s_add_u32 m0, s11, 6720
  s_nop 0
  buffer_load_dwordx4 v4, s[32:35], s10 offen lds
  s_add_u32 s10, s10, 7680
  s_add_u32 m0, s11, 7680
  s_nop 0
  buffer_load_dwordx4 v4, s[32:35], s10 offen lds
  s_add_u32 s10, s10, 7680
  s_add_u32 m0, s11, 8640
  s_nop 0
  buffer_load_dwordx4 v4, s[32:35], s10 offen lds
  s_add_u32 s10, s10, 7680
  s_add_u32 m0, s11, 9600
  s_nop 0
  buffer_load_dwordx4 v4, s[32:35], s10 offen lds
  s_add_u32 s10, s10, 7680
  s_add_u32 m0, s11, 10560
  s_nop 0
  buffer_load_dwordx4 v4, s[32:35], s10 offen lds
  s_add_u32 s10, s10, 7680
  s_add_u32 m0, s11, 11520
  s_nop 0
  buffer_load_dwordx4 v4, s[32:35], s10 offen lds
  s_add_u32 s10, s10, 7680
  s_add_u32 m0, s11, 12480
  s_nop 0
  buffer_load_dwordx4 v4, s[32:35], s10 offen lds
  s_add_u32 s10, s10, 7680
  s_add_u32 m0, s11, 13440
  s_nop 0
  buffer_load_dwordx4 v4, s[32:35], s10 offen lds
  s_add_u32 s10, s10, 7680
  s_add_u32 m0, s11, 14400
  s_nop 0
  buffer_load_dwordx4 v4, s[32:35], s10 offen lds
  s_add_u32 s10, s10, 7680
  s_mov_b64 exec, -1
  v_bfe_u32 v6, v1, 2, 1
  v_and_b32 v7, 1, v1
  v_lshl_add_u32 v6, v6, 2, v7
  v_bfe_u32 v7, v1, 3, 1
  v_bfe_u32 v2, v1, 1, 1
  v_lshl_add_u32 v7, v7, 1, v2
  v_mul_u32_u24 v2, 40, v7
  v_add_u32 v2, v2, v6
  v_lshl_add_u32 v6, v7, 3, v6
  v_lshrrev_b32 v3, 4, v1
  v_mul_u32_u24 v6, 12288, v6
  v_lshl_add_u32 v6, v3, 4, v6
  v_mul_u32_u24 v7, 12288, v2
  v_lshl_add_u32 v7, v3, 4, v7
  s_mul_i32 s15, s13, 2457600
  s_mul_i32 s22, s9, 384
  s_add_u32 s15, s15, s22
  v_lshlrev_b32 v2, 4, v1
  s_mul_i32 s22, s9, 40
  s_mul_i32 s23, s14, 5
  s_add_u32 s22, s22, s23
  s_mul_i32 s22, s22, 20
  s_mul_i32 s23, s13, 5
  s_add_u32 s22, s22, s23
  s_lshl_b32 s22, s22, 10
  s_add_u32 s22, s22, 0
  s_lshr_b32 s24, s3, 1
  s_mul_i32 s24, s24, 24576
  s_and_b32 s25, s3, 1
  s_mul_i32 s25, s25, 192
  s_add_u32 s15, s15, s24
  s_add_u32 s15, s15, s25
  s_mul_i32 s24, s3, 3072
  s_mov_b32 s26, 491520
  s_add_u32 m0, s24, 61440
  s_nop 0
  buffer_load_dwordx4 v6, s[16:19], s15 offen offset:0 lds
  s_add_u32 m0, s24, 62400
  s_nop 0
  buffer_load_dwordx4 v6, s[16:19], s15 offen offset:64 lds
  s_add_u32 m0, s24, 63360
  s_nop 0
  buffer_load_dwordx4 v6, s[16:19], s15 offen offset:128 lds
  s_add_u32 s15, s15, s26
  s_cmp_eq_u32 s13, 3
  s_cselect_b32 s26, 1966080, s26
  s_cselect_b32 s27, 7471104, 0
  s_cselect_b64 vcc, -1, 0
  s_sub_u32 s15, s15, s27
  v_cndmask_b32 v6, v6, v7, vcc
  s_waitcnt vmcnt(13)
  ds_read_b64_tr_b16 a[0:1], v5 offset:0
  ds_read_b64_tr_b16 a[2:3], v5 offset:640
  ds_read_b64_tr_b16 a[24:25], v5 offset:32
  ds_read_b64_tr_b16 a[26:27], v5 offset:672
  ds_read_b64_tr_b16 a[48:49], v5 offset:64
  ds_read_b64_tr_b16 a[50:51], v5 offset:704
  ds_read_b64_tr_b16 a[72:73], v5 offset:96
  ds_read_b64_tr_b16 a[74:75], v5 offset:736
  ds_read_b64_tr_b16 a[96:97], v5 offset:128
  ds_read_b64_tr_b16 a[98:99], v5 offset:768
  s_waitcnt lgkmcnt(0)
  s_mov_b64 exec, s[20:21]
  s_add_u32 m0, s11, 0
  s_nop 0
  buffer_load_dwordx4 v4, s[32:35], s10 offen lds
  s_add_u32 s10, s10, 7680
  s_add_u32 m0, s11, 960
  s_nop 0
  buffer_load_dwordx4 v4, s[32:35], s10 offen lds
  s_add_u32 s10, s10, 7680
  s_add_u32 m0, s11, 1920
  s_nop 0
  buffer_load_dwordx4 v4, s[32:35], s10 offen lds
  s_add_u32 s10, s10, 7680
  s_add_u32 m0, s11, 2880
  s_nop 0
  buffer_load_dwordx4 v4, s[32:35], s10 offen lds
  s_add_u32 s10, s10, 7680
  s_add_u32 m0, s11, 3840
  s_nop 0
  buffer_load_dwordx4 v4, s[32:35], s10 offen lds
  s_add_u32 s10, s10, 7680
  s_mov_b64 exec, -1
  s_waitcnt vmcnt(13)
  ds_read_b64_tr_b16 a[4:5], v5 offset:5120
  ds_read_b64_tr_b16 a[6:7], v5 offset:5760
  ds_read_b64_tr_b16 a[28:29], v5 offset:5152
  ds_read_b64_tr_b16 a[30:31], v5 offset:5792
  ds_read_b64_tr_b16 a[52:53], v5 offset:5184
  ds_read_b64_tr_b16 a[54:55], v5 offset:5824
  ds_read_b64_tr_b16 a[76:77], v5 offset:5216
  ds_read_b64_tr_b16 a[78:79], v5 offset:5856
  ds_read_b64_tr_b16 a[100:101], v5 offset:5248
  ds_read_b64_tr_b16 a[102:103], v5 offset:5888
  s_waitcnt lgkmcnt(0)
  s_mov_b64 exec, s[20:21]
  s_add_u32 m0, s11, 4800
  s_nop 0
  buffer_load_dwordx4 v4, s[32:35], s10 offen lds
  s_add_u32 s10, s10, 7680
  s_add_u32 m0, s11, 5760
  s_nop 0
  buffer_load_dwordx4 v4, s[32:35], s10 offen lds
  s_add_u32 s10, s10, 7680
  s_add_u32 m0, s11, 6720
  s_nop 0
  buffer_load_dwordx4 v4, s[32:35], s10 offen lds
  s_add_u32 s10, s10, 7680
  s_add_u32 m0, s11, 7680
  s_nop 0
  buffer_load_dwordx4 v4, s[32:35], s10 offen lds
  s_add_u32 s10, s10, 7680
  s_add_u32 m0, s11, 8640
  s_nop 0
  buffer_load_dwordx4 v4, s[32:35], s10 offen lds
  s_add_u32 s10, s10, 7680
  s_mov_b64 exec, -1
  s_waitcnt vmcnt(13)
  ds_read_b64_tr_b16 a[8:9], v5 offset:10240
  ds_read_b64_tr_b16 a[10:11], v5 offset:10880
  ds_read_b64_tr_b16 a[32:33], v5 offset:10272
  ds_read_b64_tr_b16 a[34:35], v5 offset:10912
  ds_read_b64_tr_b16 a[56:57], v5 offset:10304
  ds_read_b64_tr_b16 a[58:59], v5 offset:10944
  ds_read_b64_tr_b16 a[80:81], v5 offset:10336
  ds_read_b64_tr_b16 a[82:83], v5 offset:10976
  ds_read_b64_tr_b16 a[104:105], v5 offset:10368
  ds_read_b64_tr_b16 a[106:107], v5 offset:11008
  s_waitcnt lgkmcnt(0)
  s_mov_b64 exec, s[20:21]
  s_add_u32 m0, s11, 9600
  s_nop 0
  buffer_load_dwordx4 v4, s[32:35], s10 offen lds
  s_add_u32 s10, s10, 7680
  s_add_u32 m0, s11, 10560
  s_nop 0
  buffer_load_dwordx4 v4, s[32:35], s10 offen lds
  s_add_u32 s10, s10, 7680
  s_add_u32 m0, s11, 11520
  s_nop 0
  buffer_load_dwordx4 v4, s[32:35], s10 offen lds
  s_add_u32 s10, s10, 7680
  s_add_u32 m0, s11, 12480
  s_nop 0
  buffer_load_dwordx4 v4, s[32:35], s10 offen lds
  s_add_u32 s10, s10, 7680
  s_add_u32 m0, s11, 13440
  s_nop 0
  buffer_load_dwordx4 v4, s[32:35], s10 offen lds
  s_add_u32 s10, s10, 7680
  s_add_u32 m0, s11, 14400
  s_nop 0
  buffer_load_dwordx4 v4, s[32:35], s10 offen lds
  s_add_u32 s10, s10, 7680
  s_mov_b64 exec, -1
  s_waitcnt vmcnt(10)
  ds_read_b64_tr_b16 a[12:13], v5 offset:0
  ds_read_b64_tr_b16 a[14:15], v5 offset:640
  ds_read_b64_tr_b16 a[36:37], v5 offset:32
  ds_read_b64_tr_b16 a[38:39], v5 offset:672
  ds_read_b64_tr_b16 a[60:61], v5 offset:64
  ds_read_b64_tr_b16 a[62:63], v5 offset:704
  ds_read_b64_tr_b16 a[84:85], v5 offset:96
  ds_read_b64_tr_b16 a[86:87], v5 offset:736
  ds_read_b64_tr_b16 a[108:109], v5 offset:128
  ds_read_b64_tr_b16 a[110:111], v5 offset:768
  s_waitcnt vmcnt(5)
  ds_read_b64_tr_b16 a[16:17], v5 offset:5120
  ds_read_b64_tr_b16 a[18:19], v5 offset:5760
  ds_read_b64_tr_b16 a[40:41], v5 offset:5152
  ds_read_b64_tr_b16 a[42:43], v5 offset:5792
  ds_read_b64_tr_b16 a[64:65], v5 offset:5184
  ds_read_b64_tr_b16 a[66:67], v5 offset:5824
  ds_read_b64_tr_b16 a[88:89], v5 offset:5216
  ds_read_b64_tr_b16 a[90:91], v5 offset:5856
  ds_read_b64_tr_b16 a[112:113], v5 offset:5248
  ds_read_b64_tr_b16 a[114:115], v5 offset:5888
  s_waitcnt vmcnt(0)
  ds_read_b64_tr_b16 a[20:21], v5 offset:10240
  ds_read_b64_tr_b16 a[22:23], v5 offset:10880
  ds_read_b64_tr_b16 a[44:45], v5 offset:10272
  ds_read_b64_tr_b16 a[46:47], v5 offset:10912
  ds_read_b64_tr_b16 a[68:69], v5 offset:10304
  ds_read_b64_tr_b16 a[70:71], v5 offset:10944
  ds_read_b64_tr_b16 a[92:93], v5 offset:10336
  ds_read_b64_tr_b16 a[94:95], v5 offset:10976
  ds_read_b64_tr_b16 a[116:117], v5 offset:10368
  ds_read_b64_tr_b16 a[118:119], v5 offset:11008
  s_waitcnt lgkmcnt(0)
  s_barrier
  s_add_u32 m0, s24, 0
  s_nop 0
  buffer_load_dwordx4 v6, s[16:19], s15 offen offset:0 lds
  s_add_u32 m0, s24, 960
  s_nop 0
  buffer_load_dwordx4 v6, s[16:19], s15 offen offset:64 lds
  s_add_u32 m0, s24, 1920
  s_nop 0
  buffer_load_dwordx4 v6, s[16:19], s15 offen offset:128 lds
  s_add_u32 s15, s15, s26
  s_add_u32 m0, s24, 12288
  s_nop 0
  buffer_load_dwordx4 v6, s[16:19], s15 offen offset:0 lds
  s_add_u32 m0, s24, 13248
  s_nop 0
  buffer_load_dwordx4 v6, s[16:19], s15 offen offset:64 lds
  s_add_u32 m0, s24, 14208
  s_nop 0
  buffer_load_dwordx4 v6, s[16:19], s15 offen offset:128 lds
  s_add_u32 s15, s15, s26
  s_add_u32 m0, s24, 24576
  s_nop 0
  buffer_load_dwordx4 v6, s[16:19], s15 offen offset:0 lds
  s_add_u32 m0, s24, 25536
  s_nop 0
  buffer_load_dwordx4 v6, s[16:19], s15 offen offset:64 lds
  s_add_u32 m0, s24, 26496
  s_nop 0
  buffer_load_dwordx4 v6, s[16:19], s15 offen offset:128 lds
  s_add_u32 s15, s15, s26
  s_add_u32 m0, s24, 36864
  s_nop 0
  buffer_load_dwordx4 v6, s[16:19], s15 offen offset:0 lds
  s_add_u32 m0, s24, 37824
  s_nop 0
  buffer_load_dwordx4 v6, s[16:19], s15 offen offset:64 lds
  s_add_u32 m0, s24, 38784
  s_nop 0
  buffer_load_dwordx4 v6, s[16:19], s15 offen offset:128 lds
  s_add_u32 s15, s15, s26
  v_add_u32 v3, 61440, v2
  ds_read_b128 v[8:11], v3 offset:0
  ds_read_b128 v[12:15], v3 offset:1024
  ds_read_b128 v[16:19], v3 offset:2048
  ds_read_b128 v[20:23], v3 offset:3072
  ds_read_b128 v[24:27], v3 offset:4096
  ds_read_b128 v[28:31], v3 offset:5120
  ds_read_b128 v[32:35], v3 offset:6144
  ds_read_b128 v[36:39], v3 offset:7168
  ds_read_b128 v[40:43], v3 offset:8192
  ds_read_b128 v[44:47], v3 offset:9216
  ds_read_b128 v[48:51], v3 offset:10240
  ds_read_b128 v[52:55], v3 offset:11264
  s_waitcnt lgkmcnt(0)
  v_mfma_f32_16x16x32_bf16 v[104:107], v[8:11], a[0:3], 0
  v_mfma_f32_16x16x32_bf16 v[108:111], v[32:35], a[0:3], 0
  v_mfma_f32_16x16x32_bf16 v[104:107], v[12:15], a[4:7], v[104:107]
  v_mfma_f32_16x16x32_bf16 v[108:111], v[36:39], a[4:7], v[108:111]
  v_mfma_f32_16x16x32_bf16 v[104:107], v[16:19], a[8:11], v[104:107]
  v_mfma_f32_16x16x32_bf16 v[108:111], v[40:43], a[8:11], v[108:111]
  v_mfma_f32_16x16x32_bf16 v[104:107], v[20:23], a[12:15], v[104:107]
  v_mfma_f32_16x16x32_bf16 v[108:111], v[44:47], a[12:15], v[108:111]
  v_mfma_f32_16x16x32_bf16 v[104:107], v[24:27], a[16:19], v[104:107]
  v_mfma_f32_16x16x32_bf16 v[108:111], v[48:51], a[16:19], v[108:111]
  v_mfma_f32_16x16x32_bf16 v[104:107], v[28:31], a[20:23], v[104:107]
  v_mfma_f32_16x16x32_bf16 v[108:111], v[52:55], a[20:23], v[108:111]
  v_mfma_f32_16x16x32_bf16 v[112:115], v[8:11], a[24:27], 0
  v_mfma_f32_16x16x32_bf16 v[116:119], v[32:35], a[24:27], 0
  v_mfma_f32_16x16x32_bf16 v[112:115], v[12:15], a[28:31], v[112:115]
  v_mfma_f32_16x16x32_bf16 v[116:119], v[36:39], a[28:31], v[116:119]
  v_mfma_f32_16x16x32_bf16 v[112:115], v[16:19], a[32:35], v[112:115]
  v_mfma_f32_16x16x32_bf16 v[116:119], v[40:43], a[32:35], v[116:119]
  v_mfma_f32_16x16x32_bf16 v[112:115], v[20:23], a[36:39], v[112:115]
  v_mfma_f32_16x16x32_bf16 v[116:119], v[44:47], a[36:39], v[116:119]
  s_add_u32 s23, s22, 0
  v_cvt_pk_bf16_f32 v120, v104, v105
  v_cvt_pk_bf16_f32 v121, v106, v107
  v_cvt_pk_bf16_f32 v122, v108, v109
  v_cvt_pk_bf16_f32 v123, v110, v111
  buffer_store_dwordx4 v[120:123], v2, s[4:7], s23 offen
  v_mfma_f32_16x16x32_bf16 v[112:115], v[24:27], a[40:43], v[112:115]
  v_mfma_f32_16x16x32_bf16 v[116:119], v[48:51], a[40:43], v[116:119]
  v_mfma_f32_16x16x32_bf16 v[112:115], v[28:31], a[44:47], v[112:115]
  v_mfma_f32_16x16x32_bf16 v[116:119], v[52:55], a[44:47], v[116:119]
  v_mfma_f32_16x16x32_bf16 v[104:107], v[8:11], a[48:51], 0
  v_mfma_f32_16x16x32_bf16 v[108:111], v[32:35], a[48:51], 0
  v_mfma_f32_16x16x32_bf16 v[104:107], v[12:15], a[52:55], v[104:107]
  v_mfma_f32_16x16x32_bf16 v[108:111], v[36:39], a[52:55], v[108:111]
  v_mfma_f32_16x16x32_bf16 v[104:107], v[16:19], a[56:59], v[104:107]
  v_mfma_f32_16x16x32_bf16 v[108:111], v[40:43], a[56:59], v[108:111]
  v_mfma_f32_16x16x32_bf16 v[104:107], v[20:23], a[60:63], v[104:107]
  v_mfma_f32_16x16x32_bf16 v[108:111], v[44:47], a[60:63], v[108:111]
  s_add_u32 s23, s22, 20480
  v_cvt_pk_bf16_f32 v124, v112, v113
  v_cvt_pk_bf16_f32 v125, v114, v115
  v_cvt_pk_bf16_f32 v126, v116, v117
  v_cvt_pk_bf16_f32 v127, v118, v119
  buffer_store_dwordx4 v[124:127], v2, s[4:7], s23 offen
  v_mfma_f32_16x16x32_bf16 v[104:107], v[24:27], a[64:67], v[104:107]
  v_mfma_f32_16x16x32_bf16 v[108:111], v[48:51], a[64:67], v[108:111]
  v_mfma_f32_16x16x32_bf16 v[104:107], v[28:31], a[68:71], v[104:107]
  v_mfma_f32_16x16x32_bf16 v[108:111], v[52:55], a[68:71], v[108:111]
  v_mfma_f32_16x16x32_bf16 v[112:115], v[8:11], a[72:75], 0
  v_mfma_f32_16x16x32_bf16 v[116:119], v[32:35], a[72:75], 0
  v_mfma_f32_16x16x32_bf16 v[112:115], v[12:15], a[76:79], v[112:115]
  v_mfma_f32_16x16x32_bf16 v[116:119], v[36:39], a[76:79], v[116:119]
  v_mfma_f32_16x16x32_bf16 v[112:115], v[16:19], a[80:83], v[112:115]
  v_mfma_f32_16x16x32_bf16 v[116:119], v[40:43], a[80:83], v[116:119]
  v_mfma_f32_16x16x32_bf16 v[112:115], v[20:23], a[84:87], v[112:115]
  v_mfma_f32_16x16x32_bf16 v[116:119], v[44:47], a[84:87], v[116:119]
  s_add_u32 s23, s22, 40960
  v_cvt_pk_bf16_f32 v120, v104, v105
  v_cvt_pk_bf16_f32 v121, v106, v107
  v_cvt_pk_bf16_f32 v122, v108, v109
  v_cvt_pk_bf16_f32 v123, v110, v111
  buffer_store_dwordx4 v[120:123], v2, s[4:7], s23 offen
  v_mfma_f32_16x16x32_bf16 v[112:115], v[24:27], a[88:91], v[112:115]
  v_mfma_f32_16x16x32_bf16 v[116:119], v[48:51], a[88:91], v[116:119]
  v_mfma_f32_16x16x32_bf16 v[112:115], v[28:31], a[92:95], v[112:115]
  v_mfma_f32_16x16x32_bf16 v[116:119], v[52:55], a[92:95], v[116:119]
  s_waitcnt vmcnt(3)
  s_barrier
  ds_read_b128 v[56:59], v2 offset:0
  ds_read_b128 v[60:63], v2 offset:1024
  ds_read_b128 v[64:67], v2 offset:2048
  ds_read_b128 v[68:71], v2 offset:3072
  ds_read_b128 v[72:75], v2 offset:4096
  ds_read_b128 v[76:79], v2 offset:5120
  ds_read_b128 v[80:83], v2 offset:6144
  ds_read_b128 v[84:87], v2 offset:7168
  ds_read_b128 v[88:91], v2 offset:8192
  ds_read_b128 v[92:95], v2 offset:9216
  ds_read_b128 v[96:99], v2 offset:10240
  ds_read_b128 v[100:103], v2 offset:11264
  v_mfma_f32_16x16x32_bf16 v[104:107], v[8:11], a[96:99], 0
  v_mfma_f32_16x16x32_bf16 v[108:111], v[32:35], a[96:99], 0
  v_mfma_f32_16x16x32_bf16 v[104:107], v[12:15], a[100:103], v[104:107]
  v_mfma_f32_16x16x32_bf16 v[108:111], v[36:39], a[100:103], v[108:111]
  v_mfma_f32_16x16x32_bf16 v[104:107], v[16:19], a[104:107], v[104:107]
  v_mfma_f32_16x16x32_bf16 v[108:111], v[40:43], a[104:107], v[108:111]
  v_mfma_f32_16x16x32_bf16 v[104:107], v[20:23], a[108:111], v[104:107]
  v_mfma_f32_16x16x32_bf16 v[108:111], v[44:47], a[108:111], v[108:111]
  s_add_u32 s23, s22, 61440
  v_cvt_pk_bf16_f32 v124, v112, v113
  v_cvt_pk_bf16_f32 v125, v114, v115
  v_cvt_pk_bf16_f32 v126, v116, v117
  v_cvt_pk_bf16_f32 v127, v118, v119
  buffer_store_dwordx4 v[124:127], v2, s[4:7], s23 offen
  v_mfma_f32_16x16x32_bf16 v[104:107], v[24:27], a[112:115], v[104:107]
  v_mfma_f32_16x16x32_bf16 v[108:111], v[48:51], a[112:115], v[108:111]
  v_mfma_f32_16x16x32_bf16 v[104:107], v[28:31], a[116:119], v[104:107]
  v_mfma_f32_16x16x32_bf16 v[108:111], v[52:55], a[116:119], v[108:111]
  s_waitcnt lgkmcnt(0)
  v_mfma_f32_16x16x32_bf16 v[112:115], v[56:59], a[0:3], 0
  v_mfma_f32_16x16x32_bf16 v[116:119], v[80:83], a[0:3], 0
  v_mfma_f32_16x16x32_bf16 v[112:115], v[60:63], a[4:7], v[112:115]
  v_mfma_f32_16x16x32_bf16 v[116:119], v[84:87], a[4:7], v[116:119]
  v_mfma_f32_16x16x32_bf16 v[112:115], v[64:67], a[8:11], v[112:115]
  v_mfma_f32_16x16x32_bf16 v[116:119], v[88:91], a[8:11], v[116:119]
  v_mfma_f32_16x16x32_bf16 v[112:115], v[68:71], a[12:15], v[112:115]
  v_mfma_f32_16x16x32_bf16 v[116:119], v[92:95], a[12:15], v[116:119]
  s_add_u32 s23, s22, 81920
  v_cvt_pk_bf16_f32 v120, v104, v105
  v_cvt_pk_bf16_f32 v121, v106, v107
  v_cvt_pk_bf16_f32 v122, v108, v109
  v_cvt_pk_bf16_f32 v123, v110, v111
  buffer_store_dwordx4 v[120:123], v2, s[4:7], s23 offen
  v_mfma_f32_16x16x32_bf16 v[112:115], v[72:75], a[16:19], v[112:115]
  v_mfma_f32_16x16x32_bf16 v[116:119], v[96:99], a[16:19], v[116:119]
  v_mfma_f32_16x16x32_bf16 v[112:115], v[76:79], a[20:23], v[112:115]
  v_mfma_f32_16x16x32_bf16 v[116:119], v[100:103], a[20:23], v[116:119]
  v_mfma_f32_16x16x32_bf16 v[104:107], v[56:59], a[24:27], 0
  v_mfma_f32_16x16x32_bf16 v[108:111], v[80:83], a[24:27], 0
  v_mfma_f32_16x16x32_bf16 v[104:107], v[60:63], a[28:31], v[104:107]
  v_mfma_f32_16x16x32_bf16 v[108:111], v[84:87], a[28:31], v[108:111]
  v_mfma_f32_16x16x32_bf16 v[104:107], v[64:67], a[32:35], v[104:107]
  v_mfma_f32_16x16x32_bf16 v[108:111], v[88:91], a[32:35], v[108:111]
  v_mfma_f32_16x16x32_bf16 v[104:107], v[68:71], a[36:39], v[104:107]
  v_mfma_f32_16x16x32_bf16 v[108:111], v[92:95], a[36:39], v[108:111]
  s_add_u32 s23, s22, 1024
  v_cvt_pk_bf16_f32 v124, v112, v113
  v_cvt_pk_bf16_f32 v125, v114, v115
  v_cvt_pk_bf16_f32 v126, v116, v117
  v_cvt_pk_bf16_f32 v127, v118, v119
  buffer_store_dwordx4 v[124:127], v2, s[4:7], s23 offen
  v_mfma_f32_16x16x32_bf16 v[104:107], v[72:75], a[40:43], v[104:107]
  v_mfma_f32_16x16x32_bf16 v[108:111], v[96:99], a[40:43], v[108:111]
  v_mfma_f32_16x16x32_bf16 v[104:107], v[76:79], a[44:47], v[104:107]
  v_mfma_f32_16x16x32_bf16 v[108:111], v[100:103], a[44:47], v[108:111]
  v_mfma_f32_16x16x32_bf16 v[112:115], v[56:59], a[48:51], 0
  v_mfma_f32_16x16x32_bf16 v[116:119], v[80:83], a[48:51], 0
  v_mfma_f32_16x16x32_bf16 v[112:115], v[60:63], a[52:55], v[112:115]
  v_mfma_f32_16x16x32_bf16 v[116:119], v[84:87], a[52:55], v[116:119]
  v_mfma_f32_16x16x32_bf16 v[112:115], v[64:67], a[56:59], v[112:115]
  v_mfma_f32_16x16x32_bf16 v[116:119], v[88:91], a[56:59], v[116:119]
  v_mfma_f32_16x16x32_bf16 v[112:115], v[68:71], a[60:63], v[112:115]
  v_mfma_f32_16x16x32_bf16 v[116:119], v[92:95], a[60:63], v[116:119]
  s_add_u32 s23, s22, 21504
  v_cvt_pk_bf16_f32 v120, v104, v105
  v_cvt_pk_bf16_f32 v121, v106, v107
  v_cvt_pk_bf16_f32 v122, v108, v109
  v_cvt_pk_bf16_f32 v123, v110, v111
  buffer_store_dwordx4 v[120:123], v2, s[4:7], s23 offen
  v_mfma_f32_16x16x32_bf16 v[112:115], v[72:75], a[64:67], v[112:115]
  v_mfma_f32_16x16x32_bf16 v[116:119], v[96:99], a[64:67], v[116:119]
  v_mfma_f32_16x16x32_bf16 v[112:115], v[76:79], a[68:71], v[112:115]
  v_mfma_f32_16x16x32_bf16 v[116:119], v[100:103], a[68:71], v[116:119]
  v_mfma_f32_16x16x32_bf16 v[104:107], v[56:59], a[72:75], 0
  v_mfma_f32_16x16x32_bf16 v[108:111], v[80:83], a[72:75], 0
  v_mfma_f32_16x16x32_bf16 v[104:107], v[60:63], a[76:79], v[104:107]
  v_mfma_f32_16x16x32_bf16 v[108:111], v[84:87], a[76:79], v[108:111]
  v_mfma_f32_16x16x32_bf16 v[104:107], v[64:67], a[80:83], v[104:107]
  v_mfma_f32_16x16x32_bf16 v[108:111], v[88:91], a[80:83], v[108:111]
  v_mfma_f32_16x16x32_bf16 v[104:107], v[68:71], a[84:87], v[104:107]
  v_mfma_f32_16x16x32_bf16 v[108:111], v[92:95], a[84:87], v[108:111]
  s_add_u32 s23, s22, 41984
  v_cvt_pk_bf16_f32 v124, v112, v113
  v_cvt_pk_bf16_f32 v125, v114, v115
  v_cvt_pk_bf16_f32 v126, v116, v117
  v_cvt_pk_bf16_f32 v127, v118, v119
  buffer_store_dwordx4 v[124:127], v2, s[4:7], s23 offen
  v_mfma_f32_16x16x32_bf16 v[104:107], v[72:75], a[88:91], v[104:107]
  v_mfma_f32_16x16x32_bf16 v[108:111], v[96:99], a[88:91], v[108:111]
  v_mfma_f32_16x16x32_bf16 v[104:107], v[76:79], a[92:95], v[104:107]
  v_mfma_f32_16x16x32_bf16 v[108:111], v[100:103], a[92:95], v[108:111]
  ds_read_b128 v[8:11], v2 offset:12288
  ds_read_b128 v[12:15], v2 offset:13312
  ds_read_b128 v[16:19], v2 offset:14336
  ds_read_b128 v[20:23], v2 offset:15360
  ds_read_b128 v[24:27], v2 offset:16384
  ds_read_b128 v[28:31], v2 offset:17408
  ds_read_b128 v[32:35], v2 offset:18432
  ds_read_b128 v[36:39], v2 offset:19456
  ds_read_b128 v[40:43], v2 offset:20480
  ds_read_b128 v[44:47], v2 offset:21504
  ds_read_b128 v[48:51], v2 offset:22528
  ds_read_b128 v[52:55], v2 offset:23552
  v_mfma_f32_16x16x32_bf16 v[112:115], v[56:59], a[96:99], 0
  v_mfma_f32_16x16x32_bf16 v[116:119], v[80:83], a[96:99], 0
  v_mfma_f32_16x16x32_bf16 v[112:115], v[60:63], a[100:103], v[112:115]
  v_mfma_f32_16x16x32_bf16 v[116:119], v[84:87], a[100:103], v[116:119]
  v_mfma_f32_16x16x32_bf16 v[112:115], v[64:67], a[104:107], v[112:115]
  v_mfma_f32_16x16x32_bf16 v[116:119], v[88:91], a[104:107], v[116:119]
  v_mfma_f32_16x16x32_bf16 v[112:115], v[68:71], a[108:111], v[112:115]
  v_mfma_f32_16x16x32_bf16 v[116:119], v[92:95], a[108:111], v[116:119]
  s_add_u32 s23, s22, 62464
  v_cvt_pk_bf16_f32 v120, v104, v105
  v_cvt_pk_bf16_f32 v121, v106, v107
  v_cvt_pk_bf16_f32 v122, v108, v109
  v_cvt_pk_bf16_f32 v123, v110, v111
  buffer_store_dwordx4 v[120:123], v2, s[4:7], s23 offen
  v_mfma_f32_16x16x32_bf16 v[112:115], v[72:75], a[112:115], v[112:115]
  v_mfma_f32_16x16x32_bf16 v[116:119], v[96:99], a[112:115], v[116:119]
  v_mfma_f32_16x16x32_bf16 v[112:115], v[76:79], a[116:119], v[112:115]
  v_mfma_f32_16x16x32_bf16 v[116:119], v[100:103], a[116:119], v[116:119]
  s_waitcnt lgkmcnt(0)
  v_mfma_f32_16x16x32_bf16 v[104:107], v[8:11], a[0:3], 0
  v_mfma_f32_16x16x32_bf16 v[108:111], v[32:35], a[0:3], 0
  v_mfma_f32_16x16x32_bf16 v[104:107], v[12:15], a[4:7], v[104:107]
  v_mfma_f32_16x16x32_bf16 v[108:111], v[36:39], a[4:7], v[108:111]
  v_mfma_f32_16x16x32_bf16 v[104:107], v[16:19], a[8:11], v[104:107]
  v_mfma_f32_16x16x32_bf16 v[108:111], v[40:43], a[8:11], v[108:111]
  v_mfma_f32_16x16x32_bf16 v[104:107], v[20:23], a[12:15], v[104:107]
  v_mfma_f32_16x16x32_bf16 v[108:111], v[44:47], a[12:15], v[108:111]
  s_add_u32 s23, s22, 82944
  v_cvt_pk_bf16_f32 v124, v112, v113
  v_cvt_pk_bf16_f32 v125, v114, v115
  v_cvt_pk_bf16_f32 v126, v116, v117
  v_cvt_pk_bf16_f32 v127, v118, v119
  buffer_store_dwordx4 v[124:127], v2, s[4:7], s23 offen
  v_mfma_f32_16x16x32_bf16 v[104:107], v[24:27], a[16:19], v[104:107]
  v_mfma_f32_16x16x32_bf16 v[108:111], v[48:51], a[16:19], v[108:111]
  v_mfma_f32_16x16x32_bf16 v[104:107], v[28:31], a[20:23], v[104:107]
  v_mfma_f32_16x16x32_bf16 v[108:111], v[52:55], a[20:23], v[108:111]
  v_mfma_f32_16x16x32_bf16 v[112:115], v[8:11], a[24:27], 0
  v_mfma_f32_16x16x32_bf16 v[116:119], v[32:35], a[24:27], 0
  v_mfma_f32_16x16x32_bf16 v[112:115], v[12:15], a[28:31], v[112:115]
  v_mfma_f32_16x16x32_bf16 v[116:119], v[36:39], a[28:31], v[116:119]
  v_mfma_f32_16x16x32_bf16 v[112:115], v[16:19], a[32:35], v[112:115]
  v_mfma_f32_16x16x32_bf16 v[116:119], v[40:43], a[32:35], v[116:119]
  v_mfma_f32_16x16x32_bf16 v[112:115], v[20:23], a[36:39], v[112:115]
  v_mfma_f32_16x16x32_bf16 v[116:119], v[44:47], a[36:39], v[116:119]
  s_add_u32 s23, s22, 2048
  v_cvt_pk_bf16_f32 v120, v104, v105
  v_cvt_pk_bf16_f32 v121, v106, v107
  v_cvt_pk_bf16_f32 v122, v108, v109
  v_cvt_pk_bf16_f32 v123, v110, v111
  buffer_store_dwordx4 v[120:123], v2, s[4:7], s23 offen
  v_mfma_f32_16x16x32_bf16 v[112:115], v[24:27], a[40:43], v[112:115]
  v_mfma_f32_16x16x32_bf16 v[116:119], v[48:51], a[40:43], v[116:119]
  v_mfma_f32_16x16x32_bf16 v[112:115], v[28:31], a[44:47], v[112:115]
  v_mfma_f32_16x16x32_bf16 v[116:119], v[52:55], a[44:47], v[116:119]
  v_mfma_f32_16x16x32_bf16 v[104:107], v[8:11], a[48:51], 0
  v_mfma_f32_16x16x32_bf16 v[108:111], v[32:35], a[48:51], 0
  v_mfma_f32_16x16x32_bf16 v[104:107], v[12:15], a[52:55], v[104:107]
  v_mfma_f32_16x16x32_bf16 v[108:111], v[36:39], a[52:55], v[108:111]
  v_mfma_f32_16x16x32_bf16 v[104:107], v[16:19], a[56:59], v[104:107]
  v_mfma_f32_16x16x32_bf16 v[108:111], v[40:43], a[56:59], v[108:111]
  v_mfma_f32_16x16x32_bf16 v[104:107], v[20:23], a[60:63], v[104:107]
  v_mfma_f32_16x16x32_bf16 v[108:111], v[44:47], a[60:63], v[108:111]
  s_add_u32 s23, s22, 22528
  v_cvt_pk_bf16_f32 v124, v112, v113
  v_cvt_pk_bf16_f32 v125, v114, v115
  v_cvt_pk_bf16_f32 v126, v116, v117
  v_cvt_pk_bf16_f32 v127, v118, v119
  buffer_store_dwordx4 v[124:127], v2, s[4:7], s23 offen
  v_mfma_f32_16x16x32_bf16 v[104:107], v[24:27], a[64:67], v[104:107]
  v_mfma_f32_16x16x32_bf16 v[108:111], v[48:51], a[64:67], v[108:111]
  v_mfma_f32_16x16x32_bf16 v[104:107], v[28:31], a[68:71], v[104:107]
  v_mfma_f32_16x16x32_bf16 v[108:111], v[52:55], a[68:71], v[108:111]
  v_mfma_f32_16x16x32_bf16 v[112:115], v[8:11], a[72:75], 0
  v_mfma_f32_16x16x32_bf16 v[116:119], v[32:35], a[72:75], 0
  v_mfma_f32_16x16x32_bf16 v[112:115], v[12:15], a[76:79], v[112:115]
  v_mfma_f32_16x16x32_bf16 v[116:119], v[36:39], a[76:79], v[116:119]
  v_mfma_f32_16x16x32_bf16 v[112:115], v[16:19], a[80:83], v[112:115]
  v_mfma_f32_16x16x32_bf16 v[116:119], v[40:43], a[80:83], v[116:119]
  v_mfma_f32_16x16x32_bf16 v[112:115], v[20:23], a[84:87], v[112:115]
  v_mfma_f32_16x16x32_bf16 v[116:119], v[44:47], a[84:87], v[116:119]
  s_add_u32 s23, s22, 43008
  v_cvt_pk_bf16_f32 v120, v104, v105
  v_cvt_pk_bf16_f32 v121, v106, v107
  v_cvt_pk_bf16_f32 v122, v108, v109
  v_cvt_pk_bf16_f32 v123, v110, v111
  buffer_store_dwordx4 v[120:123], v2, s[4:7], s23 offen
  v_mfma_f32_16x16x32_bf16 v[112:115], v[24:27], a[88:91], v[112:115]
  v_mfma_f32_16x16x32_bf16 v[116:119], v[48:51], a[88:91], v[116:119]
  v_mfma_f32_16x16x32_bf16 v[112:115], v[28:31], a[92:95], v[112:115]
  v_mfma_f32_16x16x32_bf16 v[116:119], v[52:55], a[92:95], v[116:119]
  ds_read_b128 v[56:59], v2 offset:24576
  ds_read_b128 v[60:63], v2 offset:25600
  ds_read_b128 v[64:67], v2 offset:26624
  ds_read_b128 v[68:71], v2 offset:27648
  ds_read_b128 v[72:75], v2 offset:28672
  ds_read_b128 v[76:79], v2 offset:29696
  ds_read_b128 v[80:83], v2 offset:30720
  ds_read_b128 v[84:87], v2 offset:31744
  ds_read_b128 v[88:91], v2 offset:32768
  ds_read_b128 v[92:95], v2 offset:33792
  ds_read_b128 v[96:99], v2 offset:34816
  ds_read_b128 v[100:103], v2 offset:35840
  v_mfma_f32_16x16x32_bf16 v[104:107], v[8:11], a[96:99], 0
  v_mfma_f32_16x16x32_bf16 v[108:111], v[32:35], a[96:99], 0
  v_mfma_f32_16x16x32_bf16 v[104:107], v[12:15], a[100:103], v[104:107]
  v_mfma_f32_16x16x32_bf16 v[108:111], v[36:39], a[100:103], v[108:111]
  v_mfma_f32_16x16x32_bf16 v[104:107], v[16:19], a[104:107], v[104:107]
  v_mfma_f32_16x16x32_bf16 v[108:111], v[40:43], a[104:107], v[108:111]
  v_mfma_f32_16x16x32_bf16 v[104:107], v[20:23], a[108:111], v[104:107]
  v_mfma_f32_16x16x32_bf16 v[108:111], v[44:47], a[108:111], v[108:111]
  s_add_u32 s23, s22, 63488
  v_cvt_pk_bf16_f32 v124, v112, v113
  v_cvt_pk_bf16_f32 v125, v114, v115
  v_cvt_pk_bf16_f32 v126, v116, v117
  v_cvt_pk_bf16_f32 v127, v118, v119
  buffer_store_dwordx4 v[124:127], v2, s[4:7], s23 offen
  v_mfma_f32_16x16x32_bf16 v[104:107], v[24:27], a[112:115], v[104:107]
  v_mfma_f32_16x16x32_bf16 v[108:111], v[48:51], a[112:115], v[108:111]
  v_mfma_f32_16x16x32_bf16 v[104:107], v[28:31], a[116:119], v[104:107]
  v_mfma_f32_16x16x32_bf16 v[108:111], v[52:55], a[116:119], v[108:111]
  s_waitcnt lgkmcnt(0)
  v_mfma_f32_16x16x32_bf16 v[112:115], v[56:59], a[0:3], 0
  v_mfma_f32_16x16x32_bf16 v[116:119], v[80:83], a[0:3], 0
  v_mfma_f32_16x16x32_bf16 v[112:115], v[60:63], a[4:7], v[112:115]
  v_mfma_f32_16x16x32_bf16 v[116:119], v[84:87], a[4:7], v[116:119]
  v_mfma_f32_16x16x32_bf16 v[112:115], v[64:67], a[8:11], v[112:115]
  v_mfma_f32_16x16x32_bf16 v[116:119], v[88:91], a[8:11], v[116:119]
  v_mfma_f32_16x16x32_bf16 v[112:115], v[68:71], a[12:15], v[112:115]
  v_mfma_f32_16x16x32_bf16 v[116:119], v[92:95], a[12:15], v[116:119]
  s_add_u32 s23, s22, 83968
  v_cvt_pk_bf16_f32 v120, v104, v105
  v_cvt_pk_bf16_f32 v121, v106, v107
  v_cvt_pk_bf16_f32 v122, v108, v109
  v_cvt_pk_bf16_f32 v123, v110, v111
  buffer_store_dwordx4 v[120:123], v2, s[4:7], s23 offen
  v_mfma_f32_16x16x32_bf16 v[112:115], v[72:75], a[16:19], v[112:115]
  v_mfma_f32_16x16x32_bf16 v[116:119], v[96:99], a[16:19], v[116:119]
  v_mfma_f32_16x16x32_bf16 v[112:115], v[76:79], a[20:23], v[112:115]
  v_mfma_f32_16x16x32_bf16 v[116:119], v[100:103], a[20:23], v[116:119]
  v_mfma_f32_16x16x32_bf16 v[104:107], v[56:59], a[24:27], 0
  v_mfma_f32_16x16x32_bf16 v[108:111], v[80:83], a[24:27], 0
  v_mfma_f32_16x16x32_bf16 v[104:107], v[60:63], a[28:31], v[104:107]
  v_mfma_f32_16x16x32_bf16 v[108:111], v[84:87], a[28:31], v[108:111]
  v_mfma_f32_16x16x32_bf16 v[104:107], v[64:67], a[32:35], v[104:107]
  v_mfma_f32_16x16x32_bf16 v[108:111], v[88:91], a[32:35], v[108:111]
  v_mfma_f32_16x16x32_bf16 v[104:107], v[68:71], a[36:39], v[104:107]
  v_mfma_f32_16x16x32_bf16 v[108:111], v[92:95], a[36:39], v[108:111]
  s_add_u32 s23, s22, 3072
  v_cvt_pk_bf16_f32 v124, v112, v113
  v_cvt_pk_bf16_f32 v125, v114, v115
  v_cvt_pk_bf16_f32 v126, v116, v117
  v_cvt_pk_bf16_f32 v127, v118, v119
  buffer_store_dwordx4 v[124:127], v2, s[4:7], s23 offen
  v_mfma_f32_16x16x32_bf16 v[104:107], v[72:75], a[40:43], v[104:107]
  v_mfma_f32_16x16x32_bf16 v[108:111], v[96:99], a[40:43], v[108:111]
  v_mfma_f32_16x16x32_bf16 v[104:107], v[76:79], a[44:47], v[104:107]
  v_mfma_f32_16x16x32_bf16 v[108:111], v[100:103], a[44:47], v[108:111]
  v_mfma_f32_16x16x32_bf16 v[112:115], v[56:59], a[48:51], 0
  v_mfma_f32_16x16x32_bf16 v[116:119], v[80:83], a[48:51], 0
  v_mfma_f32_16x16x32_bf16 v[112:115], v[60:63], a[52:55], v[112:115]
  v_mfma_f32_16x16x32_bf16 v[116:119], v[84:87], a[52:55], v[116:119]
  v_mfma_f32_16x16x32_bf16 v[112:115], v[64:67], a[56:59], v[112:115]
  v_mfma_f32_16x16x32_bf16 v[116:119], v[88:91], a[56:59], v[116:119]
  v_mfma_f32_16x16x32_bf16 v[112:115], v[68:71], a[60:63], v[112:115]
  v_mfma_f32_16x16x32_bf16 v[116:119], v[92:95], a[60:63], v[116:119]
  s_add_u32 s23, s22, 23552
  v_cvt_pk_bf16_f32 v120, v104, v105
  v_cvt_pk_bf16_f32 v121, v106, v107
  v_cvt_pk_bf16_f32 v122, v108, v109
  v_cvt_pk_bf16_f32 v123, v110, v111
  buffer_store_dwordx4 v[120:123], v2, s[4:7], s23 offen
  v_mfma_f32_16x16x32_bf16 v[112:115], v[72:75], a[64:67], v[112:115]
  v_mfma_f32_16x16x32_bf16 v[116:119], v[96:99], a[64:67], v[116:119]
  v_mfma_f32_16x16x32_bf16 v[112:115], v[76:79], a[68:71], v[112:115]
  v_mfma_f32_16x16x32_bf16 v[116:119], v[100:103], a[68:71], v[116:119]
  v_mfma_f32_16x16x32_bf16 v[104:107], v[56:59], a[72:75], 0
  v_mfma_f32_16x16x32_bf16 v[108:111], v[80:83], a[72:75], 0
  v_mfma_f32_16x16x32_bf16 v[104:107], v[60:63], a[76:79], v[104:107]
  v_mfma_f32_16x16x32_bf16 v[108:111], v[84:87], a[76:79], v[108:111]
  v_mfma_f32_16x16x32_bf16 v[104:107], v[64:67], a[80:83], v[104:107]
  v_mfma_f32_16x16x32_bf16 v[108:111], v[88:91], a[80:83], v[108:111]
  v_mfma_f32_16x16x32_bf16 v[104:107], v[68:71], a[84:87], v[104:107]
  v_mfma_f32_16x16x32_bf16 v[108:111], v[92:95], a[84:87], v[108:111]
  s_add_u32 s23, s22, 44032
  v_cvt_pk_bf16_f32 v124, v112, v113
  v_cvt_pk_bf16_f32 v125, v114, v115
  v_cvt_pk_bf16_f32 v126, v116, v117
  v_cvt_pk_bf16_f32 v127, v118, v119
  buffer_store_dwordx4 v[124:127], v2, s[4:7], s23 offen
  v_mfma_f32_16x16x32_bf16 v[104:107], v[72:75], a[88:91], v[104:107]
  v_mfma_f32_16x16x32_bf16 v[108:111], v[96:99], a[88:91], v[108:111]
  v_mfma_f32_16x16x32_bf16 v[104:107], v[76:79], a[92:95], v[104:107]
  v_mfma_f32_16x16x32_bf16 v[108:111], v[100:103], a[92:95], v[108:111]
  ds_read_b128 v[8:11], v2 offset:36864
  ds_read_b128 v[12:15], v2 offset:37888
  ds_read_b128 v[16:19], v2 offset:38912
  ds_read_b128 v[20:23], v2 offset:39936
  ds_read_b128 v[24:27], v2 offset:40960
  ds_read_b128 v[28:31], v2 offset:41984
  ds_read_b128 v[32:35], v2 offset:43008
  ds_read_b128 v[36:39], v2 offset:44032
  ds_read_b128 v[40:43], v2 offset:45056
  ds_read_b128 v[44:47], v2 offset:46080
  ds_read_b128 v[48:51], v2 offset:47104
  ds_read_b128 v[52:55], v2 offset:48128
  v_mfma_f32_16x16x32_bf16 v[112:115], v[56:59], a[96:99], 0
  v_mfma_f32_16x16x32_bf16 v[116:119], v[80:83], a[96:99], 0
  v_mfma_f32_16x16x32_bf16 v[112:115], v[60:63], a[100:103], v[112:115]
  v_mfma_f32_16x16x32_bf16 v[116:119], v[84:87], a[100:103], v[116:119]
  v_mfma_f32_16x16x32_bf16 v[112:115], v[64:67], a[104:107], v[112:115]
  v_mfma_f32_16x16x32_bf16 v[116:119], v[88:91], a[104:107], v[116:119]
  v_mfma_f32_16x16x32_bf16 v[112:115], v[68:71], a[108:111], v[112:115]
  v_mfma_f32_16x16x32_bf16 v[116:119], v[92:95], a[108:111], v[116:119]
  s_add_u32 s23, s22, 64512
  v_cvt_pk_bf16_f32 v120, v104, v105
  v_cvt_pk_bf16_f32 v121, v106, v107
  v_cvt_pk_bf16_f32 v122, v108, v109
  v_cvt_pk_bf16_f32 v123, v110, v111
  buffer_store_dwordx4 v[120:123], v2, s[4:7], s23 offen
  v_mfma_f32_16x16x32_bf16 v[112:115], v[72:75], a[112:115], v[112:115]
  v_mfma_f32_16x16x32_bf16 v[116:119], v[96:99], a[112:115], v[116:119]
  v_mfma_f32_16x16x32_bf16 v[112:115], v[76:79], a[116:119], v[112:115]
  v_mfma_f32_16x16x32_bf16 v[116:119], v[100:103], a[116:119], v[116:119]
  s_waitcnt lgkmcnt(0)
  v_mfma_f32_16x16x32_bf16 v[104:107], v[8:11], a[0:3], 0
  v_mfma_f32_16x16x32_bf16 v[108:111], v[32:35], a[0:3], 0
  v_mfma_f32_16x16x32_bf16 v[104:107], v[12:15], a[4:7], v[104:107]
  v_mfma_f32_16x16x32_bf16 v[108:111], v[36:39], a[4:7], v[108:111]
  v_mfma_f32_16x16x32_bf16 v[104:107], v[16:19], a[8:11], v[104:107]
  v_mfma_f32_16x16x32_bf16 v[108:111], v[40:43], a[8:11], v[108:111]
  v_mfma_f32_16x16x32_bf16 v[104:107], v[20:23], a[12:15], v[104:107]
  v_mfma_f32_16x16x32_bf16 v[108:111], v[44:47], a[12:15], v[108:111]
  s_add_u32 s23, s22, 84992
  v_cvt_pk_bf16_f32 v124, v112, v113
  v_cvt_pk_bf16_f32 v125, v114, v115
  v_cvt_pk_bf16_f32 v126, v116, v117
  v_cvt_pk_bf16_f32 v127, v118, v119
  buffer_store_dwordx4 v[124:127], v2, s[4:7], s23 offen
  v_mfma_f32_16x16x32_bf16 v[104:107], v[24:27], a[16:19], v[104:107]
  v_mfma_f32_16x16x32_bf16 v[108:111], v[48:51], a[16:19], v[108:111]
  v_mfma_f32_16x16x32_bf16 v[104:107], v[28:31], a[20:23], v[104:107]
  v_mfma_f32_16x16x32_bf16 v[108:111], v[52:55], a[20:23], v[108:111]
  v_mfma_f32_16x16x32_bf16 v[112:115], v[8:11], a[24:27], 0
  v_mfma_f32_16x16x32_bf16 v[116:119], v[32:35], a[24:27], 0
  v_mfma_f32_16x16x32_bf16 v[112:115], v[12:15], a[28:31], v[112:115]
  v_mfma_f32_16x16x32_bf16 v[116:119], v[36:39], a[28:31], v[116:119]
  v_mfma_f32_16x16x32_bf16 v[112:115], v[16:19], a[32:35], v[112:115]
  v_mfma_f32_16x16x32_bf16 v[116:119], v[40:43], a[32:35], v[116:119]
  v_mfma_f32_16x16x32_bf16 v[112:115], v[20:23], a[36:39], v[112:115]
  v_mfma_f32_16x16x32_bf16 v[116:119], v[44:47], a[36:39], v[116:119]
  s_add_u32 s23, s22, 4096
  v_cvt_pk_bf16_f32 v120, v104, v105
  v_cvt_pk_bf16_f32 v121, v106, v107
  v_cvt_pk_bf16_f32 v122, v108, v109
  v_cvt_pk_bf16_f32 v123, v110, v111
  buffer_store_dwordx4 v[120:123], v2, s[4:7], s23 offen
  v_mfma_f32_16x16x32_bf16 v[112:115], v[24:27], a[40:43], v[112:115]
  v_mfma_f32_16x16x32_bf16 v[116:119], v[48:51], a[40:43], v[116:119]
  v_mfma_f32_16x16x32_bf16 v[112:115], v[28:31], a[44:47], v[112:115]
  v_mfma_f32_16x16x32_bf16 v[116:119], v[52:55], a[44:47], v[116:119]
  v_mfma_f32_16x16x32_bf16 v[104:107], v[8:11], a[48:51], 0
  v_mfma_f32_16x16x32_bf16 v[108:111], v[32:35], a[48:51], 0
  v_mfma_f32_16x16x32_bf16 v[104:107], v[12:15], a[52:55], v[104:107]
  v_mfma_f32_16x16x32_bf16 v[108:111], v[36:39], a[52:55], v[108:111]
  v_mfma_f32_16x16x32_bf16 v[104:107], v[16:19], a[56:59], v[104:107]
  v_mfma_f32_16x16x32_bf16 v[108:111], v[40:43], a[56:59], v[108:111]
  v_mfma_f32_16x16x32_bf16 v[104:107], v[20:23], a[60:63], v[104:107]
  v_mfma_f32_16x16x32_bf16 v[108:111], v[44:47], a[60:63], v[108:111]
  s_add_u32 s23, s22, 24576
  v_cvt_pk_bf16_f32 v124, v112, v113
  v_cvt_pk_bf16_f32 v125, v114, v115
  v_cvt_pk_bf16_f32 v126, v116, v117
  v_cvt_pk_bf16_f32 v127, v118, v119
  buffer_store_dwordx4 v[124:127], v2, s[4:7], s23 offen
  v_mfma_f32_16x16x32_bf16 v[104:107], v[24:27], a[64:67], v[104:107]
  v_mfma_f32_16x16x32_bf16 v[108:111], v[48:51], a[64:67], v[108:111]
  v_mfma_f32_16x16x32_bf16 v[104:107], v[28:31], a[68:71], v[104:107]
  v_mfma_f32_16x16x32_bf16 v[108:111], v[52:55], a[68:71], v[108:111]
  v_mfma_f32_16x16x32_bf16 v[112:115], v[8:11], a[72:75], 0
  v_mfma_f32_16x16x32_bf16 v[116:119], v[32:35], a[72:75], 0
  v_mfma_f32_16x16x32_bf16 v[112:115], v[12:15], a[76:79], v[112:115]
  v_mfma_f32_16x16x32_bf16 v[116:119], v[36:39], a[76:79], v[116:119]
  v_mfma_f32_16x16x32_bf16 v[112:115], v[16:19], a[80:83], v[112:115]
  v_mfma_f32_16x16x32_bf16 v[116:119], v[40:43], a[80:83], v[116:119]
  v_mfma_f32_16x16x32_bf16 v[112:115], v[20:23], a[84:87], v[112:115]
  v_mfma_f32_16x16x32_bf16 v[116:119], v[44:47], a[84:87], v[116:119]
  s_add_u32 s23, s22, 45056
  v_cvt_pk_bf16_f32 v120, v104, v105
  v_cvt_pk_bf16_f32 v121, v106, v107
  v_cvt_pk_bf16_f32 v122, v108, v109
  v_cvt_pk_bf16_f32 v123, v110, v111
  buffer_store_dwordx4 v[120:123], v2, s[4:7], s23 offen
  v_mfma_f32_16x16x32_bf16 v[112:115], v[24:27], a[88:91], v[112:115]
  v_mfma_f32_16x16x32_bf16 v[116:119], v[48:51], a[88:91], v[116:119]
  v_mfma_f32_16x16x32_bf16 v[112:115], v[28:31], a[92:95], v[112:115]
  v_mfma_f32_16x16x32_bf16 v[116:119], v[52:55], a[92:95], v[116:119]
  v_mfma_f32_16x16x32_bf16 v[104:107], v[8:11], a[96:99], 0
  v_mfma_f32_16x16x32_bf16 v[108:111], v[32:35], a[96:99], 0
  v_mfma_f32_16x16x32_bf16 v[104:107], v[12:15], a[100:103], v[104:107]
  v_mfma_f32_16x16x32_bf16 v[108:111], v[36:39], a[100:103], v[108:111]
  v_mfma_f32_16x16x32_bf16 v[104:107], v[16:19], a[104:107], v[104:107]
  v_mfma_f32_16x16x32_bf16 v[108:111], v[40:43], a[104:107], v[108:111]
  v_mfma_f32_16x16x32_bf16 v[104:107], v[20:23], a[108:111], v[104:107]
  v_mfma_f32_16x16x32_bf16 v[108:111], v[44:47], a[108:111], v[108:111]
  s_add_u32 s23, s22, 65536
  v_cvt_pk_bf16_f32 v124, v112, v113
  v_cvt_pk_bf16_f32 v125, v114, v115
  v_cvt_pk_bf16_f32 v126, v116, v117
  v_cvt_pk_bf16_f32 v127, v118, v119
  buffer_store_dwordx4 v[124:127], v2, s[4:7], s23 offen
  v_mfma_f32_16x16x32_bf16 v[104:107], v[24:27], a[112:115], v[104:107]
  v_mfma_f32_16x16x32_bf16 v[108:111], v[48:51], a[112:115], v[108:111]
  v_mfma_f32_16x16x32_bf16 v[104:107], v[28:31], a[116:119], v[104:107]
  v_mfma_f32_16x16x32_bf16 v[108:111], v[52:55], a[116:119], v[108:111]
  s_add_u32 s23, s22, 86016
  s_nop 3
  v_cvt_pk_bf16_f32 v120, v104, v105
  v_cvt_pk_bf16_f32 v121, v106, v107
  s_nop 0
  v_cvt_pk_bf16_f32 v122, v108, v109
  v_cvt_pk_bf16_f32 v123, v110, v111
  buffer_store_dwordx4 v[120:123], v2, s[4:7], s23 offen
  s_endpgm
prep_nobmat:
  s_sub_u32 s2, s2, 264
  s_lshl_b32 s2, s2, 2
  s_add_u32 s2, s2, s3
  s_cmp_ge_u32 s2, 512
  s_cbranch_scc1 prep_noto2
  v_and_b32 v2, 15, v1
  v_lshrrev_b32 v3, 4, v1
  v_mul_u32_u24 v4, 1280, v3
  v_lshl_add_u32 v4, v2, 4, v4
  s_mul_i32 s20, s2, 5120
  buffer_load_dwordx4 v[8:11], v4, s[36:39], s20 offen offset:0
  buffer_load_dwordx4 v[12:15], v4, s[36:39], s20 offen offset:256
  buffer_load_dwordx4 v[16:19], v4, s[36:39], s20 offen offset:512
  buffer_load_dwordx4 v[20:23], v4, s[36:39], s20 offen offset:768
  buffer_load_dwordx4 v[24:27], v4, s[36:39], s20 offen offset:1024
  v_lshrrev_b32 v5, 2, v2
  v_lshlrev_b32 v5, 10, v5
  v_and_b32 v6, 3, v2
  v_lshl_add_u32 v5, v6, 8, v5
  v_lshl_add_u32 v5, v3, 4, v5
  s_lshr_b32 s21, s2, 2
  s_mul_i32 s21, s21, 20480
  s_and_b32 s22, s2, 3
  s_lshl_b32 s22, s22, 6
  s_add_u32 s21, s21, s22
  s_add_u32 s21, s21, 26214400
  s_mov_b32 s30, 0xffff0000
  s_waitcnt vmcnt(0)
  v_lshlrev_b32 v32, 16, v8
  v_and_b32 v33, s30, v8
  v_lshlrev_b32 v34, 16, v9
  v_and_b32 v35, s30, v9
  v_pk_add_f32 v[6:7], v[32:33], v[34:35]
  v_lshlrev_b32 v36, 16, v10
  v_and_b32 v37, s30, v10
  v_pk_add_f32 v[6:7], v[6:7], v[36:37]
  v_lshlrev_b32 v38, 16, v11
  v_and_b32 v39, s30, v11
  v_pk_add_f32 v[6:7], v[6:7], v[38:39]
  v_lshlrev_b32 v40, 16, v12
  v_and_b32 v41, s30, v12
  v_pk_add_f32 v[6:7], v[6:7], v[40:41]
  v_lshlrev_b32 v42, 16, v13
  v_and_b32 v43, s30, v13
  v_pk_add_f32 v[6:7], v[6:7], v[42:43]
  v_lshlrev_b32 v44, 16, v14
  v_and_b32 v45, s30, v14
  v_pk_add_f32 v[6:7], v[6:7], v[44:45]
  v_lshlrev_b32 v46, 16, v15
  v_and_b32 v47, s30, v15
  v_pk_add_f32 v[6:7], v[6:7], v[46:47]
  v_lshlrev_b32 v48, 16, v16
  v_and_b32 v49, s30, v16
  v_pk_add_f32 v[6:7], v[6:7], v[48:49]
  v_lshlrev_b32 v50, 16, v17
  v_and_b32 v51, s30, v17
  v_pk_add_f32 v[6:7], v[6:7], v[50:51]
  v_lshlrev_b32 v52, 16, v18
  v_and_b32 v53, s30, v18
  v_pk_add_f32 v[6:7], v[6:7], v[52:53]
  v_lshlrev_b32 v54, 16, v19
  v_and_b32 v55, s30, v19
  v_pk_add_f32 v[6:7], v[6:7], v[54:55]
  v_lshlrev_b32 v56, 16, v20
  v_and_b32 v57, s30, v20
  v_pk_add_f32 v[6:7], v[6:7], v[56:57]
  v_lshlrev_b32 v58, 16, v21
  v_and_b32 v59, s30, v21
  v_pk_add_f32 v[6:7], v[6:7], v[58:59]
  v_lshlrev_b32 v60, 16, v22
  v_and_b32 v61, s30, v22
  v_pk_add_f32 v[6:7], v[6:7], v[60:61]
  v_lshlrev_b32 v62, 16, v23
  v_and_b32 v63, s30, v23
  v_pk_add_f32 v[6:7], v[6:7], v[62:63]
  v_lshlrev_b32 v64, 16, v24
  v_and_b32 v65, s30, v24
  v_pk_add_f32 v[6:7], v[6:7], v[64:65]
  v_lshlrev_b32 v66, 16, v25
  v_and_b32 v67, s30, v25
  v_pk_add_f32 v[6:7], v[6:7], v[66:67]
  v_lshlrev_b32 v68, 16, v26
  v_and_b32 v69, s30, v26
  v_pk_add_f32 v[6:7], v[6:7], v[68:69]
  v_lshlrev_b32 v70, 16, v27
  v_and_b32 v71, s30, v27
  v_pk_add_f32 v[6:7], v[6:7], v[70:71]
  v_add_f32 v6, v6, v7
  s_nop 1
  v_add_f32_dpp v6, v6, v6 row_ror:8 row_mask:0xf bank_mask:0xf
  s_nop 1
  v_add_f32_dpp v6, v6, v6 row_ror:4 row_mask:0xf bank_mask:0xf
  s_nop 1
  v_add_f32_dpp v6, v6, v6 row_ror:2 row_mask:0xf bank_mask:0xf
  s_nop 1
  v_add_f32_dpp v6, v6, v6 row_ror:1 row_mask:0xf bank_mask:0xf
  v_mul_f32 v6, 0xbacccccd, v6
  v_mov_b32 v7, v6
  v_pk_add_f32 v[32:33], v[32:33], v[6:7]
  v_pk_mul_f32 v[28:29], v[32:33], v[32:33]
  v_pk_add_f32 v[34:35], v[34:35], v[6:7]
  v_pk_fma_f32 v[28:29], v[34:35], v[34:35], v[28:29]
  v_pk_add_f32 v[36:37], v[36:37], v[6:7]
  v_pk_fma_f32 v[28:29], v[36:37], v[36:37], v[28:29]
  v_pk_add_f32 v[38:39], v[38:39], v[6:7]
  v_pk_fma_f32 v[28:29], v[38:39], v[38:39], v[28:29]
  v_pk_add_f32 v[40:41], v[40:41], v[6:7]
  v_pk_fma_f32 v[28:29], v[40:41], v[40:41], v[28:29]
  v_pk_add_f32 v[42:43], v[42:43], v[6:7]
  v_pk_fma_f32 v[28:29], v[42:43], v[42:43], v[28:29]
  v_pk_add_f32 v[44:45], v[44:45], v[6:7]
  v_pk_fma_f32 v[28:29], v[44:45], v[44:45], v[28:29]
  v_pk_add_f32 v[46:47], v[46:47], v[6:7]
  v_pk_fma_f32 v[28:29], v[46:47], v[46:47], v[28:29]
  v_pk_add_f32 v[48:49], v[48:49], v[6:7]
  v_pk_fma_f32 v[28:29], v[48:49], v[48:49], v[28:29]
  v_pk_add_f32 v[50:51], v[50:51], v[6:7]
  v_pk_fma_f32 v[28:29], v[50:51], v[50:51], v[28:29]
  v_pk_add_f32 v[52:53], v[52:53], v[6:7]
  v_pk_fma_f32 v[28:29], v[52:53], v[52:53], v[28:29]
  v_pk_add_f32 v[54:55], v[54:55], v[6:7]
  v_pk_fma_f32 v[28:29], v[54:55], v[54:55], v[28:29]
  v_pk_add_f32 v[56:57], v[56:57], v[6:7]
  v_pk_fma_f32 v[28:29], v[56:57], v[56:57], v[28:29]
  v_pk_add_f32 v[58:59], v[58:59], v[6:7]
  v_pk_fma_f32 v[28:29], v[58:59], v[58:59], v[28:29]
  v_pk_add_f32 v[60:61], v[60:61], v[6:7]
  v_pk_fma_f32 v[28:29], v[60:61], v[60:61], v[28:29]
  v_pk_add_f32 v[62:63], v[62:63], v[6:7]
  v_pk_fma_f32 v[28:29], v[62:63], v[62:63], v[28:29]
  v_pk_add_f32 v[64:65], v[64:65], v[6:7]
  v_pk_fma_f32 v[28:29], v[64:65], v[64:65], v[28:29]
  v_pk_add_f32 v[66:67], v[66:67], v[6:7]
  v_pk_fma_f32 v[28:29], v[66:67], v[66:67], v[28:29]
  v_pk_add_f32 v[68:69], v[68:69], v[6:7]
  v_pk_fma_f32 v[28:29], v[68:69], v[68:69], v[28:29]
  v_pk_add_f32 v[70:71], v[70:71], v[6:7]
  v_pk_fma_f32 v[28:29], v[70:71], v[70:71], v[28:29]
  v_add_f32 v28, v28, v29
  s_nop 1
  v_add_f32_dpp v28, v28, v28 row_ror:8 row_mask:0xf bank_mask:0xf
  s_nop 1
  v_add_f32_dpp v28, v28, v28 row_ror:4 row_mask:0xf bank_mask:0xf
  s_nop 1
  v_add_f32_dpp v28, v28, v28 row_ror:2 row_mask:0xf bank_mask:0xf
  s_nop 1
  v_add_f32_dpp v28, v28, v28 row_ror:1 row_mask:0xf bank_mask:0xf
  v_mov_b32 v6, 0x3727c5ac
  v_fmac_f32 v6, 0x3acccccd, v28
  v_rsq_f32 v6, v6
  s_nop 0
  v_mov_b32 v7, v6
  v_pk_mul_f32 v[32:33], v[32:33], v[6:7]
  v_cvt_pk_bf16_f32 v8, v32, v33
  v_pk_mul_f32 v[34:35], v[34:35], v[6:7]
  v_cvt_pk_bf16_f32 v9, v34, v35
  v_pk_mul_f32 v[36:37], v[36:37], v[6:7]
  v_cvt_pk_bf16_f32 v10, v36, v37
  v_pk_mul_f32 v[38:39], v[38:39], v[6:7]
  v_cvt_pk_bf16_f32 v11, v38, v39
  buffer_store_dwordx4 v[8:11], v5, s[4:7], s21 offen
  s_add_u32 s21, s21, 4096
  v_pk_mul_f32 v[40:41], v[40:41], v[6:7]
  v_cvt_pk_bf16_f32 v12, v40, v41
  v_pk_mul_f32 v[42:43], v[42:43], v[6:7]
  v_cvt_pk_bf16_f32 v13, v42, v43
  v_pk_mul_f32 v[44:45], v[44:45], v[6:7]
  v_cvt_pk_bf16_f32 v14, v44, v45
  v_pk_mul_f32 v[46:47], v[46:47], v[6:7]
  v_cvt_pk_bf16_f32 v15, v46, v47
  buffer_store_dwordx4 v[12:15], v5, s[4:7], s21 offen
  s_add_u32 s21, s21, 4096
  v_pk_mul_f32 v[48:49], v[48:49], v[6:7]
  v_cvt_pk_bf16_f32 v16, v48, v49
  v_pk_mul_f32 v[50:51], v[50:51], v[6:7]
  v_cvt_pk_bf16_f32 v17, v50, v51
  v_pk_mul_f32 v[52:53], v[52:53], v[6:7]
  v_cvt_pk_bf16_f32 v18, v52, v53
  v_pk_mul_f32 v[54:55], v[54:55], v[6:7]
  v_cvt_pk_bf16_f32 v19, v54, v55
  buffer_store_dwordx4 v[16:19], v5, s[4:7], s21 offen
  s_add_u32 s21, s21, 4096
  v_pk_mul_f32 v[56:57], v[56:57], v[6:7]
  v_cvt_pk_bf16_f32 v20, v56, v57
  v_pk_mul_f32 v[58:59], v[58:59], v[6:7]
  v_cvt_pk_bf16_f32 v21, v58, v59
  v_pk_mul_f32 v[60:61], v[60:61], v[6:7]
  v_cvt_pk_bf16_f32 v22, v60, v61
  v_pk_mul_f32 v[62:63], v[62:63], v[6:7]
  v_cvt_pk_bf16_f32 v23, v62, v63
  buffer_store_dwordx4 v[20:23], v5, s[4:7], s21 offen
  s_add_u32 s21, s21, 4096
  v_pk_mul_f32 v[64:65], v[64:65], v[6:7]
  v_cvt_pk_bf16_f32 v24, v64, v65
  v_pk_mul_f32 v[66:67], v[66:67], v[6:7]
  v_cvt_pk_bf16_f32 v25, v66, v67
  v_pk_mul_f32 v[68:69], v[68:69], v[6:7]
  v_cvt_pk_bf16_f32 v26, v68, v69
  v_pk_mul_f32 v[70:71], v[70:71], v[6:7]
  v_cvt_pk_bf16_f32 v27, v70, v71
  buffer_store_dwordx4 v[24:27], v5, s[4:7], s21 offen
  s_add_u32 s21, s21, 4096
  s_endpgm
prep_noto2:
  v_lshlrev_b32 v3, 4, v1
  v_mov_b32 v4, -1
  v_mov_b32 v5, -1
  v_mov_b32 v6, -1
  v_mov_b32 v7, -1
  s_cmp_ge_u32 s2, 528
  s_cbranch_scc1 prep_notinit
  s_sub_u32 s2, s2, 512
  v_bfe_u32 v2, v1, 2, 2
  v_and_b32 v48, 1, v1
  v_lshl_add_u32 v2, v2, 1, v48
  v_mul_u32_u24 v2, 1280, v2
  v_bfe_u32 v48, v1, 1, 1
  v_lshrrev_b32 v49, 4, v1
  v_lshl_add_u32 v50, v49, 1, v48
  v_mul_u32_u24 v50, 80, v50
  v_add_u32 v50, v50, v2
  v_lshl_add_u32 v2, v48, 4, v2
  v_and_b32 v48, 1, v49
  v_lshl_add_u32 v2, v48, 5, v2
  v_lshrrev_b32 v48, 1, v49
  v_mul_u32_u24 v48, 80, v48
  v_add_u32 v2, v2, v48
  buffer_load_dwordx4 v[8:11], v2, s[40:43], 0 offen offset:0
  buffer_load_dwordx4 v[12:15], v2, s[40:43], 0 offen offset:160
  buffer_load_dwordx4 v[16:19], v2, s[40:43], 0 offen offset:320
  buffer_load_dwordx4 v[20:23], v2, s[40:43], 0 offen offset:480
  buffer_load_dwordx4 v[24:27], v2, s[40:43], 0 offen offset:640
  buffer_load_dwordx4 v[28:31], v2, s[40:43], 0 offen offset:800
  buffer_load_dwordx4 v[32:35], v2, s[40:43], 0 offen offset:960
  buffer_load_dwordx4 v[36:39], v2, s[40:43], 0 offen offset:1120
  buffer_load_dwordx4 v[40:43], v50, s[40:43], 0 offen offset:64
  buffer_load_dwordx4 v[44:47], v50, s[40:43], 0 offen offset:704
  s_mul_i32 s20, s2, 20480
  s_add_u32 s20, s20, 61243392
  s_add_u32 s21, s20, 10240
  s_waitcnt vmcnt(0)
  v_min_u32 v8, -2, v8
  v_min_u32 v9, -2, v9
  v_min_u32 v10, -2, v10
  v_min_u32 v11, -2, v11
  v_min_u32 v12, -2, v12
  v_min_u32 v13, -2, v13
  v_min_u32 v14, -2, v14
  v_min_u32 v15, -2, v15
  v_min_u32 v16, -2, v16
  v_min_u32 v17, -2, v17
  v_min_u32 v18, -2, v18
  v_min_u32 v19, -2, v19
  v_min_u32 v20, -2, v20
  v_min_u32 v21, -2, v21
  v_min_u32 v22, -2, v22
  v_min_u32 v23, -2, v23
  v_min_u32 v24, -2, v24
  v_min_u32 v25, -2, v25
  v_min_u32 v26, -2, v26
  v_min_u32 v27, -2, v27
  v_min_u32 v28, -2, v28
  v_min_u32 v29, -2, v29
  v_min_u32 v30, -2, v30
  v_min_u32 v31, -2, v31
  v_min_u32 v32, -2, v32
  v_min_u32 v33, -2, v33
  v_min_u32 v34, -2, v34
  v_min_u32 v35, -2, v35
  v_min_u32 v36, -2, v36
  v_min_u32 v37, -2, v37
  v_min_u32 v38, -2, v38
  v_min_u32 v39, -2, v39
  v_min_u32 v40, -2, v40
  v_min_u32 v41, -2, v41
  v_min_u32 v42, -2, v42
  v_min_u32 v43, -2, v43
  v_min_u32 v44, -2, v44
  v_min_u32 v45, -2, v45
  v_min_u32 v46, -2, v46
  v_min_u32 v47, -2, v47
  buffer_store_dwordx4 v[8:11], v3, s[4:7], s20 offen offset:0
  buffer_store_dwordx4 v[4:7], v3, s[4:7], s21 offen offset:0
  buffer_store_dwordx4 v[12:15], v3, s[4:7], s20 offen offset:1024
  buffer_store_dwordx4 v[4:7], v3, s[4:7], s21 offen offset:1024
  buffer_store_dwordx4 v[16:19], v3, s[4:7], s20 offen offset:2048
  buffer_store_dwordx4 v[4:7], v3, s[4:7], s21 offen offset:2048
  buffer_store_dwordx4 v[20:23], v3, s[4:7], s20 offen offset:3072
  buffer_store_dwordx4 v[4:7], v3, s[4:7], s21 offen offset:3072
  s_add_u32 s20, s20, 4096
  s_add_u32 s21, s21, 4096
  buffer_store_dwordx4 v[24:27], v3, s[4:7], s20 offen offset:0
  buffer_store_dwordx4 v[4:7], v3, s[4:7], s21 offen offset:0
  buffer_store_dwordx4 v[28:31], v3, s[4:7], s20 offen offset:1024
  buffer_store_dwordx4 v[4:7], v3, s[4:7], s21 offen offset:1024
  buffer_store_dwordx4 v[32:35], v3, s[4:7], s20 offen offset:2048
  buffer_store_dwordx4 v[4:7], v3, s[4:7], s21 offen offset:2048
  buffer_store_dwordx4 v[36:39], v3, s[4:7], s20 offen offset:3072
  buffer_store_dwordx4 v[4:7], v3, s[4:7], s21 offen offset:3072
  s_add_u32 s20, s20, 4096
  s_add_u32 s21, s21, 4096
  buffer_store_dwordx4 v[40:43], v3, s[4:7], s20 offen offset:0
  buffer_store_dwordx4 v[4:7], v3, s[4:7], s21 offen offset:0
  buffer_store_dwordx4 v[44:47], v3, s[4:7], s20 offen offset:1024
  buffer_store_dwordx4 v[4:7], v3, s[4:7], s21 offen offset:1024
  s_endpgm
prep_notinit:
  s_cmp_ge_u32 s2, 768
  s_cbranch_scc1 prep_nothb
  s_sub_u32 s2, s2, 528
  s_add_u32 s20, s4, 63995903
  s_and_b32 s20, s20, 0xffe00000
  s_sub_u32 s20, s20, s4
  s_cmp_ge_u32 s2, 120
  s_cselect_b32 s21, 8, 0
  s_add_u32 s21, s21, s2
  s_lshl_b32 s21, s21, 14
  s_add_u32 s20, s20, s21
  buffer_store_dwordx4 v[4:7], v3, s[4:7], s20 offen offset:0
  buffer_store_dwordx4 v[4:7], v3, s[4:7], s20 offen offset:1024
  buffer_store_dwordx4 v[4:7], v3, s[4:7], s20 offen offset:2048
  buffer_store_dwordx4 v[4:7], v3, s[4:7], s20 offen offset:3072
  s_add_u32 s20, s20, 4096
  buffer_store_dwordx4 v[4:7], v3, s[4:7], s20 offen offset:0
  buffer_store_dwordx4 v[4:7], v3, s[4:7], s20 offen offset:1024
  buffer_store_dwordx4 v[4:7], v3, s[4:7], s20 offen offset:2048
  buffer_store_dwordx4 v[4:7], v3, s[4:7], s20 offen offset:3072
  s_add_u32 s20, s20, 4096
  buffer_store_dwordx4 v[4:7], v3, s[4:7], s20 offen offset:0
  buffer_store_dwordx4 v[4:7], v3, s[4:7], s20 offen offset:1024
  buffer_store_dwordx4 v[4:7], v3, s[4:7], s20 offen offset:2048
  buffer_store_dwordx4 v[4:7], v3, s[4:7], s20 offen offset:3072
  s_add_u32 s20, s20, 4096
  buffer_store_dwordx4 v[4:7], v3, s[4:7], s20 offen offset:0
  buffer_store_dwordx4 v[4:7], v3, s[4:7], s20 offen offset:1024
  buffer_store_dwordx4 v[4:7], v3, s[4:7], s20 offen offset:2048
  buffer_store_dwordx4 v[4:7], v3, s[4:7], s20 offen offset:3072
  s_endpgm
prep_nothb:
  s_cmp_ge_u32 s2, 814
  s_cbranch_scc1 prep_end
  s_sub_u32 s2, s2, 768
  s_lshl_b32 s20, s2, 14
  s_add_u32 s21, s20, 61571072
  s_add_u32 s22, s20, 97517568
  s_add_u32 s23, s20, 67534848
  s_cmp_lt_u32 s2, 20
  s_cselect_b32 s20, s21, s22
  s_cmp_lt_u32 s2, 40
  s_cselect_b32 s20, s20, s23
  s_cselect_b32 s21, -1, 0
  v_mov_b32 v4, s21
  v_mov_b32 v5, s21
  v_mov_b32 v6, s21
  v_mov_b32 v7, s21
  buffer_store_dwordx4 v[4:7], v3, s[4:7], s20 offen offset:0
  buffer_store_dwordx4 v[4:7], v3, s[4:7], s20 offen offset:1024
  buffer_store_dwordx4 v[4:7], v3, s[4:7], s20 offen offset:2048
  buffer_store_dwordx4 v[4:7], v3, s[4:7], s20 offen offset:3072
  s_add_u32 s20, s20, 4096
  buffer_store_dwordx4 v[4:7], v3, s[4:7], s20 offen offset:0
  buffer_store_dwordx4 v[4:7], v3, s[4:7], s20 offen offset:1024
  buffer_store_dwordx4 v[4:7], v3, s[4:7], s20 offen offset:2048
  buffer_store_dwordx4 v[4:7], v3, s[4:7], s20 offen offset:3072
  s_add_u32 s20, s20, 4096
  buffer_store_dwordx4 v[4:7], v3, s[4:7], s20 offen offset:0
  buffer_store_dwordx4 v[4:7], v3, s[4:7], s20 offen offset:1024
  buffer_store_dwordx4 v[4:7], v3, s[4:7], s20 offen offset:2048
  buffer_store_dwordx4 v[4:7], v3, s[4:7], s20 offen offset:3072
  s_add_u32 s20, s20, 4096
  buffer_store_dwordx4 v[4:7], v3, s[4:7], s20 offen offset:0
  buffer_store_dwordx4 v[4:7], v3, s[4:7], s20 offen offset:1024
  buffer_store_dwordx4 v[4:7], v3, s[4:7], s20 offen offset:2048
  buffer_store_dwordx4 v[4:7], v3, s[4:7], s20 offen offset:3072
prep_end:
  s_endpgm

.globl mega0_kernel
.p2align 8
.type mega0_kernel,@function
mega0_kernel:
  s_mov_b32 s70, 0
mega_common:
  s_load_dwordx2 s[4:5], s[0:1], 104
  s_mov_b32 s6, 0x10000000
  s_mov_b32 s7, 0x20000
  s_load_dwordx2 s[44:45], s[0:1], 96
  s_mov_b32 s46, 0x100
  s_mov_b32 s47, 0x20000
  s_load_dwordx2 s[84:85], s[0:1], 0
  s_mov_b32 s86, 0x280000
  s_mov_b32 s87, 0x20000
  s_load_dwordx8 s[8:15], s[0:1], 16
  s_mov_b32 s94, 0x780000
  s_mov_b32 s95, 0x20000
  s_mov_b32 s98, 0x780000
  s_mov_b32 s99, 0x20000
  s_mov_b32 s82, -1
  s_mov_b32 s83, 0x0fffffff
  v_lshrrev_b32 v1, 6, v0
  s_nop 0
  v_readfirstlane_b32 s3, v1
  v_and_b32 v1, 63, v0
  s_mov_b32 s79, s2
  s_cmp_ge_u32 s2, 256
  s_cbranch_scc1 mega_end
  s_mul_i32 s71, s70, 49152
  s_add_u32 s71, s71, 68190208
  s_and_b32 s68, s2, 7
  s_waitcnt lgkmcnt(0)
  s_add_u32 s16, s4, 56000512
  s_addc_u32 s17, s5, 0
  s_cmp_eq_u32 s70, 0
  s_cselect_b32 s84, s84, s16
  s_cselect_b32 s85, s85, s17
  s_bfe_u32 s81, s2, 0x20005
  s_mov_b64 s[92:93], s[8:9]
  s_mov_b64 s[96:97], s[10:11]
  s_cmp_lt_u32 s2, 128
  s_cselect_b32 s16, 2, s81
  s_cmp_eq_u32 s16, 0
  s_cselect_b64 s[92:93], s[10:11], s[92:93]
  s_cmp_eq_u32 s16, 1
  s_cselect_b64 s[92:93], s[12:13], s[92:93]
  s_cmp_eq_u32 s16, 3
  s_cselect_b64 s[92:93], s[14:15], s[92:93]
  s_getreg_b32 s27, hwreg(HW_REG_XCC_ID)
  s_and_b32 s27, s27, 7
  s_mul_i32 s28, s27, s27
  s_lshl_b32 s28, s28, 14
  s_lshl_b32 s27, s27, 6
  s_add_u32 s27, s27, s28
  s_add_u32 s27, s27, 1
  s_lshl_b32 s69, s27, 5
  s_lshl_b32 s29, s68, 2
  s_cmp_lg_u32 s3, 0
  s_cbranch_scc1 mega_noatom
  v_mov_b32 v15, 0
  v_mov_b32 v14, s27
  s_mov_b64 exec, 1
  buffer_atomic_add v14, v15, s[44:47], s29 offen sc1
  s_mov_b64 exec, -1
mega_noatom:
  s_cmp_lt_u32 s2, 128
  s_cbranch_scc1 mega_rec
  s_lshl_b32 s8, s68, 2
  s_bfe_u32 s9, s2, 0x20003
  s_add_u32 s80, s8, s9
  s_mul_i32 s78, s68, 1953792
  s_add_u32 s78, s78, 28835840
  s_cmp_eq_u32 s81, 2
  s_cbranch_scc1 mega_qrole
  s_cmp_eq_u32 s81, 3
  s_cbranch_scc1 mega_urole
  v_lshlrev_b32 v2, 4, v1
  v_mov_b32 v7, 0
  s_mul_i32 s10, s80, 384
  s_mul_i32 s11, s3, 96
  s_add_u32 s10, s10, s11
  s_mul_i32 s11, s3, 30720
  s_add_u32 s11, s11, 40960
  v_mul_u32_u24 v18, 10923, v1
  v_lshrrev_b32 v18, 16, v18
  v_mul_u32_u24 v16, 6, v18
  v_sub_u32 v16, v1, v16
  v_lshlrev_b32 v16, 4, v16
  v_mul_u32_u24 v18, 12288, v18
  v_add_u32 v16, v16, v18
  v_lshrrev_b32 v18, 4, v1
  v_mul_u32_u24 v18, 8, v18
  v_bfe_u32 v17, v1, 2, 2
  v_add_u32 v18, v18, v17
  v_mul_u32_u24 v18, 96, v18
  v_and_b32 v17, 3, v1
  v_lshl_add_u32 v17, v17, 3, v18
  v_add_u32 v17, s11, v17
  s_mul_i32 s13, s3, 10240
  s_add_u32 s12, s13, 26214400
  s_lshl_b32 s15, s3, 10
  v_add_u32 v3, s15, v2
  s_and_b32 s9, s80, 3
  s_add_u32 m0, s13, 0
  s_add_u32 s18, s12, 0
  buffer_load_dwordx4 v2, s[4:7], s18 offen offset:0 lds
  buffer_load_dwordx4 v2, s[4:7], s18 offen offset:1024 lds
  buffer_load_dwordx4 v2, s[4:7], s18 offen offset:2048 lds
  buffer_load_dwordx4 v2, s[4:7], s18 offen offset:3072 lds
  s_add_u32 m0, s13, 4096
  s_add_u32 s18, s12, 4096
  buffer_load_dwordx4 v2, s[4:7], s18 offen offset:0 lds
  buffer_load_dwordx4 v2, s[4:7], s18 offen offset:1024 lds
  buffer_load_dwordx4 v2, s[4:7], s18 offen offset:2048 lds
  buffer_load_dwordx4 v2, s[4:7], s18 offen offset:3072 lds
  s_add_u32 m0, s13, 8192
  s_add_u32 s18, s12, 8192
  buffer_load_dwordx4 v2, s[4:7], s18 offen offset:0 lds
  buffer_load_dwordx4 v2, s[4:7], s18 offen offset:1024 lds
  s_add_u32 s12, s12, 40960
  s_add_u32 s13, s13, 40960
  s_mov_b32 s19, 40960
  s_mov_b64 exec, s[82:83]
  s_add_u32 m0, s11, 0
  s_nop 0
  buffer_load_dwordx4 v16, s[92:95], s10 offen lds
  s_add_u32 s10, s10, 122880
  s_add_u32 m0, s11, 960
  s_nop 0
  buffer_load_dwordx4 v16, s[92:95], s10 offen lds
  s_add_u32 s10, s10, 122880
  s_add_u32 m0, s11, 1920
  s_nop 0
  buffer_load_dwordx4 v16, s[92:95], s10 offen lds
  s_add_u32 s10, s10, 122880
  s_add_u32 m0, s11, 2880
  s_nop 0
  buffer_load_dwordx4 v16, s[92:95], s10 offen lds
  s_add_u32 s10, s10, 122880
  s_add_u32 m0, s11, 3840
  s_nop 0
  buffer_load_dwordx4 v16, s[92:95], s10 offen lds
  s_add_u32 s10, s10, 122880
  s_add_u32 m0, s11, 4800
  s_nop 0
  buffer_load_dwordx4 v16, s[92:95], s10 offen lds
  s_add_u32 s10, s10, 122880
  s_add_u32 m0, s11, 5760
  s_nop 0
  buffer_load_dwordx4 v16, s[92:95], s10 offen lds
  s_add_u32 s10, s10, 122880
  s_add_u32 m0, s11, 6720
  s_nop 0
  buffer_load_dwordx4 v16, s[92:95], s10 offen lds
  s_add_u32 s10, s10, 122880
  s_add_u32 m0, s11, 7680
  s_nop 0
  buffer_load_dwordx4 v16, s[92:95], s10 offen lds
  s_add_u32 s10, s10, 122880
  s_add_u32 m0, s11, 8640
  s_nop 0
  buffer_load_dwordx4 v16, s[92:95], s10 offen lds
  s_add_u32 s10, s10, 122880
  s_add_u32 m0, s11, 9600
  s_nop 0
  buffer_load_dwordx4 v16, s[92:95], s10 offen lds
  s_add_u32 s10, s10, 122880
  s_add_u32 m0, s11, 10560
  s_nop 0
  buffer_load_dwordx4 v16, s[92:95], s10 offen lds
  s_add_u32 s10, s10, 122880
  s_add_u32 m0, s11, 11520
  s_nop 0
  buffer_load_dwordx4 v16, s[92:95], s10 offen lds
  s_add_u32 s10, s10, 122880
  s_add_u32 m0, s11, 12480
  s_nop 0
  buffer_load_dwordx4 v16, s[92:95], s10 offen lds
  s_add_u32 s10, s10, 122880
  s_add_u32 m0, s11, 13440
  s_nop 0
  buffer_load_dwordx4 v16, s[92:95], s10 offen lds
  s_add_u32 s10, s10, 122880
  s_add_u32 m0, s11, 14400
  s_nop 0
  buffer_load_dwordx4 v16, s[92:95], s10 offen lds
  s_add_u32 s10, s10, 122880
  s_add_u32 m0, s11, 15360
  s_nop 0
  buffer_load_dwordx4 v16, s[92:95], s10 offen lds
  s_add_u32 s10, s10, 122880
  s_add_u32 m0, s11, 16320
  s_nop 0
  buffer_load_dwordx4 v16, s[92:95], s10 offen lds
  s_add_u32 s10, s10, 122880
  s_add_u32 m0, s11, 17280
  s_nop 0
  buffer_load_dwordx4 v16, s[92:95], s10 offen lds
  s_add_u32 s10, s10, 122880
  s_add_u32 m0, s11, 18240
  s_nop 0
  buffer_load_dwordx4 v16, s[92:95], s10 offen lds
  s_add_u32 s10, s10, 122880
  s_add_u32 m0, s11, 19200
  s_nop 0
  buffer_load_dwordx4 v16, s[92:95], s10 offen lds
  s_add_u32 s10, s10, 122880
  s_add_u32 m0, s11, 20160
  s_nop 0
  buffer_load_dwordx4 v16, s[92:95], s10 offen lds
  s_add_u32 s10, s10, 122880
  s_add_u32 m0, s11, 21120
  s_nop 0
  buffer_load_dwordx4 v16, s[92:95], s10 offen lds
  s_add_u32 s10, s10, 122880
  s_add_u32 m0, s11, 22080
  s_nop 0
  buffer_load_dwordx4 v16, s[92:95], s10 offen lds
  s_add_u32 s10, s10, 122880
  s_add_u32 m0, s11, 23040
  s_nop 0
  buffer_load_dwordx4 v16, s[92:95], s10 offen lds
  s_add_u32 s10, s10, 122880
  s_add_u32 m0, s11, 24000
  s_nop 0
  buffer_load_dwordx4 v16, s[92:95], s10 offen lds
  s_add_u32 s10, s10, 122880
  s_add_u32 m0, s11, 24960
  s_nop 0
  buffer_load_dwordx4 v16, s[92:95], s10 offen lds
  s_add_u32 s10, s10, 122880
  s_add_u32 m0, s11, 25920
  s_nop 0
  buffer_load_dwordx4 v16, s[92:95], s10 offen lds
  s_add_u32 s10, s10, 122880
  s_add_u32 m0, s11, 26880
  s_nop 0
  buffer_load_dwordx4 v16, s[92:95], s10 offen lds
  s_add_u32 s10, s10, 122880
  s_add_u32 m0, s11, 27840
  s_nop 0
  buffer_load_dwordx4 v16, s[92:95], s10 offen lds
  s_add_u32 s10, s10, 122880
  s_add_u32 m0, s11, 28800
  s_nop 0
  buffer_load_dwordx4 v16, s[92:95], s10 offen lds
  s_add_u32 s10, s10, 122880
  s_add_u32 m0, s11, 29760
  s_nop 0
  buffer_load_dwordx4 v16, s[92:95], s10 offen lds
  s_add_u32 s10, s10, 122880
  s_mov_b64 exec, -1
  s_waitcnt vmcnt(28)
  ds_read_b64_tr_b16 a[0:1], v17 offset:0
  ds_read_b64_tr_b16 a[2:3], v17 offset:384
  ds_read_b64_tr_b16 a[80:81], v17 offset:32
  ds_read_b64_tr_b16 a[82:83], v17 offset:416
  ds_read_b64_tr_b16 a[160:161], v17 offset:64
  ds_read_b64_tr_b16 a[162:163], v17 offset:448
  s_waitcnt lgkmcnt(0)
  s_mov_b64 exec, s[82:83]
  s_add_u32 m0, s11, 0
  s_nop 0
  buffer_load_dwordx4 v16, s[92:95], s10 offen lds
  s_add_u32 s10, s10, 122880
  s_add_u32 m0, s11, 960
  s_nop 0
  buffer_load_dwordx4 v16, s[92:95], s10 offen lds
  s_add_u32 s10, s10, 122880
  s_add_u32 m0, s11, 1920
  s_nop 0
  buffer_load_dwordx4 v16, s[92:95], s10 offen lds
  s_add_u32 s10, s10, 122880
  s_mov_b64 exec, -1
  s_waitcnt vmcnt(28)
  ds_read_b64_tr_b16 a[4:5], v17 offset:3072
  ds_read_b64_tr_b16 a[6:7], v17 offset:3456
  ds_read_b64_tr_b16 a[84:85], v17 offset:3104
  ds_read_b64_tr_b16 a[86:87], v17 offset:3488
  ds_read_b64_tr_b16 a[164:165], v17 offset:3136
  ds_read_b64_tr_b16 a[166:167], v17 offset:3520
  s_waitcnt lgkmcnt(0)
  s_mov_b64 exec, s[82:83]
  s_add_u32 m0, s11, 2880
  s_nop 0
  buffer_load_dwordx4 v16, s[92:95], s10 offen lds
  s_add_u32 s10, s10, 122880
  s_add_u32 m0, s11, 3840
  s_nop 0
  buffer_load_dwordx4 v16, s[92:95], s10 offen lds
  s_add_u32 s10, s10, 122880
  s_add_u32 m0, s11, 4800
  s_nop 0
  buffer_load_dwordx4 v16, s[92:95], s10 offen lds
  s_add_u32 s10, s10, 122880
  s_mov_b64 exec, -1
  s_waitcnt vmcnt(28)
  ds_read_b64_tr_b16 a[8:9], v17 offset:6144
  ds_read_b64_tr_b16 a[10:11], v17 offset:6528
  ds_read_b64_tr_b16 a[88:89], v17 offset:6176
  ds_read_b64_tr_b16 a[90:91], v17 offset:6560
  ds_read_b64_tr_b16 a[168:169], v17 offset:6208
  ds_read_b64_tr_b16 a[170:171], v17 offset:6592
  s_waitcnt lgkmcnt(0)
  s_mov_b64 exec, s[82:83]
  s_add_u32 m0, s11, 5760
  s_nop 0
  buffer_load_dwordx4 v16, s[92:95], s10 offen lds
  s_add_u32 s10, s10, 122880
  s_add_u32 m0, s11, 6720
  s_nop 0
  buffer_load_dwordx4 v16, s[92:95], s10 offen lds
  s_add_u32 s10, s10, 122880
  s_add_u32 m0, s11, 7680
  s_nop 0
  buffer_load_dwordx4 v16, s[92:95], s10 offen lds
  s_add_u32 s10, s10, 122880
  s_mov_b64 exec, -1
  s_waitcnt vmcnt(28)
  ds_read_b64_tr_b16 a[12:13], v17 offset:9216
  ds_read_b64_tr_b16 a[14:15], v17 offset:9600
  ds_read_b64_tr_b16 a[92:93], v17 offset:9248
  ds_read_b64_tr_b16 a[94:95], v17 offset:9632
  ds_read_b64_tr_b16 a[172:173], v17 offset:9280
  ds_read_b64_tr_b16 a[174:175], v17 offset:9664
  s_waitcnt lgkmcnt(0)
  s_mov_b64 exec, s[82:83]
  s_add_u32 m0, s11, 8640
  s_nop 0
  buffer_load_dwordx4 v16, s[92:95], s10 offen lds
  s_add_u32 s10, s10, 122880
  s_add_u32 m0, s11, 9600
  s_nop 0
  buffer_load_dwordx4 v16, s[92:95], s10 offen lds
  s_add_u32 s10, s10, 122880
  s_add_u32 m0, s11, 10560
  s_nop 0
  buffer_load_dwordx4 v16, s[92:95], s10 offen lds
  s_add_u32 s10, s10, 122880
  s_mov_b64 exec, -1
  s_waitcnt vmcnt(28)
  ds_read_b64_tr_b16 a[16:17], v17 offset:12288
  ds_read_b64_tr_b16 a[18:19], v17 offset:12672
  ds_read_b64_tr_b16 a[96:97], v17 offset:12320
  ds_read_b64_tr_b16 a[98:99], v17 offset:12704
  ds_read_b64_tr_b16 a[176:177], v17 offset:12352
  ds_read_b64_tr_b16 a[178:179], v17 offset:12736
  s_waitcnt lgkmcnt(0)
  s_mov_b64 exec, s[82:83]
  s_add_u32 m0, s11, 11520
  s_nop 0
  buffer_load_dwordx4 v16, s[92:95], s10 offen lds
  s_add_u32 s10, s10, 122880
  s_add_u32 m0, s11, 12480
  s_nop 0
  buffer_load_dwordx4 v16, s[92:95], s10 offen lds
  s_add_u32 s10, s10, 122880
  s_add_u32 m0, s11, 13440
  s_nop 0
  buffer_load_dwordx4 v16, s[92:95], s10 offen lds
  s_add_u32 s10, s10, 122880
  s_add_u32 m0, s11, 14400
  s_nop 0
  buffer_load_dwordx4 v16, s[92:95], s10 offen lds
  s_add_u32 s10, s10, 122880
  s_mov_b64 exec, -1
  s_waitcnt vmcnt(28)
  ds_read_b64_tr_b16 a[20:21], v17 offset:15360
  ds_read_b64_tr_b16 a[22:23], v17 offset:15744
  ds_read_b64_tr_b16 a[100:101], v17 offset:15392
  ds_read_b64_tr_b16 a[102:103], v17 offset:15776
  ds_read_b64_tr_b16 a[180:181], v17 offset:15424
  ds_read_b64_tr_b16 a[182:183], v17 offset:15808
  s_waitcnt lgkmcnt(0)
  s_mov_b64 exec, s[82:83]
  s_add_u32 m0, s11, 15360
  s_nop 0
  buffer_load_dwordx4 v16, s[92:95], s10 offen lds
  s_add_u32 s10, s10, 122880
  s_add_u32 m0, s11, 16320
  s_nop 0
  buffer_load_dwordx4 v16, s[92:95], s10 offen lds
  s_add_u32 s10, s10, 122880
  s_add_u32 m0, s11, 17280
  s_nop 0
  buffer_load_dwordx4 v16, s[92:95], s10 offen lds
  s_add_u32 s10, s10, 122880
  s_mov_b64 exec, -1
  s_waitcnt vmcnt(28)
  ds_read_b64_tr_b16 a[24:25], v17 offset:18432
  ds_read_b64_tr_b16 a[26:27], v17 offset:18816
  ds_read_b64_tr_b16 a[104:105], v17 offset:18464
  ds_read_b64_tr_b16 a[106:107], v17 offset:18848
  ds_read_b64_tr_b16 a[184:185], v17 offset:18496
  ds_read_b64_tr_b16 a[186:187], v17 offset:18880
  s_waitcnt lgkmcnt(0)
  s_mov_b64 exec, s[82:83]
  s_add_u32 m0, s11, 18240
  s_nop 0
  buffer_load_dwordx4 v16, s[92:95], s10 offen lds
  s_add_u32 s10, s10, 122880
  s_add_u32 m0, s11, 19200
  s_nop 0
  buffer_load_dwordx4 v16, s[92:95], s10 offen lds
  s_add_u32 s10, s10, 122880
  s_add_u32 m0, s11, 20160
  s_nop 0
  buffer_load_dwordx4 v16, s[92:95], s10 offen lds
  s_add_u32 s10, s10, 122880
  s_mov_b64 exec, -1
  s_waitcnt vmcnt(28)
  ds_read_b64_tr_b16 a[28:29], v17 offset:21504
  ds_read_b64_tr_b16 a[30:31], v17 offset:21888
  ds_read_b64_tr_b16 a[108:109], v17 offset:21536
  ds_read_b64_tr_b16 a[110:111], v17 offset:21920
  ds_read_b64_tr_b16 a[188:189], v17 offset:21568
  ds_read_b64_tr_b16 a[190:191], v17 offset:21952
  s_waitcnt lgkmcnt(0)
  s_mov_b64 exec, s[82:83]
  s_add_u32 m0, s11, 21120
  s_nop 0
  buffer_load_dwordx4 v16, s[92:95], s10 offen lds
  s_add_u32 s10, s10, 122880
  s_add_u32 m0, s11, 22080
  s_nop 0
  buffer_load_dwordx4 v16, s[92:95], s10 offen lds
  s_add_u32 s10, s10, 122880
  s_add_u32 m0, s11, 23040
  s_nop 0
  buffer_load_dwordx4 v16, s[92:95], s10 offen lds
  s_add_u32 s10, s10, 122880
  s_mov_b64 exec, -1
  s_waitcnt vmcnt(28)
  ds_read_b64_tr_b16 a[32:33], v17 offset:24576
  ds_read_b64_tr_b16 a[34:35], v17 offset:24960
  ds_read_b64_tr_b16 a[112:113], v17 offset:24608
  ds_read_b64_tr_b16 a[114:115], v17 offset:24992
  ds_read_b64_tr_b16 a[192:193], v17 offset:24640
  ds_read_b64_tr_b16 a[194:195], v17 offset:25024
  s_waitcnt lgkmcnt(0)
  s_mov_b64 exec, s[82:83]
  s_add_u32 m0, s11, 24000
  s_nop 0
  buffer_load_dwordx4 v16, s[92:95], s10 offen lds
  s_add_u32 s10, s10, 122880
  s_add_u32 m0, s11, 24960
  s_nop 0
  buffer_load_dwordx4 v16, s[92:95], s10 offen lds
  s_add_u32 s10, s10, 122880
  s_add_u32 m0, s11, 25920
  s_nop 0
  buffer_load_dwordx4 v16, s[92:95], s10 offen lds
  s_add_u32 s10, s10, 122880
  s_mov_b64 exec, -1
  s_waitcnt vmcnt(28)
  ds_read_b64_tr_b16 a[36:37], v17 offset:27648
  ds_read_b64_tr_b16 a[38:39], v17 offset:28032
  ds_read_b64_tr_b16 a[116:117], v17 offset:27680
  ds_read_b64_tr_b16 a[118:119], v17 offset:28064
  ds_read_b64_tr_b16 a[196:197], v17 offset:27712
  ds_read_b64_tr_b16 a[198:199], v17 offset:28096
  s_waitcnt lgkmcnt(0)
  s_mov_b64 exec, s[82:83]
  s_add_u32 m0, s11, 26880
  s_nop 0
  buffer_load_dwordx4 v16, s[92:95], s10 offen lds
  s_add_u32 s10, s10, 122880
  s_add_u32 m0, s11, 27840
  s_nop 0
  buffer_load_dwordx4 v16, s[92:95], s10 offen lds
  s_add_u32 s10, s10, 122880
  s_add_u32 m0, s11, 28800
  s_nop 0
  buffer_load_dwordx4 v16, s[92:95], s10 offen lds
  s_add_u32 s10, s10, 122880
  s_add_u32 m0, s11, 29760
  s_nop 0
  buffer_load_dwordx4 v16, s[92:95], s10 offen lds
  s_add_u32 s10, s10, 122880
  s_mov_b64 exec, -1
  s_waitcnt vmcnt(28)
  ds_read_b64_tr_b16 a[40:41], v17 offset:0
  ds_read_b64_tr_b16 a[42:43], v17 offset:384
  ds_read_b64_tr_b16 a[120:121], v17 offset:32
  ds_read_b64_tr_b16 a[122:123], v17 offset:416
  ds_read_b64_tr_b16 a[200:201], v17 offset:64
  ds_read_b64_tr_b16 a[202:203], v17 offset:448
  s_waitcnt vmcnt(25)
  ds_read_b64_tr_b16 a[44:45], v17 offset:3072
  ds_read_b64_tr_b16 a[46:47], v17 offset:3456
  ds_read_b64_tr_b16 a[124:125], v17 offset:3104
  ds_read_b64_tr_b16 a[126:127], v17 offset:3488
  ds_read_b64_tr_b16 a[204:205], v17 offset:3136
  ds_read_b64_tr_b16 a[206:207], v17 offset:3520
  s_waitcnt vmcnt(22)
  ds_read_b64_tr_b16 a[48:49], v17 offset:6144
  ds_read_b64_tr_b16 a[50:51], v17 offset:6528
  ds_read_b64_tr_b16 a[128:129], v17 offset:6176
  ds_read_b64_tr_b16 a[130:131], v17 offset:6560
  ds_read_b64_tr_b16 a[208:209], v17 offset:6208
  ds_read_b64_tr_b16 a[210:211], v17 offset:6592
  s_waitcnt vmcnt(19)
  ds_read_b64_tr_b16 a[52:53], v17 offset:9216
  ds_read_b64_tr_b16 a[54:55], v17 offset:9600
  ds_read_b64_tr_b16 a[132:133], v17 offset:9248
  ds_read_b64_tr_b16 a[134:135], v17 offset:9632
  ds_read_b64_tr_b16 a[212:213], v17 offset:9280
  ds_read_b64_tr_b16 a[214:215], v17 offset:9664
  s_waitcnt vmcnt(16)
  ds_read_b64_tr_b16 a[56:57], v17 offset:12288
  ds_read_b64_tr_b16 a[58:59], v17 offset:12672
  ds_read_b64_tr_b16 a[136:137], v17 offset:12320
  ds_read_b64_tr_b16 a[138:139], v17 offset:12704
  ds_read_b64_tr_b16 a[216:217], v17 offset:12352
  ds_read_b64_tr_b16 a[218:219], v17 offset:12736
  s_waitcnt vmcnt(12)
  ds_read_b64_tr_b16 a[60:61], v17 offset:15360
  ds_read_b64_tr_b16 a[62:63], v17 offset:15744
  ds_read_b64_tr_b16 a[140:141], v17 offset:15392
  ds_read_b64_tr_b16 a[142:143], v17 offset:15776
  ds_read_b64_tr_b16 a[220:221], v17 offset:15424
  ds_read_b64_tr_b16 a[222:223], v17 offset:15808
  s_waitcnt vmcnt(9)
  ds_read_b64_tr_b16 a[64:65], v17 offset:18432
  ds_read_b64_tr_b16 a[66:67], v17 offset:18816
  ds_read_b64_tr_b16 a[144:145], v17 offset:18464
  ds_read_b64_tr_b16 a[146:147], v17 offset:18848
  ds_read_b64_tr_b16 a[224:225], v17 offset:18496
  ds_read_b64_tr_b16 a[226:227], v17 offset:18880
  s_waitcnt vmcnt(6)
  ds_read_b64_tr_b16 a[68:69], v17 offset:21504
  ds_read_b64_tr_b16 a[70:71], v17 offset:21888
  ds_read_b64_tr_b16 a[148:149], v17 offset:21536
  ds_read_b64_tr_b16 a[150:151], v17 offset:21920
  ds_read_b64_tr_b16 a[228:229], v17 offset:21568
  ds_read_b64_tr_b16 a[230:231], v17 offset:21952
  s_waitcnt vmcnt(3)
  ds_read_b64_tr_b16 a[72:73], v17 offset:24576
  ds_read_b64_tr_b16 a[74:75], v17 offset:24960
  ds_read_b64_tr_b16 a[152:153], v17 offset:24608
  ds_read_b64_tr_b16 a[154:155], v17 offset:24992
  ds_read_b64_tr_b16 a[232:233], v17 offset:24640
  ds_read_b64_tr_b16 a[234:235], v17 offset:25024
  s_waitcnt vmcnt(0)
  ds_read_b64_tr_b16 a[76:77], v17 offset:27648
  ds_read_b64_tr_b16 a[78:79], v17 offset:28032
  ds_read_b64_tr_b16 a[156:157], v17 offset:27680
  ds_read_b64_tr_b16 a[158:159], v17 offset:28064
  ds_read_b64_tr_b16 a[236:237], v17 offset:27712
  ds_read_b64_tr_b16 a[238:239], v17 offset:28096
  s_waitcnt lgkmcnt(0)
  s_lshl_b32 s28, s68, 2
  v_mov_b32 v17, s28
  s_mov_b32 s28, 0
mega0_kernel_cen1:
  buffer_load_dword v16, v17, s[44:47], 0 offen sc1
  s_waitcnt vmcnt(0)
  v_readfirstlane_b32 s26, v16
  s_nop 0
  s_and_b32 s27, s26, 63
  s_cmp_eq_u32 s27, 32
  s_cbranch_scc1 mega0_kernel_cen1_done
  s_sleep 4
  s_add_u32 s28, s28, 1
  s_cmp_lt_u32 s28, 262144
  s_cbranch_scc1 mega0_kernel_cen1
  s_branch mega_fail
mega0_kernel_cen1_done:
  s_cmp_eq_u32 s26, s69
  s_cselect_b32 s69, 0, 1
  v_mov_b32 v5, v2
  s_mov_b32 s24, 0
  v_add_u32 v4, 4096, v3
  v_add_u32 v9, 8192, v3
  s_mul_i32 s14, s81, 49152
  s_mul_i32 s15, s9, 12288
  s_add_u32 s14, s14, s15
  s_add_u32 s14, s14, s78
  s_add_u32 s14, s14, 204800
  s_mov_b32 s20, 0
  s_lshl_b32 s25, s81, 12
  s_lshl_b32 s15, s80, 7
  s_add_u32 s25, s25, s15
  s_lshl_b32 s15, s3, 2
  s_add_u32 s25, s25, s15
  s_add_u32 s25, s25, s71
  s_mul_i32 s15, s81, 3
  s_add_u32 s15, s15, s3
  s_lshl_b32 s16, s81, 1
  s_add_u32 s16, s16, 3
  s_mul_i32 s26, s9, 5
  s_add_u32 s26, s26, s15
  s_cmp_lt_u32 s15, s16
  s_cselect_b32 s21, 6, 64
  s_cselect_b32 s22, 1, 0
  s_lshl_b32 s16, s9, 3
  s_add_u32 s16, s16, s15
  s_cmp_eq_u32 s16, 6
  s_cselect_b32 s27, 4, s9
  s_cselect_b32 s15, 5, s15
  s_cmp_eq_u32 s15, 5
  s_cselect_b32 s21, 9, s21
  s_cselect_b32 s22, 2, s22
mega_kv_loop:
  s_barrier
  ds_read_b128 v[16:19], v5 offset:0
  ds_read_b128 v[20:23], v5 offset:20480
  ds_read_b128 v[24:27], v5 offset:1024
  ds_read_b128 v[28:31], v5 offset:21504
  ds_read_b128 v[32:35], v5 offset:2048
  ds_read_b128 v[36:39], v5 offset:22528
  s_waitcnt lgkmcnt(4)
  v_mfma_f32_16x16x32_bf16 v[48:51], a[0:3], v[16:19], 0
  ds_read_b128 v[40:43], v5 offset:3072
  v_mfma_f32_16x16x32_bf16 v[52:55], a[80:83], v[16:19], 0
  s_add_u32 m0, s13, 0
  s_add_u32 s18, s12, 0
  buffer_load_dwordx4 v2, s[4:7], s18 offen offset:0 lds
  v_mfma_f32_16x16x32_bf16 v[56:59], a[160:163], v[16:19], 0
  v_mfma_f32_16x16x32_bf16 v[60:63], a[0:3], v[20:23], 0
  ds_read_b128 v[44:47], v5 offset:23552
  v_mfma_f32_16x16x32_bf16 v[64:67], a[80:83], v[20:23], 0
  v_mfma_f32_16x16x32_bf16 v[68:71], a[160:163], v[20:23], 0
  s_waitcnt lgkmcnt(4)
  v_mfma_f32_16x16x32_bf16 v[48:51], a[4:7], v[24:27], v[48:51]
  ds_read_b128 v[16:19], v5 offset:4096
  v_mfma_f32_16x16x32_bf16 v[52:55], a[84:87], v[24:27], v[52:55]
  v_mfma_f32_16x16x32_bf16 v[56:59], a[164:167], v[24:27], v[56:59]
  buffer_load_dwordx4 v2, s[4:7], s18 offen offset:1024 lds
  v_mfma_f32_16x16x32_bf16 v[60:63], a[4:7], v[28:31], v[60:63]
  ds_read_b128 v[20:23], v5 offset:24576
  v_mfma_f32_16x16x32_bf16 v[64:67], a[84:87], v[28:31], v[64:67]
  v_mfma_f32_16x16x32_bf16 v[68:71], a[164:167], v[28:31], v[68:71]
  s_waitcnt lgkmcnt(4)
  v_mfma_f32_16x16x32_bf16 v[48:51], a[8:11], v[32:35], v[48:51]
  ds_read_b128 v[24:27], v5 offset:5120
  v_mfma_f32_16x16x32_bf16 v[52:55], a[88:91], v[32:35], v[52:55]
  v_mfma_f32_16x16x32_bf16 v[56:59], a[168:171], v[32:35], v[56:59]
  v_mfma_f32_16x16x32_bf16 v[60:63], a[8:11], v[36:39], v[60:63]
  ds_read_b128 v[28:31], v5 offset:25600
  v_mfma_f32_16x16x32_bf16 v[64:67], a[88:91], v[36:39], v[64:67]
  v_mfma_f32_16x16x32_bf16 v[68:71], a[168:171], v[36:39], v[68:71]
  buffer_load_dwordx4 v2, s[4:7], s18 offen offset:2048 lds
  s_waitcnt lgkmcnt(4)
  v_mfma_f32_16x16x32_bf16 v[48:51], a[12:15], v[40:43], v[48:51]
  ds_read_b128 v[32:35], v5 offset:6144
  v_mfma_f32_16x16x32_bf16 v[52:55], a[92:95], v[40:43], v[52:55]
  v_mfma_f32_16x16x32_bf16 v[56:59], a[172:175], v[40:43], v[56:59]
  v_mfma_f32_16x16x32_bf16 v[60:63], a[12:15], v[44:47], v[60:63]
  ds_read_b128 v[36:39], v5 offset:26624
  v_mfma_f32_16x16x32_bf16 v[64:67], a[92:95], v[44:47], v[64:67]
  v_mfma_f32_16x16x32_bf16 v[68:71], a[172:175], v[44:47], v[68:71]
  s_waitcnt lgkmcnt(4)
  v_mfma_f32_16x16x32_bf16 v[48:51], a[16:19], v[16:19], v[48:51]
  ds_read_b128 v[40:43], v5 offset:7168
  v_mfma_f32_16x16x32_bf16 v[52:55], a[96:99], v[16:19], v[52:55]
  buffer_load_dwordx4 v2, s[4:7], s18 offen offset:3072 lds
  v_mfma_f32_16x16x32_bf16 v[56:59], a[176:179], v[16:19], v[56:59]
  v_mfma_f32_16x16x32_bf16 v[60:63], a[16:19], v[20:23], v[60:63]
  ds_read_b128 v[44:47], v5 offset:27648
  v_mfma_f32_16x16x32_bf16 v[64:67], a[96:99], v[20:23], v[64:67]
  v_mfma_f32_16x16x32_bf16 v[68:71], a[176:179], v[20:23], v[68:71]
  s_waitcnt lgkmcnt(4)
  v_mfma_f32_16x16x32_bf16 v[48:51], a[20:23], v[24:27], v[48:51]
  ds_read_b128 v[16:19], v5 offset:8192
  v_mfma_f32_16x16x32_bf16 v[52:55], a[100:103], v[24:27], v[52:55]
  v_mfma_f32_16x16x32_bf16 v[56:59], a[180:183], v[24:27], v[56:59]
  v_mfma_f32_16x16x32_bf16 v[60:63], a[20:23], v[28:31], v[60:63]
  ds_read_b128 v[20:23], v5 offset:28672
  v_mfma_f32_16x16x32_bf16 v[64:67], a[100:103], v[28:31], v[64:67]
  s_add_u32 m0, s13, 4096
  s_add_u32 s18, s12, 4096
  buffer_load_dwordx4 v2, s[4:7], s18 offen offset:0 lds
  v_mfma_f32_16x16x32_bf16 v[68:71], a[180:183], v[28:31], v[68:71]
  s_waitcnt lgkmcnt(4)
  v_mfma_f32_16x16x32_bf16 v[48:51], a[24:27], v[32:35], v[48:51]
  ds_read_b128 v[24:27], v5 offset:9216
  v_mfma_f32_16x16x32_bf16 v[52:55], a[104:107], v[32:35], v[52:55]
  v_mfma_f32_16x16x32_bf16 v[56:59], a[184:187], v[32:35], v[56:59]
  v_mfma_f32_16x16x32_bf16 v[60:63], a[24:27], v[36:39], v[60:63]
  ds_read_b128 v[28:31], v5 offset:29696
  v_mfma_f32_16x16x32_bf16 v[64:67], a[104:107], v[36:39], v[64:67]
  v_mfma_f32_16x16x32_bf16 v[68:71], a[184:187], v[36:39], v[68:71]
  s_waitcnt lgkmcnt(4)
  v_mfma_f32_16x16x32_bf16 v[48:51], a[28:31], v[40:43], v[48:51]
  ds_read_b128 v[32:35], v5 offset:10240
  v_mfma_f32_16x16x32_bf16 v[52:55], a[108:111], v[40:43], v[52:55]
  buffer_load_dwordx4 v2, s[4:7], s18 offen offset:1024 lds
  v_mfma_f32_16x16x32_bf16 v[56:59], a[188:191], v[40:43], v[56:59]
  v_mfma_f32_16x16x32_bf16 v[60:63], a[28:31], v[44:47], v[60:63]
  ds_read_b128 v[36:39], v5 offset:30720
  v_mfma_f32_16x16x32_bf16 v[64:67], a[108:111], v[44:47], v[64:67]
  v_mfma_f32_16x16x32_bf16 v[68:71], a[188:191], v[44:47], v[68:71]
  s_waitcnt lgkmcnt(4)
  v_mfma_f32_16x16x32_bf16 v[48:51], a[32:35], v[16:19], v[48:51]
  ds_read_b128 v[40:43], v5 offset:11264
  v_mfma_f32_16x16x32_bf16 v[52:55], a[112:115], v[16:19], v[52:55]
  v_mfma_f32_16x16x32_bf16 v[56:59], a[192:195], v[16:19], v[56:59]
  buffer_load_dwordx4 v2, s[4:7], s18 offen offset:2048 lds
  v_mfma_f32_16x16x32_bf16 v[60:63], a[32:35], v[20:23], v[60:63]
  ds_read_b128 v[44:47], v5 offset:31744
  v_mfma_f32_16x16x32_bf16 v[64:67], a[112:115], v[20:23], v[64:67]
  v_mfma_f32_16x16x32_bf16 v[68:71], a[192:195], v[20:23], v[68:71]
  s_waitcnt lgkmcnt(4)
  v_mfma_f32_16x16x32_bf16 v[48:51], a[36:39], v[24:27], v[48:51]
  ds_read_b128 v[16:19], v5 offset:12288
  v_mfma_f32_16x16x32_bf16 v[52:55], a[116:119], v[24:27], v[52:55]
  v_mfma_f32_16x16x32_bf16 v[56:59], a[196:199], v[24:27], v[56:59]
  v_mfma_f32_16x16x32_bf16 v[60:63], a[36:39], v[28:31], v[60:63]
  ds_read_b128 v[20:23], v5 offset:32768
  v_mfma_f32_16x16x32_bf16 v[64:67], a[116:119], v[28:31], v[64:67]
  v_mfma_f32_16x16x32_bf16 v[68:71], a[196:199], v[28:31], v[68:71]
  buffer_load_dwordx4 v2, s[4:7], s18 offen offset:3072 lds
  s_waitcnt lgkmcnt(4)
  v_mfma_f32_16x16x32_bf16 v[48:51], a[40:43], v[32:35], v[48:51]
  ds_read_b128 v[24:27], v5 offset:13312
  v_mfma_f32_16x16x32_bf16 v[52:55], a[120:123], v[32:35], v[52:55]
  v_mfma_f32_16x16x32_bf16 v[56:59], a[200:203], v[32:35], v[56:59]
  v_mfma_f32_16x16x32_bf16 v[60:63], a[40:43], v[36:39], v[60:63]
  ds_read_b128 v[28:31], v5 offset:33792
  v_mfma_f32_16x16x32_bf16 v[64:67], a[120:123], v[36:39], v[64:67]
  v_mfma_f32_16x16x32_bf16 v[68:71], a[200:203], v[36:39], v[68:71]
  s_waitcnt lgkmcnt(4)
  v_mfma_f32_16x16x32_bf16 v[48:51], a[44:47], v[40:43], v[48:51]
  ds_read_b128 v[32:35], v5 offset:14336
  v_mfma_f32_16x16x32_bf16 v[52:55], a[124:127], v[40:43], v[52:55]
  s_add_u32 m0, s13, 8192
  s_add_u32 s18, s12, 8192
  buffer_load_dwordx4 v2, s[4:7], s18 offen offset:0 lds
  v_mfma_f32_16x16x32_bf16 v[56:59], a[204:207], v[40:43], v[56:59]
  v_mfma_f32_16x16x32_bf16 v[60:63], a[44:47], v[44:47], v[60:63]
  ds_read_b128 v[36:39], v5 offset:34816
  v_mfma_f32_16x16x32_bf16 v[64:67], a[124:127], v[44:47], v[64:67]
  v_mfma_f32_16x16x32_bf16 v[68:71], a[204:207], v[44:47], v[68:71]
  s_waitcnt lgkmcnt(4)
  v_mfma_f32_16x16x32_bf16 v[48:51], a[48:51], v[16:19], v[48:51]
  ds_read_b128 v[40:43], v5 offset:15360
  v_mfma_f32_16x16x32_bf16 v[52:55], a[128:131], v[16:19], v[52:55]
  v_mfma_f32_16x16x32_bf16 v[56:59], a[208:211], v[16:19], v[56:59]
  v_mfma_f32_16x16x32_bf16 v[60:63], a[48:51], v[20:23], v[60:63]
  ds_read_b128 v[44:47], v5 offset:35840
  v_mfma_f32_16x16x32_bf16 v[64:67], a[128:131], v[20:23], v[64:67]
  buffer_load_dwordx4 v2, s[4:7], s18 offen offset:1024 lds
  v_mfma_f32_16x16x32_bf16 v[68:71], a[208:211], v[20:23], v[68:71]
  s_waitcnt lgkmcnt(4)
  v_mfma_f32_16x16x32_bf16 v[48:51], a[52:55], v[24:27], v[48:51]
  ds_read_b128 v[16:19], v5 offset:16384
  v_mfma_f32_16x16x32_bf16 v[52:55], a[132:135], v[24:27], v[52:55]
  v_mfma_f32_16x16x32_bf16 v[56:59], a[212:215], v[24:27], v[56:59]
  v_mfma_f32_16x16x32_bf16 v[60:63], a[52:55], v[28:31], v[60:63]
  ds_read_b128 v[20:23], v5 offset:36864
  v_mfma_f32_16x16x32_bf16 v[64:67], a[132:135], v[28:31], v[64:67]
  v_mfma_f32_16x16x32_bf16 v[68:71], a[212:215], v[28:31], v[68:71]
  s_waitcnt lgkmcnt(4)
  v_mfma_f32_16x16x32_bf16 v[48:51], a[56:59], v[32:35], v[48:51]
  ds_read_b128 v[24:27], v5 offset:17408
  v_mfma_f32_16x16x32_bf16 v[52:55], a[136:139], v[32:35], v[52:55]
  v_mfma_f32_16x16x32_bf16 v[56:59], a[216:219], v[32:35], v[56:59]
  v_mfma_f32_16x16x32_bf16 v[60:63], a[56:59], v[36:39], v[60:63]
  ds_read_b128 v[28:31], v5 offset:37888
  v_mfma_f32_16x16x32_bf16 v[64:67], a[136:139], v[36:39], v[64:67]
  v_mfma_f32_16x16x32_bf16 v[68:71], a[216:219], v[36:39], v[68:71]
  s_waitcnt lgkmcnt(4)
  v_mfma_f32_16x16x32_bf16 v[48:51], a[60:63], v[40:43], v[48:51]
  ds_read_b128 v[32:35], v5 offset:18432
  v_mfma_f32_16x16x32_bf16 v[52:55], a[140:143], v[40:43], v[52:55]
  v_mfma_f32_16x16x32_bf16 v[56:59], a[220:223], v[40:43], v[56:59]
  v_mfma_f32_16x16x32_bf16 v[60:63], a[60:63], v[44:47], v[60:63]
  ds_read_b128 v[36:39], v5 offset:38912
  v_mfma_f32_16x16x32_bf16 v[64:67], a[140:143], v[44:47], v[64:67]
  v_mfma_f32_16x16x32_bf16 v[68:71], a[220:223], v[44:47], v[68:71]
  s_waitcnt lgkmcnt(4)
  v_mfma_f32_16x16x32_bf16 v[48:51], a[64:67], v[16:19], v[48:51]
  ds_read_b128 v[40:43], v5 offset:19456
  v_mfma_f32_16x16x32_bf16 v[52:55], a[144:147], v[16:19], v[52:55]
  v_mfma_f32_16x16x32_bf16 v[56:59], a[224:227], v[16:19], v[56:59]
  v_mfma_f32_16x16x32_bf16 v[60:63], a[64:67], v[20:23], v[60:63]
  ds_read_b128 v[44:47], v5 offset:39936
  v_mfma_f32_16x16x32_bf16 v[64:67], a[144:147], v[20:23], v[64:67]
  v_mfma_f32_16x16x32_bf16 v[68:71], a[224:227], v[20:23], v[68:71]
  s_waitcnt lgkmcnt(4)
  v_mfma_f32_16x16x32_bf16 v[48:51], a[68:71], v[24:27], v[48:51]
  v_mfma_f32_16x16x32_bf16 v[52:55], a[148:151], v[24:27], v[52:55]
  v_mfma_f32_16x16x32_bf16 v[56:59], a[228:231], v[24:27], v[56:59]
  v_mfma_f32_16x16x32_bf16 v[60:63], a[68:71], v[28:31], v[60:63]
  v_mfma_f32_16x16x32_bf16 v[64:67], a[148:151], v[28:31], v[64:67]
  v_mfma_f32_16x16x32_bf16 v[68:71], a[228:231], v[28:31], v[68:71]
  s_waitcnt lgkmcnt(2)
  v_mfma_f32_16x16x32_bf16 v[48:51], a[72:75], v[32:35], v[48:51]
  v_mfma_f32_16x16x32_bf16 v[52:55], a[152:155], v[32:35], v[52:55]
  v_mfma_f32_16x16x32_bf16 v[56:59], a[232:235], v[32:35], v[56:59]
  v_mfma_f32_16x16x32_bf16 v[60:63], a[72:75], v[36:39], v[60:63]
  v_mfma_f32_16x16x32_bf16 v[64:67], a[152:155], v[36:39], v[64:67]
  v_mfma_f32_16x16x32_bf16 v[68:71], a[232:235], v[36:39], v[68:71]
  s_waitcnt lgkmcnt(0)
  v_mfma_f32_16x16x32_bf16 v[48:51], a[76:79], v[40:43], v[48:51]
  v_mfma_f32_16x16x32_bf16 v[52:55], a[156:159], v[40:43], v[52:55]
  v_mfma_f32_16x16x32_bf16 v[56:59], a[236:239], v[40:43], v[56:59]
  v_mfma_f32_16x16x32_bf16 v[60:63], a[76:79], v[44:47], v[60:63]
  v_mfma_f32_16x16x32_bf16 v[64:67], a[156:159], v[44:47], v[64:67]
  v_mfma_f32_16x16x32_bf16 v[68:71], a[236:239], v[44:47], v[68:71]
  v_add_u32 v5, s19, v5
  s_sub_u32 s13, s13, s19
  s_sub_u32 s19, 0, s19
  s_add_u32 s12, s12, 40960
  s_add_u32 s24, s24, 1
  s_add_u32 s15, s14, s20
  v_cvt_pk_bf16_f32 v72, v48, v49
  v_cvt_pk_bf16_f32 v73, v50, v51
  v_cvt_pk_bf16_f32 v74, v52, v53
  v_cvt_pk_bf16_f32 v75, v54, v55
  v_cvt_pk_bf16_f32 v80, v56, v57
  v_cvt_pk_bf16_f32 v81, v58, v59
  buffer_store_dwordx4 v[72:75], v3, s[4:7], s15 offen
  v_cvt_pk_bf16_f32 v76, v60, v61
  v_cvt_pk_bf16_f32 v77, v62, v63
  v_cvt_pk_bf16_f32 v78, v64, v65
  v_cvt_pk_bf16_f32 v79, v66, v67
  v_cvt_pk_bf16_f32 v82, v68, v69
  v_cvt_pk_bf16_f32 v83, v70, v71
  buffer_store_dwordx4 v[76:79], v4, s[4:7], s15 offen
  buffer_store_dwordx4 v[80:83], v9, s[4:7], s15 offen
  s_waitcnt vmcnt(0)
  v_mov_b32 v8, s24
  s_mov_b64 exec, 1
  s_cmp_lg_u32 s69, 0
  s_cbranch_scc1 mega0_kernel_pf2
  buffer_store_dword v8, v7, s[4:7], s25 offen
mega0_kernel_pf2_b:
  s_mov_b64 exec, -1
  s_add_u32 s20, s20, 325632
  s_cmp_ge_u32 s20, 1953792
  s_cselect_b32 s20, 0, s20
  s_cmp_lt_u32 s24, s21
  s_cbranch_scc1 mega_kv_loop
  s_cmp_eq_u32 s22, 2
  s_cbranch_scc1 mega_kv_red
  s_cmp_eq_u32 s22, 1
  s_cbranch_scc1 mega_kv_tout
  s_endpgm
mega_kv_tout:
  v_and_b32 v84, 15, v1
  v_lshrrev_b32 v85, 2, v84
  v_lshlrev_b32 v85, 3, v85
  v_and_b32 v86, 3, v1
  v_add_u32 v85, v85, v86
  v_lshlrev_b32 v85, 6, v85
  v_lshrrev_b32 v87, 4, v1
  v_lshl_add_u32 v10, v87, 4, v85
  v_add_u32 v15, 20480, v2
  v_lshrrev_b32 v85, 2, v84
  v_lshlrev_b32 v85, 7, v85
  v_lshl_add_u32 v85, v86, 2, v85
  s_lshl_b32 s15, s68, 9
  v_add_u32 v85, s15, v85
  v_add_u32 v86, 8192, v85
  v_add_u32 v87, 16400, v85
  s_lshl_b32 s15, s80, 7
  s_add_u32 s15, s15, 16384
  v_mov_b32 v85, s15
  v_cmp_gt_u32 vcc, 16, v1
  s_nop 1
  v_cndmask_b32 v11, v85, v86, vcc
  v_cndmask_b32 v12, v87, v86, vcc
  v_cndmask_b32 v13, 0, 1, vcc
  s_lshl_b32 s28, s26, 11
  s_add_u32 s28, s28, s78
  s_add_u32 s29, s78, 315392
  s_mul_i32 s31, s68, 40
  s_add_u32 s31, s31, s26
  s_lshl_b32 s31, s31, 10
  s_add_u32 s31, s31, 68288512
  s_mov_b32 s32, 0x40000000
  s_lshl_b32 s33, s26, 3
  s_add_u32 s33, s33, s68
  s_lshl_b32 s33, s33, 7
  s_add_u32 s33, s33, s71
  s_add_u32 s33, s33, 20480
  s_mov_b32 s34, 0
mega_kv_tl:
  s_add_u32 s36, s28, s20
  s_add_u32 s37, s36, 40960
  s_add_u32 s38, s36, 81920
  s_add_u32 s39, s36, 122880
  s_add_u32 s40, s36, 163840
  s_add_u32 s41, s29, s20
  s_add_u32 s42, s41, 4096
  s_add_u32 s43, s41, 8192
  s_add_u32 s35, s34, 2
  s_mov_b32 s30, 0
mega0_kernel_pv3:
  buffer_load_dword v14, v11, s[4:7], s71 offen sc1
  s_waitcnt vmcnt(0)
mega0_kernel_pv3_t:
  v_add_u32 v14, v14, v13
  v_cmp_gt_u32 vcc, s35, v14
  s_nop 0
  s_cbranch_vccz mega0_kernel_pv3_ok
  s_sleep 2
  s_add_u32 s30, s30, 1
  s_cmp_lt_u32 s30, 262144
  s_cbranch_scc1 mega0_kernel_pv3
  s_branch mega_fail
mega0_kernel_pv3_ok:
  s_barrier
  ds_read_b128 v[16:19], v5 offset:0
  ds_read_b128 v[20:23], v5 offset:20480
  ds_read_b128 v[24:27], v5 offset:1024
  ds_read_b128 v[28:31], v5 offset:21504
  ds_read_b128 v[32:35], v5 offset:2048
  ds_read_b128 v[36:39], v5 offset:22528
  s_waitcnt lgkmcnt(4)
  v_mfma_f32_16x16x32_bf16 v[48:51], a[0:3], v[16:19], 0
  ds_read_b128 v[40:43], v5 offset:3072
  v_mfma_f32_16x16x32_bf16 v[52:55], a[80:83], v[16:19], 0
  s_add_u32 m0, s13, 0
  s_add_u32 s18, s12, 0
  buffer_load_dwordx4 v2, s[4:7], s18 offen offset:0 lds
  v_mfma_f32_16x16x32_bf16 v[56:59], a[160:163], v[16:19], 0
  buffer_load_dwordx4 v[96:99], v10, s[4:7], s36 offen offset:0 sc1
  v_mfma_f32_16x16x32_bf16 v[60:63], a[0:3], v[20:23], 0
  ds_read_b128 v[44:47], v5 offset:23552
  v_mfma_f32_16x16x32_bf16 v[64:67], a[80:83], v[20:23], 0
  v_mfma_f32_16x16x32_bf16 v[68:71], a[160:163], v[20:23], 0
  buffer_load_dwordx4 v[100:103], v10, s[4:7], s36 offen offset:256 sc1
  s_waitcnt lgkmcnt(4)
  v_mfma_f32_16x16x32_bf16 v[48:51], a[4:7], v[24:27], v[48:51]
  ds_read_b128 v[16:19], v5 offset:4096
  v_mfma_f32_16x16x32_bf16 v[52:55], a[84:87], v[24:27], v[52:55]
  v_mfma_f32_16x16x32_bf16 v[56:59], a[164:167], v[24:27], v[56:59]
  buffer_load_dwordx4 v2, s[4:7], s18 offen offset:1024 lds
  v_mfma_f32_16x16x32_bf16 v[60:63], a[4:7], v[28:31], v[60:63]
  ds_read_b128 v[20:23], v5 offset:24576
  v_mfma_f32_16x16x32_bf16 v[64:67], a[84:87], v[28:31], v[64:67]
  v_mfma_f32_16x16x32_bf16 v[68:71], a[164:167], v[28:31], v[68:71]
  buffer_load_dwordx4 v[136:139], v2, s[4:7], s41 offen offset:0 sc1
  s_waitcnt lgkmcnt(4)
  v_mfma_f32_16x16x32_bf16 v[48:51], a[8:11], v[32:35], v[48:51]
  ds_read_b128 v[24:27], v5 offset:5120
  v_mfma_f32_16x16x32_bf16 v[52:55], a[88:91], v[32:35], v[52:55]
  v_mfma_f32_16x16x32_bf16 v[56:59], a[168:171], v[32:35], v[56:59]
  buffer_load_dwordx4 v[140:143], v2, s[4:7], s42 offen offset:1024 sc1
  v_mfma_f32_16x16x32_bf16 v[60:63], a[8:11], v[36:39], v[60:63]
  ds_read_b128 v[28:31], v5 offset:25600
  v_mfma_f32_16x16x32_bf16 v[64:67], a[88:91], v[36:39], v[64:67]
  v_mfma_f32_16x16x32_bf16 v[68:71], a[168:171], v[36:39], v[68:71]
  buffer_load_dwordx4 v2, s[4:7], s18 offen offset:2048 lds
  s_waitcnt lgkmcnt(4)
  v_mfma_f32_16x16x32_bf16 v[48:51], a[12:15], v[40:43], v[48:51]
  ds_read_b128 v[32:35], v5 offset:6144
  v_mfma_f32_16x16x32_bf16 v[52:55], a[92:95], v[40:43], v[52:55]
  v_mfma_f32_16x16x32_bf16 v[56:59], a[172:175], v[40:43], v[56:59]
  buffer_load_dwordx4 v[104:107], v10, s[4:7], s37 offen offset:0 sc1
  v_mfma_f32_16x16x32_bf16 v[60:63], a[12:15], v[44:47], v[60:63]
  ds_read_b128 v[36:39], v5 offset:26624
  v_mfma_f32_16x16x32_bf16 v[64:67], a[92:95], v[44:47], v[64:67]
  buffer_load_dwordx4 v[108:111], v10, s[4:7], s37 offen offset:256 sc1
  v_mfma_f32_16x16x32_bf16 v[68:71], a[172:175], v[44:47], v[68:71]
  s_waitcnt lgkmcnt(4)
  v_mfma_f32_16x16x32_bf16 v[48:51], a[16:19], v[16:19], v[48:51]
  ds_read_b128 v[40:43], v5 offset:7168
  v_mfma_f32_16x16x32_bf16 v[52:55], a[96:99], v[16:19], v[52:55]
  buffer_load_dwordx4 v2, s[4:7], s18 offen offset:3072 lds
  v_mfma_f32_16x16x32_bf16 v[56:59], a[176:179], v[16:19], v[56:59]
  v_mfma_f32_16x16x32_bf16 v[60:63], a[16:19], v[20:23], v[60:63]
  ds_read_b128 v[44:47], v5 offset:27648
  v_mfma_f32_16x16x32_bf16 v[64:67], a[96:99], v[20:23], v[64:67]
  buffer_load_dwordx4 v[144:147], v2, s[4:7], s41 offen offset:1024 sc1
  v_mfma_f32_16x16x32_bf16 v[68:71], a[176:179], v[20:23], v[68:71]
  s_waitcnt lgkmcnt(4)
  v_mfma_f32_16x16x32_bf16 v[48:51], a[20:23], v[24:27], v[48:51]
  ds_read_b128 v[16:19], v5 offset:8192
  v_mfma_f32_16x16x32_bf16 v[52:55], a[100:103], v[24:27], v[52:55]
  buffer_load_dwordx4 v[148:151], v2, s[4:7], s42 offen offset:2048 sc1
  v_mfma_f32_16x16x32_bf16 v[56:59], a[180:183], v[24:27], v[56:59]
  v_mfma_f32_16x16x32_bf16 v[60:63], a[20:23], v[28:31], v[60:63]
  ds_read_b128 v[20:23], v5 offset:28672
  v_mfma_f32_16x16x32_bf16 v[64:67], a[100:103], v[28:31], v[64:67]
  s_add_u32 m0, s13, 4096
  s_add_u32 s18, s12, 4096
  buffer_load_dwordx4 v2, s[4:7], s18 offen offset:0 lds
  v_mfma_f32_16x16x32_bf16 v[68:71], a[180:183], v[28:31], v[68:71]
  s_waitcnt lgkmcnt(4)
  v_mfma_f32_16x16x32_bf16 v[48:51], a[24:27], v[32:35], v[48:51]
  ds_read_b128 v[24:27], v5 offset:9216
  v_mfma_f32_16x16x32_bf16 v[52:55], a[104:107], v[32:35], v[52:55]
  buffer_load_dwordx4 v[112:115], v10, s[4:7], s38 offen offset:0 sc1
  v_mfma_f32_16x16x32_bf16 v[56:59], a[184:187], v[32:35], v[56:59]
  v_mfma_f32_16x16x32_bf16 v[60:63], a[24:27], v[36:39], v[60:63]
  ds_read_b128 v[28:31], v5 offset:29696
  v_mfma_f32_16x16x32_bf16 v[64:67], a[104:107], v[36:39], v[64:67]
  buffer_load_dwordx4 v[116:119], v10, s[4:7], s38 offen offset:256 sc1
  v_mfma_f32_16x16x32_bf16 v[68:71], a[184:187], v[36:39], v[68:71]
  s_waitcnt lgkmcnt(4)
  v_mfma_f32_16x16x32_bf16 v[48:51], a[28:31], v[40:43], v[48:51]
  ds_read_b128 v[32:35], v5 offset:10240
  v_mfma_f32_16x16x32_bf16 v[52:55], a[108:111], v[40:43], v[52:55]
  buffer_load_dwordx4 v2, s[4:7], s18 offen offset:1024 lds
  v_mfma_f32_16x16x32_bf16 v[56:59], a[188:191], v[40:43], v[56:59]
  buffer_load_dwordx4 v[152:155], v2, s[4:7], s41 offen offset:2048 sc1
  v_mfma_f32_16x16x32_bf16 v[60:63], a[28:31], v[44:47], v[60:63]
  ds_read_b128 v[36:39], v5 offset:30720
  v_mfma_f32_16x16x32_bf16 v[64:67], a[108:111], v[44:47], v[64:67]
  v_mfma_f32_16x16x32_bf16 v[68:71], a[188:191], v[44:47], v[68:71]
  buffer_load_dwordx4 v[156:159], v2, s[4:7], s42 offen offset:3072 sc1
  s_waitcnt lgkmcnt(4)
  v_mfma_f32_16x16x32_bf16 v[48:51], a[32:35], v[16:19], v[48:51]
  ds_read_b128 v[40:43], v5 offset:11264
  v_mfma_f32_16x16x32_bf16 v[52:55], a[112:115], v[16:19], v[52:55]
  v_mfma_f32_16x16x32_bf16 v[56:59], a[192:195], v[16:19], v[56:59]
  buffer_load_dwordx4 v2, s[4:7], s18 offen offset:2048 lds
  v_mfma_f32_16x16x32_bf16 v[60:63], a[32:35], v[20:23], v[60:63]
  ds_read_b128 v[44:47], v5 offset:31744
  v_mfma_f32_16x16x32_bf16 v[64:67], a[112:115], v[20:23], v[64:67]
  v_mfma_f32_16x16x32_bf16 v[68:71], a[192:195], v[20:23], v[68:71]
  buffer_load_dwordx4 v[120:123], v10, s[4:7], s39 offen offset:0 sc1
  s_waitcnt lgkmcnt(4)
  v_mfma_f32_16x16x32_bf16 v[48:51], a[36:39], v[24:27], v[48:51]
  ds_read_b128 v[16:19], v5 offset:12288
  v_mfma_f32_16x16x32_bf16 v[52:55], a[116:119], v[24:27], v[52:55]
  v_mfma_f32_16x16x32_bf16 v[56:59], a[196:199], v[24:27], v[56:59]
  buffer_load_dwordx4 v[124:127], v10, s[4:7], s39 offen offset:256 sc1
  v_mfma_f32_16x16x32_bf16 v[60:63], a[36:39], v[28:31], v[60:63]
  ds_read_b128 v[20:23], v5 offset:32768
  v_mfma_f32_16x16x32_bf16 v[64:67], a[116:119], v[28:31], v[64:67]
  v_mfma_f32_16x16x32_bf16 v[68:71], a[196:199], v[28:31], v[68:71]
  buffer_load_dwordx4 v2, s[4:7], s18 offen offset:3072 lds
  s_waitcnt lgkmcnt(4)
  v_mfma_f32_16x16x32_bf16 v[48:51], a[40:43], v[32:35], v[48:51]
  ds_read_b128 v[24:27], v5 offset:13312
  v_mfma_f32_16x16x32_bf16 v[52:55], a[120:123], v[32:35], v[52:55]
  v_mfma_f32_16x16x32_bf16 v[56:59], a[200:203], v[32:35], v[56:59]
  buffer_load_dwordx4 v[160:163], v2, s[4:7], s41 offen offset:3072 sc1
  v_mfma_f32_16x16x32_bf16 v[60:63], a[40:43], v[36:39], v[60:63]
  ds_read_b128 v[28:31], v5 offset:33792
  v_mfma_f32_16x16x32_bf16 v[64:67], a[120:123], v[36:39], v[64:67]
  buffer_load_dwordx4 v[164:167], v2, s[4:7], s43 offen offset:0 sc1
  v_mfma_f32_16x16x32_bf16 v[68:71], a[200:203], v[36:39], v[68:71]
  s_waitcnt lgkmcnt(4)
  v_mfma_f32_16x16x32_bf16 v[48:51], a[44:47], v[40:43], v[48:51]
  ds_read_b128 v[32:35], v5 offset:14336
  v_mfma_f32_16x16x32_bf16 v[52:55], a[124:127], v[40:43], v[52:55]
  s_add_u32 m0, s13, 8192
  s_add_u32 s18, s12, 8192
  buffer_load_dwordx4 v2, s[4:7], s18 offen offset:0 lds
  v_mfma_f32_16x16x32_bf16 v[56:59], a[204:207], v[40:43], v[56:59]
  v_mfma_f32_16x16x32_bf16 v[60:63], a[44:47], v[44:47], v[60:63]
  ds_read_b128 v[36:39], v5 offset:34816
  v_mfma_f32_16x16x32_bf16 v[64:67], a[124:127], v[44:47], v[64:67]
  buffer_load_dwordx4 v[128:131], v10, s[4:7], s40 offen offset:0 sc1
  v_mfma_f32_16x16x32_bf16 v[68:71], a[204:207], v[44:47], v[68:71]
  s_waitcnt lgkmcnt(4)
  v_mfma_f32_16x16x32_bf16 v[48:51], a[48:51], v[16:19], v[48:51]
  ds_read_b128 v[40:43], v5 offset:15360
  v_mfma_f32_16x16x32_bf16 v[52:55], a[128:131], v[16:19], v[52:55]
  buffer_load_dwordx4 v[132:135], v10, s[4:7], s40 offen offset:256 sc1
  v_mfma_f32_16x16x32_bf16 v[56:59], a[208:211], v[16:19], v[56:59]
  v_mfma_f32_16x16x32_bf16 v[60:63], a[48:51], v[20:23], v[60:63]
  ds_read_b128 v[44:47], v5 offset:35840
  v_mfma_f32_16x16x32_bf16 v[64:67], a[128:131], v[20:23], v[64:67]
  buffer_load_dwordx4 v2, s[4:7], s18 offen offset:1024 lds
  v_mfma_f32_16x16x32_bf16 v[68:71], a[208:211], v[20:23], v[68:71]
  s_waitcnt lgkmcnt(4)
  v_mfma_f32_16x16x32_bf16 v[48:51], a[52:55], v[24:27], v[48:51]
  ds_read_b128 v[16:19], v5 offset:16384
  v_mfma_f32_16x16x32_bf16 v[52:55], a[132:135], v[24:27], v[52:55]
  buffer_load_dwordx4 v[168:171], v2, s[4:7], s42 offen offset:0 sc1
  v_mfma_f32_16x16x32_bf16 v[56:59], a[212:215], v[24:27], v[56:59]
  v_mfma_f32_16x16x32_bf16 v[60:63], a[52:55], v[28:31], v[60:63]
  ds_read_b128 v[20:23], v5 offset:36864
  v_mfma_f32_16x16x32_bf16 v[64:67], a[132:135], v[28:31], v[64:67]
  buffer_load_dwordx4 v[172:175], v2, s[4:7], s43 offen offset:1024 sc1
  v_mfma_f32_16x16x32_bf16 v[68:71], a[212:215], v[28:31], v[68:71]
  s_waitcnt lgkmcnt(4)
  v_mfma_f32_16x16x32_bf16 v[48:51], a[56:59], v[32:35], v[48:51]
  ds_read_b128 v[24:27], v5 offset:17408
  v_mfma_f32_16x16x32_bf16 v[52:55], a[136:139], v[32:35], v[52:55]
  buffer_store_dwordx4 v[192:195], v2, s[4:7], s32 offen sc1
  v_mfma_f32_16x16x32_bf16 v[56:59], a[216:219], v[32:35], v[56:59]
  buffer_store_dwordx4 v[196:199], v15, s[4:7], s32 offen sc1
  v_mfma_f32_16x16x32_bf16 v[60:63], a[56:59], v[36:39], v[60:63]
  ds_read_b128 v[28:31], v5 offset:37888
  v_mfma_f32_16x16x32_bf16 v[64:67], a[136:139], v[36:39], v[64:67]
  s_add_i32 s15, s34, -1
  s_max_i32 s15, s15, 0
  v_mov_b32 v8, s15
  s_mov_b64 exec, 1
  buffer_store_dword v8, v7, s[4:7], s33 offen sc1
  s_mov_b64 exec, -1
  v_mfma_f32_16x16x32_bf16 v[68:71], a[216:219], v[36:39], v[68:71]
  s_waitcnt lgkmcnt(4)
  v_mfma_f32_16x16x32_bf16 v[48:51], a[60:63], v[40:43], v[48:51]
  ds_read_b128 v[32:35], v5 offset:18432
  v_mfma_f32_16x16x32_bf16 v[52:55], a[140:143], v[40:43], v[52:55]
  v_mfma_f32_16x16x32_bf16 v[56:59], a[220:223], v[40:43], v[56:59]
  v_mfma_f32_16x16x32_bf16 v[60:63], a[60:63], v[44:47], v[60:63]
  ds_read_b128 v[36:39], v5 offset:38912
  v_mfma_f32_16x16x32_bf16 v[64:67], a[140:143], v[44:47], v[64:67]
  v_mfma_f32_16x16x32_bf16 v[68:71], a[220:223], v[44:47], v[68:71]
  s_waitcnt lgkmcnt(4)
  v_mfma_f32_16x16x32_bf16 v[48:51], a[64:67], v[16:19], v[48:51]
  ds_read_b128 v[40:43], v5 offset:19456
  v_mfma_f32_16x16x32_bf16 v[52:55], a[144:147], v[16:19], v[52:55]
  v_mfma_f32_16x16x32_bf16 v[56:59], a[224:227], v[16:19], v[56:59]
  v_mfma_f32_16x16x32_bf16 v[60:63], a[64:67], v[20:23], v[60:63]
  ds_read_b128 v[44:47], v5 offset:39936
  v_mfma_f32_16x16x32_bf16 v[64:67], a[144:147], v[20:23], v[64:67]
  v_mfma_f32_16x16x32_bf16 v[68:71], a[224:227], v[20:23], v[68:71]
  s_waitcnt lgkmcnt(4)
  v_mfma_f32_16x16x32_bf16 v[48:51], a[68:71], v[24:27], v[48:51]
  v_mfma_f32_16x16x32_bf16 v[52:55], a[148:151], v[24:27], v[52:55]
  v_mfma_f32_16x16x32_bf16 v[56:59], a[228:231], v[24:27], v[56:59]
  v_mfma_f32_16x16x32_bf16 v[60:63], a[68:71], v[28:31], v[60:63]
  v_mfma_f32_16x16x32_bf16 v[64:67], a[148:151], v[28:31], v[64:67]
  v_mfma_f32_16x16x32_bf16 v[68:71], a[228:231], v[28:31], v[68:71]
  s_waitcnt lgkmcnt(2)
  v_mfma_f32_16x16x32_bf16 v[48:51], a[72:75], v[32:35], v[48:51]
  v_mfma_f32_16x16x32_bf16 v[52:55], a[152:155], v[32:35], v[52:55]
  v_mfma_f32_16x16x32_bf16 v[56:59], a[232:235], v[32:35], v[56:59]
  v_mfma_f32_16x16x32_bf16 v[60:63], a[72:75], v[36:39], v[60:63]
  v_mfma_f32_16x16x32_bf16 v[64:67], a[152:155], v[36:39], v[64:67]
  v_mfma_f32_16x16x32_bf16 v[68:71], a[232:235], v[36:39], v[68:71]
  s_waitcnt lgkmcnt(0)
  v_mfma_f32_16x16x32_bf16 v[48:51], a[76:79], v[40:43], v[48:51]
  v_mfma_f32_16x16x32_bf16 v[52:55], a[156:159], v[40:43], v[52:55]
  v_mfma_f32_16x16x32_bf16 v[56:59], a[236:239], v[40:43], v[56:59]
  v_mfma_f32_16x16x32_bf16 v[60:63], a[76:79], v[44:47], v[60:63]
  v_mfma_f32_16x16x32_bf16 v[64:67], a[156:159], v[44:47], v[64:67]
  v_mfma_f32_16x16x32_bf16 v[68:71], a[236:239], v[44:47], v[68:71]
  v_add_u32 v5, s19, v5
  s_sub_u32 s13, s13, s19
  s_sub_u32 s19, 0, s19
  s_add_u32 s12, s12, 40960
  s_add_u32 s24, s24, 1
  s_add_u32 s15, s14, s20
  v_cvt_pk_bf16_f32 v72, v48, v49
  v_cvt_pk_bf16_f32 v73, v50, v51
  v_cvt_pk_bf16_f32 v74, v52, v53
  v_cvt_pk_bf16_f32 v75, v54, v55
  v_cvt_pk_bf16_f32 v80, v56, v57
  v_cvt_pk_bf16_f32 v81, v58, v59
  buffer_store_dwordx4 v[72:75], v3, s[4:7], s15 offen
  v_cvt_pk_bf16_f32 v76, v60, v61
  v_cvt_pk_bf16_f32 v77, v62, v63
  v_cvt_pk_bf16_f32 v78, v64, v65
  v_cvt_pk_bf16_f32 v79, v66, v67
  v_cvt_pk_bf16_f32 v82, v68, v69
  v_cvt_pk_bf16_f32 v83, v70, v71
  buffer_store_dwordx4 v[76:79], v4, s[4:7], s15 offen
  buffer_store_dwordx4 v[80:83], v9, s[4:7], s15 offen
  s_waitcnt vmcnt(6)
  v_mfma_f32_16x16x32_bf16 v[176:179], v[96:99], v[136:139], 0
  v_mfma_f32_16x16x32_bf16 v[184:187], v[96:99], v[140:143], 0
  v_mfma_f32_16x16x32_bf16 v[180:183], v[100:103], v[136:139], 0
  v_mfma_f32_16x16x32_bf16 v[188:191], v[100:103], v[140:143], 0
  v_mfma_f32_16x16x32_bf16 v[176:179], v[104:107], v[144:147], v[176:179]
  v_mfma_f32_16x16x32_bf16 v[184:187], v[104:107], v[148:151], v[184:187]
  v_mfma_f32_16x16x32_bf16 v[180:183], v[108:111], v[144:147], v[180:183]
  v_mfma_f32_16x16x32_bf16 v[188:191], v[108:111], v[148:151], v[188:191]
  v_mfma_f32_16x16x32_bf16 v[176:179], v[112:115], v[152:155], v[176:179]
  v_mfma_f32_16x16x32_bf16 v[184:187], v[112:115], v[156:159], v[184:187]
  v_mfma_f32_16x16x32_bf16 v[180:183], v[116:119], v[152:155], v[180:183]
  v_mfma_f32_16x16x32_bf16 v[188:191], v[116:119], v[156:159], v[188:191]
  v_mfma_f32_16x16x32_bf16 v[176:179], v[120:123], v[160:163], v[176:179]
  v_mfma_f32_16x16x32_bf16 v[184:187], v[120:123], v[164:167], v[184:187]
  v_mfma_f32_16x16x32_bf16 v[180:183], v[124:127], v[160:163], v[180:183]
  v_mfma_f32_16x16x32_bf16 v[188:191], v[124:127], v[164:167], v[188:191]
  v_mfma_f32_16x16x32_bf16 v[176:179], v[128:131], v[168:171], v[176:179]
  v_mfma_f32_16x16x32_bf16 v[184:187], v[128:131], v[172:175], v[184:187]
  v_mfma_f32_16x16x32_bf16 v[180:183], v[132:135], v[168:171], v[180:183]
  v_mfma_f32_16x16x32_bf16 v[188:191], v[132:135], v[172:175], v[188:191]
  s_waitcnt vmcnt(0)
  v_mov_b32 v8, s24
  s_mov_b64 exec, 1
  s_cmp_lg_u32 s69, 0
  s_cbranch_scc1 mega0_kernel_pf4
  buffer_store_dword v8, v7, s[4:7], s25 offen
mega0_kernel_pf4_b:
  s_mov_b64 exec, -1
  s_add_u32 s20, s20, 325632
  s_cmp_ge_u32 s20, 1953792
  s_cselect_b32 s20, 0, s20
  v_cvt_pk_bf16_f32 v192, v176, v177
  v_cvt_pk_bf16_f32 v193, v178, v179
  v_cvt_pk_bf16_f32 v194, v180, v181
  v_cvt_pk_bf16_f32 v195, v182, v183
  v_cvt_pk_bf16_f32 v196, v184, v185
  v_cvt_pk_bf16_f32 v197, v186, v187
  v_cvt_pk_bf16_f32 v198, v188, v189
  v_cvt_pk_bf16_f32 v199, v190, v191
  s_mov_b32 s32, s31
  s_add_u32 s31, s31, 327680
  s_add_u32 s34, s34, 1
  s_cmp_lt_u32 s24, 64
  s_cbranch_scc1 mega_kv_tl
mega_kv_tt:
  buffer_store_dwordx4 v[192:195], v2, s[4:7], s32 offen sc1
  buffer_store_dwordx4 v[196:199], v15, s[4:7], s32 offen sc1
  s_cmp_eq_u32 s34, 64
  s_cbranch_scc1 mega_kv_te
  s_add_u32 s36, s28, s20
  s_add_u32 s37, s36, 40960
  s_add_u32 s38, s36, 81920
  s_add_u32 s39, s36, 122880
  s_add_u32 s40, s36, 163840
  s_add_u32 s41, s29, s20
  s_add_u32 s42, s41, 4096
  s_add_u32 s43, s41, 8192
  s_add_u32 s35, s34, 2
  buffer_load_dwordx4 v[96:99], v10, s[4:7], s36 offen offset:0 sc1
  buffer_load_dwordx4 v[100:103], v10, s[4:7], s36 offen offset:256 sc1
  buffer_load_dwordx4 v[104:107], v10, s[4:7], s37 offen offset:0 sc1
  buffer_load_dwordx4 v[108:111], v10, s[4:7], s37 offen offset:256 sc1
  buffer_load_dwordx4 v[112:115], v10, s[4:7], s38 offen offset:0 sc1
  buffer_load_dwordx4 v[116:119], v10, s[4:7], s38 offen offset:256 sc1
  buffer_load_dwordx4 v[120:123], v10, s[4:7], s39 offen offset:0 sc1
  buffer_load_dwordx4 v[124:127], v10, s[4:7], s39 offen offset:256 sc1
  s_waitcnt vmcnt(8)
  s_add_i32 s15, s34, 0
  s_max_i32 s15, s15, 0
  v_mov_b32 v8, s15
  s_mov_b64 exec, 1
  buffer_store_dword v8, v7, s[4:7], s33 offen sc1
  s_mov_b64 exec, -1
  s_cmp_ge_u32 s34, 62
  s_cselect_b64 vcc, -1, 0
  v_cndmask_b32 v11, v11, v12, vcc
  v_cndmask_b32 v13, v13, 1, vcc
  s_mov_b32 s30, 0
mega0_kernel_pv5:
  buffer_load_dword v14, v11, s[4:7], s71 offen sc1
  s_waitcnt vmcnt(0)
mega0_kernel_pv5_t:
  v_add_u32 v14, v14, v13
  v_cmp_gt_u32 vcc, s35, v14
  s_nop 0
  s_cbranch_vccz mega0_kernel_pv5_ok
  s_sleep 1
  s_add_u32 s30, s30, 1
  s_cmp_lt_u32 s30, 262144
  s_cbranch_scc1 mega0_kernel_pv5
  s_branch mega_fail
mega0_kernel_pv5_ok:
  buffer_load_dwordx4 v[136:139], v2, s[4:7], s41 offen offset:0 sc1
  buffer_load_dwordx4 v[140:143], v2, s[4:7], s42 offen offset:1024 sc1
  buffer_load_dwordx4 v[144:147], v2, s[4:7], s41 offen offset:1024 sc1
  buffer_load_dwordx4 v[148:151], v2, s[4:7], s42 offen offset:2048 sc1
  buffer_load_dwordx4 v[152:155], v2, s[4:7], s41 offen offset:2048 sc1
  buffer_load_dwordx4 v[156:159], v2, s[4:7], s42 offen offset:3072 sc1
  buffer_load_dwordx4 v[160:163], v2, s[4:7], s41 offen offset:3072 sc1
  buffer_load_dwordx4 v[164:167], v2, s[4:7], s43 offen offset:0 sc1
  buffer_load_dwordx4 v[168:171], v2, s[4:7], s42 offen offset:0 sc1
  buffer_load_dwordx4 v[172:175], v2, s[4:7], s43 offen offset:1024 sc1
  buffer_load_dwordx4 v[128:131], v10, s[4:7], s40 offen offset:0 sc1
  buffer_load_dwordx4 v[132:135], v10, s[4:7], s40 offen offset:256 sc1
  s_waitcnt vmcnt(10)
  v_mfma_f32_16x16x32_bf16 v[176:179], v[96:99], v[136:139], 0
  v_mfma_f32_16x16x32_bf16 v[184:187], v[96:99], v[140:143], 0
  v_mfma_f32_16x16x32_bf16 v[180:183], v[100:103], v[136:139], 0
  v_mfma_f32_16x16x32_bf16 v[188:191], v[100:103], v[140:143], 0
  s_waitcnt vmcnt(8)
  v_mfma_f32_16x16x32_bf16 v[176:179], v[104:107], v[144:147], v[176:179]
  v_mfma_f32_16x16x32_bf16 v[184:187], v[104:107], v[148:151], v[184:187]
  v_mfma_f32_16x16x32_bf16 v[180:183], v[108:111], v[144:147], v[180:183]
  v_mfma_f32_16x16x32_bf16 v[188:191], v[108:111], v[148:151], v[188:191]
  s_waitcnt vmcnt(6)
  v_mfma_f32_16x16x32_bf16 v[176:179], v[112:115], v[152:155], v[176:179]
  v_mfma_f32_16x16x32_bf16 v[184:187], v[112:115], v[156:159], v[184:187]
  v_mfma_f32_16x16x32_bf16 v[180:183], v[116:119], v[152:155], v[180:183]
  v_mfma_f32_16x16x32_bf16 v[188:191], v[116:119], v[156:159], v[188:191]
  s_waitcnt vmcnt(4)
  v_mfma_f32_16x16x32_bf16 v[176:179], v[120:123], v[160:163], v[176:179]
  v_mfma_f32_16x16x32_bf16 v[184:187], v[120:123], v[164:167], v[184:187]
  v_mfma_f32_16x16x32_bf16 v[180:183], v[124:127], v[160:163], v[180:183]
  v_mfma_f32_16x16x32_bf16 v[188:191], v[124:127], v[164:167], v[188:191]
  s_waitcnt vmcnt(0)
  v_mfma_f32_16x16x32_bf16 v[176:179], v[128:131], v[168:171], v[176:179]
  v_mfma_f32_16x16x32_bf16 v[184:187], v[128:131], v[172:175], v[184:187]
  v_mfma_f32_16x16x32_bf16 v[180:183], v[132:135], v[168:171], v[180:183]
  v_mfma_f32_16x16x32_bf16 v[188:191], v[132:135], v[172:175], v[188:191]
  s_add_u32 s20, s20, 325632
  s_cmp_ge_u32 s20, 1953792
  s_cselect_b32 s20, 0, s20
  v_cvt_pk_bf16_f32 v192, v176, v177
  v_cvt_pk_bf16_f32 v193, v178, v179
  v_cvt_pk_bf16_f32 v194, v180, v181
  v_cvt_pk_bf16_f32 v195, v182, v183
  v_cvt_pk_bf16_f32 v196, v184, v185
  v_cvt_pk_bf16_f32 v197, v186, v187
  v_cvt_pk_bf16_f32 v198, v188, v189
  v_cvt_pk_bf16_f32 v199, v190, v191
  s_mov_b32 s32, s31
  s_add_u32 s31, s31, 327680
  s_add_u32 s34, s34, 1
  s_branch mega_kv_tt
mega_kv_te:
  s_waitcnt vmcnt(0)
  s_add_i32 s15, s34, 0
  s_max_i32 s15, s15, 0
  v_mov_b32 v8, s15
  s_mov_b64 exec, 1
  buffer_store_dword v8, v7, s[4:7], s33 offen sc1
  s_mov_b64 exec, -1
  s_endpgm
mega_kv_red:
  s_mul_i32 s26, s68, 5
  s_add_u32 s26, s26, s27
  s_cmp_ge_u32 s26, 20
  s_cselect_b32 s15, 20, 0
  s_cselect_b32 s16, 20480, 0
  s_sub_u32 s27, s26, s15
  s_lshl_b32 s28, s26, 10
  s_add_u32 s31, s28, 68288512
  s_add_u32 s32, s28, 56000512
  s_lshl_b32 s15, s27, 6
  s_add_u32 s16, s16, s15
  s_cmp_eq_u32 s70, 0
  s_cselect_b32 s33, s16, s28
  s_cselect_b64 vcc, -1, 0
  v_and_b32 v84, 15, v1
  v_mul_u32_u24 v84, 1280, v84
  v_lshrrev_b32 v85, 4, v1
  v_lshl_add_u32 v84, v85, 4, v84
  v_cndmask_b32 v10, v2, v84, vcc
  v_and_b32 v84, 7, v1
  v_lshlrev_b32 v84, 7, v84
  s_lshl_b32 s15, s27, 10
  s_add_u32 s15, s15, 20480
  v_add_u32 v11, s15, v84
  s_mov_b32 s35, 1
  s_mov_b32 s34, 0xffff0000
  v_mov_b32 v14, 0
mega_kv_rl:
  s_mov_b32 s30, 0
  s_branch mega0_kernel_pv6_t
mega0_kernel_pv6:
  buffer_load_dword v14, v11, s[4:7], s71 offen sc1
  s_waitcnt vmcnt(0)
mega0_kernel_pv6_t:
  v_cmp_gt_u32 vcc, s35, v14
  s_nop 0
  s_cbranch_vccz mega0_kernel_pv6_ok
  s_sleep 2
  s_add_u32 s30, s30, 1
  s_cmp_lt_u32 s30, 262144
  s_cbranch_scc1 mega0_kernel_pv6
  s_branch mega_fail
mega0_kernel_pv6_ok:
  s_barrier
  ds_read_b128 v[16:19], v5 offset:0
  ds_read_b128 v[20:23], v5 offset:20480
  ds_read_b128 v[24:27], v5 offset:1024
  ds_read_b128 v[28:31], v5 offset:21504
  ds_read_b128 v[32:35], v5 offset:2048
  ds_read_b128 v[36:39], v5 offset:22528
  s_waitcnt lgkmcnt(4)
  v_mfma_f32_16x16x32_bf16 v[48:51], a[0:3], v[16:19], 0
  ds_read_b128 v[40:43], v5 offset:3072
  v_mfma_f32_16x16x32_bf16 v[52:55], a[80:83], v[16:19], 0
  s_add_u32 m0, s13, 0
  s_add_u32 s18, s12, 0
  buffer_load_dwordx4 v2, s[4:7], s18 offen offset:0 lds
  v_mfma_f32_16x16x32_bf16 v[56:59], a[160:163], v[16:19], 0
  v_mfma_f32_16x16x32_bf16 v[60:63], a[0:3], v[20:23], 0
  ds_read_b128 v[44:47], v5 offset:23552
  v_mfma_f32_16x16x32_bf16 v[64:67], a[80:83], v[20:23], 0
  v_mfma_f32_16x16x32_bf16 v[68:71], a[160:163], v[20:23], 0
  s_waitcnt lgkmcnt(4)
  v_mfma_f32_16x16x32_bf16 v[48:51], a[4:7], v[24:27], v[48:51]
  ds_read_b128 v[16:19], v5 offset:4096
  v_mfma_f32_16x16x32_bf16 v[52:55], a[84:87], v[24:27], v[52:55]
  v_mfma_f32_16x16x32_bf16 v[56:59], a[164:167], v[24:27], v[56:59]
  buffer_load_dwordx4 v2, s[4:7], s18 offen offset:1024 lds
  v_mfma_f32_16x16x32_bf16 v[60:63], a[4:7], v[28:31], v[60:63]
  ds_read_b128 v[20:23], v5 offset:24576
  v_mfma_f32_16x16x32_bf16 v[64:67], a[84:87], v[28:31], v[64:67]
  v_mfma_f32_16x16x32_bf16 v[68:71], a[164:167], v[28:31], v[68:71]
  s_waitcnt lgkmcnt(4)
  v_mfma_f32_16x16x32_bf16 v[48:51], a[8:11], v[32:35], v[48:51]
  ds_read_b128 v[24:27], v5 offset:5120
  v_mfma_f32_16x16x32_bf16 v[52:55], a[88:91], v[32:35], v[52:55]
  v_mfma_f32_16x16x32_bf16 v[56:59], a[168:171], v[32:35], v[56:59]
  v_mfma_f32_16x16x32_bf16 v[60:63], a[8:11], v[36:39], v[60:63]
  ds_read_b128 v[28:31], v5 offset:25600
  v_mfma_f32_16x16x32_bf16 v[64:67], a[88:91], v[36:39], v[64:67]
  v_mfma_f32_16x16x32_bf16 v[68:71], a[168:171], v[36:39], v[68:71]
  buffer_load_dwordx4 v2, s[4:7], s18 offen offset:2048 lds
  s_waitcnt lgkmcnt(4)
  v_mfma_f32_16x16x32_bf16 v[48:51], a[12:15], v[40:43], v[48:51]
  ds_read_b128 v[32:35], v5 offset:6144
  v_mfma_f32_16x16x32_bf16 v[52:55], a[92:95], v[40:43], v[52:55]
  v_mfma_f32_16x16x32_bf16 v[56:59], a[172:175], v[40:43], v[56:59]
  v_mfma_f32_16x16x32_bf16 v[60:63], a[12:15], v[44:47], v[60:63]
  ds_read_b128 v[36:39], v5 offset:26624
  v_mfma_f32_16x16x32_bf16 v[64:67], a[92:95], v[44:47], v[64:67]
  v_mfma_f32_16x16x32_bf16 v[68:71], a[172:175], v[44:47], v[68:71]
  s_waitcnt lgkmcnt(4)
  v_mfma_f32_16x16x32_bf16 v[48:51], a[16:19], v[16:19], v[48:51]
  ds_read_b128 v[40:43], v5 offset:7168
  v_mfma_f32_16x16x32_bf16 v[52:55], a[96:99], v[16:19], v[52:55]
  buffer_load_dwordx4 v2, s[4:7], s18 offen offset:3072 lds
  v_mfma_f32_16x16x32_bf16 v[56:59], a[176:179], v[16:19], v[56:59]
  v_mfma_f32_16x16x32_bf16 v[60:63], a[16:19], v[20:23], v[60:63]
  ds_read_b128 v[44:47], v5 offset:27648
  v_mfma_f32_16x16x32_bf16 v[64:67], a[96:99], v[20:23], v[64:67]
  v_mfma_f32_16x16x32_bf16 v[68:71], a[176:179], v[20:23], v[68:71]
  s_waitcnt lgkmcnt(4)
  v_mfma_f32_16x16x32_bf16 v[48:51], a[20:23], v[24:27], v[48:51]
  ds_read_b128 v[16:19], v5 offset:8192
  v_mfma_f32_16x16x32_bf16 v[52:55], a[100:103], v[24:27], v[52:55]
  v_mfma_f32_16x16x32_bf16 v[56:59], a[180:183], v[24:27], v[56:59]
  v_mfma_f32_16x16x32_bf16 v[60:63], a[20:23], v[28:31], v[60:63]
  ds_read_b128 v[20:23], v5 offset:28672
  v_mfma_f32_16x16x32_bf16 v[64:67], a[100:103], v[28:31], v[64:67]
  s_add_u32 m0, s13, 4096
  s_add_u32 s18, s12, 4096
  buffer_load_dwordx4 v2, s[4:7], s18 offen offset:0 lds
  v_mfma_f32_16x16x32_bf16 v[68:71], a[180:183], v[28:31], v[68:71]
  s_waitcnt lgkmcnt(4)
  v_mfma_f32_16x16x32_bf16 v[48:51], a[24:27], v[32:35], v[48:51]
  ds_read_b128 v[24:27], v5 offset:9216
  v_mfma_f32_16x16x32_bf16 v[52:55], a[104:107], v[32:35], v[52:55]
  v_mfma_f32_16x16x32_bf16 v[56:59], a[184:187], v[32:35], v[56:59]
  v_mfma_f32_16x16x32_bf16 v[60:63], a[24:27], v[36:39], v[60:63]
  ds_read_b128 v[28:31], v5 offset:29696
  v_mfma_f32_16x16x32_bf16 v[64:67], a[104:107], v[36:39], v[64:67]
  v_mfma_f32_16x16x32_bf16 v[68:71], a[184:187], v[36:39], v[68:71]
  s_waitcnt lgkmcnt(4)
  v_mfma_f32_16x16x32_bf16 v[48:51], a[28:31], v[40:43], v[48:51]
  ds_read_b128 v[32:35], v5 offset:10240
  v_mfma_f32_16x16x32_bf16 v[52:55], a[108:111], v[40:43], v[52:55]
  buffer_load_dwordx4 v2, s[4:7], s18 offen offset:1024 lds
  v_mfma_f32_16x16x32_bf16 v[56:59], a[188:191], v[40:43], v[56:59]
  v_mfma_f32_16x16x32_bf16 v[60:63], a[28:31], v[44:47], v[60:63]
  ds_read_b128 v[36:39], v5 offset:30720
  v_mfma_f32_16x16x32_bf16 v[64:67], a[108:111], v[44:47], v[64:67]
  v_mfma_f32_16x16x32_bf16 v[68:71], a[188:191], v[44:47], v[68:71]
  s_waitcnt lgkmcnt(4)
  v_mfma_f32_16x16x32_bf16 v[48:51], a[32:35], v[16:19], v[48:51]
  ds_read_b128 v[40:43], v5 offset:11264
  v_mfma_f32_16x16x32_bf16 v[52:55], a[112:115], v[16:19], v[52:55]
  v_mfma_f32_16x16x32_bf16 v[56:59], a[192:195], v[16:19], v[56:59]
  buffer_load_dwordx4 v2, s[4:7], s18 offen offset:2048 lds
  v_mfma_f32_16x16x32_bf16 v[60:63], a[32:35], v[20:23], v[60:63]
  ds_read_b128 v[44:47], v5 offset:31744
  v_mfma_f32_16x16x32_bf16 v[64:67], a[112:115], v[20:23], v[64:67]
  v_mfma_f32_16x16x32_bf16 v[68:71], a[192:195], v[20:23], v[68:71]
  s_waitcnt lgkmcnt(4)
  v_mfma_f32_16x16x32_bf16 v[48:51], a[36:39], v[24:27], v[48:51]
  ds_read_b128 v[16:19], v5 offset:12288
  v_mfma_f32_16x16x32_bf16 v[52:55], a[116:119], v[24:27], v[52:55]
  v_mfma_f32_16x16x32_bf16 v[56:59], a[196:199], v[24:27], v[56:59]
  v_mfma_f32_16x16x32_bf16 v[60:63], a[36:39], v[28:31], v[60:63]
  ds_read_b128 v[20:23], v5 offset:32768
  v_mfma_f32_16x16x32_bf16 v[64:67], a[116:119], v[28:31], v[64:67]
  v_mfma_f32_16x16x32_bf16 v[68:71], a[196:199], v[28:31], v[68:71]
  buffer_load_dwordx4 v2, s[4:7], s18 offen offset:3072 lds
  s_waitcnt lgkmcnt(4)
  v_mfma_f32_16x16x32_bf16 v[48:51], a[40:43], v[32:35], v[48:51]
  ds_read_b128 v[24:27], v5 offset:13312
  v_mfma_f32_16x16x32_bf16 v[52:55], a[120:123], v[32:35], v[52:55]
  v_mfma_f32_16x16x32_bf16 v[56:59], a[200:203], v[32:35], v[56:59]
  v_mfma_f32_16x16x32_bf16 v[60:63], a[40:43], v[36:39], v[60:63]
  ds_read_b128 v[28:31], v5 offset:33792
  v_mfma_f32_16x16x32_bf16 v[64:67], a[120:123], v[36:39], v[64:67]
  v_mfma_f32_16x16x32_bf16 v[68:71], a[200:203], v[36:39], v[68:71]
  s_waitcnt lgkmcnt(4)
  v_mfma_f32_16x16x32_bf16 v[48:51], a[44:47], v[40:43], v[48:51]
  ds_read_b128 v[32:35], v5 offset:14336
  v_mfma_f32_16x16x32_bf16 v[52:55], a[124:127], v[40:43], v[52:55]
  s_add_u32 m0, s13, 8192
  s_add_u32 s18, s12, 8192
  buffer_load_dwordx4 v2, s[4:7], s18 offen offset:0 lds
  v_mfma_f32_16x16x32_bf16 v[56:59], a[204:207], v[40:43], v[56:59]
  v_mfma_f32_16x16x32_bf16 v[60:63], a[44:47], v[44:47], v[60:63]
  ds_read_b128 v[36:39], v5 offset:34816
  v_mfma_f32_16x16x32_bf16 v[64:67], a[124:127], v[44:47], v[64:67]
  v_mfma_f32_16x16x32_bf16 v[68:71], a[204:207], v[44:47], v[68:71]
  s_waitcnt lgkmcnt(4)
  v_mfma_f32_16x16x32_bf16 v[48:51], a[48:51], v[16:19], v[48:51]
  ds_read_b128 v[40:43], v5 offset:15360
  v_mfma_f32_16x16x32_bf16 v[52:55], a[128:131], v[16:19], v[52:55]
  v_mfma_f32_16x16x32_bf16 v[56:59], a[208:211], v[16:19], v[56:59]
  v_mfma_f32_16x16x32_bf16 v[60:63], a[48:51], v[20:23], v[60:63]
  ds_read_b128 v[44:47], v5 offset:35840
  v_mfma_f32_16x16x32_bf16 v[64:67], a[128:131], v[20:23], v[64:67]
  buffer_load_dwordx4 v2, s[4:7], s18 offen offset:1024 lds
  v_mfma_f32_16x16x32_bf16 v[68:71], a[208:211], v[20:23], v[68:71]
  s_waitcnt lgkmcnt(4)
  v_mfma_f32_16x16x32_bf16 v[48:51], a[52:55], v[24:27], v[48:51]
  ds_read_b128 v[16:19], v5 offset:16384
  v_mfma_f32_16x16x32_bf16 v[52:55], a[132:135], v[24:27], v[52:55]
  v_mfma_f32_16x16x32_bf16 v[56:59], a[212:215], v[24:27], v[56:59]
  v_mfma_f32_16x16x32_bf16 v[60:63], a[52:55], v[28:31], v[60:63]
  ds_read_b128 v[20:23], v5 offset:36864
  v_mfma_f32_16x16x32_bf16 v[64:67], a[132:135], v[28:31], v[64:67]
  v_mfma_f32_16x16x32_bf16 v[68:71], a[212:215], v[28:31], v[68:71]
  s_waitcnt lgkmcnt(4)
  v_mfma_f32_16x16x32_bf16 v[48:51], a[56:59], v[32:35], v[48:51]
  ds_read_b128 v[24:27], v5 offset:17408
  v_mfma_f32_16x16x32_bf16 v[52:55], a[136:139], v[32:35], v[52:55]
  buffer_load_dwordx4 v[96:99], v2, s[4:7], s31 offen sc1
  s_add_u32 s31, s31, 40960
  v_mfma_f32_16x16x32_bf16 v[56:59], a[216:219], v[32:35], v[56:59]
  buffer_load_dwordx4 v[100:103], v2, s[4:7], s31 offen sc1
  s_add_u32 s31, s31, 40960
  v_mfma_f32_16x16x32_bf16 v[60:63], a[56:59], v[36:39], v[60:63]
  ds_read_b128 v[28:31], v5 offset:37888
  v_mfma_f32_16x16x32_bf16 v[64:67], a[136:139], v[36:39], v[64:67]
  buffer_load_dwordx4 v[104:107], v2, s[4:7], s31 offen sc1
  s_add_u32 s31, s31, 40960
  v_mfma_f32_16x16x32_bf16 v[68:71], a[216:219], v[36:39], v[68:71]
  buffer_load_dwordx4 v[108:111], v2, s[4:7], s31 offen sc1
  s_add_u32 s31, s31, 40960
  s_waitcnt lgkmcnt(4)
  v_mfma_f32_16x16x32_bf16 v[48:51], a[60:63], v[40:43], v[48:51]
  ds_read_b128 v[32:35], v5 offset:18432
  v_mfma_f32_16x16x32_bf16 v[52:55], a[140:143], v[40:43], v[52:55]
  buffer_load_dwordx4 v[112:115], v2, s[4:7], s31 offen sc1
  s_add_u32 s31, s31, 40960
  v_mfma_f32_16x16x32_bf16 v[56:59], a[220:223], v[40:43], v[56:59]
  buffer_load_dwordx4 v[116:119], v2, s[4:7], s31 offen sc1
  s_add_u32 s31, s31, 40960
  v_mfma_f32_16x16x32_bf16 v[60:63], a[60:63], v[44:47], v[60:63]
  ds_read_b128 v[36:39], v5 offset:38912
  v_mfma_f32_16x16x32_bf16 v[64:67], a[140:143], v[44:47], v[64:67]
  buffer_load_dwordx4 v[120:123], v2, s[4:7], s31 offen sc1
  s_add_u32 s31, s31, 40960
  v_mfma_f32_16x16x32_bf16 v[68:71], a[220:223], v[44:47], v[68:71]
  buffer_load_dwordx4 v[124:127], v2, s[4:7], s31 offen sc1
  s_add_u32 s31, s31, 40960
  s_waitcnt lgkmcnt(4)
  v_mfma_f32_16x16x32_bf16 v[48:51], a[64:67], v[16:19], v[48:51]
  ds_read_b128 v[40:43], v5 offset:19456
  v_mfma_f32_16x16x32_bf16 v[52:55], a[144:147], v[16:19], v[52:55]
  buffer_load_dwordx4 v[128:131], v10, s[84:87], s33 offen
  s_add_u32 s33, s33, 40960
  v_mfma_f32_16x16x32_bf16 v[56:59], a[224:227], v[16:19], v[56:59]
  buffer_load_dword v14, v11, s[4:7], s71 offen sc1
  v_mfma_f32_16x16x32_bf16 v[60:63], a[64:67], v[20:23], v[60:63]
  ds_read_b128 v[44:47], v5 offset:39936
  v_mfma_f32_16x16x32_bf16 v[64:67], a[144:147], v[20:23], v[64:67]
  v_mfma_f32_16x16x32_bf16 v[68:71], a[224:227], v[20:23], v[68:71]
  s_waitcnt lgkmcnt(4)
  v_mfma_f32_16x16x32_bf16 v[48:51], a[68:71], v[24:27], v[48:51]
  v_mfma_f32_16x16x32_bf16 v[52:55], a[148:151], v[24:27], v[52:55]
  v_mfma_f32_16x16x32_bf16 v[56:59], a[228:231], v[24:27], v[56:59]
  v_mfma_f32_16x16x32_bf16 v[60:63], a[68:71], v[28:31], v[60:63]
  v_mfma_f32_16x16x32_bf16 v[64:67], a[148:151], v[28:31], v[64:67]
  v_mfma_f32_16x16x32_bf16 v[68:71], a[228:231], v[28:31], v[68:71]
  s_waitcnt lgkmcnt(2)
  v_mfma_f32_16x16x32_bf16 v[48:51], a[72:75], v[32:35], v[48:51]
  v_mfma_f32_16x16x32_bf16 v[52:55], a[152:155], v[32:35], v[52:55]
  v_mfma_f32_16x16x32_bf16 v[56:59], a[232:235], v[32:35], v[56:59]
  v_mfma_f32_16x16x32_bf16 v[60:63], a[72:75], v[36:39], v[60:63]
  v_mfma_f32_16x16x32_bf16 v[64:67], a[152:155], v[36:39], v[64:67]
  v_mfma_f32_16x16x32_bf16 v[68:71], a[232:235], v[36:39], v[68:71]
  s_waitcnt lgkmcnt(0)
  v_mfma_f32_16x16x32_bf16 v[48:51], a[76:79], v[40:43], v[48:51]
  v_mfma_f32_16x16x32_bf16 v[52:55], a[156:159], v[40:43], v[52:55]
  v_mfma_f32_16x16x32_bf16 v[56:59], a[236:239], v[40:43], v[56:59]
  v_mfma_f32_16x16x32_bf16 v[60:63], a[76:79], v[44:47], v[60:63]
  v_mfma_f32_16x16x32_bf16 v[64:67], a[156:159], v[44:47], v[64:67]
  v_mfma_f32_16x16x32_bf16 v[68:71], a[236:239], v[44:47], v[68:71]
  v_add_u32 v5, s19, v5
  s_sub_u32 s13, s13, s19
  s_sub_u32 s19, 0, s19
  s_add_u32 s12, s12, 40960
  s_add_u32 s24, s24, 1
  s_add_u32 s15, s14, s20
  v_cvt_pk_bf16_f32 v72, v48, v49
  v_cvt_pk_bf16_f32 v73, v50, v51
  v_cvt_pk_bf16_f32 v74, v52, v53
  v_cvt_pk_bf16_f32 v75, v54, v55
  v_cvt_pk_bf16_f32 v80, v56, v57
  v_cvt_pk_bf16_f32 v81, v58, v59
  buffer_store_dwordx4 v[72:75], v3, s[4:7], s15 offen
  v_cvt_pk_bf16_f32 v76, v60, v61
  v_cvt_pk_bf16_f32 v77, v62, v63
  v_cvt_pk_bf16_f32 v78, v64, v65
  v_cvt_pk_bf16_f32 v79, v66, v67
  v_cvt_pk_bf16_f32 v82, v68, v69
  v_cvt_pk_bf16_f32 v83, v70, v71
  buffer_store_dwordx4 v[76:79], v4, s[4:7], s15 offen
  buffer_store_dwordx4 v[80:83], v9, s[4:7], s15 offen
  s_waitcnt vmcnt(0)
  v_mov_b32 v8, s24
  s_mov_b64 exec, 1
  s_cmp_lg_u32 s69, 0
  s_cbranch_scc1 mega0_kernel_pf7
  buffer_store_dword v8, v7, s[4:7], s25 offen
mega0_kernel_pf7_b:
  s_mov_b64 exec, -1
  s_add_u32 s20, s20, 325632
  s_cmp_ge_u32 s20, 1953792
  s_cselect_b32 s20, 0, s20
  v_lshlrev_b32 v132, 16, v96
  v_and_b32 v133, s34, v96
  v_lshlrev_b32 v134, 16, v97
  v_and_b32 v135, s34, v97
  v_lshlrev_b32 v136, 16, v98
  v_and_b32 v137, s34, v98
  v_lshlrev_b32 v138, 16, v99
  v_and_b32 v139, s34, v99
  v_lshlrev_b32 v140, 16, v100
  v_and_b32 v141, s34, v100
  v_pk_add_f32 v[132:133], v[132:133], v[140:141]
  v_lshlrev_b32 v142, 16, v101
  v_and_b32 v143, s34, v101
  v_pk_add_f32 v[134:135], v[134:135], v[142:143]
  v_lshlrev_b32 v140, 16, v102
  v_and_b32 v141, s34, v102
  v_pk_add_f32 v[136:137], v[136:137], v[140:141]
  v_lshlrev_b32 v142, 16, v103
  v_and_b32 v143, s34, v103
  v_pk_add_f32 v[138:139], v[138:139], v[142:143]
  v_lshlrev_b32 v140, 16, v104
  v_and_b32 v141, s34, v104
  v_pk_add_f32 v[132:133], v[132:133], v[140:141]
  v_lshlrev_b32 v142, 16, v105
  v_and_b32 v143, s34, v105
  v_pk_add_f32 v[134:135], v[134:135], v[142:143]
  v_lshlrev_b32 v140, 16, v106
  v_and_b32 v141, s34, v106
  v_pk_add_f32 v[136:137], v[136:137], v[140:141]
  v_lshlrev_b32 v142, 16, v107
  v_and_b32 v143, s34, v107
  v_pk_add_f32 v[138:139], v[138:139], v[142:143]
  v_lshlrev_b32 v140, 16, v108
  v_and_b32 v141, s34, v108
  v_pk_add_f32 v[132:133], v[132:133], v[140:141]
  v_lshlrev_b32 v142, 16, v109
  v_and_b32 v143, s34, v109
  v_pk_add_f32 v[134:135], v[134:135], v[142:143]
  v_lshlrev_b32 v140, 16, v110
  v_and_b32 v141, s34, v110
  v_pk_add_f32 v[136:137], v[136:137], v[140:141]
  v_lshlrev_b32 v142, 16, v111
  v_and_b32 v143, s34, v111
  v_pk_add_f32 v[138:139], v[138:139], v[142:143]
  v_lshlrev_b32 v140, 16, v112
  v_and_b32 v141, s34, v112
  v_pk_add_f32 v[132:133], v[132:133], v[140:141]
  v_lshlrev_b32 v142, 16, v113
  v_and_b32 v143, s34, v113
  v_pk_add_f32 v[134:135], v[134:135], v[142:143]
  v_lshlrev_b32 v140, 16, v114
  v_and_b32 v141, s34, v114
  v_pk_add_f32 v[136:137], v[136:137], v[140:141]
  v_lshlrev_b32 v142, 16, v115
  v_and_b32 v143, s34, v115
  v_pk_add_f32 v[138:139], v[138:139], v[142:143]
  v_lshlrev_b32 v140, 16, v116
  v_and_b32 v141, s34, v116
  v_pk_add_f32 v[132:133], v[132:133], v[140:141]
  v_lshlrev_b32 v142, 16, v117
  v_and_b32 v143, s34, v117
  v_pk_add_f32 v[134:135], v[134:135], v[142:143]
  v_lshlrev_b32 v140, 16, v118
  v_and_b32 v141, s34, v118
  v_pk_add_f32 v[136:137], v[136:137], v[140:141]
  v_lshlrev_b32 v142, 16, v119
  v_and_b32 v143, s34, v119
  v_pk_add_f32 v[138:139], v[138:139], v[142:143]
  v_lshlrev_b32 v140, 16, v120
  v_and_b32 v141, s34, v120
  v_pk_add_f32 v[132:133], v[132:133], v[140:141]
  v_lshlrev_b32 v142, 16, v121
  v_and_b32 v143, s34, v121
  v_pk_add_f32 v[134:135], v[134:135], v[142:143]
  v_lshlrev_b32 v140, 16, v122
  v_and_b32 v141, s34, v122
  v_pk_add_f32 v[136:137], v[136:137], v[140:141]
  v_lshlrev_b32 v142, 16, v123
  v_and_b32 v143, s34, v123
  v_pk_add_f32 v[138:139], v[138:139], v[142:143]
  v_lshlrev_b32 v140, 16, v124
  v_and_b32 v141, s34, v124
  v_pk_add_f32 v[132:133], v[132:133], v[140:141]
  v_lshlrev_b32 v142, 16, v125
  v_and_b32 v143, s34, v125
  v_pk_add_f32 v[134:135], v[134:135], v[142:143]
  v_lshlrev_b32 v140, 16, v126
  v_and_b32 v141, s34, v126
  v_pk_add_f32 v[136:137], v[136:137], v[140:141]
  v_lshlrev_b32 v142, 16, v127
  v_and_b32 v143, s34, v127
  v_pk_add_f32 v[138:139], v[138:139], v[142:143]
  v_lshlrev_b32 v140, 16, v128
  v_and_b32 v141, s34, v128
  v_pk_add_f32 v[132:133], v[132:133], v[140:141]
  v_lshlrev_b32 v142, 16, v129
  v_and_b32 v143, s34, v129
  v_pk_add_f32 v[134:135], v[134:135], v[142:143]
  v_lshlrev_b32 v140, 16, v130
  v_and_b32 v141, s34, v130
  v_pk_add_f32 v[136:137], v[136:137], v[140:141]
  v_lshlrev_b32 v142, 16, v131
  v_and_b32 v143, s34, v131
  v_pk_add_f32 v[138:139], v[138:139], v[142:143]
  v_cvt_pk_bf16_f32 v144, v132, v133
  v_cvt_pk_bf16_f32 v145, v134, v135
  v_cvt_pk_bf16_f32 v146, v136, v137
  v_cvt_pk_bf16_f32 v147, v138, v139
  buffer_store_dwordx4 v[144:147], v2, s[4:7], s32 offen
  s_add_u32 s32, s32, 40960
  s_add_u32 s35, s35, 1
  s_cmp_lt_u32 s24, 64
  s_cbranch_scc1 mega_kv_rl
mega_kv_rt:
  s_mov_b32 s30, 0
mega0_kernel_pv8:
  buffer_load_dword v14, v11, s[4:7], s71 offen sc1
  s_waitcnt vmcnt(0)
mega0_kernel_pv8_t:
  v_cmp_gt_u32 vcc, s35, v14
  s_nop 0
  s_cbranch_vccz mega0_kernel_pv8_ok
  s_sleep 1
  s_add_u32 s30, s30, 1
  s_cmp_lt_u32 s30, 262144
  s_cbranch_scc1 mega0_kernel_pv8
  s_branch mega_fail
mega0_kernel_pv8_ok:
  buffer_load_dwordx4 v[96:99], v2, s[4:7], s31 offen sc1
  s_add_u32 s31, s31, 40960
  buffer_load_dwordx4 v[100:103], v2, s[4:7], s31 offen sc1
  s_add_u32 s31, s31, 40960
  buffer_load_dwordx4 v[104:107], v2, s[4:7], s31 offen sc1
  s_add_u32 s31, s31, 40960
  buffer_load_dwordx4 v[108:111], v2, s[4:7], s31 offen sc1
  s_add_u32 s31, s31, 40960
  buffer_load_dwordx4 v[112:115], v2, s[4:7], s31 offen sc1
  s_add_u32 s31, s31, 40960
  buffer_load_dwordx4 v[116:119], v2, s[4:7], s31 offen sc1
  s_add_u32 s31, s31, 40960
  buffer_load_dwordx4 v[120:123], v2, s[4:7], s31 offen sc1
  s_add_u32 s31, s31, 40960
  buffer_load_dwordx4 v[124:127], v2, s[4:7], s31 offen sc1
  s_add_u32 s31, s31, 40960
  buffer_load_dwordx4 v[128:131], v10, s[84:87], s33 offen
  s_add_u32 s33, s33, 40960
  s_waitcnt vmcnt(0)
  v_lshlrev_b32 v132, 16, v96
  v_and_b32 v133, s34, v96
  v_lshlrev_b32 v134, 16, v97
  v_and_b32 v135, s34, v97
  v_lshlrev_b32 v136, 16, v98
  v_and_b32 v137, s34, v98
  v_lshlrev_b32 v138, 16, v99
  v_and_b32 v139, s34, v99
  v_lshlrev_b32 v140, 16, v100
  v_and_b32 v141, s34, v100
  v_pk_add_f32 v[132:133], v[132:133], v[140:141]
  v_lshlrev_b32 v142, 16, v101
  v_and_b32 v143, s34, v101
  v_pk_add_f32 v[134:135], v[134:135], v[142:143]
  v_lshlrev_b32 v140, 16, v102
  v_and_b32 v141, s34, v102
  v_pk_add_f32 v[136:137], v[136:137], v[140:141]
  v_lshlrev_b32 v142, 16, v103
  v_and_b32 v143, s34, v103
  v_pk_add_f32 v[138:139], v[138:139], v[142:143]
  v_lshlrev_b32 v140, 16, v104
  v_and_b32 v141, s34, v104
  v_pk_add_f32 v[132:133], v[132:133], v[140:141]
  v_lshlrev_b32 v142, 16, v105
  v_and_b32 v143, s34, v105
  v_pk_add_f32 v[134:135], v[134:135], v[142:143]
  v_lshlrev_b32 v140, 16, v106
  v_and_b32 v141, s34, v106
  v_pk_add_f32 v[136:137], v[136:137], v[140:141]
  v_lshlrev_b32 v142, 16, v107
  v_and_b32 v143, s34, v107
  v_pk_add_f32 v[138:139], v[138:139], v[142:143]
  v_lshlrev_b32 v140, 16, v108
  v_and_b32 v141, s34, v108
  v_pk_add_f32 v[132:133], v[132:133], v[140:141]
  v_lshlrev_b32 v142, 16, v109
  v_and_b32 v143, s34, v109
  v_pk_add_f32 v[134:135], v[134:135], v[142:143]
  v_lshlrev_b32 v140, 16, v110
  v_and_b32 v141, s34, v110
  v_pk_add_f32 v[136:137], v[136:137], v[140:141]
  v_lshlrev_b32 v142, 16, v111
  v_and_b32 v143, s34, v111
  v_pk_add_f32 v[138:139], v[138:139], v[142:143]
  v_lshlrev_b32 v140, 16, v112
  v_and_b32 v141, s34, v112
  v_pk_add_f32 v[132:133], v[132:133], v[140:141]
  v_lshlrev_b32 v142, 16, v113
  v_and_b32 v143, s34, v113
  v_pk_add_f32 v[134:135], v[134:135], v[142:143]
  v_lshlrev_b32 v140, 16, v114
  v_and_b32 v141, s34, v114
  v_pk_add_f32 v[136:137], v[136:137], v[140:141]
  v_lshlrev_b32 v142, 16, v115
  v_and_b32 v143, s34, v115
  v_pk_add_f32 v[138:139], v[138:139], v[142:143]
  v_lshlrev_b32 v140, 16, v116
  v_and_b32 v141, s34, v116
  v_pk_add_f32 v[132:133], v[132:133], v[140:141]
  v_lshlrev_b32 v142, 16, v117
  v_and_b32 v143, s34, v117
  v_pk_add_f32 v[134:135], v[134:135], v[142:143]
  v_lshlrev_b32 v140, 16, v118
  v_and_b32 v141, s34, v118
  v_pk_add_f32 v[136:137], v[136:137], v[140:141]
  v_lshlrev_b32 v142, 16, v119
  v_and_b32 v143, s34, v119
  v_pk_add_f32 v[138:139], v[138:139], v[142:143]
  v_lshlrev_b32 v140, 16, v120
  v_and_b32 v141, s34, v120
  v_pk_add_f32 v[132:133], v[132:133], v[140:141]
  v_lshlrev_b32 v142, 16, v121
  v_and_b32 v143, s34, v121
  v_pk_add_f32 v[134:135], v[134:135], v[142:143]
  v_lshlrev_b32 v140, 16, v122
  v_and_b32 v141, s34, v122
  v_pk_add_f32 v[136:137], v[136:137], v[140:141]
  v_lshlrev_b32 v142, 16, v123
  v_and_b32 v143, s34, v123
  v_pk_add_f32 v[138:139], v[138:139], v[142:143]
  v_lshlrev_b32 v140, 16, v124
  v_and_b32 v141, s34, v124
  v_pk_add_f32 v[132:133], v[132:133], v[140:141]
  v_lshlrev_b32 v142, 16, v125
  v_and_b32 v143, s34, v125
  v_pk_add_f32 v[134:135], v[134:135], v[142:143]
  v_lshlrev_b32 v140, 16, v126
  v_and_b32 v141, s34, v126
  v_pk_add_f32 v[136:137], v[136:137], v[140:141]
  v_lshlrev_b32 v142, 16, v127
  v_and_b32 v143, s34, v127
  v_pk_add_f32 v[138:139], v[138:139], v[142:143]
  v_lshlrev_b32 v140, 16, v128
  v_and_b32 v141, s34, v128
  v_pk_add_f32 v[132:133], v[132:133], v[140:141]
  v_lshlrev_b32 v142, 16, v129
  v_and_b32 v143, s34, v129
  v_pk_add_f32 v[134:135], v[134:135], v[142:143]
  v_lshlrev_b32 v140, 16, v130
  v_and_b32 v141, s34, v130
  v_pk_add_f32 v[136:137], v[136:137], v[140:141]
  v_lshlrev_b32 v142, 16, v131
  v_and_b32 v143, s34, v131
  v_pk_add_f32 v[138:139], v[138:139], v[142:143]
  v_cvt_pk_bf16_f32 v144, v132, v133
  v_cvt_pk_bf16_f32 v145, v134, v135
  v_cvt_pk_bf16_f32 v146, v136, v137
  v_cvt_pk_bf16_f32 v147, v138, v139
  buffer_store_dwordx4 v[144:147], v2, s[4:7], s32 offen
  s_add_u32 s32, s32, 40960
  s_add_u32 s35, s35, 1
  s_cmp_le_u32 s35, 64
  s_cbranch_scc1 mega_kv_rt
  s_endpgm
mega_urole:
  v_lshlrev_b32 v2, 4, v1
  v_mov_b32 v7, 0
  s_mul_i32 s10, s80, 245760
  s_mul_i32 s11, s3, 320
  s_add_u32 s10, s10, s11
  s_mul_i32 s11, s3, 30720
  v_mul_u32_u24 v18, 3277, v1
  v_lshrrev_b32 v18, 16, v18
  v_mul_u32_u24 v16, 20, v18
  v_sub_u32 v16, v1, v16
  v_lshlrev_b32 v16, 4, v16
  v_mul_u32_u24 v18, 1280, v18
  v_add_u32 v16, v16, v18
  v_lshrrev_b32 v18, 4, v1
  v_mul_u32_u24 v18, 4, v18
  v_bfe_u32 v17, v1, 2, 2
  v_add_u32 v18, v18, v17
  v_mul_u32_u24 v18, 320, v18
  v_and_b32 v17, 3, v1
  v_lshl_add_u32 v17, v17, 3, v18
  v_add_u32 v17, s11, v17
  s_mov_b64 exec, s[82:83]
  s_add_u32 m0, s11, 0
  s_nop 0
  buffer_load_dwordx4 v16, s[92:95], s10 offen lds
  s_add_u32 s10, s10, 3840
  s_add_u32 m0, s11, 960
  s_nop 0
  buffer_load_dwordx4 v16, s[92:95], s10 offen lds
  s_add_u32 s10, s10, 3840
  s_add_u32 m0, s11, 1920
  s_nop 0
  buffer_load_dwordx4 v16, s[92:95], s10 offen lds
  s_add_u32 s10, s10, 3840
  s_add_u32 m0, s11, 2880
  s_nop 0
  buffer_load_dwordx4 v16, s[92:95], s10 offen lds
  s_add_u32 s10, s10, 3840
  s_add_u32 m0, s11, 3840
  s_nop 0
  buffer_load_dwordx4 v16, s[92:95], s10 offen lds
  s_add_u32 s10, s10, 3840
  s_add_u32 m0, s11, 4800
  s_nop 0
  buffer_load_dwordx4 v16, s[92:95], s10 offen lds
  s_add_u32 s10, s10, 3840
  s_add_u32 m0, s11, 5760
  s_nop 0
  buffer_load_dwordx4 v16, s[92:95], s10 offen lds
  s_add_u32 s10, s10, 3840
  s_add_u32 m0, s11, 6720
  s_nop 0
  buffer_load_dwordx4 v16, s[92:95], s10 offen lds
  s_add_u32 s10, s10, 3840
  s_add_u32 m0, s11, 7680
  s_nop 0
  buffer_load_dwordx4 v16, s[92:95], s10 offen lds
  s_add_u32 s10, s10, 3840
  s_add_u32 m0, s11, 8640
  s_nop 0
  buffer_load_dwordx4 v16, s[92:95], s10 offen lds
  s_add_u32 s10, s10, 3840
  s_add_u32 m0, s11, 9600
  s_nop 0
  buffer_load_dwordx4 v16, s[92:95], s10 offen lds
  s_add_u32 s10, s10, 3840
  s_add_u32 m0, s11, 10560
  s_nop 0
  buffer_load_dwordx4 v16, s[92:95], s10 offen lds
  s_add_u32 s10, s10, 3840
  s_add_u32 m0, s11, 11520
  s_nop 0
  buffer_load_dwordx4 v16, s[92:95], s10 offen lds
  s_add_u32 s10, s10, 3840
  s_add_u32 m0, s11, 12480
  s_nop 0
  buffer_load_dwordx4 v16, s[92:95], s10 offen lds
  s_add_u32 s10, s10, 3840
  s_add_u32 m0, s11, 13440
  s_nop 0
  buffer_load_dwordx4 v16, s[92:95], s10 offen lds
  s_add_u32 s10, s10, 3840
  s_add_u32 m0, s11, 14400
  s_nop 0
  buffer_load_dwordx4 v16, s[92:95], s10 offen lds
  s_add_u32 s10, s10, 3840
  s_add_u32 m0, s11, 15360
  s_nop 0
  buffer_load_dwordx4 v16, s[92:95], s10 offen lds
  s_add_u32 s10, s10, 3840
  s_add_u32 m0, s11, 16320
  s_nop 0
  buffer_load_dwordx4 v16, s[92:95], s10 offen lds
  s_add_u32 s10, s10, 3840
  s_add_u32 m0, s11, 17280
  s_nop 0
  buffer_load_dwordx4 v16, s[92:95], s10 offen lds
  s_add_u32 s10, s10, 3840
  s_add_u32 m0, s11, 18240
  s_nop 0
  buffer_load_dwordx4 v16, s[92:95], s10 offen lds
  s_add_u32 s10, s10, 3840
  s_add_u32 m0, s11, 19200
  s_nop 0
  buffer_load_dwordx4 v16, s[92:95], s10 offen lds
  s_add_u32 s10, s10, 3840
  s_add_u32 m0, s11, 20160
  s_nop 0
  buffer_load_dwordx4 v16, s[92:95], s10 offen lds
  s_add_u32 s10, s10, 3840
  s_add_u32 m0, s11, 21120
  s_nop 0
  buffer_load_dwordx4 v16, s[92:95], s10 offen lds
  s_add_u32 s10, s10, 3840
  s_add_u32 m0, s11, 22080
  s_nop 0
  buffer_load_dwordx4 v16, s[92:95], s10 offen lds
  s_add_u32 s10, s10, 3840
  s_add_u32 m0, s11, 23040
  s_nop 0
  buffer_load_dwordx4 v16, s[92:95], s10 offen lds
  s_add_u32 s10, s10, 3840
  s_add_u32 m0, s11, 24000
  s_nop 0
  buffer_load_dwordx4 v16, s[92:95], s10 offen lds
  s_add_u32 s10, s10, 3840
  s_add_u32 m0, s11, 24960
  s_nop 0
  buffer_load_dwordx4 v16, s[92:95], s10 offen lds
  s_add_u32 s10, s10, 3840
  s_add_u32 m0, s11, 25920
  s_nop 0
  buffer_load_dwordx4 v16, s[92:95], s10 offen lds
  s_add_u32 s10, s10, 3840
  s_add_u32 m0, s11, 26880
  s_nop 0
  buffer_load_dwordx4 v16, s[92:95], s10 offen lds
  s_add_u32 s10, s10, 3840
  s_add_u32 m0, s11, 27840
  s_nop 0
  buffer_load_dwordx4 v16, s[92:95], s10 offen lds
  s_add_u32 s10, s10, 3840
  s_add_u32 m0, s11, 28800
  s_nop 0
  buffer_load_dwordx4 v16, s[92:95], s10 offen lds
  s_add_u32 s10, s10, 3840
  s_add_u32 m0, s11, 29760
  s_nop 0
  buffer_load_dwordx4 v16, s[92:95], s10 offen lds
  s_add_u32 s10, s10, 3840
  s_mov_b64 exec, -1
  s_waitcnt vmcnt(26)
  ds_read_b64_tr_b16 a[0:1], v17 offset:0
  ds_read_b64_tr_b16 a[24:25], v17 offset:32
  ds_read_b64_tr_b16 a[48:49], v17 offset:64
  ds_read_b64_tr_b16 a[72:73], v17 offset:96
  ds_read_b64_tr_b16 a[96:97], v17 offset:128
  ds_read_b64_tr_b16 a[120:121], v17 offset:160
  ds_read_b64_tr_b16 a[144:145], v17 offset:192
  ds_read_b64_tr_b16 a[168:169], v17 offset:224
  ds_read_b64_tr_b16 a[192:193], v17 offset:256
  ds_read_b64_tr_b16 a[216:217], v17 offset:288
  s_waitcnt lgkmcnt(0)
  s_mov_b64 exec, s[82:83]
  s_add_u32 m0, s11, 0
  s_nop 0
  buffer_load_dwordx4 v16, s[92:95], s10 offen lds
  s_add_u32 s10, s10, 3840
  s_add_u32 m0, s11, 960
  s_nop 0
  buffer_load_dwordx4 v16, s[92:95], s10 offen lds
  s_add_u32 s10, s10, 3840
  s_add_u32 m0, s11, 1920
  s_nop 0
  buffer_load_dwordx4 v16, s[92:95], s10 offen lds
  s_add_u32 s10, s10, 3840
  s_add_u32 m0, s11, 2880
  s_nop 0
  buffer_load_dwordx4 v16, s[92:95], s10 offen lds
  s_add_u32 s10, s10, 3840
  s_add_u32 m0, s11, 3840
  s_nop 0
  buffer_load_dwordx4 v16, s[92:95], s10 offen lds
  s_add_u32 s10, s10, 3840
  s_mov_b64 exec, -1
  s_waitcnt vmcnt(26)
  ds_read_b64_tr_b16 a[2:3], v17 offset:5120
  ds_read_b64_tr_b16 a[26:27], v17 offset:5152
  ds_read_b64_tr_b16 a[50:51], v17 offset:5184
  ds_read_b64_tr_b16 a[74:75], v17 offset:5216
  ds_read_b64_tr_b16 a[98:99], v17 offset:5248
  ds_read_b64_tr_b16 a[122:123], v17 offset:5280
  ds_read_b64_tr_b16 a[146:147], v17 offset:5312
  ds_read_b64_tr_b16 a[170:171], v17 offset:5344
  ds_read_b64_tr_b16 a[194:195], v17 offset:5376
  ds_read_b64_tr_b16 a[218:219], v17 offset:5408
  s_waitcnt lgkmcnt(0)
  s_mov_b64 exec, s[82:83]
  s_add_u32 m0, s11, 4800
  s_nop 0
  buffer_load_dwordx4 v16, s[92:95], s10 offen lds
  s_add_u32 s10, s10, 3840
  s_add_u32 m0, s11, 5760
  s_nop 0
  buffer_load_dwordx4 v16, s[92:95], s10 offen lds
  s_add_u32 s10, s10, 3840
  s_add_u32 m0, s11, 6720
  s_nop 0
  buffer_load_dwordx4 v16, s[92:95], s10 offen lds
  s_add_u32 s10, s10, 3840
  s_add_u32 m0, s11, 7680
  s_nop 0
  buffer_load_dwordx4 v16, s[92:95], s10 offen lds
  s_add_u32 s10, s10, 3840
  s_add_u32 m0, s11, 8640
  s_nop 0
  buffer_load_dwordx4 v16, s[92:95], s10 offen lds
  s_add_u32 s10, s10, 3840
  s_mov_b64 exec, -1
  s_waitcnt vmcnt(26)
  ds_read_b64_tr_b16 a[16:17], v17 offset:10240
  ds_read_b64_tr_b16 a[40:41], v17 offset:10272
  ds_read_b64_tr_b16 a[64:65], v17 offset:10304
  ds_read_b64_tr_b16 a[88:89], v17 offset:10336
  ds_read_b64_tr_b16 a[112:113], v17 offset:10368
  ds_read_b64_tr_b16 a[136:137], v17 offset:10400
  ds_read_b64_tr_b16 a[160:161], v17 offset:10432
  ds_read_b64_tr_b16 a[184:185], v17 offset:10464
  ds_read_b64_tr_b16 a[208:209], v17 offset:10496
  ds_read_b64_tr_b16 a[232:233], v17 offset:10528
  s_waitcnt lgkmcnt(0)
  s_mov_b64 exec, s[82:83]
  s_add_u32 m0, s11, 9600
  s_nop 0
  buffer_load_dwordx4 v16, s[92:95], s10 offen lds
  s_add_u32 s10, s10, 3840
  s_add_u32 m0, s11, 10560
  s_nop 0
  buffer_load_dwordx4 v16, s[92:95], s10 offen lds
  s_add_u32 s10, s10, 3840
  s_add_u32 m0, s11, 11520
  s_nop 0
  buffer_load_dwordx4 v16, s[92:95], s10 offen lds
  s_add_u32 s10, s10, 3840
  s_add_u32 m0, s11, 12480
  s_nop 0
  buffer_load_dwordx4 v16, s[92:95], s10 offen lds
  s_add_u32 s10, s10, 3840
  s_add_u32 m0, s11, 13440
  s_nop 0
  buffer_load_dwordx4 v16, s[92:95], s10 offen lds
  s_add_u32 s10, s10, 3840
  s_add_u32 m0, s11, 14400
  s_nop 0
  buffer_load_dwordx4 v16, s[92:95], s10 offen lds
  s_add_u32 s10, s10, 3840
  s_mov_b64 exec, -1
  s_waitcnt vmcnt(26)
  ds_read_b64_tr_b16 a[4:5], v17 offset:15360
  ds_read_b64_tr_b16 a[28:29], v17 offset:15392
  ds_read_b64_tr_b16 a[52:53], v17 offset:15424
  ds_read_b64_tr_b16 a[76:77], v17 offset:15456
  ds_read_b64_tr_b16 a[100:101], v17 offset:15488
  ds_read_b64_tr_b16 a[124:125], v17 offset:15520
  ds_read_b64_tr_b16 a[148:149], v17 offset:15552
  ds_read_b64_tr_b16 a[172:173], v17 offset:15584
  ds_read_b64_tr_b16 a[196:197], v17 offset:15616
  ds_read_b64_tr_b16 a[220:221], v17 offset:15648
  s_waitcnt lgkmcnt(0)
  s_mov_b64 exec, s[82:83]
  s_add_u32 m0, s11, 15360
  s_nop 0
  buffer_load_dwordx4 v16, s[92:95], s10 offen lds
  s_add_u32 s10, s10, 3840
  s_add_u32 m0, s11, 16320
  s_nop 0
  buffer_load_dwordx4 v16, s[92:95], s10 offen lds
  s_add_u32 s10, s10, 3840
  s_add_u32 m0, s11, 17280
  s_nop 0
  buffer_load_dwordx4 v16, s[92:95], s10 offen lds
  s_add_u32 s10, s10, 3840
  s_add_u32 m0, s11, 18240
  s_nop 0
  buffer_load_dwordx4 v16, s[92:95], s10 offen lds
  s_add_u32 s10, s10, 3840
  s_add_u32 m0, s11, 19200
  s_nop 0
  buffer_load_dwordx4 v16, s[92:95], s10 offen lds
  s_add_u32 s10, s10, 3840
  s_mov_b64 exec, -1
  s_waitcnt vmcnt(26)
  ds_read_b64_tr_b16 a[6:7], v17 offset:20480
  ds_read_b64_tr_b16 a[30:31], v17 offset:20512
  ds_read_b64_tr_b16 a[54:55], v17 offset:20544
  ds_read_b64_tr_b16 a[78:79], v17 offset:20576
  ds_read_b64_tr_b16 a[102:103], v17 offset:20608
  ds_read_b64_tr_b16 a[126:127], v17 offset:20640
  ds_read_b64_tr_b16 a[150:151], v17 offset:20672
  ds_read_b64_tr_b16 a[174:175], v17 offset:20704
  ds_read_b64_tr_b16 a[198:199], v17 offset:20736
  ds_read_b64_tr_b16 a[222:223], v17 offset:20768
  s_waitcnt lgkmcnt(0)
  s_mov_b64 exec, s[82:83]
  s_add_u32 m0, s11, 20160
  s_nop 0
  buffer_load_dwordx4 v16, s[92:95], s10 offen lds
  s_add_u32 s10, s10, 3840
  s_add_u32 m0, s11, 21120
  s_nop 0
  buffer_load_dwordx4 v16, s[92:95], s10 offen lds
  s_add_u32 s10, s10, 3840
  s_add_u32 m0, s11, 22080
  s_nop 0
  buffer_load_dwordx4 v16, s[92:95], s10 offen lds
  s_add_u32 s10, s10, 3840
  s_add_u32 m0, s11, 23040
  s_nop 0
  buffer_load_dwordx4 v16, s[92:95], s10 offen lds
  s_add_u32 s10, s10, 3840
  s_add_u32 m0, s11, 24000
  s_nop 0
  buffer_load_dwordx4 v16, s[92:95], s10 offen lds
  s_add_u32 s10, s10, 3840
  s_mov_b64 exec, -1
  s_waitcnt vmcnt(26)
  ds_read_b64_tr_b16 a[18:19], v17 offset:25600
  ds_read_b64_tr_b16 a[42:43], v17 offset:25632
  ds_read_b64_tr_b16 a[66:67], v17 offset:25664
  ds_read_b64_tr_b16 a[90:91], v17 offset:25696
  ds_read_b64_tr_b16 a[114:115], v17 offset:25728
  ds_read_b64_tr_b16 a[138:139], v17 offset:25760
  ds_read_b64_tr_b16 a[162:163], v17 offset:25792
  ds_read_b64_tr_b16 a[186:187], v17 offset:25824
  ds_read_b64_tr_b16 a[210:211], v17 offset:25856
  ds_read_b64_tr_b16 a[234:235], v17 offset:25888
  s_waitcnt lgkmcnt(0)
  s_mov_b64 exec, s[82:83]
  s_add_u32 m0, s11, 24960
  s_nop 0
  buffer_load_dwordx4 v16, s[92:95], s10 offen lds
  s_add_u32 s10, s10, 3840
  s_add_u32 m0, s11, 25920
  s_nop 0
  buffer_load_dwordx4 v16, s[92:95], s10 offen lds
  s_add_u32 s10, s10, 3840
  s_add_u32 m0, s11, 26880
  s_nop 0
  buffer_load_dwordx4 v16, s[92:95], s10 offen lds
  s_add_u32 s10, s10, 3840
  s_add_u32 m0, s11, 27840
  s_nop 0
  buffer_load_dwordx4 v16, s[92:95], s10 offen lds
  s_add_u32 s10, s10, 3840
  s_add_u32 m0, s11, 28800
  s_nop 0
  buffer_load_dwordx4 v16, s[92:95], s10 offen lds
  s_add_u32 s10, s10, 3840
  s_add_u32 m0, s11, 29760
  s_nop 0
  buffer_load_dwordx4 v16, s[92:95], s10 offen lds
  s_add_u32 s10, s10, 3840
  s_mov_b64 exec, -1
  s_waitcnt vmcnt(26)
  ds_read_b64_tr_b16 a[8:9], v17 offset:0
  ds_read_b64_tr_b16 a[32:33], v17 offset:32
  ds_read_b64_tr_b16 a[56:57], v17 offset:64
  ds_read_b64_tr_b16 a[80:81], v17 offset:96
  ds_read_b64_tr_b16 a[104:105], v17 offset:128
  ds_read_b64_tr_b16 a[128:129], v17 offset:160
  ds_read_b64_tr_b16 a[152:153], v17 offset:192
  ds_read_b64_tr_b16 a[176:177], v17 offset:224
  ds_read_b64_tr_b16 a[200:201], v17 offset:256
  ds_read_b64_tr_b16 a[224:225], v17 offset:288
  s_waitcnt vmcnt(21)
  ds_read_b64_tr_b16 a[10:11], v17 offset:5120
  ds_read_b64_tr_b16 a[34:35], v17 offset:5152
  ds_read_b64_tr_b16 a[58:59], v17 offset:5184
  ds_read_b64_tr_b16 a[82:83], v17 offset:5216
  ds_read_b64_tr_b16 a[106:107], v17 offset:5248
  ds_read_b64_tr_b16 a[130:131], v17 offset:5280
  ds_read_b64_tr_b16 a[154:155], v17 offset:5312
  ds_read_b64_tr_b16 a[178:179], v17 offset:5344
  ds_read_b64_tr_b16 a[202:203], v17 offset:5376
  ds_read_b64_tr_b16 a[226:227], v17 offset:5408
  s_waitcnt vmcnt(16)
  ds_read_b64_tr_b16 a[20:21], v17 offset:10240
  ds_read_b64_tr_b16 a[44:45], v17 offset:10272
  ds_read_b64_tr_b16 a[68:69], v17 offset:10304
  ds_read_b64_tr_b16 a[92:93], v17 offset:10336
  ds_read_b64_tr_b16 a[116:117], v17 offset:10368
  ds_read_b64_tr_b16 a[140:141], v17 offset:10400
  ds_read_b64_tr_b16 a[164:165], v17 offset:10432
  ds_read_b64_tr_b16 a[188:189], v17 offset:10464
  ds_read_b64_tr_b16 a[212:213], v17 offset:10496
  ds_read_b64_tr_b16 a[236:237], v17 offset:10528
  s_waitcnt vmcnt(10)
  ds_read_b64_tr_b16 a[12:13], v17 offset:15360
  ds_read_b64_tr_b16 a[36:37], v17 offset:15392
  ds_read_b64_tr_b16 a[60:61], v17 offset:15424
  ds_read_b64_tr_b16 a[84:85], v17 offset:15456
  ds_read_b64_tr_b16 a[108:109], v17 offset:15488
  ds_read_b64_tr_b16 a[132:133], v17 offset:15520
  ds_read_b64_tr_b16 a[156:157], v17 offset:15552
  ds_read_b64_tr_b16 a[180:181], v17 offset:15584
  ds_read_b64_tr_b16 a[204:205], v17 offset:15616
  ds_read_b64_tr_b16 a[228:229], v17 offset:15648
  s_waitcnt vmcnt(5)
  ds_read_b64_tr_b16 a[14:15], v17 offset:20480
  ds_read_b64_tr_b16 a[38:39], v17 offset:20512
  ds_read_b64_tr_b16 a[62:63], v17 offset:20544
  ds_read_b64_tr_b16 a[86:87], v17 offset:20576
  ds_read_b64_tr_b16 a[110:111], v17 offset:20608
  ds_read_b64_tr_b16 a[134:135], v17 offset:20640
  ds_read_b64_tr_b16 a[158:159], v17 offset:20672
  ds_read_b64_tr_b16 a[182:183], v17 offset:20704
  ds_read_b64_tr_b16 a[206:207], v17 offset:20736
  ds_read_b64_tr_b16 a[230:231], v17 offset:20768
  s_waitcnt vmcnt(0)
  ds_read_b64_tr_b16 a[22:23], v17 offset:25600
  ds_read_b64_tr_b16 a[46:47], v17 offset:25632
  ds_read_b64_tr_b16 a[70:71], v17 offset:25664
  ds_read_b64_tr_b16 a[94:95], v17 offset:25696
  ds_read_b64_tr_b16 a[118:119], v17 offset:25728
  ds_read_b64_tr_b16 a[142:143], v17 offset:25760
  ds_read_b64_tr_b16 a[166:167], v17 offset:25792
  ds_read_b64_tr_b16 a[190:191], v17 offset:25824
  ds_read_b64_tr_b16 a[214:215], v17 offset:25856
  ds_read_b64_tr_b16 a[238:239], v17 offset:25888
  s_waitcnt lgkmcnt(0)
  s_lshl_b32 s28, s68, 2
  v_mov_b32 v17, s28
  s_mov_b32 s28, 0
mega0_kernel_cen9:
  buffer_load_dword v16, v17, s[44:47], 0 offen sc1
  s_waitcnt vmcnt(0)
  v_readfirstlane_b32 s26, v16
  s_nop 0
  s_and_b32 s27, s26, 63
  s_cmp_eq_u32 s27, 32
  s_cbranch_scc1 mega0_kernel_cen9_done
  s_sleep 4
  s_add_u32 s28, s28, 1
  s_cmp_lt_u32 s28, 262144
  s_cbranch_scc1 mega0_kernel_cen9
  s_branch mega_fail
mega0_kernel_cen9_done:
  s_cmp_eq_u32 s26, s69
  s_cselect_b32 s69, 0, 1
  s_and_b32 s9, s80, 3
  s_mul_i32 s12, s9, 12288
  s_lshl_b32 s13, s3, 10
  s_add_u32 s12, s12, s13
  s_add_u32 s12, s12, s78
  s_add_u32 s12, s12, 253952
  s_add_u32 s13, s13, 122880
  v_add_u32 v5, 122880, v2
  s_mov_b32 s19, 12288
  s_mul_i32 s14, s9, 40960
  s_mul_i32 s15, s3, 10240
  s_add_u32 s14, s14, s15
  s_add_u32 s14, s14, s78
  v_and_b32 v3, 15, v1
  v_lshlrev_b32 v3, 6, v3
  v_lshrrev_b32 v4, 4, v1
  v_lshl_add_u32 v3, v4, 4, v3
  s_lshl_b32 s21, s80, 7
  s_add_u32 s21, s21, s71
  s_lshl_b32 s15, s3, 2
  s_add_u32 s21, s21, s15
  s_add_u32 s21, s21, 12288
  v_and_b32 v6, 3, v1
  v_lshlrev_b32 v6, 2, v6
  v_bfe_u32 v8, v1, 2, 2
  v_lshl_add_u32 v6, v8, 7, v6
  v_bfe_u32 v8, v1, 4, 1
  v_lshl_add_u32 v6, v8, 12, v6
  s_lshl_b32 s15, s68, 9
  v_add_u32 v6, s15, v6
  s_mov_b32 s20, 0
  s_mov_b32 s24, 1
mega_u_loop:
  s_add_u32 s15, s12, s20
  s_add_u32 s16, s14, s20
  s_add_u32 s17, s16, 4096
  s_add_u32 s18, s16, 8192
  s_mov_b32 s30, 0
mega0_kernel_pv10:
  buffer_load_dword v8, v6, s[4:7], s71 offen sc1
  s_waitcnt vmcnt(0)
mega0_kernel_pv10_t:
  v_cmp_gt_u32 vcc, s24, v8
  s_nop 0
  s_cbranch_vccz mega0_kernel_pv10_ok
  s_sleep 1
  s_add_u32 s30, s30, 1
  s_cmp_lt_u32 s30, 262144
  s_cbranch_scc1 mega0_kernel_pv10
  s_branch mega_fail
mega0_kernel_pv10_ok:
  s_add_u32 m0, s13, 0
  s_add_u32 s22, s15, 0
  buffer_load_dwordx4 v2, s[4:7], s22 offen sc1 lds
  s_add_u32 m0, s13, 4096
  s_add_u32 s22, s15, 4096
  buffer_load_dwordx4 v2, s[4:7], s22 offen sc1 lds
  s_add_u32 m0, s13, 8192
  s_add_u32 s22, s15, 8192
  buffer_load_dwordx4 v2, s[4:7], s22 offen sc1 lds
  s_waitcnt vmcnt(0)
  s_barrier
  ds_read_b128 v[16:19], v5 offset:0
  ds_read_b128 v[40:43], v5 offset:4096
  ds_read_b128 v[20:23], v5 offset:1024
  ds_read_b128 v[44:47], v5 offset:5120
  ds_read_b128 v[24:27], v5 offset:2048
  ds_read_b128 v[48:51], v5 offset:6144
  ds_read_b128 v[28:31], v5 offset:3072
  ds_read_b128 v[52:55], v5 offset:7168
  ds_read_b64 v[32:33], v5 offset:8192
  ds_read_b64 v[34:35], v5 offset:9216
  ds_read_b64 v[56:57], v5 offset:8200
  ds_read_b64 v[58:59], v5 offset:9224
  ds_read_b64 v[36:37], v5 offset:10240
  ds_read_b64 v[38:39], v5 offset:11264
  s_waitcnt lgkmcnt(12)
  ds_read_b64 v[60:61], v5 offset:10248
  ds_read_b64 v[62:63], v5 offset:11272
  s_waitcnt lgkmcnt(14)
  v_mfma_f32_16x16x32_bf16 v[112:115], v[16:19], a[0:3], 0
  v_mfma_f32_16x16x32_bf16 v[116:119], v[40:43], a[0:3], 0
  s_waitcnt lgkmcnt(12)
  v_mfma_f32_16x16x32_bf16 v[112:115], v[20:23], a[4:7], v[112:115]
  v_mfma_f32_16x16x32_bf16 v[116:119], v[44:47], a[4:7], v[116:119]
  s_waitcnt lgkmcnt(10)
  v_mfma_f32_16x16x32_bf16 v[112:115], v[24:27], a[8:11], v[112:115]
  v_mfma_f32_16x16x32_bf16 v[116:119], v[48:51], a[8:11], v[116:119]
  s_waitcnt lgkmcnt(8)
  v_mfma_f32_16x16x32_bf16 v[112:115], v[28:31], a[12:15], v[112:115]
  v_mfma_f32_16x16x32_bf16 v[116:119], v[52:55], a[12:15], v[116:119]
  s_waitcnt lgkmcnt(4)
  v_mfma_f32_16x16x32_bf16 v[112:115], v[32:35], a[16:19], v[112:115]
  v_mfma_f32_16x16x32_bf16 v[116:119], v[56:59], a[16:19], v[116:119]
  s_waitcnt lgkmcnt(0)
  v_mfma_f32_16x16x32_bf16 v[112:115], v[36:39], a[20:23], v[112:115]
  v_mfma_f32_16x16x32_bf16 v[116:119], v[60:63], a[20:23], v[116:119]
  v_mfma_f32_16x16x32_bf16 v[120:123], v[16:19], a[24:27], 0
  v_mfma_f32_16x16x32_bf16 v[124:127], v[40:43], a[24:27], 0
  v_mfma_f32_16x16x32_bf16 v[120:123], v[20:23], a[28:31], v[120:123]
  v_mfma_f32_16x16x32_bf16 v[124:127], v[44:47], a[28:31], v[124:127]
  v_mfma_f32_16x16x32_bf16 v[120:123], v[24:27], a[32:35], v[120:123]
  v_mfma_f32_16x16x32_bf16 v[124:127], v[48:51], a[32:35], v[124:127]
  v_cvt_pk_bf16_f32 v128, v112, v113
  v_cvt_pk_bf16_f32 v129, v114, v115
  v_cvt_pk_bf16_f32 v130, v116, v117
  v_cvt_pk_bf16_f32 v131, v118, v119
  buffer_store_dwordx4 v[128:131], v3, s[4:7], s16 offen offset:0
  v_mfma_f32_16x16x32_bf16 v[120:123], v[28:31], a[36:39], v[120:123]
  v_mfma_f32_16x16x32_bf16 v[124:127], v[52:55], a[36:39], v[124:127]
  v_mfma_f32_16x16x32_bf16 v[120:123], v[32:35], a[40:43], v[120:123]
  v_mfma_f32_16x16x32_bf16 v[124:127], v[56:59], a[40:43], v[124:127]
  v_mfma_f32_16x16x32_bf16 v[120:123], v[36:39], a[44:47], v[120:123]
  v_mfma_f32_16x16x32_bf16 v[124:127], v[60:63], a[44:47], v[124:127]
  v_mfma_f32_16x16x32_bf16 v[112:115], v[16:19], a[48:51], 0
  v_mfma_f32_16x16x32_bf16 v[116:119], v[40:43], a[48:51], 0
  v_mfma_f32_16x16x32_bf16 v[112:115], v[20:23], a[52:55], v[112:115]
  v_mfma_f32_16x16x32_bf16 v[116:119], v[44:47], a[52:55], v[116:119]
  v_mfma_f32_16x16x32_bf16 v[112:115], v[24:27], a[56:59], v[112:115]
  v_mfma_f32_16x16x32_bf16 v[116:119], v[48:51], a[56:59], v[116:119]
  v_cvt_pk_bf16_f32 v132, v120, v121
  v_cvt_pk_bf16_f32 v133, v122, v123
  v_cvt_pk_bf16_f32 v134, v124, v125
  v_cvt_pk_bf16_f32 v135, v126, v127
  buffer_store_dwordx4 v[132:135], v3, s[4:7], s16 offen offset:1024
  v_mfma_f32_16x16x32_bf16 v[112:115], v[28:31], a[60:63], v[112:115]
  v_mfma_f32_16x16x32_bf16 v[116:119], v[52:55], a[60:63], v[116:119]
  v_mfma_f32_16x16x32_bf16 v[112:115], v[32:35], a[64:67], v[112:115]
  v_mfma_f32_16x16x32_bf16 v[116:119], v[56:59], a[64:67], v[116:119]
  v_mfma_f32_16x16x32_bf16 v[112:115], v[36:39], a[68:71], v[112:115]
  v_mfma_f32_16x16x32_bf16 v[116:119], v[60:63], a[68:71], v[116:119]
  v_mfma_f32_16x16x32_bf16 v[120:123], v[16:19], a[72:75], 0
  v_mfma_f32_16x16x32_bf16 v[124:127], v[40:43], a[72:75], 0
  v_mfma_f32_16x16x32_bf16 v[120:123], v[20:23], a[76:79], v[120:123]
  v_mfma_f32_16x16x32_bf16 v[124:127], v[44:47], a[76:79], v[124:127]
  v_mfma_f32_16x16x32_bf16 v[120:123], v[24:27], a[80:83], v[120:123]
  v_mfma_f32_16x16x32_bf16 v[124:127], v[48:51], a[80:83], v[124:127]
  v_cvt_pk_bf16_f32 v128, v112, v113
  v_cvt_pk_bf16_f32 v129, v114, v115
  v_cvt_pk_bf16_f32 v130, v116, v117
  v_cvt_pk_bf16_f32 v131, v118, v119
  buffer_store_dwordx4 v[128:131], v3, s[4:7], s16 offen offset:2048
  v_mfma_f32_16x16x32_bf16 v[120:123], v[28:31], a[84:87], v[120:123]
  v_mfma_f32_16x16x32_bf16 v[124:127], v[52:55], a[84:87], v[124:127]
  v_mfma_f32_16x16x32_bf16 v[120:123], v[32:35], a[88:91], v[120:123]
  v_mfma_f32_16x16x32_bf16 v[124:127], v[56:59], a[88:91], v[124:127]
  v_mfma_f32_16x16x32_bf16 v[120:123], v[36:39], a[92:95], v[120:123]
  v_mfma_f32_16x16x32_bf16 v[124:127], v[60:63], a[92:95], v[124:127]
  v_mfma_f32_16x16x32_bf16 v[112:115], v[16:19], a[96:99], 0
  v_mfma_f32_16x16x32_bf16 v[116:119], v[40:43], a[96:99], 0
  v_mfma_f32_16x16x32_bf16 v[112:115], v[20:23], a[100:103], v[112:115]
  v_mfma_f32_16x16x32_bf16 v[116:119], v[44:47], a[100:103], v[116:119]
  v_mfma_f32_16x16x32_bf16 v[112:115], v[24:27], a[104:107], v[112:115]
  v_mfma_f32_16x16x32_bf16 v[116:119], v[48:51], a[104:107], v[116:119]
  v_cvt_pk_bf16_f32 v132, v120, v121
  v_cvt_pk_bf16_f32 v133, v122, v123
  v_cvt_pk_bf16_f32 v134, v124, v125
  v_cvt_pk_bf16_f32 v135, v126, v127
  buffer_store_dwordx4 v[132:135], v3, s[4:7], s16 offen offset:3072
  v_mfma_f32_16x16x32_bf16 v[112:115], v[28:31], a[108:111], v[112:115]
  v_mfma_f32_16x16x32_bf16 v[116:119], v[52:55], a[108:111], v[116:119]
  v_mfma_f32_16x16x32_bf16 v[112:115], v[32:35], a[112:115], v[112:115]
  v_mfma_f32_16x16x32_bf16 v[116:119], v[56:59], a[112:115], v[116:119]
  v_mfma_f32_16x16x32_bf16 v[112:115], v[36:39], a[116:119], v[112:115]
  v_mfma_f32_16x16x32_bf16 v[116:119], v[60:63], a[116:119], v[116:119]
  v_mfma_f32_16x16x32_bf16 v[120:123], v[16:19], a[120:123], 0
  v_mfma_f32_16x16x32_bf16 v[124:127], v[40:43], a[120:123], 0
  v_mfma_f32_16x16x32_bf16 v[120:123], v[20:23], a[124:127], v[120:123]
  v_mfma_f32_16x16x32_bf16 v[124:127], v[44:47], a[124:127], v[124:127]
  v_mfma_f32_16x16x32_bf16 v[120:123], v[24:27], a[128:131], v[120:123]
  v_mfma_f32_16x16x32_bf16 v[124:127], v[48:51], a[128:131], v[124:127]
  v_cvt_pk_bf16_f32 v128, v112, v113
  v_cvt_pk_bf16_f32 v129, v114, v115
  v_cvt_pk_bf16_f32 v130, v116, v117
  v_cvt_pk_bf16_f32 v131, v118, v119
  buffer_store_dwordx4 v[128:131], v3, s[4:7], s17 offen offset:0
  v_mfma_f32_16x16x32_bf16 v[120:123], v[28:31], a[132:135], v[120:123]
  v_mfma_f32_16x16x32_bf16 v[124:127], v[52:55], a[132:135], v[124:127]
  v_mfma_f32_16x16x32_bf16 v[120:123], v[32:35], a[136:139], v[120:123]
  v_mfma_f32_16x16x32_bf16 v[124:127], v[56:59], a[136:139], v[124:127]
  v_mfma_f32_16x16x32_bf16 v[120:123], v[36:39], a[140:143], v[120:123]
  v_mfma_f32_16x16x32_bf16 v[124:127], v[60:63], a[140:143], v[124:127]
  v_mfma_f32_16x16x32_bf16 v[112:115], v[16:19], a[144:147], 0
  v_mfma_f32_16x16x32_bf16 v[116:119], v[40:43], a[144:147], 0
  v_mfma_f32_16x16x32_bf16 v[112:115], v[20:23], a[148:151], v[112:115]
  v_mfma_f32_16x16x32_bf16 v[116:119], v[44:47], a[148:151], v[116:119]
  v_mfma_f32_16x16x32_bf16 v[112:115], v[24:27], a[152:155], v[112:115]
  v_mfma_f32_16x16x32_bf16 v[116:119], v[48:51], a[152:155], v[116:119]
  v_cvt_pk_bf16_f32 v132, v120, v121
  v_cvt_pk_bf16_f32 v133, v122, v123
  v_cvt_pk_bf16_f32 v134, v124, v125
  v_cvt_pk_bf16_f32 v135, v126, v127
  buffer_store_dwordx4 v[132:135], v3, s[4:7], s17 offen offset:1024
  v_mfma_f32_16x16x32_bf16 v[112:115], v[28:31], a[156:159], v[112:115]
  v_mfma_f32_16x16x32_bf16 v[116:119], v[52:55], a[156:159], v[116:119]
  v_mfma_f32_16x16x32_bf16 v[112:115], v[32:35], a[160:163], v[112:115]
  v_mfma_f32_16x16x32_bf16 v[116:119], v[56:59], a[160:163], v[116:119]
  v_mfma_f32_16x16x32_bf16 v[112:115], v[36:39], a[164:167], v[112:115]
  v_mfma_f32_16x16x32_bf16 v[116:119], v[60:63], a[164:167], v[116:119]
  v_mfma_f32_16x16x32_bf16 v[120:123], v[16:19], a[168:171], 0
  v_mfma_f32_16x16x32_bf16 v[124:127], v[40:43], a[168:171], 0
  v_mfma_f32_16x16x32_bf16 v[120:123], v[20:23], a[172:175], v[120:123]
  v_mfma_f32_16x16x32_bf16 v[124:127], v[44:47], a[172:175], v[124:127]
  v_mfma_f32_16x16x32_bf16 v[120:123], v[24:27], a[176:179], v[120:123]
  v_mfma_f32_16x16x32_bf16 v[124:127], v[48:51], a[176:179], v[124:127]
  v_cvt_pk_bf16_f32 v128, v112, v113
  v_cvt_pk_bf16_f32 v129, v114, v115
  v_cvt_pk_bf16_f32 v130, v116, v117
  v_cvt_pk_bf16_f32 v131, v118, v119
  buffer_store_dwordx4 v[128:131], v3, s[4:7], s17 offen offset:2048
  v_mfma_f32_16x16x32_bf16 v[120:123], v[28:31], a[180:183], v[120:123]
  v_mfma_f32_16x16x32_bf16 v[124:127], v[52:55], a[180:183], v[124:127]
  v_mfma_f32_16x16x32_bf16 v[120:123], v[32:35], a[184:187], v[120:123]
  v_mfma_f32_16x16x32_bf16 v[124:127], v[56:59], a[184:187], v[124:127]
  v_mfma_f32_16x16x32_bf16 v[120:123], v[36:39], a[188:191], v[120:123]
  v_mfma_f32_16x16x32_bf16 v[124:127], v[60:63], a[188:191], v[124:127]
  v_mfma_f32_16x16x32_bf16 v[112:115], v[16:19], a[192:195], 0
  v_mfma_f32_16x16x32_bf16 v[116:119], v[40:43], a[192:195], 0
  v_mfma_f32_16x16x32_bf16 v[112:115], v[20:23], a[196:199], v[112:115]
  v_mfma_f32_16x16x32_bf16 v[116:119], v[44:47], a[196:199], v[116:119]
  v_mfma_f32_16x16x32_bf16 v[112:115], v[24:27], a[200:203], v[112:115]
  v_mfma_f32_16x16x32_bf16 v[116:119], v[48:51], a[200:203], v[116:119]
  v_cvt_pk_bf16_f32 v132, v120, v121
  v_cvt_pk_bf16_f32 v133, v122, v123
  v_cvt_pk_bf16_f32 v134, v124, v125
  v_cvt_pk_bf16_f32 v135, v126, v127
  buffer_store_dwordx4 v[132:135], v3, s[4:7], s17 offen offset:3072
  v_mfma_f32_16x16x32_bf16 v[112:115], v[28:31], a[204:207], v[112:115]
  v_mfma_f32_16x16x32_bf16 v[116:119], v[52:55], a[204:207], v[116:119]
  v_mfma_f32_16x16x32_bf16 v[112:115], v[32:35], a[208:211], v[112:115]
  v_mfma_f32_16x16x32_bf16 v[116:119], v[56:59], a[208:211], v[116:119]
  v_mfma_f32_16x16x32_bf16 v[112:115], v[36:39], a[212:215], v[112:115]
  v_mfma_f32_16x16x32_bf16 v[116:119], v[60:63], a[212:215], v[116:119]
  v_mfma_f32_16x16x32_bf16 v[120:123], v[16:19], a[216:219], 0
  v_mfma_f32_16x16x32_bf16 v[124:127], v[40:43], a[216:219], 0
  v_mfma_f32_16x16x32_bf16 v[120:123], v[20:23], a[220:223], v[120:123]
  v_mfma_f32_16x16x32_bf16 v[124:127], v[44:47], a[220:223], v[124:127]
  v_mfma_f32_16x16x32_bf16 v[120:123], v[24:27], a[224:227], v[120:123]
  v_mfma_f32_16x16x32_bf16 v[124:127], v[48:51], a[224:227], v[124:127]
  v_cvt_pk_bf16_f32 v128, v112, v113
  v_cvt_pk_bf16_f32 v129, v114, v115
  v_cvt_pk_bf16_f32 v130, v116, v117
  v_cvt_pk_bf16_f32 v131, v118, v119
  buffer_store_dwordx4 v[128:131], v3, s[4:7], s18 offen offset:0
  v_mfma_f32_16x16x32_bf16 v[120:123], v[28:31], a[228:231], v[120:123]
  v_mfma_f32_16x16x32_bf16 v[124:127], v[52:55], a[228:231], v[124:127]
  v_mfma_f32_16x16x32_bf16 v[120:123], v[32:35], a[232:235], v[120:123]
  v_mfma_f32_16x16x32_bf16 v[124:127], v[56:59], a[232:235], v[124:127]
  v_mfma_f32_16x16x32_bf16 v[120:123], v[36:39], a[236:239], v[120:123]
  v_mfma_f32_16x16x32_bf16 v[124:127], v[60:63], a[236:239], v[124:127]
  v_add_u32 v5, s19, v5
  s_add_u32 s13, s13, s19
  s_sub_u32 s19, 0, s19
  s_add_u32 s20, s20, 325632
  s_cmp_ge_u32 s20, 1953792
  s_cselect_b32 s20, 0, s20
  v_cvt_pk_bf16_f32 v132, v120, v121
  v_cvt_pk_bf16_f32 v133, v122, v123
  v_cvt_pk_bf16_f32 v134, v124, v125
  v_cvt_pk_bf16_f32 v135, v126, v127
  buffer_store_dwordx4 v[132:135], v3, s[4:7], s18 offen offset:1024
  s_waitcnt vmcnt(0)
  v_mov_b32 v8, s24
  s_mov_b64 exec, 1
  s_cmp_lg_u32 s69, 0
  s_cbranch_scc1 mega0_kernel_pf11
  buffer_store_dword v8, v7, s[4:7], s21 offen
mega0_kernel_pf11_b:
  s_mov_b64 exec, -1
  s_add_u32 s24, s24, 1
  s_cmp_le_u32 s24, 64
  s_cbranch_scc1 mega_u_loop
  s_cmp_lg_u32 s70, 0
  s_cbranch_scc1 mega_end
  s_lshl_b32 s73, s80, 2
  s_add_u32 s73, s73, s3
  s_load_dwordx2 s[52:53], s[0:1], 64
  s_mov_b32 s54, 0x258000
  s_mov_b32 s55, 0x20000
  s_load_dwordx2 s[56:57], s[0:1], 72
  s_mov_b32 s58, 0x6400
  s_mov_b32 s59, 0x20000
  s_load_dwordx2 s[60:61], s[0:1], 80
  s_mov_b32 s62, 0xc8000
  s_mov_b32 s63, 0x20000
  s_waitcnt lgkmcnt(0)
mega_bj:
  s_cmp_ge_u32 s73, 520
  s_cbranch_scc1 mega_bjdone
  s_mov_b32 s2, s73
  s_add_u32 s73, s73, 128
  s_cmp_ge_u32 s2, 320
  s_cbranch_scc1 mega_bj1
  s_and_b32 s72, s2, 3
  s_lshr_b32 s2, s2, 2
  s_mul_hi_u32 s64, s2, 0x6666667
  s_mul_i32 s65, s64, 40
  s_sub_u32 s65, s2, s65
  s_mul_hi_u32 s66, s65, 0x33333334
  s_mul_i32 s67, s66, 5
  s_sub_u32 s67, s65, s67
  v_and_b32 v2, 15, v1
  v_lshrrev_b32 v3, 4, v1
  v_lshrrev_b32 v4, 2, v2
  v_and_b32 v5, 3, v2
  v_lshlrev_b32 v6, 3, v3
  v_mul_u32_u24 v7, 20, v4
  v_sub_u32 v6, v6, v7
  v_mul_i32_i24 v7, 40, v6
  v_mul_u32_u24 v8, 800, v4
  v_add_u32 v7, v7, v8
  v_lshl_add_u32 v7, v5, 1, v7
  s_mul_i32 s20, s66, 3200
  s_lshl_b32 s21, s67, 3
  s_add_u32 s20, s20, s21
  v_mov_b32 v9, 0x100000
  v_add_u32 v10, 0, v6
  v_cmp_gt_u32 vcc, 20, v10
  v_add_u32 v11, 0, v7
  s_nop 0
  v_cndmask_b32 v11, v9, v11, vcc
  buffer_load_ushort v32, v11, s[56:59], s20 offen
  v_add_u32 v10, 1, v6
  v_cmp_gt_u32 vcc, 20, v10
  v_add_u32 v11, 40, v7
  s_nop 0
  v_cndmask_b32 v11, v9, v11, vcc
  buffer_load_ushort v33, v11, s[56:59], s20 offen
  v_add_u32 v10, 2, v6
  v_cmp_gt_u32 vcc, 20, v10
  v_add_u32 v11, 80, v7
  s_nop 0
  v_cndmask_b32 v11, v9, v11, vcc
  buffer_load_ushort v34, v11, s[56:59], s20 offen
  v_add_u32 v10, 3, v6
  v_cmp_gt_u32 vcc, 20, v10
  v_add_u32 v11, 120, v7
  s_nop 0
  v_cndmask_b32 v11, v9, v11, vcc
  buffer_load_ushort v35, v11, s[56:59], s20 offen
  v_add_u32 v10, 4, v6
  v_cmp_gt_u32 vcc, 20, v10
  v_add_u32 v11, 160, v7
  s_nop 0
  v_cndmask_b32 v11, v9, v11, vcc
  buffer_load_ushort v36, v11, s[56:59], s20 offen
  v_add_u32 v10, 5, v6
  v_cmp_gt_u32 vcc, 20, v10
  v_add_u32 v11, 200, v7
  s_nop 0
  v_cndmask_b32 v11, v9, v11, vcc
  buffer_load_ushort v37, v11, s[56:59], s20 offen
  v_add_u32 v10, 6, v6
  v_cmp_gt_u32 vcc, 20, v10
  v_add_u32 v11, 240, v7
  s_nop 0
  v_cndmask_b32 v11, v9, v11, vcc
  buffer_load_ushort v38, v11, s[56:59], s20 offen
  v_add_u32 v10, 7, v6
  v_cmp_gt_u32 vcc, 20, v10
  v_add_u32 v11, 280, v7
  s_nop 0
  v_cndmask_b32 v11, v9, v11, vcc
  buffer_load_ushort v39, v11, s[56:59], s20 offen
  v_add_u32 v10, 32, v6
  v_cmp_gt_u32 vcc, 20, v10
  v_add_u32 v11, 1280, v7
  s_nop 0
  v_cndmask_b32 v11, v9, v11, vcc
  buffer_load_ushort v40, v11, s[56:59], s20 offen
  v_add_u32 v10, 33, v6
  v_cmp_gt_u32 vcc, 20, v10
  v_add_u32 v11, 1320, v7
  s_nop 0
  v_cndmask_b32 v11, v9, v11, vcc
  buffer_load_ushort v41, v11, s[56:59], s20 offen
  v_add_u32 v10, 34, v6
  v_cmp_gt_u32 vcc, 20, v10
  v_add_u32 v11, 1360, v7
  s_nop 0
  v_cndmask_b32 v11, v9, v11, vcc
  buffer_load_ushort v42, v11, s[56:59], s20 offen
  v_add_u32 v10, 35, v6
  v_cmp_gt_u32 vcc, 20, v10
  v_add_u32 v11, 1400, v7
  s_nop 0
  v_cndmask_b32 v11, v9, v11, vcc
  buffer_load_ushort v43, v11, s[56:59], s20 offen
  v_add_u32 v10, 36, v6
  v_cmp_gt_u32 vcc, 20, v10
  v_add_u32 v11, 1440, v7
  s_nop 0
  v_cndmask_b32 v11, v9, v11, vcc
  buffer_load_ushort v44, v11, s[56:59], s20 offen
  v_add_u32 v10, 37, v6
  v_cmp_gt_u32 vcc, 20, v10
  v_add_u32 v11, 1480, v7
  s_nop 0
  v_cndmask_b32 v11, v9, v11, vcc
  buffer_load_ushort v45, v11, s[56:59], s20 offen
  v_add_u32 v10, 38, v6
  v_cmp_gt_u32 vcc, 20, v10
  v_add_u32 v11, 1520, v7
  s_nop 0
  v_cndmask_b32 v11, v9, v11, vcc
  buffer_load_ushort v46, v11, s[56:59], s20 offen
  v_add_u32 v10, 39, v6
  v_cmp_gt_u32 vcc, 20, v10
  v_add_u32 v11, 1560, v7
  s_nop 0
  v_cndmask_b32 v11, v9, v11, vcc
  buffer_load_ushort v47, v11, s[56:59], s20 offen
  v_add_u32 v10, 64, v6
  v_cmp_gt_u32 vcc, 20, v10
  v_add_u32 v11, 2560, v7
  s_nop 0
  v_cndmask_b32 v11, v9, v11, vcc
  buffer_load_ushort v48, v11, s[56:59], s20 offen
  v_add_u32 v10, 65, v6
  v_cmp_gt_u32 vcc, 20, v10
  v_add_u32 v11, 2600, v7
  s_nop 0
  v_cndmask_b32 v11, v9, v11, vcc
  buffer_load_ushort v49, v11, s[56:59], s20 offen
  v_add_u32 v10, 66, v6
  v_cmp_gt_u32 vcc, 20, v10
  v_add_u32 v11, 2640, v7
  s_nop 0
  v_cndmask_b32 v11, v9, v11, vcc
  buffer_load_ushort v50, v11, s[56:59], s20 offen
  v_add_u32 v10, 67, v6
  v_cmp_gt_u32 vcc, 20, v10
  v_add_u32 v11, 2680, v7
  s_nop 0
  v_cndmask_b32 v11, v9, v11, vcc
  buffer_load_ushort v51, v11, s[56:59], s20 offen
  v_add_u32 v10, 68, v6
  v_cmp_gt_u32 vcc, 20, v10
  v_add_u32 v11, 2720, v7
  s_nop 0
  v_cndmask_b32 v11, v9, v11, vcc
  buffer_load_ushort v52, v11, s[56:59], s20 offen
  v_add_u32 v10, 69, v6
  v_cmp_gt_u32 vcc, 20, v10
  v_add_u32 v11, 2760, v7
  s_nop 0
  v_cndmask_b32 v11, v9, v11, vcc
  buffer_load_ushort v53, v11, s[56:59], s20 offen
  v_add_u32 v10, 70, v6
  v_cmp_gt_u32 vcc, 20, v10
  v_add_u32 v11, 2800, v7
  s_nop 0
  v_cndmask_b32 v11, v9, v11, vcc
  buffer_load_ushort v54, v11, s[56:59], s20 offen
  v_add_u32 v10, 71, v6
  v_cmp_gt_u32 vcc, 20, v10
  v_add_u32 v11, 2840, v7
  s_nop 0
  v_cndmask_b32 v11, v9, v11, vcc
  buffer_load_ushort v55, v11, s[56:59], s20 offen
  v_lshl_add_u32 v10, v4, 3, v5
  v_mul_u32_u24 v10, 3840, v10
  v_lshl_add_u32 v10, v3, 4, v10
  v_add_u32 v11, 15360, v10
  s_mul_i32 s21, s64, 1280
  s_mul_i32 s22, s66, 160
  s_add_u32 s21, s21, s22
  s_mul_i32 s22, s72, 614400
  s_add_u32 s21, s21, s22
  s_mul_i32 s22, s66, 307200
  s_mul_i32 s23, s64, 5
  s_add_u32 s23, s23, s67
  s_lshl_b32 s23, s23, 10
  s_add_u32 s22, s22, s23
  s_add_u32 s22, s22, 94507008
  s_mul_i32 s23, s72, 76800
  s_add_u32 s22, s22, s23
  v_lshlrev_b32 v12, 4, v1
  buffer_load_dwordx4 a[0:3], v10, s[52:55], s21 offen offset:0
  buffer_load_dwordx4 a[4:7], v10, s[52:55], s21 offen offset:64
  buffer_load_dwordx4 a[8:11], v10, s[52:55], s21 offen offset:128
  buffer_load_dwordx4 a[12:15], v11, s[52:55], s21 offen offset:0
  buffer_load_dwordx4 a[16:19], v11, s[52:55], s21 offen offset:64
  buffer_load_dwordx4 a[20:23], v11, s[52:55], s21 offen offset:128
  s_add_u32 s21, s21, 122880
  buffer_load_dwordx4 a[24:27], v10, s[52:55], s21 offen offset:0
  buffer_load_dwordx4 a[28:31], v10, s[52:55], s21 offen offset:64
  buffer_load_dwordx4 a[32:35], v10, s[52:55], s21 offen offset:128
  buffer_load_dwordx4 a[36:39], v11, s[52:55], s21 offen offset:0
  buffer_load_dwordx4 a[40:43], v11, s[52:55], s21 offen offset:64
  buffer_load_dwordx4 a[44:47], v11, s[52:55], s21 offen offset:128
  s_add_u32 s21, s21, 122880
  buffer_load_dwordx4 a[48:51], v10, s[52:55], s21 offen offset:0
  buffer_load_dwordx4 a[52:55], v10, s[52:55], s21 offen offset:64
  buffer_load_dwordx4 a[56:59], v10, s[52:55], s21 offen offset:128
  buffer_load_dwordx4 a[60:63], v11, s[52:55], s21 offen offset:0
  buffer_load_dwordx4 a[64:67], v11, s[52:55], s21 offen offset:64
  buffer_load_dwordx4 a[68:71], v11, s[52:55], s21 offen offset:128
  s_add_u32 s21, s21, 122880
  buffer_load_dwordx4 a[72:75], v10, s[52:55], s21 offen offset:0
  buffer_load_dwordx4 a[76:79], v10, s[52:55], s21 offen offset:64
  buffer_load_dwordx4 a[80:83], v10, s[52:55], s21 offen offset:128
  buffer_load_dwordx4 a[84:87], v11, s[52:55], s21 offen offset:0
  buffer_load_dwordx4 a[88:91], v11, s[52:55], s21 offen offset:64
  buffer_load_dwordx4 a[92:95], v11, s[52:55], s21 offen offset:128
  s_add_u32 s21, s21, 122880
  buffer_load_dwordx4 a[96:99], v10, s[52:55], s21 offen offset:0
  buffer_load_dwordx4 a[100:103], v10, s[52:55], s21 offen offset:64
  buffer_load_dwordx4 a[104:107], v10, s[52:55], s21 offen offset:128
  buffer_load_dwordx4 a[108:111], v11, s[52:55], s21 offen offset:0
  buffer_load_dwordx4 a[112:115], v11, s[52:55], s21 offen offset:64
  buffer_load_dwordx4 a[116:119], v11, s[52:55], s21 offen offset:128
  s_add_u32 s21, s21, 122880
  s_waitcnt vmcnt(30)
  v_lshl_or_b32 v16, v33, 16, v32
  v_lshl_or_b32 v17, v35, 16, v34
  v_lshl_or_b32 v18, v37, 16, v36
  v_lshl_or_b32 v19, v39, 16, v38
  v_lshl_or_b32 v20, v41, 16, v40
  v_lshl_or_b32 v21, v43, 16, v42
  v_lshl_or_b32 v22, v45, 16, v44
  v_lshl_or_b32 v23, v47, 16, v46
  v_lshl_or_b32 v24, v49, 16, v48
  v_lshl_or_b32 v25, v51, 16, v50
  v_lshl_or_b32 v26, v53, 16, v52
  v_lshl_or_b32 v27, v55, 16, v54
  s_waitcnt vmcnt(24)
  v_mfma_f32_16x16x32_bf16 v[56:59], a[0:3], v[16:19], 0
  v_mfma_f32_16x16x32_bf16 v[56:59], a[4:7], v[20:23], v[56:59]
  v_mfma_f32_16x16x32_bf16 v[56:59], a[8:11], v[24:27], v[56:59]
  v_mfma_f32_16x16x32_bf16 v[60:63], a[12:15], v[16:19], 0
  v_mfma_f32_16x16x32_bf16 v[60:63], a[16:19], v[20:23], v[60:63]
  v_mfma_f32_16x16x32_bf16 v[60:63], a[20:23], v[24:27], v[60:63]
  s_waitcnt vmcnt(18)
  v_mfma_f32_16x16x32_bf16 v[64:67], a[24:27], v[16:19], 0
  v_mfma_f32_16x16x32_bf16 v[64:67], a[28:31], v[20:23], v[64:67]
  v_mfma_f32_16x16x32_bf16 v[64:67], a[32:35], v[24:27], v[64:67]
  v_mfma_f32_16x16x32_bf16 v[68:71], a[36:39], v[16:19], 0
  v_mfma_f32_16x16x32_bf16 v[68:71], a[40:43], v[20:23], v[68:71]
  v_mfma_f32_16x16x32_bf16 v[68:71], a[44:47], v[24:27], v[68:71]
  s_waitcnt vmcnt(12)
  v_mfma_f32_16x16x32_bf16 v[72:75], a[48:51], v[16:19], 0
  v_mfma_f32_16x16x32_bf16 v[72:75], a[52:55], v[20:23], v[72:75]
  v_mfma_f32_16x16x32_bf16 v[72:75], a[56:59], v[24:27], v[72:75]
  v_mfma_f32_16x16x32_bf16 v[76:79], a[60:63], v[16:19], 0
  v_mfma_f32_16x16x32_bf16 v[76:79], a[64:67], v[20:23], v[76:79]
  v_mfma_f32_16x16x32_bf16 v[76:79], a[68:71], v[24:27], v[76:79]
  s_waitcnt vmcnt(6)
  v_mfma_f32_16x16x32_bf16 v[80:83], a[72:75], v[16:19], 0
  v_mfma_f32_16x16x32_bf16 v[80:83], a[76:79], v[20:23], v[80:83]
  v_mfma_f32_16x16x32_bf16 v[80:83], a[80:83], v[24:27], v[80:83]
  v_mfma_f32_16x16x32_bf16 v[84:87], a[84:87], v[16:19], 0
  v_mfma_f32_16x16x32_bf16 v[84:87], a[88:91], v[20:23], v[84:87]
  v_mfma_f32_16x16x32_bf16 v[84:87], a[92:95], v[24:27], v[84:87]
  s_waitcnt vmcnt(0)
  v_mfma_f32_16x16x32_bf16 v[88:91], a[96:99], v[16:19], 0
  v_mfma_f32_16x16x32_bf16 v[88:91], a[100:103], v[20:23], v[88:91]
  v_mfma_f32_16x16x32_bf16 v[88:91], a[104:107], v[24:27], v[88:91]
  v_mfma_f32_16x16x32_bf16 v[92:95], a[108:111], v[16:19], 0
  v_mfma_f32_16x16x32_bf16 v[92:95], a[112:115], v[20:23], v[92:95]
  v_mfma_f32_16x16x32_bf16 v[92:95], a[116:119], v[24:27], v[92:95]
  v_cvt_pk_bf16_f32 v56, v56, v57
  v_cvt_pk_bf16_f32 v57, v58, v59
  v_cvt_pk_bf16_f32 v58, v60, v61
  v_cvt_pk_bf16_f32 v59, v62, v63
  buffer_store_dwordx4 v[56:59], v12, s[4:7], s22 offen
  s_add_u32 s22, s22, 15360
  v_cvt_pk_bf16_f32 v64, v64, v65
  v_cvt_pk_bf16_f32 v65, v66, v67
  v_cvt_pk_bf16_f32 v66, v68, v69
  v_cvt_pk_bf16_f32 v67, v70, v71
  buffer_store_dwordx4 v[64:67], v12, s[4:7], s22 offen
  s_add_u32 s22, s22, 15360
  v_cvt_pk_bf16_f32 v72, v72, v73
  v_cvt_pk_bf16_f32 v73, v74, v75
  v_cvt_pk_bf16_f32 v74, v76, v77
  v_cvt_pk_bf16_f32 v75, v78, v79
  buffer_store_dwordx4 v[72:75], v12, s[4:7], s22 offen
  s_add_u32 s22, s22, 15360
  v_cvt_pk_bf16_f32 v80, v80, v81
  v_cvt_pk_bf16_f32 v81, v82, v83
  v_cvt_pk_bf16_f32 v82, v84, v85
  v_cvt_pk_bf16_f32 v83, v86, v87
  buffer_store_dwordx4 v[80:83], v12, s[4:7], s22 offen
  s_add_u32 s22, s22, 15360
  v_cvt_pk_bf16_f32 v88, v88, v89
  v_cvt_pk_bf16_f32 v89, v90, v91
  v_cvt_pk_bf16_f32 v90, v92, v93
  v_cvt_pk_bf16_f32 v91, v94, v95
  buffer_store_dwordx4 v[88:91], v12, s[4:7], s22 offen
  s_add_u32 s22, s22, 15360
  s_branch mega_bj
mega_bj1:
  s_cmp_ge_u32 s2, 420
  s_cbranch_scc1 mega_bj2
  s_sub_u32 s2, s2, 320
  s_mul_hi_u32 s66, s2, 0x33333334
  s_mul_i32 s67, s66, 5
  s_sub_u32 s67, s2, s67
  s_mul_i32 s20, s66, 122880
  s_lshl_b32 s68, s67, 8
  s_add_u32 s20, s20, s68
  s_add_u32 s20, s20, 2560
  s_mov_b32 s21, 30720
  s_mov_b32 s22, 15360
  s_mov_b32 s23, 3840
  s_mul_i32 s24, s66, 15360
  s_add_u32 s24, s24, 94517248
  s_lshl_b32 s25, s67, 3
  v_lshlrev_b32 v2, 2, v1
  v_lshrrev_b32 v3, 3, v1
  v_add_u32 v3, s25, v3
  v_mul_u32_u24 v4, 205, v3
  v_lshrrev_b32 v4, 10, v4
  v_mul_u32_u24 v5, 5, v4
  v_sub_u32 v3, v3, v5
  v_lshlrev_b32 v3, 10, v3
  v_mul_u32_u24 v4, 307200, v4
  v_add_u32 v3, v3, v4
  v_and_b32 v4, 7, v1
  v_lshl_add_u32 v3, v4, 5, v3
  s_mov_b32 s26, 0x05040100
  s_mov_b32 s27, 0x07060302
  s_mov_b32 s28, s20
  buffer_load_dword v8, v2, s[52:55], s28 offen
  s_add_u32 s28, s28, s23
  buffer_load_dword v9, v2, s[52:55], s28 offen
  s_add_u32 s28, s28, s23
  buffer_load_dword v10, v2, s[52:55], s28 offen
  s_add_u32 s28, s28, s23
  buffer_load_dword v11, v2, s[52:55], s28 offen
  s_add_u32 s28, s20, s22
  buffer_load_dword v12, v2, s[52:55], s28 offen
  s_add_u32 s28, s28, s23
  buffer_load_dword v13, v2, s[52:55], s28 offen
  s_add_u32 s28, s28, s23
  buffer_load_dword v14, v2, s[52:55], s28 offen
  s_add_u32 s28, s28, s23
  buffer_load_dword v15, v2, s[52:55], s28 offen
  s_add_u32 s20, s20, s21
  s_mov_b32 s28, s20
  buffer_load_dword v16, v2, s[52:55], s28 offen
  s_add_u32 s28, s28, s23
  buffer_load_dword v17, v2, s[52:55], s28 offen
  s_add_u32 s28, s28, s23
  buffer_load_dword v18, v2, s[52:55], s28 offen
  s_add_u32 s28, s28, s23
  buffer_load_dword v19, v2, s[52:55], s28 offen
  s_add_u32 s28, s20, s22
  buffer_load_dword v20, v2, s[52:55], s28 offen
  s_add_u32 s28, s28, s23
  buffer_load_dword v21, v2, s[52:55], s28 offen
  s_add_u32 s28, s28, s23
  buffer_load_dword v22, v2, s[52:55], s28 offen
  s_add_u32 s28, s28, s23
  buffer_load_dword v23, v2, s[52:55], s28 offen
  s_add_u32 s20, s20, s21
  s_mov_b32 s28, s20
  buffer_load_dword v24, v2, s[52:55], s28 offen
  s_add_u32 s28, s28, s23
  buffer_load_dword v25, v2, s[52:55], s28 offen
  s_add_u32 s28, s28, s23
  buffer_load_dword v26, v2, s[52:55], s28 offen
  s_add_u32 s28, s28, s23
  buffer_load_dword v27, v2, s[52:55], s28 offen
  s_add_u32 s28, s20, s22
  buffer_load_dword v28, v2, s[52:55], s28 offen
  s_add_u32 s28, s28, s23
  buffer_load_dword v29, v2, s[52:55], s28 offen
  s_add_u32 s28, s28, s23
  buffer_load_dword v30, v2, s[52:55], s28 offen
  s_add_u32 s28, s28, s23
  buffer_load_dword v31, v2, s[52:55], s28 offen
  s_add_u32 s20, s20, s21
  s_mov_b32 s28, s20
  buffer_load_dword v32, v2, s[52:55], s28 offen
  s_add_u32 s28, s28, s23
  buffer_load_dword v33, v2, s[52:55], s28 offen
  s_add_u32 s28, s28, s23
  buffer_load_dword v34, v2, s[52:55], s28 offen
  s_add_u32 s28, s28, s23
  buffer_load_dword v35, v2, s[52:55], s28 offen
  s_add_u32 s28, s20, s22
  buffer_load_dword v36, v2, s[52:55], s28 offen
  s_add_u32 s28, s28, s23
  buffer_load_dword v37, v2, s[52:55], s28 offen
  s_add_u32 s28, s28, s23
  buffer_load_dword v38, v2, s[52:55], s28 offen
  s_add_u32 s28, s28, s23
  buffer_load_dword v39, v2, s[52:55], s28 offen
  s_waitcnt vmcnt(24)
  v_perm_b32 v40, v9, v8, s26
  v_perm_b32 v44, v9, v8, s27
  v_perm_b32 v41, v11, v10, s26
  v_perm_b32 v45, v11, v10, s27
  v_perm_b32 v42, v13, v12, s26
  v_perm_b32 v46, v13, v12, s27
  v_perm_b32 v43, v15, v14, s26
  v_perm_b32 v47, v15, v14, s27
  buffer_store_dwordx4 v[40:43], v3, s[4:7], s24 offen offset:0
  buffer_store_dwordx4 v[44:47], v3, s[4:7], s24 offen offset:16
  s_waitcnt vmcnt(18)
  v_perm_b32 v48, v17, v16, s26
  v_perm_b32 v52, v17, v16, s27
  v_perm_b32 v49, v19, v18, s26
  v_perm_b32 v53, v19, v18, s27
  v_perm_b32 v50, v21, v20, s26
  v_perm_b32 v54, v21, v20, s27
  v_perm_b32 v51, v23, v22, s26
  v_perm_b32 v55, v23, v22, s27
  buffer_store_dwordx4 v[48:51], v3, s[4:7], s24 offen offset:256
  buffer_store_dwordx4 v[52:55], v3, s[4:7], s24 offen offset:272
  s_waitcnt vmcnt(12)
  v_perm_b32 v56, v25, v24, s26
  v_perm_b32 v60, v25, v24, s27
  v_perm_b32 v57, v27, v26, s26
  v_perm_b32 v61, v27, v26, s27
  v_perm_b32 v58, v29, v28, s26
  v_perm_b32 v62, v29, v28, s27
  v_perm_b32 v59, v31, v30, s26
  v_perm_b32 v63, v31, v30, s27
  buffer_store_dwordx4 v[56:59], v3, s[4:7], s24 offen offset:512
  buffer_store_dwordx4 v[60:63], v3, s[4:7], s24 offen offset:528
  s_waitcnt vmcnt(6)
  v_perm_b32 v64, v33, v32, s26
  v_perm_b32 v68, v33, v32, s27
  v_perm_b32 v65, v35, v34, s26
  v_perm_b32 v69, v35, v34, s27
  v_perm_b32 v66, v37, v36, s26
  v_perm_b32 v70, v37, v36, s27
  v_perm_b32 v67, v39, v38, s26
  v_perm_b32 v71, v39, v38, s27
  buffer_store_dwordx4 v[64:67], v3, s[4:7], s24 offen offset:768
  buffer_store_dwordx4 v[68:71], v3, s[4:7], s24 offen offset:784
  s_branch mega_bj
mega_bj2:
  s_sub_u32 s2, s2, 420
  s_mul_hi_u32 s66, s2, 0x33333334
  s_mul_i32 s67, s66, 5
  s_sub_u32 s67, s2, s67
  s_mul_hi_u32 s64, s66, 0x33333334
  s_mul_i32 s65, s64, 5
  s_sub_u32 s65, s66, s65
  s_lshl_b32 s68, s65, 3
  s_add_u32 s69, s68, 60
  s_cmp_lt_u32 s65, 3
  s_cselect_b32 s68, s68, s69
  s_cmp_eq_u32 s65, 2
  s_cselect_b32 s22, 64, 4
  s_mul_i32 s22, s22, 1280
  s_mul_i32 s69, s64, 160
  s_add_u32 s68, s68, s69
  s_mul_i32 s20, s68, 1280
  s_lshl_b32 s68, s67, 8
  s_add_u32 s20, s20, s68
  s_mov_b32 s21, 25600
  s_mov_b32 s23, 1280
  s_mul_i32 s24, s67, 163840
  s_lshl_b32 s68, s66, 10
  s_add_u32 s24, s24, s68
  s_add_u32 s24, s24, 96964608
  v_lshlrev_b32 v2, 2, v1
  v_lshrrev_b32 v3, 4, v1
  v_lshlrev_b32 v3, 1, v3
  v_bfe_u32 v4, v1, 1, 1
  v_add_u32 v3, v3, v4
  v_mul_u32_u24 v3, 20480, v3
  v_bfe_u32 v4, v1, 2, 2
  v_lshl_add_u32 v3, v4, 6, v3
  v_and_b32 v4, 1, v1
  v_lshl_add_u32 v3, v4, 5, v3
  s_mov_b32 s26, 0x05040100
  s_mov_b32 s27, 0x07060302
  s_mov_b32 s28, s20
  buffer_load_dword v8, v2, s[60:63], s28 offen
  s_add_u32 s28, s28, s23
  buffer_load_dword v9, v2, s[60:63], s28 offen
  s_add_u32 s28, s28, s23
  buffer_load_dword v10, v2, s[60:63], s28 offen
  s_add_u32 s28, s28, s23
  buffer_load_dword v11, v2, s[60:63], s28 offen
  s_add_u32 s28, s20, s22
  buffer_load_dword v12, v2, s[60:63], s28 offen
  s_add_u32 s28, s28, s23
  buffer_load_dword v13, v2, s[60:63], s28 offen
  s_add_u32 s28, s28, s23
  buffer_load_dword v14, v2, s[60:63], s28 offen
  s_add_u32 s28, s28, s23
  buffer_load_dword v15, v2, s[60:63], s28 offen
  s_add_u32 s20, s20, s21
  s_mov_b32 s28, s20
  buffer_load_dword v16, v2, s[60:63], s28 offen
  s_add_u32 s28, s28, s23
  buffer_load_dword v17, v2, s[60:63], s28 offen
  s_add_u32 s28, s28, s23
  buffer_load_dword v18, v2, s[60:63], s28 offen
  s_add_u32 s28, s28, s23
  buffer_load_dword v19, v2, s[60:63], s28 offen
  s_add_u32 s28, s20, s22
  buffer_load_dword v20, v2, s[60:63], s28 offen
  s_add_u32 s28, s28, s23
  buffer_load_dword v21, v2, s[60:63], s28 offen
  s_add_u32 s28, s28, s23
  buffer_load_dword v22, v2, s[60:63], s28 offen
  s_add_u32 s28, s28, s23
  buffer_load_dword v23, v2, s[60:63], s28 offen
  s_add_u32 s20, s20, s21
  s_mov_b32 s28, s20
  buffer_load_dword v24, v2, s[60:63], s28 offen
  s_add_u32 s28, s28, s23
  buffer_load_dword v25, v2, s[60:63], s28 offen
  s_add_u32 s28, s28, s23
  buffer_load_dword v26, v2, s[60:63], s28 offen
  s_add_u32 s28, s28, s23
  buffer_load_dword v27, v2, s[60:63], s28 offen
  s_add_u32 s28, s20, s22
  buffer_load_dword v28, v2, s[60:63], s28 offen
  s_add_u32 s28, s28, s23
  buffer_load_dword v29, v2, s[60:63], s28 offen
  s_add_u32 s28, s28, s23
  buffer_load_dword v30, v2, s[60:63], s28 offen
  s_add_u32 s28, s28, s23
  buffer_load_dword v31, v2, s[60:63], s28 offen
  s_add_u32 s20, s20, s21
  s_mov_b32 s28, s20
  buffer_load_dword v32, v2, s[60:63], s28 offen
  s_add_u32 s28, s28, s23
  buffer_load_dword v33, v2, s[60:63], s28 offen
  s_add_u32 s28, s28, s23
  buffer_load_dword v34, v2, s[60:63], s28 offen
  s_add_u32 s28, s28, s23
  buffer_load_dword v35, v2, s[60:63], s28 offen
  s_add_u32 s28, s20, s22
  buffer_load_dword v36, v2, s[60:63], s28 offen
  s_add_u32 s28, s28, s23
  buffer_load_dword v37, v2, s[60:63], s28 offen
  s_add_u32 s28, s28, s23
  buffer_load_dword v38, v2, s[60:63], s28 offen
  s_add_u32 s28, s28, s23
  buffer_load_dword v39, v2, s[60:63], s28 offen
  s_waitcnt vmcnt(24)
  v_perm_b32 v40, v9, v8, s26
  v_perm_b32 v44, v9, v8, s27
  v_perm_b32 v41, v11, v10, s26
  v_perm_b32 v45, v11, v10, s27
  v_perm_b32 v42, v13, v12, s26
  v_perm_b32 v46, v13, v12, s27
  v_perm_b32 v43, v15, v14, s26
  v_perm_b32 v47, v15, v14, s27
  buffer_store_dwordx4 v[40:43], v3, s[4:7], s24 offen offset:0
  buffer_store_dwordx4 v[44:47], v3, s[4:7], s24 offen offset:16
  s_waitcnt vmcnt(18)
  v_perm_b32 v48, v17, v16, s26
  v_perm_b32 v52, v17, v16, s27
  v_perm_b32 v49, v19, v18, s26
  v_perm_b32 v53, v19, v18, s27
  v_perm_b32 v50, v21, v20, s26
  v_perm_b32 v54, v21, v20, s27
  v_perm_b32 v51, v23, v22, s26
  v_perm_b32 v55, v23, v22, s27
  buffer_store_dwordx4 v[48:51], v3, s[4:7], s24 offen offset:256
  buffer_store_dwordx4 v[52:55], v3, s[4:7], s24 offen offset:272
  s_waitcnt vmcnt(12)
  v_perm_b32 v56, v25, v24, s26
  v_perm_b32 v60, v25, v24, s27
  v_perm_b32 v57, v27, v26, s26
  v_perm_b32 v61, v27, v26, s27
  v_perm_b32 v58, v29, v28, s26
  v_perm_b32 v62, v29, v28, s27
  v_perm_b32 v59, v31, v30, s26
  v_perm_b32 v63, v31, v30, s27
  buffer_store_dwordx4 v[56:59], v3, s[4:7], s24 offen offset:512
  buffer_store_dwordx4 v[60:63], v3, s[4:7], s24 offen offset:528
  s_waitcnt vmcnt(6)
  v_perm_b32 v64, v33, v32, s26
  v_perm_b32 v68, v33, v32, s27
  v_perm_b32 v65, v35, v34, s26
  v_perm_b32 v69, v35, v34, s27
  v_perm_b32 v66, v37, v36, s26
  v_perm_b32 v70, v37, v36, s27
  v_perm_b32 v67, v39, v38, s26
  v_perm_b32 v71, v39, v38, s27
  buffer_store_dwordx4 v[64:67], v3, s[4:7], s24 offen offset:768
  buffer_store_dwordx4 v[68:71], v3, s[4:7], s24 offen offset:784
  s_branch mega_bj
mega_bjdone:
  s_endpgm
mega_qrole:
  v_lshlrev_b32 v2, 4, v1
  v_mov_b32 v7, 0
  s_mul_i32 s10, s80, 384
  s_mul_i32 s11, s3, 96
  s_add_u32 s10, s10, s11
  s_mul_i32 s11, s3, 30720
  s_add_u32 s11, s11, 40960
  v_mul_u32_u24 v18, 10923, v1
  v_lshrrev_b32 v18, 16, v18
  v_mul_u32_u24 v16, 6, v18
  v_sub_u32 v16, v1, v16
  v_lshlrev_b32 v16, 4, v16
  v_mul_u32_u24 v18, 12288, v18
  v_add_u32 v16, v16, v18
  v_lshrrev_b32 v18, 4, v1
  v_mul_u32_u24 v18, 8, v18
  v_bfe_u32 v17, v1, 2, 2
  v_add_u32 v18, v18, v17
  v_mul_u32_u24 v18, 96, v18
  v_and_b32 v17, 3, v1
  v_lshl_add_u32 v17, v17, 3, v18
  v_add_u32 v17, s11, v17
  s_mul_i32 s13, s3, 10240
  s_add_u32 s12, s13, 26214400
  s_lshl_b32 s15, s3, 10
  v_add_u32 v3, s15, v2
  s_and_b32 s9, s80, 3
  s_sleep 100
  s_sleep 100
  s_add_u32 m0, s13, 0
  s_add_u32 s18, s12, 0
  buffer_load_dwordx4 v2, s[4:7], s18 offen offset:0 lds
  buffer_load_dwordx4 v2, s[4:7], s18 offen offset:1024 lds
  buffer_load_dwordx4 v2, s[4:7], s18 offen offset:2048 lds
  buffer_load_dwordx4 v2, s[4:7], s18 offen offset:3072 lds
  s_add_u32 m0, s13, 4096
  s_add_u32 s18, s12, 4096
  buffer_load_dwordx4 v2, s[4:7], s18 offen offset:0 lds
  buffer_load_dwordx4 v2, s[4:7], s18 offen offset:1024 lds
  buffer_load_dwordx4 v2, s[4:7], s18 offen offset:2048 lds
  buffer_load_dwordx4 v2, s[4:7], s18 offen offset:3072 lds
  s_add_u32 m0, s13, 8192
  s_add_u32 s18, s12, 8192
  buffer_load_dwordx4 v2, s[4:7], s18 offen offset:0 lds
  buffer_load_dwordx4 v2, s[4:7], s18 offen offset:1024 lds
  s_add_u32 s12, s12, 40960
  s_add_u32 s13, s13, 40960
  s_mov_b32 s19, 40960
  s_mov_b64 exec, s[82:83]
  s_add_u32 m0, s11, 0
  s_nop 0
  buffer_load_dwordx4 v16, s[92:95], s10 offen lds
  s_add_u32 s10, s10, 122880
  s_add_u32 m0, s11, 960
  s_nop 0
  buffer_load_dwordx4 v16, s[92:95], s10 offen lds
  s_add_u32 s10, s10, 122880
  s_add_u32 m0, s11, 1920
  s_nop 0
  buffer_load_dwordx4 v16, s[92:95], s10 offen lds
  s_add_u32 s10, s10, 122880
  s_add_u32 m0, s11, 2880
  s_nop 0
  buffer_load_dwordx4 v16, s[92:95], s10 offen lds
  s_add_u32 s10, s10, 122880
  s_add_u32 m0, s11, 3840
  s_nop 0
  buffer_load_dwordx4 v16, s[92:95], s10 offen lds
  s_add_u32 s10, s10, 122880
  s_add_u32 m0, s11, 4800
  s_nop 0
  buffer_load_dwordx4 v16, s[92:95], s10 offen lds
  s_add_u32 s10, s10, 122880
  s_add_u32 m0, s11, 5760
  s_nop 0
  buffer_load_dwordx4 v16, s[92:95], s10 offen lds
  s_add_u32 s10, s10, 122880
  s_add_u32 m0, s11, 6720
  s_nop 0
  buffer_load_dwordx4 v16, s[92:95], s10 offen lds
  s_add_u32 s10, s10, 122880
  s_add_u32 m0, s11, 7680
  s_nop 0
  buffer_load_dwordx4 v16, s[92:95], s10 offen lds
  s_add_u32 s10, s10, 122880
  s_add_u32 m0, s11, 8640
  s_nop 0
  buffer_load_dwordx4 v16, s[92:95], s10 offen lds
  s_add_u32 s10, s10, 122880
  s_add_u32 m0, s11, 9600
  s_nop 0
  buffer_load_dwordx4 v16, s[92:95], s10 offen lds
  s_add_u32 s10, s10, 122880
  s_add_u32 m0, s11, 10560
  s_nop 0
  buffer_load_dwordx4 v16, s[92:95], s10 offen lds
  s_add_u32 s10, s10, 122880
  s_add_u32 m0, s11, 11520
  s_nop 0
  buffer_load_dwordx4 v16, s[92:95], s10 offen lds
  s_add_u32 s10, s10, 122880
  s_add_u32 m0, s11, 12480
  s_nop 0
  buffer_load_dwordx4 v16, s[92:95], s10 offen lds
  s_add_u32 s10, s10, 122880
  s_add_u32 m0, s11, 13440
  s_nop 0
  buffer_load_dwordx4 v16, s[92:95], s10 offen lds
  s_add_u32 s10, s10, 122880
  s_add_u32 m0, s11, 14400
  s_nop 0
  buffer_load_dwordx4 v16, s[92:95], s10 offen lds
  s_add_u32 s10, s10, 122880
  s_add_u32 m0, s11, 15360
  s_nop 0
  buffer_load_dwordx4 v16, s[92:95], s10 offen lds
  s_add_u32 s10, s10, 122880
  s_add_u32 m0, s11, 16320
  s_nop 0
  buffer_load_dwordx4 v16, s[92:95], s10 offen lds
  s_add_u32 s10, s10, 122880
  s_add_u32 m0, s11, 17280
  s_nop 0
  buffer_load_dwordx4 v16, s[92:95], s10 offen lds
  s_add_u32 s10, s10, 122880
  s_add_u32 m0, s11, 18240
  s_nop 0
  buffer_load_dwordx4 v16, s[92:95], s10 offen lds
  s_add_u32 s10, s10, 122880
  s_add_u32 m0, s11, 19200
  s_nop 0
  buffer_load_dwordx4 v16, s[92:95], s10 offen lds
  s_add_u32 s10, s10, 122880
  s_add_u32 m0, s11, 20160
  s_nop 0
  buffer_load_dwordx4 v16, s[92:95], s10 offen lds
  s_add_u32 s10, s10, 122880
  s_add_u32 m0, s11, 21120
  s_nop 0
  buffer_load_dwordx4 v16, s[92:95], s10 offen lds
  s_add_u32 s10, s10, 122880
  s_add_u32 m0, s11, 22080
  s_nop 0
  buffer_load_dwordx4 v16, s[92:95], s10 offen lds
  s_add_u32 s10, s10, 122880
  s_add_u32 m0, s11, 23040
  s_nop 0
  buffer_load_dwordx4 v16, s[92:95], s10 offen lds
  s_add_u32 s10, s10, 122880
  s_add_u32 m0, s11, 24000
  s_nop 0
  buffer_load_dwordx4 v16, s[92:95], s10 offen lds
  s_add_u32 s10, s10, 122880
  s_add_u32 m0, s11, 24960
  s_nop 0
  buffer_load_dwordx4 v16, s[92:95], s10 offen lds
  s_add_u32 s10, s10, 122880
  s_add_u32 m0, s11, 25920
  s_nop 0
  buffer_load_dwordx4 v16, s[92:95], s10 offen lds
  s_add_u32 s10, s10, 122880
  s_add_u32 m0, s11, 26880
  s_nop 0
  buffer_load_dwordx4 v16, s[92:95], s10 offen lds
  s_add_u32 s10, s10, 122880
  s_add_u32 m0, s11, 27840
  s_nop 0
  buffer_load_dwordx4 v16, s[92:95], s10 offen lds
  s_add_u32 s10, s10, 122880
  s_add_u32 m0, s11, 28800
  s_nop 0
  buffer_load_dwordx4 v16, s[92:95], s10 offen lds
  s_add_u32 s10, s10, 122880
  s_add_u32 m0, s11, 29760
  s_nop 0
  buffer_load_dwordx4 v16, s[92:95], s10 offen lds
  s_add_u32 s10, s10, 122880
  s_mov_b64 exec, -1
  s_waitcnt vmcnt(28)
  ds_read_b64_tr_b16 a[0:1], v17 offset:0
  ds_read_b64_tr_b16 a[2:3], v17 offset:384
  ds_read_b64_tr_b16 a[80:81], v17 offset:32
  ds_read_b64_tr_b16 a[82:83], v17 offset:416
  ds_read_b64_tr_b16 a[160:161], v17 offset:64
  ds_read_b64_tr_b16 a[162:163], v17 offset:448
  s_waitcnt lgkmcnt(0)
  s_mov_b64 exec, s[82:83]
  s_add_u32 m0, s11, 0
  s_nop 0
  buffer_load_dwordx4 v16, s[92:95], s10 offen lds
  s_add_u32 s10, s10, 122880
  s_add_u32 m0, s11, 960
  s_nop 0
  buffer_load_dwordx4 v16, s[92:95], s10 offen lds
  s_add_u32 s10, s10, 122880
  s_add_u32 m0, s11, 1920
  s_nop 0
  buffer_load_dwordx4 v16, s[92:95], s10 offen lds
  s_add_u32 s10, s10, 122880
  s_mov_b64 exec, -1
  s_waitcnt vmcnt(28)
  ds_read_b64_tr_b16 a[4:5], v17 offset:3072
  ds_read_b64_tr_b16 a[6:7], v17 offset:3456
  ds_read_b64_tr_b16 a[84:85], v17 offset:3104
  ds_read_b64_tr_b16 a[86:87], v17 offset:3488
  ds_read_b64_tr_b16 a[164:165], v17 offset:3136
  ds_read_b64_tr_b16 a[166:167], v17 offset:3520
  s_waitcnt lgkmcnt(0)
  s_mov_b64 exec, s[82:83]
  s_add_u32 m0, s11, 2880
  s_nop 0
  buffer_load_dwordx4 v16, s[92:95], s10 offen lds
  s_add_u32 s10, s10, 122880
  s_add_u32 m0, s11, 3840
  s_nop 0
  buffer_load_dwordx4 v16, s[92:95], s10 offen lds
  s_add_u32 s10, s10, 122880
  s_add_u32 m0, s11, 4800
  s_nop 0
  buffer_load_dwordx4 v16, s[92:95], s10 offen lds
  s_add_u32 s10, s10, 122880
  s_mov_b64 exec, -1
  s_waitcnt vmcnt(28)
  ds_read_b64_tr_b16 a[8:9], v17 offset:6144
  ds_read_b64_tr_b16 a[10:11], v17 offset:6528
  ds_read_b64_tr_b16 a[88:89], v17 offset:6176
  ds_read_b64_tr_b16 a[90:91], v17 offset:6560
  ds_read_b64_tr_b16 a[168:169], v17 offset:6208
  ds_read_b64_tr_b16 a[170:171], v17 offset:6592
  s_waitcnt lgkmcnt(0)
  s_mov_b64 exec, s[82:83]
  s_add_u32 m0, s11, 5760
  s_nop 0
  buffer_load_dwordx4 v16, s[92:95], s10 offen lds
  s_add_u32 s10, s10, 122880
  s_add_u32 m0, s11, 6720
  s_nop 0
  buffer_load_dwordx4 v16, s[92:95], s10 offen lds
  s_add_u32 s10, s10, 122880
  s_add_u32 m0, s11, 7680
  s_nop 0
  buffer_load_dwordx4 v16, s[92:95], s10 offen lds
  s_add_u32 s10, s10, 122880
  s_mov_b64 exec, -1
  s_waitcnt vmcnt(28)
  ds_read_b64_tr_b16 a[12:13], v17 offset:9216
  ds_read_b64_tr_b16 a[14:15], v17 offset:9600
  ds_read_b64_tr_b16 a[92:93], v17 offset:9248
  ds_read_b64_tr_b16 a[94:95], v17 offset:9632
  ds_read_b64_tr_b16 a[172:173], v17 offset:9280
  ds_read_b64_tr_b16 a[174:175], v17 offset:9664
  s_waitcnt lgkmcnt(0)
  s_mov_b64 exec, s[82:83]
  s_add_u32 m0, s11, 8640
  s_nop 0
  buffer_load_dwordx4 v16, s[92:95], s10 offen lds
  s_add_u32 s10, s10, 122880
  s_add_u32 m0, s11, 9600
  s_nop 0
  buffer_load_dwordx4 v16, s[92:95], s10 offen lds
  s_add_u32 s10, s10, 122880
  s_add_u32 m0, s11, 10560
  s_nop 0
  buffer_load_dwordx4 v16, s[92:95], s10 offen lds
  s_add_u32 s10, s10, 122880
  s_mov_b64 exec, -1
  s_waitcnt vmcnt(28)
  ds_read_b64_tr_b16 a[16:17], v17 offset:12288
  ds_read_b64_tr_b16 a[18:19], v17 offset:12672
  ds_read_b64_tr_b16 a[96:97], v17 offset:12320
  ds_read_b64_tr_b16 a[98:99], v17 offset:12704
  ds_read_b64_tr_b16 a[176:177], v17 offset:12352
  ds_read_b64_tr_b16 a[178:179], v17 offset:12736
  s_waitcnt lgkmcnt(0)
  s_mov_b64 exec, s[82:83]
  s_add_u32 m0, s11, 11520
  s_nop 0
  buffer_load_dwordx4 v16, s[92:95], s10 offen lds
  s_add_u32 s10, s10, 122880
  s_add_u32 m0, s11, 12480
  s_nop 0
  buffer_load_dwordx4 v16, s[92:95], s10 offen lds
  s_add_u32 s10, s10, 122880
  s_add_u32 m0, s11, 13440
  s_nop 0
  buffer_load_dwordx4 v16, s[92:95], s10 offen lds
  s_add_u32 s10, s10, 122880
  s_add_u32 m0, s11, 14400
  s_nop 0
  buffer_load_dwordx4 v16, s[92:95], s10 offen lds
  s_add_u32 s10, s10, 122880
  s_mov_b64 exec, -1
  s_waitcnt vmcnt(28)
  ds_read_b64_tr_b16 a[20:21], v17 offset:15360
  ds_read_b64_tr_b16 a[22:23], v17 offset:15744
  ds_read_b64_tr_b16 a[100:101], v17 offset:15392
  ds_read_b64_tr_b16 a[102:103], v17 offset:15776
  ds_read_b64_tr_b16 a[180:181], v17 offset:15424
  ds_read_b64_tr_b16 a[182:183], v17 offset:15808
  s_waitcnt lgkmcnt(0)
  s_mov_b64 exec, s[82:83]
  s_add_u32 m0, s11, 15360
  s_nop 0
  buffer_load_dwordx4 v16, s[92:95], s10 offen lds
  s_add_u32 s10, s10, 122880
  s_add_u32 m0, s11, 16320
  s_nop 0
  buffer_load_dwordx4 v16, s[92:95], s10 offen lds
  s_add_u32 s10, s10, 122880
  s_add_u32 m0, s11, 17280
  s_nop 0
  buffer_load_dwordx4 v16, s[92:95], s10 offen lds
  s_add_u32 s10, s10, 122880
  s_mov_b64 exec, -1
  s_waitcnt vmcnt(28)
  ds_read_b64_tr_b16 a[24:25], v17 offset:18432
  ds_read_b64_tr_b16 a[26:27], v17 offset:18816
  ds_read_b64_tr_b16 a[104:105], v17 offset:18464
  ds_read_b64_tr_b16 a[106:107], v17 offset:18848
  ds_read_b64_tr_b16 a[184:185], v17 offset:18496
  ds_read_b64_tr_b16 a[186:187], v17 offset:18880
  s_waitcnt lgkmcnt(0)
  s_mov_b64 exec, s[82:83]
  s_add_u32 m0, s11, 18240
  s_nop 0
  buffer_load_dwordx4 v16, s[92:95], s10 offen lds
  s_add_u32 s10, s10, 122880
  s_add_u32 m0, s11, 19200
  s_nop 0
  buffer_load_dwordx4 v16, s[92:95], s10 offen lds
  s_add_u32 s10, s10, 122880
  s_add_u32 m0, s11, 20160
  s_nop 0
  buffer_load_dwordx4 v16, s[92:95], s10 offen lds
  s_add_u32 s10, s10, 122880
  s_mov_b64 exec, -1
  s_waitcnt vmcnt(28)
  ds_read_b64_tr_b16 a[28:29], v17 offset:21504
  ds_read_b64_tr_b16 a[30:31], v17 offset:21888
  ds_read_b64_tr_b16 a[108:109], v17 offset:21536
  ds_read_b64_tr_b16 a[110:111], v17 offset:21920
  ds_read_b64_tr_b16 a[188:189], v17 offset:21568
  ds_read_b64_tr_b16 a[190:191], v17 offset:21952
  s_waitcnt lgkmcnt(0)
  s_mov_b64 exec, s[82:83]
  s_add_u32 m0, s11, 21120
  s_nop 0
  buffer_load_dwordx4 v16, s[92:95], s10 offen lds
  s_add_u32 s10, s10, 122880
  s_add_u32 m0, s11, 22080
  s_nop 0
  buffer_load_dwordx4 v16, s[92:95], s10 offen lds
  s_add_u32 s10, s10, 122880
  s_add_u32 m0, s11, 23040
  s_nop 0
  buffer_load_dwordx4 v16, s[92:95], s10 offen lds
  s_add_u32 s10, s10, 122880
  s_mov_b64 exec, -1
  s_waitcnt vmcnt(28)
  ds_read_b64_tr_b16 a[32:33], v17 offset:24576
  ds_read_b64_tr_b16 a[34:35], v17 offset:24960
  ds_read_b64_tr_b16 a[112:113], v17 offset:24608
  ds_read_b64_tr_b16 a[114:115], v17 offset:24992
  ds_read_b64_tr_b16 a[192:193], v17 offset:24640
  ds_read_b64_tr_b16 a[194:195], v17 offset:25024
  s_waitcnt lgkmcnt(0)
  s_mov_b64 exec, s[82:83]
  s_add_u32 m0, s11, 24000
  s_nop 0
  buffer_load_dwordx4 v16, s[92:95], s10 offen lds
  s_add_u32 s10, s10, 122880
  s_add_u32 m0, s11, 24960
  s_nop 0
  buffer_load_dwordx4 v16, s[92:95], s10 offen lds
  s_add_u32 s10, s10, 122880
  s_add_u32 m0, s11, 25920
  s_nop 0
  buffer_load_dwordx4 v16, s[92:95], s10 offen lds
  s_add_u32 s10, s10, 122880
  s_mov_b64 exec, -1
  s_waitcnt vmcnt(28)
  ds_read_b64_tr_b16 a[36:37], v17 offset:27648
  ds_read_b64_tr_b16 a[38:39], v17 offset:28032
  ds_read_b64_tr_b16 a[116:117], v17 offset:27680
  ds_read_b64_tr_b16 a[118:119], v17 offset:28064
  ds_read_b64_tr_b16 a[196:197], v17 offset:27712
  ds_read_b64_tr_b16 a[198:199], v17 offset:28096
  s_waitcnt lgkmcnt(0)
  s_mov_b64 exec, s[82:83]
  s_add_u32 m0, s11, 26880
  s_nop 0
  buffer_load_dwordx4 v16, s[92:95], s10 offen lds
  s_add_u32 s10, s10, 122880
  s_add_u32 m0, s11, 27840
  s_nop 0
  buffer_load_dwordx4 v16, s[92:95], s10 offen lds
  s_add_u32 s10, s10, 122880
  s_add_u32 m0, s11, 28800
  s_nop 0
  buffer_load_dwordx4 v16, s[92:95], s10 offen lds
  s_add_u32 s10, s10, 122880
  s_add_u32 m0, s11, 29760
  s_nop 0
  buffer_load_dwordx4 v16, s[92:95], s10 offen lds
  s_add_u32 s10, s10, 122880
  s_mov_b64 exec, -1
  s_waitcnt vmcnt(28)
  ds_read_b64_tr_b16 a[40:41], v17 offset:0
  ds_read_b64_tr_b16 a[42:43], v17 offset:384
  ds_read_b64_tr_b16 a[120:121], v17 offset:32
  ds_read_b64_tr_b16 a[122:123], v17 offset:416
  ds_read_b64_tr_b16 a[200:201], v17 offset:64
  ds_read_b64_tr_b16 a[202:203], v17 offset:448
  s_waitcnt vmcnt(25)
  ds_read_b64_tr_b16 a[44:45], v17 offset:3072
  ds_read_b64_tr_b16 a[46:47], v17 offset:3456
  ds_read_b64_tr_b16 a[124:125], v17 offset:3104
  ds_read_b64_tr_b16 a[126:127], v17 offset:3488
  ds_read_b64_tr_b16 a[204:205], v17 offset:3136
  ds_read_b64_tr_b16 a[206:207], v17 offset:3520
  s_waitcnt vmcnt(22)
  ds_read_b64_tr_b16 a[48:49], v17 offset:6144
  ds_read_b64_tr_b16 a[50:51], v17 offset:6528
  ds_read_b64_tr_b16 a[128:129], v17 offset:6176
  ds_read_b64_tr_b16 a[130:131], v17 offset:6560
  ds_read_b64_tr_b16 a[208:209], v17 offset:6208
  ds_read_b64_tr_b16 a[210:211], v17 offset:6592
  s_waitcnt vmcnt(19)
  ds_read_b64_tr_b16 a[52:53], v17 offset:9216
  ds_read_b64_tr_b16 a[54:55], v17 offset:9600
  ds_read_b64_tr_b16 a[132:133], v17 offset:9248
  ds_read_b64_tr_b16 a[134:135], v17 offset:9632
  ds_read_b64_tr_b16 a[212:213], v17 offset:9280
  ds_read_b64_tr_b16 a[214:215], v17 offset:9664
  s_waitcnt vmcnt(16)
  ds_read_b64_tr_b16 a[56:57], v17 offset:12288
  ds_read_b64_tr_b16 a[58:59], v17 offset:12672
  ds_read_b64_tr_b16 a[136:137], v17 offset:12320
  ds_read_b64_tr_b16 a[138:139], v17 offset:12704
  ds_read_b64_tr_b16 a[216:217], v17 offset:12352
  ds_read_b64_tr_b16 a[218:219], v17 offset:12736
  s_waitcnt vmcnt(12)
  ds_read_b64_tr_b16 a[60:61], v17 offset:15360
  ds_read_b64_tr_b16 a[62:63], v17 offset:15744
  ds_read_b64_tr_b16 a[140:141], v17 offset:15392
  ds_read_b64_tr_b16 a[142:143], v17 offset:15776
  ds_read_b64_tr_b16 a[220:221], v17 offset:15424
  ds_read_b64_tr_b16 a[222:223], v17 offset:15808
  s_waitcnt vmcnt(9)
  ds_read_b64_tr_b16 a[64:65], v17 offset:18432
  ds_read_b64_tr_b16 a[66:67], v17 offset:18816
  ds_read_b64_tr_b16 a[144:145], v17 offset:18464
  ds_read_b64_tr_b16 a[146:147], v17 offset:18848
  ds_read_b64_tr_b16 a[224:225], v17 offset:18496
  ds_read_b64_tr_b16 a[226:227], v17 offset:18880
  s_waitcnt vmcnt(6)
  ds_read_b64_tr_b16 a[68:69], v17 offset:21504
  ds_read_b64_tr_b16 a[70:71], v17 offset:21888
  ds_read_b64_tr_b16 a[148:149], v17 offset:21536
  ds_read_b64_tr_b16 a[150:151], v17 offset:21920
  ds_read_b64_tr_b16 a[228:229], v17 offset:21568
  ds_read_b64_tr_b16 a[230:231], v17 offset:21952
  s_waitcnt vmcnt(3)
  ds_read_b64_tr_b16 a[72:73], v17 offset:24576
  ds_read_b64_tr_b16 a[74:75], v17 offset:24960
  ds_read_b64_tr_b16 a[152:153], v17 offset:24608
  ds_read_b64_tr_b16 a[154:155], v17 offset:24992
  ds_read_b64_tr_b16 a[232:233], v17 offset:24640
  ds_read_b64_tr_b16 a[234:235], v17 offset:25024
  s_waitcnt vmcnt(0)
  ds_read_b64_tr_b16 a[76:77], v17 offset:27648
  ds_read_b64_tr_b16 a[78:79], v17 offset:28032
  ds_read_b64_tr_b16 a[156:157], v17 offset:27680
  ds_read_b64_tr_b16 a[158:159], v17 offset:28064
  ds_read_b64_tr_b16 a[236:237], v17 offset:27712
  ds_read_b64_tr_b16 a[238:239], v17 offset:28096
  s_waitcnt lgkmcnt(0)
  s_lshl_b32 s28, s68, 2
  v_mov_b32 v17, s28
  s_mov_b32 s28, 0
mega0_kernel_cen12:
  buffer_load_dword v16, v17, s[44:47], 0 offen sc1
  s_waitcnt vmcnt(0)
  v_readfirstlane_b32 s26, v16
  s_nop 0
  s_and_b32 s27, s26, 63
  s_cmp_eq_u32 s27, 32
  s_cbranch_scc1 mega0_kernel_cen12_done
  s_sleep 4
  s_add_u32 s28, s28, 1
  s_cmp_lt_u32 s28, 262144
  s_cbranch_scc1 mega0_kernel_cen12
  s_branch mega_fail
mega0_kernel_cen12_done:
  s_cmp_eq_u32 s26, s69
  s_cselect_b32 s69, 0, 1
  v_mov_b32 v5, v2
  s_mov_b32 s24, 0
  s_lshr_b32 s15, s3, 1
  s_add_u32 s15, s15, 4
  s_lshl_b32 s15, s15, 10
  s_and_b32 s16, s3, 1
  s_lshl_b32 s16, s16, 3
  s_add_u32 s15, s15, s16
  v_add_u32 v4, s15, v2
  v_and_b32 v9, 15, v1
  v_lshrrev_b32 v10, 4, v1
  v_and_b32 v11, 7, v1
  v_lshlrev_b32 v11, 4, v11
  v_lshl_add_u32 v11, v10, 7, v11
  v_lshrrev_b32 v8, 1, v11
  v_add_u32 v3, 122880, v3
  v_add_u32 v4, 122880, v4
  s_mul_i32 s26, s3, 6144
  s_add_u32 s26, s26, 122880
  v_add_u32 v12, s26, v2
  v_mov_b32 v13, 0xd04e79ff
  v_lshlrev_b32 v14, 2, v10
  v_add_u32 v15, 0, v14
  v_cmp_le_u32 s[32:33], v15, v9
  v_add_u32 v15, 1, v14
  v_cmp_le_u32 s[34:35], v15, v9
  v_add_u32 v15, 2, v14
  v_cmp_le_u32 s[36:37], v15, v9
  v_add_u32 v15, 3, v14
  v_cmp_le_u32 s[38:39], v15, v9
  s_mov_b32 s40, -1
  s_mov_b32 s41, 0
  s_mov_b32 s42, 0x3dd53b95
  s_lshr_b32 s31, s3, 1
  s_mul_i32 s20, s31, 325632
  s_add_u32 s60, s31, 1
  s_mul_i32 s26, s9, 12288
  s_add_u32 s26, s26, s78
  s_add_u32 s26, s26, 204800
  s_mul_i32 s27, s9, 3072
  s_add_u32 s27, s27, s78
  s_add_u32 s27, s27, 303104
  s_and_b32 s28, s3, 1
  s_mul_i32 s28, s28, 5120
  s_add_u32 s28, s28, s78
  s_add_u32 s28, s28, 315392
  s_lshl_b32 s29, s9, 10
  v_add_u32 v14, s29, v2
  s_lshl_b32 s29, s9, 8
  s_add_u32 s29, s29, 4096
  v_lshlrev_b32 v15, 3, v10
  v_lshl_add_u32 v15, v9, 4, v15
  v_add_u32 v15, s29, v15
  s_lshl_b32 s48, s80, 7
  v_and_b32 v84, 3, v1
  v_lshlrev_b32 v84, 2, v84
  v_add_u32 v84, s48, v84
  v_add_u32 v85, 16384, v84
  s_lshl_b32 s50, s3, 2
  s_add_u32 s50, s50, s48
  s_add_u32 s50, s50, s71
  s_add_u32 s50, s50, 8192
  s_mov_b32 s62, 0
  s_barrier
  ds_read_b128 v[16:19], v5 offset:0
  ds_read_b128 v[20:23], v5 offset:20480
  ds_read_b128 v[24:27], v5 offset:1024
  ds_read_b128 v[28:31], v5 offset:21504
  ds_read_b128 v[32:35], v5 offset:2048
  ds_read_b128 v[36:39], v5 offset:22528
  s_waitcnt lgkmcnt(4)
  v_mfma_f32_16x16x32_bf16 v[48:51], a[0:3], v[16:19], 0
  ds_read_b128 v[40:43], v5 offset:3072
  v_mfma_f32_16x16x32_bf16 v[52:55], a[80:83], v[16:19], 0
  s_add_u32 m0, s13, 0
  s_add_u32 s18, s12, 0
  buffer_load_dwordx4 v2, s[4:7], s18 offen offset:0 lds
  v_mfma_f32_16x16x32_bf16 v[56:59], a[160:163], v[16:19], 0
  v_mfma_f32_16x16x32_bf16 v[60:63], a[0:3], v[20:23], 0
  ds_read_b128 v[44:47], v5 offset:23552
  v_mfma_f32_16x16x32_bf16 v[64:67], a[80:83], v[20:23], 0
  v_mfma_f32_16x16x32_bf16 v[68:71], a[160:163], v[20:23], 0
  s_waitcnt lgkmcnt(4)
  v_mfma_f32_16x16x32_bf16 v[48:51], a[4:7], v[24:27], v[48:51]
  ds_read_b128 v[16:19], v5 offset:4096
  v_mfma_f32_16x16x32_bf16 v[52:55], a[84:87], v[24:27], v[52:55]
  v_mfma_f32_16x16x32_bf16 v[56:59], a[164:167], v[24:27], v[56:59]
  buffer_load_dwordx4 v2, s[4:7], s18 offen offset:1024 lds
  v_mfma_f32_16x16x32_bf16 v[60:63], a[4:7], v[28:31], v[60:63]
  ds_read_b128 v[20:23], v5 offset:24576
  v_mfma_f32_16x16x32_bf16 v[64:67], a[84:87], v[28:31], v[64:67]
  v_mfma_f32_16x16x32_bf16 v[68:71], a[164:167], v[28:31], v[68:71]
  s_waitcnt lgkmcnt(4)
  v_mfma_f32_16x16x32_bf16 v[48:51], a[8:11], v[32:35], v[48:51]
  ds_read_b128 v[24:27], v5 offset:5120
  v_mfma_f32_16x16x32_bf16 v[52:55], a[88:91], v[32:35], v[52:55]
  v_mfma_f32_16x16x32_bf16 v[56:59], a[168:171], v[32:35], v[56:59]
  v_mfma_f32_16x16x32_bf16 v[60:63], a[8:11], v[36:39], v[60:63]
  ds_read_b128 v[28:31], v5 offset:25600
  v_mfma_f32_16x16x32_bf16 v[64:67], a[88:91], v[36:39], v[64:67]
  v_mfma_f32_16x16x32_bf16 v[68:71], a[168:171], v[36:39], v[68:71]
  buffer_load_dwordx4 v2, s[4:7], s18 offen offset:2048 lds
  s_waitcnt lgkmcnt(4)
  v_mfma_f32_16x16x32_bf16 v[48:51], a[12:15], v[40:43], v[48:51]
  ds_read_b128 v[32:35], v5 offset:6144
  v_mfma_f32_16x16x32_bf16 v[52:55], a[92:95], v[40:43], v[52:55]
  v_mfma_f32_16x16x32_bf16 v[56:59], a[172:175], v[40:43], v[56:59]
  v_mfma_f32_16x16x32_bf16 v[60:63], a[12:15], v[44:47], v[60:63]
  ds_read_b128 v[36:39], v5 offset:26624
  v_mfma_f32_16x16x32_bf16 v[64:67], a[92:95], v[44:47], v[64:67]
  v_mfma_f32_16x16x32_bf16 v[68:71], a[172:175], v[44:47], v[68:71]
  s_waitcnt lgkmcnt(4)
  v_mfma_f32_16x16x32_bf16 v[48:51], a[16:19], v[16:19], v[48:51]
  ds_read_b128 v[40:43], v5 offset:7168
  v_mfma_f32_16x16x32_bf16 v[52:55], a[96:99], v[16:19], v[52:55]
  buffer_load_dwordx4 v2, s[4:7], s18 offen offset:3072 lds
  v_mfma_f32_16x16x32_bf16 v[56:59], a[176:179], v[16:19], v[56:59]
  v_mfma_f32_16x16x32_bf16 v[60:63], a[16:19], v[20:23], v[60:63]
  ds_read_b128 v[44:47], v5 offset:27648
  v_mfma_f32_16x16x32_bf16 v[64:67], a[96:99], v[20:23], v[64:67]
  v_mfma_f32_16x16x32_bf16 v[68:71], a[176:179], v[20:23], v[68:71]
  s_waitcnt lgkmcnt(4)
  v_mfma_f32_16x16x32_bf16 v[48:51], a[20:23], v[24:27], v[48:51]
  ds_read_b128 v[16:19], v5 offset:8192
  v_mfma_f32_16x16x32_bf16 v[52:55], a[100:103], v[24:27], v[52:55]
  v_mfma_f32_16x16x32_bf16 v[56:59], a[180:183], v[24:27], v[56:59]
  v_mfma_f32_16x16x32_bf16 v[60:63], a[20:23], v[28:31], v[60:63]
  ds_read_b128 v[20:23], v5 offset:28672
  v_mfma_f32_16x16x32_bf16 v[64:67], a[100:103], v[28:31], v[64:67]
  s_add_u32 m0, s13, 4096
  s_add_u32 s18, s12, 4096
  buffer_load_dwordx4 v2, s[4:7], s18 offen offset:0 lds
  v_mfma_f32_16x16x32_bf16 v[68:71], a[180:183], v[28:31], v[68:71]
  s_waitcnt lgkmcnt(4)
  v_mfma_f32_16x16x32_bf16 v[48:51], a[24:27], v[32:35], v[48:51]
  ds_read_b128 v[24:27], v5 offset:9216
  v_mfma_f32_16x16x32_bf16 v[52:55], a[104:107], v[32:35], v[52:55]
  v_mfma_f32_16x16x32_bf16 v[56:59], a[184:187], v[32:35], v[56:59]
  v_mfma_f32_16x16x32_bf16 v[60:63], a[24:27], v[36:39], v[60:63]
  ds_read_b128 v[28:31], v5 offset:29696
  v_mfma_f32_16x16x32_bf16 v[64:67], a[104:107], v[36:39], v[64:67]
  v_mfma_f32_16x16x32_bf16 v[68:71], a[184:187], v[36:39], v[68:71]
  s_waitcnt lgkmcnt(4)
  v_mfma_f32_16x16x32_bf16 v[48:51], a[28:31], v[40:43], v[48:51]
  ds_read_b128 v[32:35], v5 offset:10240
  v_mfma_f32_16x16x32_bf16 v[52:55], a[108:111], v[40:43], v[52:55]
  buffer_load_dwordx4 v2, s[4:7], s18 offen offset:1024 lds
  v_mfma_f32_16x16x32_bf16 v[56:59], a[188:191], v[40:43], v[56:59]
  v_mfma_f32_16x16x32_bf16 v[60:63], a[28:31], v[44:47], v[60:63]
  ds_read_b128 v[36:39], v5 offset:30720
  v_mfma_f32_16x16x32_bf16 v[64:67], a[108:111], v[44:47], v[64:67]
  v_mfma_f32_16x16x32_bf16 v[68:71], a[188:191], v[44:47], v[68:71]
  s_waitcnt lgkmcnt(4)
  v_mfma_f32_16x16x32_bf16 v[48:51], a[32:35], v[16:19], v[48:51]
  ds_read_b128 v[40:43], v5 offset:11264
  v_mfma_f32_16x16x32_bf16 v[52:55], a[112:115], v[16:19], v[52:55]
  v_mfma_f32_16x16x32_bf16 v[56:59], a[192:195], v[16:19], v[56:59]
  buffer_load_dwordx4 v2, s[4:7], s18 offen offset:2048 lds
  v_mfma_f32_16x16x32_bf16 v[60:63], a[32:35], v[20:23], v[60:63]
  ds_read_b128 v[44:47], v5 offset:31744
  v_mfma_f32_16x16x32_bf16 v[64:67], a[112:115], v[20:23], v[64:67]
  v_mfma_f32_16x16x32_bf16 v[68:71], a[192:195], v[20:23], v[68:71]
  s_waitcnt lgkmcnt(4)
  v_mfma_f32_16x16x32_bf16 v[48:51], a[36:39], v[24:27], v[48:51]
  ds_read_b128 v[16:19], v5 offset:12288
  v_mfma_f32_16x16x32_bf16 v[52:55], a[116:119], v[24:27], v[52:55]
  v_mfma_f32_16x16x32_bf16 v[56:59], a[196:199], v[24:27], v[56:59]
  v_mfma_f32_16x16x32_bf16 v[60:63], a[36:39], v[28:31], v[60:63]
  ds_read_b128 v[20:23], v5 offset:32768
  v_mfma_f32_16x16x32_bf16 v[64:67], a[116:119], v[28:31], v[64:67]
  v_mfma_f32_16x16x32_bf16 v[68:71], a[196:199], v[28:31], v[68:71]
  buffer_load_dwordx4 v2, s[4:7], s18 offen offset:3072 lds
  s_waitcnt lgkmcnt(4)
  v_mfma_f32_16x16x32_bf16 v[48:51], a[40:43], v[32:35], v[48:51]
  ds_read_b128 v[24:27], v5 offset:13312
  v_mfma_f32_16x16x32_bf16 v[52:55], a[120:123], v[32:35], v[52:55]
  v_mfma_f32_16x16x32_bf16 v[56:59], a[200:203], v[32:35], v[56:59]
  v_mfma_f32_16x16x32_bf16 v[60:63], a[40:43], v[36:39], v[60:63]
  ds_read_b128 v[28:31], v5 offset:33792
  v_mfma_f32_16x16x32_bf16 v[64:67], a[120:123], v[36:39], v[64:67]
  v_mfma_f32_16x16x32_bf16 v[68:71], a[200:203], v[36:39], v[68:71]
  s_waitcnt lgkmcnt(4)
  v_mfma_f32_16x16x32_bf16 v[48:51], a[44:47], v[40:43], v[48:51]
  ds_read_b128 v[32:35], v5 offset:14336
  v_mfma_f32_16x16x32_bf16 v[52:55], a[124:127], v[40:43], v[52:55]
  s_add_u32 m0, s13, 8192
  s_add_u32 s18, s12, 8192
  buffer_load_dwordx4 v2, s[4:7], s18 offen offset:0 lds
  v_mfma_f32_16x16x32_bf16 v[56:59], a[204:207], v[40:43], v[56:59]
  v_mfma_f32_16x16x32_bf16 v[60:63], a[44:47], v[44:47], v[60:63]
  ds_read_b128 v[36:39], v5 offset:34816
  v_mfma_f32_16x16x32_bf16 v[64:67], a[124:127], v[44:47], v[64:67]
  v_mfma_f32_16x16x32_bf16 v[68:71], a[204:207], v[44:47], v[68:71]
  s_waitcnt lgkmcnt(4)
  v_mfma_f32_16x16x32_bf16 v[48:51], a[48:51], v[16:19], v[48:51]
  ds_read_b128 v[40:43], v5 offset:15360
  v_mfma_f32_16x16x32_bf16 v[52:55], a[128:131], v[16:19], v[52:55]
  v_mfma_f32_16x16x32_bf16 v[56:59], a[208:211], v[16:19], v[56:59]
  v_mfma_f32_16x16x32_bf16 v[60:63], a[48:51], v[20:23], v[60:63]
  ds_read_b128 v[44:47], v5 offset:35840
  v_mfma_f32_16x16x32_bf16 v[64:67], a[128:131], v[20:23], v[64:67]
  buffer_load_dwordx4 v2, s[4:7], s18 offen offset:1024 lds
  v_mfma_f32_16x16x32_bf16 v[68:71], a[208:211], v[20:23], v[68:71]
  s_waitcnt lgkmcnt(4)
  v_mfma_f32_16x16x32_bf16 v[48:51], a[52:55], v[24:27], v[48:51]
  ds_read_b128 v[16:19], v5 offset:16384
  v_mfma_f32_16x16x32_bf16 v[52:55], a[132:135], v[24:27], v[52:55]
  v_mfma_f32_16x16x32_bf16 v[56:59], a[212:215], v[24:27], v[56:59]
  v_mfma_f32_16x16x32_bf16 v[60:63], a[52:55], v[28:31], v[60:63]
  ds_read_b128 v[20:23], v5 offset:36864
  v_mfma_f32_16x16x32_bf16 v[64:67], a[132:135], v[28:31], v[64:67]
  v_mfma_f32_16x16x32_bf16 v[68:71], a[212:215], v[28:31], v[68:71]
  s_waitcnt lgkmcnt(4)
  v_mfma_f32_16x16x32_bf16 v[48:51], a[56:59], v[32:35], v[48:51]
  ds_read_b128 v[24:27], v5 offset:17408
  v_mfma_f32_16x16x32_bf16 v[52:55], a[136:139], v[32:35], v[52:55]
  v_mfma_f32_16x16x32_bf16 v[56:59], a[216:219], v[32:35], v[56:59]
  v_mfma_f32_16x16x32_bf16 v[60:63], a[56:59], v[36:39], v[60:63]
  ds_read_b128 v[28:31], v5 offset:37888
  v_mfma_f32_16x16x32_bf16 v[64:67], a[136:139], v[36:39], v[64:67]
  v_mfma_f32_16x16x32_bf16 v[68:71], a[216:219], v[36:39], v[68:71]
  s_waitcnt lgkmcnt(4)
  v_mfma_f32_16x16x32_bf16 v[48:51], a[60:63], v[40:43], v[48:51]
  ds_read_b128 v[32:35], v5 offset:18432
  v_mfma_f32_16x16x32_bf16 v[52:55], a[140:143], v[40:43], v[52:55]
  v_mfma_f32_16x16x32_bf16 v[56:59], a[220:223], v[40:43], v[56:59]
  v_mfma_f32_16x16x32_bf16 v[60:63], a[60:63], v[44:47], v[60:63]
  ds_read_b128 v[36:39], v5 offset:38912
  v_mfma_f32_16x16x32_bf16 v[64:67], a[140:143], v[44:47], v[64:67]
  v_mfma_f32_16x16x32_bf16 v[68:71], a[220:223], v[44:47], v[68:71]
  s_waitcnt lgkmcnt(4)
  v_mfma_f32_16x16x32_bf16 v[48:51], a[64:67], v[16:19], v[48:51]
  ds_read_b128 v[40:43], v5 offset:19456
  v_mfma_f32_16x16x32_bf16 v[52:55], a[144:147], v[16:19], v[52:55]
  v_mfma_f32_16x16x32_bf16 v[56:59], a[224:227], v[16:19], v[56:59]
  v_mfma_f32_16x16x32_bf16 v[60:63], a[64:67], v[20:23], v[60:63]
  ds_read_b128 v[44:47], v5 offset:39936
  v_mfma_f32_16x16x32_bf16 v[64:67], a[144:147], v[20:23], v[64:67]
  v_mfma_f32_16x16x32_bf16 v[68:71], a[224:227], v[20:23], v[68:71]
  s_waitcnt lgkmcnt(4)
  v_mfma_f32_16x16x32_bf16 v[48:51], a[68:71], v[24:27], v[48:51]
  v_mfma_f32_16x16x32_bf16 v[52:55], a[148:151], v[24:27], v[52:55]
  v_mfma_f32_16x16x32_bf16 v[56:59], a[228:231], v[24:27], v[56:59]
  v_mfma_f32_16x16x32_bf16 v[60:63], a[68:71], v[28:31], v[60:63]
  v_mfma_f32_16x16x32_bf16 v[64:67], a[148:151], v[28:31], v[64:67]
  v_mfma_f32_16x16x32_bf16 v[68:71], a[228:231], v[28:31], v[68:71]
  s_waitcnt lgkmcnt(2)
  v_mfma_f32_16x16x32_bf16 v[48:51], a[72:75], v[32:35], v[48:51]
  v_mfma_f32_16x16x32_bf16 v[52:55], a[152:155], v[32:35], v[52:55]
  v_mfma_f32_16x16x32_bf16 v[56:59], a[232:235], v[32:35], v[56:59]
  v_mfma_f32_16x16x32_bf16 v[60:63], a[72:75], v[36:39], v[60:63]
  v_mfma_f32_16x16x32_bf16 v[64:67], a[152:155], v[36:39], v[64:67]
  v_mfma_f32_16x16x32_bf16 v[68:71], a[232:235], v[36:39], v[68:71]
  s_waitcnt lgkmcnt(0)
  v_mfma_f32_16x16x32_bf16 v[48:51], a[76:79], v[40:43], v[48:51]
  v_mfma_f32_16x16x32_bf16 v[52:55], a[156:159], v[40:43], v[52:55]
  v_mfma_f32_16x16x32_bf16 v[56:59], a[236:239], v[40:43], v[56:59]
  v_mfma_f32_16x16x32_bf16 v[60:63], a[76:79], v[44:47], v[60:63]
  v_mfma_f32_16x16x32_bf16 v[64:67], a[156:159], v[44:47], v[64:67]
  v_mfma_f32_16x16x32_bf16 v[68:71], a[236:239], v[44:47], v[68:71]
  v_add_u32 v5, s19, v5
  s_sub_u32 s13, s13, s19
  s_sub_u32 s19, 0, s19
  s_add_u32 s12, s12, 40960
  s_add_u32 s24, s24, 1
  v_cvt_pk_bf16_f32 v96, v48, v49
  v_cvt_pk_bf16_f32 v97, v50, v51
  v_cvt_pk_bf16_f32 v98, v52, v53
  v_cvt_pk_bf16_f32 v99, v54, v55
  v_cvt_pk_bf16_f32 v100, v56, v57
  v_cvt_pk_bf16_f32 v101, v58, v59
  ds_write_b128 v3, v[96:99] offset:0
  ds_write_b64 v4, v[100:101] offset:0
  v_cvt_pk_bf16_f32 v104, v60, v61
  v_cvt_pk_bf16_f32 v105, v62, v63
  v_cvt_pk_bf16_f32 v106, v64, v65
  v_cvt_pk_bf16_f32 v107, v66, v67
  v_cvt_pk_bf16_f32 v108, v68, v69
  v_cvt_pk_bf16_f32 v109, v70, v71
  ds_write_b128 v3, v[104:107] offset:6144
  ds_write_b64 v4, v[108:109] offset:6144
  s_waitcnt vmcnt(0)
  s_barrier
  ds_read_b128 v[16:19], v5 offset:0
  ds_read_b128 v[20:23], v5 offset:20480
  ds_read_b128 v[24:27], v5 offset:1024
  ds_read_b128 v[28:31], v5 offset:21504
  ds_read_b128 v[32:35], v5 offset:2048
  ds_read_b128 v[36:39], v5 offset:22528
  s_waitcnt lgkmcnt(4)
  v_mfma_f32_16x16x32_bf16 v[48:51], a[0:3], v[16:19], 0
  ds_read_b128 v[40:43], v5 offset:3072
  v_mfma_f32_16x16x32_bf16 v[52:55], a[80:83], v[16:19], 0
  s_add_u32 m0, s13, 0
  s_add_u32 s18, s12, 0
  buffer_load_dwordx4 v2, s[4:7], s18 offen offset:0 lds
  v_mfma_f32_16x16x32_bf16 v[56:59], a[160:163], v[16:19], 0
  v_mfma_f32_16x16x32_bf16 v[60:63], a[0:3], v[20:23], 0
  ds_read_b128 v[44:47], v5 offset:23552
  v_mfma_f32_16x16x32_bf16 v[64:67], a[80:83], v[20:23], 0
  v_mfma_f32_16x16x32_bf16 v[68:71], a[160:163], v[20:23], 0
  s_waitcnt lgkmcnt(4)
  v_mfma_f32_16x16x32_bf16 v[48:51], a[4:7], v[24:27], v[48:51]
  ds_read_b128 v[16:19], v5 offset:4096
  v_mfma_f32_16x16x32_bf16 v[52:55], a[84:87], v[24:27], v[52:55]
  v_mfma_f32_16x16x32_bf16 v[56:59], a[164:167], v[24:27], v[56:59]
  v_mfma_f32_16x16x32_bf16 v[60:63], a[4:7], v[28:31], v[60:63]
  ds_read_b128 v[20:23], v5 offset:24576
  v_mfma_f32_16x16x32_bf16 v[64:67], a[84:87], v[28:31], v[64:67]
  buffer_load_dwordx4 v2, s[4:7], s18 offen offset:1024 lds
  v_mfma_f32_16x16x32_bf16 v[68:71], a[164:167], v[28:31], v[68:71]
  s_waitcnt lgkmcnt(4)
  v_mfma_f32_16x16x32_bf16 v[48:51], a[8:11], v[32:35], v[48:51]
  ds_read_b128 v[24:27], v5 offset:5120
  v_mfma_f32_16x16x32_bf16 v[52:55], a[88:91], v[32:35], v[52:55]
  v_mfma_f32_16x16x32_bf16 v[56:59], a[168:171], v[32:35], v[56:59]
  v_mfma_f32_16x16x32_bf16 v[60:63], a[8:11], v[36:39], v[60:63]
  ds_read_b128 v[28:31], v5 offset:25600
  v_mfma_f32_16x16x32_bf16 v[64:67], a[88:91], v[36:39], v[64:67]
  v_mfma_f32_16x16x32_bf16 v[68:71], a[168:171], v[36:39], v[68:71]
  s_waitcnt lgkmcnt(4)
  v_mfma_f32_16x16x32_bf16 v[48:51], a[12:15], v[40:43], v[48:51]
  ds_read_b128 v[32:35], v5 offset:6144
  v_mfma_f32_16x16x32_bf16 v[52:55], a[92:95], v[40:43], v[52:55]
  v_mfma_f32_16x16x32_bf16 v[56:59], a[172:175], v[40:43], v[56:59]
  buffer_load_dwordx4 v2, s[4:7], s18 offen offset:2048 lds
  v_mfma_f32_16x16x32_bf16 v[60:63], a[12:15], v[44:47], v[60:63]
  ds_read_b128 v[36:39], v5 offset:26624
  v_mfma_f32_16x16x32_bf16 v[64:67], a[92:95], v[44:47], v[64:67]
  v_mfma_f32_16x16x32_bf16 v[68:71], a[172:175], v[44:47], v[68:71]
  s_waitcnt lgkmcnt(4)
  v_mfma_f32_16x16x32_bf16 v[48:51], a[16:19], v[16:19], v[48:51]
  ds_read_b128 v[40:43], v5 offset:7168
  v_mfma_f32_16x16x32_bf16 v[52:55], a[96:99], v[16:19], v[52:55]
  v_mfma_f32_16x16x32_bf16 v[56:59], a[176:179], v[16:19], v[56:59]
  v_mfma_f32_16x16x32_bf16 v[60:63], a[16:19], v[20:23], v[60:63]
  ds_read_b128 v[44:47], v5 offset:27648
  v_mfma_f32_16x16x32_bf16 v[64:67], a[96:99], v[20:23], v[64:67]
  v_mfma_f32_16x16x32_bf16 v[68:71], a[176:179], v[20:23], v[68:71]
  s_waitcnt lgkmcnt(4)
  v_mfma_f32_16x16x32_bf16 v[48:51], a[20:23], v[24:27], v[48:51]
  ds_read_b128 v[16:19], v5 offset:8192
  v_mfma_f32_16x16x32_bf16 v[52:55], a[100:103], v[24:27], v[52:55]
  buffer_load_dwordx4 v2, s[4:7], s18 offen offset:3072 lds
  v_mfma_f32_16x16x32_bf16 v[56:59], a[180:183], v[24:27], v[56:59]
  v_mfma_f32_16x16x32_bf16 v[60:63], a[20:23], v[28:31], v[60:63]
  ds_read_b128 v[20:23], v5 offset:28672
  v_mfma_f32_16x16x32_bf16 v[64:67], a[100:103], v[28:31], v[64:67]
  v_mfma_f32_16x16x32_bf16 v[68:71], a[180:183], v[28:31], v[68:71]
  s_waitcnt lgkmcnt(4)
  v_mfma_f32_16x16x32_bf16 v[48:51], a[24:27], v[32:35], v[48:51]
  ds_read_b128 v[24:27], v5 offset:9216
  v_mfma_f32_16x16x32_bf16 v[52:55], a[104:107], v[32:35], v[52:55]
  v_mfma_f32_16x16x32_bf16 v[56:59], a[184:187], v[32:35], v[56:59]
  v_mfma_f32_16x16x32_bf16 v[60:63], a[24:27], v[36:39], v[60:63]
  ds_read_b128 v[28:31], v5 offset:29696
  v_mfma_f32_16x16x32_bf16 v[64:67], a[104:107], v[36:39], v[64:67]
  v_mfma_f32_16x16x32_bf16 v[68:71], a[184:187], v[36:39], v[68:71]
  s_add_u32 m0, s13, 4096
  s_add_u32 s18, s12, 4096
  buffer_load_dwordx4 v2, s[4:7], s18 offen offset:0 lds
  s_waitcnt lgkmcnt(4)
  v_mfma_f32_16x16x32_bf16 v[48:51], a[28:31], v[40:43], v[48:51]
  ds_read_b128 v[32:35], v5 offset:10240
  v_mfma_f32_16x16x32_bf16 v[52:55], a[108:111], v[40:43], v[52:55]
  v_mfma_f32_16x16x32_bf16 v[56:59], a[188:191], v[40:43], v[56:59]
  v_mfma_f32_16x16x32_bf16 v[60:63], a[28:31], v[44:47], v[60:63]
  ds_read_b128 v[36:39], v5 offset:30720
  v_mfma_f32_16x16x32_bf16 v[64:67], a[108:111], v[44:47], v[64:67]
  v_mfma_f32_16x16x32_bf16 v[68:71], a[188:191], v[44:47], v[68:71]
  s_waitcnt lgkmcnt(4)
  v_mfma_f32_16x16x32_bf16 v[48:51], a[32:35], v[16:19], v[48:51]
  ds_read_b128 v[40:43], v5 offset:11264
  v_mfma_f32_16x16x32_bf16 v[52:55], a[112:115], v[16:19], v[52:55]
  v_mfma_f32_16x16x32_bf16 v[56:59], a[192:195], v[16:19], v[56:59]
  v_mfma_f32_16x16x32_bf16 v[60:63], a[32:35], v[20:23], v[60:63]
  ds_read_b128 v[44:47], v5 offset:31744
  v_mfma_f32_16x16x32_bf16 v[64:67], a[112:115], v[20:23], v[64:67]
  buffer_load_dwordx4 v2, s[4:7], s18 offen offset:1024 lds
  v_mfma_f32_16x16x32_bf16 v[68:71], a[192:195], v[20:23], v[68:71]
  s_waitcnt lgkmcnt(4)
  v_mfma_f32_16x16x32_bf16 v[48:51], a[36:39], v[24:27], v[48:51]
  ds_read_b128 v[16:19], v5 offset:12288
  v_mfma_f32_16x16x32_bf16 v[52:55], a[116:119], v[24:27], v[52:55]
  v_mfma_f32_16x16x32_bf16 v[56:59], a[196:199], v[24:27], v[56:59]
  v_mfma_f32_16x16x32_bf16 v[60:63], a[36:39], v[28:31], v[60:63]
  ds_read_b128 v[20:23], v5 offset:32768
  v_mfma_f32_16x16x32_bf16 v[64:67], a[116:119], v[28:31], v[64:67]
  v_mfma_f32_16x16x32_bf16 v[68:71], a[196:199], v[28:31], v[68:71]
  s_waitcnt lgkmcnt(4)
  v_mfma_f32_16x16x32_bf16 v[48:51], a[40:43], v[32:35], v[48:51]
  ds_read_b128 v[24:27], v5 offset:13312
  v_mfma_f32_16x16x32_bf16 v[52:55], a[120:123], v[32:35], v[52:55]
  buffer_load_dwordx4 v2, s[4:7], s18 offen offset:2048 lds
  v_mfma_f32_16x16x32_bf16 v[56:59], a[200:203], v[32:35], v[56:59]
  v_mfma_f32_16x16x32_bf16 v[60:63], a[40:43], v[36:39], v[60:63]
  ds_read_b128 v[28:31], v5 offset:33792
  v_mfma_f32_16x16x32_bf16 v[64:67], a[120:123], v[36:39], v[64:67]
  v_mfma_f32_16x16x32_bf16 v[68:71], a[200:203], v[36:39], v[68:71]
  s_waitcnt lgkmcnt(4)
  v_mfma_f32_16x16x32_bf16 v[48:51], a[44:47], v[40:43], v[48:51]
  ds_read_b128 v[32:35], v5 offset:14336
  v_mfma_f32_16x16x32_bf16 v[52:55], a[124:127], v[40:43], v[52:55]
  v_mfma_f32_16x16x32_bf16 v[56:59], a[204:207], v[40:43], v[56:59]
  v_mfma_f32_16x16x32_bf16 v[60:63], a[44:47], v[44:47], v[60:63]
  ds_read_b128 v[36:39], v5 offset:34816
  v_mfma_f32_16x16x32_bf16 v[64:67], a[124:127], v[44:47], v[64:67]
  v_mfma_f32_16x16x32_bf16 v[68:71], a[204:207], v[44:47], v[68:71]
  buffer_load_dwordx4 v2, s[4:7], s18 offen offset:3072 lds
  s_waitcnt lgkmcnt(4)
  v_mfma_f32_16x16x32_bf16 v[48:51], a[48:51], v[16:19], v[48:51]
  ds_read_b128 v[40:43], v5 offset:15360
  v_mfma_f32_16x16x32_bf16 v[52:55], a[128:131], v[16:19], v[52:55]
  v_mfma_f32_16x16x32_bf16 v[56:59], a[208:211], v[16:19], v[56:59]
  v_mfma_f32_16x16x32_bf16 v[60:63], a[48:51], v[20:23], v[60:63]
  ds_read_b128 v[44:47], v5 offset:35840
  v_mfma_f32_16x16x32_bf16 v[64:67], a[128:131], v[20:23], v[64:67]
  v_mfma_f32_16x16x32_bf16 v[68:71], a[208:211], v[20:23], v[68:71]
  s_waitcnt lgkmcnt(4)
  v_mfma_f32_16x16x32_bf16 v[48:51], a[52:55], v[24:27], v[48:51]
  ds_read_b128 v[16:19], v5 offset:16384
  v_mfma_f32_16x16x32_bf16 v[52:55], a[132:135], v[24:27], v[52:55]
  v_mfma_f32_16x16x32_bf16 v[56:59], a[212:215], v[24:27], v[56:59]
  v_mfma_f32_16x16x32_bf16 v[60:63], a[52:55], v[28:31], v[60:63]
  ds_read_b128 v[20:23], v5 offset:36864
  v_mfma_f32_16x16x32_bf16 v[64:67], a[132:135], v[28:31], v[64:67]
  s_add_u32 m0, s13, 8192
  s_add_u32 s18, s12, 8192
  buffer_load_dwordx4 v2, s[4:7], s18 offen offset:0 lds
  v_mfma_f32_16x16x32_bf16 v[68:71], a[212:215], v[28:31], v[68:71]
  s_waitcnt lgkmcnt(4)
  v_mfma_f32_16x16x32_bf16 v[48:51], a[56:59], v[32:35], v[48:51]
  ds_read_b128 v[24:27], v5 offset:17408
  v_mfma_f32_16x16x32_bf16 v[52:55], a[136:139], v[32:35], v[52:55]
  v_mfma_f32_16x16x32_bf16 v[56:59], a[216:219], v[32:35], v[56:59]
  v_mfma_f32_16x16x32_bf16 v[60:63], a[56:59], v[36:39], v[60:63]
  ds_read_b128 v[28:31], v5 offset:37888
  v_mfma_f32_16x16x32_bf16 v[64:67], a[136:139], v[36:39], v[64:67]
  v_mfma_f32_16x16x32_bf16 v[68:71], a[216:219], v[36:39], v[68:71]
  s_waitcnt lgkmcnt(4)
  v_mfma_f32_16x16x32_bf16 v[48:51], a[60:63], v[40:43], v[48:51]
  ds_read_b128 v[32:35], v5 offset:18432
  v_mfma_f32_16x16x32_bf16 v[52:55], a[140:143], v[40:43], v[52:55]
  v_mfma_f32_16x16x32_bf16 v[56:59], a[220:223], v[40:43], v[56:59]
  buffer_load_dwordx4 v2, s[4:7], s18 offen offset:1024 lds
  v_mfma_f32_16x16x32_bf16 v[60:63], a[60:63], v[44:47], v[60:63]
  ds_read_b128 v[36:39], v5 offset:38912
  v_mfma_f32_16x16x32_bf16 v[64:67], a[140:143], v[44:47], v[64:67]
  v_mfma_f32_16x16x32_bf16 v[68:71], a[220:223], v[44:47], v[68:71]
  s_waitcnt lgkmcnt(4)
  v_mfma_f32_16x16x32_bf16 v[48:51], a[64:67], v[16:19], v[48:51]
  ds_read_b128 v[40:43], v5 offset:19456
  v_mfma_f32_16x16x32_bf16 v[52:55], a[144:147], v[16:19], v[52:55]
  v_mfma_f32_16x16x32_bf16 v[56:59], a[224:227], v[16:19], v[56:59]
  v_mfma_f32_16x16x32_bf16 v[60:63], a[64:67], v[20:23], v[60:63]
  ds_read_b128 v[44:47], v5 offset:39936
  v_mfma_f32_16x16x32_bf16 v[64:67], a[144:147], v[20:23], v[64:67]
  v_mfma_f32_16x16x32_bf16 v[68:71], a[224:227], v[20:23], v[68:71]
  s_waitcnt lgkmcnt(4)
  v_mfma_f32_16x16x32_bf16 v[48:51], a[68:71], v[24:27], v[48:51]
  v_mfma_f32_16x16x32_bf16 v[52:55], a[148:151], v[24:27], v[52:55]
  v_mfma_f32_16x16x32_bf16 v[56:59], a[228:231], v[24:27], v[56:59]
  v_mfma_f32_16x16x32_bf16 v[60:63], a[68:71], v[28:31], v[60:63]
  v_mfma_f32_16x16x32_bf16 v[64:67], a[148:151], v[28:31], v[64:67]
  v_mfma_f32_16x16x32_bf16 v[68:71], a[228:231], v[28:31], v[68:71]
  s_waitcnt lgkmcnt(2)
  v_mfma_f32_16x16x32_bf16 v[48:51], a[72:75], v[32:35], v[48:51]
  v_mfma_f32_16x16x32_bf16 v[52:55], a[152:155], v[32:35], v[52:55]
  v_mfma_f32_16x16x32_bf16 v[56:59], a[232:235], v[32:35], v[56:59]
  v_mfma_f32_16x16x32_bf16 v[60:63], a[72:75], v[36:39], v[60:63]
  v_mfma_f32_16x16x32_bf16 v[64:67], a[152:155], v[36:39], v[64:67]
  v_mfma_f32_16x16x32_bf16 v[68:71], a[232:235], v[36:39], v[68:71]
  s_waitcnt lgkmcnt(0)
  v_mfma_f32_16x16x32_bf16 v[48:51], a[76:79], v[40:43], v[48:51]
  v_mfma_f32_16x16x32_bf16 v[52:55], a[156:159], v[40:43], v[52:55]
  v_mfma_f32_16x16x32_bf16 v[56:59], a[236:239], v[40:43], v[56:59]
  v_mfma_f32_16x16x32_bf16 v[60:63], a[76:79], v[44:47], v[60:63]
  v_mfma_f32_16x16x32_bf16 v[64:67], a[156:159], v[44:47], v[64:67]
  v_mfma_f32_16x16x32_bf16 v[68:71], a[236:239], v[44:47], v[68:71]
  v_add_u32 v5, s19, v5
  s_sub_u32 s13, s13, s19
  s_sub_u32 s19, 0, s19
  s_add_u32 s12, s12, 40960
  s_add_u32 s24, s24, 1
  v_cvt_pk_bf16_f32 v96, v48, v49
  v_cvt_pk_bf16_f32 v97, v50, v51
  v_cvt_pk_bf16_f32 v98, v52, v53
  v_cvt_pk_bf16_f32 v99, v54, v55
  v_cvt_pk_bf16_f32 v100, v56, v57
  v_cvt_pk_bf16_f32 v101, v58, v59
  ds_write_b128 v3, v[96:99] offset:12288
  ds_write_b64 v4, v[100:101] offset:12288
  v_cvt_pk_bf16_f32 v104, v60, v61
  v_cvt_pk_bf16_f32 v105, v62, v63
  v_cvt_pk_bf16_f32 v106, v64, v65
  v_cvt_pk_bf16_f32 v107, v66, v67
  v_cvt_pk_bf16_f32 v108, v68, v69
  v_cvt_pk_bf16_f32 v109, v70, v71
  ds_write_b128 v3, v[104:107] offset:18432
  ds_write_b64 v4, v[108:109] offset:18432
  s_waitcnt lgkmcnt(0)
  s_barrier
  ds_read_b128 v[232:235], v12 offset:0
  ds_read_b128 v[236:239], v12 offset:1024
  ds_read_b128 v[240:243], v12 offset:2048
  ds_read_b128 v[244:247], v12 offset:3072
  ds_read_b128 v[248:251], v12 offset:4096
  ds_read_b128 v[252:255], v12 offset:5120
  s_waitcnt vmcnt(0)
mega_q_loop:
  s_waitcnt lgkmcnt(0)
  v_mov_b32 v112, v232
  v_mov_b32 v113, v233
  v_mov_b32 v114, v234
  v_mov_b32 v115, v235
  v_mov_b32 v116, v236
  v_mov_b32 v117, v237
  v_mov_b32 v118, v238
  v_mov_b32 v119, v239
  v_mov_b32 v120, v240
  v_mov_b32 v121, v241
  v_mov_b32 v122, v242
  v_mov_b32 v123, v243
  v_mov_b32 v124, v244
  v_mov_b32 v125, v245
  v_mov_b32 v126, v246
  v_mov_b32 v127, v247
  v_mov_b32 v128, v248
  v_mov_b32 v129, v249
  v_mov_b32 v130, v250
  v_mov_b32 v131, v251
  v_mov_b32 v132, v252
  v_mov_b32 v133, v253
  v_mov_b32 v134, v254
  v_mov_b32 v135, v255
  s_cmp_eq_u32 s62, 62
  s_cbranch_scc1 mega_q_last
  s_barrier
  ds_read_b128 v[16:19], v5 offset:0
  ds_read_b128 v[20:23], v5 offset:20480
  ds_read_b128 v[24:27], v5 offset:1024
  ds_read_b128 v[28:31], v5 offset:21504
  ds_read_b128 v[32:35], v5 offset:2048
  ds_read_b128 v[36:39], v5 offset:22528
  s_waitcnt lgkmcnt(4)
  v_mfma_f32_16x16x32_bf16 v[48:51], a[0:3], v[16:19], 0
  ds_read_b128 v[40:43], v5 offset:3072
  v_mfma_f32_16x16x32_bf16 v[52:55], a[80:83], v[16:19], 0
  s_add_u32 m0, s13, 0
  s_add_u32 s18, s12, 0
  buffer_load_dwordx4 v2, s[4:7], s18 offen offset:0 lds
  v_mfma_f32_16x16x32_bf16 v[56:59], a[160:163], v[16:19], 0
  v_mfma_f32_16x16x32_bf16 v[60:63], a[0:3], v[20:23], 0
  ds_read_b128 v[44:47], v5 offset:23552
  v_mfma_f32_16x16x32_bf16 v[64:67], a[80:83], v[20:23], 0
  v_mfma_f32_16x16x32_bf16 v[68:71], a[160:163], v[20:23], 0
  s_waitcnt lgkmcnt(4)
  v_mfma_f32_16x16x32_bf16 v[48:51], a[4:7], v[24:27], v[48:51]
  ds_read_b128 v[16:19], v5 offset:4096
  v_mfma_f32_16x16x32_bf16 v[52:55], a[84:87], v[24:27], v[52:55]
  v_mfma_f32_16x16x32_bf16 v[56:59], a[164:167], v[24:27], v[56:59]
  buffer_load_dwordx4 v2, s[4:7], s18 offen offset:1024 lds
  v_mfma_f32_16x16x32_bf16 v[60:63], a[4:7], v[28:31], v[60:63]
  ds_read_b128 v[20:23], v5 offset:24576
  v_mfma_f32_16x16x32_bf16 v[64:67], a[84:87], v[28:31], v[64:67]
  v_mfma_f32_16x16x32_bf16 v[68:71], a[164:167], v[28:31], v[68:71]
  s_waitcnt lgkmcnt(4)
  v_mfma_f32_16x16x32_bf16 v[48:51], a[8:11], v[32:35], v[48:51]
  ds_read_b128 v[24:27], v5 offset:5120
  v_mfma_f32_16x16x32_bf16 v[52:55], a[88:91], v[32:35], v[52:55]
  v_mfma_f32_16x16x32_bf16 v[56:59], a[168:171], v[32:35], v[56:59]
  v_mfma_f32_16x16x32_bf16 v[60:63], a[8:11], v[36:39], v[60:63]
  ds_read_b128 v[28:31], v5 offset:25600
  v_mfma_f32_16x16x32_bf16 v[64:67], a[88:91], v[36:39], v[64:67]
  v_mfma_f32_16x16x32_bf16 v[68:71], a[168:171], v[36:39], v[68:71]
  buffer_load_dwordx4 v2, s[4:7], s18 offen offset:2048 lds
  s_waitcnt lgkmcnt(4)
  v_mfma_f32_16x16x32_bf16 v[48:51], a[12:15], v[40:43], v[48:51]
  ds_read_b128 v[32:35], v5 offset:6144
  v_mfma_f32_16x16x32_bf16 v[52:55], a[92:95], v[40:43], v[52:55]
  v_mfma_f32_16x16x32_bf16 v[56:59], a[172:175], v[40:43], v[56:59]
  v_mfma_f32_16x16x32_bf16 v[60:63], a[12:15], v[44:47], v[60:63]
  ds_read_b128 v[36:39], v5 offset:26624
  v_mfma_f32_16x16x32_bf16 v[64:67], a[92:95], v[44:47], v[64:67]
  v_mfma_f32_16x16x32_bf16 v[68:71], a[172:175], v[44:47], v[68:71]
  s_waitcnt lgkmcnt(4)
  v_mfma_f32_16x16x32_bf16 v[48:51], a[16:19], v[16:19], v[48:51]
  ds_read_b128 v[40:43], v5 offset:7168
  v_mfma_f32_16x16x32_bf16 v[52:55], a[96:99], v[16:19], v[52:55]
  buffer_load_dwordx4 v2, s[4:7], s18 offen offset:3072 lds
  v_mfma_f32_16x16x32_bf16 v[56:59], a[176:179], v[16:19], v[56:59]
  v_mfma_f32_16x16x32_bf16 v[60:63], a[16:19], v[20:23], v[60:63]
  ds_read_b128 v[44:47], v5 offset:27648
  v_mfma_f32_16x16x32_bf16 v[64:67], a[96:99], v[20:23], v[64:67]
  v_mfma_f32_16x16x32_bf16 v[68:71], a[176:179], v[20:23], v[68:71]
  s_waitcnt lgkmcnt(4)
  v_mfma_f32_16x16x32_bf16 v[48:51], a[20:23], v[24:27], v[48:51]
  ds_read_b128 v[16:19], v5 offset:8192
  v_mfma_f32_16x16x32_bf16 v[52:55], a[100:103], v[24:27], v[52:55]
  v_mfma_f32_16x16x32_bf16 v[56:59], a[180:183], v[24:27], v[56:59]
  v_mfma_f32_16x16x32_bf16 v[60:63], a[20:23], v[28:31], v[60:63]
  ds_read_b128 v[20:23], v5 offset:28672
  v_mfma_f32_16x16x32_bf16 v[64:67], a[100:103], v[28:31], v[64:67]
  s_add_u32 m0, s13, 4096
  s_add_u32 s18, s12, 4096
  buffer_load_dwordx4 v2, s[4:7], s18 offen offset:0 lds
  v_mfma_f32_16x16x32_bf16 v[68:71], a[180:183], v[28:31], v[68:71]
  s_waitcnt lgkmcnt(4)
  v_mfma_f32_16x16x32_bf16 v[48:51], a[24:27], v[32:35], v[48:51]
  ds_read_b128 v[24:27], v5 offset:9216
  v_mfma_f32_16x16x32_bf16 v[52:55], a[104:107], v[32:35], v[52:55]
  v_mfma_f32_16x16x32_bf16 v[56:59], a[184:187], v[32:35], v[56:59]
  v_mfma_f32_16x16x32_bf16 v[60:63], a[24:27], v[36:39], v[60:63]
  ds_read_b128 v[28:31], v5 offset:29696
  v_mfma_f32_16x16x32_bf16 v[64:67], a[104:107], v[36:39], v[64:67]
  v_mfma_f32_16x16x32_bf16 v[68:71], a[184:187], v[36:39], v[68:71]
  s_waitcnt lgkmcnt(4)
  v_mfma_f32_16x16x32_bf16 v[48:51], a[28:31], v[40:43], v[48:51]
  ds_read_b128 v[32:35], v5 offset:10240
  v_mfma_f32_16x16x32_bf16 v[52:55], a[108:111], v[40:43], v[52:55]
  buffer_load_dwordx4 v2, s[4:7], s18 offen offset:1024 lds
  v_mfma_f32_16x16x32_bf16 v[56:59], a[188:191], v[40:43], v[56:59]
  v_mfma_f32_16x16x32_bf16 v[60:63], a[28:31], v[44:47], v[60:63]
  ds_read_b128 v[36:39], v5 offset:30720
  v_mfma_f32_16x16x32_bf16 v[64:67], a[108:111], v[44:47], v[64:67]
  v_mfma_f32_16x16x32_bf16 v[68:71], a[188:191], v[44:47], v[68:71]
  s_waitcnt lgkmcnt(4)
  v_mfma_f32_16x16x32_bf16 v[48:51], a[32:35], v[16:19], v[48:51]
  ds_read_b128 v[40:43], v5 offset:11264
  v_mfma_f32_16x16x32_bf16 v[52:55], a[112:115], v[16:19], v[52:55]
  v_mfma_f32_16x16x32_bf16 v[56:59], a[192:195], v[16:19], v[56:59]
  buffer_load_dwordx4 v2, s[4:7], s18 offen offset:2048 lds
  v_mfma_f32_16x16x32_bf16 v[60:63], a[32:35], v[20:23], v[60:63]
  ds_read_b128 v[44:47], v5 offset:31744
  v_mfma_f32_16x16x32_bf16 v[64:67], a[112:115], v[20:23], v[64:67]
  v_mfma_f32_16x16x32_bf16 v[68:71], a[192:195], v[20:23], v[68:71]
  s_waitcnt lgkmcnt(4)
  v_mfma_f32_16x16x32_bf16 v[48:51], a[36:39], v[24:27], v[48:51]
  ds_read_b128 v[16:19], v5 offset:12288
  v_mfma_f32_16x16x32_bf16 v[52:55], a[116:119], v[24:27], v[52:55]
  v_mfma_f32_16x16x32_bf16 v[56:59], a[196:199], v[24:27], v[56:59]
  v_mfma_f32_16x16x32_bf16 v[60:63], a[36:39], v[28:31], v[60:63]
  ds_read_b128 v[20:23], v5 offset:32768
  v_mfma_f32_16x16x32_bf16 v[64:67], a[116:119], v[28:31], v[64:67]
  v_mfma_f32_16x16x32_bf16 v[68:71], a[196:199], v[28:31], v[68:71]
  buffer_load_dwordx4 v2, s[4:7], s18 offen offset:3072 lds
  s_waitcnt lgkmcnt(4)
  v_mfma_f32_16x16x32_bf16 v[48:51], a[40:43], v[32:35], v[48:51]
  ds_read_b128 v[24:27], v5 offset:13312
  v_mfma_f32_16x16x32_bf16 v[52:55], a[120:123], v[32:35], v[52:55]
  v_mfma_f32_16x16x32_bf16 v[56:59], a[200:203], v[32:35], v[56:59]
  v_mfma_f32_16x16x32_bf16 v[60:63], a[40:43], v[36:39], v[60:63]
  ds_read_b128 v[28:31], v5 offset:33792
  v_mfma_f32_16x16x32_bf16 v[64:67], a[120:123], v[36:39], v[64:67]
  v_mfma_f32_16x16x32_bf16 v[68:71], a[200:203], v[36:39], v[68:71]
  s_waitcnt lgkmcnt(4)
  v_mfma_f32_16x16x32_bf16 v[48:51], a[44:47], v[40:43], v[48:51]
  ds_read_b128 v[32:35], v5 offset:14336
  v_mfma_f32_16x16x32_bf16 v[52:55], a[124:127], v[40:43], v[52:55]
  s_add_u32 m0, s13, 8192
  s_add_u32 s18, s12, 8192
  buffer_load_dwordx4 v2, s[4:7], s18 offen offset:0 lds
  v_mfma_f32_16x16x32_bf16 v[56:59], a[204:207], v[40:43], v[56:59]
  v_mfma_f32_16x16x32_bf16 v[60:63], a[44:47], v[44:47], v[60:63]
  ds_read_b128 v[36:39], v5 offset:34816
  v_mfma_f32_16x16x32_bf16 v[64:67], a[124:127], v[44:47], v[64:67]
  v_mfma_f32_16x16x32_bf16 v[68:71], a[204:207], v[44:47], v[68:71]
  s_waitcnt lgkmcnt(4)
  v_mfma_f32_16x16x32_bf16 v[48:51], a[48:51], v[16:19], v[48:51]
  ds_read_b128 v[40:43], v5 offset:15360
  v_mfma_f32_16x16x32_bf16 v[52:55], a[128:131], v[16:19], v[52:55]
  v_mfma_f32_16x16x32_bf16 v[56:59], a[208:211], v[16:19], v[56:59]
  v_mfma_f32_16x16x32_bf16 v[60:63], a[48:51], v[20:23], v[60:63]
  ds_read_b128 v[44:47], v5 offset:35840
  v_mfma_f32_16x16x32_bf16 v[64:67], a[128:131], v[20:23], v[64:67]
  buffer_load_dwordx4 v2, s[4:7], s18 offen offset:1024 lds
  v_mfma_f32_16x16x32_bf16 v[68:71], a[208:211], v[20:23], v[68:71]
  s_waitcnt lgkmcnt(4)
  v_mfma_f32_16x16x32_bf16 v[48:51], a[52:55], v[24:27], v[48:51]
  ds_read_b128 v[16:19], v5 offset:16384
  v_mfma_f32_16x16x32_bf16 v[52:55], a[132:135], v[24:27], v[52:55]
  v_mfma_f32_16x16x32_bf16 v[56:59], a[212:215], v[24:27], v[56:59]
  v_mfma_f32_16x16x32_bf16 v[60:63], a[52:55], v[28:31], v[60:63]
  ds_read_b128 v[20:23], v5 offset:36864
  v_mfma_f32_16x16x32_bf16 v[64:67], a[132:135], v[28:31], v[64:67]
  v_mfma_f32_16x16x32_bf16 v[68:71], a[212:215], v[28:31], v[68:71]
  s_waitcnt lgkmcnt(4)
  v_mfma_f32_16x16x32_bf16 v[48:51], a[56:59], v[32:35], v[48:51]
  ds_read_b128 v[24:27], v5 offset:17408
  v_mfma_f32_16x16x32_bf16 v[52:55], a[136:139], v[32:35], v[52:55]
  buffer_load_dword v86, v84, s[4:7], s71 offen sc1
  v_mfma_f32_16x16x32_bf16 v[56:59], a[216:219], v[32:35], v[56:59]
  v_mfma_f32_16x16x32_bf16 v[60:63], a[56:59], v[36:39], v[60:63]
  ds_read_b128 v[28:31], v5 offset:37888
  v_mfma_f32_16x16x32_bf16 v[64:67], a[136:139], v[36:39], v[64:67]
  v_mfma_f32_16x16x32_bf16 v[68:71], a[216:219], v[36:39], v[68:71]
  s_waitcnt lgkmcnt(4)
  v_mfma_f32_16x16x32_bf16 v[48:51], a[60:63], v[40:43], v[48:51]
  ds_read_b128 v[32:35], v5 offset:18432
  v_mfma_f32_16x16x32_bf16 v[52:55], a[140:143], v[40:43], v[52:55]
  v_mfma_f32_16x16x32_bf16 v[56:59], a[220:223], v[40:43], v[56:59]
  v_mfma_f32_16x16x32_bf16 v[60:63], a[60:63], v[44:47], v[60:63]
  ds_read_b128 v[36:39], v5 offset:38912
  v_mfma_f32_16x16x32_bf16 v[64:67], a[140:143], v[44:47], v[64:67]
  v_mfma_f32_16x16x32_bf16 v[68:71], a[220:223], v[44:47], v[68:71]
  s_waitcnt lgkmcnt(4)
  v_mfma_f32_16x16x32_bf16 v[48:51], a[64:67], v[16:19], v[48:51]
  ds_read_b128 v[40:43], v5 offset:19456
  v_mfma_f32_16x16x32_bf16 v[52:55], a[144:147], v[16:19], v[52:55]
  v_mfma_f32_16x16x32_bf16 v[56:59], a[224:227], v[16:19], v[56:59]
  v_mfma_f32_16x16x32_bf16 v[60:63], a[64:67], v[20:23], v[60:63]
  ds_read_b128 v[44:47], v5 offset:39936
  v_mfma_f32_16x16x32_bf16 v[64:67], a[144:147], v[20:23], v[64:67]
  v_mfma_f32_16x16x32_bf16 v[68:71], a[224:227], v[20:23], v[68:71]
  s_waitcnt lgkmcnt(4)
  v_mfma_f32_16x16x32_bf16 v[48:51], a[68:71], v[24:27], v[48:51]
  v_mfma_f32_16x16x32_bf16 v[52:55], a[148:151], v[24:27], v[52:55]
  v_mfma_f32_16x16x32_bf16 v[56:59], a[228:231], v[24:27], v[56:59]
  v_mfma_f32_16x16x32_bf16 v[60:63], a[68:71], v[28:31], v[60:63]
  v_mfma_f32_16x16x32_bf16 v[64:67], a[148:151], v[28:31], v[64:67]
  v_mfma_f32_16x16x32_bf16 v[68:71], a[228:231], v[28:31], v[68:71]
  s_waitcnt lgkmcnt(2)
  v_mfma_f32_16x16x32_bf16 v[48:51], a[72:75], v[32:35], v[48:51]
  v_mfma_f32_16x16x32_bf16 v[52:55], a[152:155], v[32:35], v[52:55]
  v_mfma_f32_16x16x32_bf16 v[56:59], a[232:235], v[32:35], v[56:59]
  v_mfma_f32_16x16x32_bf16 v[60:63], a[72:75], v[36:39], v[60:63]
  v_mfma_f32_16x16x32_bf16 v[64:67], a[152:155], v[36:39], v[64:67]
  v_mfma_f32_16x16x32_bf16 v[68:71], a[232:235], v[36:39], v[68:71]
  s_waitcnt lgkmcnt(0)
  v_mfma_f32_16x16x32_bf16 v[48:51], a[76:79], v[40:43], v[48:51]
  v_mfma_f32_16x16x32_bf16 v[52:55], a[156:159], v[40:43], v[52:55]
  v_mfma_f32_16x16x32_bf16 v[56:59], a[236:239], v[40:43], v[56:59]
  v_mfma_f32_16x16x32_bf16 v[60:63], a[76:79], v[44:47], v[60:63]
  v_mfma_f32_16x16x32_bf16 v[64:67], a[156:159], v[44:47], v[64:67]
  v_mfma_f32_16x16x32_bf16 v[68:71], a[236:239], v[44:47], v[68:71]
  v_add_u32 v5, s19, v5
  s_sub_u32 s13, s13, s19
  s_sub_u32 s19, 0, s19
  s_add_u32 s12, s12, 40960
  s_add_u32 s24, s24, 1
  v_cvt_pk_bf16_f32 v96, v48, v49
  v_cvt_pk_bf16_f32 v97, v50, v51
  v_cvt_pk_bf16_f32 v98, v52, v53
  v_cvt_pk_bf16_f32 v99, v54, v55
  v_cvt_pk_bf16_f32 v100, v56, v57
  v_cvt_pk_bf16_f32 v101, v58, v59
  ds_write_b128 v3, v[96:99] offset:0
  ds_write_b64 v4, v[100:101] offset:0
  v_cvt_pk_bf16_f32 v104, v60, v61
  v_cvt_pk_bf16_f32 v105, v62, v63
  v_cvt_pk_bf16_f32 v106, v64, v65
  v_cvt_pk_bf16_f32 v107, v66, v67
  v_cvt_pk_bf16_f32 v108, v68, v69
  v_cvt_pk_bf16_f32 v109, v70, v71
  ds_write_b128 v3, v[104:107] offset:6144
  ds_write_b64 v4, v[108:109] offset:6144
  s_waitcnt vmcnt(0)
  s_add_u32 s52, s26, s20
  s_add_u32 s53, s52, 4096
  s_add_u32 s54, s52, 8192
  s_mov_b32 s30, 0
  s_branch mega0_kernel_pv13_t
mega0_kernel_pv13:
  buffer_load_dword v86, v84, s[4:7], s71 offen sc1
  s_waitcnt vmcnt(0)
mega0_kernel_pv13_t:
  v_cmp_gt_u32 vcc, s60, v86
  s_nop 0
  s_cbranch_vccz mega0_kernel_pv13_ok
  s_sleep 2
  s_add_u32 s30, s30, 1
  s_cmp_lt_u32 s30, 262144
  s_cbranch_scc1 mega0_kernel_pv13
  s_branch mega_fail
mega0_kernel_pv13_ok:
  s_barrier
  ds_read_b128 v[16:19], v5 offset:0
  ds_read_b128 v[20:23], v5 offset:20480
  ds_read_b128 v[24:27], v5 offset:1024
  ds_read_b128 v[28:31], v5 offset:21504
  ds_read_b128 v[32:35], v5 offset:2048
  ds_read_b128 v[36:39], v5 offset:22528
  s_waitcnt lgkmcnt(4)
  v_mfma_f32_16x16x32_bf16 v[48:51], a[0:3], v[16:19], 0
  ds_read_b128 v[40:43], v5 offset:3072
  v_mfma_f32_16x16x32_bf16 v[52:55], a[80:83], v[16:19], 0
  s_add_u32 m0, s13, 0
  s_add_u32 s18, s12, 0
  buffer_load_dwordx4 v2, s[4:7], s18 offen offset:0 lds
  v_mfma_f32_16x16x32_bf16 v[56:59], a[160:163], v[16:19], 0
  v_mfma_f32_16x16x32_bf16 v[60:63], a[0:3], v[20:23], 0
  ds_read_b128 v[44:47], v5 offset:23552
  v_mfma_f32_16x16x32_bf16 v[64:67], a[80:83], v[20:23], 0
  buffer_load_dwordx4 v[136:139], v2, s[4:7], s52 offen offset:0 sc1
  v_mfma_f32_16x16x32_bf16 v[68:71], a[160:163], v[20:23], 0
  s_waitcnt lgkmcnt(4)
  v_mfma_f32_16x16x32_bf16 v[48:51], a[4:7], v[24:27], v[48:51]
  ds_read_b128 v[16:19], v5 offset:4096
  v_mfma_f32_16x16x32_bf16 v[52:55], a[84:87], v[24:27], v[52:55]
  v_mfma_f32_16x16x32_bf16 v[56:59], a[164:167], v[24:27], v[56:59]
  buffer_load_dwordx4 v2, s[4:7], s18 offen offset:1024 lds
  v_mfma_f32_16x16x32_bf16 v[60:63], a[4:7], v[28:31], v[60:63]
  ds_read_b128 v[20:23], v5 offset:24576
  v_mfma_f32_16x16x32_bf16 v[64:67], a[84:87], v[28:31], v[64:67]
  v_mfma_f32_16x16x32_bf16 v[68:71], a[164:167], v[28:31], v[68:71]
  buffer_load_dwordx4 v[140:143], v2, s[4:7], s52 offen offset:1024 sc1
  s_waitcnt lgkmcnt(4)
  v_mfma_f32_16x16x32_bf16 v[48:51], a[8:11], v[32:35], v[48:51]
  ds_read_b128 v[24:27], v5 offset:5120
  v_mfma_f32_16x16x32_bf16 v[52:55], a[88:91], v[32:35], v[52:55]
  v_mfma_f32_16x16x32_bf16 v[56:59], a[168:171], v[32:35], v[56:59]
  v_mfma_f32_16x16x32_bf16 v[60:63], a[8:11], v[36:39], v[60:63]
  ds_read_b128 v[28:31], v5 offset:25600
  v_mfma_f32_16x16x32_bf16 v[64:67], a[88:91], v[36:39], v[64:67]
  buffer_load_dwordx4 v[144:147], v2, s[4:7], s52 offen offset:2048 sc1
  v_mfma_f32_16x16x32_bf16 v[68:71], a[168:171], v[36:39], v[68:71]
  s_waitcnt lgkmcnt(4)
  v_mfma_f32_16x16x32_bf16 v[48:51], a[12:15], v[40:43], v[48:51]
  ds_read_b128 v[32:35], v5 offset:6144
  v_mfma_f32_16x16x32_bf16 v[52:55], a[92:95], v[40:43], v[52:55]
  v_mfma_f32_16x16x32_bf16 v[56:59], a[172:175], v[40:43], v[56:59]
  buffer_load_dwordx4 v2, s[4:7], s18 offen offset:2048 lds
  v_mfma_f32_16x16x32_bf16 v[60:63], a[12:15], v[44:47], v[60:63]
  ds_read_b128 v[36:39], v5 offset:26624
  v_mfma_f32_16x16x32_bf16 v[64:67], a[92:95], v[44:47], v[64:67]
  v_mfma_f32_16x16x32_bf16 v[68:71], a[172:175], v[44:47], v[68:71]
  buffer_load_dwordx4 v[148:151], v2, s[4:7], s52 offen offset:3072 sc1
  s_waitcnt lgkmcnt(4)
  v_mfma_f32_16x16x32_bf16 v[48:51], a[16:19], v[16:19], v[48:51]
  ds_read_b128 v[40:43], v5 offset:7168
  v_mfma_f32_16x16x32_bf16 v[52:55], a[96:99], v[16:19], v[52:55]
  v_mfma_f32_16x16x32_bf16 v[56:59], a[176:179], v[16:19], v[56:59]
  v_mfma_f32_16x16x32_bf16 v[60:63], a[16:19], v[20:23], v[60:63]
  ds_read_b128 v[44:47], v5 offset:27648
  v_mfma_f32_16x16x32_bf16 v[64:67], a[96:99], v[20:23], v[64:67]
  buffer_load_dwordx2 v[152:153], v2, s[4:7], s54 offen offset:0 sc1
  v_mfma_f32_16x16x32_bf16 v[68:71], a[176:179], v[20:23], v[68:71]
  s_waitcnt lgkmcnt(4)
  v_mfma_f32_16x16x32_bf16 v[48:51], a[20:23], v[24:27], v[48:51]
  ds_read_b128 v[16:19], v5 offset:8192
  v_mfma_f32_16x16x32_bf16 v[52:55], a[100:103], v[24:27], v[52:55]
  buffer_load_dwordx4 v2, s[4:7], s18 offen offset:3072 lds
  v_mfma_f32_16x16x32_bf16 v[56:59], a[180:183], v[24:27], v[56:59]
  v_mfma_f32_16x16x32_bf16 v[60:63], a[20:23], v[28:31], v[60:63]
  ds_read_b128 v[20:23], v5 offset:28672
  v_mfma_f32_16x16x32_bf16 v[64:67], a[100:103], v[28:31], v[64:67]
  v_mfma_f32_16x16x32_bf16 v[68:71], a[180:183], v[28:31], v[68:71]
  buffer_load_dwordx2 v[154:155], v2, s[4:7], s54 offen offset:1024 sc1
  s_waitcnt lgkmcnt(4)
  v_mfma_f32_16x16x32_bf16 v[48:51], a[24:27], v[32:35], v[48:51]
  ds_read_b128 v[24:27], v5 offset:9216
  v_mfma_f32_16x16x32_bf16 v[52:55], a[104:107], v[32:35], v[52:55]
  v_mfma_f32_16x16x32_bf16 v[56:59], a[184:187], v[32:35], v[56:59]
  v_mfma_f32_16x16x32_bf16 v[60:63], a[24:27], v[36:39], v[60:63]
  ds_read_b128 v[28:31], v5 offset:29696
  v_mfma_f32_16x16x32_bf16 v[64:67], a[104:107], v[36:39], v[64:67]
  s_add_u32 m0, s13, 4096
  s_add_u32 s18, s12, 4096
  buffer_load_dwordx4 v2, s[4:7], s18 offen offset:0 lds
  v_mfma_f32_16x16x32_bf16 v[68:71], a[184:187], v[36:39], v[68:71]
  s_waitcnt lgkmcnt(4)
  v_mfma_f32_16x16x32_bf16 v[48:51], a[28:31], v[40:43], v[48:51]
  ds_read_b128 v[32:35], v5 offset:10240
  v_mfma_f32_16x16x32_bf16 v[52:55], a[108:111], v[40:43], v[52:55]
  buffer_load_dwordx2 v[156:157], v2, s[4:7], s54 offen offset:2048 sc1
  v_mfma_f32_16x16x32_bf16 v[56:59], a[188:191], v[40:43], v[56:59]
  v_mfma_f32_16x16x32_bf16 v[60:63], a[28:31], v[44:47], v[60:63]
  ds_read_b128 v[36:39], v5 offset:30720
  v_mfma_f32_16x16x32_bf16 v[64:67], a[108:111], v[44:47], v[64:67]
  v_mfma_f32_16x16x32_bf16 v[68:71], a[188:191], v[44:47], v[68:71]
  buffer_load_dwordx2 v[158:159], v2, s[4:7], s54 offen offset:3072 sc1
  s_waitcnt lgkmcnt(4)
  v_mfma_f32_16x16x32_bf16 v[48:51], a[32:35], v[16:19], v[48:51]
  ds_read_b128 v[40:43], v5 offset:11264
  v_mfma_f32_16x16x32_bf16 v[52:55], a[112:115], v[16:19], v[52:55]
  v_mfma_f32_16x16x32_bf16 v[56:59], a[192:195], v[16:19], v[56:59]
  v_mfma_f32_16x16x32_bf16 v[60:63], a[32:35], v[20:23], v[60:63]
  ds_read_b128 v[44:47], v5 offset:31744
  v_mfma_f32_16x16x32_bf16 v[64:67], a[112:115], v[20:23], v[64:67]
  buffer_load_dwordx4 v2, s[4:7], s18 offen offset:1024 lds
  v_mfma_f32_16x16x32_bf16 v[68:71], a[192:195], v[20:23], v[68:71]
  s_waitcnt lgkmcnt(4)
  v_mfma_f32_16x16x32_bf16 v[48:51], a[36:39], v[24:27], v[48:51]
  ds_read_b128 v[16:19], v5 offset:12288
  v_mfma_f32_16x16x32_bf16 v[52:55], a[116:119], v[24:27], v[52:55]
  buffer_load_dwordx4 v[160:163], v2, s[4:7], s53 offen offset:0 sc1
  v_mfma_f32_16x16x32_bf16 v[56:59], a[196:199], v[24:27], v[56:59]
  v_mfma_f32_16x16x32_bf16 v[60:63], a[36:39], v[28:31], v[60:63]
  ds_read_b128 v[20:23], v5 offset:32768
  v_mfma_f32_16x16x32_bf16 v[64:67], a[116:119], v[28:31], v[64:67]
  v_mfma_f32_16x16x32_bf16 v[68:71], a[196:199], v[28:31], v[68:71]
  buffer_load_dwordx4 v[164:167], v2, s[4:7], s53 offen offset:1024 sc1
  s_waitcnt lgkmcnt(4)
  v_mfma_f32_16x16x32_bf16 v[48:51], a[40:43], v[32:35], v[48:51]
  ds_read_b128 v[24:27], v5 offset:13312
  v_mfma_f32_16x16x32_bf16 v[52:55], a[120:123], v[32:35], v[52:55]
  v_mfma_f32_16x16x32_bf16 v[56:59], a[200:203], v[32:35], v[56:59]
  buffer_load_dwordx4 v2, s[4:7], s18 offen offset:2048 lds
  v_mfma_f32_16x16x32_bf16 v[60:63], a[40:43], v[36:39], v[60:63]
  ds_read_b128 v[28:31], v5 offset:33792
  v_mfma_f32_16x16x32_bf16 v[64:67], a[120:123], v[36:39], v[64:67]
  v_mfma_f32_16x16x32_bf16 v[68:71], a[200:203], v[36:39], v[68:71]
  s_waitcnt lgkmcnt(4)
  v_mfma_f32_16x16x32_bf16 v[48:51], a[44:47], v[40:43], v[48:51]
  ds_read_b128 v[32:35], v5 offset:14336
  v_mfma_f32_16x16x32_bf16 v[52:55], a[124:127], v[40:43], v[52:55]
  buffer_load_dwordx4 v[168:171], v2, s[4:7], s53 offen offset:2048 sc1
  v_mfma_f32_16x16x32_bf16 v[56:59], a[204:207], v[40:43], v[56:59]
  v_mfma_f32_16x16x32_bf16 v[60:63], a[44:47], v[44:47], v[60:63]
  ds_read_b128 v[36:39], v5 offset:34816
  v_mfma_f32_16x16x32_bf16 v[64:67], a[124:127], v[44:47], v[64:67]
  v_mfma_f32_16x16x32_bf16 v[68:71], a[204:207], v[44:47], v[68:71]
  buffer_load_dwordx4 v2, s[4:7], s18 offen offset:3072 lds
  s_waitcnt lgkmcnt(4)
  v_mfma_f32_16x16x32_bf16 v[48:51], a[48:51], v[16:19], v[48:51]
  ds_read_b128 v[40:43], v5 offset:15360
  v_mfma_f32_16x16x32_bf16 v[52:55], a[128:131], v[16:19], v[52:55]
  v_mfma_f32_16x16x32_bf16 v[56:59], a[208:211], v[16:19], v[56:59]
  buffer_load_dwordx4 v[172:175], v2, s[4:7], s53 offen offset:3072 sc1
  v_mfma_f32_16x16x32_bf16 v[60:63], a[48:51], v[20:23], v[60:63]
  ds_read_b128 v[44:47], v5 offset:35840
  v_mfma_f32_16x16x32_bf16 v[64:67], a[128:131], v[20:23], v[64:67]
  v_mfma_f32_16x16x32_bf16 v[68:71], a[208:211], v[20:23], v[68:71]
  s_waitcnt lgkmcnt(4)
  v_mfma_f32_16x16x32_bf16 v[48:51], a[52:55], v[24:27], v[48:51]
  ds_read_b128 v[16:19], v5 offset:16384
  v_mfma_f32_16x16x32_bf16 v[52:55], a[132:135], v[24:27], v[52:55]
  buffer_load_dwordx2 v[176:177], v2, s[4:7], s54 offen offset:8 sc1
  v_mfma_f32_16x16x32_bf16 v[56:59], a[212:215], v[24:27], v[56:59]
  v_mfma_f32_16x16x32_bf16 v[60:63], a[52:55], v[28:31], v[60:63]
  ds_read_b128 v[20:23], v5 offset:36864
  v_mfma_f32_16x16x32_bf16 v[64:67], a[132:135], v[28:31], v[64:67]
  s_add_u32 m0, s13, 8192
  s_add_u32 s18, s12, 8192
  buffer_load_dwordx4 v2, s[4:7], s18 offen offset:0 lds
  v_mfma_f32_16x16x32_bf16 v[68:71], a[212:215], v[28:31], v[68:71]
  s_waitcnt lgkmcnt(4)
  v_mfma_f32_16x16x32_bf16 v[48:51], a[56:59], v[32:35], v[48:51]
  ds_read_b128 v[24:27], v5 offset:17408
  v_mfma_f32_16x16x32_bf16 v[52:55], a[136:139], v[32:35], v[52:55]
  v_mfma_f32_16x16x32_bf16 v[56:59], a[216:219], v[32:35], v[56:59]
  buffer_load_dwordx2 v[178:179], v2, s[4:7], s54 offen offset:1032 sc1
  v_mfma_f32_16x16x32_bf16 v[60:63], a[56:59], v[36:39], v[60:63]
  ds_read_b128 v[28:31], v5 offset:37888
  v_mfma_f32_16x16x32_bf16 v[64:67], a[136:139], v[36:39], v[64:67]
  v_mfma_f32_16x16x32_bf16 v[68:71], a[216:219], v[36:39], v[68:71]
  s_waitcnt lgkmcnt(4)
  v_mfma_f32_16x16x32_bf16 v[48:51], a[60:63], v[40:43], v[48:51]
  ds_read_b128 v[32:35], v5 offset:18432
  v_mfma_f32_16x16x32_bf16 v[52:55], a[140:143], v[40:43], v[52:55]
  buffer_load_dwordx2 v[180:181], v2, s[4:7], s54 offen offset:2056 sc1
  v_mfma_f32_16x16x32_bf16 v[56:59], a[220:223], v[40:43], v[56:59]
  v_mfma_f32_16x16x32_bf16 v[60:63], a[60:63], v[44:47], v[60:63]
  ds_read_b128 v[36:39], v5 offset:38912
  v_mfma_f32_16x16x32_bf16 v[64:67], a[140:143], v[44:47], v[64:67]
  buffer_load_dwordx4 v2, s[4:7], s18 offen offset:1024 lds
  v_mfma_f32_16x16x32_bf16 v[68:71], a[220:223], v[44:47], v[68:71]
  s_waitcnt lgkmcnt(4)
  v_mfma_f32_16x16x32_bf16 v[48:51], a[64:67], v[16:19], v[48:51]
  ds_read_b128 v[40:43], v5 offset:19456
  v_mfma_f32_16x16x32_bf16 v[52:55], a[144:147], v[16:19], v[52:55]
  v_mfma_f32_16x16x32_bf16 v[56:59], a[224:227], v[16:19], v[56:59]
  buffer_load_dwordx2 v[182:183], v2, s[4:7], s54 offen offset:3080 sc1
  v_mfma_f32_16x16x32_bf16 v[60:63], a[64:67], v[20:23], v[60:63]
  ds_read_b128 v[44:47], v5 offset:39936
  v_mfma_f32_16x16x32_bf16 v[64:67], a[144:147], v[20:23], v[64:67]
  v_mfma_f32_16x16x32_bf16 v[68:71], a[224:227], v[20:23], v[68:71]
  s_waitcnt lgkmcnt(4)
  v_mfma_f32_16x16x32_bf16 v[48:51], a[68:71], v[24:27], v[48:51]
  v_mfma_f32_16x16x32_bf16 v[52:55], a[148:151], v[24:27], v[52:55]
  v_mfma_f32_16x16x32_bf16 v[56:59], a[228:231], v[24:27], v[56:59]
  v_mfma_f32_16x16x32_bf16 v[60:63], a[68:71], v[28:31], v[60:63]
  v_mfma_f32_16x16x32_bf16 v[64:67], a[148:151], v[28:31], v[64:67]
  v_mfma_f32_16x16x32_bf16 v[68:71], a[228:231], v[28:31], v[68:71]
  s_waitcnt lgkmcnt(2)
  v_mfma_f32_16x16x32_bf16 v[48:51], a[72:75], v[32:35], v[48:51]
  v_mfma_f32_16x16x32_bf16 v[52:55], a[152:155], v[32:35], v[52:55]
  v_mfma_f32_16x16x32_bf16 v[56:59], a[232:235], v[32:35], v[56:59]
  v_mfma_f32_16x16x32_bf16 v[60:63], a[72:75], v[36:39], v[60:63]
  v_mfma_f32_16x16x32_bf16 v[64:67], a[152:155], v[36:39], v[64:67]
  v_mfma_f32_16x16x32_bf16 v[68:71], a[232:235], v[36:39], v[68:71]
  s_waitcnt lgkmcnt(0)
  v_mfma_f32_16x16x32_bf16 v[48:51], a[76:79], v[40:43], v[48:51]
  v_mfma_f32_16x16x32_bf16 v[52:55], a[156:159], v[40:43], v[52:55]
  v_mfma_f32_16x16x32_bf16 v[56:59], a[236:239], v[40:43], v[56:59]
  v_mfma_f32_16x16x32_bf16 v[60:63], a[76:79], v[44:47], v[60:63]
  v_mfma_f32_16x16x32_bf16 v[64:67], a[156:159], v[44:47], v[64:67]
  v_mfma_f32_16x16x32_bf16 v[68:71], a[236:239], v[44:47], v[68:71]
  v_add_u32 v5, s19, v5
  s_sub_u32 s13, s13, s19
  s_sub_u32 s19, 0, s19
  s_add_u32 s12, s12, 40960
  s_add_u32 s24, s24, 1
  v_cvt_pk_bf16_f32 v96, v48, v49
  v_cvt_pk_bf16_f32 v97, v50, v51
  v_cvt_pk_bf16_f32 v98, v52, v53
  v_cvt_pk_bf16_f32 v99, v54, v55
  v_cvt_pk_bf16_f32 v100, v56, v57
  v_cvt_pk_bf16_f32 v101, v58, v59
  ds_write_b128 v3, v[96:99] offset:12288
  ds_write_b64 v4, v[100:101] offset:12288
  v_cvt_pk_bf16_f32 v104, v60, v61
  v_cvt_pk_bf16_f32 v105, v62, v63
  v_cvt_pk_bf16_f32 v106, v64, v65
  v_cvt_pk_bf16_f32 v107, v66, v67
  v_cvt_pk_bf16_f32 v108, v68, v69
  v_cvt_pk_bf16_f32 v109, v70, v71
  ds_write_b128 v3, v[104:107] offset:18432
  ds_write_b64 v4, v[108:109] offset:18432
  s_waitcnt lgkmcnt(0)
  s_barrier
  ds_read_b128 v[232:235], v12 offset:0
  ds_read_b128 v[236:239], v12 offset:1024
  ds_read_b128 v[240:243], v12 offset:2048
  ds_read_b128 v[244:247], v12 offset:3072
  ds_read_b128 v[248:251], v12 offset:4096
  ds_read_b128 v[252:255], v12 offset:5120
  s_branch mega_q_sc
mega_q_last:
  s_add_u32 s52, s26, s20
  s_add_u32 s53, s52, 4096
  s_add_u32 s54, s52, 8192
  s_mov_b32 s30, 0
mega0_kernel_pv14:
  buffer_load_dword v86, v84, s[4:7], s71 offen sc1
  s_waitcnt vmcnt(0)
mega0_kernel_pv14_t:
  v_cmp_gt_u32 vcc, s60, v86
  s_nop 0
  s_cbranch_vccz mega0_kernel_pv14_ok
  s_sleep 2
  s_add_u32 s30, s30, 1
  s_cmp_lt_u32 s30, 262144
  s_cbranch_scc1 mega0_kernel_pv14
  s_branch mega_fail
mega0_kernel_pv14_ok:
  buffer_load_dwordx4 v[136:139], v2, s[4:7], s52 offen offset:0 sc1
  buffer_load_dwordx4 v[140:143], v2, s[4:7], s52 offen offset:1024 sc1
  buffer_load_dwordx4 v[144:147], v2, s[4:7], s52 offen offset:2048 sc1
  buffer_load_dwordx4 v[148:151], v2, s[4:7], s52 offen offset:3072 sc1
  buffer_load_dwordx2 v[152:153], v2, s[4:7], s54 offen offset:0 sc1
  buffer_load_dwordx2 v[154:155], v2, s[4:7], s54 offen offset:1024 sc1
  buffer_load_dwordx2 v[156:157], v2, s[4:7], s54 offen offset:2048 sc1
  buffer_load_dwordx2 v[158:159], v2, s[4:7], s54 offen offset:3072 sc1
  buffer_load_dwordx4 v[160:163], v2, s[4:7], s53 offen offset:0 sc1
  buffer_load_dwordx4 v[164:167], v2, s[4:7], s53 offen offset:1024 sc1
  buffer_load_dwordx4 v[168:171], v2, s[4:7], s53 offen offset:2048 sc1
  buffer_load_dwordx4 v[172:175], v2, s[4:7], s53 offen offset:3072 sc1
  buffer_load_dwordx2 v[176:177], v2, s[4:7], s54 offen offset:8 sc1
  buffer_load_dwordx2 v[178:179], v2, s[4:7], s54 offen offset:1032 sc1
  buffer_load_dwordx2 v[180:181], v2, s[4:7], s54 offen offset:2056 sc1
  buffer_load_dwordx2 v[182:183], v2, s[4:7], s54 offen offset:3080 sc1
mega_q_sc:
  s_waitcnt vmcnt(0)
  v_mfma_f32_16x16x32_bf16 v[208:211], v[136:139], v[112:115], 0
  v_mfma_f32_16x16x32_bf16 v[212:215], v[160:163], v[112:115], 0
  v_mfma_f32_16x16x32_bf16 v[208:211], v[140:143], v[116:119], v[208:211]
  v_mfma_f32_16x16x32_bf16 v[212:215], v[164:167], v[116:119], v[212:215]
  v_mfma_f32_16x16x32_bf16 v[208:211], v[144:147], v[120:123], v[208:211]
  v_mfma_f32_16x16x32_bf16 v[212:215], v[168:171], v[120:123], v[212:215]
  v_mfma_f32_16x16x32_bf16 v[208:211], v[148:151], v[124:127], v[208:211]
  v_mfma_f32_16x16x32_bf16 v[212:215], v[172:175], v[124:127], v[212:215]
  v_mfma_f32_16x16x32_bf16 v[208:211], v[152:155], v[128:131], v[208:211]
  v_mfma_f32_16x16x32_bf16 v[212:215], v[176:179], v[128:131], v[212:215]
  v_mfma_f32_16x16x32_bf16 v[208:211], v[156:159], v[132:135], v[208:211]
  v_mfma_f32_16x16x32_bf16 v[212:215], v[180:183], v[132:135], v[212:215]
  s_add_u32 s52, s27, s20
  s_add_u32 s53, s28, s20
  s_mov_b32 s30, 0
mega0_kernel_pv15:
  buffer_load_dword v86, v85, s[4:7], s71 offen sc1
  s_waitcnt vmcnt(0)
mega0_kernel_pv15_t:
  v_cmp_gt_u32 vcc, s60, v86
  s_nop 0
  s_cbranch_vccz mega0_kernel_pv15_ok
  s_sleep 1
  s_add_u32 s30, s30, 1
  s_cmp_lt_u32 s30, 262144
  s_cbranch_scc1 mega0_kernel_pv15
  s_branch mega_fail
mega0_kernel_pv15_ok:
  buffer_load_dwordx4 v[184:187], v11, s[4:7], s52 offen offset:0 sc1
  buffer_load_dwordx4 v[188:191], v11, s[4:7], s52 offen offset:512 sc1
  buffer_load_dwordx4 v[192:195], v11, s[4:7], s52 offen offset:1024 sc1
  buffer_load_dwordx4 v[196:199], v11, s[4:7], s52 offen offset:1536 sc1
  buffer_load_dwordx2 v[200:201], v8, s[4:7], s52 offen offset:2048 sc1
  buffer_load_dwordx2 v[202:203], v8, s[4:7], s52 offen offset:2304 sc1
  buffer_load_dwordx2 v[204:205], v8, s[4:7], s52 offen offset:2560 sc1
  buffer_load_dwordx2 v[206:207], v8, s[4:7], s52 offen offset:2816 sc1
  s_bitcmp0_b32 s3, 0
  s_cselect_b64 s[56:57], s[32:33], -1
  s_cselect_b64 s[58:59], 0, s[32:33]
  v_cndmask_b32 v208, v13, v208, s[56:57]
  v_cndmask_b32 v212, v13, v212, s[58:59]
  s_cselect_b64 s[56:57], s[34:35], -1
  s_cselect_b64 s[58:59], 0, s[34:35]
  v_cndmask_b32 v209, v13, v209, s[56:57]
  v_cndmask_b32 v213, v13, v213, s[58:59]
  s_cselect_b64 s[56:57], s[36:37], -1
  s_cselect_b64 s[58:59], 0, s[36:37]
  v_cndmask_b32 v210, v13, v210, s[56:57]
  v_cndmask_b32 v214, v13, v214, s[58:59]
  s_cselect_b64 s[56:57], s[38:39], -1
  s_cselect_b64 s[58:59], 0, s[38:39]
  v_cndmask_b32 v211, v13, v211, s[56:57]
  v_cndmask_b32 v215, v13, v215, s[58:59]
  v_max3_f32 v220, v208, v209, v210
  v_max3_f32 v220, v220, v211, v212
  v_max3_f32 v220, v220, v213, v214
  v_max_f32 v220, v220, v215
  s_waitcnt vmcnt(7)
  v_mfma_f32_16x16x32_bf16 v[216:219], v[184:187], v[112:115], 0
  s_waitcnt vmcnt(6)
  v_mfma_f32_16x16x32_bf16 v[216:219], v[188:191], v[116:119], v[216:219]
  s_waitcnt vmcnt(5)
  v_mfma_f32_16x16x32_bf16 v[216:219], v[192:195], v[120:123], v[216:219]
  s_waitcnt vmcnt(4)
  v_mfma_f32_16x16x32_bf16 v[216:219], v[196:199], v[124:127], v[216:219]
  s_waitcnt vmcnt(2)
  v_mfma_f32_16x16x32_bf16 v[216:219], v[200:203], v[128:131], v[216:219]
  s_waitcnt vmcnt(0)
  v_mfma_f32_16x16x32_bf16 v[216:219], v[204:207], v[132:135], v[216:219]
  s_nop 7
  v_cndmask_b32 v216, v13, v216, s[40:41]
  v_cndmask_b32 v217, v13, v217, s[40:41]
  v_cndmask_b32 v218, v13, v218, s[40:41]
  v_cndmask_b32 v219, v13, v219, s[40:41]
  v_max3_f32 v220, v220, v216, v217
  v_max3_f32 v220, v220, v218, v219
  v_mov_b32 v221, v220
  s_nop 1
  v_permlane16_swap_b32 v220, v221
  v_max_f32 v220, v220, v221
  v_mov_b32 v221, v220
  s_nop 1
  v_permlane32_swap_b32 v220, v221
  v_max_f32 v220, v220, v221
  v_mul_f32 v220, s42, v220
  v_fma_f32 v208, v208, s42, -v220
  v_fma_f32 v209, v209, s42, -v220
  v_fma_f32 v210, v210, s42, -v220
  v_fma_f32 v211, v211, s42, -v220
  v_fma_f32 v212, v212, s42, -v220
  v_fma_f32 v213, v213, s42, -v220
  v_fma_f32 v214, v214, s42, -v220
  v_fma_f32 v215, v215, s42, -v220
  v_fma_f32 v216, v216, s42, -v220
  v_fma_f32 v217, v217, s42, -v220
  v_fma_f32 v218, v218, s42, -v220
  v_fma_f32 v219, v219, s42, -v220
  v_exp_f32 v208, v208
  v_exp_f32 v209, v209
  v_exp_f32 v210, v210
  v_exp_f32 v211, v211
  v_exp_f32 v212, v212
  v_exp_f32 v213, v213
  v_exp_f32 v214, v214
  v_exp_f32 v215, v215
  v_exp_f32 v216, v216
  v_exp_f32 v217, v217
  v_exp_f32 v218, v218
  v_exp_f32 v219, v219
  v_cndmask_b32 v216, 0, v216, s[40:41]
  v_cndmask_b32 v217, 0, v217, s[40:41]
  v_cndmask_b32 v218, 0, v218, s[40:41]
  v_cndmask_b32 v219, 0, v219, s[40:41]
  v_add_f32 v220, v208, v209
  v_add_f32 v220, v220, v210
  v_add_f32 v220, v220, v211
  v_add_f32 v220, v220, v212
  v_add_f32 v220, v220, v213
  v_add_f32 v220, v220, v214
  v_add_f32 v220, v220, v215
  v_add_f32 v220, v220, v216
  v_add_f32 v220, v220, v217
  v_add_f32 v220, v220, v218
  v_add_f32 v220, v220, v219
  v_mov_b32 v221, v220
  s_nop 1
  v_permlane16_swap_b32 v220, v221
  v_add_f32 v220, v220, v221
  v_mov_b32 v221, v220
  s_nop 1
  v_permlane32_swap_b32 v220, v221
  v_add_f32 v220, v220, v221
  v_rcp_f32 v220, v220
  s_nop 0
  v_mul_f32 v208, v208, v220
  v_mul_f32 v209, v209, v220
  v_mul_f32 v210, v210, v220
  v_mul_f32 v211, v211, v220
  v_mul_f32 v212, v212, v220
  v_mul_f32 v213, v213, v220
  v_mul_f32 v214, v214, v220
  v_mul_f32 v215, v215, v220
  v_mul_f32 v216, v216, v220
  v_mul_f32 v217, v217, v220
  v_mul_f32 v218, v218, v220
  v_mul_f32 v219, v219, v220
  v_cvt_pk_bf16_f32 v224, v208, v209
  v_cvt_pk_bf16_f32 v225, v210, v211
  v_cvt_pk_bf16_f32 v226, v212, v213
  v_cvt_pk_bf16_f32 v227, v214, v215
  v_cvt_pk_bf16_f32 v228, v216, v217
  v_cvt_pk_bf16_f32 v229, v218, v219
  buffer_store_dwordx4 v[224:227], v14, s[4:7], s53 offen
  s_mov_b64 exec, s[40:41]
  buffer_store_dwordx2 v[228:229], v15, s[4:7], s53 offen
  s_mov_b64 exec, -1
  s_add_u32 s20, s20, 651264
  s_cmp_ge_u32 s20, 1953792
  s_cselect_b32 s30, 1953792, 0
  s_sub_u32 s20, s20, s30
  s_add_u32 s60, s60, 2
  s_add_u32 s62, s62, 2
  s_waitcnt vmcnt(0)
  v_mov_b32 v220, s62
  s_mov_b64 exec, 1
  s_cmp_lg_u32 s69, 0
  s_cbranch_scc1 mega0_kernel_pf16
  buffer_store_dword v220, v7, s[4:7], s50 offen
mega0_kernel_pf16_b:
  s_mov_b64 exec, -1
  s_cmp_lt_u32 s62, 64
  s_cbranch_scc1 mega_q_loop
  s_endpgm
mega0_kernel_pf2:
  buffer_wbl2 sc1
  s_waitcnt vmcnt(0)
  buffer_store_dword v8, v7, s[4:7], s25 offen sc1
  s_branch mega0_kernel_pf2_b
mega0_kernel_pf4:
  buffer_wbl2 sc1
  s_waitcnt vmcnt(0)
  buffer_store_dword v8, v7, s[4:7], s25 offen sc1
  s_branch mega0_kernel_pf4_b
mega0_kernel_pf7:
  buffer_wbl2 sc1
  s_waitcnt vmcnt(0)
  buffer_store_dword v8, v7, s[4:7], s25 offen sc1
  s_branch mega0_kernel_pf7_b
mega0_kernel_pf11:
  buffer_wbl2 sc1
  s_waitcnt vmcnt(0)
  buffer_store_dword v8, v7, s[4:7], s21 offen sc1
  s_branch mega0_kernel_pf11_b
mega0_kernel_pf16:
  buffer_wbl2 sc1
  s_waitcnt vmcnt(0)
  buffer_store_dword v220, v7, s[4:7], s50 offen sc1
  s_branch mega0_kernel_pf16_b
mega_rec:
  s_lshr_b32 s9, s2, 3
  s_lshr_b32 s10, s9, 2
  s_lshl_b32 s27, s68, 2
  s_add_u32 s10, s10, s27
  s_and_b32 s11, s9, 3
  s_mul_i32 s48, s10, 384
  s_mul_i32 s28, s11, 96
  s_add_u32 s48, s48, s28
  s_mul_i32 s28, s3, 1966080
  s_add_u32 s48, s48, s28
  s_mov_b32 s49, s48
  s_mul_i32 s50, s3, 15360
  s_add_u32 s50, s50, 40960
  s_add_u32 s51, s50, 61440
  v_mul_u32_u24 v22, 10923, v1
  v_lshrrev_b32 v22, 16, v22
  v_mul_u32_u24 v20, 6, v22
  v_sub_u32 v20, v1, v20
  v_lshlrev_b32 v20, 4, v20
  v_mul_u32_u24 v22, 12288, v22
  v_add_u32 v20, v20, v22
  v_lshrrev_b32 v22, 4, v1
  v_mul_u32_u24 v22, 8, v22
  v_bfe_u32 v21, v1, 2, 2
  v_add_u32 v22, v22, v21
  v_mul_u32_u24 v22, 96, v22
  v_and_b32 v21, 3, v1
  v_lshl_add_u32 v21, v21, 3, v22
  s_mov_b64 exec, s[82:83]
  s_add_u32 m0, s50, 0
  s_nop 0
  buffer_load_dwordx4 v20, s[92:95], s48 offen lds
  s_add_u32 s48, s48, 122880
  s_add_u32 m0, s50, 960
  s_nop 0
  buffer_load_dwordx4 v20, s[92:95], s48 offen lds
  s_add_u32 s48, s48, 122880
  s_add_u32 m0, s50, 1920
  s_nop 0
  buffer_load_dwordx4 v20, s[92:95], s48 offen lds
  s_add_u32 s48, s48, 122880
  s_add_u32 m0, s50, 2880
  s_nop 0
  buffer_load_dwordx4 v20, s[92:95], s48 offen lds
  s_add_u32 s48, s48, 122880
  s_add_u32 m0, s50, 3840
  s_nop 0
  buffer_load_dwordx4 v20, s[92:95], s48 offen lds
  s_add_u32 s48, s48, 122880
  s_add_u32 m0, s50, 4800
  s_nop 0
  buffer_load_dwordx4 v20, s[92:95], s48 offen lds
  s_add_u32 s48, s48, 122880
  s_add_u32 m0, s50, 5760
  s_nop 0
  buffer_load_dwordx4 v20, s[92:95], s48 offen lds
  s_add_u32 s48, s48, 122880
  s_add_u32 m0, s50, 6720
  s_nop 0
  buffer_load_dwordx4 v20, s[92:95], s48 offen lds
  s_add_u32 s48, s48, 122880
  s_add_u32 m0, s50, 7680
  s_nop 0
  buffer_load_dwordx4 v20, s[92:95], s48 offen lds
  s_add_u32 s48, s48, 122880
  s_add_u32 m0, s50, 8640
  s_nop 0
  buffer_load_dwordx4 v20, s[92:95], s48 offen lds
  s_add_u32 s48, s48, 122880
  s_add_u32 m0, s50, 9600
  s_nop 0
  buffer_load_dwordx4 v20, s[92:95], s48 offen lds
  s_add_u32 s48, s48, 122880
  s_add_u32 m0, s50, 10560
  s_nop 0
  buffer_load_dwordx4 v20, s[92:95], s48 offen lds
  s_add_u32 s48, s48, 122880
  s_add_u32 m0, s50, 11520
  s_nop 0
  buffer_load_dwordx4 v20, s[92:95], s48 offen lds
  s_add_u32 s48, s48, 122880
  s_add_u32 m0, s50, 12480
  s_nop 0
  buffer_load_dwordx4 v20, s[92:95], s48 offen lds
  s_add_u32 s48, s48, 122880
  s_add_u32 m0, s50, 13440
  s_nop 0
  buffer_load_dwordx4 v20, s[92:95], s48 offen lds
  s_add_u32 s48, s48, 122880
  s_add_u32 m0, s50, 14400
  s_nop 0
  buffer_load_dwordx4 v20, s[92:95], s48 offen lds
  s_add_u32 s48, s48, 122880
  s_mov_b64 exec, -1
  s_mov_b64 exec, s[82:83]
  s_add_u32 m0, s51, 0
  s_nop 0
  buffer_load_dwordx4 v20, s[96:99], s49 offen lds
  s_add_u32 s49, s49, 122880
  s_add_u32 m0, s51, 960
  s_nop 0
  buffer_load_dwordx4 v20, s[96:99], s49 offen lds
  s_add_u32 s49, s49, 122880
  s_add_u32 m0, s51, 1920
  s_nop 0
  buffer_load_dwordx4 v20, s[96:99], s49 offen lds
  s_add_u32 s49, s49, 122880
  s_add_u32 m0, s51, 2880
  s_nop 0
  buffer_load_dwordx4 v20, s[96:99], s49 offen lds
  s_add_u32 s49, s49, 122880
  s_add_u32 m0, s51, 3840
  s_nop 0
  buffer_load_dwordx4 v20, s[96:99], s49 offen lds
  s_add_u32 s49, s49, 122880
  s_add_u32 m0, s51, 4800
  s_nop 0
  buffer_load_dwordx4 v20, s[96:99], s49 offen lds
  s_add_u32 s49, s49, 122880
  s_add_u32 m0, s51, 5760
  s_nop 0
  buffer_load_dwordx4 v20, s[96:99], s49 offen lds
  s_add_u32 s49, s49, 122880
  s_add_u32 m0, s51, 6720
  s_nop 0
  buffer_load_dwordx4 v20, s[96:99], s49 offen lds
  s_add_u32 s49, s49, 122880
  s_add_u32 m0, s51, 7680
  s_nop 0
  buffer_load_dwordx4 v20, s[96:99], s49 offen lds
  s_add_u32 s49, s49, 122880
  s_add_u32 m0, s51, 8640
  s_nop 0
  buffer_load_dwordx4 v20, s[96:99], s49 offen lds
  s_add_u32 s49, s49, 122880
  s_add_u32 m0, s51, 9600
  s_nop 0
  buffer_load_dwordx4 v20, s[96:99], s49 offen lds
  s_add_u32 s49, s49, 122880
  s_add_u32 m0, s51, 10560
  s_nop 0
  buffer_load_dwordx4 v20, s[96:99], s49 offen lds
  s_add_u32 s49, s49, 122880
  s_add_u32 m0, s51, 11520
  s_nop 0
  buffer_load_dwordx4 v20, s[96:99], s49 offen lds
  s_add_u32 s49, s49, 122880
  s_add_u32 m0, s51, 12480
  s_nop 0
  buffer_load_dwordx4 v20, s[96:99], s49 offen lds
  s_add_u32 s49, s49, 122880
  s_add_u32 m0, s51, 13440
  s_nop 0
  buffer_load_dwordx4 v20, s[96:99], s49 offen lds
  s_add_u32 s49, s49, 122880
  s_add_u32 m0, s51, 14400
  s_nop 0
  buffer_load_dwordx4 v20, s[96:99], s49 offen lds
  s_add_u32 s49, s49, 122880
  s_mov_b64 exec, -1
  v_and_b32 v16, 15, v1
  v_lshrrev_b32 v17, 4, v1
  v_and_b32 v18, 7, v1
  v_lshrrev_b32 v19, 3, v16
  v_lshlrev_b32 v2, 4, v1
  s_mul_i32 s27, s9, 40
  v_add_u32 v20, s27, v16
  v_lshrrev_b32 v22, 4, v20
  v_mul_u32_u24 v22, 20480, v22
  v_and_b32 v20, 15, v20
  v_lshl_add_u32 v22, v20, 4, v22
  v_lshl_add_u32 v22, v17, 8, v22
  s_lshl_b32 s28, s68, 2
  s_mul_i32 s53, s28, 819200
  s_add_u32 s53, s53, 0
  s_mul_i32 s28, s3, 819200
  s_add_u32 s52, s53, s28
  buffer_load_dwordx4 a[0:3], v22, s[4:7], s52 offen offset:0
  buffer_load_dwordx4 a[4:7], v22, s[4:7], s52 offen offset:1024
  buffer_load_dwordx4 a[8:11], v22, s[4:7], s52 offen offset:2048
  buffer_load_dwordx4 a[12:15], v22, s[4:7], s52 offen offset:3072
  s_add_u32 s52, s52, 4096
  buffer_load_dwordx4 a[16:19], v22, s[4:7], s52 offen offset:0
  buffer_load_dwordx4 a[20:23], v22, s[4:7], s52 offen offset:1024
  buffer_load_dwordx4 a[24:27], v22, s[4:7], s52 offen offset:2048
  buffer_load_dwordx4 a[28:31], v22, s[4:7], s52 offen offset:3072
  s_add_u32 s52, s52, 4096
  buffer_load_dwordx4 a[32:35], v22, s[4:7], s52 offen offset:0
  buffer_load_dwordx4 a[36:39], v22, s[4:7], s52 offen offset:1024
  buffer_load_dwordx4 a[40:43], v22, s[4:7], s52 offen offset:2048
  buffer_load_dwordx4 a[44:47], v22, s[4:7], s52 offen offset:3072
  s_add_u32 s52, s52, 4096
  buffer_load_dwordx4 a[48:51], v22, s[4:7], s52 offen offset:0
  buffer_load_dwordx4 a[52:55], v22, s[4:7], s52 offen offset:1024
  buffer_load_dwordx4 a[56:59], v22, s[4:7], s52 offen offset:2048
  buffer_load_dwordx4 a[60:63], v22, s[4:7], s52 offen offset:3072
  s_add_u32 s52, s52, 4096
  buffer_load_dwordx4 a[64:67], v22, s[4:7], s52 offen offset:0
  buffer_load_dwordx4 a[68:71], v22, s[4:7], s52 offen offset:1024
  buffer_load_dwordx4 a[72:75], v22, s[4:7], s52 offen offset:2048
  buffer_load_dwordx4 a[76:79], v22, s[4:7], s52 offen offset:3072
  s_add_u32 s52, s52, 4096
  s_add_u32 s27, s27, 32
  v_add_u32 v20, s27, v18
  v_lshrrev_b32 v23, 4, v20
  v_mul_u32_u24 v23, 20480, v23
  v_and_b32 v20, 15, v20
  v_lshl_add_u32 v23, v20, 4, v23
  v_lshl_add_u32 v23, v17, 8, v23
  v_mul_u32_u24 v20, 819200, v19
  v_add_u32 v23, v23, v20
  s_mov_b32 s26, 0x3dd53b95
  s_mov_b32 s42, 0xff00ff00
  s_mov_b32 s43, 0xff00ff00
  v_bfe_u32 v20, v1, 1, 1
  v_mul_u32_u24 v20, 0xaaaa, v20
  v_add_u32 v9, 0x4444, v20
  s_lshr_b32 s27, s3, 1
  s_lshl_b32 s27, s27, 10
  s_and_b32 s28, s3, 1
  s_lshl_b32 s28, s28, 3
  s_add_u32 s27, s27, s28
  v_add_u32 v3, s27, v2
  v_mul_u32_u24 v20, 640, v17
  v_lshl_add_u32 v4, v16, 4, v20
  v_lshrrev_b32 v21, 2, v16
  v_lshl_add_u32 v5, v21, 5, v20
  v_and_b32 v21, 1, v16
  v_lshl_add_u32 v5, v21, 4, v5
  v_lshl_add_u32 v20, v19, 2, v17
  v_and_b32 v6, 3, v1
  v_lshlrev_b32 v6, 8, v6
  v_lshl_add_u32 v6, v20, 4, v6
  v_and_b32 v21, 4, v1
  v_lshl_add_u32 v6, v21, 1, v6
  s_lshl_b32 s27, s3, 10
  v_add_u32 v6, s27, v6
  v_lshlrev_b32 v7, 1, v18
  v_lshl_add_u32 v7, v20, 4, v7
  s_lshl_b32 s28, s3, 8
  v_add_u32 v7, s28, v7
  v_lshlrev_b32 v8, 2, v17
  v_lshl_add_u32 v8, v16, 4, v8
  v_add_u32 v8, s28, v8
  v_bfe_u32 v20, v1, 2, 1
  v_and_b32 v21, 1, v17
  v_lshl_add_u32 v20, v21, 2, v20
  v_lshrrev_b32 v21, 1, v17
  v_lshl_add_u32 v21, v21, 1, v19
  v_lshl_add_u32 v24, v21, 3, v20
  v_mul_u32_u24 v21, 40, v21
  v_add_u32 v26, v21, v20
  v_and_b32 v20, 3, v1
  v_lshlrev_b32 v20, 3, v20
  v_mul_u32_u24 v24, 96, v24
  v_add_u32 v24, v24, v20
  v_add_u32 v24, 40960, v24
  v_add_u32 v25, 61440, v24
  v_mul_u32_u24 v26, 96, v26
  v_add_u32 v26, v26, v20
  v_add_u32 v26, 40960, v26
  v_add_u32 v27, 61440, v26
  v_and_b32 v20, 1, v1
  v_lshlrev_b32 v20, 4, v20
  v_mov_b32 v21, 0x3f80
  v_lshlrev_b32 v20, v20, v21
  v_lshrrev_b32 v21, 1, v16
  v_cmp_eq_u32 vcc, 0, v21
  s_nop 1
  v_cndmask_b32 v28, 0, v20, vcc
  v_cmp_eq_u32 vcc, 4, v21
  s_nop 1
  v_cndmask_b32 v32, 0, v20, vcc
  v_or_b32 v36, v28, v32
  v_cmp_eq_u32 vcc, 1, v21
  s_nop 1
  v_cndmask_b32 v29, 0, v20, vcc
  v_cmp_eq_u32 vcc, 5, v21
  s_nop 1
  v_cndmask_b32 v33, 0, v20, vcc
  v_or_b32 v37, v29, v33
  v_cmp_eq_u32 vcc, 2, v21
  s_nop 1
  v_cndmask_b32 v30, 0, v20, vcc
  v_cmp_eq_u32 vcc, 6, v21
  s_nop 1
  v_cndmask_b32 v34, 0, v20, vcc
  v_or_b32 v38, v30, v34
  v_cmp_eq_u32 vcc, 3, v21
  s_nop 1
  v_cndmask_b32 v31, 0, v20, vcc
  v_cmp_eq_u32 vcc, 7, v21
  s_nop 1
  v_cndmask_b32 v35, 0, v20, vcc
  v_or_b32 v39, v31, v35
  v_cmp_eq_u32 vcc, v17, v21
  s_nop 1
  v_cndmask_b32 v40, 0, v20, vcc
  v_add_u32 v41, 4, v17
  v_cmp_eq_u32 vcc, v41, v21
  s_nop 1
  v_cndmask_b32 v41, 0, v20, vcc
  v_mov_b32 v42, v40
  v_mov_b32 v43, v41
  s_mul_i32 s27, s68, 20480
  s_mul_i32 s28, s70, 163840
  s_add_u32 s27, s27, s28
  s_add_u32 s16, s27, 61243392
  s_add_u32 s17, s16, 10240
  s_add_u32 s27, s27, 61571072
  s_mul_i32 s28, s9, 640
  s_add_u32 s18, s27, s28
  s_add_u32 s19, s18, 10240
  s_mul_i32 s28, s3, 2560
  s_add_u32 s20, s27, s28
  s_add_u32 s21, s20, 10240
  s_mul_i32 s29, s68, 1953792
  s_add_u32 s29, s29, 28835840
  s_lshr_b32 s28, s9, 2
  s_mul_i32 s22, s28, 12288
  s_lshl_b32 s27, s11, 10
  s_add_u32 s22, s22, s27
  s_add_u32 s22, s22, s29
  s_add_u32 s22, s22, 204800
  s_mul_i32 s23, s28, 3072
  s_add_u32 s23, s23, s29
  s_add_u32 s23, s23, 303104
  s_mul_i32 s27, s9, 2560
  s_add_u32 s24, s27, s29
  s_add_u32 s25, s24, 163840
  s_mov_b32 s72, 0
  s_mov_b32 s12, 0
  s_mov_b32 s76, 0
  s_lshl_b32 s27, s10, 7
  s_lshl_b32 s28, s11, 2
  s_add_u32 s54, s27, s28
  s_add_u32 s77, s54, s71
  s_add_u32 s77, s77, 16384
  s_lshl_b32 s27, s70, 5
  s_add_u32 s27, s27, 94502912
  s_add_u32 s56, s4, s27
  s_addc_u32 s57, s5, 0
  s_load_dwordx8 s[60:67], s[56:57], 0
  s_add_u32 s31, s4, 63995903
  s_and_b32 s31, s31, 0xffe00000
  s_sub_u32 s31, s31, s4
  s_lshl_b32 s27, s70, 21
  s_add_u32 s31, s31, s27
  s_lshl_b32 s27, s9, 1
  s_add_u32 s27, s27, s3
  s_lshr_b32 s28, s27, 2
  s_lshl_b32 s28, s28, 14
  s_and_b32 s27, s27, 3
  s_lshl_b32 s27, s27, 11
  s_add_u32 s27, s27, s28
  s_lshr_b32 s28, s9, 3
  s_add_u32 s28, s28, 8
  s_lshl_b32 s28, s28, 14
  s_and_b32 s29, s9, 7
  s_lshl_b32 s29, s29, 10
  s_add_u32 s28, s28, s29
  s_cmp_lt_u32 s3, 2
  s_cselect_b32 s27, s27, s28
  s_cselect_b32 s28, 8, 7
  s_lshl_b32 s29, s68, s28
  s_add_u32 s31, s31, s27
  s_waitcnt lgkmcnt(0)
  s_add_u32 s60, s60, s61
  s_add_u32 s60, s60, s62
  s_add_u32 s60, s60, s63
  s_add_u32 s60, s60, s64
  s_add_u32 s60, s60, s65
  s_add_u32 s60, s60, s66
  s_add_u32 s60, s60, s67
  s_cmp_ge_u32 s60, 4
  s_cselect_b32 s27, 0, 1
  s_lshr_b32 s28, s68, 2
  s_xor_b32 s27, s27, s28
  s_lshl_b32 s27, s27, 13
  s_xor_b32 s28, s27, 8192
  s_add_u32 s30, s31, s28
  s_add_u32 s31, s31, s27
  s_and_b32 s27, s68, 3
  s_mul_i32 s27, s27, 163840
  s_add_u32 s32, s31, s27
  s_add_u32 s30, s30, s29
  s_add_u32 s31, s31, s29
  s_mov_b32 s39, 1310720
  s_mov_b32 s15, 0
  s_mov_b32 s78, 0
  s_mov_b32 s75, 0
  s_mov_b32 s80, 0
  s_waitcnt vmcnt(40)
  buffer_load_dwordx4 a[80:83], v22, s[4:7], s52 offen offset:0
  buffer_load_dwordx4 a[84:87], v22, s[4:7], s52 offen offset:1024
  buffer_load_dwordx4 a[88:91], v22, s[4:7], s52 offen offset:2048
  buffer_load_dwordx4 a[92:95], v22, s[4:7], s52 offen offset:3072
  s_add_u32 s52, s52, 4096
  buffer_load_dwordx4 a[96:99], v22, s[4:7], s52 offen offset:0
  buffer_load_dwordx4 a[100:103], v22, s[4:7], s52 offen offset:1024
  buffer_load_dwordx4 a[104:107], v22, s[4:7], s52 offen offset:2048
  buffer_load_dwordx4 a[108:111], v22, s[4:7], s52 offen offset:3072
  s_add_u32 s52, s52, 4096
  buffer_load_dwordx4 a[112:115], v22, s[4:7], s52 offen offset:0
  buffer_load_dwordx4 a[116:119], v22, s[4:7], s52 offen offset:1024
  buffer_load_dwordx4 a[120:123], v22, s[4:7], s52 offen offset:2048
  buffer_load_dwordx4 a[124:127], v22, s[4:7], s52 offen offset:3072
  s_add_u32 s52, s52, 4096
  buffer_load_dwordx4 a[128:131], v22, s[4:7], s52 offen offset:0
  buffer_load_dwordx4 a[132:135], v22, s[4:7], s52 offen offset:1024
  buffer_load_dwordx4 a[136:139], v22, s[4:7], s52 offen offset:2048
  buffer_load_dwordx4 a[140:143], v22, s[4:7], s52 offen offset:3072
  s_add_u32 s52, s52, 4096
  buffer_load_dwordx4 a[144:147], v22, s[4:7], s52 offen offset:0
  buffer_load_dwordx4 a[148:151], v22, s[4:7], s52 offen offset:1024
  buffer_load_dwordx4 a[152:155], v22, s[4:7], s52 offen offset:2048
  buffer_load_dwordx4 a[156:159], v22, s[4:7], s52 offen offset:3072
  s_add_u32 s52, s52, 4096
  s_waitcnt vmcnt(40)
  s_barrier
  s_cmp_eq_u32 s3, 1
  s_cbranch_scc1 mega_pro1
  s_cmp_eq_u32 s3, 2
  s_cbranch_scc1 mega_pro2
  s_cmp_eq_u32 s3, 3
  s_cbranch_scc1 mega_pro3
  ds_read_b64_tr_b16 v[136:137], v24 offset:0
  ds_read_b64_tr_b16 v[138:139], v24 offset:192
  ds_read_b64_tr_b16 v[140:141], v24 offset:3840
  ds_read_b64_tr_b16 v[142:143], v24 offset:4032
  ds_read_b64_tr_b16 v[144:145], v25 offset:0
  ds_read_b64_tr_b16 v[146:147], v25 offset:192
  ds_read_b64_tr_b16 v[148:149], v25 offset:3840
  ds_read_b64_tr_b16 v[150:151], v25 offset:4032
  ds_read_b64_tr_b16 v[152:153], v24 offset:7680
  ds_read_b64_tr_b16 v[154:155], v24 offset:7872
  ds_read_b64_tr_b16 v[156:157], v24 offset:11520
  ds_read_b64_tr_b16 v[158:159], v24 offset:11712
  ds_read_b64_tr_b16 v[160:161], v25 offset:7680
  ds_read_b64_tr_b16 v[162:163], v25 offset:7872
  ds_read_b64_tr_b16 v[164:165], v25 offset:11520
  ds_read_b64_tr_b16 v[166:167], v25 offset:11712
  ds_read_b64_tr_b16 v[168:169], v24 offset:15360
  ds_read_b64_tr_b16 v[170:171], v24 offset:15552
  ds_read_b64_tr_b16 v[172:173], v24 offset:19200
  ds_read_b64_tr_b16 v[174:175], v24 offset:19392
  ds_read_b64_tr_b16 v[176:177], v25 offset:15360
  ds_read_b64_tr_b16 v[178:179], v25 offset:15552
  ds_read_b64_tr_b16 v[180:181], v25 offset:19200
  ds_read_b64_tr_b16 v[182:183], v25 offset:19392
  ds_read_b64_tr_b16 v[184:185], v24 offset:32
  ds_read_b64_tr_b16 v[186:187], v24 offset:224
  ds_read_b64_tr_b16 v[188:189], v24 offset:3872
  ds_read_b64_tr_b16 v[190:191], v24 offset:4064
  ds_read_b64_tr_b16 v[192:193], v25 offset:32
  ds_read_b64_tr_b16 v[194:195], v25 offset:224
  ds_read_b64_tr_b16 v[196:197], v25 offset:3872
  ds_read_b64_tr_b16 v[198:199], v25 offset:4064
  ds_read_b64_tr_b16 v[200:201], v24 offset:7712
  ds_read_b64_tr_b16 v[202:203], v24 offset:7904
  ds_read_b64_tr_b16 v[204:205], v24 offset:11552
  ds_read_b64_tr_b16 v[206:207], v24 offset:11744
  ds_read_b64_tr_b16 v[208:209], v25 offset:7712
  ds_read_b64_tr_b16 v[210:211], v25 offset:7904
  ds_read_b64_tr_b16 v[212:213], v25 offset:11552
  ds_read_b64_tr_b16 v[214:215], v25 offset:11744
  ds_read_b64_tr_b16 v[216:217], v24 offset:15392
  ds_read_b64_tr_b16 v[218:219], v24 offset:15584
  ds_read_b64_tr_b16 v[220:221], v24 offset:19232
  ds_read_b64_tr_b16 v[222:223], v24 offset:19424
  ds_read_b64_tr_b16 v[224:225], v24 offset:64
  ds_read_b64_tr_b16 v[226:227], v24 offset:256
  ds_read_b64_tr_b16 v[228:229], v24 offset:3904
  ds_read_b64_tr_b16 v[230:231], v24 offset:4096
  ds_read_b64_tr_b16 v[232:233], v25 offset:64
  ds_read_b64_tr_b16 v[234:235], v25 offset:256
  ds_read_b64_tr_b16 v[236:237], v25 offset:3904
  ds_read_b64_tr_b16 v[238:239], v25 offset:4096
  ds_read_b64_tr_b16 v[240:241], v24 offset:7744
  ds_read_b64_tr_b16 v[242:243], v24 offset:7936
  ds_read_b64_tr_b16 v[244:245], v24 offset:11584
  ds_read_b64_tr_b16 v[246:247], v24 offset:11776
  ds_read_b64_tr_b16 v[248:249], v25 offset:7744
  ds_read_b64_tr_b16 v[250:251], v25 offset:7936
  ds_read_b64_tr_b16 v[252:253], v25 offset:11584
  ds_read_b64_tr_b16 v[254:255], v25 offset:11776
  v_accvgpr_write_b32 a160, v28
  v_accvgpr_write_b32 a161, v29
  v_accvgpr_write_b32 a162, v30
  v_accvgpr_write_b32 a163, v31
  v_accvgpr_write_b32 a164, v32
  v_accvgpr_write_b32 a165, v33
  v_accvgpr_write_b32 a166, v34
  v_accvgpr_write_b32 a167, v35
  v_accvgpr_write_b32 a168, v36
  v_accvgpr_write_b32 a169, v37
  v_accvgpr_write_b32 a170, v38
  v_accvgpr_write_b32 a171, v39
  v_accvgpr_write_b32 a172, v40
  v_accvgpr_write_b32 a173, v41
  v_accvgpr_write_b32 a174, v42
  v_accvgpr_write_b32 a175, v43
  v_lshrrev_b32 v20, 1, v18
  v_lshlrev_b32 v44, 6, v20
  v_and_b32 v20, 1, v18
  v_lshl_add_u32 v44, v20, 4, v44
  v_lshlrev_b32 v12, 8, v17
  v_lshl_add_u32 v12, v18, 4, v12
  v_add_u32 v13, 0, v2
  v_lshlrev_b32 v60, 4, v17
  v_lshl_add_u32 v60, v16, 6, v60
  v_add_u32 v60, 0, v60
  v_mov_b32 v66, v60
  v_lshlrev_b32 v10, 6, v18
  v_lshl_add_u32 v10, v17, 4, v10
  v_add_u32 v10, 0, v10
  v_cmp_gt_u32 vcc, 8, v16
  v_mov_b32 v0, 0x40000000
  s_nop 0
  v_cndmask_b32 v10, v0, v10, vcc
  v_and_b32 v20, 3, v16
  v_lshlrev_b32 v11, 6, v20
  v_lshrrev_b32 v20, 2, v16
  v_lshl_add_u32 v11, v20, 4, v11
  v_lshl_add_u32 v11, v17, 8, v11
  v_lshrrev_b32 v20, 1, v17
  v_lshl_add_u32 v61, v20, 5, v44
  v_and_b32 v20, 1, v17
  v_lshl_add_u32 v20, v20, 1, v19
  v_mul_u32_u24 v20, 163840, v20
  v_add_u32 v61, v61, v20
  v_mov_b32 v62, v2
  v_lshlrev_b32 v63, 4, v16
  v_lshl_add_u32 v63, v17, 3, v63
  s_lshl_b32 s27, s9, 9
  s_add_u32 s27, s27, 0
  v_add_u32 v63, s27, v63
  v_cmp_gt_u32 vcc, 32, v1
  v_mov_b32 v0, 0x40000000
  s_nop 0
  v_cndmask_b32 v63, v0, v63, vcc
  v_mov_b32 v118, 0
  v_mov_b32 v119, 0
  v_mov_b32 v126, 0
  v_mov_b32 v127, 0
  v_mov_b32 v132, -1
  v_mov_b32 v133, -1
  v_mov_b32 v134, -1
  v_mov_b32 v135, -1
  s_add_u32 s38, s32, s39
  s_add_u32 s39, s39, 655360
  s_cmp_eq_u32 s39, 1966080
  s_cselect_b32 s39, 0, s39
  s_add_u32 s37, s32, s39
  s_add_u32 s33, s30, s39
  s_add_u32 s34, s33, 327680
  s_add_u32 s35, s31, s39
  s_add_u32 s36, s35, 327680
  s_waitcnt lgkmcnt(0)
  v_mov_b32 v28, 0
  v_mov_b32 v29, 0
  v_mov_b32 v30, 0
  v_mov_b32 v31, 0
  v_mov_b32 v32, 0
  v_mov_b32 v33, 0
  v_mov_b32 v34, 0
  v_mov_b32 v35, 0
  v_mov_b32 v36, 0
  v_mov_b32 v37, 0
  v_mov_b32 v38, 0
  v_mov_b32 v39, 0
  v_mov_b32 v40, 0
  v_mov_b32 v41, 0
  v_mov_b32 v42, 0
  v_mov_b32 v43, 0
  v_mov_b32 v44, 0
  v_mov_b32 v45, 0
  v_mov_b32 v46, 0
  v_mov_b32 v47, 0
  v_mov_b32 v48, 0
  v_mov_b32 v49, 0
  v_mov_b32 v50, 0
  v_mov_b32 v51, 0
  v_mov_b32 v52, 0
  v_mov_b32 v53, 0
  v_mov_b32 v54, 0
  v_mov_b32 v55, 0
  v_mov_b32 v56, 0
  v_mov_b32 v57, 0
  v_mov_b32 v58, 0
  v_mov_b32 v59, 0
  s_add_u32 s13, s16, 0
  s_add_u32 s14, s16, 2048
  s_lshl_b32 s29, s68, 2
  v_mov_b32 v15, s29
  s_mov_b32 s29, 0
mega0_kernel_cen17:
  buffer_load_dword v14, v15, s[44:47], 0 offen sc1
  s_waitcnt vmcnt(0)
  v_readfirstlane_b32 s27, v14
  s_nop 0
  s_and_b32 s28, s27, 63
  s_cmp_eq_u32 s28, 32
  s_cbranch_scc1 mega0_kernel_cen17_done
  s_sleep 4
  s_add_u32 s29, s29, 1
  s_cmp_lt_u32 s29, 262144
  s_cbranch_scc1 mega0_kernel_cen17
  s_branch mega_fail
mega0_kernel_cen17_done:
  s_cmp_eq_u32 s27, s69
  s_cselect_b32 s69, 0, 1
  s_cmp_eq_u32 s69, 0
  s_cbranch_scc1 mega_loop0
  s_branch mega_loop4
mega_pro1:
  ds_read_b64_tr_b16 v[136:137], v24 offset:23104
  ds_read_b64_tr_b16 v[138:139], v24 offset:23296
  ds_read_b64_tr_b16 v[140:141], v24 offset:26944
  ds_read_b64_tr_b16 v[142:143], v24 offset:27136
  ds_read_b64_tr_b16 v[144:145], v25 offset:23104
  ds_read_b64_tr_b16 v[146:147], v25 offset:23296
  ds_read_b64_tr_b16 v[148:149], v25 offset:26944
  ds_read_b64_tr_b16 v[150:151], v25 offset:27136
  ds_read_b64_tr_b16 v[152:153], v24 offset:30784
  ds_read_b64_tr_b16 v[154:155], v24 offset:30976
  ds_read_b64_tr_b16 v[156:157], v24 offset:34624
  ds_read_b64_tr_b16 v[158:159], v24 offset:34816
  ds_read_b64_tr_b16 v[160:161], v25 offset:30784
  ds_read_b64_tr_b16 v[162:163], v25 offset:30976
  ds_read_b64_tr_b16 v[164:165], v25 offset:34624
  ds_read_b64_tr_b16 v[166:167], v25 offset:34816
  ds_read_b64_tr_b16 v[168:169], v24 offset:15424
  ds_read_b64_tr_b16 v[170:171], v24 offset:15616
  ds_read_b64_tr_b16 v[172:173], v24 offset:19264
  ds_read_b64_tr_b16 v[174:175], v24 offset:19456
  ds_read_b64_tr_b16 v[176:177], v25 offset:15424
  ds_read_b64_tr_b16 v[178:179], v25 offset:15616
  ds_read_b64_tr_b16 v[180:181], v25 offset:19264
  ds_read_b64_tr_b16 v[182:183], v25 offset:19456
  ds_read_b64_tr_b16 v[184:185], v24 offset:23072
  ds_read_b64_tr_b16 v[186:187], v24 offset:23264
  ds_read_b64_tr_b16 v[188:189], v24 offset:26912
  ds_read_b64_tr_b16 v[190:191], v24 offset:27104
  ds_read_b64_tr_b16 v[192:193], v25 offset:23072
  ds_read_b64_tr_b16 v[194:195], v25 offset:23264
  ds_read_b64_tr_b16 v[196:197], v25 offset:26912
  ds_read_b64_tr_b16 v[198:199], v25 offset:27104
  ds_read_b64_tr_b16 v[200:201], v24 offset:30752
  ds_read_b64_tr_b16 v[202:203], v24 offset:30944
  ds_read_b64_tr_b16 v[204:205], v24 offset:34592
  ds_read_b64_tr_b16 v[206:207], v24 offset:34784
  ds_read_b64_tr_b16 v[208:209], v25 offset:30752
  ds_read_b64_tr_b16 v[210:211], v25 offset:30944
  ds_read_b64_tr_b16 v[212:213], v25 offset:34592
  ds_read_b64_tr_b16 v[214:215], v25 offset:34784
  ds_read_b64_tr_b16 v[216:217], v25 offset:15392
  ds_read_b64_tr_b16 v[218:219], v25 offset:15584
  ds_read_b64_tr_b16 v[220:221], v25 offset:19232
  ds_read_b64_tr_b16 v[222:223], v25 offset:19424
  ds_read_b64_tr_b16 v[224:225], v24 offset:23040
  ds_read_b64_tr_b16 v[226:227], v24 offset:23232
  ds_read_b64_tr_b16 v[228:229], v24 offset:26880
  ds_read_b64_tr_b16 v[230:231], v24 offset:27072
  ds_read_b64_tr_b16 v[232:233], v25 offset:23040
  ds_read_b64_tr_b16 v[234:235], v25 offset:23232
  ds_read_b64_tr_b16 v[236:237], v25 offset:26880
  ds_read_b64_tr_b16 v[238:239], v25 offset:27072
  ds_read_b64_tr_b16 v[240:241], v24 offset:30720
  ds_read_b64_tr_b16 v[242:243], v24 offset:30912
  ds_read_b64_tr_b16 v[244:245], v24 offset:34560
  ds_read_b64_tr_b16 v[246:247], v24 offset:34752
  ds_read_b64_tr_b16 v[248:249], v25 offset:30720
  ds_read_b64_tr_b16 v[250:251], v25 offset:30912
  ds_read_b64_tr_b16 v[252:253], v25 offset:34560
  ds_read_b64_tr_b16 v[254:255], v25 offset:34752
  v_accvgpr_write_b32 a160, v28
  v_accvgpr_write_b32 a161, v29
  v_accvgpr_write_b32 a162, v30
  v_accvgpr_write_b32 a163, v31
  v_accvgpr_write_b32 a164, v32
  v_accvgpr_write_b32 a165, v33
  v_accvgpr_write_b32 a166, v34
  v_accvgpr_write_b32 a167, v35
  v_accvgpr_write_b32 a168, v36
  v_accvgpr_write_b32 a169, v37
  v_accvgpr_write_b32 a170, v38
  v_accvgpr_write_b32 a171, v39
  v_accvgpr_write_b32 a172, v40
  v_accvgpr_write_b32 a173, v41
  v_accvgpr_write_b32 a174, v42
  v_accvgpr_write_b32 a175, v43
  v_lshrrev_b32 v20, 1, v18
  v_lshlrev_b32 v44, 6, v20
  v_and_b32 v20, 1, v18
  v_lshl_add_u32 v44, v20, 4, v44
  v_lshlrev_b32 v12, 8, v17
  v_lshl_add_u32 v12, v18, 4, v12
  v_add_u32 v13, 1024, v2
  v_lshlrev_b32 v60, 4, v17
  v_lshl_add_u32 v60, v16, 6, v60
  v_add_u32 v60, 1024, v60
  v_mov_b32 v66, v60
  v_lshlrev_b32 v10, 6, v18
  v_lshl_add_u32 v10, v17, 4, v10
  v_add_u32 v10, 8, v10
  v_cmp_gt_u32 vcc, 8, v16
  v_mov_b32 v0, 0x40000000
  s_nop 0
  v_cndmask_b32 v10, v0, v10, vcc
  v_and_b32 v20, 3, v16
  v_lshlrev_b32 v11, 6, v20
  v_lshrrev_b32 v20, 2, v16
  v_lshl_add_u32 v11, v20, 4, v11
  v_lshl_add_u32 v11, v17, 8, v11
  v_lshrrev_b32 v20, 1, v17
  v_lshl_add_u32 v61, v20, 5, v44
  v_and_b32 v20, 1, v17
  v_lshl_add_u32 v20, v20, 1, v19
  v_mul_u32_u24 v20, 163840, v20
  v_add_u32 v61, v61, v20
  v_mov_b32 v62, v2
  v_lshlrev_b32 v63, 4, v16
  v_lshl_add_u32 v63, v17, 3, v63
  s_lshl_b32 s27, s9, 9
  s_add_u32 s27, s27, 256
  v_add_u32 v63, s27, v63
  v_cmp_gt_u32 vcc, 32, v1
  v_mov_b32 v0, 0x40000000
  s_nop 0
  v_cndmask_b32 v63, v0, v63, vcc
  v_mov_b32 v118, 0
  v_mov_b32 v119, 0
  v_mov_b32 v126, 0
  v_mov_b32 v127, 0
  v_mov_b32 v132, -1
  v_mov_b32 v133, -1
  v_mov_b32 v134, -1
  v_mov_b32 v135, -1
  s_add_u32 s38, s32, s39
  s_add_u32 s39, s39, 655360
  s_cmp_eq_u32 s39, 1966080
  s_cselect_b32 s39, 0, s39
  s_add_u32 s37, s32, s39
  s_add_u32 s33, s30, s39
  s_add_u32 s34, s33, 327680
  s_add_u32 s35, s31, s39
  s_add_u32 s36, s35, 327680
  s_waitcnt lgkmcnt(0)
  v_mov_b32 v28, 0
  v_mov_b32 v29, 0
  v_mov_b32 v30, 0
  v_mov_b32 v31, 0
  v_mov_b32 v32, 0
  v_mov_b32 v33, 0
  v_mov_b32 v34, 0
  v_mov_b32 v35, 0
  v_mov_b32 v36, 0
  v_mov_b32 v37, 0
  v_mov_b32 v38, 0
  v_mov_b32 v39, 0
  v_mov_b32 v40, 0
  v_mov_b32 v41, 0
  v_mov_b32 v42, 0
  v_mov_b32 v43, 0
  v_mov_b32 v44, 0
  v_mov_b32 v45, 0
  v_mov_b32 v46, 0
  v_mov_b32 v47, 0
  v_mov_b32 v48, 0
  v_mov_b32 v49, 0
  v_mov_b32 v50, 0
  v_mov_b32 v51, 0
  v_mov_b32 v52, 0
  v_mov_b32 v53, 0
  v_mov_b32 v54, 0
  v_mov_b32 v55, 0
  v_mov_b32 v56, 0
  v_mov_b32 v57, 0
  v_mov_b32 v58, 0
  v_mov_b32 v59, 0
  s_add_u32 s13, s16, 3072
  s_add_u32 s14, s16, 2048
  s_lshl_b32 s29, s68, 2
  v_mov_b32 v15, s29
  s_mov_b32 s29, 0
mega0_kernel_cen18:
  buffer_load_dword v14, v15, s[44:47], 0 offen sc1
  s_waitcnt vmcnt(0)
  v_readfirstlane_b32 s27, v14
  s_nop 0
  s_and_b32 s28, s27, 63
  s_cmp_eq_u32 s28, 32
  s_cbranch_scc1 mega0_kernel_cen18_done
  s_sleep 4
  s_add_u32 s29, s29, 1
  s_cmp_lt_u32 s29, 262144
  s_cbranch_scc1 mega0_kernel_cen18
  s_branch mega_fail
mega0_kernel_cen18_done:
  s_cmp_eq_u32 s27, s69
  s_cselect_b32 s69, 0, 1
  s_cmp_eq_u32 s69, 0
  s_cbranch_scc1 mega_loop1
  s_branch mega_loop5
mega_pro2:
  ds_read_b64_tr_b16 v[136:137], v24 offset:38400
  ds_read_b64_tr_b16 v[138:139], v24 offset:38592
  ds_read_b64_tr_b16 v[140:141], v24 offset:42240
  ds_read_b64_tr_b16 v[142:143], v24 offset:42432
  ds_read_b64_tr_b16 v[144:145], v25 offset:38400
  ds_read_b64_tr_b16 v[146:147], v25 offset:38592
  ds_read_b64_tr_b16 v[148:149], v25 offset:42240
  ds_read_b64_tr_b16 v[150:151], v25 offset:42432
  ds_read_b64_tr_b16 v[152:153], v24 offset:46080
  ds_read_b64_tr_b16 v[154:155], v24 offset:46272
  ds_read_b64_tr_b16 v[156:157], v24 offset:49920
  ds_read_b64_tr_b16 v[158:159], v24 offset:50112
  ds_read_b64_tr_b16 v[160:161], v25 offset:46080
  ds_read_b64_tr_b16 v[162:163], v25 offset:46272
  ds_read_b64_tr_b16 v[164:165], v25 offset:49920
  ds_read_b64_tr_b16 v[166:167], v25 offset:50112
  ds_read_b64_tr_b16 v[168:169], v24 offset:53760
  ds_read_b64_tr_b16 v[170:171], v24 offset:53952
  ds_read_b64_tr_b16 v[172:173], v24 offset:57600
  ds_read_b64_tr_b16 v[174:175], v24 offset:57792
  ds_read_b64_tr_b16 v[176:177], v25 offset:53760
  ds_read_b64_tr_b16 v[178:179], v25 offset:53952
  ds_read_b64_tr_b16 v[180:181], v25 offset:57600
  ds_read_b64_tr_b16 v[182:183], v25 offset:57792
  ds_read_b64_tr_b16 v[184:185], v24 offset:38432
  ds_read_b64_tr_b16 v[186:187], v24 offset:38624
  ds_read_b64_tr_b16 v[188:189], v24 offset:42272
  ds_read_b64_tr_b16 v[190:191], v24 offset:42464
  ds_read_b64_tr_b16 v[192:193], v25 offset:38432
  ds_read_b64_tr_b16 v[194:195], v25 offset:38624
  ds_read_b64_tr_b16 v[196:197], v25 offset:42272
  ds_read_b64_tr_b16 v[198:199], v25 offset:42464
  ds_read_b64_tr_b16 v[200:201], v24 offset:46112
  ds_read_b64_tr_b16 v[202:203], v24 offset:46304
  ds_read_b64_tr_b16 v[204:205], v24 offset:49952
  ds_read_b64_tr_b16 v[206:207], v24 offset:50144
  ds_read_b64_tr_b16 v[208:209], v25 offset:46112
  ds_read_b64_tr_b16 v[210:211], v25 offset:46304
  ds_read_b64_tr_b16 v[212:213], v25 offset:49952
  ds_read_b64_tr_b16 v[214:215], v25 offset:50144
  ds_read_b64_tr_b16 v[216:217], v24 offset:53792
  ds_read_b64_tr_b16 v[218:219], v24 offset:53984
  ds_read_b64_tr_b16 v[220:221], v24 offset:57632
  ds_read_b64_tr_b16 v[222:223], v24 offset:57824
  ds_read_b64_tr_b16 v[224:225], v24 offset:38464
  ds_read_b64_tr_b16 v[226:227], v24 offset:38656
  ds_read_b64_tr_b16 v[228:229], v24 offset:42304
  ds_read_b64_tr_b16 v[230:231], v24 offset:42496
  ds_read_b64_tr_b16 v[232:233], v25 offset:38464
  ds_read_b64_tr_b16 v[234:235], v25 offset:38656
  ds_read_b64_tr_b16 v[236:237], v25 offset:42304
  ds_read_b64_tr_b16 v[238:239], v25 offset:42496
  ds_read_b64_tr_b16 v[240:241], v24 offset:46144
  ds_read_b64_tr_b16 v[242:243], v24 offset:46336
  ds_read_b64_tr_b16 v[244:245], v24 offset:49984
  ds_read_b64_tr_b16 v[246:247], v24 offset:50176
  ds_read_b64_tr_b16 v[248:249], v25 offset:46144
  ds_read_b64_tr_b16 v[250:251], v25 offset:46336
  ds_read_b64_tr_b16 v[252:253], v25 offset:49984
  ds_read_b64_tr_b16 v[254:255], v25 offset:50176
  v_accvgpr_write_b32 a160, v28
  v_accvgpr_write_b32 a161, v29
  v_accvgpr_write_b32 a162, v30
  v_accvgpr_write_b32 a163, v31
  v_accvgpr_write_b32 a164, v32
  v_accvgpr_write_b32 a165, v33
  v_accvgpr_write_b32 a166, v34
  v_accvgpr_write_b32 a167, v35
  v_accvgpr_write_b32 a168, v36
  v_accvgpr_write_b32 a169, v37
  v_accvgpr_write_b32 a170, v38
  v_accvgpr_write_b32 a171, v39
  v_accvgpr_write_b32 a172, v40
  v_accvgpr_write_b32 a173, v41
  v_accvgpr_write_b32 a174, v42
  v_accvgpr_write_b32 a175, v43
  v_lshrrev_b32 v20, 1, v18
  v_lshlrev_b32 v44, 6, v20
  v_and_b32 v20, 1, v18
  v_lshl_add_u32 v44, v20, 4, v44
  v_lshlrev_b32 v12, 8, v17
  v_lshl_add_u32 v12, v18, 4, v12
  v_add_u32 v13, 2048, v2
  v_lshlrev_b32 v60, 4, v17
  v_lshl_add_u32 v60, v16, 6, v60
  v_add_u32 v60, 2048, v60
  v_mov_b32 v66, v60
  v_and_b32 v20, 3, v18
  v_lshlrev_b32 v10, 5, v20
  v_lshrrev_b32 v20, 2, v18
  v_lshl_add_u32 v10, v20, 4, v10
  v_lshl_add_u32 v10, v17, 3, v10
  v_add_u32 v10, 496, v10
  v_and_b32 v21, 40, v1
  v_cmp_eq_u32 vcc, 32, v21
  v_mov_b32 v0, 0x40000000
  s_nop 0
  v_cndmask_b32 v10, v0, v10, vcc
  v_lshlrev_b32 v61, 4, v18
  v_lshl_add_u32 v62, v17, 7, v61
  v_and_b32 v20, 1, v17
  v_lshl_add_u32 v61, v20, 3, v61
  v_and_b32 v20, 2, v17
  v_add_u32 v20, v20, v19
  v_mul_u32_u24 v20, 163840, v20
  v_add_u32 v61, v61, v20
  v_lshlrev_b32 v20, 9, v19
  v_sub_u32 v60, v60, v20
  v_lshlrev_b32 v20, 7, v19
  v_sub_u32 v13, v13, v20
  v_lshl_add_u32 v63, v17, 3, v44
  s_lshr_b32 s27, s9, 1
  s_lshl_b32 s27, s27, 8
  s_and_b32 s28, s9, 1
  s_lshl_b32 s28, s28, 5
  s_add_u32 s27, s27, s28
  s_add_u32 s27, s27, 8192
  v_add_u32 v63, s27, v63
  v_cmp_eq_u32 vcc, 0, v21
  v_mov_b32 v0, 0x40000000
  s_nop 0
  v_cndmask_b32 v63, v0, v63, vcc
  v_cmp_gt_u32 vcc, 8, v16
  v_mov_b32 v0, 0x40000000
  s_nop 0
  v_cndmask_b32 v66, v0, v66, vcc
  s_lshl_b32 s27, s11, 9
  v_add_u32 v64, s27, v62
  v_lshrrev_b32 v65, 1, v64
  v_add_u32 v65, 2048, v65
  v_cmp_le_u32 vcc, 8, v16
  v_mov_b32 v0, 0x40000000
  s_nop 0
  v_cndmask_b32 v64, v0, v64, vcc
  v_cmp_le_u32 vcc, 8, v16
  v_mov_b32 v0, 0x40000000
  s_nop 0
  v_cndmask_b32 v65, v0, v65, vcc
  v_mov_b32 v67, 0
  v_cmp_eq_u32 vcc, 0, v1
  v_mov_b32 v0, 0x40000000
  s_nop 0
  v_cndmask_b32 v67, v0, v67, vcc
  v_mov_b32 v118, 0
  v_mov_b32 v119, 0
  v_mov_b32 v126, 0
  v_mov_b32 v127, 0
  v_mov_b32 v132, -1
  v_mov_b32 v133, -1
  v_mov_b32 v134, -1
  v_mov_b32 v135, -1
  s_add_u32 s38, s32, s39
  s_add_u32 s39, s39, 655360
  s_cmp_eq_u32 s39, 1966080
  s_cselect_b32 s39, 0, s39
  s_add_u32 s37, s32, s39
  s_add_u32 s33, s30, s39
  s_add_u32 s34, s33, 327680
  s_add_u32 s35, s31, s39
  s_add_u32 s36, s35, 327680
  s_waitcnt lgkmcnt(0)
  v_mov_b32 v28, 0
  v_mov_b32 v29, 0
  v_mov_b32 v30, 0
  v_mov_b32 v31, 0
  v_mov_b32 v32, 0
  v_mov_b32 v33, 0
  v_mov_b32 v34, 0
  v_mov_b32 v35, 0
  v_mov_b32 v36, 0
  v_mov_b32 v37, 0
  v_mov_b32 v38, 0
  v_mov_b32 v39, 0
  v_mov_b32 v40, 0
  v_mov_b32 v41, 0
  v_mov_b32 v42, 0
  v_mov_b32 v43, 0
  v_mov_b32 v44, 0
  v_mov_b32 v45, 0
  v_mov_b32 v46, 0
  v_mov_b32 v47, 0
  v_mov_b32 v48, 0
  v_mov_b32 v49, 0
  v_mov_b32 v50, 0
  v_mov_b32 v51, 0
  v_mov_b32 v52, 0
  v_mov_b32 v53, 0
  v_mov_b32 v54, 0
  v_mov_b32 v55, 0
  v_mov_b32 v56, 0
  v_mov_b32 v57, 0
  v_mov_b32 v58, 0
  v_mov_b32 v59, 0
  s_add_u32 s13, s16, 5120
  s_add_u32 s14, s16, 7168
  s_lshl_b32 s29, s68, 2
  v_mov_b32 v15, s29
  s_mov_b32 s29, 0
mega0_kernel_cen19:
  buffer_load_dword v14, v15, s[44:47], 0 offen sc1
  s_waitcnt vmcnt(0)
  v_readfirstlane_b32 s27, v14
  s_nop 0
  s_and_b32 s28, s27, 63
  s_cmp_eq_u32 s28, 32
  s_cbranch_scc1 mega0_kernel_cen19_done
  s_sleep 4
  s_add_u32 s29, s29, 1
  s_cmp_lt_u32 s29, 262144
  s_cbranch_scc1 mega0_kernel_cen19
  s_branch mega_fail
mega0_kernel_cen19_done:
  s_cmp_eq_u32 s27, s69
  s_cselect_b32 s69, 0, 1
  s_cmp_eq_u32 s69, 0
  s_cbranch_scc1 mega_loop2
  s_branch mega_loop6
mega_pro3:
  ds_read_b64_tr_b16 v[136:137], v26 offset:3136
  ds_read_b64_tr_b16 v[138:139], v26 offset:3328
  ds_read_b64_tr_b16 v[140:141], v26 offset:18496
  ds_read_b64_tr_b16 v[142:143], v26 offset:18688
  ds_read_b64_tr_b16 v[144:145], v27 offset:3136
  ds_read_b64_tr_b16 v[146:147], v27 offset:3328
  ds_read_b64_tr_b16 v[148:149], v27 offset:18496
  ds_read_b64_tr_b16 v[150:151], v27 offset:18688
  ds_read_b64_tr_b16 v[152:153], v26 offset:33856
  ds_read_b64_tr_b16 v[154:155], v26 offset:34048
  ds_read_b64_tr_b16 v[156:157], v26 offset:49216
  ds_read_b64_tr_b16 v[158:159], v26 offset:49408
  ds_read_b64_tr_b16 v[160:161], v27 offset:33856
  ds_read_b64_tr_b16 v[162:163], v27 offset:34048
  ds_read_b64_tr_b16 v[164:165], v27 offset:49216
  ds_read_b64_tr_b16 v[166:167], v27 offset:49408
  ds_read_b64_tr_b16 v[168:169], v24 offset:53824
  ds_read_b64_tr_b16 v[170:171], v24 offset:54016
  ds_read_b64_tr_b16 v[172:173], v24 offset:57664
  ds_read_b64_tr_b16 v[174:175], v24 offset:57856
  ds_read_b64_tr_b16 v[176:177], v25 offset:53824
  ds_read_b64_tr_b16 v[178:179], v25 offset:54016
  ds_read_b64_tr_b16 v[180:181], v25 offset:57664
  ds_read_b64_tr_b16 v[182:183], v25 offset:57856
  ds_read_b64_tr_b16 v[184:185], v26 offset:3104
  ds_read_b64_tr_b16 v[186:187], v26 offset:3296
  ds_read_b64_tr_b16 v[188:189], v26 offset:18464
  ds_read_b64_tr_b16 v[190:191], v26 offset:18656
  ds_read_b64_tr_b16 v[192:193], v27 offset:3104
  ds_read_b64_tr_b16 v[194:195], v27 offset:3296
  ds_read_b64_tr_b16 v[196:197], v27 offset:18464
  ds_read_b64_tr_b16 v[198:199], v27 offset:18656
  ds_read_b64_tr_b16 v[200:201], v26 offset:33824
  ds_read_b64_tr_b16 v[202:203], v26 offset:34016
  ds_read_b64_tr_b16 v[204:205], v26 offset:49184
  ds_read_b64_tr_b16 v[206:207], v26 offset:49376
  ds_read_b64_tr_b16 v[208:209], v27 offset:33824
  ds_read_b64_tr_b16 v[210:211], v27 offset:34016
  ds_read_b64_tr_b16 v[212:213], v27 offset:49184
  ds_read_b64_tr_b16 v[214:215], v27 offset:49376
  ds_read_b64_tr_b16 v[216:217], v25 offset:53792
  ds_read_b64_tr_b16 v[218:219], v25 offset:53984
  ds_read_b64_tr_b16 v[220:221], v25 offset:57632
  ds_read_b64_tr_b16 v[222:223], v25 offset:57824
  ds_read_b64_tr_b16 v[224:225], v26 offset:3072
  ds_read_b64_tr_b16 v[226:227], v26 offset:3264
  ds_read_b64_tr_b16 v[228:229], v26 offset:18432
  ds_read_b64_tr_b16 v[230:231], v26 offset:18624
  ds_read_b64_tr_b16 v[232:233], v27 offset:3072
  ds_read_b64_tr_b16 v[234:235], v27 offset:3264
  ds_read_b64_tr_b16 v[236:237], v27 offset:18432
  ds_read_b64_tr_b16 v[238:239], v27 offset:18624
  ds_read_b64_tr_b16 v[240:241], v26 offset:33792
  ds_read_b64_tr_b16 v[242:243], v26 offset:33984
  ds_read_b64_tr_b16 v[244:245], v26 offset:49152
  ds_read_b64_tr_b16 v[246:247], v26 offset:49344
  ds_read_b64_tr_b16 v[248:249], v27 offset:33792
  ds_read_b64_tr_b16 v[250:251], v27 offset:33984
  ds_read_b64_tr_b16 v[252:253], v27 offset:49152
  ds_read_b64_tr_b16 v[254:255], v27 offset:49344
  buffer_load_dwordx4 a[160:163], v23, s[4:7], s53 offen offset:0
  buffer_load_dwordx4 a[164:167], v23, s[4:7], s53 offen offset:1024
  buffer_load_dwordx4 a[168:171], v23, s[4:7], s53 offen offset:2048
  buffer_load_dwordx4 a[172:175], v23, s[4:7], s53 offen offset:3072
  s_add_u32 s53, s53, 4096
  buffer_load_dwordx4 a[176:179], v23, s[4:7], s53 offen offset:0
  buffer_load_dwordx4 a[180:183], v23, s[4:7], s53 offen offset:1024
  buffer_load_dwordx4 a[184:187], v23, s[4:7], s53 offen offset:2048
  buffer_load_dwordx4 a[188:191], v23, s[4:7], s53 offen offset:3072
  s_add_u32 s53, s53, 4096
  buffer_load_dwordx4 a[192:195], v23, s[4:7], s53 offen offset:0
  buffer_load_dwordx4 a[196:199], v23, s[4:7], s53 offen offset:1024
  buffer_load_dwordx4 a[200:203], v23, s[4:7], s53 offen offset:2048
  buffer_load_dwordx4 a[204:207], v23, s[4:7], s53 offen offset:3072
  s_add_u32 s53, s53, 4096
  buffer_load_dwordx4 a[208:211], v23, s[4:7], s53 offen offset:0
  buffer_load_dwordx4 a[212:215], v23, s[4:7], s53 offen offset:1024
  buffer_load_dwordx4 a[216:219], v23, s[4:7], s53 offen offset:2048
  buffer_load_dwordx4 a[220:223], v23, s[4:7], s53 offen offset:3072
  s_add_u32 s53, s53, 4096
  buffer_load_dwordx4 a[224:227], v23, s[4:7], s53 offen offset:0
  buffer_load_dwordx4 a[228:231], v23, s[4:7], s53 offen offset:1024
  buffer_load_dwordx4 a[232:235], v23, s[4:7], s53 offen offset:2048
  buffer_load_dwordx4 a[236:239], v23, s[4:7], s53 offen offset:3072
  s_add_u32 s53, s53, 4096
  s_add_u32 s53, s53, 1617920
  ds_write_b128 v2, v[28:31] offset:37888
  ds_write_b128 v2, v[32:35] offset:38912
  ds_write_b128 v2, v[36:39] offset:39936
  v_lshlrev_b32 v10, 2, v17
  v_lshl_add_u32 v10, v18, 4, v10
  v_lshl_add_u32 v10, v19, 8, v10
  v_lshrrev_b32 v20, 5, v1
  v_mul_u32_u24 v20, 38400, v20
  v_add_u32 v11, v20, v2
  v_and_b32 v20, 3, v1
  v_lshlrev_b32 v20, 7, v20
  s_lshl_b32 s27, s68, 9
  s_and_b32 s28, s9, 12
  s_add_u32 s27, s27, s28
  s_add_u32 s27, s27, 12288
  v_add_u32 v20, s27, v20
  s_add_u32 s27, s54, 0
  v_mov_b32 v21, s27
  v_and_b32 v12, 4, v1
  v_cmp_eq_u32 vcc, 0, v12
  s_nop 1
  v_cndmask_b32 v12, v21, v20, vcc
  s_waitcnt vmcnt(40)
  buffer_load_dwordx4 a[240:243], v23, s[4:7], s53 offen offset:0
  buffer_load_dwordx4 a[244:247], v23, s[4:7], s53 offen offset:1024
  buffer_load_dwordx4 a[248:251], v23, s[4:7], s53 offen offset:2048
  buffer_load_dwordx4 a[252:255], v23, s[4:7], s53 offen offset:3072
  s_add_u32 s53, s53, 4096
  buffer_load_dwordx4 v[72:75], v23, s[4:7], s53 offen offset:0
  buffer_load_dwordx4 v[76:79], v23, s[4:7], s53 offen offset:1024
  buffer_load_dwordx4 v[80:83], v23, s[4:7], s53 offen offset:2048
  buffer_load_dwordx4 v[84:87], v23, s[4:7], s53 offen offset:3072
  s_add_u32 s53, s53, 4096
  buffer_load_dwordx4 v[88:91], v23, s[4:7], s53 offen offset:0
  buffer_load_dwordx4 v[92:95], v23, s[4:7], s53 offen offset:1024
  buffer_load_dwordx4 v[96:99], v23, s[4:7], s53 offen offset:2048
  buffer_load_dwordx4 v[100:103], v23, s[4:7], s53 offen offset:3072
  s_add_u32 s53, s53, 4096
  buffer_load_dwordx4 v[104:107], v23, s[4:7], s53 offen offset:0
  buffer_load_dwordx4 v[108:111], v23, s[4:7], s53 offen offset:1024
  buffer_load_dwordx4 v[112:115], v23, s[4:7], s53 offen offset:2048
  buffer_load_dwordx4 v[116:119], v23, s[4:7], s53 offen offset:3072
  s_add_u32 s53, s53, 4096
  buffer_load_dwordx4 v[120:123], v23, s[4:7], s53 offen offset:0
  buffer_load_dwordx4 v[124:127], v23, s[4:7], s53 offen offset:1024
  buffer_load_dwordx4 v[128:131], v23, s[4:7], s53 offen offset:2048
  buffer_load_dwordx4 v[132:135], v23, s[4:7], s53 offen offset:3072
  s_add_u32 s53, s53, 4096
  s_waitcnt lgkmcnt(0)
  v_mov_b32 v28, 0
  v_mov_b32 v29, 0
  v_mov_b32 v30, 0
  v_mov_b32 v31, 0
  v_mov_b32 v32, 0
  v_mov_b32 v33, 0
  v_mov_b32 v34, 0
  v_mov_b32 v35, 0
  v_mov_b32 v36, 0
  v_mov_b32 v37, 0
  v_mov_b32 v38, 0
  v_mov_b32 v39, 0
  v_mov_b32 v40, 0
  v_mov_b32 v41, 0
  v_mov_b32 v42, 0
  v_mov_b32 v43, 0
  v_mov_b32 v44, 0
  v_mov_b32 v45, 0
  v_mov_b32 v46, 0
  v_mov_b32 v47, 0
  v_mov_b32 v48, 0
  v_mov_b32 v49, 0
  v_mov_b32 v50, 0
  v_mov_b32 v51, 0
  v_mov_b32 v52, 0
  v_mov_b32 v53, 0
  v_mov_b32 v54, 0
  v_mov_b32 v55, 0
  v_mov_b32 v56, 0
  v_mov_b32 v57, 0
  v_mov_b32 v58, 0
  v_mov_b32 v59, 0
  v_mov_b32 v60, 0
  v_mov_b32 v61, 0
  v_mov_b32 v62, 0
  v_mov_b32 v63, 0
  v_mov_b32 v64, 0
  v_mov_b32 v65, 0
  v_mov_b32 v66, 0
  v_mov_b32 v67, 0
  s_add_u32 s13, s16, 8192
  s_add_u32 s14, s16, 7168
  s_lshl_b32 s29, s68, 2
  v_mov_b32 v15, s29
  s_mov_b32 s29, 0
mega0_kernel_cen20:
  buffer_load_dword v14, v15, s[44:47], 0 offen sc1
  s_waitcnt vmcnt(0)
  v_readfirstlane_b32 s27, v14
  s_nop 0
  s_and_b32 s28, s27, 63
  s_cmp_eq_u32 s28, 32
  s_cbranch_scc1 mega0_kernel_cen20_done
  s_sleep 4
  s_add_u32 s29, s29, 1
  s_cmp_lt_u32 s29, 262144
  s_cbranch_scc1 mega0_kernel_cen20
  s_branch mega_fail
mega0_kernel_cen20_done:
  s_cmp_eq_u32 s27, s69
  s_cselect_b32 s69, 0, 1
  s_add_u32 s29, s12, 1
  s_cmp_lt_u32 s76, s29
  s_cbranch_scc1 mega0_kernel_sd21_wait
mega0_kernel_sd21_go:
  s_mov_b32 m0, 34816
  s_add_u32 s27, s22, 0
  buffer_load_dwordx4 v2, s[4:7], s27 offen sc1 lds
  s_mov_b32 m0, 35840
  s_add_u32 s27, s22, 4096
  buffer_load_dwordx4 v2, s[4:7], s27 offen sc1 lds
  s_mov_b32 m0, 36864
  s_add_u32 s27, s22, 8192
  buffer_load_dwordx4 v2, s[4:7], s27 offen sc1 lds
  s_mov_b32 m0, 24576
  s_add_u32 s27, s24, 0
  buffer_load_dwordx4 v2, s[4:7], s27 offen sc1 lds
  s_mov_b32 m0, 25600
  s_add_u32 s27, s24, 1024
  buffer_load_dwordx4 v2, s[4:7], s27 offen sc1 lds
  s_mov_b32 m0, 26624
  s_add_u32 s27, s24, 2048
  buffer_load_dwordx4 v11, s[4:7], s27 offen sc1 lds
  s_mov_b32 m0, 27648
  s_add_u32 s27, s24, 41472
  buffer_load_dwordx4 v2, s[4:7], s27 offen sc1 lds
  s_mov_b32 m0, 28672
  s_add_u32 s27, s24, 42496
  buffer_load_dwordx4 v2, s[4:7], s27 offen sc1 lds
  s_mov_b32 m0, 29696
  s_add_u32 s27, s24, 81920
  buffer_load_dwordx4 v2, s[4:7], s27 offen sc1 lds
  s_mov_b32 m0, 30720
  s_add_u32 s27, s24, 82944
  buffer_load_dwordx4 v2, s[4:7], s27 offen sc1 lds
  s_mov_b32 m0, 31744
  s_add_u32 s27, s24, 83968
  buffer_load_dwordx4 v11, s[4:7], s27 offen sc1 lds
  s_mov_b32 m0, 32768
  s_add_u32 s27, s24, 123392
  buffer_load_dwordx4 v2, s[4:7], s27 offen sc1 lds
  s_mov_b32 m0, 33792
  s_add_u32 s27, s24, 124416
  buffer_load_dwordx4 v2, s[4:7], s27 offen sc1 lds
  buffer_load_dword v13, v12, s[4:7], s71 offen sc1
  s_add_u32 s72, s72, 1
  s_cmp_eq_u32 s72, 6
  s_cselect_b32 s72, 0, s72
  s_mov_b32 s73, 325632
  s_cselect_b32 s73, 0xffe72800, s73
  s_add_u32 s22, s22, s73
  s_add_u32 s24, s24, s73
  s_cmp_eq_u32 s69, 0
  s_cbranch_scc1 mega_loop3
  s_branch mega_loop7
mega_loop0:
  buffer_load_dwordx4 v[16:19], v2, s[4:7], s13 offen sc1
  buffer_load_dwordx4 v[20:23], v2, s[4:7], s13 offen offset:1024 sc1
  buffer_load_dwordx4 v[24:27], v2, s[4:7], s14 offen sc1
mega_loop0_pc:
  buffer_load_dwordx4 v[16:19], v2, s[4:7], s13 offen sc1
  buffer_load_dwordx4 v[20:23], v2, s[4:7], s13 offen offset:1024 sc1
  buffer_load_dwordx4 v[24:27], v2, s[4:7], s14 offen sc1
  s_waitcnt vmcnt(3)
  v_max3_u32 v14, v16, v17, v18
  v_max3_u32 v14, v14, v19, v20
  v_smfmac_f32_16x16x64_bf16 v[28:31], v[16:19], v[136:143], v9
  v_max3_u32 v14, v14, v21, v22
  v_smfmac_f32_16x16x64_bf16 v[32:35], v[16:19], v[144:151], v9
  v_max3_u32 v14, v14, v23, v24
  v_smfmac_f32_16x16x64_bf16 v[28:31], v[20:23], v[152:159], v9
  v_max3_u32 v14, v14, v25, v26
  v_smfmac_f32_16x16x64_bf16 v[32:35], v[20:23], v[160:167], v9
  v_max_u32 v14, v14, v27
  v_smfmac_f32_16x16x64_bf16 v[28:31], v[24:27], v[168:175], v9
  v_cmp_eq_u32 vcc, -1, v14
  v_smfmac_f32_16x16x64_bf16 v[32:35], v[24:27], v[176:183], v9
  s_cbranch_vccnz mega_loop0_pcf
  ds_write_b128 v2, v[16:19] offset:0
  v_smfmac_f32_16x16x64_bf16 v[36:39], v[16:19], v[184:191], v9
  ds_write_b128 v2, v[20:23] offset:1024
  v_smfmac_f32_16x16x64_bf16 v[40:43], v[16:19], v[192:199], v9
  ds_write_b128 v2, v[24:27] offset:2048
  v_smfmac_f32_16x16x64_bf16 v[36:39], v[20:23], v[200:207], v9
  v_pk_add_f32 v[28:29], v[28:29], v[30:31]
  v_smfmac_f32_16x16x64_bf16 v[40:43], v[20:23], v[208:215], v9
  v_pk_add_f32 v[32:33], v[32:33], v[34:35]
  v_smfmac_f32_16x16x64_bf16 v[36:39], v[24:27], v[216:223], v9
  v_cvt_pk_bf16_f32 v30, v28, v29
  v_smfmac_f32_16x16x64_bf16 v[44:47], v[16:19], v[224:231], v9
  v_cvt_pk_bf16_f32 v31, v32, v33
  v_smfmac_f32_16x16x64_bf16 v[48:51], v[16:19], v[232:239], v9
  ds_write_b64 v3, v[30:31] offset:10240
  v_smfmac_f32_16x16x64_bf16 v[44:47], v[20:23], v[240:247], v9
  v_pk_add_f32 v[36:37], v[36:37], v[38:39]
  v_smfmac_f32_16x16x64_bf16 v[48:51], v[20:23], v[248:255], v9
  v_pk_add_f32 v[40:41], v[40:41], v[42:43]
  v_cvt_pk_bf16_f32 v38, v36, v37
  v_cvt_pk_bf16_f32 v39, v40, v41
  ds_write_b64 v3, v[38:39] offset:12288
  v_smfmac_f32_16x16x64_bf16 v[52:55], v[16:19], a[0:7], v9
  v_pk_add_f32 v[44:45], v[44:45], v[46:47]
  s_nop 1
  v_pk_add_f32 v[48:49], v[48:49], v[50:51]
  v_cvt_pk_bf16_f32 v46, v44, v45
  v_cvt_pk_bf16_f32 v47, v48, v49
  ds_write_b64 v3, v[46:47] offset:14336
  v_smfmac_f32_16x16x64_bf16 v[56:59], v[16:19], a[80:87], v9
  v_smfmac_f32_16x16x64_bf16 v[52:55], v[20:23], a[8:15], v9
  v_smfmac_f32_16x16x64_bf16 v[56:59], v[20:23], a[88:95], v9
  s_waitcnt lgkmcnt(0)
  s_barrier
  ds_read_b128 v[28:31], v2 offset:10240
  ds_read_b128 v[32:35], v2 offset:11264
  ds_read_b128 v[36:39], v2 offset:12288
  ds_read_b128 v[40:43], v2 offset:13312
  ds_read_b128 v[44:47], v2 offset:14336
  ds_read_b128 v[48:51], v2 offset:15360
  ds_read_b128 v[120:123], v11 offset:34816
  ds_read_b64 v[124:125], v11 offset:36864
  v_smfmac_f32_16x16x64_bf16 v[52:55], v[24:27], a[16:23], v9
  v_smfmac_f32_16x16x64_bf16 v[56:59], v[24:27], a[96:103], v9
  s_waitcnt lgkmcnt(7)
  v_mfma_f32_16x16x32_bf16 v[100:103], v[28:31], a[172:175], 0
  ds_read_b128 v[72:75], v2 offset:3072
  s_waitcnt lgkmcnt(7)
  v_mfma_f32_16x16x32_bf16 v[100:103], v[32:35], a[172:175], v[100:103]
  ds_read_b128 v[76:79], v2 offset:4096
  s_waitcnt lgkmcnt(7)
  v_mfma_f32_16x16x32_bf16 v[104:107], v[36:39], a[172:175], 0
  ds_read_b128 v[80:83], v2 offset:5120
  s_waitcnt lgkmcnt(7)
  v_mfma_f32_16x16x32_bf16 v[104:107], v[40:43], a[172:175], v[104:107]
  ds_read_b128 v[84:87], v2 offset:6144
  s_waitcnt lgkmcnt(7)
  v_mfma_f32_16x16x32_bf16 v[108:111], v[44:47], a[172:175], 0
  ds_read_b128 v[88:91], v2 offset:7168
  v_cvt_pk_bf16_f32 v112, v100, v101
  v_cvt_pk_bf16_f32 v113, v102, v103
  s_waitcnt lgkmcnt(7)
  v_mfma_f32_16x16x32_bf16 v[108:111], v[48:51], a[172:175], v[108:111]
  ds_read_b128 v[92:95], v2 offset:8192
  v_cvt_pk_bf16_f32 v114, v104, v105
  v_cvt_pk_bf16_f32 v115, v106, v107
  ds_read_b128 v[96:99], v2 offset:9216
  s_waitcnt lgkmcnt(7)
  v_mfma_f32_16x16x32_bf16 v[128:131], v[120:123], v[112:115], 0
  s_nop 1
  v_cvt_pk_bf16_f32 v116, v108, v109
  v_cvt_pk_bf16_f32 v117, v110, v111
  s_nop 1
  v_mfma_f32_16x16x32_bf16 v[128:131], v[124:127], v[116:119], v[128:131]
  s_waitcnt lgkmcnt(6)
  v_smfmac_f32_16x16x64_bf16 v[52:55], v[72:75], a[24:31], v9
  ds_read_b128 a[176:179], v60 offset:24576
  ds_read_b128 a[180:183], v60 offset:27136
  ds_read_b128 a[184:187], v60 offset:29696
  ds_read_b128 a[188:191], v60 offset:32256
  s_nop 0
  v_cvt_pk_bf16_f32 v68, v128, v129
  v_cvt_pk_bf16_f32 v69, v130, v131
  v_min_u32 v68, -2, v68
  v_min_u32 v69, -2, v69
  buffer_store_dwordx2 v[68:69], v10, s[4:7], s18 offen
  s_cmp_eq_u32 s12, 63
  s_cbranch_scc1 mega_loop0_last
  v_smfmac_f32_16x16x64_bf16 v[56:59], v[72:75], a[104:111], v9
  s_waitcnt lgkmcnt(4)
  buffer_store_dwordx2 v[132:133], v10, s[4:7], s19 offen
  v_smfmac_f32_16x16x64_bf16 v[52:55], v[76:79], a[32:39], v9
  v_smfmac_f32_16x16x64_bf16 v[56:59], v[76:79], a[112:119], v9
  v_smfmac_f32_16x16x64_bf16 v[52:55], v[80:83], a[40:47], v9
  v_smfmac_f32_16x16x64_bf16 v[56:59], v[80:83], a[120:127], v9
  v_smfmac_f32_16x16x64_bf16 v[52:55], v[84:87], a[48:55], v9
  v_smfmac_f32_16x16x64_bf16 v[56:59], v[84:87], a[128:135], v9
  buffer_load_dwordx4 v[16:19], v4, s[4:7], s20 offen sc1
  v_smfmac_f32_16x16x64_bf16 v[52:55], v[88:91], a[56:63], v9
  buffer_load_dwordx4 v[20:23], v4, s[4:7], s20 offen offset:256 sc1
  v_smfmac_f32_16x16x64_bf16 v[56:59], v[88:91], a[136:143], v9
  buffer_load_dwordx4 v[24:27], v5, s[4:7], s20 offen offset:512 sc1
  v_smfmac_f32_16x16x64_bf16 v[52:55], v[92:95], a[64:71], v9
  v_smfmac_f32_16x16x64_bf16 v[56:59], v[92:95], a[144:151], v9
  v_smfmac_f32_16x16x64_bf16 v[52:55], v[96:99], a[72:79], v9
  v_smfmac_f32_16x16x64_bf16 v[56:59], v[96:99], a[152:159], v9
  s_nop 4
  v_pk_add_f32 v[52:53], v[52:53], v[54:55]
  v_cvt_pk_bf16_f32 v52, v52, v53
  ds_write_b32 v8, v52 offset:21504
  v_pk_add_f32 v[56:57], v[56:57], v[58:59]
  v_cvt_pk_bf16_f32 v56, v56, v57
  ds_write_b32 v8, v56 offset:22528
mega_loop0_pa:
  buffer_load_dwordx4 v[16:19], v4, s[4:7], s20 offen sc1
  buffer_load_dwordx4 v[20:23], v4, s[4:7], s20 offen offset:256 sc1
  buffer_load_dwordx4 v[24:27], v5, s[4:7], s20 offen offset:512 sc1
  s_waitcnt vmcnt(3)
  v_max3_u32 v14, v16, v17, v18
  v_max3_u32 v14, v14, v19, v20
  v_mfma_f32_16x16x32_bf16 v[40:43], v[16:19], a[160:163], 0
  v_max3_u32 v14, v14, v21, v22
  v_max3_u32 v14, v14, v23, v24
  v_mfma_f32_16x16x32_bf16 v[40:43], v[20:23], a[164:167], v[40:43]
  v_max3_u32 v14, v14, v25, v26
  v_max_u32 v14, v14, v27
  v_mfma_f32_16x16x32_bf16 v[44:47], v[24:27], a[168:171], 0
  v_cmp_eq_u32 vcc, -1, v14
  s_nop 0
  s_cbranch_vccnz mega_loop0_paf
  s_nop 1
  v_max3_f32 v48, v40, v41, v42
  s_nop 1
  v_cndmask_b32 v44, v44, v45, s[42:43]
  v_max3_f32 v48, v48, v43, v44
  s_nop 1
  v_max_f32_dpp v48, v48, v48 quad_perm:[1,0,3,2] row_mask:0xf bank_mask:0xf
  s_nop 1
  v_max_f32_dpp v48, v48, v48 quad_perm:[2,3,0,1] row_mask:0xf bank_mask:0xf
  s_nop 1
  v_max_f32_dpp v48, v48, v48 row_half_mirror row_mask:0xf bank_mask:0xf
  v_mul_f32 v48, s26, v48
  v_fma_f32 v40, v40, s26, -v48
  v_fma_f32 v41, v41, s26, -v48
  v_fma_f32 v42, v42, s26, -v48
  v_fma_f32 v43, v43, s26, -v48
  v_fma_f32 v44, v44, s26, -v48
  v_exp_f32 v40, v40
  v_exp_f32 v41, v41
  v_exp_f32 v42, v42
  v_exp_f32 v43, v43
  v_exp_f32 v44, v44
  v_add_f32 v48, v40, v41
  v_add_f32 v49, v42, v43
  v_add_f32 v48, v48, v49
  v_add_f32 v48, v48, v44
  s_nop 1
  v_add_f32_dpp v48, v48, v48 quad_perm:[1,0,3,2] row_mask:0xf bank_mask:0xf
  s_nop 1
  v_add_f32_dpp v48, v48, v48 quad_perm:[2,3,0,1] row_mask:0xf bank_mask:0xf
  s_nop 1
  v_add_f32_dpp v48, v48, v48 row_half_mirror row_mask:0xf bank_mask:0xf
  v_rcp_f32 v48, v48
  s_nop 0
  v_pk_mul_f32 v[40:41], v[40:41], v[48:49] op_sel_hi:[1,0]
  v_pk_mul_f32 v[42:43], v[42:43], v[48:49] op_sel_hi:[1,0]
  v_mul_f32 v44, v44, v48
  v_cvt_pk_bf16_f32 v40, v40, v41
  v_cvt_pk_bf16_f32 v41, v42, v43
  ds_write_b64 v6, v[40:41] offset:16384
  v_cvt_pk_bf16_f32 v44, v44, v44
  ds_write_b16 v7, v44 offset:20480
  s_waitcnt lgkmcnt(0)
  s_barrier
  ds_read_b128 v[72:75], v12 offset:16384
  ds_read_b128 v[76:79], v12 offset:17408
  ds_read_b128 v[80:83], v12 offset:18432
  ds_read_b128 v[84:87], v12 offset:19456
  ds_read_b128 v[88:91], v12 offset:20480
  ds_read_b128 v[92:95], v13 offset:21504
  s_waitcnt lgkmcnt(5)
  v_mfma_f32_16x16x32_bf16 v[128:131], a[176:179], v[72:75], 0
  s_waitcnt lgkmcnt(4)
  v_mfma_f32_16x16x32_bf16 v[128:131], a[180:183], v[76:79], v[128:131]
  s_waitcnt lgkmcnt(3)
  v_mfma_f32_16x16x32_bf16 v[128:131], a[184:187], v[80:83], v[128:131]
  s_waitcnt lgkmcnt(2)
  v_mfma_f32_16x16x32_bf16 v[128:131], a[188:191], v[84:87], v[128:131]
  s_waitcnt lgkmcnt(0)
  v_mfma_f32_16x16x32_bf16 v[128:131], v[92:95], v[88:91], v[128:131]
  v_mov_b32 v28, 0
  v_mov_b32 v29, 0
  v_mov_b32 v30, 0
  v_mov_b32 v31, 0
  v_mov_b32 v32, 0
  v_mov_b32 v33, 0
  v_mov_b32 v34, 0
  s_nop 0
  v_cvt_pk_bf16_f32 v68, v128, v129
  v_cvt_pk_bf16_f32 v69, v130, v131
  v_min_u32 v71, -2, v69
  v_min_u32 v70, -2, v68
  v_min_u32 v69, -2, v69
  v_min_u32 v68, -2, v68
  s_nop 1
  v_permlane16_swap_b32 v68, v70
  v_permlane16_swap_b32 v69, v71
  buffer_store_dwordx4 v[68:71], v61, s[4:7], s33 offen sc1
  buffer_store_dwordx4 v[68:71], v61, s[4:7], s35 offen sc1
  v_mov_b32 v35, 0
  v_mov_b32 v36, 0
  v_mov_b32 v37, 0
  v_mov_b32 v38, 0
  v_mov_b32 v39, 0
  v_mov_b32 v40, 0
  v_mov_b32 v41, 0
  v_mov_b32 v42, 0
  v_mov_b32 v43, 0
  v_mov_b32 v44, 0
  v_mov_b32 v45, 0
  v_mov_b32 v46, 0
  v_mov_b32 v47, 0
  v_mov_b32 v48, 0
  v_mov_b32 v49, 0
  v_mov_b32 v50, 0
  v_mov_b32 v51, 0
  v_mov_b32 v52, 0
  v_mov_b32 v53, 0
  v_mov_b32 v54, 0
  v_mov_b32 v55, 0
  v_mov_b32 v56, 0
  v_mov_b32 v57, 0
  v_mov_b32 v58, 0
  v_mov_b32 v59, 0
  s_xor_b32 s18, s18, s19
  s_xor_b32 s19, s19, s18
  s_xor_b32 s18, s18, s19
  s_xor_b32 s20, s20, s21
  s_xor_b32 s21, s21, s20
  s_xor_b32 s20, s20, s21
  s_add_u32 s72, s72, 1
  s_cmp_eq_u32 s72, 6
  s_cselect_b32 s72, 0, s72
  s_mov_b32 s73, 325632
  s_cselect_b32 s73, 0xffe72800, s73
  s_add_u32 s23, s23, s73
  s_mov_b32 s15, 0
  s_nop 15
  s_nop 15
  s_nop 15
  s_nop 15
  s_nop 9
  buffer_load_dwordx4 v[96:99], v62, s[4:7], s37 offen offset:0 sc1
  buffer_load_dwordx4 v[100:103], v62, s[4:7], s37 offen offset:1024 sc1
  s_barrier
  buffer_store_dwordx4 v[92:95], v66, s[4:7], s25 offen
  buffer_store_dwordx4 v[132:135], v2, s[4:7], s38 offen offset:0 sc1
  buffer_store_dwordx4 v[132:135], v2, s[4:7], s38 offen offset:1024 sc1
  s_add_u32 s25, s25, s73
  s_waitcnt vmcnt(3)
  v_max3_u32 v14, v96, v97, v98
  v_max3_u32 v14, v14, v99, v100
  v_mfma_f32_16x16x32_bf16 v[128:131], a[160:163], v[96:99], 0
  v_max3_u32 v14, v14, v101, v102
  v_max_u32 v14, v14, v103
  v_mfma_f32_16x16x32_bf16 v[128:131], a[160:163], v[100:103], v[128:131]
  v_cmp_eq_u32 vcc, -1, v14
  s_nop 0
  s_cbranch_vccnz mega_loop0_pbf
mega_loop0_pbok:
  s_nop 4
  v_cvt_pk_bf16_f32 v68, v128, v129
  v_cvt_pk_bf16_f32 v69, v130, v131
  v_min_u32 v68, -2, v68
  v_min_u32 v69, -2, v69
  buffer_store_dwordx2 v[68:69], v63, s[4:7], s17 offen
  buffer_store_dwordx2 v[132:133], v63, s[4:7], s16 offen
  s_add_u32 s12, s12, 1
  s_xor_b32 s16, s16, s17
  s_xor_b32 s17, s17, s16
  s_xor_b32 s16, s16, s17
  s_add_u32 s13, s16, 0
  s_add_u32 s14, s16, 2048
  s_add_u32 s38, s32, s39
  s_add_u32 s39, s39, 655360
  s_cmp_eq_u32 s39, 1966080
  s_cselect_b32 s39, 0, s39
  s_add_u32 s37, s32, s39
  s_add_u32 s33, s30, s39
  s_add_u32 s34, s33, 327680
  s_add_u32 s35, s31, s39
  s_add_u32 s36, s35, 327680
  s_barrier
  s_nop 3
  s_branch mega_loop0
mega0_kernel_sd21_wait:
  s_mov_b32 s15, 0
mega0_kernel_sd21_w2:
  buffer_load_dword v13, v12, s[4:7], s71 offen sc1
  s_waitcnt vmcnt(0)
  v_min_u32_dpp v13, v13, v13 quad_perm:[1,0,3,2] row_mask:0xf bank_mask:0xf
  s_nop 1
  v_min_u32_dpp v13, v13, v13 quad_perm:[2,3,0,1] row_mask:0xf bank_mask:0xf
  s_nop 1
  v_min_u32_dpp v13, v13, v13 row_half_mirror row_mask:0xf bank_mask:0xf
  s_nop 0
  v_readfirstlane_b32 s76, v13
  s_nop 0
  s_cmp_ge_u32 s76, s29
  s_cbranch_scc1 mega0_kernel_sd21_go
  s_sleep 1
  s_add_u32 s15, s15, 1
  s_cmp_lt_u32 s15, 262144
  s_cbranch_scc1 mega0_kernel_sd21_w2
  s_branch mega_fail
mega_loop0_pcf:
  s_nop 3
  v_mov_b32 v28, 0
  v_mov_b32 v29, 0
  v_mov_b32 v30, 0
  v_mov_b32 v31, 0
  v_mov_b32 v32, 0
  v_mov_b32 v33, 0
  v_mov_b32 v34, 0
  v_mov_b32 v35, 0
  s_add_u32 s15, s15, 1
  s_cmp_lt_u32 s15, 262144
  s_cbranch_scc1 mega_loop0_pc
  s_branch mega_fail
mega_loop0_last:
  v_smfmac_f32_16x16x64_bf16 v[56:59], v[72:75], a[104:111], v9
  s_waitcnt lgkmcnt(4)
  buffer_store_dwordx2 v[132:133], v10, s[4:7], s19 offen
  v_smfmac_f32_16x16x64_bf16 v[52:55], v[76:79], a[32:39], v9
  v_smfmac_f32_16x16x64_bf16 v[56:59], v[76:79], a[112:119], v9
  v_smfmac_f32_16x16x64_bf16 v[52:55], v[80:83], a[40:47], v9
  v_smfmac_f32_16x16x64_bf16 v[56:59], v[80:83], a[120:127], v9
  v_smfmac_f32_16x16x64_bf16 v[52:55], v[84:87], a[48:55], v9
  v_smfmac_f32_16x16x64_bf16 v[56:59], v[84:87], a[128:135], v9
  v_smfmac_f32_16x16x64_bf16 v[52:55], v[88:91], a[56:63], v9
  v_smfmac_f32_16x16x64_bf16 v[56:59], v[88:91], a[136:143], v9
  v_smfmac_f32_16x16x64_bf16 v[52:55], v[92:95], a[64:71], v9
  v_smfmac_f32_16x16x64_bf16 v[56:59], v[92:95], a[144:151], v9
  v_smfmac_f32_16x16x64_bf16 v[52:55], v[96:99], a[72:79], v9
  v_smfmac_f32_16x16x64_bf16 v[56:59], v[96:99], a[152:159], v9
  s_nop 4
  v_pk_add_f32 v[52:53], v[52:53], v[54:55]
  v_cvt_pk_bf16_f32 v52, v52, v53
  ds_write_b32 v8, v52 offset:21504
  v_pk_add_f32 v[56:57], v[56:57], v[58:59]
  v_cvt_pk_bf16_f32 v56, v56, v57
  ds_write_b32 v8, v56 offset:22528
  s_waitcnt lgkmcnt(0)
  s_barrier
  ds_read_b128 v[92:95], v13 offset:21504
  s_waitcnt lgkmcnt(0)
  buffer_store_dwordx4 v[92:95], v66, s[4:7], s25 offen
  s_waitcnt vmcnt(0)
  s_barrier
  s_endpgm
mega_loop0_paf:
  s_add_u32 s15, s15, 1
  s_cmp_lt_u32 s15, 262144
  s_cbranch_scc1 mega_loop0_pa
  s_branch mega_fail
mega_loop0_pbf:
  buffer_load_dwordx4 v[96:99], v62, s[4:7], s37 offen offset:0 sc1
  buffer_load_dwordx4 v[100:103], v62, s[4:7], s37 offen offset:1024 sc1
mega_loop0_pbl:
  buffer_load_dwordx4 v[96:99], v62, s[4:7], s37 offen offset:0 sc1
  buffer_load_dwordx4 v[100:103], v62, s[4:7], s37 offen offset:1024 sc1
  s_waitcnt vmcnt(2)
  v_max3_u32 v14, v96, v97, v98
  v_max3_u32 v14, v14, v99, v100
  v_mfma_f32_16x16x32_bf16 v[128:131], a[160:163], v[96:99], 0
  v_max3_u32 v14, v14, v101, v102
  v_max_u32 v14, v14, v103
  v_mfma_f32_16x16x32_bf16 v[128:131], a[160:163], v[100:103], v[128:131]
  v_cmp_eq_u32 vcc, -1, v14
  s_nop 0
  s_cbranch_vccz mega_loop0_pbok
  s_add_u32 s15, s15, 1
  s_cmp_lt_u32 s15, 262144
  s_cbranch_scc1 mega_loop0_pbl
  s_branch mega_fail
mega_loop1:
  buffer_load_dwordx4 v[16:19], v2, s[4:7], s13 offen sc1
  buffer_load_dwordx4 v[20:23], v2, s[4:7], s13 offen offset:1024 sc1
  buffer_load_dwordx4 v[24:27], v2, s[4:7], s14 offen sc1
mega_loop1_pc:
  buffer_load_dwordx4 v[16:19], v2, s[4:7], s13 offen sc1
  buffer_load_dwordx4 v[20:23], v2, s[4:7], s13 offen offset:1024 sc1
  buffer_load_dwordx4 v[24:27], v2, s[4:7], s14 offen sc1
  s_waitcnt vmcnt(3)
  v_max3_u32 v14, v16, v17, v18
  v_max3_u32 v14, v14, v19, v20
  v_smfmac_f32_16x16x64_bf16 v[44:47], v[16:19], v[136:143], v9
  v_max3_u32 v14, v14, v21, v22
  v_smfmac_f32_16x16x64_bf16 v[48:51], v[16:19], v[144:151], v9
  v_max3_u32 v14, v14, v23, v24
  v_smfmac_f32_16x16x64_bf16 v[44:47], v[20:23], v[152:159], v9
  v_max3_u32 v14, v14, v25, v26
  v_smfmac_f32_16x16x64_bf16 v[48:51], v[20:23], v[160:167], v9
  v_max_u32 v14, v14, v27
  v_smfmac_f32_16x16x64_bf16 v[44:47], v[24:27], v[168:175], v9
  v_cmp_eq_u32 vcc, -1, v14
  v_smfmac_f32_16x16x64_bf16 v[48:51], v[24:27], v[176:183], v9
  s_cbranch_vccnz mega_loop1_pcf
  ds_write_b128 v2, v[16:19] offset:3072
  v_smfmac_f32_16x16x64_bf16 v[36:39], v[16:19], v[184:191], v9
  ds_write_b128 v2, v[20:23] offset:4096
  v_smfmac_f32_16x16x64_bf16 v[40:43], v[16:19], v[192:199], v9
  v_smfmac_f32_16x16x64_bf16 v[36:39], v[20:23], v[200:207], v9
  v_pk_add_f32 v[44:45], v[44:45], v[46:47]
  v_smfmac_f32_16x16x64_bf16 v[40:43], v[20:23], v[208:215], v9
  v_pk_add_f32 v[48:49], v[48:49], v[50:51]
  v_smfmac_f32_16x16x64_bf16 v[40:43], v[24:27], v[216:223], v9
  v_cvt_pk_bf16_f32 v46, v44, v45
  v_smfmac_f32_16x16x64_bf16 v[28:31], v[16:19], v[224:231], v9
  v_cvt_pk_bf16_f32 v47, v48, v49
  v_smfmac_f32_16x16x64_bf16 v[32:35], v[16:19], v[232:239], v9
  ds_write_b64 v3, v[46:47] offset:14336
  v_smfmac_f32_16x16x64_bf16 v[28:31], v[20:23], v[240:247], v9
  v_pk_add_f32 v[36:37], v[36:37], v[38:39]
  v_smfmac_f32_16x16x64_bf16 v[32:35], v[20:23], v[248:255], v9
  v_pk_add_f32 v[40:41], v[40:41], v[42:43]
  v_cvt_pk_bf16_f32 v38, v36, v37
  v_cvt_pk_bf16_f32 v39, v40, v41
  ds_write_b64 v3, v[38:39] offset:12288
  v_smfmac_f32_16x16x64_bf16 v[52:55], v[16:19], a[24:31], v9
  v_pk_add_f32 v[28:29], v[28:29], v[30:31]
  s_nop 1
  v_pk_add_f32 v[32:33], v[32:33], v[34:35]
  v_cvt_pk_bf16_f32 v30, v28, v29
  v_cvt_pk_bf16_f32 v31, v32, v33
  ds_write_b64 v3, v[30:31] offset:10240
  v_smfmac_f32_16x16x64_bf16 v[56:59], v[16:19], a[104:111], v9
  v_smfmac_f32_16x16x64_bf16 v[52:55], v[20:23], a[32:39], v9
  v_smfmac_f32_16x16x64_bf16 v[56:59], v[20:23], a[112:119], v9
  s_waitcnt lgkmcnt(0)
  s_barrier
  ds_read_b128 v[28:31], v2 offset:10240
  ds_read_b128 v[32:35], v2 offset:11264
  ds_read_b128 v[36:39], v2 offset:12288
  ds_read_b128 v[40:43], v2 offset:13312
  ds_read_b128 v[44:47], v2 offset:14336
  ds_read_b128 v[48:51], v2 offset:15360
  ds_read_b128 v[120:123], v11 offset:35840
  ds_read_b64 v[124:125], v11 offset:36872
  v_smfmac_f32_16x16x64_bf16 v[52:55], v[24:27], a[16:23], v9
  v_smfmac_f32_16x16x64_bf16 v[56:59], v[24:27], a[96:103], v9
  s_waitcnt lgkmcnt(7)
  v_mfma_f32_16x16x32_bf16 v[100:103], v[28:31], a[172:175], 0
  ds_read_b128 v[72:75], v2 offset:0
  s_waitcnt lgkmcnt(7)
  v_mfma_f32_16x16x32_bf16 v[100:103], v[32:35], a[172:175], v[100:103]
  ds_read_b128 v[76:79], v2 offset:1024
  s_waitcnt lgkmcnt(7)
  v_mfma_f32_16x16x32_bf16 v[104:107], v[36:39], a[172:175], 0
  ds_read_b128 v[80:83], v2 offset:5120
  s_waitcnt lgkmcnt(7)
  v_mfma_f32_16x16x32_bf16 v[104:107], v[40:43], a[172:175], v[104:107]
  ds_read_b128 v[84:87], v2 offset:6144
  s_waitcnt lgkmcnt(7)
  v_mfma_f32_16x16x32_bf16 v[108:111], v[44:47], a[172:175], 0
  ds_read_b128 v[88:91], v2 offset:7168
  v_cvt_pk_bf16_f32 v112, v100, v101
  v_cvt_pk_bf16_f32 v113, v102, v103
  s_waitcnt lgkmcnt(7)
  v_mfma_f32_16x16x32_bf16 v[108:111], v[48:51], a[172:175], v[108:111]
  ds_read_b128 v[92:95], v2 offset:8192
  v_cvt_pk_bf16_f32 v114, v104, v105
  v_cvt_pk_bf16_f32 v115, v106, v107
  ds_read_b128 v[96:99], v2 offset:9216
  s_waitcnt lgkmcnt(7)
  v_mfma_f32_16x16x32_bf16 v[128:131], v[120:123], v[112:115], 0
  s_nop 1
  v_cvt_pk_bf16_f32 v116, v108, v109
  v_cvt_pk_bf16_f32 v117, v110, v111
  s_nop 1
  v_mfma_f32_16x16x32_bf16 v[128:131], v[124:127], v[116:119], v[128:131]
  s_waitcnt lgkmcnt(6)
  v_smfmac_f32_16x16x64_bf16 v[52:55], v[72:75], a[0:7], v9
  ds_read_b128 a[176:179], v60 offset:24576
  ds_read_b128 a[180:183], v60 offset:27136
  ds_read_b128 a[184:187], v60 offset:29696
  ds_read_b128 a[188:191], v60 offset:32256
  s_nop 0
  v_cvt_pk_bf16_f32 v68, v128, v129
  v_cvt_pk_bf16_f32 v69, v130, v131
  v_min_u32 v68, -2, v68
  v_min_u32 v69, -2, v69
  buffer_store_dwordx2 v[68:69], v10, s[4:7], s18 offen
  s_cmp_eq_u32 s12, 63
  s_cbranch_scc1 mega_loop1_last
  v_smfmac_f32_16x16x64_bf16 v[56:59], v[72:75], a[80:87], v9
  s_waitcnt lgkmcnt(4)
  buffer_store_dwordx2 v[132:133], v10, s[4:7], s19 offen
  v_smfmac_f32_16x16x64_bf16 v[52:55], v[76:79], a[8:15], v9
  v_smfmac_f32_16x16x64_bf16 v[56:59], v[76:79], a[88:95], v9
  v_smfmac_f32_16x16x64_bf16 v[52:55], v[80:83], a[40:47], v9
  v_smfmac_f32_16x16x64_bf16 v[56:59], v[80:83], a[120:127], v9
  v_smfmac_f32_16x16x64_bf16 v[52:55], v[84:87], a[48:55], v9
  v_smfmac_f32_16x16x64_bf16 v[56:59], v[84:87], a[128:135], v9
  buffer_load_dwordx4 v[16:19], v4, s[4:7], s20 offen sc1
  v_smfmac_f32_16x16x64_bf16 v[52:55], v[88:91], a[56:63], v9
  buffer_load_dwordx4 v[20:23], v4, s[4:7], s20 offen offset:256 sc1
  v_smfmac_f32_16x16x64_bf16 v[56:59], v[88:91], a[136:143], v9
  buffer_load_dwordx4 v[24:27], v5, s[4:7], s20 offen offset:512 sc1
  v_smfmac_f32_16x16x64_bf16 v[52:55], v[92:95], a[64:71], v9
  v_smfmac_f32_16x16x64_bf16 v[56:59], v[92:95], a[144:151], v9
  v_smfmac_f32_16x16x64_bf16 v[52:55], v[96:99], a[72:79], v9
  v_smfmac_f32_16x16x64_bf16 v[56:59], v[96:99], a[152:159], v9
  s_nop 4
  v_pk_add_f32 v[52:53], v[52:53], v[54:55]
  v_cvt_pk_bf16_f32 v52, v52, v53
  ds_write_b32 v8, v52 offset:21504
  v_pk_add_f32 v[56:57], v[56:57], v[58:59]
  v_cvt_pk_bf16_f32 v56, v56, v57
  ds_write_b32 v8, v56 offset:22528
mega_loop1_pa:
  buffer_load_dwordx4 v[16:19], v4, s[4:7], s20 offen sc1
  buffer_load_dwordx4 v[20:23], v4, s[4:7], s20 offen offset:256 sc1
  buffer_load_dwordx4 v[24:27], v5, s[4:7], s20 offen offset:512 sc1
  s_waitcnt vmcnt(3)
  v_max3_u32 v14, v16, v17, v18
  v_max3_u32 v14, v14, v19, v20
  v_mfma_f32_16x16x32_bf16 v[40:43], v[16:19], a[160:163], 0
  v_max3_u32 v14, v14, v21, v22
  v_max3_u32 v14, v14, v23, v24
  v_mfma_f32_16x16x32_bf16 v[40:43], v[20:23], a[164:167], v[40:43]
  v_max3_u32 v14, v14, v25, v26
  v_max_u32 v14, v14, v27
  v_mfma_f32_16x16x32_bf16 v[44:47], v[24:27], a[168:171], 0
  v_cmp_eq_u32 vcc, -1, v14
  s_nop 0
  s_cbranch_vccnz mega_loop1_paf
  s_nop 1
  v_max3_f32 v48, v40, v41, v42
  s_nop 1
  v_cndmask_b32 v44, v44, v45, s[42:43]
  v_max3_f32 v48, v48, v43, v44
  s_nop 1
  v_max_f32_dpp v48, v48, v48 quad_perm:[1,0,3,2] row_mask:0xf bank_mask:0xf
  s_nop 1
  v_max_f32_dpp v48, v48, v48 quad_perm:[2,3,0,1] row_mask:0xf bank_mask:0xf
  s_nop 1
  v_max_f32_dpp v48, v48, v48 row_half_mirror row_mask:0xf bank_mask:0xf
  v_mul_f32 v48, s26, v48
  v_fma_f32 v40, v40, s26, -v48
  v_fma_f32 v41, v41, s26, -v48
  v_fma_f32 v42, v42, s26, -v48
  v_fma_f32 v43, v43, s26, -v48
  v_fma_f32 v44, v44, s26, -v48
  v_exp_f32 v40, v40
  v_exp_f32 v41, v41
  v_exp_f32 v42, v42
  v_exp_f32 v43, v43
  v_exp_f32 v44, v44
  v_add_f32 v48, v40, v41
  v_add_f32 v49, v42, v43
  v_add_f32 v48, v48, v49
  v_add_f32 v48, v48, v44
  s_nop 1
  v_add_f32_dpp v48, v48, v48 quad_perm:[1,0,3,2] row_mask:0xf bank_mask:0xf
  s_nop 1
  v_add_f32_dpp v48, v48, v48 quad_perm:[2,3,0,1] row_mask:0xf bank_mask:0xf
  s_nop 1
  v_add_f32_dpp v48, v48, v48 row_half_mirror row_mask:0xf bank_mask:0xf
  v_rcp_f32 v48, v48
  s_nop 0
  v_pk_mul_f32 v[40:41], v[40:41], v[48:49] op_sel_hi:[1,0]
  v_pk_mul_f32 v[42:43], v[42:43], v[48:49] op_sel_hi:[1,0]
  v_mul_f32 v44, v44, v48
  v_cvt_pk_bf16_f32 v40, v40, v41
  v_cvt_pk_bf16_f32 v41, v42, v43
  ds_write_b64 v6, v[40:41] offset:16384
  v_cvt_pk_bf16_f32 v44, v44, v44
  ds_write_b16 v7, v44 offset:20480
  s_waitcnt lgkmcnt(0)
  s_barrier
  ds_read_b128 v[72:75], v12 offset:16384
  ds_read_b128 v[76:79], v12 offset:17408
  ds_read_b128 v[80:83], v12 offset:18432
  ds_read_b128 v[84:87], v12 offset:19456
  ds_read_b128 v[88:91], v12 offset:20480
  ds_read_b128 v[92:95], v13 offset:21504
  s_waitcnt lgkmcnt(5)
  v_mfma_f32_16x16x32_bf16 v[128:131], a[176:179], v[72:75], 0
  s_waitcnt lgkmcnt(4)
  v_mfma_f32_16x16x32_bf16 v[128:131], a[180:183], v[76:79], v[128:131]
  s_waitcnt lgkmcnt(3)
  v_mfma_f32_16x16x32_bf16 v[128:131], a[184:187], v[80:83], v[128:131]
  s_waitcnt lgkmcnt(2)
  v_mfma_f32_16x16x32_bf16 v[128:131], a[188:191], v[84:87], v[128:131]
  s_waitcnt lgkmcnt(0)
  v_mfma_f32_16x16x32_bf16 v[128:131], v[92:95], v[88:91], v[128:131]
  v_mov_b32 v28, 0
  v_mov_b32 v29, 0
  v_mov_b32 v30, 0
  v_mov_b32 v31, 0
  v_mov_b32 v32, 0
  v_mov_b32 v33, 0
  v_mov_b32 v34, 0
  s_nop 0
  v_cvt_pk_bf16_f32 v68, v128, v129
  v_cvt_pk_bf16_f32 v69, v130, v131
  v_min_u32 v71, -2, v69
  v_min_u32 v70, -2, v68
  v_min_u32 v69, -2, v69
  v_min_u32 v68, -2, v68
  s_nop 1
  v_permlane16_swap_b32 v68, v70
  v_permlane16_swap_b32 v69, v71
  buffer_store_dwordx4 v[68:71], v61, s[4:7], s33 offen sc1
  buffer_store_dwordx4 v[68:71], v61, s[4:7], s35 offen sc1
  v_mov_b32 v35, 0
  v_mov_b32 v36, 0
  v_mov_b32 v37, 0
  v_mov_b32 v38, 0
  v_mov_b32 v39, 0
  v_mov_b32 v40, 0
  v_mov_b32 v41, 0
  v_mov_b32 v42, 0
  v_mov_b32 v43, 0
  v_mov_b32 v44, 0
  v_mov_b32 v45, 0
  v_mov_b32 v46, 0
  v_mov_b32 v47, 0
  v_mov_b32 v48, 0
  v_mov_b32 v49, 0
  v_mov_b32 v50, 0
  v_mov_b32 v51, 0
  v_mov_b32 v52, 0
  v_mov_b32 v53, 0
  v_mov_b32 v54, 0
  v_mov_b32 v55, 0
  v_mov_b32 v56, 0
  v_mov_b32 v57, 0
  v_mov_b32 v58, 0
  v_mov_b32 v59, 0
  s_xor_b32 s18, s18, s19
  s_xor_b32 s19, s19, s18
  s_xor_b32 s18, s18, s19
  s_xor_b32 s20, s20, s21
  s_xor_b32 s21, s21, s20
  s_xor_b32 s20, s20, s21
  s_add_u32 s72, s72, 1
  s_cmp_eq_u32 s72, 6
  s_cselect_b32 s72, 0, s72
  s_mov_b32 s73, 325632
  s_cselect_b32 s73, 0xffe72800, s73
  s_add_u32 s23, s23, s73
  s_mov_b32 s15, 0
  s_nop 15
  s_nop 15
  s_nop 15
  s_nop 15
  s_nop 9
  buffer_load_dwordx4 v[96:99], v62, s[4:7], s37 offen offset:0 sc1
  buffer_load_dwordx4 v[100:103], v62, s[4:7], s37 offen offset:1024 sc1
  s_barrier
  buffer_store_dwordx4 v[92:95], v66, s[4:7], s25 offen
  buffer_store_dwordx4 v[132:135], v2, s[4:7], s38 offen offset:0 sc1
  buffer_store_dwordx4 v[132:135], v2, s[4:7], s38 offen offset:1024 sc1
  s_add_u32 s25, s25, s73
  s_waitcnt vmcnt(3)
  v_max3_u32 v14, v96, v97, v98
  v_max3_u32 v14, v14, v99, v100
  v_mfma_f32_16x16x32_bf16 v[128:131], a[160:163], v[96:99], 0
  v_max3_u32 v14, v14, v101, v102
  v_max_u32 v14, v14, v103
  v_mfma_f32_16x16x32_bf16 v[128:131], a[160:163], v[100:103], v[128:131]
  v_cmp_eq_u32 vcc, -1, v14
  s_nop 0
  s_cbranch_vccnz mega_loop1_pbf
mega_loop1_pbok:
  s_nop 4
  v_cvt_pk_bf16_f32 v68, v128, v129
  v_cvt_pk_bf16_f32 v69, v130, v131
  v_min_u32 v68, -2, v68
  v_min_u32 v69, -2, v69
  buffer_store_dwordx2 v[68:69], v63, s[4:7], s17 offen
  buffer_store_dwordx2 v[132:133], v63, s[4:7], s16 offen
  s_add_u32 s12, s12, 1
  s_xor_b32 s16, s16, s17
  s_xor_b32 s17, s17, s16
  s_xor_b32 s16, s16, s17
  s_add_u32 s13, s16, 3072
  s_add_u32 s14, s16, 2048
  s_add_u32 s38, s32, s39
  s_add_u32 s39, s39, 655360
  s_cmp_eq_u32 s39, 1966080
  s_cselect_b32 s39, 0, s39
  s_add_u32 s37, s32, s39
  s_add_u32 s33, s30, s39
  s_add_u32 s34, s33, 327680
  s_add_u32 s35, s31, s39
  s_add_u32 s36, s35, 327680
  s_barrier
  s_nop 3
  s_branch mega_loop1
mega_loop1_pcf:
  s_nop 3
  v_mov_b32 v44, 0
  v_mov_b32 v45, 0
  v_mov_b32 v46, 0
  v_mov_b32 v47, 0
  v_mov_b32 v48, 0
  v_mov_b32 v49, 0
  v_mov_b32 v50, 0
  v_mov_b32 v51, 0
  s_add_u32 s15, s15, 1
  s_cmp_lt_u32 s15, 262144
  s_cbranch_scc1 mega_loop1_pc
  s_branch mega_fail
mega_loop1_last:
  v_smfmac_f32_16x16x64_bf16 v[56:59], v[72:75], a[80:87], v9
  s_waitcnt lgkmcnt(4)
  buffer_store_dwordx2 v[132:133], v10, s[4:7], s19 offen
  v_smfmac_f32_16x16x64_bf16 v[52:55], v[76:79], a[8:15], v9
  v_smfmac_f32_16x16x64_bf16 v[56:59], v[76:79], a[88:95], v9
  v_smfmac_f32_16x16x64_bf16 v[52:55], v[80:83], a[40:47], v9
  v_smfmac_f32_16x16x64_bf16 v[56:59], v[80:83], a[120:127], v9
  v_smfmac_f32_16x16x64_bf16 v[52:55], v[84:87], a[48:55], v9
  v_smfmac_f32_16x16x64_bf16 v[56:59], v[84:87], a[128:135], v9
  v_smfmac_f32_16x16x64_bf16 v[52:55], v[88:91], a[56:63], v9
  v_smfmac_f32_16x16x64_bf16 v[56:59], v[88:91], a[136:143], v9
  v_smfmac_f32_16x16x64_bf16 v[52:55], v[92:95], a[64:71], v9
  v_smfmac_f32_16x16x64_bf16 v[56:59], v[92:95], a[144:151], v9
  v_smfmac_f32_16x16x64_bf16 v[52:55], v[96:99], a[72:79], v9
  v_smfmac_f32_16x16x64_bf16 v[56:59], v[96:99], a[152:159], v9
  s_nop 4
  v_pk_add_f32 v[52:53], v[52:53], v[54:55]
  v_cvt_pk_bf16_f32 v52, v52, v53
  ds_write_b32 v8, v52 offset:21504
  v_pk_add_f32 v[56:57], v[56:57], v[58:59]
  v_cvt_pk_bf16_f32 v56, v56, v57
  ds_write_b32 v8, v56 offset:22528
  s_waitcnt lgkmcnt(0)
  s_barrier
  ds_read_b128 v[92:95], v13 offset:21504
  s_waitcnt lgkmcnt(0)
  buffer_store_dwordx4 v[92:95], v66, s[4:7], s25 offen
  s_waitcnt vmcnt(0)
  s_barrier
  s_endpgm
mega_loop1_paf:
  s_add_u32 s15, s15, 1
  s_cmp_lt_u32 s15, 262144
  s_cbranch_scc1 mega_loop1_pa
  s_branch mega_fail
mega_loop1_pbf:
  buffer_load_dwordx4 v[96:99], v62, s[4:7], s37 offen offset:0 sc1
  buffer_load_dwordx4 v[100:103], v62, s[4:7], s37 offen offset:1024 sc1
mega_loop1_pbl:
  buffer_load_dwordx4 v[96:99], v62, s[4:7], s37 offen offset:0 sc1
  buffer_load_dwordx4 v[100:103], v62, s[4:7], s37 offen offset:1024 sc1
  s_waitcnt vmcnt(2)
  v_max3_u32 v14, v96, v97, v98
  v_max3_u32 v14, v14, v99, v100
  v_mfma_f32_16x16x32_bf16 v[128:131], a[160:163], v[96:99], 0
  v_max3_u32 v14, v14, v101, v102
  v_max_u32 v14, v14, v103
  v_mfma_f32_16x16x32_bf16 v[128:131], a[160:163], v[100:103], v[128:131]
  v_cmp_eq_u32 vcc, -1, v14
  s_nop 0
  s_cbranch_vccz mega_loop1_pbok
  s_add_u32 s15, s15, 1
  s_cmp_lt_u32 s15, 262144
  s_cbranch_scc1 mega_loop1_pbl
  s_branch mega_fail
mega_loop2:
  buffer_load_dwordx4 v[16:19], v2, s[4:7], s13 offen sc1
  buffer_load_dwordx4 v[20:23], v2, s[4:7], s13 offen offset:1024 sc1
  buffer_load_dwordx4 v[24:27], v2, s[4:7], s14 offen sc1
mega_loop2_pc:
  buffer_load_dwordx4 v[16:19], v2, s[4:7], s13 offen sc1
  buffer_load_dwordx4 v[20:23], v2, s[4:7], s13 offen offset:1024 sc1
  buffer_load_dwordx4 v[24:27], v2, s[4:7], s14 offen sc1
  s_waitcnt vmcnt(3)
  v_max3_u32 v14, v16, v17, v18
  v_max3_u32 v14, v14, v19, v20
  v_smfmac_f32_16x16x64_bf16 v[28:31], v[16:19], v[136:143], v9
  v_max3_u32 v14, v14, v21, v22
  v_smfmac_f32_16x16x64_bf16 v[32:35], v[16:19], v[144:151], v9
  v_max3_u32 v14, v14, v23, v24
  v_smfmac_f32_16x16x64_bf16 v[28:31], v[20:23], v[152:159], v9
  v_max3_u32 v14, v14, v25, v26
  v_smfmac_f32_16x16x64_bf16 v[32:35], v[20:23], v[160:167], v9
  v_max_u32 v14, v14, v27
  v_smfmac_f32_16x16x64_bf16 v[28:31], v[24:27], v[168:175], v9
  v_cmp_eq_u32 vcc, -1, v14
  v_smfmac_f32_16x16x64_bf16 v[32:35], v[24:27], v[176:183], v9
  s_cbranch_vccnz mega_loop2_pcf
  ds_write_b128 v2, v[16:19] offset:5120
  v_smfmac_f32_16x16x64_bf16 v[36:39], v[16:19], v[184:191], v9
  ds_write_b128 v2, v[20:23] offset:6144
  v_smfmac_f32_16x16x64_bf16 v[40:43], v[16:19], v[192:199], v9
  ds_write_b128 v2, v[24:27] offset:7168
  v_smfmac_f32_16x16x64_bf16 v[36:39], v[20:23], v[200:207], v9
  v_pk_add_f32 v[28:29], v[28:29], v[30:31]
  v_smfmac_f32_16x16x64_bf16 v[40:43], v[20:23], v[208:215], v9
  v_pk_add_f32 v[32:33], v[32:33], v[34:35]
  v_smfmac_f32_16x16x64_bf16 v[36:39], v[24:27], v[216:223], v9
  v_cvt_pk_bf16_f32 v30, v28, v29
  v_smfmac_f32_16x16x64_bf16 v[44:47], v[16:19], v[224:231], v9
  v_cvt_pk_bf16_f32 v31, v32, v33
  v_smfmac_f32_16x16x64_bf16 v[48:51], v[16:19], v[232:239], v9
  ds_write_b64 v3, v[30:31] offset:10240
  v_smfmac_f32_16x16x64_bf16 v[44:47], v[20:23], v[240:247], v9
  v_pk_add_f32 v[36:37], v[36:37], v[38:39]
  v_smfmac_f32_16x16x64_bf16 v[48:51], v[20:23], v[248:255], v9
  v_pk_add_f32 v[40:41], v[40:41], v[42:43]
  v_cvt_pk_bf16_f32 v38, v36, v37
  v_cvt_pk_bf16_f32 v39, v40, v41
  ds_write_b64 v3, v[38:39] offset:12288
  v_smfmac_f32_16x16x64_bf16 v[52:55], v[16:19], a[40:47], v9
  v_pk_add_f32 v[44:45], v[44:45], v[46:47]
  s_nop 1
  v_pk_add_f32 v[48:49], v[48:49], v[50:51]
  v_cvt_pk_bf16_f32 v46, v44, v45
  v_cvt_pk_bf16_f32 v47, v48, v49
  ds_write_b64 v3, v[46:47] offset:14336
  v_smfmac_f32_16x16x64_bf16 v[56:59], v[16:19], a[120:127], v9
  v_smfmac_f32_16x16x64_bf16 v[52:55], v[20:23], a[48:55], v9
  v_smfmac_f32_16x16x64_bf16 v[56:59], v[20:23], a[128:135], v9
  s_waitcnt lgkmcnt(0)
  s_barrier
  ds_read_b128 v[28:31], v2 offset:10240
  ds_read_b128 v[32:35], v2 offset:11264
  ds_read_b128 v[36:39], v2 offset:12288
  ds_read_b128 v[40:43], v2 offset:13312
  ds_read_b128 v[44:47], v2 offset:14336
  ds_read_b128 v[48:51], v2 offset:15360
  v_smfmac_f32_16x16x64_bf16 v[52:55], v[24:27], a[56:63], v9
  v_smfmac_f32_16x16x64_bf16 v[56:59], v[24:27], a[136:143], v9
  s_waitcnt lgkmcnt(5)
  v_mfma_f32_16x16x32_bf16 v[100:103], v[28:31], a[172:175], 0
  ds_read_b128 v[72:75], v2 offset:0
  s_waitcnt lgkmcnt(5)
  v_mfma_f32_16x16x32_bf16 v[100:103], v[32:35], a[172:175], v[100:103]
  ds_read_b128 v[76:79], v2 offset:1024
  s_waitcnt lgkmcnt(5)
  v_mfma_f32_16x16x32_bf16 v[104:107], v[36:39], a[172:175], 0
  ds_read_b128 v[80:83], v2 offset:2048
  s_waitcnt lgkmcnt(5)
  v_mfma_f32_16x16x32_bf16 v[104:107], v[40:43], a[172:175], v[104:107]
  ds_read_b128 v[84:87], v2 offset:3072
  s_waitcnt lgkmcnt(5)
  v_mfma_f32_16x16x32_bf16 v[108:111], v[44:47], a[172:175], 0
  ds_read_b128 v[88:91], v2 offset:4096
  v_cvt_pk_bf16_f32 v112, v100, v101
  v_cvt_pk_bf16_f32 v113, v102, v103
  s_waitcnt lgkmcnt(5)
  v_mfma_f32_16x16x32_bf16 v[108:111], v[48:51], a[172:175], v[108:111]
  ds_read_b128 v[92:95], v2 offset:8192
  v_cvt_pk_bf16_f32 v114, v104, v105
  v_cvt_pk_bf16_f32 v115, v106, v107
  ds_read_b128 v[96:99], v2 offset:9216
  s_waitcnt lgkmcnt(7)
  v_mfma_f32_16x16x32_bf16 v[128:131], v[112:115], v[112:115], 0
  s_nop 1
  v_cvt_pk_bf16_f32 v116, v108, v109
  v_cvt_pk_bf16_f32 v117, v110, v111
  s_nop 1
  v_mfma_f32_16x16x32_bf16 v[128:131], v[116:119], v[116:119], v[128:131]
  s_waitcnt lgkmcnt(6)
  v_smfmac_f32_16x16x64_bf16 v[52:55], v[72:75], a[0:7], v9
  ds_read_b128 a[176:179], v60 offset:24576
  ds_read_b128 a[180:183], v60 offset:27136
  ds_read_b128 a[184:187], v60 offset:29696
  ds_read_b128 a[188:191], v60 offset:32256
  s_nop 0
  v_cvt_pk_bf16_f32 v68, v128, v129
  v_cvt_pk_bf16_f32 v69, v130, v131
  v_min_u32 v68, -2, v68
  v_min_u32 v69, -2, v69
  buffer_store_dwordx2 v[68:69], v10, s[4:7], s18 offen
  s_cmp_eq_u32 s12, 63
  s_cbranch_scc1 mega_loop2_last
  v_smfmac_f32_16x16x64_bf16 v[56:59], v[72:75], a[80:87], v9
  s_waitcnt lgkmcnt(4)
  buffer_store_dwordx4 v[112:115], v64, s[4:7], s23 offen
  v_smfmac_f32_16x16x64_bf16 v[52:55], v[76:79], a[8:15], v9
  buffer_store_dwordx2 v[116:117], v65, s[4:7], s23 offen
  v_smfmac_f32_16x16x64_bf16 v[56:59], v[76:79], a[88:95], v9
  buffer_store_dwordx2 v[132:133], v10, s[4:7], s19 offen
  v_smfmac_f32_16x16x64_bf16 v[52:55], v[80:83], a[16:23], v9
  v_smfmac_f32_16x16x64_bf16 v[56:59], v[80:83], a[96:103], v9
  v_smfmac_f32_16x16x64_bf16 v[52:55], v[84:87], a[24:31], v9
  v_smfmac_f32_16x16x64_bf16 v[56:59], v[84:87], a[104:111], v9
  buffer_load_dwordx4 v[16:19], v4, s[4:7], s20 offen sc1
  v_smfmac_f32_16x16x64_bf16 v[52:55], v[88:91], a[32:39], v9
  buffer_load_dwordx4 v[20:23], v4, s[4:7], s20 offen offset:256 sc1
  v_smfmac_f32_16x16x64_bf16 v[56:59], v[88:91], a[112:119], v9
  buffer_load_dwordx4 v[24:27], v5, s[4:7], s20 offen offset:512 sc1
  v_smfmac_f32_16x16x64_bf16 v[52:55], v[92:95], a[64:71], v9
  v_smfmac_f32_16x16x64_bf16 v[56:59], v[92:95], a[144:151], v9
  v_smfmac_f32_16x16x64_bf16 v[52:55], v[96:99], a[72:79], v9
  v_smfmac_f32_16x16x64_bf16 v[56:59], v[96:99], a[152:159], v9
  s_nop 4
  v_pk_add_f32 v[52:53], v[52:53], v[54:55]
  v_cvt_pk_bf16_f32 v52, v52, v53
  ds_write_b32 v8, v52 offset:21504
  v_pk_add_f32 v[56:57], v[56:57], v[58:59]
  v_cvt_pk_bf16_f32 v56, v56, v57
  ds_write_b32 v8, v56 offset:22528
mega_loop2_pa:
  buffer_load_dwordx4 v[16:19], v4, s[4:7], s20 offen sc1
  buffer_load_dwordx4 v[20:23], v4, s[4:7], s20 offen offset:256 sc1
  buffer_load_dwordx4 v[24:27], v5, s[4:7], s20 offen offset:512 sc1
  s_waitcnt vmcnt(3)
  v_max3_u32 v14, v16, v17, v18
  v_max3_u32 v14, v14, v19, v20
  v_mfma_f32_16x16x32_bf16 v[40:43], v[16:19], a[160:163], 0
  v_max3_u32 v14, v14, v21, v22
  v_max3_u32 v14, v14, v23, v24
  v_mfma_f32_16x16x32_bf16 v[40:43], v[20:23], a[164:167], v[40:43]
  v_max3_u32 v14, v14, v25, v26
  v_max_u32 v14, v14, v27
  v_mfma_f32_16x16x32_bf16 v[44:47], v[24:27], a[168:171], 0
  v_cmp_eq_u32 vcc, -1, v14
  s_nop 0
  s_cbranch_vccnz mega_loop2_paf
  s_nop 1
  v_max3_f32 v48, v40, v41, v42
  s_nop 1
  v_cndmask_b32 v44, v44, v45, s[42:43]
  v_max3_f32 v48, v48, v43, v44
  s_nop 1
  v_max_f32_dpp v48, v48, v48 quad_perm:[1,0,3,2] row_mask:0xf bank_mask:0xf
  s_nop 1
  v_max_f32_dpp v48, v48, v48 quad_perm:[2,3,0,1] row_mask:0xf bank_mask:0xf
  s_nop 1
  v_max_f32_dpp v48, v48, v48 row_half_mirror row_mask:0xf bank_mask:0xf
  v_mul_f32 v48, s26, v48
  v_fma_f32 v40, v40, s26, -v48
  v_fma_f32 v41, v41, s26, -v48
  v_fma_f32 v42, v42, s26, -v48
  v_fma_f32 v43, v43, s26, -v48
  v_fma_f32 v44, v44, s26, -v48
  v_exp_f32 v40, v40
  v_exp_f32 v41, v41
  v_exp_f32 v42, v42
  v_exp_f32 v43, v43
  v_exp_f32 v44, v44
  v_add_f32 v48, v40, v41
  v_add_f32 v49, v42, v43
  v_add_f32 v48, v48, v49
  v_add_f32 v48, v48, v44
  s_nop 1
  v_add_f32_dpp v48, v48, v48 quad_perm:[1,0,3,2] row_mask:0xf bank_mask:0xf
  s_nop 1
  v_add_f32_dpp v48, v48, v48 quad_perm:[2,3,0,1] row_mask:0xf bank_mask:0xf
  s_nop 1
  v_add_f32_dpp v48, v48, v48 row_half_mirror row_mask:0xf bank_mask:0xf
  v_rcp_f32 v48, v48
  s_nop 0
  v_pk_mul_f32 v[40:41], v[40:41], v[48:49] op_sel_hi:[1,0]
  v_pk_mul_f32 v[42:43], v[42:43], v[48:49] op_sel_hi:[1,0]
  v_mul_f32 v44, v44, v48
  v_cvt_pk_bf16_f32 v40, v40, v41
  v_cvt_pk_bf16_f32 v41, v42, v43
  ds_write_b64 v6, v[40:41] offset:16384
  v_cvt_pk_bf16_f32 v44, v44, v44
  ds_write_b16 v7, v44 offset:20480
  s_add_u32 s27, s12, 1
  v_mov_b32 v14, s27
  buffer_store_dword v14, v67, s[4:7], s77 offen offset:0
  s_waitcnt lgkmcnt(0)
  s_barrier
  ds_read_b128 v[72:75], v12 offset:16384
  ds_read_b128 v[76:79], v12 offset:17408
  ds_read_b128 v[80:83], v12 offset:18432
  ds_read_b128 v[84:87], v12 offset:19456
  ds_read_b128 v[88:91], v12 offset:20480
  ds_read_b128 v[92:95], v13 offset:21504
  s_waitcnt lgkmcnt(5)
  v_mfma_f32_16x16x32_bf16 v[128:131], a[176:179], v[72:75], 0
  s_waitcnt lgkmcnt(4)
  v_mfma_f32_16x16x32_bf16 v[128:131], a[180:183], v[76:79], v[128:131]
  s_waitcnt lgkmcnt(3)
  v_mfma_f32_16x16x32_bf16 v[128:131], a[184:187], v[80:83], v[128:131]
  s_waitcnt lgkmcnt(2)
  v_mfma_f32_16x16x32_bf16 v[128:131], a[188:191], v[84:87], v[128:131]
  s_waitcnt lgkmcnt(0)
  v_mfma_f32_16x16x32_bf16 v[128:131], v[92:95], v[88:91], v[128:131]
  v_mov_b32 v28, 0
  v_mov_b32 v29, 0
  v_mov_b32 v30, 0
  v_mov_b32 v31, 0
  v_mov_b32 v32, 0
  v_mov_b32 v33, 0
  v_mov_b32 v34, 0
  s_nop 0
  v_cvt_pk_bf16_f32 v68, v128, v129
  v_cvt_pk_bf16_f32 v69, v130, v131
  v_min_u32 v68, -2, v68
  v_min_u32 v69, -2, v69
  buffer_store_dwordx2 v[68:69], v61, s[4:7], s33 offen sc1
  buffer_store_dwordx2 v[68:69], v61, s[4:7], s35 offen sc1
  v_mov_b32 v35, 0
  v_mov_b32 v36, 0
  v_mov_b32 v37, 0
  v_mov_b32 v38, 0
  v_mov_b32 v39, 0
  v_mov_b32 v40, 0
  v_mov_b32 v41, 0
  v_mov_b32 v42, 0
  v_mov_b32 v43, 0
  v_mov_b32 v44, 0
  v_mov_b32 v45, 0
  v_mov_b32 v46, 0
  v_mov_b32 v47, 0
  v_mov_b32 v48, 0
  v_mov_b32 v49, 0
  v_mov_b32 v50, 0
  v_mov_b32 v51, 0
  v_mov_b32 v52, 0
  v_mov_b32 v53, 0
  v_mov_b32 v54, 0
  v_mov_b32 v55, 0
  v_mov_b32 v56, 0
  v_mov_b32 v57, 0
  v_mov_b32 v58, 0
  v_mov_b32 v59, 0
  s_xor_b32 s18, s18, s19
  s_xor_b32 s19, s19, s18
  s_xor_b32 s18, s18, s19
  s_xor_b32 s20, s20, s21
  s_xor_b32 s21, s21, s20
  s_xor_b32 s20, s20, s21
  s_add_u32 s72, s72, 1
  s_cmp_eq_u32 s72, 6
  s_cselect_b32 s72, 0, s72
  s_mov_b32 s73, 325632
  s_cselect_b32 s73, 0xffe72800, s73
  s_add_u32 s23, s23, s73
  s_mov_b32 s15, 0
  s_nop 15
  s_nop 15
  s_nop 15
  s_nop 15
  s_nop 9
  buffer_load_dwordx4 v[96:99], v62, s[4:7], s37 offen offset:0 sc1
  buffer_load_dwordx4 v[100:103], v62, s[4:7], s37 offen offset:512 sc1
  s_barrier
  buffer_store_dwordx4 v[92:95], v66, s[4:7], s25 offen
  buffer_store_dwordx4 v[132:135], v2, s[4:7], s38 offen offset:0 sc1
  s_add_u32 s25, s25, s73
  s_waitcnt vmcnt(2)
  v_max3_u32 v14, v96, v97, v98
  v_max3_u32 v14, v14, v99, v100
  v_mfma_f32_16x16x32_bf16 v[128:131], a[160:163], v[96:99], 0
  v_max3_u32 v14, v14, v101, v102
  v_max_u32 v14, v14, v103
  v_mfma_f32_16x16x32_bf16 v[128:131], a[160:163], v[100:103], v[128:131]
  v_cmp_eq_u32 vcc, -1, v14
  s_nop 0
  s_cbranch_vccnz mega_loop2_pbf
mega_loop2_pbok:
  s_nop 4
  v_cvt_pk_bf16_f32 v68, v128, v129
  v_cvt_pk_bf16_f32 v69, v130, v131
  v_min_u32 v68, -2, v68
  v_min_u32 v69, -2, v69
  buffer_store_dwordx2 v[68:69], v63, s[4:7], s17 offen
  buffer_store_dwordx2 v[132:133], v63, s[4:7], s16 offen
  s_add_u32 s12, s12, 1
  s_xor_b32 s16, s16, s17
  s_xor_b32 s17, s17, s16
  s_xor_b32 s16, s16, s17
  s_add_u32 s13, s16, 5120
  s_add_u32 s14, s16, 7168
  s_add_u32 s38, s32, s39
  s_add_u32 s39, s39, 655360
  s_cmp_eq_u32 s39, 1966080
  s_cselect_b32 s39, 0, s39
  s_add_u32 s37, s32, s39
  s_add_u32 s33, s30, s39
  s_add_u32 s34, s33, 327680
  s_add_u32 s35, s31, s39
  s_add_u32 s36, s35, 327680
  s_barrier
  s_nop 3
  s_branch mega_loop2
mega_loop2_pcf:
  s_nop 3
  v_mov_b32 v28, 0
  v_mov_b32 v29, 0
  v_mov_b32 v30, 0
  v_mov_b32 v31, 0
  v_mov_b32 v32, 0
  v_mov_b32 v33, 0
  v_mov_b32 v34, 0
  v_mov_b32 v35, 0
  s_add_u32 s15, s15, 1
  s_cmp_lt_u32 s15, 262144
  s_cbranch_scc1 mega_loop2_pc
  s_branch mega_fail
mega_loop2_last:
  v_smfmac_f32_16x16x64_bf16 v[56:59], v[72:75], a[80:87], v9
  s_waitcnt lgkmcnt(4)
  buffer_store_dwordx4 v[112:115], v64, s[4:7], s23 offen
  v_smfmac_f32_16x16x64_bf16 v[52:55], v[76:79], a[8:15], v9
  buffer_store_dwordx2 v[116:117], v65, s[4:7], s23 offen
  v_smfmac_f32_16x16x64_bf16 v[56:59], v[76:79], a[88:95], v9
  buffer_store_dwordx2 v[132:133], v10, s[4:7], s19 offen
  v_smfmac_f32_16x16x64_bf16 v[52:55], v[80:83], a[16:23], v9
  v_smfmac_f32_16x16x64_bf16 v[56:59], v[80:83], a[96:103], v9
  v_smfmac_f32_16x16x64_bf16 v[52:55], v[84:87], a[24:31], v9
  v_smfmac_f32_16x16x64_bf16 v[56:59], v[84:87], a[104:111], v9
  v_smfmac_f32_16x16x64_bf16 v[52:55], v[88:91], a[32:39], v9
  v_smfmac_f32_16x16x64_bf16 v[56:59], v[88:91], a[112:119], v9
  v_smfmac_f32_16x16x64_bf16 v[52:55], v[92:95], a[64:71], v9
  v_smfmac_f32_16x16x64_bf16 v[56:59], v[92:95], a[144:151], v9
  v_smfmac_f32_16x16x64_bf16 v[52:55], v[96:99], a[72:79], v9
  v_smfmac_f32_16x16x64_bf16 v[56:59], v[96:99], a[152:159], v9
  s_nop 4
  v_pk_add_f32 v[52:53], v[52:53], v[54:55]
  v_cvt_pk_bf16_f32 v52, v52, v53
  ds_write_b32 v8, v52 offset:21504
  v_pk_add_f32 v[56:57], v[56:57], v[58:59]
  v_cvt_pk_bf16_f32 v56, v56, v57
  ds_write_b32 v8, v56 offset:22528
  s_waitcnt vmcnt(0)
  s_add_u32 s27, s12, 1
  v_mov_b32 v14, s27
  buffer_store_dword v14, v67, s[4:7], s77 offen offset:0
  s_waitcnt lgkmcnt(0)
  s_barrier
  ds_read_b128 v[92:95], v13 offset:21504
  s_waitcnt lgkmcnt(0)
  buffer_store_dwordx4 v[92:95], v66, s[4:7], s25 offen
  s_waitcnt vmcnt(0)
  s_barrier
  s_add_u32 s27, s12, 1
  v_mov_b32 v14, s27
  buffer_store_dword v14, v67, s[4:7], s77 offen offset:16
  s_endpgm
mega_loop2_paf:
  s_add_u32 s15, s15, 1
  s_cmp_lt_u32 s15, 262144
  s_cbranch_scc1 mega_loop2_pa
  s_branch mega_fail
mega_loop2_pbf:
  buffer_load_dwordx4 v[96:99], v62, s[4:7], s37 offen offset:0 sc1
  buffer_load_dwordx4 v[100:103], v62, s[4:7], s37 offen offset:512 sc1
mega_loop2_pbl:
  buffer_load_dwordx4 v[96:99], v62, s[4:7], s37 offen offset:0 sc1
  buffer_load_dwordx4 v[100:103], v62, s[4:7], s37 offen offset:512 sc1
  s_waitcnt vmcnt(2)
  v_max3_u32 v14, v96, v97, v98
  v_max3_u32 v14, v14, v99, v100
  v_mfma_f32_16x16x32_bf16 v[128:131], a[160:163], v[96:99], 0
  v_max3_u32 v14, v14, v101, v102
  v_max_u32 v14, v14, v103
  v_mfma_f32_16x16x32_bf16 v[128:131], a[160:163], v[100:103], v[128:131]
  v_cmp_eq_u32 vcc, -1, v14
  s_nop 0
  s_cbranch_vccz mega_loop2_pbok
  s_add_u32 s15, s15, 1
  s_cmp_lt_u32 s15, 262144
  s_cbranch_scc1 mega_loop2_pbl
  s_branch mega_fail
mega_loop3:
  buffer_load_dwordx4 v[16:19], v2, s[4:7], s13 offen sc1
  buffer_load_dwordx4 v[20:23], v2, s[4:7], s13 offen offset:1024 sc1
  buffer_load_dwordx4 v[24:27], v2, s[4:7], s14 offen sc1
mega_loop3_pc:
  buffer_load_dwordx4 v[16:19], v2, s[4:7], s13 offen sc1
  buffer_load_dwordx4 v[20:23], v2, s[4:7], s13 offen offset:1024 sc1
  buffer_load_dwordx4 v[24:27], v2, s[4:7], s14 offen sc1
  s_waitcnt vmcnt(3)
  v_max3_u32 v14, v16, v17, v18
  v_max3_u32 v14, v14, v19, v20
  v_smfmac_f32_16x16x64_bf16 v[44:47], v[16:19], v[136:143], v9
  v_max3_u32 v14, v14, v21, v22
  v_smfmac_f32_16x16x64_bf16 v[48:51], v[16:19], v[144:151], v9
  v_max3_u32 v14, v14, v23, v24
  v_smfmac_f32_16x16x64_bf16 v[44:47], v[20:23], v[152:159], v9
  v_max3_u32 v14, v14, v25, v26
  v_smfmac_f32_16x16x64_bf16 v[48:51], v[20:23], v[160:167], v9
  v_max_u32 v14, v14, v27
  v_smfmac_f32_16x16x64_bf16 v[44:47], v[24:27], v[168:175], v9
  v_cmp_eq_u32 vcc, -1, v14
  v_smfmac_f32_16x16x64_bf16 v[48:51], v[24:27], v[176:183], v9
  s_cbranch_vccnz mega_loop3_pcf
  ds_write_b128 v2, v[16:19] offset:8192
  v_smfmac_f32_16x16x64_bf16 v[36:39], v[16:19], v[184:191], v9
  ds_write_b128 v2, v[20:23] offset:9216
  v_smfmac_f32_16x16x64_bf16 v[40:43], v[16:19], v[192:199], v9
  v_smfmac_f32_16x16x64_bf16 v[36:39], v[20:23], v[200:207], v9
  v_pk_add_f32 v[44:45], v[44:45], v[46:47]
  v_smfmac_f32_16x16x64_bf16 v[40:43], v[20:23], v[208:215], v9
  v_pk_add_f32 v[48:49], v[48:49], v[50:51]
  v_smfmac_f32_16x16x64_bf16 v[40:43], v[24:27], v[216:223], v9
  v_cvt_pk_bf16_f32 v46, v44, v45
  v_smfmac_f32_16x16x64_bf16 v[28:31], v[16:19], v[224:231], v9
  v_cvt_pk_bf16_f32 v47, v48, v49
  v_smfmac_f32_16x16x64_bf16 v[32:35], v[16:19], v[232:239], v9
  ds_write_b64 v3, v[46:47] offset:14336
  v_smfmac_f32_16x16x64_bf16 v[28:31], v[20:23], v[240:247], v9
  v_pk_add_f32 v[36:37], v[36:37], v[38:39]
  v_smfmac_f32_16x16x64_bf16 v[32:35], v[20:23], v[248:255], v9
  v_pk_add_f32 v[40:41], v[40:41], v[42:43]
  v_cvt_pk_bf16_f32 v38, v36, v37
  v_cvt_pk_bf16_f32 v39, v40, v41
  ds_write_b64 v3, v[38:39] offset:12288
  v_smfmac_f32_16x16x64_bf16 v[52:55], v[16:19], a[64:71], v9
  v_pk_add_f32 v[28:29], v[28:29], v[30:31]
  s_nop 1
  v_pk_add_f32 v[32:33], v[32:33], v[34:35]
  v_cvt_pk_bf16_f32 v30, v28, v29
  v_cvt_pk_bf16_f32 v31, v32, v33
  ds_write_b64 v3, v[30:31] offset:10240
  v_smfmac_f32_16x16x64_bf16 v[56:59], v[16:19], a[144:151], v9
  v_smfmac_f32_16x16x64_bf16 v[60:63], v[16:19], a[224:231], v9
  v_smfmac_f32_16x16x64_bf16 v[64:67], v[16:19], v[120:127], v9
  s_waitcnt lgkmcnt(0)
  s_barrier
  v_smfmac_f32_16x16x64_bf16 v[52:55], v[20:23], a[72:79], v9
  v_smfmac_f32_16x16x64_bf16 v[56:59], v[20:23], a[152:159], v9
  ds_read_b128 v[40:43], v2 offset:0
  v_smfmac_f32_16x16x64_bf16 v[60:63], v[20:23], a[232:239], v9
  ds_read_b128 v[28:31], v2 offset:1024
  v_smfmac_f32_16x16x64_bf16 v[64:67], v[20:23], v[128:135], v9
  ds_read_b128 v[32:35], v2 offset:2048
  v_smfmac_f32_16x16x64_bf16 v[52:55], v[24:27], a[56:63], v9
  ds_read_b128 v[36:39], v2 offset:3072
  v_smfmac_f32_16x16x64_bf16 v[56:59], v[24:27], a[136:143], v9
  ds_read_b128 v[44:47], v2 offset:4096
  v_smfmac_f32_16x16x64_bf16 v[60:63], v[24:27], a[216:223], v9
  ds_read_b128 v[48:51], v2 offset:5120
  v_smfmac_f32_16x16x64_bf16 v[64:67], v[24:27], v[112:119], v9
  s_cmp_eq_u32 s12, 63
  s_cbranch_scc1 mega_loop3_last
  s_waitcnt lgkmcnt(0)
  v_smfmac_f32_16x16x64_bf16 v[52:55], v[40:43], a[0:7], v9
  v_smfmac_f32_16x16x64_bf16 v[56:59], v[40:43], a[80:87], v9
  v_smfmac_f32_16x16x64_bf16 v[60:63], v[40:43], a[160:167], v9
  v_smfmac_f32_16x16x64_bf16 v[64:67], v[40:43], a[240:247], v9
  ds_read_b128 v[40:43], v2 offset:6144
  v_smfmac_f32_16x16x64_bf16 v[52:55], v[28:31], a[8:15], v9
  v_smfmac_f32_16x16x64_bf16 v[56:59], v[28:31], a[88:95], v9
  v_smfmac_f32_16x16x64_bf16 v[60:63], v[28:31], a[168:175], v9
  v_smfmac_f32_16x16x64_bf16 v[64:67], v[28:31], a[248:255], v9
  ds_read_b128 v[28:31], v2 offset:37888
  v_smfmac_f32_16x16x64_bf16 v[52:55], v[32:35], a[16:23], v9
  v_smfmac_f32_16x16x64_bf16 v[56:59], v[32:35], a[96:103], v9
  v_smfmac_f32_16x16x64_bf16 v[60:63], v[32:35], a[176:183], v9
  v_smfmac_f32_16x16x64_bf16 v[64:67], v[32:35], v[72:79], v9
  ds_read_b128 v[32:35], v2 offset:38912
  v_smfmac_f32_16x16x64_bf16 v[52:55], v[36:39], a[24:31], v9
  v_smfmac_f32_16x16x64_bf16 v[56:59], v[36:39], a[104:111], v9
  v_smfmac_f32_16x16x64_bf16 v[60:63], v[36:39], a[184:191], v9
  v_smfmac_f32_16x16x64_bf16 v[64:67], v[36:39], v[80:87], v9
  ds_read_b128 v[36:39], v2 offset:39936
  v_smfmac_f32_16x16x64_bf16 v[52:55], v[44:47], a[32:39], v9
  v_smfmac_f32_16x16x64_bf16 v[56:59], v[44:47], a[112:119], v9
  v_smfmac_f32_16x16x64_bf16 v[60:63], v[44:47], a[192:199], v9
  buffer_load_dwordx4 v[16:19], v4, s[4:7], s20 offen sc1
  v_smfmac_f32_16x16x64_bf16 v[64:67], v[44:47], v[88:95], v9
  buffer_load_dwordx4 v[20:23], v4, s[4:7], s20 offen offset:256 sc1
  v_smfmac_f32_16x16x64_bf16 v[52:55], v[48:51], a[40:47], v9
  buffer_load_dwordx4 v[24:27], v5, s[4:7], s20 offen offset:512 sc1
  v_smfmac_f32_16x16x64_bf16 v[56:59], v[48:51], a[120:127], v9
  v_smfmac_f32_16x16x64_bf16 v[60:63], v[48:51], a[200:207], v9
  v_smfmac_f32_16x16x64_bf16 v[64:67], v[48:51], v[96:103], v9
  s_waitcnt lgkmcnt(3)
  v_smfmac_f32_16x16x64_bf16 v[52:55], v[40:43], a[48:55], v9
  v_smfmac_f32_16x16x64_bf16 v[56:59], v[40:43], a[128:135], v9
  v_smfmac_f32_16x16x64_bf16 v[60:63], v[40:43], a[208:215], v9
  v_smfmac_f32_16x16x64_bf16 v[64:67], v[40:43], v[104:111], v9
  v_pk_add_f32 v[52:53], v[52:53], v[54:55]
  v_cvt_pk_bf16_f32 v52, v52, v53
  ds_write_b32 v8, v52 offset:21504
  v_pk_add_f32 v[56:57], v[56:57], v[58:59]
  v_cvt_pk_bf16_f32 v56, v56, v57
  ds_write_b32 v8, v56 offset:22528
  v_pk_add_f32 v[60:61], v[60:61], v[62:63]
  v_cvt_pk_bf16_f32 v60, v60, v61
  ds_write_b32 v10, v60 offset:23552
  v_pk_add_f32 v[64:65], v[64:65], v[66:67]
  v_cvt_pk_bf16_f32 v64, v64, v65
  ds_write_b32 v10, v64 offset:24064
mega_loop3_pa:
  buffer_load_dwordx4 v[16:19], v4, s[4:7], s20 offen sc1
  buffer_load_dwordx4 v[20:23], v4, s[4:7], s20 offen offset:256 sc1
  buffer_load_dwordx4 v[24:27], v5, s[4:7], s20 offen offset:512 sc1
  s_waitcnt vmcnt(3) lgkmcnt(0)
  v_max3_u32 v14, v16, v17, v18
  v_max3_u32 v14, v14, v19, v20
  v_mfma_f32_16x16x32_bf16 v[40:43], v[16:19], v[28:31], 0
  v_max3_u32 v14, v14, v21, v22
  v_max3_u32 v14, v14, v23, v24
  v_mfma_f32_16x16x32_bf16 v[40:43], v[20:23], v[32:35], v[40:43]
  v_max3_u32 v14, v14, v25, v26
  v_max_u32 v14, v14, v27
  v_mfma_f32_16x16x32_bf16 v[44:47], v[24:27], v[36:39], 0
  v_cmp_eq_u32 vcc, -1, v14
  s_nop 0
  s_cbranch_vccnz mega_loop3_paf
  s_nop 1
  v_max3_f32 v48, v40, v41, v42
  s_nop 1
  v_cndmask_b32 v44, v44, v45, s[42:43]
  v_max3_f32 v48, v48, v43, v44
  s_nop 1
  v_max_f32_dpp v48, v48, v48 quad_perm:[1,0,3,2] row_mask:0xf bank_mask:0xf
  s_nop 1
  v_max_f32_dpp v48, v48, v48 quad_perm:[2,3,0,1] row_mask:0xf bank_mask:0xf
  s_nop 1
  v_max_f32_dpp v48, v48, v48 row_half_mirror row_mask:0xf bank_mask:0xf
  v_mul_f32 v48, s26, v48
  v_fma_f32 v40, v40, s26, -v48
  v_fma_f32 v41, v41, s26, -v48
  v_fma_f32 v42, v42, s26, -v48
  v_fma_f32 v43, v43, s26, -v48
  v_fma_f32 v44, v44, s26, -v48
  v_exp_f32 v40, v40
  v_exp_f32 v41, v41
  v_exp_f32 v42, v42
  v_exp_f32 v43, v43
  v_exp_f32 v44, v44
  v_add_f32 v48, v40, v41
  v_add_f32 v49, v42, v43
  v_add_f32 v48, v48, v49
  v_add_f32 v48, v48, v44
  s_nop 1
  v_add_f32_dpp v48, v48, v48 quad_perm:[1,0,3,2] row_mask:0xf bank_mask:0xf
  s_nop 1
  v_add_f32_dpp v48, v48, v48 quad_perm:[2,3,0,1] row_mask:0xf bank_mask:0xf
  s_nop 1
  v_add_f32_dpp v48, v48, v48 row_half_mirror row_mask:0xf bank_mask:0xf
  v_rcp_f32 v48, v48
  s_nop 0
  v_pk_mul_f32 v[40:41], v[40:41], v[48:49] op_sel_hi:[1,0]
  v_pk_mul_f32 v[42:43], v[42:43], v[48:49] op_sel_hi:[1,0]
  v_mul_f32 v44, v44, v48
  v_cvt_pk_bf16_f32 v40, v40, v41
  v_cvt_pk_bf16_f32 v41, v42, v43
  ds_write_b64 v6, v[40:41] offset:16384
  v_cvt_pk_bf16_f32 v44, v44, v44
  ds_write_b16 v7, v44 offset:20480
  v_min_u32_dpp v13, v13, v13 quad_perm:[1,0,3,2] row_mask:0xf bank_mask:0xf
  s_nop 1
  v_min_u32_dpp v13, v13, v13 quad_perm:[2,3,0,1] row_mask:0xf bank_mask:0xf
  s_nop 1
  v_min_u32_dpp v13, v13, v13 row_half_mirror row_mask:0xf bank_mask:0xf
  s_nop 0
  v_readfirstlane_b32 s76, v13
  s_waitcnt lgkmcnt(0)
  s_barrier
  v_mov_b32 v28, 0
  v_mov_b32 v29, 0
  v_mov_b32 v30, 0
  v_mov_b32 v31, 0
  v_mov_b32 v32, 0
  v_mov_b32 v33, 0
  v_mov_b32 v34, 0
  v_mov_b32 v35, 0
  v_mov_b32 v36, 0
  v_mov_b32 v37, 0
  v_mov_b32 v38, 0
  v_mov_b32 v39, 0
  v_mov_b32 v40, 0
  v_mov_b32 v41, 0
  v_mov_b32 v42, 0
  v_mov_b32 v43, 0
  v_mov_b32 v44, 0
  v_mov_b32 v45, 0
  v_mov_b32 v46, 0
  v_mov_b32 v47, 0
  v_mov_b32 v48, 0
  v_mov_b32 v49, 0
  v_mov_b32 v50, 0
  v_mov_b32 v51, 0
  v_mov_b32 v52, 0
  v_mov_b32 v53, 0
  v_mov_b32 v54, 0
  v_mov_b32 v55, 0
  v_mov_b32 v56, 0
  v_mov_b32 v57, 0
  v_mov_b32 v58, 0
  v_mov_b32 v59, 0
  v_mov_b32 v60, 0
  v_mov_b32 v61, 0
  v_mov_b32 v62, 0
  v_mov_b32 v63, 0
  v_mov_b32 v64, 0
  v_mov_b32 v65, 0
  v_mov_b32 v66, 0
  v_mov_b32 v67, 0
  s_xor_b32 s18, s18, s19
  s_xor_b32 s19, s19, s18
  s_xor_b32 s18, s18, s19
  s_xor_b32 s20, s20, s21
  s_xor_b32 s21, s21, s20
  s_xor_b32 s20, s20, s21
  s_mov_b32 s15, 0
  s_barrier
  s_add_u32 s29, s12, 2
  s_cmp_lt_u32 s76, s29
  s_cbranch_scc1 mega0_kernel_sd22_wait
mega0_kernel_sd22_go:
  s_mov_b32 m0, 34816
  s_add_u32 s27, s22, 0
  buffer_load_dwordx4 v2, s[4:7], s27 offen sc1 lds
  s_mov_b32 m0, 35840
  s_add_u32 s27, s22, 4096
  buffer_load_dwordx4 v2, s[4:7], s27 offen sc1 lds
  s_mov_b32 m0, 36864
  s_add_u32 s27, s22, 8192
  buffer_load_dwordx4 v2, s[4:7], s27 offen sc1 lds
  s_mov_b32 m0, 24576
  s_add_u32 s27, s24, 0
  buffer_load_dwordx4 v2, s[4:7], s27 offen sc1 lds
  s_mov_b32 m0, 25600
  s_add_u32 s27, s24, 1024
  buffer_load_dwordx4 v2, s[4:7], s27 offen sc1 lds
  s_mov_b32 m0, 26624
  s_add_u32 s27, s24, 2048
  buffer_load_dwordx4 v11, s[4:7], s27 offen sc1 lds
  s_mov_b32 m0, 27648
  s_add_u32 s27, s24, 41472
  buffer_load_dwordx4 v2, s[4:7], s27 offen sc1 lds
  s_mov_b32 m0, 28672
  s_add_u32 s27, s24, 42496
  buffer_load_dwordx4 v2, s[4:7], s27 offen sc1 lds
  s_mov_b32 m0, 29696
  s_add_u32 s27, s24, 81920
  buffer_load_dwordx4 v2, s[4:7], s27 offen sc1 lds
  s_mov_b32 m0, 30720
  s_add_u32 s27, s24, 82944
  buffer_load_dwordx4 v2, s[4:7], s27 offen sc1 lds
  s_mov_b32 m0, 31744
  s_add_u32 s27, s24, 83968
  buffer_load_dwordx4 v11, s[4:7], s27 offen sc1 lds
  s_mov_b32 m0, 32768
  s_add_u32 s27, s24, 123392
  buffer_load_dwordx4 v2, s[4:7], s27 offen sc1 lds
  s_mov_b32 m0, 33792
  s_add_u32 s27, s24, 124416
  buffer_load_dwordx4 v2, s[4:7], s27 offen sc1 lds
  buffer_load_dword v13, v12, s[4:7], s71 offen sc1
  s_add_u32 s72, s72, 1
  s_cmp_eq_u32 s72, 6
  s_cselect_b32 s72, 0, s72
  s_mov_b32 s73, 325632
  s_cselect_b32 s73, 0xffe72800, s73
  s_add_u32 s22, s22, s73
  s_add_u32 s24, s24, s73
  s_add_u32 s12, s12, 1
  s_xor_b32 s16, s16, s17
  s_xor_b32 s17, s17, s16
  s_xor_b32 s16, s16, s17
  s_add_u32 s13, s16, 8192
  s_add_u32 s14, s16, 7168
  s_barrier
  s_nop 3
  s_branch mega_loop3
mega_loop3_pcf:
  s_nop 3
  v_mov_b32 v44, 0
  v_mov_b32 v45, 0
  v_mov_b32 v46, 0
  v_mov_b32 v47, 0
  v_mov_b32 v48, 0
  v_mov_b32 v49, 0
  v_mov_b32 v50, 0
  v_mov_b32 v51, 0
  s_add_u32 s15, s15, 1
  s_cmp_lt_u32 s15, 262144
  s_cbranch_scc1 mega_loop3_pc
  s_branch mega_fail
mega_loop3_last:
  s_waitcnt lgkmcnt(0)
  v_smfmac_f32_16x16x64_bf16 v[52:55], v[40:43], a[0:7], v9
  v_smfmac_f32_16x16x64_bf16 v[56:59], v[40:43], a[80:87], v9
  v_smfmac_f32_16x16x64_bf16 v[60:63], v[40:43], a[160:167], v9
  v_smfmac_f32_16x16x64_bf16 v[64:67], v[40:43], a[240:247], v9
  ds_read_b128 v[40:43], v2 offset:6144
  v_smfmac_f32_16x16x64_bf16 v[52:55], v[28:31], a[8:15], v9
  v_smfmac_f32_16x16x64_bf16 v[56:59], v[28:31], a[88:95], v9
  v_smfmac_f32_16x16x64_bf16 v[60:63], v[28:31], a[168:175], v9
  v_smfmac_f32_16x16x64_bf16 v[64:67], v[28:31], a[248:255], v9
  ds_read_b128 v[28:31], v2 offset:37888
  v_smfmac_f32_16x16x64_bf16 v[52:55], v[32:35], a[16:23], v9
  v_smfmac_f32_16x16x64_bf16 v[56:59], v[32:35], a[96:103], v9
  v_smfmac_f32_16x16x64_bf16 v[60:63], v[32:35], a[176:183], v9
  v_smfmac_f32_16x16x64_bf16 v[64:67], v[32:35], v[72:79], v9
  ds_read_b128 v[32:35], v2 offset:38912
  v_smfmac_f32_16x16x64_bf16 v[52:55], v[36:39], a[24:31], v9
  v_smfmac_f32_16x16x64_bf16 v[56:59], v[36:39], a[104:111], v9
  v_smfmac_f32_16x16x64_bf16 v[60:63], v[36:39], a[184:191], v9
  v_smfmac_f32_16x16x64_bf16 v[64:67], v[36:39], v[80:87], v9
  ds_read_b128 v[36:39], v2 offset:39936
  v_smfmac_f32_16x16x64_bf16 v[52:55], v[44:47], a[32:39], v9
  v_smfmac_f32_16x16x64_bf16 v[56:59], v[44:47], a[112:119], v9
  v_smfmac_f32_16x16x64_bf16 v[60:63], v[44:47], a[192:199], v9
  v_smfmac_f32_16x16x64_bf16 v[64:67], v[44:47], v[88:95], v9
  v_smfmac_f32_16x16x64_bf16 v[52:55], v[48:51], a[40:47], v9
  v_smfmac_f32_16x16x64_bf16 v[56:59], v[48:51], a[120:127], v9
  v_smfmac_f32_16x16x64_bf16 v[60:63], v[48:51], a[200:207], v9
  v_smfmac_f32_16x16x64_bf16 v[64:67], v[48:51], v[96:103], v9
  s_waitcnt lgkmcnt(3)
  v_smfmac_f32_16x16x64_bf16 v[52:55], v[40:43], a[48:55], v9
  v_smfmac_f32_16x16x64_bf16 v[56:59], v[40:43], a[128:135], v9
  v_smfmac_f32_16x16x64_bf16 v[60:63], v[40:43], a[208:215], v9
  v_smfmac_f32_16x16x64_bf16 v[64:67], v[40:43], v[104:111], v9
  v_pk_add_f32 v[52:53], v[52:53], v[54:55]
  v_cvt_pk_bf16_f32 v52, v52, v53
  ds_write_b32 v8, v52 offset:21504
  v_pk_add_f32 v[56:57], v[56:57], v[58:59]
  v_cvt_pk_bf16_f32 v56, v56, v57
  ds_write_b32 v8, v56 offset:22528
  v_pk_add_f32 v[60:61], v[60:61], v[62:63]
  v_cvt_pk_bf16_f32 v60, v60, v61
  ds_write_b32 v10, v60 offset:23552
  v_pk_add_f32 v[64:65], v[64:65], v[66:67]
  v_cvt_pk_bf16_f32 v64, v64, v65
  ds_write_b32 v10, v64 offset:24064
  s_waitcnt lgkmcnt(0)
  s_barrier
  s_barrier
  s_endpgm
mega_loop3_paf:
  s_add_u32 s15, s15, 1
  s_cmp_lt_u32 s15, 262144
  s_cbranch_scc1 mega_loop3_pa
  s_branch mega_fail
mega0_kernel_sd22_wait:
  s_mov_b32 s15, 0
mega0_kernel_sd22_w2:
  buffer_load_dword v13, v12, s[4:7], s71 offen sc1
  s_waitcnt vmcnt(0)
  v_min_u32_dpp v13, v13, v13 quad_perm:[1,0,3,2] row_mask:0xf bank_mask:0xf
  s_nop 1
  v_min_u32_dpp v13, v13, v13 quad_perm:[2,3,0,1] row_mask:0xf bank_mask:0xf
  s_nop 1
  v_min_u32_dpp v13, v13, v13 row_half_mirror row_mask:0xf bank_mask:0xf
  s_nop 0
  v_readfirstlane_b32 s76, v13
  s_nop 0
  s_cmp_ge_u32 s76, s29
  s_cbranch_scc1 mega0_kernel_sd22_go
  s_sleep 1
  s_add_u32 s15, s15, 1
  s_cmp_lt_u32 s15, 262144
  s_cbranch_scc1 mega0_kernel_sd22_w2
  s_branch mega_fail
mega_loop4:
  buffer_load_dwordx4 v[16:19], v2, s[4:7], s13 offen sc1
  buffer_load_dwordx4 v[20:23], v2, s[4:7], s13 offen offset:1024 sc1
  buffer_load_dwordx4 v[24:27], v2, s[4:7], s14 offen sc1
mega_loop4_pc:
  buffer_load_dwordx4 v[16:19], v2, s[4:7], s13 offen sc1
  buffer_load_dwordx4 v[20:23], v2, s[4:7], s13 offen offset:1024 sc1
  buffer_load_dwordx4 v[24:27], v2, s[4:7], s14 offen sc1
  s_waitcnt vmcnt(3)
  v_max3_u32 v14, v16, v17, v18
  v_max3_u32 v14, v14, v19, v20
  v_smfmac_f32_16x16x64_bf16 v[28:31], v[16:19], v[136:143], v9
  v_max3_u32 v14, v14, v21, v22
  v_smfmac_f32_16x16x64_bf16 v[32:35], v[16:19], v[144:151], v9
  v_max3_u32 v14, v14, v23, v24
  v_smfmac_f32_16x16x64_bf16 v[28:31], v[20:23], v[152:159], v9
  v_max3_u32 v14, v14, v25, v26
  v_smfmac_f32_16x16x64_bf16 v[32:35], v[20:23], v[160:167], v9
  v_max_u32 v14, v14, v27
  v_smfmac_f32_16x16x64_bf16 v[28:31], v[24:27], v[168:175], v9
  v_cmp_eq_u32 vcc, -1, v14
  v_smfmac_f32_16x16x64_bf16 v[32:35], v[24:27], v[176:183], v9
  s_cbranch_vccnz mega_loop4_pcf
  ds_write_b128 v2, v[16:19] offset:0
  v_smfmac_f32_16x16x64_bf16 v[36:39], v[16:19], v[184:191], v9
  ds_write_b128 v2, v[20:23] offset:1024
  v_smfmac_f32_16x16x64_bf16 v[40:43], v[16:19], v[192:199], v9
  ds_write_b128 v2, v[24:27] offset:2048
  v_smfmac_f32_16x16x64_bf16 v[36:39], v[20:23], v[200:207], v9
  v_pk_add_f32 v[28:29], v[28:29], v[30:31]
  v_smfmac_f32_16x16x64_bf16 v[40:43], v[20:23], v[208:215], v9
  v_pk_add_f32 v[32:33], v[32:33], v[34:35]
  v_smfmac_f32_16x16x64_bf16 v[36:39], v[24:27], v[216:223], v9
  v_cvt_pk_bf16_f32 v30, v28, v29
  v_smfmac_f32_16x16x64_bf16 v[44:47], v[16:19], v[224:231], v9
  v_cvt_pk_bf16_f32 v31, v32, v33
  v_smfmac_f32_16x16x64_bf16 v[48:51], v[16:19], v[232:239], v9
  ds_write_b64 v3, v[30:31] offset:10240
  v_smfmac_f32_16x16x64_bf16 v[44:47], v[20:23], v[240:247], v9
  v_pk_add_f32 v[36:37], v[36:37], v[38:39]
  v_smfmac_f32_16x16x64_bf16 v[48:51], v[20:23], v[248:255], v9
  v_pk_add_f32 v[40:41], v[40:41], v[42:43]
  v_cvt_pk_bf16_f32 v38, v36, v37
  v_cvt_pk_bf16_f32 v39, v40, v41
  ds_write_b64 v3, v[38:39] offset:12288
  v_smfmac_f32_16x16x64_bf16 v[52:55], v[16:19], a[0:7], v9
  v_pk_add_f32 v[44:45], v[44:45], v[46:47]
  s_nop 1
  v_pk_add_f32 v[48:49], v[48:49], v[50:51]
  v_cvt_pk_bf16_f32 v46, v44, v45
  v_cvt_pk_bf16_f32 v47, v48, v49
  ds_write_b64 v3, v[46:47] offset:14336
  v_smfmac_f32_16x16x64_bf16 v[56:59], v[16:19], a[80:87], v9
  v_smfmac_f32_16x16x64_bf16 v[52:55], v[20:23], a[8:15], v9
  v_smfmac_f32_16x16x64_bf16 v[56:59], v[20:23], a[88:95], v9
  s_waitcnt lgkmcnt(0)
  s_barrier
  ds_read_b128 v[28:31], v2 offset:10240
  ds_read_b128 v[32:35], v2 offset:11264
  ds_read_b128 v[36:39], v2 offset:12288
  ds_read_b128 v[40:43], v2 offset:13312
  ds_read_b128 v[44:47], v2 offset:14336
  ds_read_b128 v[48:51], v2 offset:15360
  ds_read_b128 v[120:123], v11 offset:34816
  ds_read_b64 v[124:125], v11 offset:36864
  v_smfmac_f32_16x16x64_bf16 v[52:55], v[24:27], a[16:23], v9
  v_smfmac_f32_16x16x64_bf16 v[56:59], v[24:27], a[96:103], v9
  s_waitcnt lgkmcnt(7)
  v_mfma_f32_16x16x32_bf16 v[100:103], v[28:31], a[172:175], 0
  ds_read_b128 v[72:75], v2 offset:3072
  s_waitcnt lgkmcnt(7)
  v_mfma_f32_16x16x32_bf16 v[100:103], v[32:35], a[172:175], v[100:103]
  ds_read_b128 v[76:79], v2 offset:4096
  s_waitcnt lgkmcnt(7)
  v_mfma_f32_16x16x32_bf16 v[104:107], v[36:39], a[172:175], 0
  ds_read_b128 v[80:83], v2 offset:5120
  s_waitcnt lgkmcnt(7)
  v_mfma_f32_16x16x32_bf16 v[104:107], v[40:43], a[172:175], v[104:107]
  ds_read_b128 v[84:87], v2 offset:6144
  s_waitcnt lgkmcnt(7)
  v_mfma_f32_16x16x32_bf16 v[108:111], v[44:47], a[172:175], 0
  ds_read_b128 v[88:91], v2 offset:7168
  v_cvt_pk_bf16_f32 v112, v100, v101
  v_cvt_pk_bf16_f32 v113, v102, v103
  s_waitcnt lgkmcnt(7)
  v_mfma_f32_16x16x32_bf16 v[108:111], v[48:51], a[172:175], v[108:111]
  ds_read_b128 v[92:95], v2 offset:8192
  v_cvt_pk_bf16_f32 v114, v104, v105
  v_cvt_pk_bf16_f32 v115, v106, v107
  ds_read_b128 v[96:99], v2 offset:9216
  s_waitcnt lgkmcnt(7)
  v_mfma_f32_16x16x32_bf16 v[128:131], v[120:123], v[112:115], 0
  s_nop 1
  v_cvt_pk_bf16_f32 v116, v108, v109
  v_cvt_pk_bf16_f32 v117, v110, v111
  s_nop 1
  v_mfma_f32_16x16x32_bf16 v[128:131], v[124:127], v[116:119], v[128:131]
  s_waitcnt lgkmcnt(6)
  v_smfmac_f32_16x16x64_bf16 v[52:55], v[72:75], a[24:31], v9
  ds_read_b128 a[176:179], v60 offset:24576
  ds_read_b128 a[180:183], v60 offset:27136
  ds_read_b128 a[184:187], v60 offset:29696
  ds_read_b128 a[188:191], v60 offset:32256
  s_nop 0
  v_cvt_pk_bf16_f32 v68, v128, v129
  v_cvt_pk_bf16_f32 v69, v130, v131
  v_min_u32 v68, -2, v68
  v_min_u32 v69, -2, v69
  buffer_store_dwordx2 v[68:69], v10, s[4:7], s18 offen sc1
  s_cmp_eq_u32 s12, 63
  s_cbranch_scc1 mega_loop4_last
  v_smfmac_f32_16x16x64_bf16 v[56:59], v[72:75], a[104:111], v9
  s_waitcnt lgkmcnt(4)
  buffer_store_dwordx2 v[132:133], v10, s[4:7], s19 offen sc1
  v_smfmac_f32_16x16x64_bf16 v[52:55], v[76:79], a[32:39], v9
  v_smfmac_f32_16x16x64_bf16 v[56:59], v[76:79], a[112:119], v9
  v_smfmac_f32_16x16x64_bf16 v[52:55], v[80:83], a[40:47], v9
  v_smfmac_f32_16x16x64_bf16 v[56:59], v[80:83], a[120:127], v9
  v_smfmac_f32_16x16x64_bf16 v[52:55], v[84:87], a[48:55], v9
  v_smfmac_f32_16x16x64_bf16 v[56:59], v[84:87], a[128:135], v9
  buffer_load_dwordx4 v[16:19], v4, s[4:7], s20 offen sc1
  v_smfmac_f32_16x16x64_bf16 v[52:55], v[88:91], a[56:63], v9
  buffer_load_dwordx4 v[20:23], v4, s[4:7], s20 offen offset:256 sc1
  v_smfmac_f32_16x16x64_bf16 v[56:59], v[88:91], a[136:143], v9
  buffer_load_dwordx4 v[24:27], v5, s[4:7], s20 offen offset:512 sc1
  v_smfmac_f32_16x16x64_bf16 v[52:55], v[92:95], a[64:71], v9
  v_smfmac_f32_16x16x64_bf16 v[56:59], v[92:95], a[144:151], v9
  v_smfmac_f32_16x16x64_bf16 v[52:55], v[96:99], a[72:79], v9
  v_smfmac_f32_16x16x64_bf16 v[56:59], v[96:99], a[152:159], v9
  s_nop 4
  v_pk_add_f32 v[52:53], v[52:53], v[54:55]
  v_cvt_pk_bf16_f32 v52, v52, v53
  ds_write_b32 v8, v52 offset:21504
  v_pk_add_f32 v[56:57], v[56:57], v[58:59]
  v_cvt_pk_bf16_f32 v56, v56, v57
  ds_write_b32 v8, v56 offset:22528
mega_loop4_pa:
  buffer_load_dwordx4 v[16:19], v4, s[4:7], s20 offen sc1
  buffer_load_dwordx4 v[20:23], v4, s[4:7], s20 offen offset:256 sc1
  buffer_load_dwordx4 v[24:27], v5, s[4:7], s20 offen offset:512 sc1
  s_waitcnt vmcnt(3)
  v_max3_u32 v14, v16, v17, v18
  v_max3_u32 v14, v14, v19, v20
  v_mfma_f32_16x16x32_bf16 v[40:43], v[16:19], a[160:163], 0
  v_max3_u32 v14, v14, v21, v22
  v_max3_u32 v14, v14, v23, v24
  v_mfma_f32_16x16x32_bf16 v[40:43], v[20:23], a[164:167], v[40:43]
  v_max3_u32 v14, v14, v25, v26
  v_max_u32 v14, v14, v27
  v_mfma_f32_16x16x32_bf16 v[44:47], v[24:27], a[168:171], 0
  v_cmp_eq_u32 vcc, -1, v14
  s_nop 0
  s_cbranch_vccnz mega_loop4_paf
  s_nop 1
  v_max3_f32 v48, v40, v41, v42
  s_nop 1
  v_cndmask_b32 v44, v44, v45, s[42:43]
  v_max3_f32 v48, v48, v43, v44
  s_nop 1
  v_max_f32_dpp v48, v48, v48 quad_perm:[1,0,3,2] row_mask:0xf bank_mask:0xf
  s_nop 1
  v_max_f32_dpp v48, v48, v48 quad_perm:[2,3,0,1] row_mask:0xf bank_mask:0xf
  s_nop 1
  v_max_f32_dpp v48, v48, v48 row_half_mirror row_mask:0xf bank_mask:0xf
  v_mul_f32 v48, s26, v48
  v_fma_f32 v40, v40, s26, -v48
  v_fma_f32 v41, v41, s26, -v48
  v_fma_f32 v42, v42, s26, -v48
  v_fma_f32 v43, v43, s26, -v48
  v_fma_f32 v44, v44, s26, -v48
  v_exp_f32 v40, v40
  v_exp_f32 v41, v41
  v_exp_f32 v42, v42
  v_exp_f32 v43, v43
  v_exp_f32 v44, v44
  v_add_f32 v48, v40, v41
  v_add_f32 v49, v42, v43
  v_add_f32 v48, v48, v49
  v_add_f32 v48, v48, v44
  s_nop 1
  v_add_f32_dpp v48, v48, v48 quad_perm:[1,0,3,2] row_mask:0xf bank_mask:0xf
  s_nop 1
  v_add_f32_dpp v48, v48, v48 quad_perm:[2,3,0,1] row_mask:0xf bank_mask:0xf
  s_nop 1
  v_add_f32_dpp v48, v48, v48 row_half_mirror row_mask:0xf bank_mask:0xf
  v_rcp_f32 v48, v48
  s_nop 0
  v_pk_mul_f32 v[40:41], v[40:41], v[48:49] op_sel_hi:[1,0]
  v_pk_mul_f32 v[42:43], v[42:43], v[48:49] op_sel_hi:[1,0]
  v_mul_f32 v44, v44, v48
  v_cvt_pk_bf16_f32 v40, v40, v41
  v_cvt_pk_bf16_f32 v41, v42, v43
  ds_write_b64 v6, v[40:41] offset:16384
  v_cvt_pk_bf16_f32 v44, v44, v44
  ds_write_b16 v7, v44 offset:20480
  s_waitcnt lgkmcnt(0)
  s_barrier
  ds_read_b128 v[72:75], v12 offset:16384
  ds_read_b128 v[76:79], v12 offset:17408
  ds_read_b128 v[80:83], v12 offset:18432
  ds_read_b128 v[84:87], v12 offset:19456
  ds_read_b128 v[88:91], v12 offset:20480
  ds_read_b128 v[92:95], v13 offset:21504
  s_waitcnt lgkmcnt(5)
  v_mfma_f32_16x16x32_bf16 v[128:131], a[176:179], v[72:75], 0
  s_waitcnt lgkmcnt(4)
  v_mfma_f32_16x16x32_bf16 v[128:131], a[180:183], v[76:79], v[128:131]
  s_waitcnt lgkmcnt(3)
  v_mfma_f32_16x16x32_bf16 v[128:131], a[184:187], v[80:83], v[128:131]
  s_waitcnt lgkmcnt(2)
  v_mfma_f32_16x16x32_bf16 v[128:131], a[188:191], v[84:87], v[128:131]
  s_waitcnt lgkmcnt(0)
  v_mfma_f32_16x16x32_bf16 v[128:131], v[92:95], v[88:91], v[128:131]
  v_mov_b32 v28, 0
  v_mov_b32 v29, 0
  v_mov_b32 v30, 0
  v_mov_b32 v31, 0
  v_mov_b32 v32, 0
  v_mov_b32 v33, 0
  v_mov_b32 v34, 0
  s_nop 0
  v_cvt_pk_bf16_f32 v68, v128, v129
  v_cvt_pk_bf16_f32 v69, v130, v131
  v_min_u32 v71, -2, v69
  v_min_u32 v70, -2, v68
  v_min_u32 v69, -2, v69
  v_min_u32 v68, -2, v68
  s_nop 1
  v_permlane16_swap_b32 v68, v70
  v_permlane16_swap_b32 v69, v71
  buffer_store_dwordx4 v[68:71], v61, s[4:7], s33 offen sc1
  buffer_store_dwordx4 v[68:71], v61, s[4:7], s35 offen sc1
  v_mov_b32 v35, 0
  v_mov_b32 v36, 0
  v_mov_b32 v37, 0
  v_mov_b32 v38, 0
  v_mov_b32 v39, 0
  v_mov_b32 v40, 0
  v_mov_b32 v41, 0
  v_mov_b32 v42, 0
  v_mov_b32 v43, 0
  v_mov_b32 v44, 0
  v_mov_b32 v45, 0
  v_mov_b32 v46, 0
  v_mov_b32 v47, 0
  v_mov_b32 v48, 0
  v_mov_b32 v49, 0
  v_mov_b32 v50, 0
  v_mov_b32 v51, 0
  v_mov_b32 v52, 0
  v_mov_b32 v53, 0
  v_mov_b32 v54, 0
  v_mov_b32 v55, 0
  v_mov_b32 v56, 0
  v_mov_b32 v57, 0
  v_mov_b32 v58, 0
  v_mov_b32 v59, 0
  s_xor_b32 s18, s18, s19
  s_xor_b32 s19, s19, s18
  s_xor_b32 s18, s18, s19
  s_xor_b32 s20, s20, s21
  s_xor_b32 s21, s21, s20
  s_xor_b32 s20, s20, s21
  s_add_u32 s72, s72, 1
  s_cmp_eq_u32 s72, 6
  s_cselect_b32 s72, 0, s72
  s_mov_b32 s73, 325632
  s_cselect_b32 s73, 0xffe72800, s73
  s_add_u32 s23, s23, s73
  s_mov_b32 s15, 0
  s_nop 15
  s_nop 15
  s_nop 15
  s_nop 15
  s_nop 9
  buffer_load_dwordx4 v[96:99], v62, s[4:7], s37 offen offset:0 sc1
  buffer_load_dwordx4 v[100:103], v62, s[4:7], s37 offen offset:1024 sc1
  s_barrier
  buffer_store_dwordx4 v[92:95], v66, s[4:7], s25 offen sc1
  buffer_store_dwordx4 v[132:135], v2, s[4:7], s38 offen offset:0 sc1
  buffer_store_dwordx4 v[132:135], v2, s[4:7], s38 offen offset:1024 sc1
  s_add_u32 s25, s25, s73
  s_waitcnt vmcnt(3)
  v_max3_u32 v14, v96, v97, v98
  v_max3_u32 v14, v14, v99, v100
  v_mfma_f32_16x16x32_bf16 v[128:131], a[160:163], v[96:99], 0
  v_max3_u32 v14, v14, v101, v102
  v_max_u32 v14, v14, v103
  v_mfma_f32_16x16x32_bf16 v[128:131], a[160:163], v[100:103], v[128:131]
  v_cmp_eq_u32 vcc, -1, v14
  s_nop 0
  s_cbranch_vccnz mega_loop4_pbf
mega_loop4_pbok:
  s_nop 4
  v_cvt_pk_bf16_f32 v68, v128, v129
  v_cvt_pk_bf16_f32 v69, v130, v131
  v_min_u32 v68, -2, v68
  v_min_u32 v69, -2, v69
  buffer_store_dwordx2 v[68:69], v63, s[4:7], s17 offen sc1
  buffer_store_dwordx2 v[132:133], v63, s[4:7], s16 offen sc1
  s_add_u32 s12, s12, 1
  s_xor_b32 s16, s16, s17
  s_xor_b32 s17, s17, s16
  s_xor_b32 s16, s16, s17
  s_add_u32 s13, s16, 0
  s_add_u32 s14, s16, 2048
  s_add_u32 s38, s32, s39
  s_add_u32 s39, s39, 655360
  s_cmp_eq_u32 s39, 1966080
  s_cselect_b32 s39, 0, s39
  s_add_u32 s37, s32, s39
  s_add_u32 s33, s30, s39
  s_add_u32 s34, s33, 327680
  s_add_u32 s35, s31, s39
  s_add_u32 s36, s35, 327680
  s_barrier
  s_nop 3
  s_branch mega_loop4
mega_loop4_pcf:
  s_nop 3
  v_mov_b32 v28, 0
  v_mov_b32 v29, 0
  v_mov_b32 v30, 0
  v_mov_b32 v31, 0
  v_mov_b32 v32, 0
  v_mov_b32 v33, 0
  v_mov_b32 v34, 0
  v_mov_b32 v35, 0
  s_add_u32 s15, s15, 1
  s_cmp_lt_u32 s15, 262144
  s_cbranch_scc1 mega_loop4_pc
  s_branch mega_fail
mega_loop4_last:
  v_smfmac_f32_16x16x64_bf16 v[56:59], v[72:75], a[104:111], v9
  s_waitcnt lgkmcnt(4)
  buffer_store_dwordx2 v[132:133], v10, s[4:7], s19 offen sc1
  v_smfmac_f32_16x16x64_bf16 v[52:55], v[76:79], a[32:39], v9
  v_smfmac_f32_16x16x64_bf16 v[56:59], v[76:79], a[112:119], v9
  v_smfmac_f32_16x16x64_bf16 v[52:55], v[80:83], a[40:47], v9
  v_smfmac_f32_16x16x64_bf16 v[56:59], v[80:83], a[120:127], v9
  v_smfmac_f32_16x16x64_bf16 v[52:55], v[84:87], a[48:55], v9
  v_smfmac_f32_16x16x64_bf16 v[56:59], v[84:87], a[128:135], v9
  v_smfmac_f32_16x16x64_bf16 v[52:55], v[88:91], a[56:63], v9
  v_smfmac_f32_16x16x64_bf16 v[56:59], v[88:91], a[136:143], v9
  v_smfmac_f32_16x16x64_bf16 v[52:55], v[92:95], a[64:71], v9
  v_smfmac_f32_16x16x64_bf16 v[56:59], v[92:95], a[144:151], v9
  v_smfmac_f32_16x16x64_bf16 v[52:55], v[96:99], a[72:79], v9
  v_smfmac_f32_16x16x64_bf16 v[56:59], v[96:99], a[152:159], v9
  s_nop 4
  v_pk_add_f32 v[52:53], v[52:53], v[54:55]
  v_cvt_pk_bf16_f32 v52, v52, v53
  ds_write_b32 v8, v52 offset:21504
  v_pk_add_f32 v[56:57], v[56:57], v[58:59]
  v_cvt_pk_bf16_f32 v56, v56, v57
  ds_write_b32 v8, v56 offset:22528
  s_waitcnt lgkmcnt(0)
  s_barrier
  ds_read_b128 v[92:95], v13 offset:21504
  s_waitcnt lgkmcnt(0)
  buffer_store_dwordx4 v[92:95], v66, s[4:7], s25 offen sc1
  s_waitcnt vmcnt(0)
  s_barrier
  s_endpgm
mega_loop4_paf:
  s_add_u32 s15, s15, 1
  s_cmp_lt_u32 s15, 262144
  s_cbranch_scc1 mega_loop4_pa
  s_branch mega_fail
mega_loop4_pbf:
  buffer_load_dwordx4 v[96:99], v62, s[4:7], s37 offen offset:0 sc1
  buffer_load_dwordx4 v[100:103], v62, s[4:7], s37 offen offset:1024 sc1
mega_loop4_pbl:
  buffer_load_dwordx4 v[96:99], v62, s[4:7], s37 offen offset:0 sc1
  buffer_load_dwordx4 v[100:103], v62, s[4:7], s37 offen offset:1024 sc1
  s_waitcnt vmcnt(2)
  v_max3_u32 v14, v96, v97, v98
  v_max3_u32 v14, v14, v99, v100
  v_mfma_f32_16x16x32_bf16 v[128:131], a[160:163], v[96:99], 0
  v_max3_u32 v14, v14, v101, v102
  v_max_u32 v14, v14, v103
  v_mfma_f32_16x16x32_bf16 v[128:131], a[160:163], v[100:103], v[128:131]
  v_cmp_eq_u32 vcc, -1, v14
  s_nop 0
  s_cbranch_vccz mega_loop4_pbok
  s_add_u32 s15, s15, 1
  s_cmp_lt_u32 s15, 262144
  s_cbranch_scc1 mega_loop4_pbl
  s_branch mega_fail
mega_loop5:
  buffer_load_dwordx4 v[16:19], v2, s[4:7], s13 offen sc1
  buffer_load_dwordx4 v[20:23], v2, s[4:7], s13 offen offset:1024 sc1
  buffer_load_dwordx4 v[24:27], v2, s[4:7], s14 offen sc1
mega_loop5_pc:
  buffer_load_dwordx4 v[16:19], v2, s[4:7], s13 offen sc1
  buffer_load_dwordx4 v[20:23], v2, s[4:7], s13 offen offset:1024 sc1
  buffer_load_dwordx4 v[24:27], v2, s[4:7], s14 offen sc1
  s_waitcnt vmcnt(3)
  v_max3_u32 v14, v16, v17, v18
  v_max3_u32 v14, v14, v19, v20
  v_smfmac_f32_16x16x64_bf16 v[44:47], v[16:19], v[136:143], v9
  v_max3_u32 v14, v14, v21, v22
  v_smfmac_f32_16x16x64_bf16 v[48:51], v[16:19], v[144:151], v9
  v_max3_u32 v14, v14, v23, v24
  v_smfmac_f32_16x16x64_bf16 v[44:47], v[20:23], v[152:159], v9
  v_max3_u32 v14, v14, v25, v26
  v_smfmac_f32_16x16x64_bf16 v[48:51], v[20:23], v[160:167], v9
  v_max_u32 v14, v14, v27
  v_smfmac_f32_16x16x64_bf16 v[44:47], v[24:27], v[168:175], v9
  v_cmp_eq_u32 vcc, -1, v14
  v_smfmac_f32_16x16x64_bf16 v[48:51], v[24:27], v[176:183], v9
  s_cbranch_vccnz mega_loop5_pcf
  ds_write_b128 v2, v[16:19] offset:3072
  v_smfmac_f32_16x16x64_bf16 v[36:39], v[16:19], v[184:191], v9
  ds_write_b128 v2, v[20:23] offset:4096
  v_smfmac_f32_16x16x64_bf16 v[40:43], v[16:19], v[192:199], v9
  v_smfmac_f32_16x16x64_bf16 v[36:39], v[20:23], v[200:207], v9
  v_pk_add_f32 v[44:45], v[44:45], v[46:47]
  v_smfmac_f32_16x16x64_bf16 v[40:43], v[20:23], v[208:215], v9
  v_pk_add_f32 v[48:49], v[48:49], v[50:51]
  v_smfmac_f32_16x16x64_bf16 v[40:43], v[24:27], v[216:223], v9
  v_cvt_pk_bf16_f32 v46, v44, v45
  v_smfmac_f32_16x16x64_bf16 v[28:31], v[16:19], v[224:231], v9
  v_cvt_pk_bf16_f32 v47, v48, v49
  v_smfmac_f32_16x16x64_bf16 v[32:35], v[16:19], v[232:239], v9
  ds_write_b64 v3, v[46:47] offset:14336
  v_smfmac_f32_16x16x64_bf16 v[28:31], v[20:23], v[240:247], v9
  v_pk_add_f32 v[36:37], v[36:37], v[38:39]
  v_smfmac_f32_16x16x64_bf16 v[32:35], v[20:23], v[248:255], v9
  v_pk_add_f32 v[40:41], v[40:41], v[42:43]
  v_cvt_pk_bf16_f32 v38, v36, v37
  v_cvt_pk_bf16_f32 v39, v40, v41
  ds_write_b64 v3, v[38:39] offset:12288
  v_smfmac_f32_16x16x64_bf16 v[52:55], v[16:19], a[24:31], v9
  v_pk_add_f32 v[28:29], v[28:29], v[30:31]
  s_nop 1
  v_pk_add_f32 v[32:33], v[32:33], v[34:35]
  v_cvt_pk_bf16_f32 v30, v28, v29
  v_cvt_pk_bf16_f32 v31, v32, v33
  ds_write_b64 v3, v[30:31] offset:10240
  v_smfmac_f32_16x16x64_bf16 v[56:59], v[16:19], a[104:111], v9
  v_smfmac_f32_16x16x64_bf16 v[52:55], v[20:23], a[32:39], v9
  v_smfmac_f32_16x16x64_bf16 v[56:59], v[20:23], a[112:119], v9
  s_waitcnt lgkmcnt(0)
  s_barrier
  ds_read_b128 v[28:31], v2 offset:10240
  ds_read_b128 v[32:35], v2 offset:11264
  ds_read_b128 v[36:39], v2 offset:12288
  ds_read_b128 v[40:43], v2 offset:13312
  ds_read_b128 v[44:47], v2 offset:14336
  ds_read_b128 v[48:51], v2 offset:15360
  ds_read_b128 v[120:123], v11 offset:35840
  ds_read_b64 v[124:125], v11 offset:36872
  v_smfmac_f32_16x16x64_bf16 v[52:55], v[24:27], a[16:23], v9
  v_smfmac_f32_16x16x64_bf16 v[56:59], v[24:27], a[96:103], v9
  s_waitcnt lgkmcnt(7)
  v_mfma_f32_16x16x32_bf16 v[100:103], v[28:31], a[172:175], 0
  ds_read_b128 v[72:75], v2 offset:0
  s_waitcnt lgkmcnt(7)
  v_mfma_f32_16x16x32_bf16 v[100:103], v[32:35], a[172:175], v[100:103]
  ds_read_b128 v[76:79], v2 offset:1024
  s_waitcnt lgkmcnt(7)
  v_mfma_f32_16x16x32_bf16 v[104:107], v[36:39], a[172:175], 0
  ds_read_b128 v[80:83], v2 offset:5120
  s_waitcnt lgkmcnt(7)
  v_mfma_f32_16x16x32_bf16 v[104:107], v[40:43], a[172:175], v[104:107]
  ds_read_b128 v[84:87], v2 offset:6144
  s_waitcnt lgkmcnt(7)
  v_mfma_f32_16x16x32_bf16 v[108:111], v[44:47], a[172:175], 0
  ds_read_b128 v[88:91], v2 offset:7168
  v_cvt_pk_bf16_f32 v112, v100, v101
  v_cvt_pk_bf16_f32 v113, v102, v103
  s_waitcnt lgkmcnt(7)
  v_mfma_f32_16x16x32_bf16 v[108:111], v[48:51], a[172:175], v[108:111]
  ds_read_b128 v[92:95], v2 offset:8192
  v_cvt_pk_bf16_f32 v114, v104, v105
  v_cvt_pk_bf16_f32 v115, v106, v107
  ds_read_b128 v[96:99], v2 offset:9216
  s_waitcnt lgkmcnt(7)
  v_mfma_f32_16x16x32_bf16 v[128:131], v[120:123], v[112:115], 0
  s_nop 1
  v_cvt_pk_bf16_f32 v116, v108, v109
  v_cvt_pk_bf16_f32 v117, v110, v111
  s_nop 1
  v_mfma_f32_16x16x32_bf16 v[128:131], v[124:127], v[116:119], v[128:131]
  s_waitcnt lgkmcnt(6)
  v_smfmac_f32_16x16x64_bf16 v[52:55], v[72:75], a[0:7], v9
  ds_read_b128 a[176:179], v60 offset:24576
  ds_read_b128 a[180:183], v60 offset:27136
  ds_read_b128 a[184:187], v60 offset:29696
  ds_read_b128 a[188:191], v60 offset:32256
  s_nop 0
  v_cvt_pk_bf16_f32 v68, v128, v129
  v_cvt_pk_bf16_f32 v69, v130, v131
  v_min_u32 v68, -2, v68
  v_min_u32 v69, -2, v69
  buffer_store_dwordx2 v[68:69], v10, s[4:7], s18 offen sc1
  s_cmp_eq_u32 s12, 63
  s_cbranch_scc1 mega_loop5_last
  v_smfmac_f32_16x16x64_bf16 v[56:59], v[72:75], a[80:87], v9
  s_waitcnt lgkmcnt(4)
  buffer_store_dwordx2 v[132:133], v10, s[4:7], s19 offen sc1
  v_smfmac_f32_16x16x64_bf16 v[52:55], v[76:79], a[8:15], v9
  v_smfmac_f32_16x16x64_bf16 v[56:59], v[76:79], a[88:95], v9
  v_smfmac_f32_16x16x64_bf16 v[52:55], v[80:83], a[40:47], v9
  v_smfmac_f32_16x16x64_bf16 v[56:59], v[80:83], a[120:127], v9
  v_smfmac_f32_16x16x64_bf16 v[52:55], v[84:87], a[48:55], v9
  v_smfmac_f32_16x16x64_bf16 v[56:59], v[84:87], a[128:135], v9
  buffer_load_dwordx4 v[16:19], v4, s[4:7], s20 offen sc1
  v_smfmac_f32_16x16x64_bf16 v[52:55], v[88:91], a[56:63], v9
  buffer_load_dwordx4 v[20:23], v4, s[4:7], s20 offen offset:256 sc1
  v_smfmac_f32_16x16x64_bf16 v[56:59], v[88:91], a[136:143], v9
  buffer_load_dwordx4 v[24:27], v5, s[4:7], s20 offen offset:512 sc1
  v_smfmac_f32_16x16x64_bf16 v[52:55], v[92:95], a[64:71], v9
  v_smfmac_f32_16x16x64_bf16 v[56:59], v[92:95], a[144:151], v9
  v_smfmac_f32_16x16x64_bf16 v[52:55], v[96:99], a[72:79], v9
  v_smfmac_f32_16x16x64_bf16 v[56:59], v[96:99], a[152:159], v9
  s_nop 4
  v_pk_add_f32 v[52:53], v[52:53], v[54:55]
  v_cvt_pk_bf16_f32 v52, v52, v53
  ds_write_b32 v8, v52 offset:21504
  v_pk_add_f32 v[56:57], v[56:57], v[58:59]
  v_cvt_pk_bf16_f32 v56, v56, v57
  ds_write_b32 v8, v56 offset:22528
mega_loop5_pa:
  buffer_load_dwordx4 v[16:19], v4, s[4:7], s20 offen sc1
  buffer_load_dwordx4 v[20:23], v4, s[4:7], s20 offen offset:256 sc1
  buffer_load_dwordx4 v[24:27], v5, s[4:7], s20 offen offset:512 sc1
  s_waitcnt vmcnt(3)
  v_max3_u32 v14, v16, v17, v18
  v_max3_u32 v14, v14, v19, v20
  v_mfma_f32_16x16x32_bf16 v[40:43], v[16:19], a[160:163], 0
  v_max3_u32 v14, v14, v21, v22
  v_max3_u32 v14, v14, v23, v24
  v_mfma_f32_16x16x32_bf16 v[40:43], v[20:23], a[164:167], v[40:43]
  v_max3_u32 v14, v14, v25, v26
  v_max_u32 v14, v14, v27
  v_mfma_f32_16x16x32_bf16 v[44:47], v[24:27], a[168:171], 0
  v_cmp_eq_u32 vcc, -1, v14
  s_nop 0
  s_cbranch_vccnz mega_loop5_paf
  s_nop 1
  v_max3_f32 v48, v40, v41, v42
  s_nop 1
  v_cndmask_b32 v44, v44, v45, s[42:43]
  v_max3_f32 v48, v48, v43, v44
  s_nop 1
  v_max_f32_dpp v48, v48, v48 quad_perm:[1,0,3,2] row_mask:0xf bank_mask:0xf
  s_nop 1
  v_max_f32_dpp v48, v48, v48 quad_perm:[2,3,0,1] row_mask:0xf bank_mask:0xf
  s_nop 1
  v_max_f32_dpp v48, v48, v48 row_half_mirror row_mask:0xf bank_mask:0xf
  v_mul_f32 v48, s26, v48
  v_fma_f32 v40, v40, s26, -v48
  v_fma_f32 v41, v41, s26, -v48
  v_fma_f32 v42, v42, s26, -v48
  v_fma_f32 v43, v43, s26, -v48
  v_fma_f32 v44, v44, s26, -v48
  v_exp_f32 v40, v40
  v_exp_f32 v41, v41
  v_exp_f32 v42, v42
  v_exp_f32 v43, v43
  v_exp_f32 v44, v44
  v_add_f32 v48, v40, v41
  v_add_f32 v49, v42, v43
  v_add_f32 v48, v48, v49
  v_add_f32 v48, v48, v44
  s_nop 1
  v_add_f32_dpp v48, v48, v48 quad_perm:[1,0,3,2] row_mask:0xf bank_mask:0xf
  s_nop 1
  v_add_f32_dpp v48, v48, v48 quad_perm:[2,3,0,1] row_mask:0xf bank_mask:0xf
  s_nop 1
  v_add_f32_dpp v48, v48, v48 row_half_mirror row_mask:0xf bank_mask:0xf
  v_rcp_f32 v48, v48
  s_nop 0
  v_pk_mul_f32 v[40:41], v[40:41], v[48:49] op_sel_hi:[1,0]
  v_pk_mul_f32 v[42:43], v[42:43], v[48:49] op_sel_hi:[1,0]
  v_mul_f32 v44, v44, v48
  v_cvt_pk_bf16_f32 v40, v40, v41
  v_cvt_pk_bf16_f32 v41, v42, v43
  ds_write_b64 v6, v[40:41] offset:16384
  v_cvt_pk_bf16_f32 v44, v44, v44
  ds_write_b16 v7, v44 offset:20480
  s_waitcnt lgkmcnt(0)
  s_barrier
  ds_read_b128 v[72:75], v12 offset:16384
  ds_read_b128 v[76:79], v12 offset:17408
  ds_read_b128 v[80:83], v12 offset:18432
  ds_read_b128 v[84:87], v12 offset:19456
  ds_read_b128 v[88:91], v12 offset:20480
  ds_read_b128 v[92:95], v13 offset:21504
  s_waitcnt lgkmcnt(5)
  v_mfma_f32_16x16x32_bf16 v[128:131], a[176:179], v[72:75], 0
  s_waitcnt lgkmcnt(4)
  v_mfma_f32_16x16x32_bf16 v[128:131], a[180:183], v[76:79], v[128:131]
  s_waitcnt lgkmcnt(3)
  v_mfma_f32_16x16x32_bf16 v[128:131], a[184:187], v[80:83], v[128:131]
  s_waitcnt lgkmcnt(2)
  v_mfma_f32_16x16x32_bf16 v[128:131], a[188:191], v[84:87], v[128:131]
  s_waitcnt lgkmcnt(0)
  v_mfma_f32_16x16x32_bf16 v[128:131], v[92:95], v[88:91], v[128:131]
  v_mov_b32 v28, 0
  v_mov_b32 v29, 0
  v_mov_b32 v30, 0
  v_mov_b32 v31, 0
  v_mov_b32 v32, 0
  v_mov_b32 v33, 0
  v_mov_b32 v34, 0
  s_nop 0
  v_cvt_pk_bf16_f32 v68, v128, v129
  v_cvt_pk_bf16_f32 v69, v130, v131
  v_min_u32 v71, -2, v69
  v_min_u32 v70, -2, v68
  v_min_u32 v69, -2, v69
  v_min_u32 v68, -2, v68
  s_nop 1
  v_permlane16_swap_b32 v68, v70
  v_permlane16_swap_b32 v69, v71
  buffer_store_dwordx4 v[68:71], v61, s[4:7], s33 offen sc1
  buffer_store_dwordx4 v[68:71], v61, s[4:7], s35 offen sc1
  v_mov_b32 v35, 0
  v_mov_b32 v36, 0
  v_mov_b32 v37, 0
  v_mov_b32 v38, 0
  v_mov_b32 v39, 0
  v_mov_b32 v40, 0
  v_mov_b32 v41, 0
  v_mov_b32 v42, 0
  v_mov_b32 v43, 0
  v_mov_b32 v44, 0
  v_mov_b32 v45, 0
  v_mov_b32 v46, 0
  v_mov_b32 v47, 0
  v_mov_b32 v48, 0
  v_mov_b32 v49, 0
  v_mov_b32 v50, 0
  v_mov_b32 v51, 0
  v_mov_b32 v52, 0
  v_mov_b32 v53, 0
  v_mov_b32 v54, 0
  v_mov_b32 v55, 0
  v_mov_b32 v56, 0
  v_mov_b32 v57, 0
  v_mov_b32 v58, 0
  v_mov_b32 v59, 0
  s_xor_b32 s18, s18, s19
  s_xor_b32 s19, s19, s18
  s_xor_b32 s18, s18, s19
  s_xor_b32 s20, s20, s21
  s_xor_b32 s21, s21, s20
  s_xor_b32 s20, s20, s21
  s_add_u32 s72, s72, 1
  s_cmp_eq_u32 s72, 6
  s_cselect_b32 s72, 0, s72
  s_mov_b32 s73, 325632
  s_cselect_b32 s73, 0xffe72800, s73
  s_add_u32 s23, s23, s73
  s_mov_b32 s15, 0
  s_nop 15
  s_nop 15
  s_nop 15
  s_nop 15
  s_nop 9
  buffer_load_dwordx4 v[96:99], v62, s[4:7], s37 offen offset:0 sc1
  buffer_load_dwordx4 v[100:103], v62, s[4:7], s37 offen offset:1024 sc1
  s_barrier
  buffer_store_dwordx4 v[92:95], v66, s[4:7], s25 offen sc1
  buffer_store_dwordx4 v[132:135], v2, s[4:7], s38 offen offset:0 sc1
  buffer_store_dwordx4 v[132:135], v2, s[4:7], s38 offen offset:1024 sc1
  s_add_u32 s25, s25, s73
  s_waitcnt vmcnt(3)
  v_max3_u32 v14, v96, v97, v98
  v_max3_u32 v14, v14, v99, v100
  v_mfma_f32_16x16x32_bf16 v[128:131], a[160:163], v[96:99], 0
  v_max3_u32 v14, v14, v101, v102
  v_max_u32 v14, v14, v103
  v_mfma_f32_16x16x32_bf16 v[128:131], a[160:163], v[100:103], v[128:131]
  v_cmp_eq_u32 vcc, -1, v14
  s_nop 0
  s_cbranch_vccnz mega_loop5_pbf
mega_loop5_pbok:
  s_nop 4
  v_cvt_pk_bf16_f32 v68, v128, v129
  v_cvt_pk_bf16_f32 v69, v130, v131
  v_min_u32 v68, -2, v68
  v_min_u32 v69, -2, v69
  buffer_store_dwordx2 v[68:69], v63, s[4:7], s17 offen sc1
  buffer_store_dwordx2 v[132:133], v63, s[4:7], s16 offen sc1
  s_add_u32 s12, s12, 1
  s_xor_b32 s16, s16, s17
  s_xor_b32 s17, s17, s16
  s_xor_b32 s16, s16, s17
  s_add_u32 s13, s16, 3072
  s_add_u32 s14, s16, 2048
  s_add_u32 s38, s32, s39
  s_add_u32 s39, s39, 655360
  s_cmp_eq_u32 s39, 1966080
  s_cselect_b32 s39, 0, s39
  s_add_u32 s37, s32, s39
  s_add_u32 s33, s30, s39
  s_add_u32 s34, s33, 327680
  s_add_u32 s35, s31, s39
  s_add_u32 s36, s35, 327680
  s_barrier
  s_nop 3
  s_branch mega_loop5
mega_loop5_pcf:
  s_nop 3
  v_mov_b32 v44, 0
  v_mov_b32 v45, 0
  v_mov_b32 v46, 0
  v_mov_b32 v47, 0
  v_mov_b32 v48, 0
  v_mov_b32 v49, 0
  v_mov_b32 v50, 0
  v_mov_b32 v51, 0
  s_add_u32 s15, s15, 1
  s_cmp_lt_u32 s15, 262144
  s_cbranch_scc1 mega_loop5_pc
  s_branch mega_fail
mega_loop5_last:
  v_smfmac_f32_16x16x64_bf16 v[56:59], v[72:75], a[80:87], v9
  s_waitcnt lgkmcnt(4)
  buffer_store_dwordx2 v[132:133], v10, s[4:7], s19 offen sc1
  v_smfmac_f32_16x16x64_bf16 v[52:55], v[76:79], a[8:15], v9
  v_smfmac_f32_16x16x64_bf16 v[56:59], v[76:79], a[88:95], v9
  v_smfmac_f32_16x16x64_bf16 v[52:55], v[80:83], a[40:47], v9
  v_smfmac_f32_16x16x64_bf16 v[56:59], v[80:83], a[120:127], v9
  v_smfmac_f32_16x16x64_bf16 v[52:55], v[84:87], a[48:55], v9
  v_smfmac_f32_16x16x64_bf16 v[56:59], v[84:87], a[128:135], v9
  v_smfmac_f32_16x16x64_bf16 v[52:55], v[88:91], a[56:63], v9
  v_smfmac_f32_16x16x64_bf16 v[56:59], v[88:91], a[136:143], v9
  v_smfmac_f32_16x16x64_bf16 v[52:55], v[92:95], a[64:71], v9
  v_smfmac_f32_16x16x64_bf16 v[56:59], v[92:95], a[144:151], v9
  v_smfmac_f32_16x16x64_bf16 v[52:55], v[96:99], a[72:79], v9
  v_smfmac_f32_16x16x64_bf16 v[56:59], v[96:99], a[152:159], v9
  s_nop 4
  v_pk_add_f32 v[52:53], v[52:53], v[54:55]
  v_cvt_pk_bf16_f32 v52, v52, v53
  ds_write_b32 v8, v52 offset:21504
  v_pk_add_f32 v[56:57], v[56:57], v[58:59]
  v_cvt_pk_bf16_f32 v56, v56, v57
  ds_write_b32 v8, v56 offset:22528
  s_waitcnt lgkmcnt(0)
  s_barrier
  ds_read_b128 v[92:95], v13 offset:21504
  s_waitcnt lgkmcnt(0)
  buffer_store_dwordx4 v[92:95], v66, s[4:7], s25 offen sc1
  s_waitcnt vmcnt(0)
  s_barrier
  s_endpgm
mega_loop5_paf:
  s_add_u32 s15, s15, 1
  s_cmp_lt_u32 s15, 262144
  s_cbranch_scc1 mega_loop5_pa
  s_branch mega_fail
mega_loop5_pbf:
  buffer_load_dwordx4 v[96:99], v62, s[4:7], s37 offen offset:0 sc1
  buffer_load_dwordx4 v[100:103], v62, s[4:7], s37 offen offset:1024 sc1
mega_loop5_pbl:
  buffer_load_dwordx4 v[96:99], v62, s[4:7], s37 offen offset:0 sc1
  buffer_load_dwordx4 v[100:103], v62, s[4:7], s37 offen offset:1024 sc1
  s_waitcnt vmcnt(2)
  v_max3_u32 v14, v96, v97, v98
  v_max3_u32 v14, v14, v99, v100
  v_mfma_f32_16x16x32_bf16 v[128:131], a[160:163], v[96:99], 0
  v_max3_u32 v14, v14, v101, v102
  v_max_u32 v14, v14, v103
  v_mfma_f32_16x16x32_bf16 v[128:131], a[160:163], v[100:103], v[128:131]
  v_cmp_eq_u32 vcc, -1, v14
  s_nop 0
  s_cbranch_vccz mega_loop5_pbok
  s_add_u32 s15, s15, 1
  s_cmp_lt_u32 s15, 262144
  s_cbranch_scc1 mega_loop5_pbl
  s_branch mega_fail
mega_loop6:
  buffer_load_dwordx4 v[16:19], v2, s[4:7], s13 offen sc1
  buffer_load_dwordx4 v[20:23], v2, s[4:7], s13 offen offset:1024 sc1
  buffer_load_dwordx4 v[24:27], v2, s[4:7], s14 offen sc1
mega_loop6_pc:
  buffer_load_dwordx4 v[16:19], v2, s[4:7], s13 offen sc1
  buffer_load_dwordx4 v[20:23], v2, s[4:7], s13 offen offset:1024 sc1
  buffer_load_dwordx4 v[24:27], v2, s[4:7], s14 offen sc1
  s_waitcnt vmcnt(3)
  v_max3_u32 v14, v16, v17, v18
  v_max3_u32 v14, v14, v19, v20
  v_smfmac_f32_16x16x64_bf16 v[28:31], v[16:19], v[136:143], v9
  v_max3_u32 v14, v14, v21, v22
  v_smfmac_f32_16x16x64_bf16 v[32:35], v[16:19], v[144:151], v9
  v_max3_u32 v14, v14, v23, v24
  v_smfmac_f32_16x16x64_bf16 v[28:31], v[20:23], v[152:159], v9
  v_max3_u32 v14, v14, v25, v26
  v_smfmac_f32_16x16x64_bf16 v[32:35], v[20:23], v[160:167], v9
  v_max_u32 v14, v14, v27
  v_smfmac_f32_16x16x64_bf16 v[28:31], v[24:27], v[168:175], v9
  v_cmp_eq_u32 vcc, -1, v14
  v_smfmac_f32_16x16x64_bf16 v[32:35], v[24:27], v[176:183], v9
  s_cbranch_vccnz mega_loop6_pcf
  ds_write_b128 v2, v[16:19] offset:5120
  v_smfmac_f32_16x16x64_bf16 v[36:39], v[16:19], v[184:191], v9
  ds_write_b128 v2, v[20:23] offset:6144
  v_smfmac_f32_16x16x64_bf16 v[40:43], v[16:19], v[192:199], v9
  ds_write_b128 v2, v[24:27] offset:7168
  v_smfmac_f32_16x16x64_bf16 v[36:39], v[20:23], v[200:207], v9
  v_pk_add_f32 v[28:29], v[28:29], v[30:31]
  v_smfmac_f32_16x16x64_bf16 v[40:43], v[20:23], v[208:215], v9
  v_pk_add_f32 v[32:33], v[32:33], v[34:35]
  v_smfmac_f32_16x16x64_bf16 v[36:39], v[24:27], v[216:223], v9
  v_cvt_pk_bf16_f32 v30, v28, v29
  v_smfmac_f32_16x16x64_bf16 v[44:47], v[16:19], v[224:231], v9
  v_cvt_pk_bf16_f32 v31, v32, v33
  v_smfmac_f32_16x16x64_bf16 v[48:51], v[16:19], v[232:239], v9
  ds_write_b64 v3, v[30:31] offset:10240
  v_smfmac_f32_16x16x64_bf16 v[44:47], v[20:23], v[240:247], v9
  v_pk_add_f32 v[36:37], v[36:37], v[38:39]
  v_smfmac_f32_16x16x64_bf16 v[48:51], v[20:23], v[248:255], v9
  v_pk_add_f32 v[40:41], v[40:41], v[42:43]
  v_cvt_pk_bf16_f32 v38, v36, v37
  v_cvt_pk_bf16_f32 v39, v40, v41
  ds_write_b64 v3, v[38:39] offset:12288
  v_smfmac_f32_16x16x64_bf16 v[52:55], v[16:19], a[40:47], v9
  v_pk_add_f32 v[44:45], v[44:45], v[46:47]
  s_nop 1
  v_pk_add_f32 v[48:49], v[48:49], v[50:51]
  v_cvt_pk_bf16_f32 v46, v44, v45
  v_cvt_pk_bf16_f32 v47, v48, v49
  ds_write_b64 v3, v[46:47] offset:14336
  v_smfmac_f32_16x16x64_bf16 v[56:59], v[16:19], a[120:127], v9
  v_smfmac_f32_16x16x64_bf16 v[52:55], v[20:23], a[48:55], v9
  v_smfmac_f32_16x16x64_bf16 v[56:59], v[20:23], a[128:135], v9
  s_waitcnt lgkmcnt(0)
  s_barrier
  ds_read_b128 v[28:31], v2 offset:10240
  ds_read_b128 v[32:35], v2 offset:11264
  ds_read_b128 v[36:39], v2 offset:12288
  ds_read_b128 v[40:43], v2 offset:13312
  ds_read_b128 v[44:47], v2 offset:14336
  ds_read_b128 v[48:51], v2 offset:15360
  v_smfmac_f32_16x16x64_bf16 v[52:55], v[24:27], a[56:63], v9
  v_smfmac_f32_16x16x64_bf16 v[56:59], v[24:27], a[136:143], v9
  s_waitcnt lgkmcnt(5)
  v_mfma_f32_16x16x32_bf16 v[100:103], v[28:31], a[172:175], 0
  ds_read_b128 v[72:75], v2 offset:0
  s_waitcnt lgkmcnt(5)
  v_mfma_f32_16x16x32_bf16 v[100:103], v[32:35], a[172:175], v[100:103]
  ds_read_b128 v[76:79], v2 offset:1024
  s_waitcnt lgkmcnt(5)
  v_mfma_f32_16x16x32_bf16 v[104:107], v[36:39], a[172:175], 0
  ds_read_b128 v[80:83], v2 offset:2048
  s_waitcnt lgkmcnt(5)
  v_mfma_f32_16x16x32_bf16 v[104:107], v[40:43], a[172:175], v[104:107]
  ds_read_b128 v[84:87], v2 offset:3072
  s_waitcnt lgkmcnt(5)
  v_mfma_f32_16x16x32_bf16 v[108:111], v[44:47], a[172:175], 0
  ds_read_b128 v[88:91], v2 offset:4096
  v_cvt_pk_bf16_f32 v112, v100, v101
  v_cvt_pk_bf16_f32 v113, v102, v103
  s_waitcnt lgkmcnt(5)
  v_mfma_f32_16x16x32_bf16 v[108:111], v[48:51], a[172:175], v[108:111]
  ds_read_b128 v[92:95], v2 offset:8192
  v_cvt_pk_bf16_f32 v114, v104, v105
  v_cvt_pk_bf16_f32 v115, v106, v107
  ds_read_b128 v[96:99], v2 offset:9216
  s_waitcnt lgkmcnt(7)
  v_mfma_f32_16x16x32_bf16 v[128:131], v[112:115], v[112:115], 0
  s_nop 1
  v_cvt_pk_bf16_f32 v116, v108, v109
  v_cvt_pk_bf16_f32 v117, v110, v111
  s_nop 1
  v_mfma_f32_16x16x32_bf16 v[128:131], v[116:119], v[116:119], v[128:131]
  s_waitcnt lgkmcnt(6)
  v_smfmac_f32_16x16x64_bf16 v[52:55], v[72:75], a[0:7], v9
  ds_read_b128 a[176:179], v60 offset:24576
  ds_read_b128 a[180:183], v60 offset:27136
  ds_read_b128 a[184:187], v60 offset:29696
  ds_read_b128 a[188:191], v60 offset:32256
  s_nop 0
  v_cvt_pk_bf16_f32 v68, v128, v129
  v_cvt_pk_bf16_f32 v69, v130, v131
  v_min_u32 v68, -2, v68
  v_min_u32 v69, -2, v69
  buffer_store_dwordx2 v[68:69], v10, s[4:7], s18 offen sc1
  s_cmp_eq_u32 s12, 63
  s_cbranch_scc1 mega_loop6_last
  v_smfmac_f32_16x16x64_bf16 v[56:59], v[72:75], a[80:87], v9
  s_waitcnt lgkmcnt(4)
  buffer_store_dwordx4 v[112:115], v64, s[4:7], s23 offen sc1
  v_smfmac_f32_16x16x64_bf16 v[52:55], v[76:79], a[8:15], v9
  buffer_store_dwordx2 v[116:117], v65, s[4:7], s23 offen sc1
  v_smfmac_f32_16x16x64_bf16 v[56:59], v[76:79], a[88:95], v9
  buffer_store_dwordx2 v[132:133], v10, s[4:7], s19 offen sc1
  v_smfmac_f32_16x16x64_bf16 v[52:55], v[80:83], a[16:23], v9
  v_smfmac_f32_16x16x64_bf16 v[56:59], v[80:83], a[96:103], v9
  v_smfmac_f32_16x16x64_bf16 v[52:55], v[84:87], a[24:31], v9
  v_smfmac_f32_16x16x64_bf16 v[56:59], v[84:87], a[104:111], v9
  buffer_load_dwordx4 v[16:19], v4, s[4:7], s20 offen sc1
  v_smfmac_f32_16x16x64_bf16 v[52:55], v[88:91], a[32:39], v9
  buffer_load_dwordx4 v[20:23], v4, s[4:7], s20 offen offset:256 sc1
  v_smfmac_f32_16x16x64_bf16 v[56:59], v[88:91], a[112:119], v9
  buffer_load_dwordx4 v[24:27], v5, s[4:7], s20 offen offset:512 sc1
  v_smfmac_f32_16x16x64_bf16 v[52:55], v[92:95], a[64:71], v9
  v_smfmac_f32_16x16x64_bf16 v[56:59], v[92:95], a[144:151], v9
  v_smfmac_f32_16x16x64_bf16 v[52:55], v[96:99], a[72:79], v9
  v_smfmac_f32_16x16x64_bf16 v[56:59], v[96:99], a[152:159], v9
  s_nop 4
  v_pk_add_f32 v[52:53], v[52:53], v[54:55]
  v_cvt_pk_bf16_f32 v52, v52, v53
  ds_write_b32 v8, v52 offset:21504
  v_pk_add_f32 v[56:57], v[56:57], v[58:59]
  v_cvt_pk_bf16_f32 v56, v56, v57
  ds_write_b32 v8, v56 offset:22528
mega_loop6_pa:
  buffer_load_dwordx4 v[16:19], v4, s[4:7], s20 offen sc1
  buffer_load_dwordx4 v[20:23], v4, s[4:7], s20 offen offset:256 sc1
  buffer_load_dwordx4 v[24:27], v5, s[4:7], s20 offen offset:512 sc1
  s_waitcnt vmcnt(3)
  v_max3_u32 v14, v16, v17, v18
  v_max3_u32 v14, v14, v19, v20
  v_mfma_f32_16x16x32_bf16 v[40:43], v[16:19], a[160:163], 0
  v_max3_u32 v14, v14, v21, v22
  v_max3_u32 v14, v14, v23, v24
  v_mfma_f32_16x16x32_bf16 v[40:43], v[20:23], a[164:167], v[40:43]
  v_max3_u32 v14, v14, v25, v26
  v_max_u32 v14, v14, v27
  v_mfma_f32_16x16x32_bf16 v[44:47], v[24:27], a[168:171], 0
  v_cmp_eq_u32 vcc, -1, v14
  s_nop 0
  s_cbranch_vccnz mega_loop6_paf
  s_nop 1
  v_max3_f32 v48, v40, v41, v42
  s_nop 1
  v_cndmask_b32 v44, v44, v45, s[42:43]
  v_max3_f32 v48, v48, v43, v44
  s_nop 1
  v_max_f32_dpp v48, v48, v48 quad_perm:[1,0,3,2] row_mask:0xf bank_mask:0xf
  s_nop 1
  v_max_f32_dpp v48, v48, v48 quad_perm:[2,3,0,1] row_mask:0xf bank_mask:0xf
  s_nop 1
  v_max_f32_dpp v48, v48, v48 row_half_mirror row_mask:0xf bank_mask:0xf
  v_mul_f32 v48, s26, v48
  v_fma_f32 v40, v40, s26, -v48
  v_fma_f32 v41, v41, s26, -v48
  v_fma_f32 v42, v42, s26, -v48
  v_fma_f32 v43, v43, s26, -v48
  v_fma_f32 v44, v44, s26, -v48
  v_exp_f32 v40, v40
  v_exp_f32 v41, v41
  v_exp_f32 v42, v42
  v_exp_f32 v43, v43
  v_exp_f32 v44, v44
  v_add_f32 v48, v40, v41
  v_add_f32 v49, v42, v43
  v_add_f32 v48, v48, v49
  v_add_f32 v48, v48, v44
  s_nop 1
  v_add_f32_dpp v48, v48, v48 quad_perm:[1,0,3,2] row_mask:0xf bank_mask:0xf
  s_nop 1
  v_add_f32_dpp v48, v48, v48 quad_perm:[2,3,0,1] row_mask:0xf bank_mask:0xf
  s_nop 1
  v_add_f32_dpp v48, v48, v48 row_half_mirror row_mask:0xf bank_mask:0xf
  v_rcp_f32 v48, v48
  s_nop 0
  v_pk_mul_f32 v[40:41], v[40:41], v[48:49] op_sel_hi:[1,0]
  v_pk_mul_f32 v[42:43], v[42:43], v[48:49] op_sel_hi:[1,0]
  v_mul_f32 v44, v44, v48
  v_cvt_pk_bf16_f32 v40, v40, v41
  v_cvt_pk_bf16_f32 v41, v42, v43
  ds_write_b64 v6, v[40:41] offset:16384
  v_cvt_pk_bf16_f32 v44, v44, v44
  ds_write_b16 v7, v44 offset:20480
  s_add_u32 s27, s12, 1
  v_mov_b32 v14, s27
  buffer_store_dword v14, v67, s[4:7], s77 offen offset:0 sc1
  s_waitcnt lgkmcnt(0)
  s_barrier
  ds_read_b128 v[72:75], v12 offset:16384
  ds_read_b128 v[76:79], v12 offset:17408
  ds_read_b128 v[80:83], v12 offset:18432
  ds_read_b128 v[84:87], v12 offset:19456
  ds_read_b128 v[88:91], v12 offset:20480
  ds_read_b128 v[92:95], v13 offset:21504
  s_waitcnt lgkmcnt(5)
  v_mfma_f32_16x16x32_bf16 v[128:131], a[176:179], v[72:75], 0
  s_waitcnt lgkmcnt(4)
  v_mfma_f32_16x16x32_bf16 v[128:131], a[180:183], v[76:79], v[128:131]
  s_waitcnt lgkmcnt(3)
  v_mfma_f32_16x16x32_bf16 v[128:131], a[184:187], v[80:83], v[128:131]
  s_waitcnt lgkmcnt(2)
  v_mfma_f32_16x16x32_bf16 v[128:131], a[188:191], v[84:87], v[128:131]
  s_waitcnt lgkmcnt(0)
  v_mfma_f32_16x16x32_bf16 v[128:131], v[92:95], v[88:91], v[128:131]
  v_mov_b32 v28, 0
  v_mov_b32 v29, 0
  v_mov_b32 v30, 0
  v_mov_b32 v31, 0
  v_mov_b32 v32, 0
  v_mov_b32 v33, 0
  v_mov_b32 v34, 0
  s_nop 0
  v_cvt_pk_bf16_f32 v68, v128, v129
  v_cvt_pk_bf16_f32 v69, v130, v131
  v_min_u32 v68, -2, v68
  v_min_u32 v69, -2, v69
  buffer_store_dwordx2 v[68:69], v61, s[4:7], s33 offen sc1
  buffer_store_dwordx2 v[68:69], v61, s[4:7], s35 offen sc1
  v_mov_b32 v35, 0
  v_mov_b32 v36, 0
  v_mov_b32 v37, 0
  v_mov_b32 v38, 0
  v_mov_b32 v39, 0
  v_mov_b32 v40, 0
  v_mov_b32 v41, 0
  v_mov_b32 v42, 0
  v_mov_b32 v43, 0
  v_mov_b32 v44, 0
  v_mov_b32 v45, 0
  v_mov_b32 v46, 0
  v_mov_b32 v47, 0
  v_mov_b32 v48, 0
  v_mov_b32 v49, 0
  v_mov_b32 v50, 0
  v_mov_b32 v51, 0
  v_mov_b32 v52, 0
  v_mov_b32 v53, 0
  v_mov_b32 v54, 0
  v_mov_b32 v55, 0
  v_mov_b32 v56, 0
  v_mov_b32 v57, 0
  v_mov_b32 v58, 0
  v_mov_b32 v59, 0
  s_xor_b32 s18, s18, s19
  s_xor_b32 s19, s19, s18
  s_xor_b32 s18, s18, s19
  s_xor_b32 s20, s20, s21
  s_xor_b32 s21, s21, s20
  s_xor_b32 s20, s20, s21
  s_add_u32 s72, s72, 1
  s_cmp_eq_u32 s72, 6
  s_cselect_b32 s72, 0, s72
  s_mov_b32 s73, 325632
  s_cselect_b32 s73, 0xffe72800, s73
  s_add_u32 s23, s23, s73
  s_mov_b32 s15, 0
  s_nop 15
  s_nop 15
  s_nop 15
  s_nop 15
  s_nop 9
  buffer_load_dwordx4 v[96:99], v62, s[4:7], s37 offen offset:0 sc1
  buffer_load_dwordx4 v[100:103], v62, s[4:7], s37 offen offset:512 sc1
  s_barrier
  buffer_store_dwordx4 v[92:95], v66, s[4:7], s25 offen sc1
  buffer_store_dwordx4 v[132:135], v2, s[4:7], s38 offen offset:0 sc1
  s_add_u32 s25, s25, s73
  s_waitcnt vmcnt(2)
  v_max3_u32 v14, v96, v97, v98
  v_max3_u32 v14, v14, v99, v100
  v_mfma_f32_16x16x32_bf16 v[128:131], a[160:163], v[96:99], 0
  v_max3_u32 v14, v14, v101, v102
  v_max_u32 v14, v14, v103
  v_mfma_f32_16x16x32_bf16 v[128:131], a[160:163], v[100:103], v[128:131]
  v_cmp_eq_u32 vcc, -1, v14
  s_nop 0
  s_cbranch_vccnz mega_loop6_pbf
mega_loop6_pbok:
  s_nop 4
  v_cvt_pk_bf16_f32 v68, v128, v129
  v_cvt_pk_bf16_f32 v69, v130, v131
  v_min_u32 v68, -2, v68
  v_min_u32 v69, -2, v69
  buffer_store_dwordx2 v[68:69], v63, s[4:7], s17 offen sc1
  buffer_store_dwordx2 v[132:133], v63, s[4:7], s16 offen sc1
  s_add_u32 s12, s12, 1
  s_xor_b32 s16, s16, s17
  s_xor_b32 s17, s17, s16
  s_xor_b32 s16, s16, s17
  s_add_u32 s13, s16, 5120
  s_add_u32 s14, s16, 7168
  s_add_u32 s38, s32, s39
  s_add_u32 s39, s39, 655360
  s_cmp_eq_u32 s39, 1966080
  s_cselect_b32 s39, 0, s39
  s_add_u32 s37, s32, s39
  s_add_u32 s33, s30, s39
  s_add_u32 s34, s33, 327680
  s_add_u32 s35, s31, s39
  s_add_u32 s36, s35, 327680
  s_barrier
  s_nop 3
  s_branch mega_loop6
mega_loop6_pcf:
  s_nop 3
  v_mov_b32 v28, 0
  v_mov_b32 v29, 0
  v_mov_b32 v30, 0
  v_mov_b32 v31, 0
  v_mov_b32 v32, 0
  v_mov_b32 v33, 0
  v_mov_b32 v34, 0
  v_mov_b32 v35, 0
  s_add_u32 s15, s15, 1
  s_cmp_lt_u32 s15, 262144
  s_cbranch_scc1 mega_loop6_pc
  s_branch mega_fail
mega_loop6_last:
  v_smfmac_f32_16x16x64_bf16 v[56:59], v[72:75], a[80:87], v9
  s_waitcnt lgkmcnt(4)
  buffer_store_dwordx4 v[112:115], v64, s[4:7], s23 offen sc1
  v_smfmac_f32_16x16x64_bf16 v[52:55], v[76:79], a[8:15], v9
  buffer_store_dwordx2 v[116:117], v65, s[4:7], s23 offen sc1
  v_smfmac_f32_16x16x64_bf16 v[56:59], v[76:79], a[88:95], v9
  buffer_store_dwordx2 v[132:133], v10, s[4:7], s19 offen sc1
  v_smfmac_f32_16x16x64_bf16 v[52:55], v[80:83], a[16:23], v9
  v_smfmac_f32_16x16x64_bf16 v[56:59], v[80:83], a[96:103], v9
  v_smfmac_f32_16x16x64_bf16 v[52:55], v[84:87], a[24:31], v9
  v_smfmac_f32_16x16x64_bf16 v[56:59], v[84:87], a[104:111], v9
  v_smfmac_f32_16x16x64_bf16 v[52:55], v[88:91], a[32:39], v9
  v_smfmac_f32_16x16x64_bf16 v[56:59], v[88:91], a[112:119], v9
  v_smfmac_f32_16x16x64_bf16 v[52:55], v[92:95], a[64:71], v9
  v_smfmac_f32_16x16x64_bf16 v[56:59], v[92:95], a[144:151], v9
  v_smfmac_f32_16x16x64_bf16 v[52:55], v[96:99], a[72:79], v9
  v_smfmac_f32_16x16x64_bf16 v[56:59], v[96:99], a[152:159], v9
  s_nop 4
  v_pk_add_f32 v[52:53], v[52:53], v[54:55]
  v_cvt_pk_bf16_f32 v52, v52, v53
  ds_write_b32 v8, v52 offset:21504
  v_pk_add_f32 v[56:57], v[56:57], v[58:59]
  v_cvt_pk_bf16_f32 v56, v56, v57
  ds_write_b32 v8, v56 offset:22528
  s_waitcnt vmcnt(0)
  s_add_u32 s27, s12, 1
  v_mov_b32 v14, s27
  buffer_store_dword v14, v67, s[4:7], s77 offen offset:0 sc1
  s_waitcnt lgkmcnt(0)
  s_barrier
  ds_read_b128 v[92:95], v13 offset:21504
  s_waitcnt lgkmcnt(0)
  buffer_store_dwordx4 v[92:95], v66, s[4:7], s25 offen sc1
  s_waitcnt vmcnt(0)
  s_barrier
  s_add_u32 s27, s12, 1
  v_mov_b32 v14, s27
  buffer_store_dword v14, v67, s[4:7], s77 offen offset:16 sc1
  s_endpgm
mega_loop6_paf:
  s_add_u32 s15, s15, 1
  s_cmp_lt_u32 s15, 262144
  s_cbranch_scc1 mega_loop6_pa
  s_branch mega_fail
mega_loop6_pbf:
  buffer_load_dwordx4 v[96:99], v62, s[4:7], s37 offen offset:0 sc1
  buffer_load_dwordx4 v[100:103], v62, s[4:7], s37 offen offset:512 sc1
mega_loop6_pbl:
  buffer_load_dwordx4 v[96:99], v62, s[4:7], s37 offen offset:0 sc1
  buffer_load_dwordx4 v[100:103], v62, s[4:7], s37 offen offset:512 sc1
  s_waitcnt vmcnt(2)
  v_max3_u32 v14, v96, v97, v98
  v_max3_u32 v14, v14, v99, v100
  v_mfma_f32_16x16x32_bf16 v[128:131], a[160:163], v[96:99], 0
  v_max3_u32 v14, v14, v101, v102
  v_max_u32 v14, v14, v103
  v_mfma_f32_16x16x32_bf16 v[128:131], a[160:163], v[100:103], v[128:131]
  v_cmp_eq_u32 vcc, -1, v14
  s_nop 0
  s_cbranch_vccz mega_loop6_pbok
  s_add_u32 s15, s15, 1
  s_cmp_lt_u32 s15, 262144
  s_cbranch_scc1 mega_loop6_pbl
  s_branch mega_fail
mega_loop7:
  buffer_load_dwordx4 v[16:19], v2, s[4:7], s13 offen sc1
  buffer_load_dwordx4 v[20:23], v2, s[4:7], s13 offen offset:1024 sc1
  buffer_load_dwordx4 v[24:27], v2, s[4:7], s14 offen sc1
mega_loop7_pc:
  buffer_load_dwordx4 v[16:19], v2, s[4:7], s13 offen sc1
  buffer_load_dwordx4 v[20:23], v2, s[4:7], s13 offen offset:1024 sc1
  buffer_load_dwordx4 v[24:27], v2, s[4:7], s14 offen sc1
  s_waitcnt vmcnt(3)
  v_max3_u32 v14, v16, v17, v18
  v_max3_u32 v14, v14, v19, v20
  v_smfmac_f32_16x16x64_bf16 v[44:47], v[16:19], v[136:143], v9
  v_max3_u32 v14, v14, v21, v22
  v_smfmac_f32_16x16x64_bf16 v[48:51], v[16:19], v[144:151], v9
  v_max3_u32 v14, v14, v23, v24
  v_smfmac_f32_16x16x64_bf16 v[44:47], v[20:23], v[152:159], v9
  v_max3_u32 v14, v14, v25, v26
  v_smfmac_f32_16x16x64_bf16 v[48:51], v[20:23], v[160:167], v9
  v_max_u32 v14, v14, v27
  v_smfmac_f32_16x16x64_bf16 v[44:47], v[24:27], v[168:175], v9
  v_cmp_eq_u32 vcc, -1, v14
  v_smfmac_f32_16x16x64_bf16 v[48:51], v[24:27], v[176:183], v9
  s_cbranch_vccnz mega_loop7_pcf
  ds_write_b128 v2, v[16:19] offset:8192
  v_smfmac_f32_16x16x64_bf16 v[36:39], v[16:19], v[184:191], v9
  ds_write_b128 v2, v[20:23] offset:9216
  v_smfmac_f32_16x16x64_bf16 v[40:43], v[16:19], v[192:199], v9
  v_smfmac_f32_16x16x64_bf16 v[36:39], v[20:23], v[200:207], v9
  v_pk_add_f32 v[44:45], v[44:45], v[46:47]
  v_smfmac_f32_16x16x64_bf16 v[40:43], v[20:23], v[208:215], v9
  v_pk_add_f32 v[48:49], v[48:49], v[50:51]
  v_smfmac_f32_16x16x64_bf16 v[40:43], v[24:27], v[216:223], v9
  v_cvt_pk_bf16_f32 v46, v44, v45
  v_smfmac_f32_16x16x64_bf16 v[28:31], v[16:19], v[224:231], v9
  v_cvt_pk_bf16_f32 v47, v48, v49
  v_smfmac_f32_16x16x64_bf16 v[32:35], v[16:19], v[232:239], v9
  ds_write_b64 v3, v[46:47] offset:14336
  v_smfmac_f32_16x16x64_bf16 v[28:31], v[20:23], v[240:247], v9
  v_pk_add_f32 v[36:37], v[36:37], v[38:39]
  v_smfmac_f32_16x16x64_bf16 v[32:35], v[20:23], v[248:255], v9
  v_pk_add_f32 v[40:41], v[40:41], v[42:43]
  v_cvt_pk_bf16_f32 v38, v36, v37
  v_cvt_pk_bf16_f32 v39, v40, v41
  ds_write_b64 v3, v[38:39] offset:12288
  v_smfmac_f32_16x16x64_bf16 v[52:55], v[16:19], a[64:71], v9
  v_pk_add_f32 v[28:29], v[28:29], v[30:31]
  s_nop 1
  v_pk_add_f32 v[32:33], v[32:33], v[34:35]
  v_cvt_pk_bf16_f32 v30, v28, v29
  v_cvt_pk_bf16_f32 v31, v32, v33
  ds_write_b64 v3, v[30:31] offset:10240
  v_smfmac_f32_16x16x64_bf16 v[56:59], v[16:19], a[144:151], v9
  v_smfmac_f32_16x16x64_bf16 v[60:63], v[16:19], a[224:231], v9
  v_smfmac_f32_16x16x64_bf16 v[64:67], v[16:19], v[120:127], v9
  s_waitcnt lgkmcnt(0)
  s_barrier
  v_smfmac_f32_16x16x64_bf16 v[52:55], v[20:23], a[72:79], v9
  v_smfmac_f32_16x16x64_bf16 v[56:59], v[20:23], a[152:159], v9
  ds_read_b128 v[40:43], v2 offset:0
  v_smfmac_f32_16x16x64_bf16 v[60:63], v[20:23], a[232:239], v9
  ds_read_b128 v[28:31], v2 offset:1024
  v_smfmac_f32_16x16x64_bf16 v[64:67], v[20:23], v[128:135], v9
  ds_read_b128 v[32:35], v2 offset:2048
  v_smfmac_f32_16x16x64_bf16 v[52:55], v[24:27], a[56:63], v9
  ds_read_b128 v[36:39], v2 offset:3072
  v_smfmac_f32_16x16x64_bf16 v[56:59], v[24:27], a[136:143], v9
  ds_read_b128 v[44:47], v2 offset:4096
  v_smfmac_f32_16x16x64_bf16 v[60:63], v[24:27], a[216:223], v9
  ds_read_b128 v[48:51], v2 offset:5120
  v_smfmac_f32_16x16x64_bf16 v[64:67], v[24:27], v[112:119], v9
  s_cmp_eq_u32 s12, 63
  s_cbranch_scc1 mega_loop7_last
  s_waitcnt lgkmcnt(0)
  v_smfmac_f32_16x16x64_bf16 v[52:55], v[40:43], a[0:7], v9
  v_smfmac_f32_16x16x64_bf16 v[56:59], v[40:43], a[80:87], v9
  v_smfmac_f32_16x16x64_bf16 v[60:63], v[40:43], a[160:167], v9
  v_smfmac_f32_16x16x64_bf16 v[64:67], v[40:43], a[240:247], v9
  ds_read_b128 v[40:43], v2 offset:6144
  v_smfmac_f32_16x16x64_bf16 v[52:55], v[28:31], a[8:15], v9
  v_smfmac_f32_16x16x64_bf16 v[56:59], v[28:31], a[88:95], v9
  v_smfmac_f32_16x16x64_bf16 v[60:63], v[28:31], a[168:175], v9
  v_smfmac_f32_16x16x64_bf16 v[64:67], v[28:31], a[248:255], v9
  ds_read_b128 v[28:31], v2 offset:37888
  v_smfmac_f32_16x16x64_bf16 v[52:55], v[32:35], a[16:23], v9
  v_smfmac_f32_16x16x64_bf16 v[56:59], v[32:35], a[96:103], v9
  v_smfmac_f32_16x16x64_bf16 v[60:63], v[32:35], a[176:183], v9
  v_smfmac_f32_16x16x64_bf16 v[64:67], v[32:35], v[72:79], v9
  ds_read_b128 v[32:35], v2 offset:38912
  v_smfmac_f32_16x16x64_bf16 v[52:55], v[36:39], a[24:31], v9
  v_smfmac_f32_16x16x64_bf16 v[56:59], v[36:39], a[104:111], v9
  v_smfmac_f32_16x16x64_bf16 v[60:63], v[36:39], a[184:191], v9
  v_smfmac_f32_16x16x64_bf16 v[64:67], v[36:39], v[80:87], v9
  ds_read_b128 v[36:39], v2 offset:39936
  v_smfmac_f32_16x16x64_bf16 v[52:55], v[44:47], a[32:39], v9
  v_smfmac_f32_16x16x64_bf16 v[56:59], v[44:47], a[112:119], v9
  v_smfmac_f32_16x16x64_bf16 v[60:63], v[44:47], a[192:199], v9
  buffer_load_dwordx4 v[16:19], v4, s[4:7], s20 offen sc1
  v_smfmac_f32_16x16x64_bf16 v[64:67], v[44:47], v[88:95], v9
  buffer_load_dwordx4 v[20:23], v4, s[4:7], s20 offen offset:256 sc1
  v_smfmac_f32_16x16x64_bf16 v[52:55], v[48:51], a[40:47], v9
  buffer_load_dwordx4 v[24:27], v5, s[4:7], s20 offen offset:512 sc1
  v_smfmac_f32_16x16x64_bf16 v[56:59], v[48:51], a[120:127], v9
  v_smfmac_f32_16x16x64_bf16 v[60:63], v[48:51], a[200:207], v9
  v_smfmac_f32_16x16x64_bf16 v[64:67], v[48:51], v[96:103], v9
  s_waitcnt lgkmcnt(3)
  v_smfmac_f32_16x16x64_bf16 v[52:55], v[40:43], a[48:55], v9
  v_smfmac_f32_16x16x64_bf16 v[56:59], v[40:43], a[128:135], v9
  v_smfmac_f32_16x16x64_bf16 v[60:63], v[40:43], a[208:215], v9
  v_smfmac_f32_16x16x64_bf16 v[64:67], v[40:43], v[104:111], v9
  v_pk_add_f32 v[52:53], v[52:53], v[54:55]
  v_cvt_pk_bf16_f32 v52, v52, v53
  ds_write_b32 v8, v52 offset:21504
  v_pk_add_f32 v[56:57], v[56:57], v[58:59]
  v_cvt_pk_bf16_f32 v56, v56, v57
  ds_write_b32 v8, v56 offset:22528
  v_pk_add_f32 v[60:61], v[60:61], v[62:63]
  v_cvt_pk_bf16_f32 v60, v60, v61
  ds_write_b32 v10, v60 offset:23552
  v_pk_add_f32 v[64:65], v[64:65], v[66:67]
  v_cvt_pk_bf16_f32 v64, v64, v65
  ds_write_b32 v10, v64 offset:24064
mega_loop7_pa:
  buffer_load_dwordx4 v[16:19], v4, s[4:7], s20 offen sc1
  buffer_load_dwordx4 v[20:23], v4, s[4:7], s20 offen offset:256 sc1
  buffer_load_dwordx4 v[24:27], v5, s[4:7], s20 offen offset:512 sc1
  s_waitcnt vmcnt(3) lgkmcnt(0)
  v_max3_u32 v14, v16, v17, v18
  v_max3_u32 v14, v14, v19, v20
  v_mfma_f32_16x16x32_bf16 v[40:43], v[16:19], v[28:31], 0
  v_max3_u32 v14, v14, v21, v22
  v_max3_u32 v14, v14, v23, v24
  v_mfma_f32_16x16x32_bf16 v[40:43], v[20:23], v[32:35], v[40:43]
  v_max3_u32 v14, v14, v25, v26
  v_max_u32 v14, v14, v27
  v_mfma_f32_16x16x32_bf16 v[44:47], v[24:27], v[36:39], 0
  v_cmp_eq_u32 vcc, -1, v14
  s_nop 0
  s_cbranch_vccnz mega_loop7_paf
  s_nop 1
  v_max3_f32 v48, v40, v41, v42
  s_nop 1
  v_cndmask_b32 v44, v44, v45, s[42:43]
  v_max3_f32 v48, v48, v43, v44
  s_nop 1
  v_max_f32_dpp v48, v48, v48 quad_perm:[1,0,3,2] row_mask:0xf bank_mask:0xf
  s_nop 1
  v_max_f32_dpp v48, v48, v48 quad_perm:[2,3,0,1] row_mask:0xf bank_mask:0xf
  s_nop 1
  v_max_f32_dpp v48, v48, v48 row_half_mirror row_mask:0xf bank_mask:0xf
  v_mul_f32 v48, s26, v48
  v_fma_f32 v40, v40, s26, -v48
  v_fma_f32 v41, v41, s26, -v48
  v_fma_f32 v42, v42, s26, -v48
  v_fma_f32 v43, v43, s26, -v48
  v_fma_f32 v44, v44, s26, -v48
  v_exp_f32 v40, v40
  v_exp_f32 v41, v41
  v_exp_f32 v42, v42
  v_exp_f32 v43, v43
  v_exp_f32 v44, v44
  v_add_f32 v48, v40, v41
  v_add_f32 v49, v42, v43
  v_add_f32 v48, v48, v49
  v_add_f32 v48, v48, v44
  s_nop 1
  v_add_f32_dpp v48, v48, v48 quad_perm:[1,0,3,2] row_mask:0xf bank_mask:0xf
  s_nop 1
  v_add_f32_dpp v48, v48, v48 quad_perm:[2,3,0,1] row_mask:0xf bank_mask:0xf
  s_nop 1
  v_add_f32_dpp v48, v48, v48 row_half_mirror row_mask:0xf bank_mask:0xf
  v_rcp_f32 v48, v48
  s_nop 0
  v_pk_mul_f32 v[40:41], v[40:41], v[48:49] op_sel_hi:[1,0]
  v_pk_mul_f32 v[42:43], v[42:43], v[48:49] op_sel_hi:[1,0]
  v_mul_f32 v44, v44, v48
  v_cvt_pk_bf16_f32 v40, v40, v41
  v_cvt_pk_bf16_f32 v41, v42, v43
  ds_write_b64 v6, v[40:41] offset:16384
  v_cvt_pk_bf16_f32 v44, v44, v44
  ds_write_b16 v7, v44 offset:20480
  v_min_u32_dpp v13, v13, v13 quad_perm:[1,0,3,2] row_mask:0xf bank_mask:0xf
  s_nop 1
  v_min_u32_dpp v13, v13, v13 quad_perm:[2,3,0,1] row_mask:0xf bank_mask:0xf
  s_nop 1
  v_min_u32_dpp v13, v13, v13 row_half_mirror row_mask:0xf bank_mask:0xf
  s_nop 0
  v_readfirstlane_b32 s76, v13
  s_waitcnt lgkmcnt(0)
  s_barrier
  v_mov_b32 v28, 0
  v_mov_b32 v29, 0
  v_mov_b32 v30, 0
  v_mov_b32 v31, 0
  v_mov_b32 v32, 0
  v_mov_b32 v33, 0
  v_mov_b32 v34, 0
  v_mov_b32 v35, 0
  v_mov_b32 v36, 0
  v_mov_b32 v37, 0
  v_mov_b32 v38, 0
  v_mov_b32 v39, 0
  v_mov_b32 v40, 0
  v_mov_b32 v41, 0
  v_mov_b32 v42, 0
  v_mov_b32 v43, 0
  v_mov_b32 v44, 0
  v_mov_b32 v45, 0
  v_mov_b32 v46, 0
  v_mov_b32 v47, 0
  v_mov_b32 v48, 0
  v_mov_b32 v49, 0
  v_mov_b32 v50, 0
  v_mov_b32 v51, 0
  v_mov_b32 v52, 0
  v_mov_b32 v53, 0
  v_mov_b32 v54, 0
  v_mov_b32 v55, 0
  v_mov_b32 v56, 0
  v_mov_b32 v57, 0
  v_mov_b32 v58, 0
  v_mov_b32 v59, 0
  v_mov_b32 v60, 0
  v_mov_b32 v61, 0
  v_mov_b32 v62, 0
  v_mov_b32 v63, 0
  v_mov_b32 v64, 0
  v_mov_b32 v65, 0
  v_mov_b32 v66, 0
  v_mov_b32 v67, 0
  s_xor_b32 s18, s18, s19
  s_xor_b32 s19, s19, s18
  s_xor_b32 s18, s18, s19
  s_xor_b32 s20, s20, s21
  s_xor_b32 s21, s21, s20
  s_xor_b32 s20, s20, s21
  s_mov_b32 s15, 0
  s_barrier
  s_add_u32 s29, s12, 2
  s_cmp_lt_u32 s76, s29
  s_cbranch_scc1 mega0_kernel_sd23_wait
mega0_kernel_sd23_go:
  s_mov_b32 m0, 34816
  s_add_u32 s27, s22, 0
  buffer_load_dwordx4 v2, s[4:7], s27 offen sc1 lds
  s_mov_b32 m0, 35840
  s_add_u32 s27, s22, 4096
  buffer_load_dwordx4 v2, s[4:7], s27 offen sc1 lds
  s_mov_b32 m0, 36864
  s_add_u32 s27, s22, 8192
  buffer_load_dwordx4 v2, s[4:7], s27 offen sc1 lds
  s_mov_b32 m0, 24576
  s_add_u32 s27, s24, 0
  buffer_load_dwordx4 v2, s[4:7], s27 offen sc1 lds
  s_mov_b32 m0, 25600
  s_add_u32 s27, s24, 1024
  buffer_load_dwordx4 v2, s[4:7], s27 offen sc1 lds
  s_mov_b32 m0, 26624
  s_add_u32 s27, s24, 2048
  buffer_load_dwordx4 v11, s[4:7], s27 offen sc1 lds
  s_mov_b32 m0, 27648
  s_add_u32 s27, s24, 41472
  buffer_load_dwordx4 v2, s[4:7], s27 offen sc1 lds
  s_mov_b32 m0, 28672
  s_add_u32 s27, s24, 42496
  buffer_load_dwordx4 v2, s[4:7], s27 offen sc1 lds
  s_mov_b32 m0, 29696
  s_add_u32 s27, s24, 81920
  buffer_load_dwordx4 v2, s[4:7], s27 offen sc1 lds
  s_mov_b32 m0, 30720
  s_add_u32 s27, s24, 82944
  buffer_load_dwordx4 v2, s[4:7], s27 offen sc1 lds
  s_mov_b32 m0, 31744
  s_add_u32 s27, s24, 83968
  buffer_load_dwordx4 v11, s[4:7], s27 offen sc1 lds
  s_mov_b32 m0, 32768
  s_add_u32 s27, s24, 123392
  buffer_load_dwordx4 v2, s[4:7], s27 offen sc1 lds
  s_mov_b32 m0, 33792
  s_add_u32 s27, s24, 124416
  buffer_load_dwordx4 v2, s[4:7], s27 offen sc1 lds
  buffer_load_dword v13, v12, s[4:7], s71 offen sc1
  s_add_u32 s72, s72, 1
  s_cmp_eq_u32 s72, 6
  s_cselect_b32 s72, 0, s72
  s_mov_b32 s73, 325632
  s_cselect_b32 s73, 0xffe72800, s73
  s_add_u32 s22, s22, s73
  s_add_u32 s24, s24, s73
  s_add_u32 s12, s12, 1
  s_xor_b32 s16, s16, s17
  s_xor_b32 s17, s17, s16
  s_xor_b32 s16, s16, s17
  s_add_u32 s13, s16, 8192
  s_add_u32 s14, s16, 7168
  s_barrier
  s_nop 3
  s_branch mega_loop7
mega_loop7_pcf:
  s_nop 3
  v_mov_b32 v44, 0
  v_mov_b32 v45, 0
  v_mov_b32 v46, 0
  v_mov_b32 v47, 0
  v_mov_b32 v48, 0
  v_mov_b32 v49, 0
  v_mov_b32 v50, 0
  v_mov_b32 v51, 0
  s_add_u32 s15, s15, 1
  s_cmp_lt_u32 s15, 262144
  s_cbranch_scc1 mega_loop7_pc
  s_branch mega_fail
mega_loop7_last:
  s_waitcnt lgkmcnt(0)
  v_smfmac_f32_16x16x64_bf16 v[52:55], v[40:43], a[0:7], v9
  v_smfmac_f32_16x16x64_bf16 v[56:59], v[40:43], a[80:87], v9
  v_smfmac_f32_16x16x64_bf16 v[60:63], v[40:43], a[160:167], v9
  v_smfmac_f32_16x16x64_bf16 v[64:67], v[40:43], a[240:247], v9
  ds_read_b128 v[40:43], v2 offset:6144
  v_smfmac_f32_16x16x64_bf16 v[52:55], v[28:31], a[8:15], v9
  v_smfmac_f32_16x16x64_bf16 v[56:59], v[28:31], a[88:95], v9
  v_smfmac_f32_16x16x64_bf16 v[60:63], v[28:31], a[168:175], v9
  v_smfmac_f32_16x16x64_bf16 v[64:67], v[28:31], a[248:255], v9
  ds_read_b128 v[28:31], v2 offset:37888
  v_smfmac_f32_16x16x64_bf16 v[52:55], v[32:35], a[16:23], v9
  v_smfmac_f32_16x16x64_bf16 v[56:59], v[32:35], a[96:103], v9
  v_smfmac_f32_16x16x64_bf16 v[60:63], v[32:35], a[176:183], v9
  v_smfmac_f32_16x16x64_bf16 v[64:67], v[32:35], v[72:79], v9
  ds_read_b128 v[32:35], v2 offset:38912
  v_smfmac_f32_16x16x64_bf16 v[52:55], v[36:39], a[24:31], v9
  v_smfmac_f32_16x16x64_bf16 v[56:59], v[36:39], a[104:111], v9
  v_smfmac_f32_16x16x64_bf16 v[60:63], v[36:39], a[184:191], v9
  v_smfmac_f32_16x16x64_bf16 v[64:67], v[36:39], v[80:87], v9
  ds_read_b128 v[36:39], v2 offset:39936
  v_smfmac_f32_16x16x64_bf16 v[52:55], v[44:47], a[32:39], v9
  v_smfmac_f32_16x16x64_bf16 v[56:59], v[44:47], a[112:119], v9
  v_smfmac_f32_16x16x64_bf16 v[60:63], v[44:47], a[192:199], v9
  v_smfmac_f32_16x16x64_bf16 v[64:67], v[44:47], v[88:95], v9
  v_smfmac_f32_16x16x64_bf16 v[52:55], v[48:51], a[40:47], v9
  v_smfmac_f32_16x16x64_bf16 v[56:59], v[48:51], a[120:127], v9
  v_smfmac_f32_16x16x64_bf16 v[60:63], v[48:51], a[200:207], v9
  v_smfmac_f32_16x16x64_bf16 v[64:67], v[48:51], v[96:103], v9
  s_waitcnt lgkmcnt(3)
  v_smfmac_f32_16x16x64_bf16 v[52:55], v[40:43], a[48:55], v9
  v_smfmac_f32_16x16x64_bf16 v[56:59], v[40:43], a[128:135], v9
  v_smfmac_f32_16x16x64_bf16 v[60:63], v[40:43], a[208:215], v9
  v_smfmac_f32_16x16x64_bf16 v[64:67], v[40:43], v[104:111], v9
  v_pk_add_f32 v[52:53], v[52:53], v[54:55]
  v_cvt_pk_bf16_f32 v52, v52, v53
  ds_write_b32 v8, v52 offset:21504
  v_pk_add_f32 v[56:57], v[56:57], v[58:59]
  v_cvt_pk_bf16_f32 v56, v56, v57
  ds_write_b32 v8, v56 offset:22528
  v_pk_add_f32 v[60:61], v[60:61], v[62:63]
  v_cvt_pk_bf16_f32 v60, v60, v61
  ds_write_b32 v10, v60 offset:23552
  v_pk_add_f32 v[64:65], v[64:65], v[66:67]
  v_cvt_pk_bf16_f32 v64, v64, v65
  ds_write_b32 v10, v64 offset:24064
  s_waitcnt lgkmcnt(0)
  s_barrier
  s_barrier
  s_endpgm
mega_loop7_paf:
  s_add_u32 s15, s15, 1
  s_cmp_lt_u32 s15, 262144
  s_cbranch_scc1 mega_loop7_pa
  s_branch mega_fail
mega0_kernel_sd23_wait:
  s_mov_b32 s15, 0
mega0_kernel_sd23_w2:
  buffer_load_dword v13, v12, s[4:7], s71 offen sc1
  s_waitcnt vmcnt(0)
  v_min_u32_dpp v13, v13, v13 quad_perm:[1,0,3,2] row_mask:0xf bank_mask:0xf
  s_nop 1
  v_min_u32_dpp v13, v13, v13 quad_perm:[2,3,0,1] row_mask:0xf bank_mask:0xf
  s_nop 1
  v_min_u32_dpp v13, v13, v13 row_half_mirror row_mask:0xf bank_mask:0xf
  s_nop 0
  v_readfirstlane_b32 s76, v13
  s_nop 0
  s_cmp_ge_u32 s76, s29
  s_cbranch_scc1 mega0_kernel_sd23_go
  s_sleep 1
  s_add_u32 s15, s15, 1
  s_cmp_lt_u32 s15, 262144
  s_cbranch_scc1 mega0_kernel_sd23_w2
  s_branch mega_fail
mega_fail:
  s_mov_b64 exec, 1
  v_mov_b32 v24, s79
  v_add_u32 v24, 0x1000, v24
  v_mov_b32 v25, 64
  buffer_store_dword v24, v25, s[44:47], 0 offen
mega_end:
  s_endpgm

.globl mega1_kernel
.p2align 8
.type mega1_kernel,@function
mega1_kernel:
  s_mov_b32 s70, 1
  s_mov_b32 s99, 0
  s_branch mega_common

.globl b1_kernel
.p2align 8
.type b1_kernel,@function
b1_kernel:
  s_load_dwordx2 s[4:5], s[0:1], 104
  s_mov_b32 s6, 0x10000000
  s_mov_b32 s7, 0x20000
  v_lshrrev_b32 v1, 6, v0
  s_nop 0
  v_readfirstlane_b32 s3, v1
  v_and_b32 v1, 63, v0
  s_cmp_ge_u32 s2, 256
  s_cbranch_scc1 b1_end
  s_bfe_u32 s8, s2, 0x20001
  s_lshl_b32 s8, s8, 3
  s_lshr_b32 s9, s2, 5
  s_add_u32 s8, s8, s9
  s_and_b32 s9, s2, 1
  s_lshl_b32 s9, s9, 2
  s_bfe_u32 s10, s2, 0x20003
  s_add_u32 s9, s9, s10
  s_lshl_b32 s10, s8, 2
  s_add_u32 s10, s10, s3
  v_lshlrev_b32 v2, 4, v1
  v_add_u32 v3, 61440, v2
  v_add_u32 v6, 122880, v2
  v_and_b32 v4, 15, v1
  v_lshrrev_b32 v5, 4, v1
  s_mul_i32 s11, s10, 20480
  s_add_u32 s11, s11, 56000512
  s_mov_b32 s31, 0x3fb8aa3b
  s_waitcnt lgkmcnt(0)
  s_cmp_eq_u32 s3, 4
  s_cbranch_scc0 b1_comp
  s_mul_i32 s12, s9, 307200
  s_add_u32 s12, s12, 94507008
  s_sleep 2
  s_mov_b32 m0, 0
  s_nop 0
  buffer_load_dwordx4 v2, s[4:7], s12 offen offset:0 lds
  buffer_load_dwordx4 v2, s[4:7], s12 offen offset:1024 lds
  buffer_load_dwordx4 v2, s[4:7], s12 offen offset:2048 lds
  buffer_load_dwordx4 v2, s[4:7], s12 offen offset:3072 lds
  s_mov_b32 m0, 4096
  s_add_u32 s12, s12, 4096
  buffer_load_dwordx4 v2, s[4:7], s12 offen offset:0 lds
  buffer_load_dwordx4 v2, s[4:7], s12 offen offset:1024 lds
  buffer_load_dwordx4 v2, s[4:7], s12 offen offset:2048 lds
  buffer_load_dwordx4 v2, s[4:7], s12 offen offset:3072 lds
  s_mov_b32 m0, 8192
  s_add_u32 s12, s12, 4096
  buffer_load_dwordx4 v2, s[4:7], s12 offen offset:0 lds
  buffer_load_dwordx4 v2, s[4:7], s12 offen offset:1024 lds
  buffer_load_dwordx4 v2, s[4:7], s12 offen offset:2048 lds
  buffer_load_dwordx4 v2, s[4:7], s12 offen offset:3072 lds
  s_mov_b32 m0, 12288
  s_add_u32 s12, s12, 4096
  buffer_load_dwordx4 v2, s[4:7], s12 offen offset:0 lds
  buffer_load_dwordx4 v2, s[4:7], s12 offen offset:1024 lds
  buffer_load_dwordx4 v2, s[4:7], s12 offen offset:2048 lds
  s_add_u32 s12, s12, 3072
  s_mov_b32 m0, 15360
  s_nop 0
  buffer_load_dwordx4 v2, s[4:7], s12 offen offset:0 lds
  buffer_load_dwordx4 v2, s[4:7], s12 offen offset:1024 lds
  buffer_load_dwordx4 v2, s[4:7], s12 offen offset:2048 lds
  buffer_load_dwordx4 v2, s[4:7], s12 offen offset:3072 lds
  s_mov_b32 m0, 19456
  s_add_u32 s12, s12, 4096
  buffer_load_dwordx4 v2, s[4:7], s12 offen offset:0 lds
  buffer_load_dwordx4 v2, s[4:7], s12 offen offset:1024 lds
  buffer_load_dwordx4 v2, s[4:7], s12 offen offset:2048 lds
  buffer_load_dwordx4 v2, s[4:7], s12 offen offset:3072 lds
  s_mov_b32 m0, 23552
  s_add_u32 s12, s12, 4096
  buffer_load_dwordx4 v2, s[4:7], s12 offen offset:0 lds
  buffer_load_dwordx4 v2, s[4:7], s12 offen offset:1024 lds
  buffer_load_dwordx4 v2, s[4:7], s12 offen offset:2048 lds
  buffer_load_dwordx4 v2, s[4:7], s12 offen offset:3072 lds
  s_mov_b32 m0, 27648
  s_add_u32 s12, s12, 4096
  buffer_load_dwordx4 v2, s[4:7], s12 offen offset:0 lds
  buffer_load_dwordx4 v2, s[4:7], s12 offen offset:1024 lds
  buffer_load_dwordx4 v2, s[4:7], s12 offen offset:2048 lds
  s_add_u32 s12, s12, 3072
  s_mov_b32 m0, 30720
  s_nop 0
  buffer_load_dwordx4 v2, s[4:7], s12 offen offset:0 lds
  buffer_load_dwordx4 v2, s[4:7], s12 offen offset:1024 lds
  buffer_load_dwordx4 v2, s[4:7], s12 offen offset:2048 lds
  buffer_load_dwordx4 v2, s[4:7], s12 offen offset:3072 lds
  s_mov_b32 m0, 34816
  s_add_u32 s12, s12, 4096
  buffer_load_dwordx4 v2, s[4:7], s12 offen offset:0 lds
  buffer_load_dwordx4 v2, s[4:7], s12 offen offset:1024 lds
  buffer_load_dwordx4 v2, s[4:7], s12 offen offset:2048 lds
  buffer_load_dwordx4 v2, s[4:7], s12 offen offset:3072 lds
  s_mov_b32 m0, 38912
  s_add_u32 s12, s12, 4096
  buffer_load_dwordx4 v2, s[4:7], s12 offen offset:0 lds
  buffer_load_dwordx4 v2, s[4:7], s12 offen offset:1024 lds
  buffer_load_dwordx4 v2, s[4:7], s12 offen offset:2048 lds
  buffer_load_dwordx4 v2, s[4:7], s12 offen offset:3072 lds
  s_mov_b32 m0, 43008
  s_add_u32 s12, s12, 4096
  buffer_load_dwordx4 v2, s[4:7], s12 offen offset:0 lds
  buffer_load_dwordx4 v2, s[4:7], s12 offen offset:1024 lds
  buffer_load_dwordx4 v2, s[4:7], s12 offen offset:2048 lds
  s_add_u32 s12, s12, 3072
  s_mov_b32 m0, 46080
  s_nop 0
  buffer_load_dwordx4 v2, s[4:7], s12 offen offset:0 lds
  buffer_load_dwordx4 v2, s[4:7], s12 offen offset:1024 lds
  buffer_load_dwordx4 v2, s[4:7], s12 offen offset:2048 lds
  buffer_load_dwordx4 v2, s[4:7], s12 offen offset:3072 lds
  s_mov_b32 m0, 50176
  s_add_u32 s12, s12, 4096
  buffer_load_dwordx4 v2, s[4:7], s12 offen offset:0 lds
  buffer_load_dwordx4 v2, s[4:7], s12 offen offset:1024 lds
  buffer_load_dwordx4 v2, s[4:7], s12 offen offset:2048 lds
  buffer_load_dwordx4 v2, s[4:7], s12 offen offset:3072 lds
  s_mov_b32 m0, 54272
  s_add_u32 s12, s12, 4096
  buffer_load_dwordx4 v2, s[4:7], s12 offen offset:0 lds
  buffer_load_dwordx4 v2, s[4:7], s12 offen offset:1024 lds
  buffer_load_dwordx4 v2, s[4:7], s12 offen offset:2048 lds
  buffer_load_dwordx4 v2, s[4:7], s12 offen offset:3072 lds
  s_mov_b32 m0, 58368
  s_add_u32 s12, s12, 4096
  buffer_load_dwordx4 v2, s[4:7], s12 offen offset:0 lds
  buffer_load_dwordx4 v2, s[4:7], s12 offen offset:1024 lds
  buffer_load_dwordx4 v2, s[4:7], s12 offen offset:2048 lds
  s_add_u32 s12, s12, 3072
  s_waitcnt vmcnt(45)
  s_mov_b32 m0, 61440
  s_nop 0
  buffer_load_dwordx4 v2, s[4:7], s12 offen offset:0 lds
  buffer_load_dwordx4 v2, s[4:7], s12 offen offset:1024 lds
  buffer_load_dwordx4 v2, s[4:7], s12 offen offset:2048 lds
  buffer_load_dwordx4 v2, s[4:7], s12 offen offset:3072 lds
  s_mov_b32 m0, 65536
  s_add_u32 s12, s12, 4096
  buffer_load_dwordx4 v2, s[4:7], s12 offen offset:0 lds
  buffer_load_dwordx4 v2, s[4:7], s12 offen offset:1024 lds
  buffer_load_dwordx4 v2, s[4:7], s12 offen offset:2048 lds
  buffer_load_dwordx4 v2, s[4:7], s12 offen offset:3072 lds
  s_mov_b32 m0, 69632
  s_add_u32 s12, s12, 4096
  buffer_load_dwordx4 v2, s[4:7], s12 offen offset:0 lds
  buffer_load_dwordx4 v2, s[4:7], s12 offen offset:1024 lds
  buffer_load_dwordx4 v2, s[4:7], s12 offen offset:2048 lds
  buffer_load_dwordx4 v2, s[4:7], s12 offen offset:3072 lds
  s_mov_b32 m0, 73728
  s_add_u32 s12, s12, 4096
  buffer_load_dwordx4 v2, s[4:7], s12 offen offset:0 lds
  buffer_load_dwordx4 v2, s[4:7], s12 offen offset:1024 lds
  buffer_load_dwordx4 v2, s[4:7], s12 offen offset:2048 lds
  s_add_u32 s12, s12, 3072
  s_waitcnt vmcnt(45)
  s_mov_b32 m0, 76800
  s_nop 0
  buffer_load_dwordx4 v2, s[4:7], s12 offen offset:0 lds
  buffer_load_dwordx4 v2, s[4:7], s12 offen offset:1024 lds
  buffer_load_dwordx4 v2, s[4:7], s12 offen offset:2048 lds
  buffer_load_dwordx4 v2, s[4:7], s12 offen offset:3072 lds
  s_mov_b32 m0, 80896
  s_add_u32 s12, s12, 4096
  buffer_load_dwordx4 v2, s[4:7], s12 offen offset:0 lds
  buffer_load_dwordx4 v2, s[4:7], s12 offen offset:1024 lds
  buffer_load_dwordx4 v2, s[4:7], s12 offen offset:2048 lds
  buffer_load_dwordx4 v2, s[4:7], s12 offen offset:3072 lds
  s_mov_b32 m0, 84992
  s_add_u32 s12, s12, 4096
  buffer_load_dwordx4 v2, s[4:7], s12 offen offset:0 lds
  buffer_load_dwordx4 v2, s[4:7], s12 offen offset:1024 lds
  buffer_load_dwordx4 v2, s[4:7], s12 offen offset:2048 lds
  buffer_load_dwordx4 v2, s[4:7], s12 offen offset:3072 lds
  s_mov_b32 m0, 89088
  s_add_u32 s12, s12, 4096
  buffer_load_dwordx4 v2, s[4:7], s12 offen offset:0 lds
  buffer_load_dwordx4 v2, s[4:7], s12 offen offset:1024 lds
  buffer_load_dwordx4 v2, s[4:7], s12 offen offset:2048 lds
  s_add_u32 s12, s12, 3072
  s_waitcnt vmcnt(45)
  s_mov_b32 m0, 92160
  s_nop 0
  buffer_load_dwordx4 v2, s[4:7], s12 offen offset:0 lds
  buffer_load_dwordx4 v2, s[4:7], s12 offen offset:1024 lds
  buffer_load_dwordx4 v2, s[4:7], s12 offen offset:2048 lds
  buffer_load_dwordx4 v2, s[4:7], s12 offen offset:3072 lds
  s_mov_b32 m0, 96256
  s_add_u32 s12, s12, 4096
  buffer_load_dwordx4 v2, s[4:7], s12 offen offset:0 lds
  buffer_load_dwordx4 v2, s[4:7], s12 offen offset:1024 lds
  buffer_load_dwordx4 v2, s[4:7], s12 offen offset:2048 lds
  buffer_load_dwordx4 v2, s[4:7], s12 offen offset:3072 lds
  s_mov_b32 m0, 100352
  s_add_u32 s12, s12, 4096
  buffer_load_dwordx4 v2, s[4:7], s12 offen offset:0 lds
  buffer_load_dwordx4 v2, s[4:7], s12 offen offset:1024 lds
  buffer_load_dwordx4 v2, s[4:7], s12 offen offset:2048 lds
  buffer_load_dwordx4 v2, s[4:7], s12 offen offset:3072 lds
  s_mov_b32 m0, 104448
  s_add_u32 s12, s12, 4096
  buffer_load_dwordx4 v2, s[4:7], s12 offen offset:0 lds
  buffer_load_dwordx4 v2, s[4:7], s12 offen offset:1024 lds
  buffer_load_dwordx4 v2, s[4:7], s12 offen offset:2048 lds
  s_add_u32 s12, s12, 3072
  s_waitcnt vmcnt(45)
  s_mov_b32 m0, 107520
  s_nop 0
  buffer_load_dwordx4 v2, s[4:7], s12 offen offset:0 lds
  buffer_load_dwordx4 v2, s[4:7], s12 offen offset:1024 lds
  buffer_load_dwordx4 v2, s[4:7], s12 offen offset:2048 lds
  buffer_load_dwordx4 v2, s[4:7], s12 offen offset:3072 lds
  s_mov_b32 m0, 111616
  s_add_u32 s12, s12, 4096
  buffer_load_dwordx4 v2, s[4:7], s12 offen offset:0 lds
  buffer_load_dwordx4 v2, s[4:7], s12 offen offset:1024 lds
  buffer_load_dwordx4 v2, s[4:7], s12 offen offset:2048 lds
  buffer_load_dwordx4 v2, s[4:7], s12 offen offset:3072 lds
  s_mov_b32 m0, 115712
  s_add_u32 s12, s12, 4096
  buffer_load_dwordx4 v2, s[4:7], s12 offen offset:0 lds
  buffer_load_dwordx4 v2, s[4:7], s12 offen offset:1024 lds
  buffer_load_dwordx4 v2, s[4:7], s12 offen offset:2048 lds
  buffer_load_dwordx4 v2, s[4:7], s12 offen offset:3072 lds
  s_mov_b32 m0, 119808
  s_add_u32 s12, s12, 4096
  buffer_load_dwordx4 v2, s[4:7], s12 offen offset:0 lds
  buffer_load_dwordx4 v2, s[4:7], s12 offen offset:1024 lds
  buffer_load_dwordx4 v2, s[4:7], s12 offen offset:2048 lds
  s_add_u32 s12, s12, 3072
  s_waitcnt vmcnt(45)
  s_mov_b32 m0, 122880
  s_nop 0
  buffer_load_dwordx4 v2, s[4:7], s12 offen offset:0 lds
  buffer_load_dwordx4 v2, s[4:7], s12 offen offset:1024 lds
  buffer_load_dwordx4 v2, s[4:7], s12 offen offset:2048 lds
  buffer_load_dwordx4 v2, s[4:7], s12 offen offset:3072 lds
  s_mov_b32 m0, 126976
  s_add_u32 s12, s12, 4096
  buffer_load_dwordx4 v2, s[4:7], s12 offen offset:0 lds
  buffer_load_dwordx4 v2, s[4:7], s12 offen offset:1024 lds
  buffer_load_dwordx4 v2, s[4:7], s12 offen offset:2048 lds
  buffer_load_dwordx4 v2, s[4:7], s12 offen offset:3072 lds
  s_mov_b32 m0, 131072
  s_add_u32 s12, s12, 4096
  buffer_load_dwordx4 v2, s[4:7], s12 offen offset:0 lds
  buffer_load_dwordx4 v2, s[4:7], s12 offen offset:1024 lds
  buffer_load_dwordx4 v2, s[4:7], s12 offen offset:2048 lds
  buffer_load_dwordx4 v2, s[4:7], s12 offen offset:3072 lds
  s_mov_b32 m0, 135168
  s_add_u32 s12, s12, 4096
  buffer_load_dwordx4 v2, s[4:7], s12 offen offset:0 lds
  buffer_load_dwordx4 v2, s[4:7], s12 offen offset:1024 lds
  buffer_load_dwordx4 v2, s[4:7], s12 offen offset:2048 lds
  s_add_u32 s12, s12, 3072
  s_waitcnt vmcnt(45)
  s_mov_b32 m0, 138240
  s_nop 0
  buffer_load_dwordx4 v2, s[4:7], s12 offen offset:0 lds
  buffer_load_dwordx4 v2, s[4:7], s12 offen offset:1024 lds
  buffer_load_dwordx4 v2, s[4:7], s12 offen offset:2048 lds
  buffer_load_dwordx4 v2, s[4:7], s12 offen offset:3072 lds
  s_mov_b32 m0, 142336
  s_add_u32 s12, s12, 4096
  buffer_load_dwordx4 v2, s[4:7], s12 offen offset:0 lds
  buffer_load_dwordx4 v2, s[4:7], s12 offen offset:1024 lds
  buffer_load_dwordx4 v2, s[4:7], s12 offen offset:2048 lds
  buffer_load_dwordx4 v2, s[4:7], s12 offen offset:3072 lds
  s_mov_b32 m0, 146432
  s_add_u32 s12, s12, 4096
  buffer_load_dwordx4 v2, s[4:7], s12 offen offset:0 lds
  buffer_load_dwordx4 v2, s[4:7], s12 offen offset:1024 lds
  buffer_load_dwordx4 v2, s[4:7], s12 offen offset:2048 lds
  buffer_load_dwordx4 v2, s[4:7], s12 offen offset:3072 lds
  s_mov_b32 m0, 150528
  s_add_u32 s12, s12, 4096
  buffer_load_dwordx4 v2, s[4:7], s12 offen offset:0 lds
  buffer_load_dwordx4 v2, s[4:7], s12 offen offset:1024 lds
  buffer_load_dwordx4 v2, s[4:7], s12 offen offset:2048 lds
  s_add_u32 s12, s12, 3072
  s_waitcnt vmcnt(60)
  s_barrier
  s_waitcnt vmcnt(60)
  s_barrier
  s_mov_b32 m0, 0
  s_nop 0
  buffer_load_dwordx4 v2, s[4:7], s12 offen offset:0 lds
  buffer_load_dwordx4 v2, s[4:7], s12 offen offset:1024 lds
  buffer_load_dwordx4 v2, s[4:7], s12 offen offset:2048 lds
  buffer_load_dwordx4 v2, s[4:7], s12 offen offset:3072 lds
  s_mov_b32 m0, 4096
  s_add_u32 s12, s12, 4096
  buffer_load_dwordx4 v2, s[4:7], s12 offen offset:0 lds
  buffer_load_dwordx4 v2, s[4:7], s12 offen offset:1024 lds
  buffer_load_dwordx4 v2, s[4:7], s12 offen offset:2048 lds
  buffer_load_dwordx4 v2, s[4:7], s12 offen offset:3072 lds
  s_mov_b32 m0, 8192
  s_add_u32 s12, s12, 4096
  buffer_load_dwordx4 v2, s[4:7], s12 offen offset:0 lds
  buffer_load_dwordx4 v2, s[4:7], s12 offen offset:1024 lds
  buffer_load_dwordx4 v2, s[4:7], s12 offen offset:2048 lds
  buffer_load_dwordx4 v2, s[4:7], s12 offen offset:3072 lds
  s_mov_b32 m0, 12288
  s_add_u32 s12, s12, 4096
  buffer_load_dwordx4 v2, s[4:7], s12 offen offset:0 lds
  buffer_load_dwordx4 v2, s[4:7], s12 offen offset:1024 lds
  buffer_load_dwordx4 v2, s[4:7], s12 offen offset:2048 lds
  s_add_u32 s12, s12, 3072
  s_mov_b32 m0, 15360
  s_nop 0
  buffer_load_dwordx4 v2, s[4:7], s12 offen offset:0 lds
  buffer_load_dwordx4 v2, s[4:7], s12 offen offset:1024 lds
  buffer_load_dwordx4 v2, s[4:7], s12 offen offset:2048 lds
  buffer_load_dwordx4 v2, s[4:7], s12 offen offset:3072 lds
  s_mov_b32 m0, 19456
  s_add_u32 s12, s12, 4096
  buffer_load_dwordx4 v2, s[4:7], s12 offen offset:0 lds
  buffer_load_dwordx4 v2, s[4:7], s12 offen offset:1024 lds
  buffer_load_dwordx4 v2, s[4:7], s12 offen offset:2048 lds
  buffer_load_dwordx4 v2, s[4:7], s12 offen offset:3072 lds
  s_mov_b32 m0, 23552
  s_add_u32 s12, s12, 4096
  buffer_load_dwordx4 v2, s[4:7], s12 offen offset:0 lds
  buffer_load_dwordx4 v2, s[4:7], s12 offen offset:1024 lds
  buffer_load_dwordx4 v2, s[4:7], s12 offen offset:2048 lds
  buffer_load_dwordx4 v2, s[4:7], s12 offen offset:3072 lds
  s_mov_b32 m0, 27648
  s_add_u32 s12, s12, 4096
  buffer_load_dwordx4 v2, s[4:7], s12 offen offset:0 lds
  buffer_load_dwordx4 v2, s[4:7], s12 offen offset:1024 lds
  buffer_load_dwordx4 v2, s[4:7], s12 offen offset:2048 lds
  s_add_u32 s12, s12, 3072
  s_waitcnt vmcnt(60)
  s_barrier
  s_mov_b32 m0, 30720
  s_nop 0
  buffer_load_dwordx4 v2, s[4:7], s12 offen offset:0 lds
  buffer_load_dwordx4 v2, s[4:7], s12 offen offset:1024 lds
  buffer_load_dwordx4 v2, s[4:7], s12 offen offset:2048 lds
  buffer_load_dwordx4 v2, s[4:7], s12 offen offset:3072 lds
  s_mov_b32 m0, 34816
  s_add_u32 s12, s12, 4096
  buffer_load_dwordx4 v2, s[4:7], s12 offen offset:0 lds
  buffer_load_dwordx4 v2, s[4:7], s12 offen offset:1024 lds
  buffer_load_dwordx4 v2, s[4:7], s12 offen offset:2048 lds
  buffer_load_dwordx4 v2, s[4:7], s12 offen offset:3072 lds
  s_mov_b32 m0, 38912
  s_add_u32 s12, s12, 4096
  buffer_load_dwordx4 v2, s[4:7], s12 offen offset:0 lds
  buffer_load_dwordx4 v2, s[4:7], s12 offen offset:1024 lds
  buffer_load_dwordx4 v2, s[4:7], s12 offen offset:2048 lds
  buffer_load_dwordx4 v2, s[4:7], s12 offen offset:3072 lds
  s_mov_b32 m0, 43008
  s_add_u32 s12, s12, 4096
  buffer_load_dwordx4 v2, s[4:7], s12 offen offset:0 lds
  buffer_load_dwordx4 v2, s[4:7], s12 offen offset:1024 lds
  buffer_load_dwordx4 v2, s[4:7], s12 offen offset:2048 lds
  s_add_u32 s12, s12, 3072
  s_mov_b32 m0, 46080
  s_nop 0
  buffer_load_dwordx4 v2, s[4:7], s12 offen offset:0 lds
  buffer_load_dwordx4 v2, s[4:7], s12 offen offset:1024 lds
  buffer_load_dwordx4 v2, s[4:7], s12 offen offset:2048 lds
  buffer_load_dwordx4 v2, s[4:7], s12 offen offset:3072 lds
  s_mov_b32 m0, 50176
  s_add_u32 s12, s12, 4096
  buffer_load_dwordx4 v2, s[4:7], s12 offen offset:0 lds
  buffer_load_dwordx4 v2, s[4:7], s12 offen offset:1024 lds
  buffer_load_dwordx4 v2, s[4:7], s12 offen offset:2048 lds
  buffer_load_dwordx4 v2, s[4:7], s12 offen offset:3072 lds
  s_mov_b32 m0, 54272
  s_add_u32 s12, s12, 4096
  buffer_load_dwordx4 v2, s[4:7], s12 offen offset:0 lds
  buffer_load_dwordx4 v2, s[4:7], s12 offen offset:1024 lds
  buffer_load_dwordx4 v2, s[4:7], s12 offen offset:2048 lds
  buffer_load_dwordx4 v2, s[4:7], s12 offen offset:3072 lds
  s_mov_b32 m0, 58368
  s_add_u32 s12, s12, 4096
  buffer_load_dwordx4 v2, s[4:7], s12 offen offset:0 lds
  buffer_load_dwordx4 v2, s[4:7], s12 offen offset:1024 lds
  buffer_load_dwordx4 v2, s[4:7], s12 offen offset:2048 lds
  s_add_u32 s12, s12, 3072
  s_waitcnt vmcnt(60)
  s_barrier
  s_mov_b32 m0, 61440
  s_nop 0
  buffer_load_dwordx4 v2, s[4:7], s12 offen offset:0 lds
  buffer_load_dwordx4 v2, s[4:7], s12 offen offset:1024 lds
  buffer_load_dwordx4 v2, s[4:7], s12 offen offset:2048 lds
  buffer_load_dwordx4 v2, s[4:7], s12 offen offset:3072 lds
  s_mov_b32 m0, 65536
  s_add_u32 s12, s12, 4096
  buffer_load_dwordx4 v2, s[4:7], s12 offen offset:0 lds
  buffer_load_dwordx4 v2, s[4:7], s12 offen offset:1024 lds
  buffer_load_dwordx4 v2, s[4:7], s12 offen offset:2048 lds
  buffer_load_dwordx4 v2, s[4:7], s12 offen offset:3072 lds
  s_mov_b32 m0, 69632
  s_add_u32 s12, s12, 4096
  buffer_load_dwordx4 v2, s[4:7], s12 offen offset:0 lds
  buffer_load_dwordx4 v2, s[4:7], s12 offen offset:1024 lds
  buffer_load_dwordx4 v2, s[4:7], s12 offen offset:2048 lds
  buffer_load_dwordx4 v2, s[4:7], s12 offen offset:3072 lds
  s_mov_b32 m0, 73728
  s_add_u32 s12, s12, 4096
  buffer_load_dwordx4 v2, s[4:7], s12 offen offset:0 lds
  buffer_load_dwordx4 v2, s[4:7], s12 offen offset:1024 lds
  buffer_load_dwordx4 v2, s[4:7], s12 offen offset:2048 lds
  s_add_u32 s12, s12, 3072
  s_mov_b32 m0, 76800
  s_nop 0
  buffer_load_dwordx4 v2, s[4:7], s12 offen offset:0 lds
  buffer_load_dwordx4 v2, s[4:7], s12 offen offset:1024 lds
  buffer_load_dwordx4 v2, s[4:7], s12 offen offset:2048 lds
  buffer_load_dwordx4 v2, s[4:7], s12 offen offset:3072 lds
  s_mov_b32 m0, 80896
  s_add_u32 s12, s12, 4096
  buffer_load_dwordx4 v2, s[4:7], s12 offen offset:0 lds
  buffer_load_dwordx4 v2, s[4:7], s12 offen offset:1024 lds
  buffer_load_dwordx4 v2, s[4:7], s12 offen offset:2048 lds
  buffer_load_dwordx4 v2, s[4:7], s12 offen offset:3072 lds
  s_mov_b32 m0, 84992
  s_add_u32 s12, s12, 4096
  buffer_load_dwordx4 v2, s[4:7], s12 offen offset:0 lds
  buffer_load_dwordx4 v2, s[4:7], s12 offen offset:1024 lds
  buffer_load_dwordx4 v2, s[4:7], s12 offen offset:2048 lds
  buffer_load_dwordx4 v2, s[4:7], s12 offen offset:3072 lds
  s_mov_b32 m0, 89088
  s_add_u32 s12, s12, 4096
  buffer_load_dwordx4 v2, s[4:7], s12 offen offset:0 lds
  buffer_load_dwordx4 v2, s[4:7], s12 offen offset:1024 lds
  buffer_load_dwordx4 v2, s[4:7], s12 offen offset:2048 lds
  s_add_u32 s12, s12, 3072
  s_waitcnt vmcnt(60)
  s_barrier
  s_mov_b32 m0, 92160
  s_nop 0
  buffer_load_dwordx4 v2, s[4:7], s12 offen offset:0 lds
  buffer_load_dwordx4 v2, s[4:7], s12 offen offset:1024 lds
  buffer_load_dwordx4 v2, s[4:7], s12 offen offset:2048 lds
  buffer_load_dwordx4 v2, s[4:7], s12 offen offset:3072 lds
  s_mov_b32 m0, 96256
  s_add_u32 s12, s12, 4096
  buffer_load_dwordx4 v2, s[4:7], s12 offen offset:0 lds
  buffer_load_dwordx4 v2, s[4:7], s12 offen offset:1024 lds
  buffer_load_dwordx4 v2, s[4:7], s12 offen offset:2048 lds
  buffer_load_dwordx4 v2, s[4:7], s12 offen offset:3072 lds
  s_mov_b32 m0, 100352
  s_add_u32 s12, s12, 4096
  buffer_load_dwordx4 v2, s[4:7], s12 offen offset:0 lds
  buffer_load_dwordx4 v2, s[4:7], s12 offen offset:1024 lds
  buffer_load_dwordx4 v2, s[4:7], s12 offen offset:2048 lds
  buffer_load_dwordx4 v2, s[4:7], s12 offen offset:3072 lds
  s_mov_b32 m0, 104448
  s_add_u32 s12, s12, 4096
  buffer_load_dwordx4 v2, s[4:7], s12 offen offset:0 lds
  buffer_load_dwordx4 v2, s[4:7], s12 offen offset:1024 lds
  buffer_load_dwordx4 v2, s[4:7], s12 offen offset:2048 lds
  s_add_u32 s12, s12, 3072
  s_mov_b32 m0, 107520
  s_nop 0
  buffer_load_dwordx4 v2, s[4:7], s12 offen offset:0 lds
  buffer_load_dwordx4 v2, s[4:7], s12 offen offset:1024 lds
  buffer_load_dwordx4 v2, s[4:7], s12 offen offset:2048 lds
  buffer_load_dwordx4 v2, s[4:7], s12 offen offset:3072 lds
  s_mov_b32 m0, 111616
  s_add_u32 s12, s12, 4096
  buffer_load_dwordx4 v2, s[4:7], s12 offen offset:0 lds
  buffer_load_dwordx4 v2, s[4:7], s12 offen offset:1024 lds
  buffer_load_dwordx4 v2, s[4:7], s12 offen offset:2048 lds
  buffer_load_dwordx4 v2, s[4:7], s12 offen offset:3072 lds
  s_mov_b32 m0, 115712
  s_add_u32 s12, s12, 4096
  buffer_load_dwordx4 v2, s[4:7], s12 offen offset:0 lds
  buffer_load_dwordx4 v2, s[4:7], s12 offen offset:1024 lds
  buffer_load_dwordx4 v2, s[4:7], s12 offen offset:2048 lds
  buffer_load_dwordx4 v2, s[4:7], s12 offen offset:3072 lds
  s_mov_b32 m0, 119808
  s_add_u32 s12, s12, 4096
  buffer_load_dwordx4 v2, s[4:7], s12 offen offset:0 lds
  buffer_load_dwordx4 v2, s[4:7], s12 offen offset:1024 lds
  buffer_load_dwordx4 v2, s[4:7], s12 offen offset:2048 lds
  s_add_u32 s12, s12, 3072
  s_waitcnt vmcnt(60)
  s_barrier
  s_mov_b32 m0, 122880
  s_nop 0
  buffer_load_dwordx4 v2, s[4:7], s12 offen offset:0 lds
  buffer_load_dwordx4 v2, s[4:7], s12 offen offset:1024 lds
  buffer_load_dwordx4 v2, s[4:7], s12 offen offset:2048 lds
  buffer_load_dwordx4 v2, s[4:7], s12 offen offset:3072 lds
  s_mov_b32 m0, 126976
  s_add_u32 s12, s12, 4096
  buffer_load_dwordx4 v2, s[4:7], s12 offen offset:0 lds
  buffer_load_dwordx4 v2, s[4:7], s12 offen offset:1024 lds
  buffer_load_dwordx4 v2, s[4:7], s12 offen offset:2048 lds
  buffer_load_dwordx4 v2, s[4:7], s12 offen offset:3072 lds
  s_mov_b32 m0, 131072
  s_add_u32 s12, s12, 4096
  buffer_load_dwordx4 v2, s[4:7], s12 offen offset:0 lds
  buffer_load_dwordx4 v2, s[4:7], s12 offen offset:1024 lds
  buffer_load_dwordx4 v2, s[4:7], s12 offen offset:2048 lds
  buffer_load_dwordx4 v2, s[4:7], s12 offen offset:3072 lds
  s_mov_b32 m0, 135168
  s_add_u32 s12, s12, 4096
  buffer_load_dwordx4 v2, s[4:7], s12 offen offset:0 lds
  buffer_load_dwordx4 v2, s[4:7], s12 offen offset:1024 lds
  buffer_load_dwordx4 v2, s[4:7], s12 offen offset:2048 lds
  s_add_u32 s12, s12, 3072
  s_mov_b32 m0, 138240
  s_nop 0
  buffer_load_dwordx4 v2, s[4:7], s12 offen offset:0 lds
  buffer_load_dwordx4 v2, s[4:7], s12 offen offset:1024 lds
  buffer_load_dwordx4 v2, s[4:7], s12 offen offset:2048 lds
  buffer_load_dwordx4 v2, s[4:7], s12 offen offset:3072 lds
  s_mov_b32 m0, 142336
  s_add_u32 s12, s12, 4096
  buffer_load_dwordx4 v2, s[4:7], s12 offen offset:0 lds
  buffer_load_dwordx4 v2, s[4:7], s12 offen offset:1024 lds
  buffer_load_dwordx4 v2, s[4:7], s12 offen offset:2048 lds
  buffer_load_dwordx4 v2, s[4:7], s12 offen offset:3072 lds
  s_mov_b32 m0, 146432
  s_add_u32 s12, s12, 4096
  buffer_load_dwordx4 v2, s[4:7], s12 offen offset:0 lds
  buffer_load_dwordx4 v2, s[4:7], s12 offen offset:1024 lds
  buffer_load_dwordx4 v2, s[4:7], s12 offen offset:2048 lds
  buffer_load_dwordx4 v2, s[4:7], s12 offen offset:3072 lds
  s_mov_b32 m0, 150528
  s_add_u32 s12, s12, 4096
  buffer_load_dwordx4 v2, s[4:7], s12 offen offset:0 lds
  buffer_load_dwordx4 v2, s[4:7], s12 offen offset:1024 lds
  buffer_load_dwordx4 v2, s[4:7], s12 offen offset:2048 lds
  s_add_u32 s12, s12, 3072
  s_waitcnt vmcnt(60)
  s_barrier
  s_waitcnt vmcnt(60)
  s_barrier
  s_waitcnt vmcnt(30)
  s_barrier
  s_waitcnt vmcnt(0)
  s_barrier
  s_barrier
  s_endpgm
b1_comp:
  s_mov_b32 s14, s11
  buffer_load_dwordx4 v[16:19], v2, s[4:7], s14 offen offset:0
  buffer_load_dwordx4 v[20:23], v2, s[4:7], s14 offen offset:1024
  buffer_load_dwordx4 v[24:27], v2, s[4:7], s14 offen offset:2048
  buffer_load_dwordx4 v[28:31], v2, s[4:7], s14 offen offset:3072
  s_add_u32 s14, s14, 4096
  buffer_load_dwordx4 v[32:35], v2, s[4:7], s14 offen offset:0
  buffer_load_dwordx4 v[36:39], v2, s[4:7], s14 offen offset:1024
  buffer_load_dwordx4 v[40:43], v2, s[4:7], s14 offen offset:2048
  buffer_load_dwordx4 v[44:47], v2, s[4:7], s14 offen offset:3072
  s_add_u32 s14, s14, 4096
  buffer_load_dwordx4 v[48:51], v2, s[4:7], s14 offen offset:0
  buffer_load_dwordx4 v[52:55], v2, s[4:7], s14 offen offset:1024
  buffer_load_dwordx4 v[56:59], v2, s[4:7], s14 offen offset:2048
  buffer_load_dwordx4 v[60:63], v2, s[4:7], s14 offen offset:3072
  s_add_u32 s14, s14, 4096
  buffer_load_dwordx4 v[64:67], v2, s[4:7], s14 offen offset:0
  buffer_load_dwordx4 v[68:71], v2, s[4:7], s14 offen offset:1024
  buffer_load_dwordx4 v[72:75], v2, s[4:7], s14 offen offset:2048
  buffer_load_dwordx4 v[76:79], v2, s[4:7], s14 offen offset:3072
  s_add_u32 s14, s14, 4096
  buffer_load_dwordx4 v[80:83], v2, s[4:7], s14 offen offset:0
  buffer_load_dwordx4 v[84:87], v2, s[4:7], s14 offen offset:1024
  buffer_load_dwordx4 v[88:91], v2, s[4:7], s14 offen offset:2048
  buffer_load_dwordx4 v[92:95], v2, s[4:7], s14 offen offset:3072
  s_waitcnt vmcnt(0)
  s_mov_b32 s30, 0xffff0000
  v_lshlrev_b32 v96, 16, v16
  v_and_b32 v97, s30, v16
  v_lshlrev_b32 v98, 16, v17
  v_and_b32 v99, s30, v17
  v_pk_add_f32 v[8:9], v[96:97], v[98:99]
  v_lshlrev_b32 v100, 16, v18
  v_and_b32 v101, s30, v18
  v_pk_add_f32 v[8:9], v[8:9], v[100:101]
  v_lshlrev_b32 v102, 16, v19
  v_and_b32 v103, s30, v19
  v_pk_add_f32 v[8:9], v[8:9], v[102:103]
  v_lshlrev_b32 v104, 16, v20
  v_and_b32 v105, s30, v20
  v_pk_add_f32 v[8:9], v[8:9], v[104:105]
  v_lshlrev_b32 v106, 16, v21
  v_and_b32 v107, s30, v21
  v_pk_add_f32 v[8:9], v[8:9], v[106:107]
  v_lshlrev_b32 v108, 16, v22
  v_and_b32 v109, s30, v22
  v_pk_add_f32 v[8:9], v[8:9], v[108:109]
  v_lshlrev_b32 v110, 16, v23
  v_and_b32 v111, s30, v23
  v_pk_add_f32 v[8:9], v[8:9], v[110:111]
  v_lshlrev_b32 v112, 16, v24
  v_and_b32 v113, s30, v24
  v_pk_add_f32 v[8:9], v[8:9], v[112:113]
  v_lshlrev_b32 v114, 16, v25
  v_and_b32 v115, s30, v25
  v_pk_add_f32 v[8:9], v[8:9], v[114:115]
  v_lshlrev_b32 v116, 16, v26
  v_and_b32 v117, s30, v26
  v_pk_add_f32 v[8:9], v[8:9], v[116:117]
  v_lshlrev_b32 v118, 16, v27
  v_and_b32 v119, s30, v27
  v_pk_add_f32 v[8:9], v[8:9], v[118:119]
  v_lshlrev_b32 v120, 16, v28
  v_and_b32 v121, s30, v28
  v_pk_add_f32 v[8:9], v[8:9], v[120:121]
  v_lshlrev_b32 v122, 16, v29
  v_and_b32 v123, s30, v29
  v_pk_add_f32 v[8:9], v[8:9], v[122:123]
  v_lshlrev_b32 v124, 16, v30
  v_and_b32 v125, s30, v30
  v_pk_add_f32 v[8:9], v[8:9], v[124:125]
  v_lshlrev_b32 v126, 16, v31
  v_and_b32 v127, s30, v31
  v_pk_add_f32 v[8:9], v[8:9], v[126:127]
  v_lshlrev_b32 v128, 16, v32
  v_and_b32 v129, s30, v32
  v_pk_add_f32 v[8:9], v[8:9], v[128:129]
  v_lshlrev_b32 v130, 16, v33
  v_and_b32 v131, s30, v33
  v_pk_add_f32 v[8:9], v[8:9], v[130:131]
  v_lshlrev_b32 v132, 16, v34
  v_and_b32 v133, s30, v34
  v_pk_add_f32 v[8:9], v[8:9], v[132:133]
  v_lshlrev_b32 v134, 16, v35
  v_and_b32 v135, s30, v35
  v_pk_add_f32 v[8:9], v[8:9], v[134:135]
  v_lshlrev_b32 v136, 16, v36
  v_and_b32 v137, s30, v36
  v_pk_add_f32 v[8:9], v[8:9], v[136:137]
  v_lshlrev_b32 v138, 16, v37
  v_and_b32 v139, s30, v37
  v_pk_add_f32 v[8:9], v[8:9], v[138:139]
  v_lshlrev_b32 v140, 16, v38
  v_and_b32 v141, s30, v38
  v_pk_add_f32 v[8:9], v[8:9], v[140:141]
  v_lshlrev_b32 v142, 16, v39
  v_and_b32 v143, s30, v39
  v_pk_add_f32 v[8:9], v[8:9], v[142:143]
  v_lshlrev_b32 v144, 16, v40
  v_and_b32 v145, s30, v40
  v_pk_add_f32 v[8:9], v[8:9], v[144:145]
  v_lshlrev_b32 v146, 16, v41
  v_and_b32 v147, s30, v41
  v_pk_add_f32 v[8:9], v[8:9], v[146:147]
  v_lshlrev_b32 v148, 16, v42
  v_and_b32 v149, s30, v42
  v_pk_add_f32 v[8:9], v[8:9], v[148:149]
  v_lshlrev_b32 v150, 16, v43
  v_and_b32 v151, s30, v43
  v_pk_add_f32 v[8:9], v[8:9], v[150:151]
  v_lshlrev_b32 v152, 16, v44
  v_and_b32 v153, s30, v44
  v_pk_add_f32 v[8:9], v[8:9], v[152:153]
  v_lshlrev_b32 v154, 16, v45
  v_and_b32 v155, s30, v45
  v_pk_add_f32 v[8:9], v[8:9], v[154:155]
  v_lshlrev_b32 v156, 16, v46
  v_and_b32 v157, s30, v46
  v_pk_add_f32 v[8:9], v[8:9], v[156:157]
  v_lshlrev_b32 v158, 16, v47
  v_and_b32 v159, s30, v47
  v_pk_add_f32 v[8:9], v[8:9], v[158:159]
  v_lshlrev_b32 v160, 16, v48
  v_and_b32 v161, s30, v48
  v_pk_add_f32 v[8:9], v[8:9], v[160:161]
  v_lshlrev_b32 v162, 16, v49
  v_and_b32 v163, s30, v49
  v_pk_add_f32 v[8:9], v[8:9], v[162:163]
  v_lshlrev_b32 v164, 16, v50
  v_and_b32 v165, s30, v50
  v_pk_add_f32 v[8:9], v[8:9], v[164:165]
  v_lshlrev_b32 v166, 16, v51
  v_and_b32 v167, s30, v51
  v_pk_add_f32 v[8:9], v[8:9], v[166:167]
  v_lshlrev_b32 v168, 16, v52
  v_and_b32 v169, s30, v52
  v_pk_add_f32 v[8:9], v[8:9], v[168:169]
  v_lshlrev_b32 v170, 16, v53
  v_and_b32 v171, s30, v53
  v_pk_add_f32 v[8:9], v[8:9], v[170:171]
  v_lshlrev_b32 v172, 16, v54
  v_and_b32 v173, s30, v54
  v_pk_add_f32 v[8:9], v[8:9], v[172:173]
  v_lshlrev_b32 v174, 16, v55
  v_and_b32 v175, s30, v55
  v_pk_add_f32 v[8:9], v[8:9], v[174:175]
  v_lshlrev_b32 v176, 16, v56
  v_and_b32 v177, s30, v56
  v_pk_add_f32 v[8:9], v[8:9], v[176:177]
  v_lshlrev_b32 v178, 16, v57
  v_and_b32 v179, s30, v57
  v_pk_add_f32 v[8:9], v[8:9], v[178:179]
  v_lshlrev_b32 v180, 16, v58
  v_and_b32 v181, s30, v58
  v_pk_add_f32 v[8:9], v[8:9], v[180:181]
  v_lshlrev_b32 v182, 16, v59
  v_and_b32 v183, s30, v59
  v_pk_add_f32 v[8:9], v[8:9], v[182:183]
  v_lshlrev_b32 v184, 16, v60
  v_and_b32 v185, s30, v60
  v_pk_add_f32 v[8:9], v[8:9], v[184:185]
  v_lshlrev_b32 v186, 16, v61
  v_and_b32 v187, s30, v61
  v_pk_add_f32 v[8:9], v[8:9], v[186:187]
  v_lshlrev_b32 v188, 16, v62
  v_and_b32 v189, s30, v62
  v_pk_add_f32 v[8:9], v[8:9], v[188:189]
  v_lshlrev_b32 v190, 16, v63
  v_and_b32 v191, s30, v63
  v_pk_add_f32 v[8:9], v[8:9], v[190:191]
  v_lshlrev_b32 v192, 16, v64
  v_and_b32 v193, s30, v64
  v_pk_add_f32 v[8:9], v[8:9], v[192:193]
  v_lshlrev_b32 v194, 16, v65
  v_and_b32 v195, s30, v65
  v_pk_add_f32 v[8:9], v[8:9], v[194:195]
  v_lshlrev_b32 v196, 16, v66
  v_and_b32 v197, s30, v66
  v_pk_add_f32 v[8:9], v[8:9], v[196:197]
  v_lshlrev_b32 v198, 16, v67
  v_and_b32 v199, s30, v67
  v_pk_add_f32 v[8:9], v[8:9], v[198:199]
  v_lshlrev_b32 v200, 16, v68
  v_and_b32 v201, s30, v68
  v_pk_add_f32 v[8:9], v[8:9], v[200:201]
  v_lshlrev_b32 v202, 16, v69
  v_and_b32 v203, s30, v69
  v_pk_add_f32 v[8:9], v[8:9], v[202:203]
  v_lshlrev_b32 v204, 16, v70
  v_and_b32 v205, s30, v70
  v_pk_add_f32 v[8:9], v[8:9], v[204:205]
  v_lshlrev_b32 v206, 16, v71
  v_and_b32 v207, s30, v71
  v_pk_add_f32 v[8:9], v[8:9], v[206:207]
  v_lshlrev_b32 v208, 16, v72
  v_and_b32 v209, s30, v72
  v_pk_add_f32 v[8:9], v[8:9], v[208:209]
  v_lshlrev_b32 v210, 16, v73
  v_and_b32 v211, s30, v73
  v_pk_add_f32 v[8:9], v[8:9], v[210:211]
  v_lshlrev_b32 v212, 16, v74
  v_and_b32 v213, s30, v74
  v_pk_add_f32 v[8:9], v[8:9], v[212:213]
  v_lshlrev_b32 v214, 16, v75
  v_and_b32 v215, s30, v75
  v_pk_add_f32 v[8:9], v[8:9], v[214:215]
  v_lshlrev_b32 v216, 16, v76
  v_and_b32 v217, s30, v76
  v_pk_add_f32 v[8:9], v[8:9], v[216:217]
  v_lshlrev_b32 v218, 16, v77
  v_and_b32 v219, s30, v77
  v_pk_add_f32 v[8:9], v[8:9], v[218:219]
  v_lshlrev_b32 v220, 16, v78
  v_and_b32 v221, s30, v78
  v_pk_add_f32 v[8:9], v[8:9], v[220:221]
  v_lshlrev_b32 v222, 16, v79
  v_and_b32 v223, s30, v79
  v_pk_add_f32 v[8:9], v[8:9], v[222:223]
  v_lshlrev_b32 v224, 16, v80
  v_and_b32 v225, s30, v80
  v_pk_add_f32 v[8:9], v[8:9], v[224:225]
  v_lshlrev_b32 v226, 16, v81
  v_and_b32 v227, s30, v81
  v_pk_add_f32 v[8:9], v[8:9], v[226:227]
  v_lshlrev_b32 v228, 16, v82
  v_and_b32 v229, s30, v82
  v_pk_add_f32 v[8:9], v[8:9], v[228:229]
  v_lshlrev_b32 v230, 16, v83
  v_and_b32 v231, s30, v83
  v_pk_add_f32 v[8:9], v[8:9], v[230:231]
  v_lshlrev_b32 v232, 16, v84
  v_and_b32 v233, s30, v84
  v_pk_add_f32 v[8:9], v[8:9], v[232:233]
  v_lshlrev_b32 v234, 16, v85
  v_and_b32 v235, s30, v85
  v_pk_add_f32 v[8:9], v[8:9], v[234:235]
  v_lshlrev_b32 v236, 16, v86
  v_and_b32 v237, s30, v86
  v_pk_add_f32 v[8:9], v[8:9], v[236:237]
  v_lshlrev_b32 v238, 16, v87
  v_and_b32 v239, s30, v87
  v_pk_add_f32 v[8:9], v[8:9], v[238:239]
  v_lshlrev_b32 v240, 16, v88
  v_and_b32 v241, s30, v88
  v_pk_add_f32 v[8:9], v[8:9], v[240:241]
  v_lshlrev_b32 v242, 16, v89
  v_and_b32 v243, s30, v89
  v_pk_add_f32 v[8:9], v[8:9], v[242:243]
  v_lshlrev_b32 v244, 16, v90
  v_and_b32 v245, s30, v90
  v_pk_add_f32 v[8:9], v[8:9], v[244:245]
  v_lshlrev_b32 v246, 16, v91
  v_and_b32 v247, s30, v91
  v_pk_add_f32 v[8:9], v[8:9], v[246:247]
  v_lshlrev_b32 v248, 16, v92
  v_and_b32 v249, s30, v92
  v_pk_add_f32 v[8:9], v[8:9], v[248:249]
  v_lshlrev_b32 v250, 16, v93
  v_and_b32 v251, s30, v93
  v_pk_add_f32 v[8:9], v[8:9], v[250:251]
  v_lshlrev_b32 v252, 16, v94
  v_and_b32 v253, s30, v94
  v_pk_add_f32 v[8:9], v[8:9], v[252:253]
  v_lshlrev_b32 v254, 16, v95
  v_and_b32 v255, s30, v95
  v_pk_add_f32 v[8:9], v[8:9], v[254:255]
  v_add_f32 v8, v8, v9
  v_mov_b32 v9, v8
  s_nop 1
  v_permlane16_swap_b32 v8, v9
  v_add_f32 v8, v8, v9
  v_mov_b32 v9, v8
  s_nop 1
  v_permlane32_swap_b32 v8, v9
  v_add_f32 v8, v8, v9
  v_mul_f32 v8, 0xbacccccd, v8
  v_mov_b32 v9, v8
  v_pk_add_f32 v[96:97], v[96:97], v[8:9]
  v_pk_mul_f32 v[10:11], v[96:97], v[96:97]
  v_pk_add_f32 v[98:99], v[98:99], v[8:9]
  v_pk_fma_f32 v[10:11], v[98:99], v[98:99], v[10:11]
  v_pk_add_f32 v[100:101], v[100:101], v[8:9]
  v_pk_fma_f32 v[10:11], v[100:101], v[100:101], v[10:11]
  v_pk_add_f32 v[102:103], v[102:103], v[8:9]
  v_pk_fma_f32 v[10:11], v[102:103], v[102:103], v[10:11]
  v_pk_add_f32 v[104:105], v[104:105], v[8:9]
  v_pk_fma_f32 v[10:11], v[104:105], v[104:105], v[10:11]
  v_pk_add_f32 v[106:107], v[106:107], v[8:9]
  v_pk_fma_f32 v[10:11], v[106:107], v[106:107], v[10:11]
  v_pk_add_f32 v[108:109], v[108:109], v[8:9]
  v_pk_fma_f32 v[10:11], v[108:109], v[108:109], v[10:11]
  v_pk_add_f32 v[110:111], v[110:111], v[8:9]
  v_pk_fma_f32 v[10:11], v[110:111], v[110:111], v[10:11]
  v_pk_add_f32 v[112:113], v[112:113], v[8:9]
  v_pk_fma_f32 v[10:11], v[112:113], v[112:113], v[10:11]
  v_pk_add_f32 v[114:115], v[114:115], v[8:9]
  v_pk_fma_f32 v[10:11], v[114:115], v[114:115], v[10:11]
  v_pk_add_f32 v[116:117], v[116:117], v[8:9]
  v_pk_fma_f32 v[10:11], v[116:117], v[116:117], v[10:11]
  v_pk_add_f32 v[118:119], v[118:119], v[8:9]
  v_pk_fma_f32 v[10:11], v[118:119], v[118:119], v[10:11]
  v_pk_add_f32 v[120:121], v[120:121], v[8:9]
  v_pk_fma_f32 v[10:11], v[120:121], v[120:121], v[10:11]
  v_pk_add_f32 v[122:123], v[122:123], v[8:9]
  v_pk_fma_f32 v[10:11], v[122:123], v[122:123], v[10:11]
  v_pk_add_f32 v[124:125], v[124:125], v[8:9]
  v_pk_fma_f32 v[10:11], v[124:125], v[124:125], v[10:11]
  v_pk_add_f32 v[126:127], v[126:127], v[8:9]
  v_pk_fma_f32 v[10:11], v[126:127], v[126:127], v[10:11]
  v_pk_add_f32 v[128:129], v[128:129], v[8:9]
  v_pk_fma_f32 v[10:11], v[128:129], v[128:129], v[10:11]
  v_pk_add_f32 v[130:131], v[130:131], v[8:9]
  v_pk_fma_f32 v[10:11], v[130:131], v[130:131], v[10:11]
  v_pk_add_f32 v[132:133], v[132:133], v[8:9]
  v_pk_fma_f32 v[10:11], v[132:133], v[132:133], v[10:11]
  v_pk_add_f32 v[134:135], v[134:135], v[8:9]
  v_pk_fma_f32 v[10:11], v[134:135], v[134:135], v[10:11]
  v_pk_add_f32 v[136:137], v[136:137], v[8:9]
  v_pk_fma_f32 v[10:11], v[136:137], v[136:137], v[10:11]
  v_pk_add_f32 v[138:139], v[138:139], v[8:9]
  v_pk_fma_f32 v[10:11], v[138:139], v[138:139], v[10:11]
  v_pk_add_f32 v[140:141], v[140:141], v[8:9]
  v_pk_fma_f32 v[10:11], v[140:141], v[140:141], v[10:11]
  v_pk_add_f32 v[142:143], v[142:143], v[8:9]
  v_pk_fma_f32 v[10:11], v[142:143], v[142:143], v[10:11]
  v_pk_add_f32 v[144:145], v[144:145], v[8:9]
  v_pk_fma_f32 v[10:11], v[144:145], v[144:145], v[10:11]
  v_pk_add_f32 v[146:147], v[146:147], v[8:9]
  v_pk_fma_f32 v[10:11], v[146:147], v[146:147], v[10:11]
  v_pk_add_f32 v[148:149], v[148:149], v[8:9]
  v_pk_fma_f32 v[10:11], v[148:149], v[148:149], v[10:11]
  v_pk_add_f32 v[150:151], v[150:151], v[8:9]
  v_pk_fma_f32 v[10:11], v[150:151], v[150:151], v[10:11]
  v_pk_add_f32 v[152:153], v[152:153], v[8:9]
  v_pk_fma_f32 v[10:11], v[152:153], v[152:153], v[10:11]
  v_pk_add_f32 v[154:155], v[154:155], v[8:9]
  v_pk_fma_f32 v[10:11], v[154:155], v[154:155], v[10:11]
  v_pk_add_f32 v[156:157], v[156:157], v[8:9]
  v_pk_fma_f32 v[10:11], v[156:157], v[156:157], v[10:11]
  v_pk_add_f32 v[158:159], v[158:159], v[8:9]
  v_pk_fma_f32 v[10:11], v[158:159], v[158:159], v[10:11]
  v_pk_add_f32 v[160:161], v[160:161], v[8:9]
  v_pk_fma_f32 v[10:11], v[160:161], v[160:161], v[10:11]
  v_pk_add_f32 v[162:163], v[162:163], v[8:9]
  v_pk_fma_f32 v[10:11], v[162:163], v[162:163], v[10:11]
  v_pk_add_f32 v[164:165], v[164:165], v[8:9]
  v_pk_fma_f32 v[10:11], v[164:165], v[164:165], v[10:11]
  v_pk_add_f32 v[166:167], v[166:167], v[8:9]
  v_pk_fma_f32 v[10:11], v[166:167], v[166:167], v[10:11]
  v_pk_add_f32 v[168:169], v[168:169], v[8:9]
  v_pk_fma_f32 v[10:11], v[168:169], v[168:169], v[10:11]
  v_pk_add_f32 v[170:171], v[170:171], v[8:9]
  v_pk_fma_f32 v[10:11], v[170:171], v[170:171], v[10:11]
  v_pk_add_f32 v[172:173], v[172:173], v[8:9]
  v_pk_fma_f32 v[10:11], v[172:173], v[172:173], v[10:11]
  v_pk_add_f32 v[174:175], v[174:175], v[8:9]
  v_pk_fma_f32 v[10:11], v[174:175], v[174:175], v[10:11]
  v_pk_add_f32 v[176:177], v[176:177], v[8:9]
  v_pk_fma_f32 v[10:11], v[176:177], v[176:177], v[10:11]
  v_pk_add_f32 v[178:179], v[178:179], v[8:9]
  v_pk_fma_f32 v[10:11], v[178:179], v[178:179], v[10:11]
  v_pk_add_f32 v[180:181], v[180:181], v[8:9]
  v_pk_fma_f32 v[10:11], v[180:181], v[180:181], v[10:11]
  v_pk_add_f32 v[182:183], v[182:183], v[8:9]
  v_pk_fma_f32 v[10:11], v[182:183], v[182:183], v[10:11]
  v_pk_add_f32 v[184:185], v[184:185], v[8:9]
  v_pk_fma_f32 v[10:11], v[184:185], v[184:185], v[10:11]
  v_pk_add_f32 v[186:187], v[186:187], v[8:9]
  v_pk_fma_f32 v[10:11], v[186:187], v[186:187], v[10:11]
  v_pk_add_f32 v[188:189], v[188:189], v[8:9]
  v_pk_fma_f32 v[10:11], v[188:189], v[188:189], v[10:11]
  v_pk_add_f32 v[190:191], v[190:191], v[8:9]
  v_pk_fma_f32 v[10:11], v[190:191], v[190:191], v[10:11]
  v_pk_add_f32 v[192:193], v[192:193], v[8:9]
  v_pk_fma_f32 v[10:11], v[192:193], v[192:193], v[10:11]
  v_pk_add_f32 v[194:195], v[194:195], v[8:9]
  v_pk_fma_f32 v[10:11], v[194:195], v[194:195], v[10:11]
  v_pk_add_f32 v[196:197], v[196:197], v[8:9]
  v_pk_fma_f32 v[10:11], v[196:197], v[196:197], v[10:11]
  v_pk_add_f32 v[198:199], v[198:199], v[8:9]
  v_pk_fma_f32 v[10:11], v[198:199], v[198:199], v[10:11]
  v_pk_add_f32 v[200:201], v[200:201], v[8:9]
  v_pk_fma_f32 v[10:11], v[200:201], v[200:201], v[10:11]
  v_pk_add_f32 v[202:203], v[202:203], v[8:9]
  v_pk_fma_f32 v[10:11], v[202:203], v[202:203], v[10:11]
  v_pk_add_f32 v[204:205], v[204:205], v[8:9]
  v_pk_fma_f32 v[10:11], v[204:205], v[204:205], v[10:11]
  v_pk_add_f32 v[206:207], v[206:207], v[8:9]
  v_pk_fma_f32 v[10:11], v[206:207], v[206:207], v[10:11]
  v_pk_add_f32 v[208:209], v[208:209], v[8:9]
  v_pk_fma_f32 v[10:11], v[208:209], v[208:209], v[10:11]
  v_pk_add_f32 v[210:211], v[210:211], v[8:9]
  v_pk_fma_f32 v[10:11], v[210:211], v[210:211], v[10:11]
  v_pk_add_f32 v[212:213], v[212:213], v[8:9]
  v_pk_fma_f32 v[10:11], v[212:213], v[212:213], v[10:11]
  v_pk_add_f32 v[214:215], v[214:215], v[8:9]
  v_pk_fma_f32 v[10:11], v[214:215], v[214:215], v[10:11]
  v_pk_add_f32 v[216:217], v[216:217], v[8:9]
  v_pk_fma_f32 v[10:11], v[216:217], v[216:217], v[10:11]
  v_pk_add_f32 v[218:219], v[218:219], v[8:9]
  v_pk_fma_f32 v[10:11], v[218:219], v[218:219], v[10:11]
  v_pk_add_f32 v[220:221], v[220:221], v[8:9]
  v_pk_fma_f32 v[10:11], v[220:221], v[220:221], v[10:11]
  v_pk_add_f32 v[222:223], v[222:223], v[8:9]
  v_pk_fma_f32 v[10:11], v[222:223], v[222:223], v[10:11]
  v_pk_add_f32 v[224:225], v[224:225], v[8:9]
  v_pk_fma_f32 v[10:11], v[224:225], v[224:225], v[10:11]
  v_pk_add_f32 v[226:227], v[226:227], v[8:9]
  v_pk_fma_f32 v[10:11], v[226:227], v[226:227], v[10:11]
  v_pk_add_f32 v[228:229], v[228:229], v[8:9]
  v_pk_fma_f32 v[10:11], v[228:229], v[228:229], v[10:11]
  v_pk_add_f32 v[230:231], v[230:231], v[8:9]
  v_pk_fma_f32 v[10:11], v[230:231], v[230:231], v[10:11]
  v_pk_add_f32 v[232:233], v[232:233], v[8:9]
  v_pk_fma_f32 v[10:11], v[232:233], v[232:233], v[10:11]
  v_pk_add_f32 v[234:235], v[234:235], v[8:9]
  v_pk_fma_f32 v[10:11], v[234:235], v[234:235], v[10:11]
  v_pk_add_f32 v[236:237], v[236:237], v[8:9]
  v_pk_fma_f32 v[10:11], v[236:237], v[236:237], v[10:11]
  v_pk_add_f32 v[238:239], v[238:239], v[8:9]
  v_pk_fma_f32 v[10:11], v[238:239], v[238:239], v[10:11]
  v_pk_add_f32 v[240:241], v[240:241], v[8:9]
  v_pk_fma_f32 v[10:11], v[240:241], v[240:241], v[10:11]
  v_pk_add_f32 v[242:243], v[242:243], v[8:9]
  v_pk_fma_f32 v[10:11], v[242:243], v[242:243], v[10:11]
  v_pk_add_f32 v[244:245], v[244:245], v[8:9]
  v_pk_fma_f32 v[10:11], v[244:245], v[244:245], v[10:11]
  v_pk_add_f32 v[246:247], v[246:247], v[8:9]
  v_pk_fma_f32 v[10:11], v[246:247], v[246:247], v[10:11]
  v_pk_add_f32 v[248:249], v[248:249], v[8:9]
  v_pk_fma_f32 v[10:11], v[248:249], v[248:249], v[10:11]
  v_pk_add_f32 v[250:251], v[250:251], v[8:9]
  v_pk_fma_f32 v[10:11], v[250:251], v[250:251], v[10:11]
  v_pk_add_f32 v[252:253], v[252:253], v[8:9]
  v_pk_fma_f32 v[10:11], v[252:253], v[252:253], v[10:11]
  v_pk_add_f32 v[254:255], v[254:255], v[8:9]
  v_pk_fma_f32 v[10:11], v[254:255], v[254:255], v[10:11]
  v_add_f32 v10, v10, v11
  v_mov_b32 v11, v10
  s_nop 1
  v_permlane16_swap_b32 v10, v11
  v_add_f32 v10, v10, v11
  v_mov_b32 v11, v10
  s_nop 1
  v_permlane32_swap_b32 v10, v11
  v_add_f32 v10, v10, v11
  v_mov_b32 v8, 0x3727c5ac
  v_fmac_f32 v8, 0x3acccccd, v10
  v_rsq_f32 v8, v8
  s_nop 0
  v_mov_b32 v9, v8
  v_pk_mul_f32 v[96:97], v[96:97], v[8:9]
  v_cvt_pk_bf16_f32 v16, v96, v97
  v_pk_mul_f32 v[98:99], v[98:99], v[8:9]
  v_cvt_pk_bf16_f32 v17, v98, v99
  v_pk_mul_f32 v[100:101], v[100:101], v[8:9]
  v_cvt_pk_bf16_f32 v18, v100, v101
  v_pk_mul_f32 v[102:103], v[102:103], v[8:9]
  v_cvt_pk_bf16_f32 v19, v102, v103
  v_pk_mul_f32 v[104:105], v[104:105], v[8:9]
  v_cvt_pk_bf16_f32 v20, v104, v105
  v_pk_mul_f32 v[106:107], v[106:107], v[8:9]
  v_cvt_pk_bf16_f32 v21, v106, v107
  v_pk_mul_f32 v[108:109], v[108:109], v[8:9]
  v_cvt_pk_bf16_f32 v22, v108, v109
  v_pk_mul_f32 v[110:111], v[110:111], v[8:9]
  v_cvt_pk_bf16_f32 v23, v110, v111
  v_pk_mul_f32 v[112:113], v[112:113], v[8:9]
  v_cvt_pk_bf16_f32 v24, v112, v113
  v_pk_mul_f32 v[114:115], v[114:115], v[8:9]
  v_cvt_pk_bf16_f32 v25, v114, v115
  v_pk_mul_f32 v[116:117], v[116:117], v[8:9]
  v_cvt_pk_bf16_f32 v26, v116, v117
  v_pk_mul_f32 v[118:119], v[118:119], v[8:9]
  v_cvt_pk_bf16_f32 v27, v118, v119
  v_pk_mul_f32 v[120:121], v[120:121], v[8:9]
  v_cvt_pk_bf16_f32 v28, v120, v121
  v_pk_mul_f32 v[122:123], v[122:123], v[8:9]
  v_cvt_pk_bf16_f32 v29, v122, v123
  v_pk_mul_f32 v[124:125], v[124:125], v[8:9]
  v_cvt_pk_bf16_f32 v30, v124, v125
  v_pk_mul_f32 v[126:127], v[126:127], v[8:9]
  v_cvt_pk_bf16_f32 v31, v126, v127
  v_pk_mul_f32 v[128:129], v[128:129], v[8:9]
  v_cvt_pk_bf16_f32 v32, v128, v129
  v_pk_mul_f32 v[130:131], v[130:131], v[8:9]
  v_cvt_pk_bf16_f32 v33, v130, v131
  v_pk_mul_f32 v[132:133], v[132:133], v[8:9]
  v_cvt_pk_bf16_f32 v34, v132, v133
  v_pk_mul_f32 v[134:135], v[134:135], v[8:9]
  v_cvt_pk_bf16_f32 v35, v134, v135
  v_pk_mul_f32 v[136:137], v[136:137], v[8:9]
  v_cvt_pk_bf16_f32 v36, v136, v137
  v_pk_mul_f32 v[138:139], v[138:139], v[8:9]
  v_cvt_pk_bf16_f32 v37, v138, v139
  v_pk_mul_f32 v[140:141], v[140:141], v[8:9]
  v_cvt_pk_bf16_f32 v38, v140, v141
  v_pk_mul_f32 v[142:143], v[142:143], v[8:9]
  v_cvt_pk_bf16_f32 v39, v142, v143
  v_pk_mul_f32 v[144:145], v[144:145], v[8:9]
  v_cvt_pk_bf16_f32 v40, v144, v145
  v_pk_mul_f32 v[146:147], v[146:147], v[8:9]
  v_cvt_pk_bf16_f32 v41, v146, v147
  v_pk_mul_f32 v[148:149], v[148:149], v[8:9]
  v_cvt_pk_bf16_f32 v42, v148, v149
  v_pk_mul_f32 v[150:151], v[150:151], v[8:9]
  v_cvt_pk_bf16_f32 v43, v150, v151
  v_pk_mul_f32 v[152:153], v[152:153], v[8:9]
  v_cvt_pk_bf16_f32 v44, v152, v153
  v_pk_mul_f32 v[154:155], v[154:155], v[8:9]
  v_cvt_pk_bf16_f32 v45, v154, v155
  v_pk_mul_f32 v[156:157], v[156:157], v[8:9]
  v_cvt_pk_bf16_f32 v46, v156, v157
  v_pk_mul_f32 v[158:159], v[158:159], v[8:9]
  v_cvt_pk_bf16_f32 v47, v158, v159
  v_pk_mul_f32 v[160:161], v[160:161], v[8:9]
  v_cvt_pk_bf16_f32 v48, v160, v161
  v_pk_mul_f32 v[162:163], v[162:163], v[8:9]
  v_cvt_pk_bf16_f32 v49, v162, v163
  v_pk_mul_f32 v[164:165], v[164:165], v[8:9]
  v_cvt_pk_bf16_f32 v50, v164, v165
  v_pk_mul_f32 v[166:167], v[166:167], v[8:9]
  v_cvt_pk_bf16_f32 v51, v166, v167
  v_pk_mul_f32 v[168:169], v[168:169], v[8:9]
  v_cvt_pk_bf16_f32 v52, v168, v169
  v_pk_mul_f32 v[170:171], v[170:171], v[8:9]
  v_cvt_pk_bf16_f32 v53, v170, v171
  v_pk_mul_f32 v[172:173], v[172:173], v[8:9]
  v_cvt_pk_bf16_f32 v54, v172, v173
  v_pk_mul_f32 v[174:175], v[174:175], v[8:9]
  v_cvt_pk_bf16_f32 v55, v174, v175
  v_pk_mul_f32 v[176:177], v[176:177], v[8:9]
  v_cvt_pk_bf16_f32 v56, v176, v177
  v_pk_mul_f32 v[178:179], v[178:179], v[8:9]
  v_cvt_pk_bf16_f32 v57, v178, v179
  v_pk_mul_f32 v[180:181], v[180:181], v[8:9]
  v_cvt_pk_bf16_f32 v58, v180, v181
  v_pk_mul_f32 v[182:183], v[182:183], v[8:9]
  v_cvt_pk_bf16_f32 v59, v182, v183
  v_pk_mul_f32 v[184:185], v[184:185], v[8:9]
  v_cvt_pk_bf16_f32 v60, v184, v185
  v_pk_mul_f32 v[186:187], v[186:187], v[8:9]
  v_cvt_pk_bf16_f32 v61, v186, v187
  v_pk_mul_f32 v[188:189], v[188:189], v[8:9]
  v_cvt_pk_bf16_f32 v62, v188, v189
  v_pk_mul_f32 v[190:191], v[190:191], v[8:9]
  v_cvt_pk_bf16_f32 v63, v190, v191
  v_pk_mul_f32 v[192:193], v[192:193], v[8:9]
  v_cvt_pk_bf16_f32 v64, v192, v193
  v_pk_mul_f32 v[194:195], v[194:195], v[8:9]
  v_cvt_pk_bf16_f32 v65, v194, v195
  v_pk_mul_f32 v[196:197], v[196:197], v[8:9]
  v_cvt_pk_bf16_f32 v66, v196, v197
  v_pk_mul_f32 v[198:199], v[198:199], v[8:9]
  v_cvt_pk_bf16_f32 v67, v198, v199
  v_pk_mul_f32 v[200:201], v[200:201], v[8:9]
  v_cvt_pk_bf16_f32 v68, v200, v201
  v_pk_mul_f32 v[202:203], v[202:203], v[8:9]
  v_cvt_pk_bf16_f32 v69, v202, v203
  v_pk_mul_f32 v[204:205], v[204:205], v[8:9]
  v_cvt_pk_bf16_f32 v70, v204, v205
  v_pk_mul_f32 v[206:207], v[206:207], v[8:9]
  v_cvt_pk_bf16_f32 v71, v206, v207
  v_pk_mul_f32 v[208:209], v[208:209], v[8:9]
  v_cvt_pk_bf16_f32 v72, v208, v209
  v_pk_mul_f32 v[210:211], v[210:211], v[8:9]
  v_cvt_pk_bf16_f32 v73, v210, v211
  v_pk_mul_f32 v[212:213], v[212:213], v[8:9]
  v_cvt_pk_bf16_f32 v74, v212, v213
  v_pk_mul_f32 v[214:215], v[214:215], v[8:9]
  v_cvt_pk_bf16_f32 v75, v214, v215
  v_pk_mul_f32 v[216:217], v[216:217], v[8:9]
  v_cvt_pk_bf16_f32 v76, v216, v217
  v_pk_mul_f32 v[218:219], v[218:219], v[8:9]
  v_cvt_pk_bf16_f32 v77, v218, v219
  v_pk_mul_f32 v[220:221], v[220:221], v[8:9]
  v_cvt_pk_bf16_f32 v78, v220, v221
  v_pk_mul_f32 v[222:223], v[222:223], v[8:9]
  v_cvt_pk_bf16_f32 v79, v222, v223
  v_pk_mul_f32 v[224:225], v[224:225], v[8:9]
  v_cvt_pk_bf16_f32 v80, v224, v225
  v_pk_mul_f32 v[226:227], v[226:227], v[8:9]
  v_cvt_pk_bf16_f32 v81, v226, v227
  v_pk_mul_f32 v[228:229], v[228:229], v[8:9]
  v_cvt_pk_bf16_f32 v82, v228, v229
  v_pk_mul_f32 v[230:231], v[230:231], v[8:9]
  v_cvt_pk_bf16_f32 v83, v230, v231
  v_pk_mul_f32 v[232:233], v[232:233], v[8:9]
  v_cvt_pk_bf16_f32 v84, v232, v233
  v_pk_mul_f32 v[234:235], v[234:235], v[8:9]
  v_cvt_pk_bf16_f32 v85, v234, v235
  v_pk_mul_f32 v[236:237], v[236:237], v[8:9]
  v_cvt_pk_bf16_f32 v86, v236, v237
  v_pk_mul_f32 v[238:239], v[238:239], v[8:9]
  v_cvt_pk_bf16_f32 v87, v238, v239
  v_pk_mul_f32 v[240:241], v[240:241], v[8:9]
  v_cvt_pk_bf16_f32 v88, v240, v241
  v_pk_mul_f32 v[242:243], v[242:243], v[8:9]
  v_cvt_pk_bf16_f32 v89, v242, v243
  v_pk_mul_f32 v[244:245], v[244:245], v[8:9]
  v_cvt_pk_bf16_f32 v90, v244, v245
  v_pk_mul_f32 v[246:247], v[246:247], v[8:9]
  v_cvt_pk_bf16_f32 v91, v246, v247
  v_pk_mul_f32 v[248:249], v[248:249], v[8:9]
  v_cvt_pk_bf16_f32 v92, v248, v249
  v_pk_mul_f32 v[250:251], v[250:251], v[8:9]
  v_cvt_pk_bf16_f32 v93, v250, v251
  v_pk_mul_f32 v[252:253], v[252:253], v[8:9]
  v_cvt_pk_bf16_f32 v94, v252, v253
  v_pk_mul_f32 v[254:255], v[254:255], v[8:9]
  v_cvt_pk_bf16_f32 v95, v254, v255
  s_barrier
  ds_read_b128 v[96:99], v2 offset:0
  ds_read_b128 v[100:103], v2 offset:1024
  ds_read_b128 v[104:107], v2 offset:2048
  ds_read_b128 v[108:111], v2 offset:3072
  ds_read_b128 v[112:115], v2 offset:4096
  ds_read_b128 v[116:119], v2 offset:5120
  ds_read_b128 v[120:123], v2 offset:6144
  ds_read_b128 v[124:127], v2 offset:7168
  s_waitcnt lgkmcnt(6)
  v_mfma_f32_16x16x32_bf16 v[136:139], v[96:99], v[16:19], 0
  ds_read_b128 v[128:131], v2 offset:8192
  v_mfma_f32_16x16x32_bf16 v[140:143], v[100:103], v[16:19], 0
  ds_read_b128 v[132:135], v2 offset:9216
  s_waitcnt lgkmcnt(6)
  v_mfma_f32_16x16x32_bf16 v[144:147], v[104:107], v[16:19], 0
  ds_read_b128 v[96:99], v2 offset:10240
  v_mfma_f32_16x16x32_bf16 v[148:151], v[108:111], v[16:19], 0
  ds_read_b128 v[100:103], v2 offset:11264
  s_waitcnt lgkmcnt(6)
  v_mfma_f32_16x16x32_bf16 v[152:155], v[112:115], v[16:19], 0
  ds_read_b128 v[104:107], v2 offset:12288
  v_mfma_f32_16x16x32_bf16 v[156:159], v[116:119], v[16:19], 0
  ds_read_b128 v[108:111], v2 offset:13312
  s_waitcnt lgkmcnt(6)
  v_mfma_f32_16x16x32_bf16 v[160:163], v[120:123], v[16:19], 0
  ds_read_b128 v[112:115], v2 offset:14336
  v_mfma_f32_16x16x32_bf16 v[164:167], v[124:127], v[16:19], 0
  ds_read_b128 v[116:119], v2 offset:15360
  s_waitcnt lgkmcnt(6)
  v_mfma_f32_16x16x32_bf16 v[168:171], v[128:131], v[16:19], 0
  ds_read_b128 v[120:123], v2 offset:16384
  v_mfma_f32_16x16x32_bf16 v[172:175], v[132:135], v[16:19], 0
  ds_read_b128 v[124:127], v2 offset:17408
  s_waitcnt lgkmcnt(6)
  v_mfma_f32_16x16x32_bf16 v[176:179], v[16:19], v[96:99], 0
  ds_read_b128 v[128:131], v2 offset:18432
  v_mfma_f32_16x16x32_bf16 v[180:183], v[16:19], v[100:103], 0
  ds_read_b128 v[132:135], v2 offset:19456
  s_waitcnt lgkmcnt(6)
  v_mfma_f32_16x16x32_bf16 v[184:187], v[16:19], v[104:107], 0
  ds_read_b128 v[96:99], v2 offset:20480
  v_mfma_f32_16x16x32_bf16 v[188:191], v[16:19], v[108:111], 0
  ds_read_b128 v[100:103], v2 offset:21504
  s_waitcnt lgkmcnt(6)
  v_mfma_f32_16x16x32_bf16 v[192:195], v[16:19], v[112:115], 0
  ds_read_b128 v[104:107], v2 offset:22528
  v_mfma_f32_16x16x32_bf16 v[136:139], v[116:119], v[20:23], v[136:139]
  ds_read_b128 v[108:111], v2 offset:23552
  s_waitcnt lgkmcnt(6)
  v_mfma_f32_16x16x32_bf16 v[140:143], v[120:123], v[20:23], v[140:143]
  ds_read_b128 v[112:115], v2 offset:24576
  v_mfma_f32_16x16x32_bf16 v[144:147], v[124:127], v[20:23], v[144:147]
  ds_read_b128 v[116:119], v2 offset:25600
  s_waitcnt lgkmcnt(6)
  v_mfma_f32_16x16x32_bf16 v[148:151], v[128:131], v[20:23], v[148:151]
  ds_read_b128 v[120:123], v2 offset:26624
  v_mfma_f32_16x16x32_bf16 v[152:155], v[132:135], v[20:23], v[152:155]
  ds_read_b128 v[124:127], v2 offset:27648
  s_waitcnt lgkmcnt(6)
  v_mfma_f32_16x16x32_bf16 v[156:159], v[96:99], v[20:23], v[156:159]
  ds_read_b128 v[128:131], v2 offset:28672
  v_mfma_f32_16x16x32_bf16 v[160:163], v[100:103], v[20:23], v[160:163]
  ds_read_b128 v[132:135], v2 offset:29696
  s_waitcnt lgkmcnt(6)
  v_mfma_f32_16x16x32_bf16 v[164:167], v[104:107], v[20:23], v[164:167]
  v_mfma_f32_16x16x32_bf16 v[168:171], v[108:111], v[20:23], v[168:171]
  s_waitcnt lgkmcnt(4)
  v_mfma_f32_16x16x32_bf16 v[172:175], v[112:115], v[20:23], v[172:175]
  v_mfma_f32_16x16x32_bf16 v[176:179], v[20:23], v[116:119], v[176:179]
  s_waitcnt lgkmcnt(2)
  v_mfma_f32_16x16x32_bf16 v[180:183], v[20:23], v[120:123], v[180:183]
  v_mfma_f32_16x16x32_bf16 v[184:187], v[20:23], v[124:127], v[184:187]
  s_waitcnt lgkmcnt(0)
  v_mfma_f32_16x16x32_bf16 v[188:191], v[20:23], v[128:131], v[188:191]
  v_mfma_f32_16x16x32_bf16 v[192:195], v[20:23], v[132:135], v[192:195]
  s_barrier
  ds_read_b128 v[96:99], v2 offset:30720
  ds_read_b128 v[100:103], v2 offset:31744
  ds_read_b128 v[104:107], v2 offset:32768
  ds_read_b128 v[108:111], v2 offset:33792
  ds_read_b128 v[112:115], v2 offset:34816
  ds_read_b128 v[116:119], v2 offset:35840
  ds_read_b128 v[120:123], v2 offset:36864
  ds_read_b128 v[124:127], v2 offset:37888
  s_waitcnt lgkmcnt(6)
  v_mfma_f32_16x16x32_bf16 v[136:139], v[96:99], v[24:27], v[136:139]
  ds_read_b128 v[128:131], v2 offset:38912
  v_mfma_f32_16x16x32_bf16 v[140:143], v[100:103], v[24:27], v[140:143]
  ds_read_b128 v[132:135], v2 offset:39936
  s_waitcnt lgkmcnt(6)
  v_mfma_f32_16x16x32_bf16 v[144:147], v[104:107], v[24:27], v[144:147]
  ds_read_b128 v[96:99], v2 offset:40960
  v_mfma_f32_16x16x32_bf16 v[148:151], v[108:111], v[24:27], v[148:151]
  ds_read_b128 v[100:103], v2 offset:41984
  s_waitcnt lgkmcnt(6)
  v_mfma_f32_16x16x32_bf16 v[152:155], v[112:115], v[24:27], v[152:155]
  ds_read_b128 v[104:107], v2 offset:43008
  v_mfma_f32_16x16x32_bf16 v[156:159], v[116:119], v[24:27], v[156:159]
  ds_read_b128 v[108:111], v2 offset:44032
  s_waitcnt lgkmcnt(6)
  v_mfma_f32_16x16x32_bf16 v[160:163], v[120:123], v[24:27], v[160:163]
  ds_read_b128 v[112:115], v2 offset:45056
  v_mfma_f32_16x16x32_bf16 v[164:167], v[124:127], v[24:27], v[164:167]
  ds_read_b128 v[116:119], v2 offset:46080
  s_waitcnt lgkmcnt(6)
  v_mfma_f32_16x16x32_bf16 v[168:171], v[128:131], v[24:27], v[168:171]
  ds_read_b128 v[120:123], v2 offset:47104
  v_mfma_f32_16x16x32_bf16 v[172:175], v[132:135], v[24:27], v[172:175]
  ds_read_b128 v[124:127], v2 offset:48128
  s_waitcnt lgkmcnt(6)
  v_mfma_f32_16x16x32_bf16 v[176:179], v[24:27], v[96:99], v[176:179]
  ds_read_b128 v[128:131], v2 offset:49152
  v_mfma_f32_16x16x32_bf16 v[180:183], v[24:27], v[100:103], v[180:183]
  ds_read_b128 v[132:135], v2 offset:50176
  s_waitcnt lgkmcnt(6)
  v_mfma_f32_16x16x32_bf16 v[184:187], v[24:27], v[104:107], v[184:187]
  ds_read_b128 v[96:99], v2 offset:51200
  v_mfma_f32_16x16x32_bf16 v[188:191], v[24:27], v[108:111], v[188:191]
  ds_read_b128 v[100:103], v2 offset:52224
  s_waitcnt lgkmcnt(6)
  v_mfma_f32_16x16x32_bf16 v[192:195], v[24:27], v[112:115], v[192:195]
  ds_read_b128 v[104:107], v2 offset:53248
  v_mfma_f32_16x16x32_bf16 v[136:139], v[116:119], v[28:31], v[136:139]
  ds_read_b128 v[108:111], v2 offset:54272
  s_waitcnt lgkmcnt(6)
  v_mfma_f32_16x16x32_bf16 v[140:143], v[120:123], v[28:31], v[140:143]
  ds_read_b128 v[112:115], v2 offset:55296
  v_mfma_f32_16x16x32_bf16 v[144:147], v[124:127], v[28:31], v[144:147]
  ds_read_b128 v[116:119], v2 offset:56320
  s_waitcnt lgkmcnt(6)
  v_mfma_f32_16x16x32_bf16 v[148:151], v[128:131], v[28:31], v[148:151]
  ds_read_b128 v[120:123], v2 offset:57344
  v_mfma_f32_16x16x32_bf16 v[152:155], v[132:135], v[28:31], v[152:155]
  ds_read_b128 v[124:127], v2 offset:58368
  s_waitcnt lgkmcnt(6)
  v_mfma_f32_16x16x32_bf16 v[156:159], v[96:99], v[28:31], v[156:159]
  ds_read_b128 v[128:131], v2 offset:59392
  v_mfma_f32_16x16x32_bf16 v[160:163], v[100:103], v[28:31], v[160:163]
  ds_read_b128 v[132:135], v2 offset:60416
  s_waitcnt lgkmcnt(6)
  v_mfma_f32_16x16x32_bf16 v[164:167], v[104:107], v[28:31], v[164:167]
  v_mfma_f32_16x16x32_bf16 v[168:171], v[108:111], v[28:31], v[168:171]
  s_waitcnt lgkmcnt(4)
  v_mfma_f32_16x16x32_bf16 v[172:175], v[112:115], v[28:31], v[172:175]
  v_mfma_f32_16x16x32_bf16 v[176:179], v[28:31], v[116:119], v[176:179]
  s_waitcnt lgkmcnt(2)
  v_mfma_f32_16x16x32_bf16 v[180:183], v[28:31], v[120:123], v[180:183]
  v_mfma_f32_16x16x32_bf16 v[184:187], v[28:31], v[124:127], v[184:187]
  s_waitcnt lgkmcnt(0)
  v_mfma_f32_16x16x32_bf16 v[188:191], v[28:31], v[128:131], v[188:191]
  v_mfma_f32_16x16x32_bf16 v[192:195], v[28:31], v[132:135], v[192:195]
  s_barrier
  ds_read_b128 v[96:99], v3 offset:0
  ds_read_b128 v[100:103], v3 offset:1024
  ds_read_b128 v[104:107], v3 offset:2048
  ds_read_b128 v[108:111], v3 offset:3072
  ds_read_b128 v[112:115], v3 offset:4096
  ds_read_b128 v[116:119], v3 offset:5120
  ds_read_b128 v[120:123], v3 offset:6144
  ds_read_b128 v[124:127], v3 offset:7168
  s_waitcnt lgkmcnt(6)
  v_mfma_f32_16x16x32_bf16 v[136:139], v[96:99], v[32:35], v[136:139]
  ds_read_b128 v[128:131], v3 offset:8192
  v_mfma_f32_16x16x32_bf16 v[140:143], v[100:103], v[32:35], v[140:143]
  ds_read_b128 v[132:135], v3 offset:9216
  s_waitcnt lgkmcnt(6)
  v_mfma_f32_16x16x32_bf16 v[144:147], v[104:107], v[32:35], v[144:147]
  ds_read_b128 v[96:99], v3 offset:10240
  v_mfma_f32_16x16x32_bf16 v[148:151], v[108:111], v[32:35], v[148:151]
  ds_read_b128 v[100:103], v3 offset:11264
  s_waitcnt lgkmcnt(6)
  v_mfma_f32_16x16x32_bf16 v[152:155], v[112:115], v[32:35], v[152:155]
  ds_read_b128 v[104:107], v3 offset:12288
  v_mfma_f32_16x16x32_bf16 v[156:159], v[116:119], v[32:35], v[156:159]
  ds_read_b128 v[108:111], v3 offset:13312
  s_waitcnt lgkmcnt(6)
  v_mfma_f32_16x16x32_bf16 v[160:163], v[120:123], v[32:35], v[160:163]
  ds_read_b128 v[112:115], v3 offset:14336
  v_mfma_f32_16x16x32_bf16 v[164:167], v[124:127], v[32:35], v[164:167]
  ds_read_b128 v[116:119], v3 offset:15360
  s_waitcnt lgkmcnt(6)
  v_mfma_f32_16x16x32_bf16 v[168:171], v[128:131], v[32:35], v[168:171]
  ds_read_b128 v[120:123], v3 offset:16384
  v_mfma_f32_16x16x32_bf16 v[172:175], v[132:135], v[32:35], v[172:175]
  ds_read_b128 v[124:127], v3 offset:17408
  s_waitcnt lgkmcnt(6)
  v_mfma_f32_16x16x32_bf16 v[176:179], v[32:35], v[96:99], v[176:179]
  ds_read_b128 v[128:131], v3 offset:18432
  v_mfma_f32_16x16x32_bf16 v[180:183], v[32:35], v[100:103], v[180:183]
  ds_read_b128 v[132:135], v3 offset:19456
  s_waitcnt lgkmcnt(6)
  v_mfma_f32_16x16x32_bf16 v[184:187], v[32:35], v[104:107], v[184:187]
  ds_read_b128 v[96:99], v3 offset:20480
  v_mfma_f32_16x16x32_bf16 v[188:191], v[32:35], v[108:111], v[188:191]
  ds_read_b128 v[100:103], v3 offset:21504
  s_waitcnt lgkmcnt(6)
  v_mfma_f32_16x16x32_bf16 v[192:195], v[32:35], v[112:115], v[192:195]
  ds_read_b128 v[104:107], v3 offset:22528
  v_mfma_f32_16x16x32_bf16 v[136:139], v[116:119], v[36:39], v[136:139]
  ds_read_b128 v[108:111], v3 offset:23552
  s_waitcnt lgkmcnt(6)
  v_mfma_f32_16x16x32_bf16 v[140:143], v[120:123], v[36:39], v[140:143]
  ds_read_b128 v[112:115], v3 offset:24576
  v_mfma_f32_16x16x32_bf16 v[144:147], v[124:127], v[36:39], v[144:147]
  ds_read_b128 v[116:119], v3 offset:25600
  s_waitcnt lgkmcnt(6)
  v_mfma_f32_16x16x32_bf16 v[148:151], v[128:131], v[36:39], v[148:151]
  ds_read_b128 v[120:123], v3 offset:26624
  v_mfma_f32_16x16x32_bf16 v[152:155], v[132:135], v[36:39], v[152:155]
  ds_read_b128 v[124:127], v3 offset:27648
  s_waitcnt lgkmcnt(6)
  v_mfma_f32_16x16x32_bf16 v[156:159], v[96:99], v[36:39], v[156:159]
  ds_read_b128 v[128:131], v3 offset:28672
  v_mfma_f32_16x16x32_bf16 v[160:163], v[100:103], v[36:39], v[160:163]
  ds_read_b128 v[132:135], v3 offset:29696
  s_waitcnt lgkmcnt(6)
  v_mfma_f32_16x16x32_bf16 v[164:167], v[104:107], v[36:39], v[164:167]
  v_mfma_f32_16x16x32_bf16 v[168:171], v[108:111], v[36:39], v[168:171]
  s_waitcnt lgkmcnt(4)
  v_mfma_f32_16x16x32_bf16 v[172:175], v[112:115], v[36:39], v[172:175]
  v_mfma_f32_16x16x32_bf16 v[176:179], v[36:39], v[116:119], v[176:179]
  s_waitcnt lgkmcnt(2)
  v_mfma_f32_16x16x32_bf16 v[180:183], v[36:39], v[120:123], v[180:183]
  v_mfma_f32_16x16x32_bf16 v[184:187], v[36:39], v[124:127], v[184:187]
  s_waitcnt lgkmcnt(0)
  v_mfma_f32_16x16x32_bf16 v[188:191], v[36:39], v[128:131], v[188:191]
  v_mfma_f32_16x16x32_bf16 v[192:195], v[36:39], v[132:135], v[192:195]
  s_barrier
  ds_read_b128 v[96:99], v3 offset:30720
  ds_read_b128 v[100:103], v3 offset:31744
  ds_read_b128 v[104:107], v3 offset:32768
  ds_read_b128 v[108:111], v3 offset:33792
  ds_read_b128 v[112:115], v3 offset:34816
  ds_read_b128 v[116:119], v3 offset:35840
  ds_read_b128 v[120:123], v3 offset:36864
  ds_read_b128 v[124:127], v3 offset:37888
  s_waitcnt lgkmcnt(6)
  v_mfma_f32_16x16x32_bf16 v[136:139], v[96:99], v[40:43], v[136:139]
  ds_read_b128 v[128:131], v3 offset:38912
  v_mfma_f32_16x16x32_bf16 v[140:143], v[100:103], v[40:43], v[140:143]
  ds_read_b128 v[132:135], v3 offset:39936
  s_waitcnt lgkmcnt(6)
  v_mfma_f32_16x16x32_bf16 v[144:147], v[104:107], v[40:43], v[144:147]
  ds_read_b128 v[96:99], v3 offset:40960
  v_mfma_f32_16x16x32_bf16 v[148:151], v[108:111], v[40:43], v[148:151]
  ds_read_b128 v[100:103], v3 offset:41984
  s_waitcnt lgkmcnt(6)
  v_mfma_f32_16x16x32_bf16 v[152:155], v[112:115], v[40:43], v[152:155]
  ds_read_b128 v[104:107], v3 offset:43008
  v_mfma_f32_16x16x32_bf16 v[156:159], v[116:119], v[40:43], v[156:159]
  ds_read_b128 v[108:111], v3 offset:44032
  s_waitcnt lgkmcnt(6)
  v_mfma_f32_16x16x32_bf16 v[160:163], v[120:123], v[40:43], v[160:163]
  ds_read_b128 v[112:115], v3 offset:45056
  v_mfma_f32_16x16x32_bf16 v[164:167], v[124:127], v[40:43], v[164:167]
  ds_read_b128 v[116:119], v3 offset:46080
  s_waitcnt lgkmcnt(6)
  v_mfma_f32_16x16x32_bf16 v[168:171], v[128:131], v[40:43], v[168:171]
  ds_read_b128 v[120:123], v3 offset:47104
  v_mfma_f32_16x16x32_bf16 v[172:175], v[132:135], v[40:43], v[172:175]
  ds_read_b128 v[124:127], v3 offset:48128
  s_waitcnt lgkmcnt(6)
  v_mfma_f32_16x16x32_bf16 v[176:179], v[40:43], v[96:99], v[176:179]
  ds_read_b128 v[128:131], v3 offset:49152
  v_mfma_f32_16x16x32_bf16 v[180:183], v[40:43], v[100:103], v[180:183]
  ds_read_b128 v[132:135], v3 offset:50176
  s_waitcnt lgkmcnt(6)
  v_mfma_f32_16x16x32_bf16 v[184:187], v[40:43], v[104:107], v[184:187]
  ds_read_b128 v[96:99], v3 offset:51200
  v_mfma_f32_16x16x32_bf16 v[188:191], v[40:43], v[108:111], v[188:191]
  ds_read_b128 v[100:103], v3 offset:52224
  s_waitcnt lgkmcnt(6)
  v_mfma_f32_16x16x32_bf16 v[192:195], v[40:43], v[112:115], v[192:195]
  ds_read_b128 v[104:107], v3 offset:53248
  v_mfma_f32_16x16x32_bf16 v[136:139], v[116:119], v[44:47], v[136:139]
  ds_read_b128 v[108:111], v3 offset:54272
  s_waitcnt lgkmcnt(6)
  v_mfma_f32_16x16x32_bf16 v[140:143], v[120:123], v[44:47], v[140:143]
  ds_read_b128 v[112:115], v3 offset:55296
  v_mfma_f32_16x16x32_bf16 v[144:147], v[124:127], v[44:47], v[144:147]
  ds_read_b128 v[116:119], v3 offset:56320
  s_waitcnt lgkmcnt(6)
  v_mfma_f32_16x16x32_bf16 v[148:151], v[128:131], v[44:47], v[148:151]
  ds_read_b128 v[120:123], v3 offset:57344
  v_mfma_f32_16x16x32_bf16 v[152:155], v[132:135], v[44:47], v[152:155]
  ds_read_b128 v[124:127], v3 offset:58368
  s_waitcnt lgkmcnt(6)
  v_mfma_f32_16x16x32_bf16 v[156:159], v[96:99], v[44:47], v[156:159]
  ds_read_b128 v[128:131], v3 offset:59392
  v_mfma_f32_16x16x32_bf16 v[160:163], v[100:103], v[44:47], v[160:163]
  ds_read_b128 v[132:135], v3 offset:60416
  s_waitcnt lgkmcnt(6)
  v_mfma_f32_16x16x32_bf16 v[164:167], v[104:107], v[44:47], v[164:167]
  v_mfma_f32_16x16x32_bf16 v[168:171], v[108:111], v[44:47], v[168:171]
  s_waitcnt lgkmcnt(4)
  v_mfma_f32_16x16x32_bf16 v[172:175], v[112:115], v[44:47], v[172:175]
  v_mfma_f32_16x16x32_bf16 v[176:179], v[44:47], v[116:119], v[176:179]
  s_waitcnt lgkmcnt(2)
  v_mfma_f32_16x16x32_bf16 v[180:183], v[44:47], v[120:123], v[180:183]
  v_mfma_f32_16x16x32_bf16 v[184:187], v[44:47], v[124:127], v[184:187]
  s_waitcnt lgkmcnt(0)
  v_mfma_f32_16x16x32_bf16 v[188:191], v[44:47], v[128:131], v[188:191]
  v_mfma_f32_16x16x32_bf16 v[192:195], v[44:47], v[132:135], v[192:195]
  s_barrier
  ds_read_b128 v[96:99], v6 offset:0
  ds_read_b128 v[100:103], v6 offset:1024
  ds_read_b128 v[104:107], v6 offset:2048
  ds_read_b128 v[108:111], v6 offset:3072
  ds_read_b128 v[112:115], v6 offset:4096
  ds_read_b128 v[116:119], v6 offset:5120
  ds_read_b128 v[120:123], v6 offset:6144
  ds_read_b128 v[124:127], v6 offset:7168
  s_waitcnt lgkmcnt(6)
  v_mfma_f32_16x16x32_bf16 v[136:139], v[96:99], v[48:51], v[136:139]
  ds_read_b128 v[128:131], v6 offset:8192
  v_mfma_f32_16x16x32_bf16 v[140:143], v[100:103], v[48:51], v[140:143]
  ds_read_b128 v[132:135], v6 offset:9216
  s_waitcnt lgkmcnt(6)
  v_mfma_f32_16x16x32_bf16 v[144:147], v[104:107], v[48:51], v[144:147]
  ds_read_b128 v[96:99], v6 offset:10240
  v_mfma_f32_16x16x32_bf16 v[148:151], v[108:111], v[48:51], v[148:151]
  ds_read_b128 v[100:103], v6 offset:11264
  s_waitcnt lgkmcnt(6)
  v_mfma_f32_16x16x32_bf16 v[152:155], v[112:115], v[48:51], v[152:155]
  ds_read_b128 v[104:107], v6 offset:12288
  v_mfma_f32_16x16x32_bf16 v[156:159], v[116:119], v[48:51], v[156:159]
  ds_read_b128 v[108:111], v6 offset:13312
  s_waitcnt lgkmcnt(6)
  v_mfma_f32_16x16x32_bf16 v[160:163], v[120:123], v[48:51], v[160:163]
  ds_read_b128 v[112:115], v6 offset:14336
  v_mfma_f32_16x16x32_bf16 v[164:167], v[124:127], v[48:51], v[164:167]
  ds_read_b128 v[116:119], v6 offset:15360
  s_waitcnt lgkmcnt(6)
  v_mfma_f32_16x16x32_bf16 v[168:171], v[128:131], v[48:51], v[168:171]
  ds_read_b128 v[120:123], v6 offset:16384
  v_mfma_f32_16x16x32_bf16 v[172:175], v[132:135], v[48:51], v[172:175]
  ds_read_b128 v[124:127], v6 offset:17408
  s_waitcnt lgkmcnt(6)
  v_mfma_f32_16x16x32_bf16 v[176:179], v[48:51], v[96:99], v[176:179]
  ds_read_b128 v[128:131], v6 offset:18432
  v_mfma_f32_16x16x32_bf16 v[180:183], v[48:51], v[100:103], v[180:183]
  ds_read_b128 v[132:135], v6 offset:19456
  s_waitcnt lgkmcnt(6)
  v_mfma_f32_16x16x32_bf16 v[184:187], v[48:51], v[104:107], v[184:187]
  ds_read_b128 v[96:99], v6 offset:20480
  v_mfma_f32_16x16x32_bf16 v[188:191], v[48:51], v[108:111], v[188:191]
  ds_read_b128 v[100:103], v6 offset:21504
  s_waitcnt lgkmcnt(6)
  v_mfma_f32_16x16x32_bf16 v[192:195], v[48:51], v[112:115], v[192:195]
  ds_read_b128 v[104:107], v6 offset:22528
  v_mfma_f32_16x16x32_bf16 v[136:139], v[116:119], v[52:55], v[136:139]
  ds_read_b128 v[108:111], v6 offset:23552
  s_waitcnt lgkmcnt(6)
  v_mfma_f32_16x16x32_bf16 v[140:143], v[120:123], v[52:55], v[140:143]
  ds_read_b128 v[112:115], v6 offset:24576
  v_mfma_f32_16x16x32_bf16 v[144:147], v[124:127], v[52:55], v[144:147]
  ds_read_b128 v[116:119], v6 offset:25600
  s_waitcnt lgkmcnt(6)
  v_mfma_f32_16x16x32_bf16 v[148:151], v[128:131], v[52:55], v[148:151]
  ds_read_b128 v[120:123], v6 offset:26624
  v_mfma_f32_16x16x32_bf16 v[152:155], v[132:135], v[52:55], v[152:155]
  ds_read_b128 v[124:127], v6 offset:27648
  s_waitcnt lgkmcnt(6)
  v_mfma_f32_16x16x32_bf16 v[156:159], v[96:99], v[52:55], v[156:159]
  ds_read_b128 v[128:131], v6 offset:28672
  v_mfma_f32_16x16x32_bf16 v[160:163], v[100:103], v[52:55], v[160:163]
  ds_read_b128 v[132:135], v6 offset:29696
  s_waitcnt lgkmcnt(6)
  v_mfma_f32_16x16x32_bf16 v[164:167], v[104:107], v[52:55], v[164:167]
  v_mfma_f32_16x16x32_bf16 v[168:171], v[108:111], v[52:55], v[168:171]
  s_waitcnt lgkmcnt(4)
  v_mfma_f32_16x16x32_bf16 v[172:175], v[112:115], v[52:55], v[172:175]
  v_mfma_f32_16x16x32_bf16 v[176:179], v[52:55], v[116:119], v[176:179]
  s_waitcnt lgkmcnt(2)
  v_mfma_f32_16x16x32_bf16 v[180:183], v[52:55], v[120:123], v[180:183]
  v_mfma_f32_16x16x32_bf16 v[184:187], v[52:55], v[124:127], v[184:187]
  s_waitcnt lgkmcnt(0)
  v_mfma_f32_16x16x32_bf16 v[188:191], v[52:55], v[128:131], v[188:191]
  v_mfma_f32_16x16x32_bf16 v[192:195], v[52:55], v[132:135], v[192:195]
  s_barrier
  ds_read_b128 v[96:99], v2 offset:0
  ds_read_b128 v[100:103], v2 offset:1024
  ds_read_b128 v[104:107], v2 offset:2048
  ds_read_b128 v[108:111], v2 offset:3072
  ds_read_b128 v[112:115], v2 offset:4096
  ds_read_b128 v[116:119], v2 offset:5120
  ds_read_b128 v[120:123], v2 offset:6144
  ds_read_b128 v[124:127], v2 offset:7168
  s_waitcnt lgkmcnt(6)
  v_mfma_f32_16x16x32_bf16 v[136:139], v[96:99], v[56:59], v[136:139]
  ds_read_b128 v[128:131], v2 offset:8192
  v_mfma_f32_16x16x32_bf16 v[140:143], v[100:103], v[56:59], v[140:143]
  ds_read_b128 v[132:135], v2 offset:9216
  s_waitcnt lgkmcnt(6)
  v_mfma_f32_16x16x32_bf16 v[144:147], v[104:107], v[56:59], v[144:147]
  ds_read_b128 v[96:99], v2 offset:10240
  v_mfma_f32_16x16x32_bf16 v[148:151], v[108:111], v[56:59], v[148:151]
  ds_read_b128 v[100:103], v2 offset:11264
  s_waitcnt lgkmcnt(6)
  v_mfma_f32_16x16x32_bf16 v[152:155], v[112:115], v[56:59], v[152:155]
  ds_read_b128 v[104:107], v2 offset:12288
  v_mfma_f32_16x16x32_bf16 v[156:159], v[116:119], v[56:59], v[156:159]
  ds_read_b128 v[108:111], v2 offset:13312
  s_waitcnt lgkmcnt(6)
  v_mfma_f32_16x16x32_bf16 v[160:163], v[120:123], v[56:59], v[160:163]
  ds_read_b128 v[112:115], v2 offset:14336
  v_mfma_f32_16x16x32_bf16 v[164:167], v[124:127], v[56:59], v[164:167]
  ds_read_b128 v[116:119], v2 offset:15360
  s_waitcnt lgkmcnt(6)
  v_mfma_f32_16x16x32_bf16 v[168:171], v[128:131], v[56:59], v[168:171]
  ds_read_b128 v[120:123], v2 offset:16384
  v_mfma_f32_16x16x32_bf16 v[172:175], v[132:135], v[56:59], v[172:175]
  ds_read_b128 v[124:127], v2 offset:17408
  s_waitcnt lgkmcnt(6)
  v_mfma_f32_16x16x32_bf16 v[176:179], v[56:59], v[96:99], v[176:179]
  ds_read_b128 v[128:131], v2 offset:18432
  v_mfma_f32_16x16x32_bf16 v[180:183], v[56:59], v[100:103], v[180:183]
  ds_read_b128 v[132:135], v2 offset:19456
  s_waitcnt lgkmcnt(6)
  v_mfma_f32_16x16x32_bf16 v[184:187], v[56:59], v[104:107], v[184:187]
  ds_read_b128 v[96:99], v2 offset:20480
  v_mfma_f32_16x16x32_bf16 v[188:191], v[56:59], v[108:111], v[188:191]
  ds_read_b128 v[100:103], v2 offset:21504
  s_waitcnt lgkmcnt(6)
  v_mfma_f32_16x16x32_bf16 v[192:195], v[56:59], v[112:115], v[192:195]
  ds_read_b128 v[104:107], v2 offset:22528
  v_mfma_f32_16x16x32_bf16 v[136:139], v[116:119], v[60:63], v[136:139]
  ds_read_b128 v[108:111], v2 offset:23552
  s_waitcnt lgkmcnt(6)
  v_mfma_f32_16x16x32_bf16 v[140:143], v[120:123], v[60:63], v[140:143]
  ds_read_b128 v[112:115], v2 offset:24576
  v_mfma_f32_16x16x32_bf16 v[144:147], v[124:127], v[60:63], v[144:147]
  ds_read_b128 v[116:119], v2 offset:25600
  s_waitcnt lgkmcnt(6)
  v_mfma_f32_16x16x32_bf16 v[148:151], v[128:131], v[60:63], v[148:151]
  ds_read_b128 v[120:123], v2 offset:26624
  v_mfma_f32_16x16x32_bf16 v[152:155], v[132:135], v[60:63], v[152:155]
  ds_read_b128 v[124:127], v2 offset:27648
  s_waitcnt lgkmcnt(6)
  v_mfma_f32_16x16x32_bf16 v[156:159], v[96:99], v[60:63], v[156:159]
  ds_read_b128 v[128:131], v2 offset:28672
  v_mfma_f32_16x16x32_bf16 v[160:163], v[100:103], v[60:63], v[160:163]
  ds_read_b128 v[132:135], v2 offset:29696
  s_waitcnt lgkmcnt(6)
  v_mfma_f32_16x16x32_bf16 v[164:167], v[104:107], v[60:63], v[164:167]
  v_mfma_f32_16x16x32_bf16 v[168:171], v[108:111], v[60:63], v[168:171]
  s_waitcnt lgkmcnt(4)
  v_mfma_f32_16x16x32_bf16 v[172:175], v[112:115], v[60:63], v[172:175]
  v_mfma_f32_16x16x32_bf16 v[176:179], v[60:63], v[116:119], v[176:179]
  s_waitcnt lgkmcnt(2)
  v_mfma_f32_16x16x32_bf16 v[180:183], v[60:63], v[120:123], v[180:183]
  v_mfma_f32_16x16x32_bf16 v[184:187], v[60:63], v[124:127], v[184:187]
  s_waitcnt lgkmcnt(0)
  v_mfma_f32_16x16x32_bf16 v[188:191], v[60:63], v[128:131], v[188:191]
  v_mfma_f32_16x16x32_bf16 v[192:195], v[60:63], v[132:135], v[192:195]
  s_barrier
  ds_read_b128 v[96:99], v2 offset:30720
  ds_read_b128 v[100:103], v2 offset:31744
  ds_read_b128 v[104:107], v2 offset:32768
  ds_read_b128 v[108:111], v2 offset:33792
  ds_read_b128 v[112:115], v2 offset:34816
  ds_read_b128 v[116:119], v2 offset:35840
  ds_read_b128 v[120:123], v2 offset:36864
  ds_read_b128 v[124:127], v2 offset:37888
  s_waitcnt lgkmcnt(6)
  v_mfma_f32_16x16x32_bf16 v[136:139], v[96:99], v[64:67], v[136:139]
  ds_read_b128 v[128:131], v2 offset:38912
  v_mfma_f32_16x16x32_bf16 v[140:143], v[100:103], v[64:67], v[140:143]
  ds_read_b128 v[132:135], v2 offset:39936
  s_waitcnt lgkmcnt(6)
  v_mfma_f32_16x16x32_bf16 v[144:147], v[104:107], v[64:67], v[144:147]
  ds_read_b128 v[96:99], v2 offset:40960
  v_mfma_f32_16x16x32_bf16 v[148:151], v[108:111], v[64:67], v[148:151]
  ds_read_b128 v[100:103], v2 offset:41984
  s_waitcnt lgkmcnt(6)
  v_mfma_f32_16x16x32_bf16 v[152:155], v[112:115], v[64:67], v[152:155]
  ds_read_b128 v[104:107], v2 offset:43008
  v_mfma_f32_16x16x32_bf16 v[156:159], v[116:119], v[64:67], v[156:159]
  ds_read_b128 v[108:111], v2 offset:44032
  s_waitcnt lgkmcnt(6)
  v_mfma_f32_16x16x32_bf16 v[160:163], v[120:123], v[64:67], v[160:163]
  ds_read_b128 v[112:115], v2 offset:45056
  v_mfma_f32_16x16x32_bf16 v[164:167], v[124:127], v[64:67], v[164:167]
  ds_read_b128 v[116:119], v2 offset:46080
  s_waitcnt lgkmcnt(6)
  v_mfma_f32_16x16x32_bf16 v[168:171], v[128:131], v[64:67], v[168:171]
  ds_read_b128 v[120:123], v2 offset:47104
  v_mfma_f32_16x16x32_bf16 v[172:175], v[132:135], v[64:67], v[172:175]
  ds_read_b128 v[124:127], v2 offset:48128
  s_waitcnt lgkmcnt(6)
  v_mfma_f32_16x16x32_bf16 v[176:179], v[64:67], v[96:99], v[176:179]
  ds_read_b128 v[128:131], v2 offset:49152
  v_mfma_f32_16x16x32_bf16 v[180:183], v[64:67], v[100:103], v[180:183]
  ds_read_b128 v[132:135], v2 offset:50176
  s_waitcnt lgkmcnt(6)
  v_mfma_f32_16x16x32_bf16 v[184:187], v[64:67], v[104:107], v[184:187]
  ds_read_b128 v[96:99], v2 offset:51200
  v_mfma_f32_16x16x32_bf16 v[188:191], v[64:67], v[108:111], v[188:191]
  ds_read_b128 v[100:103], v2 offset:52224
  s_waitcnt lgkmcnt(6)
  v_mfma_f32_16x16x32_bf16 v[192:195], v[64:67], v[112:115], v[192:195]
  ds_read_b128 v[104:107], v2 offset:53248
  v_mfma_f32_16x16x32_bf16 v[136:139], v[116:119], v[68:71], v[136:139]
  ds_read_b128 v[108:111], v2 offset:54272
  s_waitcnt lgkmcnt(6)
  v_mfma_f32_16x16x32_bf16 v[140:143], v[120:123], v[68:71], v[140:143]
  ds_read_b128 v[112:115], v2 offset:55296
  v_mfma_f32_16x16x32_bf16 v[144:147], v[124:127], v[68:71], v[144:147]
  ds_read_b128 v[116:119], v2 offset:56320
  s_waitcnt lgkmcnt(6)
  v_mfma_f32_16x16x32_bf16 v[148:151], v[128:131], v[68:71], v[148:151]
  ds_read_b128 v[120:123], v2 offset:57344
  v_mfma_f32_16x16x32_bf16 v[152:155], v[132:135], v[68:71], v[152:155]
  ds_read_b128 v[124:127], v2 offset:58368
  s_waitcnt lgkmcnt(6)
  v_mfma_f32_16x16x32_bf16 v[156:159], v[96:99], v[68:71], v[156:159]
  ds_read_b128 v[128:131], v2 offset:59392
  v_mfma_f32_16x16x32_bf16 v[160:163], v[100:103], v[68:71], v[160:163]
  ds_read_b128 v[132:135], v2 offset:60416
  s_waitcnt lgkmcnt(6)
  v_mfma_f32_16x16x32_bf16 v[164:167], v[104:107], v[68:71], v[164:167]
  v_mfma_f32_16x16x32_bf16 v[168:171], v[108:111], v[68:71], v[168:171]
  s_waitcnt lgkmcnt(4)
  v_mfma_f32_16x16x32_bf16 v[172:175], v[112:115], v[68:71], v[172:175]
  v_mfma_f32_16x16x32_bf16 v[176:179], v[68:71], v[116:119], v[176:179]
  s_waitcnt lgkmcnt(2)
  v_mfma_f32_16x16x32_bf16 v[180:183], v[68:71], v[120:123], v[180:183]
  v_mfma_f32_16x16x32_bf16 v[184:187], v[68:71], v[124:127], v[184:187]
  s_waitcnt lgkmcnt(0)
  v_mfma_f32_16x16x32_bf16 v[188:191], v[68:71], v[128:131], v[188:191]
  v_mfma_f32_16x16x32_bf16 v[192:195], v[68:71], v[132:135], v[192:195]
  s_barrier
  ds_read_b128 v[96:99], v3 offset:0
  ds_read_b128 v[100:103], v3 offset:1024
  ds_read_b128 v[104:107], v3 offset:2048
  ds_read_b128 v[108:111], v3 offset:3072
  ds_read_b128 v[112:115], v3 offset:4096
  ds_read_b128 v[116:119], v3 offset:5120
  ds_read_b128 v[120:123], v3 offset:6144
  ds_read_b128 v[124:127], v3 offset:7168
  s_waitcnt lgkmcnt(6)
  v_mfma_f32_16x16x32_bf16 v[136:139], v[96:99], v[72:75], v[136:139]
  ds_read_b128 v[128:131], v3 offset:8192
  v_mfma_f32_16x16x32_bf16 v[140:143], v[100:103], v[72:75], v[140:143]
  ds_read_b128 v[132:135], v3 offset:9216
  s_waitcnt lgkmcnt(6)
  v_mfma_f32_16x16x32_bf16 v[144:147], v[104:107], v[72:75], v[144:147]
  ds_read_b128 v[96:99], v3 offset:10240
  v_mfma_f32_16x16x32_bf16 v[148:151], v[108:111], v[72:75], v[148:151]
  ds_read_b128 v[100:103], v3 offset:11264
  s_waitcnt lgkmcnt(6)
  v_mfma_f32_16x16x32_bf16 v[152:155], v[112:115], v[72:75], v[152:155]
  ds_read_b128 v[104:107], v3 offset:12288
  v_mfma_f32_16x16x32_bf16 v[156:159], v[116:119], v[72:75], v[156:159]
  ds_read_b128 v[108:111], v3 offset:13312
  s_waitcnt lgkmcnt(6)
  v_mfma_f32_16x16x32_bf16 v[160:163], v[120:123], v[72:75], v[160:163]
  ds_read_b128 v[112:115], v3 offset:14336
  v_mfma_f32_16x16x32_bf16 v[164:167], v[124:127], v[72:75], v[164:167]
  ds_read_b128 v[116:119], v3 offset:15360
  s_waitcnt lgkmcnt(6)
  v_mfma_f32_16x16x32_bf16 v[168:171], v[128:131], v[72:75], v[168:171]
  ds_read_b128 v[120:123], v3 offset:16384
  v_mfma_f32_16x16x32_bf16 v[172:175], v[132:135], v[72:75], v[172:175]
  ds_read_b128 v[124:127], v3 offset:17408
  s_waitcnt lgkmcnt(6)
  v_mfma_f32_16x16x32_bf16 v[176:179], v[72:75], v[96:99], v[176:179]
  ds_read_b128 v[128:131], v3 offset:18432
  v_mfma_f32_16x16x32_bf16 v[180:183], v[72:75], v[100:103], v[180:183]
  ds_read_b128 v[132:135], v3 offset:19456
  s_waitcnt lgkmcnt(6)
  v_mfma_f32_16x16x32_bf16 v[184:187], v[72:75], v[104:107], v[184:187]
  ds_read_b128 v[96:99], v3 offset:20480
  v_mfma_f32_16x16x32_bf16 v[188:191], v[72:75], v[108:111], v[188:191]
  ds_read_b128 v[100:103], v3 offset:21504
  s_waitcnt lgkmcnt(6)
  v_mfma_f32_16x16x32_bf16 v[192:195], v[72:75], v[112:115], v[192:195]
  ds_read_b128 v[104:107], v3 offset:22528
  v_mfma_f32_16x16x32_bf16 v[136:139], v[116:119], v[76:79], v[136:139]
  ds_read_b128 v[108:111], v3 offset:23552
  s_waitcnt lgkmcnt(6)
  v_mfma_f32_16x16x32_bf16 v[140:143], v[120:123], v[76:79], v[140:143]
  ds_read_b128 v[112:115], v3 offset:24576
  v_mfma_f32_16x16x32_bf16 v[144:147], v[124:127], v[76:79], v[144:147]
  ds_read_b128 v[116:119], v3 offset:25600
  s_waitcnt lgkmcnt(6)
  v_mfma_f32_16x16x32_bf16 v[148:151], v[128:131], v[76:79], v[148:151]
  ds_read_b128 v[120:123], v3 offset:26624
  v_mfma_f32_16x16x32_bf16 v[152:155], v[132:135], v[76:79], v[152:155]
  ds_read_b128 v[124:127], v3 offset:27648
  s_waitcnt lgkmcnt(6)
  v_mfma_f32_16x16x32_bf16 v[156:159], v[96:99], v[76:79], v[156:159]
  ds_read_b128 v[128:131], v3 offset:28672
  v_mfma_f32_16x16x32_bf16 v[160:163], v[100:103], v[76:79], v[160:163]
  ds_read_b128 v[132:135], v3 offset:29696
  s_waitcnt lgkmcnt(6)
  v_mfma_f32_16x16x32_bf16 v[164:167], v[104:107], v[76:79], v[164:167]
  v_mfma_f32_16x16x32_bf16 v[168:171], v[108:111], v[76:79], v[168:171]
  s_waitcnt lgkmcnt(4)
  v_mfma_f32_16x16x32_bf16 v[172:175], v[112:115], v[76:79], v[172:175]
  v_mfma_f32_16x16x32_bf16 v[176:179], v[76:79], v[116:119], v[176:179]
  s_waitcnt lgkmcnt(2)
  v_mfma_f32_16x16x32_bf16 v[180:183], v[76:79], v[120:123], v[180:183]
  v_mfma_f32_16x16x32_bf16 v[184:187], v[76:79], v[124:127], v[184:187]
  s_waitcnt lgkmcnt(0)
  v_mfma_f32_16x16x32_bf16 v[188:191], v[76:79], v[128:131], v[188:191]
  v_mfma_f32_16x16x32_bf16 v[192:195], v[76:79], v[132:135], v[192:195]
  s_barrier
  ds_read_b128 v[96:99], v3 offset:30720
  ds_read_b128 v[100:103], v3 offset:31744
  ds_read_b128 v[104:107], v3 offset:32768
  ds_read_b128 v[108:111], v3 offset:33792
  ds_read_b128 v[112:115], v3 offset:34816
  ds_read_b128 v[116:119], v3 offset:35840
  ds_read_b128 v[120:123], v3 offset:36864
  ds_read_b128 v[124:127], v3 offset:37888
  s_waitcnt lgkmcnt(6)
  v_mfma_f32_16x16x32_bf16 v[136:139], v[96:99], v[80:83], v[136:139]
  ds_read_b128 v[128:131], v3 offset:38912
  v_mfma_f32_16x16x32_bf16 v[140:143], v[100:103], v[80:83], v[140:143]
  ds_read_b128 v[132:135], v3 offset:39936
  s_waitcnt lgkmcnt(6)
  v_mfma_f32_16x16x32_bf16 v[144:147], v[104:107], v[80:83], v[144:147]
  ds_read_b128 v[96:99], v3 offset:40960
  v_mfma_f32_16x16x32_bf16 v[148:151], v[108:111], v[80:83], v[148:151]
  ds_read_b128 v[100:103], v3 offset:41984
  s_waitcnt lgkmcnt(6)
  v_mfma_f32_16x16x32_bf16 v[152:155], v[112:115], v[80:83], v[152:155]
  ds_read_b128 v[104:107], v3 offset:43008
  v_mfma_f32_16x16x32_bf16 v[156:159], v[116:119], v[80:83], v[156:159]
  ds_read_b128 v[108:111], v3 offset:44032
  s_waitcnt lgkmcnt(6)
  v_mfma_f32_16x16x32_bf16 v[160:163], v[120:123], v[80:83], v[160:163]
  ds_read_b128 v[112:115], v3 offset:45056
  v_mfma_f32_16x16x32_bf16 v[164:167], v[124:127], v[80:83], v[164:167]
  ds_read_b128 v[116:119], v3 offset:46080
  s_waitcnt lgkmcnt(6)
  v_mfma_f32_16x16x32_bf16 v[168:171], v[128:131], v[80:83], v[168:171]
  ds_read_b128 v[120:123], v3 offset:47104
  v_mfma_f32_16x16x32_bf16 v[172:175], v[132:135], v[80:83], v[172:175]
  ds_read_b128 v[124:127], v3 offset:48128
  s_waitcnt lgkmcnt(6)
  v_mfma_f32_16x16x32_bf16 v[176:179], v[80:83], v[96:99], v[176:179]
  ds_read_b128 v[128:131], v3 offset:49152
  v_mfma_f32_16x16x32_bf16 v[180:183], v[80:83], v[100:103], v[180:183]
  ds_read_b128 v[132:135], v3 offset:50176
  s_waitcnt lgkmcnt(6)
  v_mfma_f32_16x16x32_bf16 v[184:187], v[80:83], v[104:107], v[184:187]
  ds_read_b128 v[96:99], v3 offset:51200
  v_mfma_f32_16x16x32_bf16 v[188:191], v[80:83], v[108:111], v[188:191]
  ds_read_b128 v[100:103], v3 offset:52224
  s_waitcnt lgkmcnt(6)
  v_mfma_f32_16x16x32_bf16 v[192:195], v[80:83], v[112:115], v[192:195]
  ds_read_b128 v[104:107], v3 offset:53248
  v_mfma_f32_16x16x32_bf16 v[136:139], v[116:119], v[84:87], v[136:139]
  ds_read_b128 v[108:111], v3 offset:54272
  s_waitcnt lgkmcnt(6)
  v_mfma_f32_16x16x32_bf16 v[140:143], v[120:123], v[84:87], v[140:143]
  ds_read_b128 v[112:115], v3 offset:55296
  v_mfma_f32_16x16x32_bf16 v[144:147], v[124:127], v[84:87], v[144:147]
  ds_read_b128 v[116:119], v3 offset:56320
  s_waitcnt lgkmcnt(6)
  v_mfma_f32_16x16x32_bf16 v[148:151], v[128:131], v[84:87], v[148:151]
  ds_read_b128 v[120:123], v3 offset:57344
  v_mfma_f32_16x16x32_bf16 v[152:155], v[132:135], v[84:87], v[152:155]
  ds_read_b128 v[124:127], v3 offset:58368
  s_waitcnt lgkmcnt(6)
  v_mfma_f32_16x16x32_bf16 v[156:159], v[96:99], v[84:87], v[156:159]
  ds_read_b128 v[128:131], v3 offset:59392
  v_mfma_f32_16x16x32_bf16 v[160:163], v[100:103], v[84:87], v[160:163]
  ds_read_b128 v[132:135], v3 offset:60416
  s_waitcnt lgkmcnt(6)
  v_mfma_f32_16x16x32_bf16 v[164:167], v[104:107], v[84:87], v[164:167]
  v_mfma_f32_16x16x32_bf16 v[168:171], v[108:111], v[84:87], v[168:171]
  s_waitcnt lgkmcnt(4)
  v_mfma_f32_16x16x32_bf16 v[172:175], v[112:115], v[84:87], v[172:175]
  v_mfma_f32_16x16x32_bf16 v[176:179], v[84:87], v[116:119], v[176:179]
  s_waitcnt lgkmcnt(2)
  v_mfma_f32_16x16x32_bf16 v[180:183], v[84:87], v[120:123], v[180:183]
  v_mfma_f32_16x16x32_bf16 v[184:187], v[84:87], v[124:127], v[184:187]
  s_waitcnt lgkmcnt(0)
  v_mfma_f32_16x16x32_bf16 v[188:191], v[84:87], v[128:131], v[188:191]
  v_mfma_f32_16x16x32_bf16 v[192:195], v[84:87], v[132:135], v[192:195]
  s_barrier
  ds_read_b128 v[96:99], v6 offset:0
  ds_read_b128 v[100:103], v6 offset:1024
  ds_read_b128 v[104:107], v6 offset:2048
  ds_read_b128 v[108:111], v6 offset:3072
  ds_read_b128 v[112:115], v6 offset:4096
  ds_read_b128 v[116:119], v6 offset:5120
  ds_read_b128 v[120:123], v6 offset:6144
  ds_read_b128 v[124:127], v6 offset:7168
  s_waitcnt lgkmcnt(6)
  v_mfma_f32_16x16x32_bf16 v[136:139], v[96:99], v[88:91], v[136:139]
  ds_read_b128 v[128:131], v6 offset:8192
  v_mfma_f32_16x16x32_bf16 v[140:143], v[100:103], v[88:91], v[140:143]
  ds_read_b128 v[132:135], v6 offset:9216
  s_waitcnt lgkmcnt(6)
  v_mfma_f32_16x16x32_bf16 v[144:147], v[104:107], v[88:91], v[144:147]
  ds_read_b128 v[96:99], v6 offset:10240
  v_mfma_f32_16x16x32_bf16 v[148:151], v[108:111], v[88:91], v[148:151]
  ds_read_b128 v[100:103], v6 offset:11264
  s_waitcnt lgkmcnt(6)
  v_mfma_f32_16x16x32_bf16 v[152:155], v[112:115], v[88:91], v[152:155]
  ds_read_b128 v[104:107], v6 offset:12288
  v_mfma_f32_16x16x32_bf16 v[156:159], v[116:119], v[88:91], v[156:159]
  ds_read_b128 v[108:111], v6 offset:13312
  s_waitcnt lgkmcnt(6)
  v_mfma_f32_16x16x32_bf16 v[160:163], v[120:123], v[88:91], v[160:163]
  ds_read_b128 v[112:115], v6 offset:14336
  v_mfma_f32_16x16x32_bf16 v[164:167], v[124:127], v[88:91], v[164:167]
  ds_read_b128 v[116:119], v6 offset:15360
  s_waitcnt lgkmcnt(6)
  v_mfma_f32_16x16x32_bf16 v[168:171], v[128:131], v[88:91], v[168:171]
  ds_read_b128 v[120:123], v6 offset:16384
  v_mfma_f32_16x16x32_bf16 v[172:175], v[132:135], v[88:91], v[172:175]
  ds_read_b128 v[124:127], v6 offset:17408
  s_waitcnt lgkmcnt(6)
  v_mfma_f32_16x16x32_bf16 v[176:179], v[88:91], v[96:99], v[176:179]
  ds_read_b128 v[128:131], v6 offset:18432
  v_mfma_f32_16x16x32_bf16 v[180:183], v[88:91], v[100:103], v[180:183]
  ds_read_b128 v[132:135], v6 offset:19456
  s_waitcnt lgkmcnt(6)
  v_mfma_f32_16x16x32_bf16 v[184:187], v[88:91], v[104:107], v[184:187]
  ds_read_b128 v[96:99], v6 offset:20480
  v_mfma_f32_16x16x32_bf16 v[188:191], v[88:91], v[108:111], v[188:191]
  ds_read_b128 v[100:103], v6 offset:21504
  s_waitcnt lgkmcnt(6)
  v_mfma_f32_16x16x32_bf16 v[192:195], v[88:91], v[112:115], v[192:195]
  ds_read_b128 v[104:107], v6 offset:22528
  v_mfma_f32_16x16x32_bf16 v[136:139], v[116:119], v[92:95], v[136:139]
  ds_read_b128 v[108:111], v6 offset:23552
  s_waitcnt lgkmcnt(6)
  v_mfma_f32_16x16x32_bf16 v[140:143], v[120:123], v[92:95], v[140:143]
  ds_read_b128 v[112:115], v6 offset:24576
  v_mfma_f32_16x16x32_bf16 v[144:147], v[124:127], v[92:95], v[144:147]
  ds_read_b128 v[116:119], v6 offset:25600
  s_waitcnt lgkmcnt(6)
  v_mfma_f32_16x16x32_bf16 v[148:151], v[128:131], v[92:95], v[148:151]
  ds_read_b128 v[120:123], v6 offset:26624
  v_mfma_f32_16x16x32_bf16 v[152:155], v[132:135], v[92:95], v[152:155]
  ds_read_b128 v[124:127], v6 offset:27648
  s_waitcnt lgkmcnt(6)
  v_mfma_f32_16x16x32_bf16 v[156:159], v[96:99], v[92:95], v[156:159]
  ds_read_b128 v[128:131], v6 offset:28672
  v_mfma_f32_16x16x32_bf16 v[160:163], v[100:103], v[92:95], v[160:163]
  ds_read_b128 v[132:135], v6 offset:29696
  s_waitcnt lgkmcnt(6)
  v_mfma_f32_16x16x32_bf16 v[164:167], v[104:107], v[92:95], v[164:167]
  v_mfma_f32_16x16x32_bf16 v[168:171], v[108:111], v[92:95], v[168:171]
  s_waitcnt lgkmcnt(4)
  v_mfma_f32_16x16x32_bf16 v[172:175], v[112:115], v[92:95], v[172:175]
  v_mfma_f32_16x16x32_bf16 v[176:179], v[92:95], v[116:119], v[176:179]
  s_waitcnt lgkmcnt(2)
  v_mfma_f32_16x16x32_bf16 v[180:183], v[92:95], v[120:123], v[180:183]
  v_mfma_f32_16x16x32_bf16 v[184:187], v[92:95], v[124:127], v[184:187]
  s_waitcnt lgkmcnt(0)
  v_mfma_f32_16x16x32_bf16 v[188:191], v[92:95], v[128:131], v[188:191]
  v_mfma_f32_16x16x32_bf16 v[192:195], v[92:95], v[132:135], v[192:195]
  v_max3_f32 v8, v156, v157, v158
  v_max3_f32 v8, v8, v159, v160
  v_max3_f32 v8, v8, v161, v162
  v_max3_f32 v8, v8, v163, v164
  v_max3_f32 v8, v8, v165, v166
  v_max3_f32 v8, v8, v167, v168
  v_max3_f32 v8, v8, v169, v170
  v_max3_f32 v8, v8, v171, v172
  v_max3_f32 v8, v8, v173, v174
  v_max_f32 v8, v8, v175
  v_min3_f32 v9, v156, v157, v158
  v_min3_f32 v9, v9, v159, v160
  v_min3_f32 v9, v9, v161, v162
  v_min3_f32 v9, v9, v163, v164
  v_min3_f32 v9, v9, v165, v166
  v_min3_f32 v9, v9, v167, v168
  v_min3_f32 v9, v9, v169, v170
  v_min3_f32 v9, v9, v171, v172
  v_min3_f32 v9, v9, v173, v174
  v_min_f32 v9, v9, v175
  v_mul_f32 v8, s31, v8
  v_mul_f32 v9, s31, v9
  v_fma_f32 v16, v156, s31, -v8
  v_fma_f32 v36, -v156, s31, v9
  v_fma_f32 v17, v157, s31, -v8
  v_fma_f32 v37, -v157, s31, v9
  v_fma_f32 v18, v158, s31, -v8
  v_fma_f32 v38, -v158, s31, v9
  v_fma_f32 v19, v159, s31, -v8
  v_fma_f32 v39, -v159, s31, v9
  v_fma_f32 v20, v160, s31, -v8
  v_fma_f32 v40, -v160, s31, v9
  v_fma_f32 v21, v161, s31, -v8
  v_fma_f32 v41, -v161, s31, v9
  v_fma_f32 v22, v162, s31, -v8
  v_fma_f32 v42, -v162, s31, v9
  v_fma_f32 v23, v163, s31, -v8
  v_fma_f32 v43, -v163, s31, v9
  v_fma_f32 v24, v164, s31, -v8
  v_fma_f32 v44, -v164, s31, v9
  v_fma_f32 v25, v165, s31, -v8
  v_fma_f32 v45, -v165, s31, v9
  v_fma_f32 v26, v166, s31, -v8
  v_fma_f32 v46, -v166, s31, v9
  v_fma_f32 v27, v167, s31, -v8
  v_fma_f32 v47, -v167, s31, v9
  v_fma_f32 v28, v168, s31, -v8
  v_fma_f32 v48, -v168, s31, v9
  v_fma_f32 v29, v169, s31, -v8
  v_fma_f32 v49, -v169, s31, v9
  v_fma_f32 v30, v170, s31, -v8
  v_fma_f32 v50, -v170, s31, v9
  v_fma_f32 v31, v171, s31, -v8
  v_fma_f32 v51, -v171, s31, v9
  v_fma_f32 v32, v172, s31, -v8
  v_fma_f32 v52, -v172, s31, v9
  v_fma_f32 v33, v173, s31, -v8
  v_fma_f32 v53, -v173, s31, v9
  v_fma_f32 v34, v174, s31, -v8
  v_fma_f32 v54, -v174, s31, v9
  v_fma_f32 v35, v175, s31, -v8
  v_fma_f32 v55, -v175, s31, v9
  v_exp_f32 v16, v16
  v_exp_f32 v17, v17
  v_exp_f32 v18, v18
  v_exp_f32 v19, v19
  v_exp_f32 v20, v20
  v_exp_f32 v21, v21
  v_exp_f32 v22, v22
  v_exp_f32 v23, v23
  v_exp_f32 v24, v24
  v_exp_f32 v25, v25
  v_exp_f32 v26, v26
  v_exp_f32 v27, v27
  v_exp_f32 v28, v28
  v_exp_f32 v29, v29
  v_exp_f32 v30, v30
  v_exp_f32 v31, v31
  v_exp_f32 v32, v32
  v_exp_f32 v33, v33
  v_exp_f32 v34, v34
  v_exp_f32 v35, v35
  v_exp_f32 v36, v36
  v_exp_f32 v37, v37
  v_exp_f32 v38, v38
  v_exp_f32 v39, v39
  v_exp_f32 v40, v40
  v_exp_f32 v41, v41
  v_exp_f32 v42, v42
  v_exp_f32 v43, v43
  v_exp_f32 v44, v44
  v_exp_f32 v45, v45
  v_exp_f32 v46, v46
  v_exp_f32 v47, v47
  v_exp_f32 v48, v48
  v_exp_f32 v49, v49
  v_exp_f32 v50, v50
  v_exp_f32 v51, v51
  v_exp_f32 v52, v52
  v_exp_f32 v53, v53
  v_exp_f32 v54, v54
  v_exp_f32 v55, v55
  v_pk_add_f32 v[8:9], v[16:17], v[18:19]
  v_pk_add_f32 v[8:9], v[8:9], v[20:21]
  v_pk_add_f32 v[8:9], v[8:9], v[22:23]
  v_pk_add_f32 v[8:9], v[8:9], v[24:25]
  v_pk_add_f32 v[8:9], v[8:9], v[26:27]
  v_pk_add_f32 v[8:9], v[8:9], v[28:29]
  v_pk_add_f32 v[8:9], v[8:9], v[30:31]
  v_pk_add_f32 v[8:9], v[8:9], v[32:33]
  v_pk_add_f32 v[8:9], v[8:9], v[34:35]
  v_add_f32 v8, v8, v9
  v_rcp_f32 v8, v8
  s_nop 0
  v_mov_b32 v9, v8
  v_pk_mul_f32 v[16:17], v[16:17], v[8:9]
  v_cvt_pk_bf16_f32 v56, v16, v17
  v_pk_mul_f32 v[18:19], v[18:19], v[8:9]
  v_cvt_pk_bf16_f32 v57, v18, v19
  v_pk_mul_f32 v[20:21], v[20:21], v[8:9]
  v_cvt_pk_bf16_f32 v58, v20, v21
  v_pk_mul_f32 v[22:23], v[22:23], v[8:9]
  v_cvt_pk_bf16_f32 v59, v22, v23
  v_pk_mul_f32 v[24:25], v[24:25], v[8:9]
  v_cvt_pk_bf16_f32 v60, v24, v25
  v_pk_mul_f32 v[26:27], v[26:27], v[8:9]
  v_cvt_pk_bf16_f32 v61, v26, v27
  v_pk_mul_f32 v[28:29], v[28:29], v[8:9]
  v_cvt_pk_bf16_f32 v62, v28, v29
  v_pk_mul_f32 v[30:31], v[30:31], v[8:9]
  v_cvt_pk_bf16_f32 v63, v30, v31
  v_pk_mul_f32 v[32:33], v[32:33], v[8:9]
  v_cvt_pk_bf16_f32 v64, v32, v33
  v_pk_mul_f32 v[34:35], v[34:35], v[8:9]
  v_cvt_pk_bf16_f32 v65, v34, v35
  v_pk_add_f32 v[10:11], v[36:37], v[38:39]
  v_pk_add_f32 v[10:11], v[10:11], v[40:41]
  v_pk_add_f32 v[10:11], v[10:11], v[42:43]
  v_pk_add_f32 v[10:11], v[10:11], v[44:45]
  v_pk_add_f32 v[10:11], v[10:11], v[46:47]
  v_pk_add_f32 v[10:11], v[10:11], v[48:49]
  v_pk_add_f32 v[10:11], v[10:11], v[50:51]
  v_pk_add_f32 v[10:11], v[10:11], v[52:53]
  v_pk_add_f32 v[10:11], v[10:11], v[54:55]
  v_add_f32 v10, v10, v11
  v_rcp_f32 v10, v10
  s_nop 0
  v_mov_b32 v11, v10
  v_pk_mul_f32 v[36:37], v[36:37], v[10:11]
  v_cvt_pk_bf16_f32 v66, v36, v37
  v_pk_mul_f32 v[38:39], v[38:39], v[10:11]
  v_cvt_pk_bf16_f32 v67, v38, v39
  v_pk_mul_f32 v[40:41], v[40:41], v[10:11]
  v_cvt_pk_bf16_f32 v68, v40, v41
  v_pk_mul_f32 v[42:43], v[42:43], v[10:11]
  v_cvt_pk_bf16_f32 v69, v42, v43
  v_pk_mul_f32 v[44:45], v[44:45], v[10:11]
  v_cvt_pk_bf16_f32 v70, v44, v45
  v_pk_mul_f32 v[46:47], v[46:47], v[10:11]
  v_cvt_pk_bf16_f32 v71, v46, v47
  v_pk_mul_f32 v[48:49], v[48:49], v[10:11]
  v_cvt_pk_bf16_f32 v72, v48, v49
  v_pk_mul_f32 v[50:51], v[50:51], v[10:11]
  v_cvt_pk_bf16_f32 v73, v50, v51
  v_pk_mul_f32 v[52:53], v[52:53], v[10:11]
  v_cvt_pk_bf16_f32 v74, v52, v53
  v_pk_mul_f32 v[54:55], v[54:55], v[10:11]
  v_cvt_pk_bf16_f32 v75, v54, v55
  s_lshl_b32 s14, s3, 2
  v_add_u32 v7, s14, v5
  v_mul_u32_u24 v7, 1536, v7
  v_mul_u32_u24 v12, 96, v4
  v_add3_u32 v7, v7, v12, v3
  v_sub_u32 v7, v7, v2
  ds_write_b128 v7, v[56:59] offset:0
  ds_write_b128 v7, v[60:63] offset:16
  ds_write_b128 v7, v[64:67] offset:32
  ds_write_b128 v7, v[68:71] offset:48
  ds_write_b128 v7, v[72:75] offset:64
  v_lshlrev_b32 v12, 3, v1
  s_mul_i32 s14, s3, 2560
  s_add_u32 s14, s14, 86016
  v_add_u32 v13, s14, v12
  v_cvt_pk_bf16_f32 v176, v176, v177
  v_cvt_pk_bf16_f32 v177, v178, v179
  ds_write_b64 v13, v[176:177] offset:0
  v_cvt_pk_bf16_f32 v180, v180, v181
  v_cvt_pk_bf16_f32 v181, v182, v183
  ds_write_b64 v13, v[180:181] offset:512
  v_cvt_pk_bf16_f32 v184, v184, v185
  v_cvt_pk_bf16_f32 v185, v186, v187
  ds_write_b64 v13, v[184:185] offset:1024
  v_cvt_pk_bf16_f32 v188, v188, v189
  v_cvt_pk_bf16_f32 v189, v190, v191
  ds_write_b64 v13, v[188:189] offset:1536
  v_cvt_pk_bf16_f32 v192, v192, v193
  v_cvt_pk_bf16_f32 v193, v194, v195
  ds_write_b64 v13, v[192:193] offset:2048
  v_max3_f32 v8, v136, v137, v138
  v_max3_f32 v8, v8, v139, v140
  v_max3_f32 v8, v8, v141, v142
  v_max3_f32 v8, v8, v143, v144
  v_max3_f32 v8, v8, v145, v146
  v_max3_f32 v8, v8, v147, v148
  v_max3_f32 v8, v8, v149, v150
  v_max3_f32 v8, v8, v151, v152
  v_max3_f32 v8, v8, v153, v154
  v_max_f32 v8, v8, v155
  v_min3_f32 v9, v136, v137, v138
  v_min3_f32 v9, v9, v139, v140
  v_min3_f32 v9, v9, v141, v142
  v_min3_f32 v9, v9, v143, v144
  v_min3_f32 v9, v9, v145, v146
  v_min3_f32 v9, v9, v147, v148
  v_min3_f32 v9, v9, v149, v150
  v_min3_f32 v9, v9, v151, v152
  v_min3_f32 v9, v9, v153, v154
  v_min_f32 v9, v9, v155
  v_mul_f32 v8, s31, v8
  v_mul_f32 v9, s31, v9
  v_fma_f32 v16, v136, s31, -v8
  v_fma_f32 v36, -v136, s31, v9
  v_fma_f32 v17, v137, s31, -v8
  v_fma_f32 v37, -v137, s31, v9
  v_fma_f32 v18, v138, s31, -v8
  v_fma_f32 v38, -v138, s31, v9
  v_fma_f32 v19, v139, s31, -v8
  v_fma_f32 v39, -v139, s31, v9
  v_fma_f32 v20, v140, s31, -v8
  v_fma_f32 v40, -v140, s31, v9
  v_fma_f32 v21, v141, s31, -v8
  v_fma_f32 v41, -v141, s31, v9
  v_fma_f32 v22, v142, s31, -v8
  v_fma_f32 v42, -v142, s31, v9
  v_fma_f32 v23, v143, s31, -v8
  v_fma_f32 v43, -v143, s31, v9
  v_fma_f32 v24, v144, s31, -v8
  v_fma_f32 v44, -v144, s31, v9
  v_fma_f32 v25, v145, s31, -v8
  v_fma_f32 v45, -v145, s31, v9
  v_fma_f32 v26, v146, s31, -v8
  v_fma_f32 v46, -v146, s31, v9
  v_fma_f32 v27, v147, s31, -v8
  v_fma_f32 v47, -v147, s31, v9
  v_fma_f32 v28, v148, s31, -v8
  v_fma_f32 v48, -v148, s31, v9
  v_fma_f32 v29, v149, s31, -v8
  v_fma_f32 v49, -v149, s31, v9
  v_fma_f32 v30, v150, s31, -v8
  v_fma_f32 v50, -v150, s31, v9
  v_fma_f32 v31, v151, s31, -v8
  v_fma_f32 v51, -v151, s31, v9
  v_fma_f32 v32, v152, s31, -v8
  v_fma_f32 v52, -v152, s31, v9
  v_fma_f32 v33, v153, s31, -v8
  v_fma_f32 v53, -v153, s31, v9
  v_fma_f32 v34, v154, s31, -v8
  v_fma_f32 v54, -v154, s31, v9
  v_fma_f32 v35, v155, s31, -v8
  v_fma_f32 v55, -v155, s31, v9
  v_exp_f32 v16, v16
  v_exp_f32 v17, v17
  v_exp_f32 v18, v18
  v_exp_f32 v19, v19
  v_exp_f32 v20, v20
  v_exp_f32 v21, v21
  v_exp_f32 v22, v22
  v_exp_f32 v23, v23
  v_exp_f32 v24, v24
  v_exp_f32 v25, v25
  v_exp_f32 v26, v26
  v_exp_f32 v27, v27
  v_exp_f32 v28, v28
  v_exp_f32 v29, v29
  v_exp_f32 v30, v30
  v_exp_f32 v31, v31
  v_exp_f32 v32, v32
  v_exp_f32 v33, v33
  v_exp_f32 v34, v34
  v_exp_f32 v35, v35
  v_exp_f32 v36, v36
  v_exp_f32 v37, v37
  v_exp_f32 v38, v38
  v_exp_f32 v39, v39
  v_exp_f32 v40, v40
  v_exp_f32 v41, v41
  v_exp_f32 v42, v42
  v_exp_f32 v43, v43
  v_exp_f32 v44, v44
  v_exp_f32 v45, v45
  v_exp_f32 v46, v46
  v_exp_f32 v47, v47
  v_exp_f32 v48, v48
  v_exp_f32 v49, v49
  v_exp_f32 v50, v50
  v_exp_f32 v51, v51
  v_exp_f32 v52, v52
  v_exp_f32 v53, v53
  v_exp_f32 v54, v54
  v_exp_f32 v55, v55
  v_pk_add_f32 v[8:9], v[16:17], v[18:19]
  v_pk_add_f32 v[8:9], v[8:9], v[20:21]
  v_pk_add_f32 v[8:9], v[8:9], v[22:23]
  v_pk_add_f32 v[8:9], v[8:9], v[24:25]
  v_pk_add_f32 v[8:9], v[8:9], v[26:27]
  v_pk_add_f32 v[8:9], v[8:9], v[28:29]
  v_pk_add_f32 v[8:9], v[8:9], v[30:31]
  v_pk_add_f32 v[8:9], v[8:9], v[32:33]
  v_pk_add_f32 v[8:9], v[8:9], v[34:35]
  v_add_f32 v8, v8, v9
  v_rcp_f32 v8, v8
  s_nop 0
  v_mov_b32 v9, v8
  v_pk_mul_f32 v[16:17], v[16:17], v[8:9]
  v_cvt_pk_bf16_f32 v76, v16, v17
  v_pk_mul_f32 v[18:19], v[18:19], v[8:9]
  v_cvt_pk_bf16_f32 v77, v18, v19
  v_pk_mul_f32 v[20:21], v[20:21], v[8:9]
  v_cvt_pk_bf16_f32 v78, v20, v21
  v_pk_mul_f32 v[22:23], v[22:23], v[8:9]
  v_cvt_pk_bf16_f32 v79, v22, v23
  v_pk_mul_f32 v[24:25], v[24:25], v[8:9]
  v_cvt_pk_bf16_f32 v80, v24, v25
  v_pk_mul_f32 v[26:27], v[26:27], v[8:9]
  v_cvt_pk_bf16_f32 v81, v26, v27
  v_pk_mul_f32 v[28:29], v[28:29], v[8:9]
  v_cvt_pk_bf16_f32 v82, v28, v29
  v_pk_mul_f32 v[30:31], v[30:31], v[8:9]
  v_cvt_pk_bf16_f32 v83, v30, v31
  v_pk_mul_f32 v[32:33], v[32:33], v[8:9]
  v_cvt_pk_bf16_f32 v84, v32, v33
  v_pk_mul_f32 v[34:35], v[34:35], v[8:9]
  v_cvt_pk_bf16_f32 v85, v34, v35
  v_pk_add_f32 v[10:11], v[36:37], v[38:39]
  v_pk_add_f32 v[10:11], v[10:11], v[40:41]
  v_pk_add_f32 v[10:11], v[10:11], v[42:43]
  v_pk_add_f32 v[10:11], v[10:11], v[44:45]
  v_pk_add_f32 v[10:11], v[10:11], v[46:47]
  v_pk_add_f32 v[10:11], v[10:11], v[48:49]
  v_pk_add_f32 v[10:11], v[10:11], v[50:51]
  v_pk_add_f32 v[10:11], v[10:11], v[52:53]
  v_pk_add_f32 v[10:11], v[10:11], v[54:55]
  v_add_f32 v10, v10, v11
  v_rcp_f32 v10, v10
  s_nop 0
  v_mov_b32 v11, v10
  v_pk_mul_f32 v[36:37], v[36:37], v[10:11]
  v_cvt_pk_bf16_f32 v86, v36, v37
  v_pk_mul_f32 v[38:39], v[38:39], v[10:11]
  v_cvt_pk_bf16_f32 v87, v38, v39
  v_pk_mul_f32 v[40:41], v[40:41], v[10:11]
  v_cvt_pk_bf16_f32 v88, v40, v41
  v_pk_mul_f32 v[42:43], v[42:43], v[10:11]
  v_cvt_pk_bf16_f32 v89, v42, v43
  v_pk_mul_f32 v[44:45], v[44:45], v[10:11]
  v_cvt_pk_bf16_f32 v90, v44, v45
  v_pk_mul_f32 v[46:47], v[46:47], v[10:11]
  v_cvt_pk_bf16_f32 v91, v46, v47
  v_pk_mul_f32 v[48:49], v[48:49], v[10:11]
  v_cvt_pk_bf16_f32 v92, v48, v49
  v_pk_mul_f32 v[50:51], v[50:51], v[10:11]
  v_cvt_pk_bf16_f32 v93, v50, v51
  v_pk_mul_f32 v[52:53], v[52:53], v[10:11]
  v_cvt_pk_bf16_f32 v94, v52, v53
  v_pk_mul_f32 v[54:55], v[54:55], v[10:11]
  v_cvt_pk_bf16_f32 v95, v54, v55
  s_lshl_b32 s14, s10, 3
  s_add_u32 s14, s14, s9
  s_mul_i32 s14, s14, 5120
  s_add_u32 s14, s14, 44466176
  s_add_u32 s15, s14, 4096
  buffer_store_dwordx4 v[76:79], v2, s[4:7], s14 offen offset:0
  buffer_store_dwordx4 v[80:83], v2, s[4:7], s14 offen offset:1024
  buffer_store_dwordx4 v[84:87], v2, s[4:7], s14 offen offset:2048
  buffer_store_dwordx4 v[88:91], v2, s[4:7], s14 offen offset:3072
  buffer_store_dwordx4 v[92:95], v2, s[4:7], s15 offen offset:0
  s_waitcnt lgkmcnt(0)
  s_barrier
  v_lshrrev_b32 v7, 2, v1
  v_mul_u32_u24 v7, 96, v7
  v_and_b32 v13, 3, v1
  v_lshl_add_u32 v7, v13, 3, v7
  s_mul_i32 s14, s3, 1536
  s_add_u32 s14, s14, 61440
  v_add_u32 v7, s14, v7
  s_lshl_b32 s14, s3, 9
  s_add_u32 s14, s14, 86016
  v_add_u32 v13, s14, v12
  ds_read_b64_tr_b16 v[96:97], v7 offset:0
  ds_read_b64_tr_b16 v[98:99], v7 offset:6144
  ds_read_b64_tr_b16 v[100:101], v7 offset:32
  ds_read_b64_tr_b16 v[102:103], v7 offset:6176
  ds_read_b64_tr_b16 v[104:105], v7 offset:64
  ds_read_b64_tr_b16 v[106:107], v7 offset:6208
  ds_read_b64 v[120:121], v13 offset:0
  ds_read_b64 v[122:123], v13 offset:2560
  ds_read_b64 v[124:125], v13 offset:512
  ds_read_b64 v[126:127], v13 offset:3072
  ds_read_b64_tr_b16 v[108:109], v7 offset:12288
  ds_read_b64_tr_b16 v[110:111], v7 offset:18432
  ds_read_b64_tr_b16 v[112:113], v7 offset:12320
  ds_read_b64_tr_b16 v[114:115], v7 offset:18464
  ds_read_b64_tr_b16 v[116:117], v7 offset:12352
  ds_read_b64_tr_b16 v[118:119], v7 offset:18496
  ds_read_b64 v[128:129], v13 offset:5120
  ds_read_b64 v[130:131], v13 offset:7680
  ds_read_b64 v[132:133], v13 offset:5632
  ds_read_b64 v[134:135], v13 offset:8192
  s_mov_b32 s16, 0x80008000
  s_mov_b32 s17, 0x00010001
  s_cmp_lt_u32 s3, 3
  s_cselect_b32 s18, 0, s17
  s_cselect_b32 s19, 0, s17
  s_cselect_b32 s20, s16, 0
  s_cselect_b32 s21, s16, 0
  v_mov_b32 v14, 0x3f803f80
  s_waitcnt lgkmcnt(0)
  v_cndmask_b32 v120, v120, v14, s[18:19]
  v_cndmask_b32 v121, v121, v14, s[18:19]
  v_cndmask_b32 v122, v122, v14, s[18:19]
  v_cndmask_b32 v123, v123, v14, s[18:19]
  v_cndmask_b32 v124, v124, v14, s[20:21]
  v_cndmask_b32 v125, v125, v14, s[20:21]
  v_cndmask_b32 v126, v126, v14, s[20:21]
  v_cndmask_b32 v127, v127, v14, s[20:21]
  v_cndmask_b32 v128, v128, v14, s[18:19]
  v_cndmask_b32 v129, v129, v14, s[18:19]
  v_cndmask_b32 v130, v130, v14, s[18:19]
  v_cndmask_b32 v131, v131, v14, s[18:19]
  v_cndmask_b32 v132, v132, v14, s[20:21]
  v_cndmask_b32 v133, v133, v14, s[20:21]
  v_cndmask_b32 v134, v134, v14, s[20:21]
  v_cndmask_b32 v135, v135, v14, s[20:21]
  v_mfma_f32_16x16x32_bf16 v[136:139], v[96:99], v[120:123], 0
  v_mfma_f32_16x16x32_bf16 v[140:143], v[96:99], v[124:127], 0
  v_mfma_f32_16x16x32_bf16 v[144:147], v[100:103], v[120:123], 0
  v_mfma_f32_16x16x32_bf16 v[148:151], v[100:103], v[124:127], 0
  v_mfma_f32_16x16x32_bf16 v[152:155], v[104:107], v[120:123], 0
  v_mfma_f32_16x16x32_bf16 v[156:159], v[104:107], v[124:127], 0
  v_mfma_f32_16x16x32_bf16 v[136:139], v[108:111], v[128:131], v[136:139]
  v_mfma_f32_16x16x32_bf16 v[140:143], v[108:111], v[132:135], v[140:143]
  v_mfma_f32_16x16x32_bf16 v[144:147], v[112:115], v[128:131], v[144:147]
  v_mfma_f32_16x16x32_bf16 v[148:151], v[112:115], v[132:135], v[148:151]
  v_mfma_f32_16x16x32_bf16 v[152:155], v[116:119], v[128:131], v[152:155]
  v_mfma_f32_16x16x32_bf16 v[156:159], v[116:119], v[132:135], v[156:159]
  s_lshl_b32 s14, s8, 3
  s_add_u32 s14, s14, s9
  s_lshl_b32 s14, s14, 2
  s_add_u32 s14, s14, s3
  s_mul_i32 s14, s14, 6144
  s_add_u32 s14, s14, 49709056
  s_add_u32 s15, s14, 4096
  buffer_store_dwordx4 v[136:139], v2, s[4:7], s14 offen offset:0
  buffer_store_dwordx4 v[140:143], v2, s[4:7], s14 offen offset:1024
  buffer_store_dwordx4 v[144:147], v2, s[4:7], s14 offen offset:2048
  buffer_store_dwordx4 v[148:151], v2, s[4:7], s14 offen offset:3072
  buffer_store_dwordx4 v[152:155], v2, s[4:7], s15 offen offset:0
  buffer_store_dwordx4 v[156:159], v2, s[4:7], s15 offen offset:1024
b1_end:
  s_endpgm

.globl bred_kernel
.p2align 8
.type bred_kernel,@function
bred_kernel:
  s_load_dwordx2 s[4:5], s[0:1], 104
  s_mov_b32 s6, 0x10000000
  s_mov_b32 s7, 0x20000
  s_cmp_ge_u32 s2, 105
  s_cbranch_scc1 bred_end
  s_lshl_b32 s8, s2, 8
  v_add_u32 v1, s8, v0
  v_lshrrev_b32 v2, 2, v1
  v_and_b32 v3, 3, v1
  s_mov_b32 s9, 0x1381382
  v_mul_hi_u32 v4, v2, s9
  v_mul_u32_u24 v5, 210, v4
  v_sub_u32 v5, v2, v5
  v_mul_u32_u24 v6, 205, v5
  v_lshrrev_b32 v6, 11, v6
  v_mul_u32_u24 v7, 10, v6
  v_sub_u32 v7, v5, v7
  v_and_b32 v8, 3, v4
  v_lshl_add_u32 v9, v8, 2, v6
  v_cmp_gt_u32 vcc, 3, v8
  s_nop 1
  v_cndmask_b32 v10, 0, 31, vcc
  v_cmp_eq_u32 vcc, 20, v6
  s_nop 1
  v_cndmask_b32 v9, v9, v10, vcc
  v_lshrrev_b32 v10, 4, v9
  v_and_b32 v9, 15, v9
  v_lshrrev_b32 v11, 2, v7
  v_lshl_add_u32 v10, v11, 1, v10
  v_lshlrev_b32 v10, 10, v10
  v_lshl_add_u32 v10, v9, 4, v10
  v_and_b32 v11, 3, v7
  v_lshl_add_u32 v10, v11, 8, v10
  v_mul_u32_u24 v11, 6144, v4
  v_add_u32 v10, v10, v11
  v_mul_u32_u24 v11, 1572864, v3
  v_add_u32 v10, v10, v11
  s_mov_b32 s10, 49709056
  s_waitcnt lgkmcnt(0)
  buffer_load_dwordx4 v[16:19], v10, s[4:7], s10 offen
  s_add_u32 s10, s10, 196608
  buffer_load_dwordx4 v[20:23], v10, s[4:7], s10 offen
  s_add_u32 s10, s10, 196608
  buffer_load_dwordx4 v[24:27], v10, s[4:7], s10 offen
  s_add_u32 s10, s10, 196608
  buffer_load_dwordx4 v[28:31], v10, s[4:7], s10 offen
  s_add_u32 s10, s10, 196608
  buffer_load_dwordx4 v[32:35], v10, s[4:7], s10 offen
  s_add_u32 s10, s10, 196608
  buffer_load_dwordx4 v[36:39], v10, s[4:7], s10 offen
  s_add_u32 s10, s10, 196608
  buffer_load_dwordx4 v[40:43], v10, s[4:7], s10 offen
  s_add_u32 s10, s10, 196608
  buffer_load_dwordx4 v[44:47], v10, s[4:7], s10 offen
  v_lshrrev_b32 v11, 2, v4
  v_mul_u32_u24 v11, 6, v11
  v_lshrrev_b32 v12, 2, v6
  v_add_u32 v11, v11, v12
  v_mul_u32_u24 v11, 5, v11
  v_lshrrev_b32 v12, 1, v7
  v_add_u32 v11, v11, v12
  v_lshlrev_b32 v11, 8, v11
  v_lshl_add_u32 v11, v8, 6, v11
  v_and_b32 v12, 3, v6
  v_lshl_add_u32 v11, v12, 4, v11
  v_and_b32 v12, 1, v7
  v_lshl_add_u32 v11, v12, 3, v11
  s_mov_b32 s10, 97783808
  s_mov_b32 s12, 0x11111111
  s_mov_b32 s13, 0x11111111
  s_waitcnt vmcnt(0)
  v_pk_add_f32 v[16:17], v[16:17], v[32:33]
  v_pk_add_f32 v[18:19], v[18:19], v[34:35]
  v_pk_add_f32 v[20:21], v[20:21], v[36:37]
  v_pk_add_f32 v[22:23], v[22:23], v[38:39]
  v_pk_add_f32 v[24:25], v[24:25], v[40:41]
  v_pk_add_f32 v[26:27], v[26:27], v[42:43]
  v_pk_add_f32 v[28:29], v[28:29], v[44:45]
  v_pk_add_f32 v[30:31], v[30:31], v[46:47]
  v_pk_add_f32 v[16:17], v[16:17], v[24:25]
  v_pk_add_f32 v[18:19], v[18:19], v[26:27]
  v_pk_add_f32 v[20:21], v[20:21], v[28:29]
  v_pk_add_f32 v[22:23], v[22:23], v[30:31]
  v_pk_add_f32 v[16:17], v[16:17], v[20:21]
  v_pk_add_f32 v[18:19], v[18:19], v[22:23]
  s_nop 0
  v_add_f32_dpp v16, v16, v16 quad_perm:[1,0,3,2] row_mask:0xf bank_mask:0xf
  v_add_f32_dpp v17, v17, v17 quad_perm:[1,0,3,2] row_mask:0xf bank_mask:0xf
  v_add_f32_dpp v18, v18, v18 quad_perm:[1,0,3,2] row_mask:0xf bank_mask:0xf
  v_add_f32_dpp v19, v19, v19 quad_perm:[1,0,3,2] row_mask:0xf bank_mask:0xf
  v_add_f32_dpp v16, v16, v16 quad_perm:[2,3,0,1] row_mask:0xf bank_mask:0xf
  v_add_f32_dpp v17, v17, v17 quad_perm:[2,3,0,1] row_mask:0xf bank_mask:0xf
  v_add_f32_dpp v18, v18, v18 quad_perm:[2,3,0,1] row_mask:0xf bank_mask:0xf
  v_add_f32_dpp v19, v19, v19 quad_perm:[2,3,0,1] row_mask:0xf bank_mask:0xf
  v_cvt_pk_bf16_f32 v16, v16, v17
  v_cvt_pk_bf16_f32 v17, v18, v19
  s_mov_b64 exec, s[12:13]
  buffer_store_dwordx2 v[16:17], v11, s[4:7], s10 offen
bred_end:
  s_endpgm

.globl b2_kernel
.p2align 8
.type b2_kernel,@function
b2_kernel:
  s_load_dwordx2 s[4:5], s[0:1], 104
  s_mov_b32 s6, 0x10000000
  s_mov_b32 s7, 0x20000
  s_load_dwordx2 s[24:25], s[0:1], 96
  s_mov_b32 s26, 0x100
  s_mov_b32 s27, 0x20000
  v_lshrrev_b32 v1, 6, v0
  s_nop 0
  v_readfirstlane_b32 s3, v1
  v_and_b32 v1, 63, v0
  s_cmp_ge_u32 s2, 256
  s_cbranch_scc1 b2_kernel_end
  s_and_b32 s8, s2, 7
  s_lshl_b32 s8, s8, 3
  s_lshr_b32 s9, s2, 5
  s_add_u32 s8, s8, s9
  s_bfe_u32 s9, s2, 0x20003
  v_lshlrev_b32 v2, 4, v1
  v_and_b32 v4, 15, v1
  v_lshrrev_b32 v5, 4, v1
  v_mul_u32_u24 v6, 1280, v4
  v_lshl_add_u32 v6, v5, 4, v6
  s_mul_i32 s10, s9, 5
  s_add_u32 s10, s10, s3
  s_mul_i32 s11, s8, 40960
  s_lshl_b32 s12, s10, 6
  s_add_u32 s11, s11, s12
  s_mul_i32 s12, s8, 40
  s_add_u32 s12, s12, s10
  s_lshl_b32 s12, s12, 10
  s_add_u32 s22, s12, 26214400
  s_add_u32 s12, s12, 56000512
  s_mul_i32 s14, s10, 40960
  s_add_u32 s14, s14, 96964608
  v_add_u32 v3, 20480, v2
  v_lshrrev_b32 v7, 2, v4
  v_cmp_eq_u32 vcc, v7, v5
  v_lshlrev_b32 v7, 4, v4
  s_mov_b64 s[20:21], vcc
  s_mul_i32 s15, s3, 15360
  s_add_u32 s15, s15, 40960
  v_add_u32 v7, s15, v7
  s_waitcnt lgkmcnt(0)
  s_cmp_eq_u32 s3, 4
  s_cbranch_scc1 b2_kernel_ph2
  s_mul_i32 s16, s3, 15360
  s_add_u32 s16, s16, 97783808
  s_mov_b32 m0, s15
  s_nop 0
  buffer_load_dwordx4 v2, s[4:7], s16 offen offset:0 lds
  buffer_load_dwordx4 v2, s[4:7], s16 offen offset:1024 lds
  buffer_load_dwordx4 v2, s[4:7], s16 offen offset:2048 lds
  buffer_load_dwordx4 v2, s[4:7], s16 offen offset:3072 lds
  s_add_u32 s15, s15, 4096
  s_add_u32 s16, s16, 4096
  s_mov_b32 m0, s15
  s_nop 0
  buffer_load_dwordx4 v2, s[4:7], s16 offen offset:0 lds
  buffer_load_dwordx4 v2, s[4:7], s16 offen offset:1024 lds
  buffer_load_dwordx4 v2, s[4:7], s16 offen offset:2048 lds
  buffer_load_dwordx4 v2, s[4:7], s16 offen offset:3072 lds
  s_add_u32 s15, s15, 4096
  s_add_u32 s16, s16, 4096
  s_mov_b32 m0, s15
  s_nop 0
  buffer_load_dwordx4 v2, s[4:7], s16 offen offset:0 lds
  buffer_load_dwordx4 v2, s[4:7], s16 offen offset:1024 lds
  buffer_load_dwordx4 v2, s[4:7], s16 offen offset:2048 lds
  buffer_load_dwordx4 v2, s[4:7], s16 offen offset:3072 lds
  s_add_u32 s15, s15, 4096
  s_add_u32 s16, s16, 4096
  s_mov_b32 m0, s15
  s_nop 0
  buffer_load_dwordx4 v2, s[4:7], s16 offen offset:0 lds
  buffer_load_dwordx4 v2, s[4:7], s16 offen offset:1024 lds
  buffer_load_dwordx4 v2, s[4:7], s16 offen offset:2048 lds
  s_lshl_b32 s15, s8, 4
  s_lshl_b32 s16, s3, 1
  s_add_u32 s15, s15, s16
  s_mul_i32 s15, s15, 5120
  s_add_u32 s15, s15, 44466176
  s_add_u32 s17, s15, 0
  s_add_u32 s18, s17, 4096
  buffer_load_dwordx4 v[56:59], v2, s[4:7], s17 offen offset:0
  buffer_load_dwordx4 v[60:63], v2, s[4:7], s17 offen offset:1024
  buffer_load_dwordx4 v[64:67], v2, s[4:7], s17 offen offset:2048
  buffer_load_dwordx4 v[68:71], v2, s[4:7], s17 offen offset:3072
  buffer_load_dwordx4 v[72:75], v2, s[4:7], s18 offen offset:0
  s_add_u32 s17, s15, 40960
  s_add_u32 s18, s17, 4096
  buffer_load_dwordx4 v[96:99], v2, s[4:7], s17 offen offset:0
  buffer_load_dwordx4 v[100:103], v2, s[4:7], s17 offen offset:1024
  buffer_load_dwordx4 v[104:107], v2, s[4:7], s17 offen offset:2048
  buffer_load_dwordx4 v[108:111], v2, s[4:7], s17 offen offset:3072
  buffer_load_dwordx4 v[112:115], v2, s[4:7], s18 offen offset:0
  s_add_u32 s17, s15, 5120
  s_add_u32 s18, s17, 4096
  buffer_load_dwordx4 v[76:79], v2, s[4:7], s17 offen offset:0
  buffer_load_dwordx4 v[80:83], v2, s[4:7], s17 offen offset:1024
  buffer_load_dwordx4 v[84:87], v2, s[4:7], s17 offen offset:2048
  buffer_load_dwordx4 v[88:91], v2, s[4:7], s17 offen offset:3072
  buffer_load_dwordx4 v[92:95], v2, s[4:7], s18 offen offset:0
  s_add_u32 s17, s15, 46080
  s_add_u32 s18, s17, 4096
  buffer_load_dwordx4 v[116:119], v2, s[4:7], s17 offen offset:0
  buffer_load_dwordx4 v[120:123], v2, s[4:7], s17 offen offset:1024
  buffer_load_dwordx4 v[124:127], v2, s[4:7], s17 offen offset:2048
  buffer_load_dwordx4 v[128:131], v2, s[4:7], s17 offen offset:3072
  buffer_load_dwordx4 v[132:135], v2, s[4:7], s18 offen offset:0
  buffer_load_dwordx4 v[24:27], v2, s[4:7], s14 offen
  buffer_load_dwordx4 v[28:31], v3, s[4:7], s14 offen
  s_add_u32 s14, s14, 1024
  buffer_load_dwordx4 v[32:35], v2, s[4:7], s14 offen
  buffer_load_dwordx4 v[36:39], v3, s[4:7], s14 offen
  s_add_u32 s14, s14, 1024
  buffer_load_dwordx4 v[40:43], v2, s[4:7], s14 offen
  buffer_load_dwordx4 v[44:47], v3, s[4:7], s14 offen
  s_add_u32 s14, s14, 1024
  buffer_load_dwordx4 v[48:51], v2, s[4:7], s14 offen
  buffer_load_dwordx4 v[52:55], v3, s[4:7], s14 offen
  s_add_u32 s14, s14, 1024
  v_mov_b32 v136, 0
  v_mov_b32 v137, 0
  v_mov_b32 v138, 0
  v_mov_b32 v139, 0
  v_mov_b32 v140, 0
  v_mov_b32 v141, 0
  v_mov_b32 v142, 0
  v_mov_b32 v143, 0
  v_mov_b32 v144, 0
  v_mov_b32 v145, 0
  v_mov_b32 v146, 0
  v_mov_b32 v147, 0
  v_mov_b32 v148, 0
  v_mov_b32 v149, 0
  v_mov_b32 v150, 0
  v_mov_b32 v151, 0
  v_mov_b32 v152, 0
  v_mov_b32 v153, 0
  v_mov_b32 v154, 0
  v_mov_b32 v155, 0
  v_mov_b32 v156, 0
  v_mov_b32 v157, 0
  v_mov_b32 v158, 0
  v_mov_b32 v159, 0
  v_mov_b32 v160, 0
  v_mov_b32 v161, 0
  v_mov_b32 v162, 0
  v_mov_b32 v163, 0
  v_mov_b32 v164, 0
  v_mov_b32 v165, 0
  v_mov_b32 v166, 0
  v_mov_b32 v167, 0
  v_mov_b32 v168, 0
  v_mov_b32 v169, 0
  v_mov_b32 v170, 0
  v_mov_b32 v171, 0
  v_mov_b32 v172, 0
  v_mov_b32 v173, 0
  v_mov_b32 v174, 0
  v_mov_b32 v175, 0
  v_mov_b32 v176, 0
  v_mov_b32 v177, 0
  v_mov_b32 v178, 0
  v_mov_b32 v179, 0
  v_mov_b32 v180, 0
  v_mov_b32 v181, 0
  v_mov_b32 v182, 0
  v_mov_b32 v183, 0
  v_mov_b32 v184, 0
  v_mov_b32 v185, 0
  v_mov_b32 v186, 0
  v_mov_b32 v187, 0
  v_mov_b32 v188, 0
  v_mov_b32 v189, 0
  v_mov_b32 v190, 0
  v_mov_b32 v191, 0
  v_mov_b32 v192, 0
  v_mov_b32 v193, 0
  v_mov_b32 v194, 0
  v_mov_b32 v195, 0
  s_waitcnt vmcnt(28)
  s_mov_b64 exec, s[20:21]
  ds_read_b128 v[136:139], v7 offset:0
  ds_read_b128 v[140:143], v7 offset:256
  ds_read_b128 v[144:147], v7 offset:512
  ds_read_b128 v[148:151], v7 offset:768
  ds_read_b128 v[152:155], v7 offset:1024
  s_mov_b64 exec, -1
  s_mov_b64 exec, s[20:21]
  ds_read_b128 v[156:159], v7 offset:1280
  ds_read_b128 v[160:163], v7 offset:1536
  ds_read_b128 v[164:167], v7 offset:1792
  ds_read_b128 v[168:171], v7 offset:2048
  ds_read_b128 v[172:175], v7 offset:2304
  s_mov_b64 exec, -1
  s_mov_b64 exec, s[20:21]
  ds_read_b128 v[176:179], v7 offset:2560
  ds_read_b128 v[180:183], v7 offset:2816
  ds_read_b128 v[184:187], v7 offset:3072
  ds_read_b128 v[188:191], v7 offset:3328
  ds_read_b128 v[192:195], v7 offset:3584
  s_mov_b64 exec, -1
  s_mul_i32 s17, s3, 5120
  v_add_u32 v9, s17, v2
  v_mov_b32 v10, 0x358637bd
  s_waitcnt vmcnt(18)
  s_waitcnt lgkmcnt(10)
  v_mfma_f32_16x16x32_bf16 v[196:199], v[136:139], v[56:59], 0
  v_mfma_f32_16x16x32_bf16 v[200:203], v[136:139], v[96:99], 0
  v_mfma_f32_16x16x32_bf16 v[196:199], v[140:143], v[60:63], v[196:199]
  v_mfma_f32_16x16x32_bf16 v[200:203], v[140:143], v[100:103], v[200:203]
  v_mfma_f32_16x16x32_bf16 v[196:199], v[144:147], v[64:67], v[196:199]
  v_mfma_f32_16x16x32_bf16 v[200:203], v[144:147], v[104:107], v[200:203]
  v_mfma_f32_16x16x32_bf16 v[196:199], v[148:151], v[68:71], v[196:199]
  v_mfma_f32_16x16x32_bf16 v[200:203], v[148:151], v[108:111], v[200:203]
  v_mfma_f32_16x16x32_bf16 v[196:199], v[152:155], v[72:75], v[196:199]
  v_mfma_f32_16x16x32_bf16 v[200:203], v[152:155], v[112:115], v[200:203]
  s_mov_b64 exec, s[20:21]
  ds_read_b128 v[136:139], v7 offset:3840
  ds_read_b128 v[140:143], v7 offset:4096
  ds_read_b128 v[144:147], v7 offset:4352
  ds_read_b128 v[148:151], v7 offset:4608
  ds_read_b128 v[152:155], v7 offset:4864
  s_mov_b64 exec, -1
  s_waitcnt lgkmcnt(10)
  v_mfma_f32_16x16x32_bf16 v[204:207], v[156:159], v[56:59], 0
  v_mfma_f32_16x16x32_bf16 v[208:211], v[156:159], v[96:99], 0
  v_mfma_f32_16x16x32_bf16 v[204:207], v[160:163], v[60:63], v[204:207]
  v_mfma_f32_16x16x32_bf16 v[208:211], v[160:163], v[100:103], v[208:211]
  v_mfma_f32_16x16x32_bf16 v[204:207], v[164:167], v[64:67], v[204:207]
  v_mfma_f32_16x16x32_bf16 v[208:211], v[164:167], v[104:107], v[208:211]
  v_mfma_f32_16x16x32_bf16 v[204:207], v[168:171], v[68:71], v[204:207]
  v_mfma_f32_16x16x32_bf16 v[208:211], v[168:171], v[108:111], v[208:211]
  v_mfma_f32_16x16x32_bf16 v[204:207], v[172:175], v[72:75], v[204:207]
  v_mfma_f32_16x16x32_bf16 v[208:211], v[172:175], v[112:115], v[208:211]
  s_mov_b64 exec, s[20:21]
  ds_read_b128 v[156:159], v7 offset:5120
  ds_read_b128 v[160:163], v7 offset:5376
  ds_read_b128 v[164:167], v7 offset:5632
  ds_read_b128 v[168:171], v7 offset:5888
  ds_read_b128 v[172:175], v7 offset:6144
  s_mov_b64 exec, -1
  s_waitcnt lgkmcnt(10)
  v_mfma_f32_16x16x32_bf16 v[212:215], v[176:179], v[56:59], 0
  v_mfma_f32_16x16x32_bf16 v[216:219], v[176:179], v[96:99], 0
  v_mfma_f32_16x16x32_bf16 v[212:215], v[180:183], v[60:63], v[212:215]
  v_mfma_f32_16x16x32_bf16 v[216:219], v[180:183], v[100:103], v[216:219]
  v_mfma_f32_16x16x32_bf16 v[212:215], v[184:187], v[64:67], v[212:215]
  v_mfma_f32_16x16x32_bf16 v[216:219], v[184:187], v[104:107], v[216:219]
  v_mfma_f32_16x16x32_bf16 v[212:215], v[188:191], v[68:71], v[212:215]
  v_mfma_f32_16x16x32_bf16 v[216:219], v[188:191], v[108:111], v[216:219]
  v_mfma_f32_16x16x32_bf16 v[212:215], v[192:195], v[72:75], v[212:215]
  v_mfma_f32_16x16x32_bf16 v[216:219], v[192:195], v[112:115], v[216:219]
  s_mov_b64 exec, s[20:21]
  ds_read_b128 v[176:179], v7 offset:6400
  ds_read_b128 v[180:183], v7 offset:6656
  ds_read_b128 v[184:187], v7 offset:6912
  ds_read_b128 v[188:191], v7 offset:7168
  ds_read_b128 v[192:195], v7 offset:7424
  s_mov_b64 exec, -1
  s_waitcnt lgkmcnt(10)
  v_mfma_f32_16x16x32_bf16 v[220:223], v[136:139], v[56:59], 0
  v_mfma_f32_16x16x32_bf16 v[224:227], v[136:139], v[96:99], 0
  v_mfma_f32_16x16x32_bf16 v[220:223], v[140:143], v[60:63], v[220:223]
  v_mfma_f32_16x16x32_bf16 v[224:227], v[140:143], v[100:103], v[224:227]
  v_mfma_f32_16x16x32_bf16 v[220:223], v[144:147], v[64:67], v[220:223]
  v_mfma_f32_16x16x32_bf16 v[224:227], v[144:147], v[104:107], v[224:227]
  v_mfma_f32_16x16x32_bf16 v[220:223], v[148:151], v[68:71], v[220:223]
  v_mfma_f32_16x16x32_bf16 v[224:227], v[148:151], v[108:111], v[224:227]
  v_mfma_f32_16x16x32_bf16 v[220:223], v[152:155], v[72:75], v[220:223]
  v_mfma_f32_16x16x32_bf16 v[224:227], v[152:155], v[112:115], v[224:227]
  s_mov_b64 exec, s[20:21]
  ds_read_b128 v[136:139], v7 offset:7680
  ds_read_b128 v[140:143], v7 offset:7936
  ds_read_b128 v[144:147], v7 offset:8192
  ds_read_b128 v[148:151], v7 offset:8448
  ds_read_b128 v[152:155], v7 offset:8704
  s_mov_b64 exec, -1
  s_waitcnt lgkmcnt(10)
  v_mfma_f32_16x16x32_bf16 v[228:231], v[156:159], v[56:59], 0
  v_mfma_f32_16x16x32_bf16 v[232:235], v[156:159], v[96:99], 0
  v_mfma_f32_16x16x32_bf16 v[228:231], v[160:163], v[60:63], v[228:231]
  v_mfma_f32_16x16x32_bf16 v[232:235], v[160:163], v[100:103], v[232:235]
  v_mfma_f32_16x16x32_bf16 v[228:231], v[164:167], v[64:67], v[228:231]
  v_mfma_f32_16x16x32_bf16 v[232:235], v[164:167], v[104:107], v[232:235]
  v_mfma_f32_16x16x32_bf16 v[228:231], v[168:171], v[68:71], v[228:231]
  v_mfma_f32_16x16x32_bf16 v[232:235], v[168:171], v[108:111], v[232:235]
  v_mfma_f32_16x16x32_bf16 v[228:231], v[172:175], v[72:75], v[228:231]
  v_mfma_f32_16x16x32_bf16 v[232:235], v[172:175], v[112:115], v[232:235]
  s_mov_b64 exec, s[20:21]
  ds_read_b128 v[156:159], v7 offset:8960
  ds_read_b128 v[160:163], v7 offset:9216
  ds_read_b128 v[164:167], v7 offset:9472
  ds_read_b128 v[168:171], v7 offset:9728
  ds_read_b128 v[172:175], v7 offset:9984
  s_mov_b64 exec, -1
  s_waitcnt lgkmcnt(10)
  v_mfma_f32_16x16x32_bf16 v[236:239], v[176:179], v[56:59], 0
  v_mfma_f32_16x16x32_bf16 v[240:243], v[176:179], v[96:99], 0
  v_mfma_f32_16x16x32_bf16 v[236:239], v[180:183], v[60:63], v[236:239]
  v_mfma_f32_16x16x32_bf16 v[240:243], v[180:183], v[100:103], v[240:243]
  v_mfma_f32_16x16x32_bf16 v[236:239], v[184:187], v[64:67], v[236:239]
  v_mfma_f32_16x16x32_bf16 v[240:243], v[184:187], v[104:107], v[240:243]
  v_mfma_f32_16x16x32_bf16 v[236:239], v[188:191], v[68:71], v[236:239]
  v_mfma_f32_16x16x32_bf16 v[240:243], v[188:191], v[108:111], v[240:243]
  v_mfma_f32_16x16x32_bf16 v[236:239], v[192:195], v[72:75], v[236:239]
  v_mfma_f32_16x16x32_bf16 v[240:243], v[192:195], v[112:115], v[240:243]
  s_mov_b64 exec, s[20:21]
  ds_read_b128 v[176:179], v7 offset:10240
  ds_read_b128 v[180:183], v7 offset:10496
  ds_read_b128 v[184:187], v7 offset:10752
  ds_read_b128 v[188:191], v7 offset:11008
  ds_read_b128 v[192:195], v7 offset:11264
  s_mov_b64 exec, -1
  v_add_f32 v236, v236, v10
  v_rcp_f32 v236, v236
  s_nop 0
  v_mov_b32 v237, v236
  v_pk_mul_f32 v[196:197], v[196:197], v[236:237]
  v_cvt_pk_bf16_f32 v244, v196, v197
  v_pk_mul_f32 v[198:199], v[198:199], v[236:237]
  v_cvt_pk_bf16_f32 v245, v198, v199
  v_pk_mul_f32 v[204:205], v[204:205], v[236:237]
  v_cvt_pk_bf16_f32 v246, v204, v205
  v_pk_mul_f32 v[206:207], v[206:207], v[236:237]
  v_cvt_pk_bf16_f32 v247, v206, v207
  v_pk_mul_f32 v[212:213], v[212:213], v[236:237]
  v_cvt_pk_bf16_f32 v248, v212, v213
  v_pk_mul_f32 v[214:215], v[214:215], v[236:237]
  v_cvt_pk_bf16_f32 v249, v214, v215
  v_pk_mul_f32 v[220:221], v[220:221], v[236:237]
  v_cvt_pk_bf16_f32 v250, v220, v221
  v_pk_mul_f32 v[222:223], v[222:223], v[236:237]
  v_cvt_pk_bf16_f32 v251, v222, v223
  v_pk_mul_f32 v[228:229], v[228:229], v[236:237]
  v_cvt_pk_bf16_f32 v252, v228, v229
  v_pk_mul_f32 v[230:231], v[230:231], v[236:237]
  v_cvt_pk_bf16_f32 v253, v230, v231
  ds_write_b128 v9, v[244:247] offset:0
  ds_write_b128 v9, v[248:251] offset:1024
  ds_write_b64 v9, v[252:253] offset:2048
  s_waitcnt lgkmcnt(0)
  v_add_f32 v240, v240, v10
  v_rcp_f32 v240, v240
  s_nop 0
  v_mov_b32 v241, v240
  v_pk_mul_f32 v[200:201], v[200:201], v[240:241]
  v_cvt_pk_bf16_f32 v244, v200, v201
  v_pk_mul_f32 v[202:203], v[202:203], v[240:241]
  v_cvt_pk_bf16_f32 v245, v202, v203
  v_pk_mul_f32 v[208:209], v[208:209], v[240:241]
  v_cvt_pk_bf16_f32 v246, v208, v209
  v_pk_mul_f32 v[210:211], v[210:211], v[240:241]
  v_cvt_pk_bf16_f32 v247, v210, v211
  v_pk_mul_f32 v[216:217], v[216:217], v[240:241]
  v_cvt_pk_bf16_f32 v248, v216, v217
  v_pk_mul_f32 v[218:219], v[218:219], v[240:241]
  v_cvt_pk_bf16_f32 v249, v218, v219
  v_pk_mul_f32 v[224:225], v[224:225], v[240:241]
  v_cvt_pk_bf16_f32 v250, v224, v225
  v_pk_mul_f32 v[226:227], v[226:227], v[240:241]
  v_cvt_pk_bf16_f32 v251, v226, v227
  v_pk_mul_f32 v[232:233], v[232:233], v[240:241]
  v_cvt_pk_bf16_f32 v252, v232, v233
  v_pk_mul_f32 v[234:235], v[234:235], v[240:241]
  v_cvt_pk_bf16_f32 v253, v234, v235
  ds_write_b128 v9, v[244:247] offset:20480
  ds_write_b128 v9, v[248:251] offset:21504
  ds_write_b64 v9, v[252:253] offset:22528
  s_waitcnt lgkmcnt(0)
  s_waitcnt vmcnt(8)
  s_waitcnt lgkmcnt(5)
  v_mfma_f32_16x16x32_bf16 v[196:199], v[136:139], v[76:79], 0
  v_mfma_f32_16x16x32_bf16 v[200:203], v[136:139], v[116:119], 0
  v_mfma_f32_16x16x32_bf16 v[196:199], v[140:143], v[80:83], v[196:199]
  v_mfma_f32_16x16x32_bf16 v[200:203], v[140:143], v[120:123], v[200:203]
  v_mfma_f32_16x16x32_bf16 v[196:199], v[144:147], v[84:87], v[196:199]
  v_mfma_f32_16x16x32_bf16 v[200:203], v[144:147], v[124:127], v[200:203]
  v_mfma_f32_16x16x32_bf16 v[196:199], v[148:151], v[88:91], v[196:199]
  v_mfma_f32_16x16x32_bf16 v[200:203], v[148:151], v[128:131], v[200:203]
  v_mfma_f32_16x16x32_bf16 v[196:199], v[152:155], v[92:95], v[196:199]
  v_mfma_f32_16x16x32_bf16 v[200:203], v[152:155], v[132:135], v[200:203]
  s_mov_b64 exec, s[20:21]
  ds_read_b128 v[136:139], v7 offset:11520
  ds_read_b128 v[140:143], v7 offset:11776
  ds_read_b128 v[144:147], v7 offset:12032
  ds_read_b128 v[148:151], v7 offset:12288
  ds_read_b128 v[152:155], v7 offset:12544
  s_mov_b64 exec, -1
  s_waitcnt lgkmcnt(10)
  v_mfma_f32_16x16x32_bf16 v[204:207], v[156:159], v[76:79], 0
  v_mfma_f32_16x16x32_bf16 v[208:211], v[156:159], v[116:119], 0
  v_mfma_f32_16x16x32_bf16 v[204:207], v[160:163], v[80:83], v[204:207]
  v_mfma_f32_16x16x32_bf16 v[208:211], v[160:163], v[120:123], v[208:211]
  v_mfma_f32_16x16x32_bf16 v[204:207], v[164:167], v[84:87], v[204:207]
  v_mfma_f32_16x16x32_bf16 v[208:211], v[164:167], v[124:127], v[208:211]
  v_mfma_f32_16x16x32_bf16 v[204:207], v[168:171], v[88:91], v[204:207]
  v_mfma_f32_16x16x32_bf16 v[208:211], v[168:171], v[128:131], v[208:211]
  v_mfma_f32_16x16x32_bf16 v[204:207], v[172:175], v[92:95], v[204:207]
  v_mfma_f32_16x16x32_bf16 v[208:211], v[172:175], v[132:135], v[208:211]
  s_mov_b64 exec, s[20:21]
  ds_read_b128 v[156:159], v7 offset:12800
  ds_read_b128 v[160:163], v7 offset:13056
  ds_read_b128 v[164:167], v7 offset:13312
  ds_read_b128 v[168:171], v7 offset:13568
  ds_read_b128 v[172:175], v7 offset:13824
  s_mov_b64 exec, -1
  s_waitcnt lgkmcnt(10)
  v_mfma_f32_16x16x32_bf16 v[212:215], v[176:179], v[76:79], 0
  v_mfma_f32_16x16x32_bf16 v[216:219], v[176:179], v[116:119], 0
  v_mfma_f32_16x16x32_bf16 v[212:215], v[180:183], v[80:83], v[212:215]
  v_mfma_f32_16x16x32_bf16 v[216:219], v[180:183], v[120:123], v[216:219]
  v_mfma_f32_16x16x32_bf16 v[212:215], v[184:187], v[84:87], v[212:215]
  v_mfma_f32_16x16x32_bf16 v[216:219], v[184:187], v[124:127], v[216:219]
  v_mfma_f32_16x16x32_bf16 v[212:215], v[188:191], v[88:91], v[212:215]
  v_mfma_f32_16x16x32_bf16 v[216:219], v[188:191], v[128:131], v[216:219]
  v_mfma_f32_16x16x32_bf16 v[212:215], v[192:195], v[92:95], v[212:215]
  v_mfma_f32_16x16x32_bf16 v[216:219], v[192:195], v[132:135], v[216:219]
  s_mov_b64 exec, s[20:21]
  ds_read_b128 v[176:179], v7 offset:14080
  ds_read_b128 v[180:183], v7 offset:14336
  ds_read_b128 v[184:187], v7 offset:14592
  ds_read_b128 v[188:191], v7 offset:14848
  ds_read_b128 v[192:195], v7 offset:15104
  s_mov_b64 exec, -1
  s_waitcnt lgkmcnt(10)
  v_mfma_f32_16x16x32_bf16 v[220:223], v[136:139], v[76:79], 0
  v_mfma_f32_16x16x32_bf16 v[224:227], v[136:139], v[116:119], 0
  v_mfma_f32_16x16x32_bf16 v[220:223], v[140:143], v[80:83], v[220:223]
  v_mfma_f32_16x16x32_bf16 v[224:227], v[140:143], v[120:123], v[224:227]
  v_mfma_f32_16x16x32_bf16 v[220:223], v[144:147], v[84:87], v[220:223]
  v_mfma_f32_16x16x32_bf16 v[224:227], v[144:147], v[124:127], v[224:227]
  v_mfma_f32_16x16x32_bf16 v[220:223], v[148:151], v[88:91], v[220:223]
  v_mfma_f32_16x16x32_bf16 v[224:227], v[148:151], v[128:131], v[224:227]
  v_mfma_f32_16x16x32_bf16 v[220:223], v[152:155], v[92:95], v[220:223]
  v_mfma_f32_16x16x32_bf16 v[224:227], v[152:155], v[132:135], v[224:227]
  s_waitcnt lgkmcnt(5)
  v_mfma_f32_16x16x32_bf16 v[228:231], v[156:159], v[76:79], 0
  v_mfma_f32_16x16x32_bf16 v[232:235], v[156:159], v[116:119], 0
  v_mfma_f32_16x16x32_bf16 v[228:231], v[160:163], v[80:83], v[228:231]
  v_mfma_f32_16x16x32_bf16 v[232:235], v[160:163], v[120:123], v[232:235]
  v_mfma_f32_16x16x32_bf16 v[228:231], v[164:167], v[84:87], v[228:231]
  v_mfma_f32_16x16x32_bf16 v[232:235], v[164:167], v[124:127], v[232:235]
  v_mfma_f32_16x16x32_bf16 v[228:231], v[168:171], v[88:91], v[228:231]
  v_mfma_f32_16x16x32_bf16 v[232:235], v[168:171], v[128:131], v[232:235]
  v_mfma_f32_16x16x32_bf16 v[228:231], v[172:175], v[92:95], v[228:231]
  v_mfma_f32_16x16x32_bf16 v[232:235], v[172:175], v[132:135], v[232:235]
  s_waitcnt lgkmcnt(0)
  v_mfma_f32_16x16x32_bf16 v[236:239], v[176:179], v[76:79], 0
  v_mfma_f32_16x16x32_bf16 v[240:243], v[176:179], v[116:119], 0
  v_mfma_f32_16x16x32_bf16 v[236:239], v[180:183], v[80:83], v[236:239]
  v_mfma_f32_16x16x32_bf16 v[240:243], v[180:183], v[120:123], v[240:243]
  v_mfma_f32_16x16x32_bf16 v[236:239], v[184:187], v[84:87], v[236:239]
  v_mfma_f32_16x16x32_bf16 v[240:243], v[184:187], v[124:127], v[240:243]
  v_mfma_f32_16x16x32_bf16 v[236:239], v[188:191], v[88:91], v[236:239]
  v_mfma_f32_16x16x32_bf16 v[240:243], v[188:191], v[128:131], v[240:243]
  v_mfma_f32_16x16x32_bf16 v[236:239], v[192:195], v[92:95], v[236:239]
  v_mfma_f32_16x16x32_bf16 v[240:243], v[192:195], v[132:135], v[240:243]
  s_nop 4
  v_add_f32 v236, v236, v10
  v_rcp_f32 v236, v236
  s_nop 0
  v_mov_b32 v237, v236
  v_pk_mul_f32 v[196:197], v[196:197], v[236:237]
  v_cvt_pk_bf16_f32 v246, v196, v197
  v_pk_mul_f32 v[198:199], v[198:199], v[236:237]
  v_cvt_pk_bf16_f32 v247, v198, v199
  v_pk_mul_f32 v[204:205], v[204:205], v[236:237]
  v_cvt_pk_bf16_f32 v248, v204, v205
  v_pk_mul_f32 v[206:207], v[206:207], v[236:237]
  v_cvt_pk_bf16_f32 v249, v206, v207
  v_pk_mul_f32 v[212:213], v[212:213], v[236:237]
  v_cvt_pk_bf16_f32 v250, v212, v213
  v_pk_mul_f32 v[214:215], v[214:215], v[236:237]
  v_cvt_pk_bf16_f32 v251, v214, v215
  v_pk_mul_f32 v[220:221], v[220:221], v[236:237]
  v_cvt_pk_bf16_f32 v252, v220, v221
  v_pk_mul_f32 v[222:223], v[222:223], v[236:237]
  v_cvt_pk_bf16_f32 v253, v222, v223
  v_pk_mul_f32 v[228:229], v[228:229], v[236:237]
  v_cvt_pk_bf16_f32 v254, v228, v229
  v_pk_mul_f32 v[230:231], v[230:231], v[236:237]
  v_cvt_pk_bf16_f32 v255, v230, v231
  ds_write_b64 v9, v[246:247] offset:2056
  ds_write_b128 v9, v[248:251] offset:3072
  ds_write_b128 v9, v[252:255] offset:4096
  s_waitcnt lgkmcnt(0)
  v_add_f32 v240, v240, v10
  v_rcp_f32 v240, v240
  s_nop 0
  v_mov_b32 v241, v240
  v_pk_mul_f32 v[200:201], v[200:201], v[240:241]
  v_cvt_pk_bf16_f32 v246, v200, v201
  v_pk_mul_f32 v[202:203], v[202:203], v[240:241]
  v_cvt_pk_bf16_f32 v247, v202, v203
  v_pk_mul_f32 v[208:209], v[208:209], v[240:241]
  v_cvt_pk_bf16_f32 v248, v208, v209
  v_pk_mul_f32 v[210:211], v[210:211], v[240:241]
  v_cvt_pk_bf16_f32 v249, v210, v211
  v_pk_mul_f32 v[216:217], v[216:217], v[240:241]
  v_cvt_pk_bf16_f32 v250, v216, v217
  v_pk_mul_f32 v[218:219], v[218:219], v[240:241]
  v_cvt_pk_bf16_f32 v251, v218, v219
  v_pk_mul_f32 v[224:225], v[224:225], v[240:241]
  v_cvt_pk_bf16_f32 v252, v224, v225
  v_pk_mul_f32 v[226:227], v[226:227], v[240:241]
  v_cvt_pk_bf16_f32 v253, v226, v227
  v_pk_mul_f32 v[232:233], v[232:233], v[240:241]
  v_cvt_pk_bf16_f32 v254, v232, v233
  v_pk_mul_f32 v[234:235], v[234:235], v[240:241]
  v_cvt_pk_bf16_f32 v255, v234, v235
  ds_write_b64 v9, v[246:247] offset:22536
  ds_write_b128 v9, v[248:251] offset:23552
  ds_write_b128 v9, v[252:255] offset:24576
  s_waitcnt lgkmcnt(0)
  s_branch b2_kernel_ph2b
b2_kernel_ph2:
  buffer_load_dwordx4 v[24:27], v2, s[4:7], s14 offen
  buffer_load_dwordx4 v[28:31], v3, s[4:7], s14 offen
  s_add_u32 s14, s14, 1024
  buffer_load_dwordx4 v[32:35], v2, s[4:7], s14 offen
  buffer_load_dwordx4 v[36:39], v3, s[4:7], s14 offen
  s_add_u32 s14, s14, 1024
  buffer_load_dwordx4 v[40:43], v2, s[4:7], s14 offen
  buffer_load_dwordx4 v[44:47], v3, s[4:7], s14 offen
  s_add_u32 s14, s14, 1024
  buffer_load_dwordx4 v[48:51], v2, s[4:7], s14 offen
  buffer_load_dwordx4 v[52:55], v3, s[4:7], s14 offen
  s_add_u32 s14, s14, 1024
b2_kernel_ph2b:
  buffer_load_dwordx4 v[56:59], v2, s[4:7], s14 offen
  buffer_load_dwordx4 v[60:63], v3, s[4:7], s14 offen
  s_add_u32 s14, s14, 1024
  buffer_load_dwordx4 v[64:67], v2, s[4:7], s14 offen
  buffer_load_dwordx4 v[68:71], v3, s[4:7], s14 offen
  s_add_u32 s14, s14, 1024
  buffer_load_dwordx4 v[72:75], v2, s[4:7], s14 offen
  buffer_load_dwordx4 v[76:79], v3, s[4:7], s14 offen
  s_add_u32 s14, s14, 1024
  buffer_load_dwordx4 v[80:83], v2, s[4:7], s14 offen
  buffer_load_dwordx4 v[84:87], v3, s[4:7], s14 offen
  s_add_u32 s14, s14, 1024
  buffer_load_dwordx4 v[88:91], v2, s[4:7], s14 offen
  buffer_load_dwordx4 v[92:95], v3, s[4:7], s14 offen
  s_add_u32 s14, s14, 1024
  buffer_load_dwordx4 v[96:99], v2, s[4:7], s14 offen
  buffer_load_dwordx4 v[100:103], v3, s[4:7], s14 offen
  s_add_u32 s14, s14, 1024
  buffer_load_dwordx4 v[16:19], v2, s[4:7], s12 offen
  buffer_load_dwordx4 v[20:23], v3, s[4:7], s12 offen
  s_barrier
  ds_read_b128 v[136:139], v2 offset:0
  ds_read_b128 v[140:143], v3 offset:0
  ds_read_b128 v[144:147], v2 offset:1024
  ds_read_b128 v[148:151], v3 offset:1024
  ds_read_b128 v[152:155], v2 offset:2048
  ds_read_b128 v[156:159], v3 offset:2048
  s_waitcnt vmcnt(20) lgkmcnt(4)
  v_mfma_f32_16x16x32_bf16 v[168:171], v[24:27], v[136:139], 0
  v_mfma_f32_16x16x32_bf16 v[176:179], v[24:27], v[140:143], 0
  v_mfma_f32_16x16x32_bf16 v[172:175], v[28:31], v[136:139], 0
  v_mfma_f32_16x16x32_bf16 v[180:183], v[28:31], v[140:143], 0
  buffer_load_dwordx4 v[24:27], v2, s[4:7], s14 offen
  buffer_load_dwordx4 v[28:31], v3, s[4:7], s14 offen
  s_add_u32 s14, s14, 1024
  ds_read_b128 v[160:163], v2 offset:3072
  ds_read_b128 v[164:167], v3 offset:3072
  s_waitcnt vmcnt(20) lgkmcnt(4)
  v_mfma_f32_16x16x32_bf16 v[168:171], v[32:35], v[144:147], v[168:171]
  v_mfma_f32_16x16x32_bf16 v[176:179], v[32:35], v[148:151], v[176:179]
  v_mfma_f32_16x16x32_bf16 v[172:175], v[36:39], v[144:147], v[172:175]
  v_mfma_f32_16x16x32_bf16 v[180:183], v[36:39], v[148:151], v[180:183]
  buffer_load_dwordx4 v[32:35], v2, s[4:7], s14 offen
  buffer_load_dwordx4 v[36:39], v3, s[4:7], s14 offen
  s_add_u32 s14, s14, 1024
  ds_read_b128 v[136:139], v2 offset:4096
  ds_read_b128 v[140:143], v3 offset:4096
  s_waitcnt vmcnt(20) lgkmcnt(4)
  v_mfma_f32_16x16x32_bf16 v[168:171], v[40:43], v[152:155], v[168:171]
  v_mfma_f32_16x16x32_bf16 v[176:179], v[40:43], v[156:159], v[176:179]
  v_mfma_f32_16x16x32_bf16 v[172:175], v[44:47], v[152:155], v[172:175]
  v_mfma_f32_16x16x32_bf16 v[180:183], v[44:47], v[156:159], v[180:183]
  buffer_load_dwordx4 v[40:43], v2, s[4:7], s14 offen
  buffer_load_dwordx4 v[44:47], v3, s[4:7], s14 offen
  s_add_u32 s14, s14, 1024
  ds_read_b128 v[144:147], v2 offset:5120
  ds_read_b128 v[148:151], v3 offset:5120
  s_waitcnt vmcnt(20) lgkmcnt(4)
  v_mfma_f32_16x16x32_bf16 v[168:171], v[48:51], v[160:163], v[168:171]
  v_mfma_f32_16x16x32_bf16 v[176:179], v[48:51], v[164:167], v[176:179]
  v_mfma_f32_16x16x32_bf16 v[172:175], v[52:55], v[160:163], v[172:175]
  v_mfma_f32_16x16x32_bf16 v[180:183], v[52:55], v[164:167], v[180:183]
  buffer_load_dwordx4 v[48:51], v2, s[4:7], s14 offen
  buffer_load_dwordx4 v[52:55], v3, s[4:7], s14 offen
  s_add_u32 s14, s14, 1024
  ds_read_b128 v[152:155], v2 offset:6144
  ds_read_b128 v[156:159], v3 offset:6144
  s_waitcnt vmcnt(20) lgkmcnt(4)
  v_mfma_f32_16x16x32_bf16 v[168:171], v[56:59], v[136:139], v[168:171]
  v_mfma_f32_16x16x32_bf16 v[176:179], v[56:59], v[140:143], v[176:179]
  v_mfma_f32_16x16x32_bf16 v[172:175], v[60:63], v[136:139], v[172:175]
  v_mfma_f32_16x16x32_bf16 v[180:183], v[60:63], v[140:143], v[180:183]
  buffer_load_dwordx4 v[56:59], v2, s[4:7], s14 offen
  buffer_load_dwordx4 v[60:63], v3, s[4:7], s14 offen
  s_add_u32 s14, s14, 1024
  ds_read_b128 v[160:163], v2 offset:7168
  ds_read_b128 v[164:167], v3 offset:7168
  s_waitcnt vmcnt(20) lgkmcnt(4)
  v_mfma_f32_16x16x32_bf16 v[168:171], v[64:67], v[144:147], v[168:171]
  v_mfma_f32_16x16x32_bf16 v[176:179], v[64:67], v[148:151], v[176:179]
  v_mfma_f32_16x16x32_bf16 v[172:175], v[68:71], v[144:147], v[172:175]
  v_mfma_f32_16x16x32_bf16 v[180:183], v[68:71], v[148:151], v[180:183]
  buffer_load_dwordx4 v[64:67], v2, s[4:7], s14 offen
  buffer_load_dwordx4 v[68:71], v3, s[4:7], s14 offen
  s_add_u32 s14, s14, 1024
  ds_read_b128 v[136:139], v2 offset:8192
  ds_read_b128 v[140:143], v3 offset:8192
  s_waitcnt vmcnt(20) lgkmcnt(4)
  v_mfma_f32_16x16x32_bf16 v[168:171], v[72:75], v[152:155], v[168:171]
  v_mfma_f32_16x16x32_bf16 v[176:179], v[72:75], v[156:159], v[176:179]
  v_mfma_f32_16x16x32_bf16 v[172:175], v[76:79], v[152:155], v[172:175]
  v_mfma_f32_16x16x32_bf16 v[180:183], v[76:79], v[156:159], v[180:183]
  buffer_load_dwordx4 v[72:75], v2, s[4:7], s14 offen
  buffer_load_dwordx4 v[76:79], v3, s[4:7], s14 offen
  s_add_u32 s14, s14, 1024
  ds_read_b128 v[144:147], v2 offset:9216
  ds_read_b128 v[148:151], v3 offset:9216
  s_waitcnt vmcnt(20) lgkmcnt(4)
  v_mfma_f32_16x16x32_bf16 v[168:171], v[80:83], v[160:163], v[168:171]
  v_mfma_f32_16x16x32_bf16 v[176:179], v[80:83], v[164:167], v[176:179]
  v_mfma_f32_16x16x32_bf16 v[172:175], v[84:87], v[160:163], v[172:175]
  v_mfma_f32_16x16x32_bf16 v[180:183], v[84:87], v[164:167], v[180:183]
  buffer_load_dwordx4 v[80:83], v2, s[4:7], s14 offen
  buffer_load_dwordx4 v[84:87], v3, s[4:7], s14 offen
  s_add_u32 s14, s14, 1024
  ds_read_b128 v[152:155], v2 offset:10240
  ds_read_b128 v[156:159], v3 offset:10240
  s_waitcnt vmcnt(20) lgkmcnt(4)
  v_mfma_f32_16x16x32_bf16 v[168:171], v[88:91], v[136:139], v[168:171]
  v_mfma_f32_16x16x32_bf16 v[176:179], v[88:91], v[140:143], v[176:179]
  v_mfma_f32_16x16x32_bf16 v[172:175], v[92:95], v[136:139], v[172:175]
  v_mfma_f32_16x16x32_bf16 v[180:183], v[92:95], v[140:143], v[180:183]
  buffer_load_dwordx4 v[88:91], v2, s[4:7], s14 offen
  buffer_load_dwordx4 v[92:95], v3, s[4:7], s14 offen
  s_add_u32 s14, s14, 1024
  ds_read_b128 v[160:163], v2 offset:11264
  ds_read_b128 v[164:167], v3 offset:11264
  s_waitcnt vmcnt(20) lgkmcnt(4)
  v_mfma_f32_16x16x32_bf16 v[168:171], v[96:99], v[144:147], v[168:171]
  v_mfma_f32_16x16x32_bf16 v[176:179], v[96:99], v[148:151], v[176:179]
  v_mfma_f32_16x16x32_bf16 v[172:175], v[100:103], v[144:147], v[172:175]
  v_mfma_f32_16x16x32_bf16 v[180:183], v[100:103], v[148:151], v[180:183]
  buffer_load_dwordx4 v[96:99], v2, s[4:7], s14 offen
  buffer_load_dwordx4 v[100:103], v3, s[4:7], s14 offen
  s_add_u32 s14, s14, 1024
  ds_read_b128 v[136:139], v2 offset:12288
  ds_read_b128 v[140:143], v3 offset:12288
  s_waitcnt vmcnt(18) lgkmcnt(4)
  v_mfma_f32_16x16x32_bf16 v[168:171], v[24:27], v[152:155], v[168:171]
  v_mfma_f32_16x16x32_bf16 v[176:179], v[24:27], v[156:159], v[176:179]
  v_mfma_f32_16x16x32_bf16 v[172:175], v[28:31], v[152:155], v[172:175]
  v_mfma_f32_16x16x32_bf16 v[180:183], v[28:31], v[156:159], v[180:183]
  ds_read_b128 v[144:147], v2 offset:13312
  ds_read_b128 v[148:151], v3 offset:13312
  s_waitcnt vmcnt(16) lgkmcnt(4)
  v_mfma_f32_16x16x32_bf16 v[168:171], v[32:35], v[160:163], v[168:171]
  v_mfma_f32_16x16x32_bf16 v[176:179], v[32:35], v[164:167], v[176:179]
  v_mfma_f32_16x16x32_bf16 v[172:175], v[36:39], v[160:163], v[172:175]
  v_mfma_f32_16x16x32_bf16 v[180:183], v[36:39], v[164:167], v[180:183]
  ds_read_b128 v[152:155], v2 offset:14336
  ds_read_b128 v[156:159], v3 offset:14336
  s_waitcnt vmcnt(14) lgkmcnt(4)
  v_mfma_f32_16x16x32_bf16 v[168:171], v[40:43], v[136:139], v[168:171]
  v_mfma_f32_16x16x32_bf16 v[176:179], v[40:43], v[140:143], v[176:179]
  v_mfma_f32_16x16x32_bf16 v[172:175], v[44:47], v[136:139], v[172:175]
  v_mfma_f32_16x16x32_bf16 v[180:183], v[44:47], v[140:143], v[180:183]
  ds_read_b128 v[160:163], v2 offset:15360
  ds_read_b128 v[164:167], v3 offset:15360
  s_waitcnt vmcnt(12) lgkmcnt(4)
  v_mfma_f32_16x16x32_bf16 v[168:171], v[48:51], v[144:147], v[168:171]
  v_mfma_f32_16x16x32_bf16 v[176:179], v[48:51], v[148:151], v[176:179]
  v_mfma_f32_16x16x32_bf16 v[172:175], v[52:55], v[144:147], v[172:175]
  v_mfma_f32_16x16x32_bf16 v[180:183], v[52:55], v[148:151], v[180:183]
  ds_read_b128 v[136:139], v2 offset:16384
  ds_read_b128 v[140:143], v3 offset:16384
  s_waitcnt vmcnt(10) lgkmcnt(4)
  v_mfma_f32_16x16x32_bf16 v[168:171], v[56:59], v[152:155], v[168:171]
  v_mfma_f32_16x16x32_bf16 v[176:179], v[56:59], v[156:159], v[176:179]
  v_mfma_f32_16x16x32_bf16 v[172:175], v[60:63], v[152:155], v[172:175]
  v_mfma_f32_16x16x32_bf16 v[180:183], v[60:63], v[156:159], v[180:183]
  ds_read_b128 v[144:147], v2 offset:17408
  ds_read_b128 v[148:151], v3 offset:17408
  s_waitcnt vmcnt(8) lgkmcnt(4)
  v_mfma_f32_16x16x32_bf16 v[168:171], v[64:67], v[160:163], v[168:171]
  v_mfma_f32_16x16x32_bf16 v[176:179], v[64:67], v[164:167], v[176:179]
  v_mfma_f32_16x16x32_bf16 v[172:175], v[68:71], v[160:163], v[172:175]
  v_mfma_f32_16x16x32_bf16 v[180:183], v[68:71], v[164:167], v[180:183]
  ds_read_b128 v[152:155], v2 offset:18432
  ds_read_b128 v[156:159], v3 offset:18432
  s_waitcnt vmcnt(6) lgkmcnt(4)
  v_mfma_f32_16x16x32_bf16 v[168:171], v[72:75], v[136:139], v[168:171]
  v_mfma_f32_16x16x32_bf16 v[176:179], v[72:75], v[140:143], v[176:179]
  v_mfma_f32_16x16x32_bf16 v[172:175], v[76:79], v[136:139], v[172:175]
  v_mfma_f32_16x16x32_bf16 v[180:183], v[76:79], v[140:143], v[180:183]
  ds_read_b128 v[160:163], v2 offset:19456
  ds_read_b128 v[164:167], v3 offset:19456
  s_waitcnt vmcnt(4) lgkmcnt(4)
  v_mfma_f32_16x16x32_bf16 v[168:171], v[80:83], v[144:147], v[168:171]
  v_mfma_f32_16x16x32_bf16 v[176:179], v[80:83], v[148:151], v[176:179]
  v_mfma_f32_16x16x32_bf16 v[172:175], v[84:87], v[144:147], v[172:175]
  v_mfma_f32_16x16x32_bf16 v[180:183], v[84:87], v[148:151], v[180:183]
  s_waitcnt vmcnt(2) lgkmcnt(2)
  v_mfma_f32_16x16x32_bf16 v[168:171], v[88:91], v[152:155], v[168:171]
  v_mfma_f32_16x16x32_bf16 v[176:179], v[88:91], v[156:159], v[176:179]
  v_mfma_f32_16x16x32_bf16 v[172:175], v[92:95], v[152:155], v[172:175]
  v_mfma_f32_16x16x32_bf16 v[180:183], v[92:95], v[156:159], v[180:183]
  s_waitcnt vmcnt(0) lgkmcnt(0)
  v_mfma_f32_16x16x32_bf16 v[168:171], v[96:99], v[160:163], v[168:171]
  v_mfma_f32_16x16x32_bf16 v[176:179], v[96:99], v[164:167], v[176:179]
  v_mfma_f32_16x16x32_bf16 v[172:175], v[100:103], v[160:163], v[172:175]
  v_mfma_f32_16x16x32_bf16 v[180:183], v[100:103], v[164:167], v[180:183]
  s_mov_b32 s23, 0xffff0000
  v_lshlrev_b32 v10, 16, v16
  v_and_b32 v11, s23, v16
  v_pk_add_f32 v[168:169], v[168:169], v[10:11]
  v_cvt_pk_bf16_f32 v16, v168, v169
  v_lshlrev_b32 v10, 16, v17
  v_and_b32 v11, s23, v17
  v_pk_add_f32 v[170:171], v[170:171], v[10:11]
  v_cvt_pk_bf16_f32 v17, v170, v171
  v_lshlrev_b32 v10, 16, v18
  v_and_b32 v11, s23, v18
  v_pk_add_f32 v[172:173], v[172:173], v[10:11]
  v_cvt_pk_bf16_f32 v18, v172, v173
  v_lshlrev_b32 v10, 16, v19
  v_and_b32 v11, s23, v19
  v_pk_add_f32 v[174:175], v[174:175], v[10:11]
  v_cvt_pk_bf16_f32 v19, v174, v175
  v_lshlrev_b32 v10, 16, v20
  v_and_b32 v11, s23, v20
  v_pk_add_f32 v[176:177], v[176:177], v[10:11]
  v_cvt_pk_bf16_f32 v20, v176, v177
  v_lshlrev_b32 v10, 16, v21
  v_and_b32 v11, s23, v21
  v_pk_add_f32 v[178:179], v[178:179], v[10:11]
  v_cvt_pk_bf16_f32 v21, v178, v179
  v_lshlrev_b32 v10, 16, v22
  v_and_b32 v11, s23, v22
  v_pk_add_f32 v[180:181], v[180:181], v[10:11]
  v_cvt_pk_bf16_f32 v22, v180, v181
  v_lshlrev_b32 v10, 16, v23
  v_and_b32 v11, s23, v23
  v_pk_add_f32 v[182:183], v[182:183], v[10:11]
  v_cvt_pk_bf16_f32 v23, v182, v183
  v_pk_add_f32 v[10:11], v[168:169], v[170:171]
  v_pk_add_f32 v[12:13], v[172:173], v[174:175]
  v_pk_add_f32 v[10:11], v[10:11], v[12:13]
  v_add_f32 v24, v10, v11
  v_mov_b32 v10, v24
  s_nop 1
  v_permlane16_swap_b32 v24, v10
  v_add_f32 v24, v24, v10
  v_mov_b32 v10, v24
  s_nop 1
  v_permlane32_swap_b32 v24, v10
  v_add_f32 v24, v24, v10
  v_mul_f32 v24, 0x3d000000, v24
  v_sub_f32 v10, v168, v24
  v_mul_f32 v25, v10, v10
  v_sub_f32 v10, v169, v24
  v_fmac_f32 v25, v10, v10
  v_sub_f32 v10, v170, v24
  v_fmac_f32 v25, v10, v10
  v_sub_f32 v10, v171, v24
  v_fmac_f32 v25, v10, v10
  v_sub_f32 v10, v172, v24
  v_fmac_f32 v25, v10, v10
  v_sub_f32 v10, v173, v24
  v_fmac_f32 v25, v10, v10
  v_sub_f32 v10, v174, v24
  v_fmac_f32 v25, v10, v10
  v_sub_f32 v10, v175, v24
  v_fmac_f32 v25, v10, v10
  v_mov_b32 v10, v25
  s_nop 1
  v_permlane16_swap_b32 v25, v10
  v_add_f32 v25, v25, v10
  v_mov_b32 v10, v25
  s_nop 1
  v_permlane32_swap_b32 v25, v10
  v_add_f32 v25, v25, v10
  v_and_b32 v24, -2, v24
  v_and_b32 v25, -2, v25
  v_pk_add_f32 v[10:11], v[176:177], v[178:179]
  v_pk_add_f32 v[12:13], v[180:181], v[182:183]
  v_pk_add_f32 v[10:11], v[10:11], v[12:13]
  v_add_f32 v26, v10, v11
  v_mov_b32 v10, v26
  s_nop 1
  v_permlane16_swap_b32 v26, v10
  v_add_f32 v26, v26, v10
  v_mov_b32 v10, v26
  s_nop 1
  v_permlane32_swap_b32 v26, v10
  v_add_f32 v26, v26, v10
  v_mul_f32 v26, 0x3d000000, v26
  v_sub_f32 v10, v176, v26
  v_mul_f32 v27, v10, v10
  v_sub_f32 v10, v177, v26
  v_fmac_f32 v27, v10, v10
  v_sub_f32 v10, v178, v26
  v_fmac_f32 v27, v10, v10
  v_sub_f32 v10, v179, v26
  v_fmac_f32 v27, v10, v10
  v_sub_f32 v10, v180, v26
  v_fmac_f32 v27, v10, v10
  v_sub_f32 v10, v181, v26
  v_fmac_f32 v27, v10, v10
  v_sub_f32 v10, v182, v26
  v_fmac_f32 v27, v10, v10
  v_sub_f32 v10, v183, v26
  v_fmac_f32 v27, v10, v10
  v_mov_b32 v10, v27
  s_nop 1
  v_permlane16_swap_b32 v27, v10
  v_add_f32 v27, v27, v10
  v_mov_b32 v10, v27
  s_nop 1
  v_permlane32_swap_b32 v27, v10
  v_add_f32 v27, v27, v10
  v_and_b32 v26, -2, v26
  v_and_b32 v27, -2, v27
  s_mul_i32 s15, s8, 5120
  s_add_u32 s15, s15, 97845248
  s_lshl_b32 s16, s10, 7
  s_add_u32 s16, s16, s15
  v_lshlrev_b32 v8, 3, v4
  s_mov_b64 exec, 0xffff
  buffer_store_dwordx2 v[24:25], v8, s[4:7], s16 offen sc1
  buffer_store_dwordx2 v[26:27], v8, s[4:7], s16 offen offset:2560 sc1
  s_mov_b64 exec, -1
  buffer_store_dwordx4 v[16:19], v2, s[4:7], s12 offen
  buffer_store_dwordx4 v[20:23], v3, s[4:7], s12 offen
  v_mul_u32_u24 v9, 640, v5
  v_add_u32 v8, v8, v9
  s_mov_b32 s17, 0
b2_kernel_poll:
  buffer_load_dwordx2 v[32:33], v8, s[4:7], s15 offen offset:0 sc1
  buffer_load_dwordx2 v[34:35], v8, s[4:7], s15 offen offset:128 sc1
  buffer_load_dwordx2 v[36:37], v8, s[4:7], s15 offen offset:256 sc1
  buffer_load_dwordx2 v[38:39], v8, s[4:7], s15 offen offset:384 sc1
  buffer_load_dwordx2 v[40:41], v8, s[4:7], s15 offen offset:512 sc1
  buffer_load_dwordx2 v[42:43], v8, s[4:7], s15 offen offset:2560 sc1
  buffer_load_dwordx2 v[44:45], v8, s[4:7], s15 offen offset:2688 sc1
  buffer_load_dwordx2 v[46:47], v8, s[4:7], s15 offen offset:2816 sc1
  buffer_load_dwordx2 v[48:49], v8, s[4:7], s15 offen offset:2944 sc1
  buffer_load_dwordx2 v[50:51], v8, s[4:7], s15 offen offset:3072 sc1
  s_waitcnt vmcnt(0)
  v_or3_b32 v10, v32, v33, v34
  v_or3_b32 v10, v10, v35, v36
  v_or3_b32 v10, v10, v37, v38
  v_or3_b32 v10, v10, v39, v40
  v_or3_b32 v10, v10, v41, v42
  v_or3_b32 v10, v10, v43, v44
  v_or3_b32 v10, v10, v45, v46
  v_or3_b32 v10, v10, v47, v48
  v_or3_b32 v10, v10, v49, v50
  v_or_b32 v10, v10, v51
  v_and_b32 v10, 1, v10
  v_cmp_ne_u32 vcc, 0, v10
  s_nop 0
  s_cbranch_vccz b2_kernel_ok
  s_add_u32 s17, s17, 1
  s_cmp_lt_u32 s17, 262144
  s_cbranch_scc1 b2_kernel_poll
  v_mov_b32 v10, 0x2000
  v_mov_b32 v11, 68
  buffer_store_dword v10, v11, s[24:27], 0 offen
  s_endpgm
b2_kernel_ok:
  v_add_f32 v10, v32, v34
  v_add_f32 v11, v36, v38
  v_add_f32 v10, v10, v40
  v_add_f32 v10, v10, v11
  v_mov_b32 v11, v10
  s_nop 1
  v_permlane16_swap_b32 v10, v11
  v_add_f32 v10, v10, v11
  v_mov_b32 v11, v10
  s_nop 1
  v_permlane32_swap_b32 v10, v11
  v_add_f32 v10, v10, v11
  v_mul_f32 v10, 0x3d4ccccd, v10
  v_mov_b32 v12, 0
  v_sub_f32 v11, v32, v10
  v_fmac_f32 v12, v11, v11
  v_sub_f32 v11, v34, v10
  v_fmac_f32 v12, v11, v11
  v_sub_f32 v11, v36, v10
  v_fmac_f32 v12, v11, v11
  v_sub_f32 v11, v38, v10
  v_fmac_f32 v12, v11, v11
  v_sub_f32 v11, v40, v10
  v_fmac_f32 v12, v11, v11
  v_mul_f32 v12, 0x42000000, v12
  v_add_f32 v12, v12, v33
  v_add_f32 v12, v12, v35
  v_add_f32 v12, v12, v37
  v_add_f32 v12, v12, v39
  v_add_f32 v12, v12, v41
  v_mov_b32 v11, v12
  s_nop 1
  v_permlane16_swap_b32 v12, v11
  v_add_f32 v12, v12, v11
  v_mov_b32 v11, v12
  s_nop 1
  v_permlane32_swap_b32 v12, v11
  v_add_f32 v12, v12, v11
  v_mov_b32 v11, 0x3727c5ac
  v_fmac_f32 v11, 0x3acccccd, v12
  v_rsq_f32 v11, v11
  s_nop 0
  v_mul_f32 v10, v10, v11
  v_fma_f32 v168, v168, v11, -v10
  v_fma_f32 v169, v169, v11, -v10
  v_fma_f32 v170, v170, v11, -v10
  v_fma_f32 v171, v171, v11, -v10
  v_fma_f32 v172, v172, v11, -v10
  v_fma_f32 v173, v173, v11, -v10
  v_fma_f32 v174, v174, v11, -v10
  v_fma_f32 v175, v175, v11, -v10
  v_cvt_pk_bf16_f32 v60, v168, v169
  v_cvt_pk_bf16_f32 v61, v170, v171
  v_cvt_pk_bf16_f32 v62, v172, v173
  v_cvt_pk_bf16_f32 v63, v174, v175
  buffer_store_dwordx4 v[60:63], v2, s[4:7], s22 offen
  v_add_f32 v10, v42, v44
  v_add_f32 v11, v46, v48
  v_add_f32 v10, v10, v50
  v_add_f32 v10, v10, v11
  v_mov_b32 v11, v10
  s_nop 1
  v_permlane16_swap_b32 v10, v11
  v_add_f32 v10, v10, v11
  v_mov_b32 v11, v10
  s_nop 1
  v_permlane32_swap_b32 v10, v11
  v_add_f32 v10, v10, v11
  v_mul_f32 v10, 0x3d4ccccd, v10
  v_mov_b32 v12, 0
  v_sub_f32 v11, v42, v10
  v_fmac_f32 v12, v11, v11
  v_sub_f32 v11, v44, v10
  v_fmac_f32 v12, v11, v11
  v_sub_f32 v11, v46, v10
  v_fmac_f32 v12, v11, v11
  v_sub_f32 v11, v48, v10
  v_fmac_f32 v12, v11, v11
  v_sub_f32 v11, v50, v10
  v_fmac_f32 v12, v11, v11
  v_mul_f32 v12, 0x42000000, v12
  v_add_f32 v12, v12, v43
  v_add_f32 v12, v12, v45
  v_add_f32 v12, v12, v47
  v_add_f32 v12, v12, v49
  v_add_f32 v12, v12, v51
  v_mov_b32 v11, v12
  s_nop 1
  v_permlane16_swap_b32 v12, v11
  v_add_f32 v12, v12, v11
  v_mov_b32 v11, v12
  s_nop 1
  v_permlane32_swap_b32 v12, v11
  v_add_f32 v12, v12, v11
  v_mov_b32 v11, 0x3727c5ac
  v_fmac_f32 v11, 0x3acccccd, v12
  v_rsq_f32 v11, v11
  s_nop 0
  v_mul_f32 v10, v10, v11
  v_fma_f32 v176, v176, v11, -v10
  v_fma_f32 v177, v177, v11, -v10
  v_fma_f32 v178, v178, v11, -v10
  v_fma_f32 v179, v179, v11, -v10
  v_fma_f32 v180, v180, v11, -v10
  v_fma_f32 v181, v181, v11, -v10
  v_fma_f32 v182, v182, v11, -v10
  v_fma_f32 v183, v183, v11, -v10
  v_cvt_pk_bf16_f32 v64, v176, v177
  v_cvt_pk_bf16_f32 v65, v178, v179
  v_cvt_pk_bf16_f32 v66, v180, v181
  v_cvt_pk_bf16_f32 v67, v182, v183
  buffer_store_dwordx4 v[64:67], v3, s[4:7], s22 offen
b2_kernel_end:
  s_endpgm

.globl b2f_kernel
.p2align 8
.type b2f_kernel,@function
b2f_kernel:
  s_load_dwordx2 s[4:5], s[0:1], 104
  s_mov_b32 s6, 0x10000000
  s_mov_b32 s7, 0x20000
  s_load_dwordx2 s[24:25], s[0:1], 88
  s_mov_b32 s26, 0x280000
  s_mov_b32 s27, 0x20000
  v_lshrrev_b32 v1, 6, v0
  s_nop 0
  v_readfirstlane_b32 s3, v1
  v_and_b32 v1, 63, v0
  s_cmp_ge_u32 s2, 256
  s_cbranch_scc1 b2f_kernel_end
  s_and_b32 s8, s2, 7
  s_lshl_b32 s8, s8, 3
  s_lshr_b32 s9, s2, 5
  s_add_u32 s8, s8, s9
  s_bfe_u32 s9, s2, 0x20003
  v_lshlrev_b32 v2, 4, v1
  v_and_b32 v4, 15, v1
  v_lshrrev_b32 v5, 4, v1
  v_mul_u32_u24 v6, 1280, v4
  v_lshl_add_u32 v6, v5, 4, v6
  s_mul_i32 s10, s9, 5
  s_add_u32 s10, s10, s3
  s_mul_i32 s11, s8, 40960
  s_lshl_b32 s12, s10, 6
  s_add_u32 s11, s11, s12
  s_mul_i32 s12, s8, 40
  s_add_u32 s12, s12, s10
  s_lshl_b32 s12, s12, 10
  s_add_u32 s22, s12, 26214400
  s_add_u32 s12, s12, 56000512
  s_mul_i32 s14, s10, 40960
  s_add_u32 s14, s14, 96964608
  v_add_u32 v3, 20480, v2
  v_lshrrev_b32 v7, 2, v4
  v_cmp_eq_u32 vcc, v7, v5
  v_lshlrev_b32 v7, 4, v4
  s_mov_b64 s[20:21], vcc
  s_mul_i32 s15, s3, 15360
  s_add_u32 s15, s15, 40960
  v_add_u32 v7, s15, v7
  s_waitcnt lgkmcnt(0)
  s_cmp_eq_u32 s3, 4
  s_cbranch_scc1 b2f_kernel_ph2
  s_mul_i32 s16, s3, 15360
  s_add_u32 s16, s16, 97783808
  s_mov_b32 m0, s15
  s_nop 0
  buffer_load_dwordx4 v2, s[4:7], s16 offen offset:0 lds
  buffer_load_dwordx4 v2, s[4:7], s16 offen offset:1024 lds
  buffer_load_dwordx4 v2, s[4:7], s16 offen offset:2048 lds
  buffer_load_dwordx4 v2, s[4:7], s16 offen offset:3072 lds
  s_add_u32 s15, s15, 4096
  s_add_u32 s16, s16, 4096
  s_mov_b32 m0, s15
  s_nop 0
  buffer_load_dwordx4 v2, s[4:7], s16 offen offset:0 lds
  buffer_load_dwordx4 v2, s[4:7], s16 offen offset:1024 lds
  buffer_load_dwordx4 v2, s[4:7], s16 offen offset:2048 lds
  buffer_load_dwordx4 v2, s[4:7], s16 offen offset:3072 lds
  s_add_u32 s15, s15, 4096
  s_add_u32 s16, s16, 4096
  s_mov_b32 m0, s15
  s_nop 0
  buffer_load_dwordx4 v2, s[4:7], s16 offen offset:0 lds
  buffer_load_dwordx4 v2, s[4:7], s16 offen offset:1024 lds
  buffer_load_dwordx4 v2, s[4:7], s16 offen offset:2048 lds
  buffer_load_dwordx4 v2, s[4:7], s16 offen offset:3072 lds
  s_add_u32 s15, s15, 4096
  s_add_u32 s16, s16, 4096
  s_mov_b32 m0, s15
  s_nop 0
  buffer_load_dwordx4 v2, s[4:7], s16 offen offset:0 lds
  buffer_load_dwordx4 v2, s[4:7], s16 offen offset:1024 lds
  buffer_load_dwordx4 v2, s[4:7], s16 offen offset:2048 lds
  s_lshl_b32 s15, s8, 4
  s_lshl_b32 s16, s3, 1
  s_add_u32 s15, s15, s16
  s_mul_i32 s15, s15, 5120
  s_add_u32 s15, s15, 44466176
  s_add_u32 s17, s15, 0
  s_add_u32 s18, s17, 4096
  buffer_load_dwordx4 v[56:59], v2, s[4:7], s17 offen offset:0
  buffer_load_dwordx4 v[60:63], v2, s[4:7], s17 offen offset:1024
  buffer_load_dwordx4 v[64:67], v2, s[4:7], s17 offen offset:2048
  buffer_load_dwordx4 v[68:71], v2, s[4:7], s17 offen offset:3072
  buffer_load_dwordx4 v[72:75], v2, s[4:7], s18 offen offset:0
  s_add_u32 s17, s15, 40960
  s_add_u32 s18, s17, 4096
  buffer_load_dwordx4 v[96:99], v2, s[4:7], s17 offen offset:0
  buffer_load_dwordx4 v[100:103], v2, s[4:7], s17 offen offset:1024
  buffer_load_dwordx4 v[104:107], v2, s[4:7], s17 offen offset:2048
  buffer_load_dwordx4 v[108:111], v2, s[4:7], s17 offen offset:3072
  buffer_load_dwordx4 v[112:115], v2, s[4:7], s18 offen offset:0
  s_add_u32 s17, s15, 5120
  s_add_u32 s18, s17, 4096
  buffer_load_dwordx4 v[76:79], v2, s[4:7], s17 offen offset:0
  buffer_load_dwordx4 v[80:83], v2, s[4:7], s17 offen offset:1024
  buffer_load_dwordx4 v[84:87], v2, s[4:7], s17 offen offset:2048
  buffer_load_dwordx4 v[88:91], v2, s[4:7], s17 offen offset:3072
  buffer_load_dwordx4 v[92:95], v2, s[4:7], s18 offen offset:0
  s_add_u32 s17, s15, 46080
  s_add_u32 s18, s17, 4096
  buffer_load_dwordx4 v[116:119], v2, s[4:7], s17 offen offset:0
  buffer_load_dwordx4 v[120:123], v2, s[4:7], s17 offen offset:1024
  buffer_load_dwordx4 v[124:127], v2, s[4:7], s17 offen offset:2048
  buffer_load_dwordx4 v[128:131], v2, s[4:7], s17 offen offset:3072
  buffer_load_dwordx4 v[132:135], v2, s[4:7], s18 offen offset:0
  buffer_load_dwordx4 v[24:27], v2, s[4:7], s14 offen
  buffer_load_dwordx4 v[28:31], v3, s[4:7], s14 offen
  s_add_u32 s14, s14, 1024
  buffer_load_dwordx4 v[32:35], v2, s[4:7], s14 offen
  buffer_load_dwordx4 v[36:39], v3, s[4:7], s14 offen
  s_add_u32 s14, s14, 1024
  buffer_load_dwordx4 v[40:43], v2, s[4:7], s14 offen
  buffer_load_dwordx4 v[44:47], v3, s[4:7], s14 offen
  s_add_u32 s14, s14, 1024
  buffer_load_dwordx4 v[48:51], v2, s[4:7], s14 offen
  buffer_load_dwordx4 v[52:55], v3, s[4:7], s14 offen
  s_add_u32 s14, s14, 1024
  v_mov_b32 v136, 0
  v_mov_b32 v137, 0
  v_mov_b32 v138, 0
  v_mov_b32 v139, 0
  v_mov_b32 v140, 0
  v_mov_b32 v141, 0
  v_mov_b32 v142, 0
  v_mov_b32 v143, 0
  v_mov_b32 v144, 0
  v_mov_b32 v145, 0
  v_mov_b32 v146, 0
  v_mov_b32 v147, 0
  v_mov_b32 v148, 0
  v_mov_b32 v149, 0
  v_mov_b32 v150, 0
  v_mov_b32 v151, 0
  v_mov_b32 v152, 0
  v_mov_b32 v153, 0
  v_mov_b32 v154, 0
  v_mov_b32 v155, 0
  v_mov_b32 v156, 0
  v_mov_b32 v157, 0
  v_mov_b32 v158, 0
  v_mov_b32 v159, 0
  v_mov_b32 v160, 0
  v_mov_b32 v161, 0
  v_mov_b32 v162, 0
  v_mov_b32 v163, 0
  v_mov_b32 v164, 0
  v_mov_b32 v165, 0
  v_mov_b32 v166, 0
  v_mov_b32 v167, 0
  v_mov_b32 v168, 0
  v_mov_b32 v169, 0
  v_mov_b32 v170, 0
  v_mov_b32 v171, 0
  v_mov_b32 v172, 0
  v_mov_b32 v173, 0
  v_mov_b32 v174, 0
  v_mov_b32 v175, 0
  v_mov_b32 v176, 0
  v_mov_b32 v177, 0
  v_mov_b32 v178, 0
  v_mov_b32 v179, 0
  v_mov_b32 v180, 0
  v_mov_b32 v181, 0
  v_mov_b32 v182, 0
  v_mov_b32 v183, 0
  v_mov_b32 v184, 0
  v_mov_b32 v185, 0
  v_mov_b32 v186, 0
  v_mov_b32 v187, 0
  v_mov_b32 v188, 0
  v_mov_b32 v189, 0
  v_mov_b32 v190, 0
  v_mov_b32 v191, 0
  v_mov_b32 v192, 0
  v_mov_b32 v193, 0
  v_mov_b32 v194, 0
  v_mov_b32 v195, 0
  s_waitcnt vmcnt(28)
  s_mov_b64 exec, s[20:21]
  ds_read_b128 v[136:139], v7 offset:0
  ds_read_b128 v[140:143], v7 offset:256
  ds_read_b128 v[144:147], v7 offset:512
  ds_read_b128 v[148:151], v7 offset:768
  ds_read_b128 v[152:155], v7 offset:1024
  s_mov_b64 exec, -1
  s_mov_b64 exec, s[20:21]
  ds_read_b128 v[156:159], v7 offset:1280
  ds_read_b128 v[160:163], v7 offset:1536
  ds_read_b128 v[164:167], v7 offset:1792
  ds_read_b128 v[168:171], v7 offset:2048
  ds_read_b128 v[172:175], v7 offset:2304
  s_mov_b64 exec, -1
  s_mov_b64 exec, s[20:21]
  ds_read_b128 v[176:179], v7 offset:2560
  ds_read_b128 v[180:183], v7 offset:2816
  ds_read_b128 v[184:187], v7 offset:3072
  ds_read_b128 v[188:191], v7 offset:3328
  ds_read_b128 v[192:195], v7 offset:3584
  s_mov_b64 exec, -1
  s_mul_i32 s17, s3, 5120
  v_add_u32 v9, s17, v2
  v_mov_b32 v10, 0x358637bd
  s_waitcnt vmcnt(18)
  s_waitcnt lgkmcnt(10)
  v_mfma_f32_16x16x32_bf16 v[196:199], v[136:139], v[56:59], 0
  v_mfma_f32_16x16x32_bf16 v[200:203], v[136:139], v[96:99], 0
  v_mfma_f32_16x16x32_bf16 v[196:199], v[140:143], v[60:63], v[196:199]
  v_mfma_f32_16x16x32_bf16 v[200:203], v[140:143], v[100:103], v[200:203]
  v_mfma_f32_16x16x32_bf16 v[196:199], v[144:147], v[64:67], v[196:199]
  v_mfma_f32_16x16x32_bf16 v[200:203], v[144:147], v[104:107], v[200:203]
  v_mfma_f32_16x16x32_bf16 v[196:199], v[148:151], v[68:71], v[196:199]
  v_mfma_f32_16x16x32_bf16 v[200:203], v[148:151], v[108:111], v[200:203]
  v_mfma_f32_16x16x32_bf16 v[196:199], v[152:155], v[72:75], v[196:199]
  v_mfma_f32_16x16x32_bf16 v[200:203], v[152:155], v[112:115], v[200:203]
  s_mov_b64 exec, s[20:21]
  ds_read_b128 v[136:139], v7 offset:3840
  ds_read_b128 v[140:143], v7 offset:4096
  ds_read_b128 v[144:147], v7 offset:4352
  ds_read_b128 v[148:151], v7 offset:4608
  ds_read_b128 v[152:155], v7 offset:4864
  s_mov_b64 exec, -1
  s_waitcnt lgkmcnt(10)
  v_mfma_f32_16x16x32_bf16 v[204:207], v[156:159], v[56:59], 0
  v_mfma_f32_16x16x32_bf16 v[208:211], v[156:159], v[96:99], 0
  v_mfma_f32_16x16x32_bf16 v[204:207], v[160:163], v[60:63], v[204:207]
  v_mfma_f32_16x16x32_bf16 v[208:211], v[160:163], v[100:103], v[208:211]
  v_mfma_f32_16x16x32_bf16 v[204:207], v[164:167], v[64:67], v[204:207]
  v_mfma_f32_16x16x32_bf16 v[208:211], v[164:167], v[104:107], v[208:211]
  v_mfma_f32_16x16x32_bf16 v[204:207], v[168:171], v[68:71], v[204:207]
  v_mfma_f32_16x16x32_bf16 v[208:211], v[168:171], v[108:111], v[208:211]
  v_mfma_f32_16x16x32_bf16 v[204:207], v[172:175], v[72:75], v[204:207]
  v_mfma_f32_16x16x32_bf16 v[208:211], v[172:175], v[112:115], v[208:211]
  s_mov_b64 exec, s[20:21]
  ds_read_b128 v[156:159], v7 offset:5120
  ds_read_b128 v[160:163], v7 offset:5376
  ds_read_b128 v[164:167], v7 offset:5632
  ds_read_b128 v[168:171], v7 offset:5888
  ds_read_b128 v[172:175], v7 offset:6144
  s_mov_b64 exec, -1
  s_waitcnt lgkmcnt(10)
  v_mfma_f32_16x16x32_bf16 v[212:215], v[176:179], v[56:59], 0
  v_mfma_f32_16x16x32_bf16 v[216:219], v[176:179], v[96:99], 0
  v_mfma_f32_16x16x32_bf16 v[212:215], v[180:183], v[60:63], v[212:215]
  v_mfma_f32_16x16x32_bf16 v[216:219], v[180:183], v[100:103], v[216:219]
  v_mfma_f32_16x16x32_bf16 v[212:215], v[184:187], v[64:67], v[212:215]
  v_mfma_f32_16x16x32_bf16 v[216:219], v[184:187], v[104:107], v[216:219]
  v_mfma_f32_16x16x32_bf16 v[212:215], v[188:191], v[68:71], v[212:215]
  v_mfma_f32_16x16x32_bf16 v[216:219], v[188:191], v[108:111], v[216:219]
  v_mfma_f32_16x16x32_bf16 v[212:215], v[192:195], v[72:75], v[212:215]
  v_mfma_f32_16x16x32_bf16 v[216:219], v[192:195], v[112:115], v[216:219]
  s_mov_b64 exec, s[20:21]
  ds_read_b128 v[176:179], v7 offset:6400
  ds_read_b128 v[180:183], v7 offset:6656
  ds_read_b128 v[184:187], v7 offset:6912
  ds_read_b128 v[188:191], v7 offset:7168
  ds_read_b128 v[192:195], v7 offset:7424
  s_mov_b64 exec, -1
  s_waitcnt lgkmcnt(10)
  v_mfma_f32_16x16x32_bf16 v[220:223], v[136:139], v[56:59], 0
  v_mfma_f32_16x16x32_bf16 v[224:227], v[136:139], v[96:99], 0
  v_mfma_f32_16x16x32_bf16 v[220:223], v[140:143], v[60:63], v[220:223]
  v_mfma_f32_16x16x32_bf16 v[224:227], v[140:143], v[100:103], v[224:227]
  v_mfma_f32_16x16x32_bf16 v[220:223], v[144:147], v[64:67], v[220:223]
  v_mfma_f32_16x16x32_bf16 v[224:227], v[144:147], v[104:107], v[224:227]
  v_mfma_f32_16x16x32_bf16 v[220:223], v[148:151], v[68:71], v[220:223]
  v_mfma_f32_16x16x32_bf16 v[224:227], v[148:151], v[108:111], v[224:227]
  v_mfma_f32_16x16x32_bf16 v[220:223], v[152:155], v[72:75], v[220:223]
  v_mfma_f32_16x16x32_bf16 v[224:227], v[152:155], v[112:115], v[224:227]
  s_mov_b64 exec, s[20:21]
  ds_read_b128 v[136:139], v7 offset:7680
  ds_read_b128 v[140:143], v7 offset:7936
  ds_read_b128 v[144:147], v7 offset:8192
  ds_read_b128 v[148:151], v7 offset:8448
  ds_read_b128 v[152:155], v7 offset:8704
  s_mov_b64 exec, -1
  s_waitcnt lgkmcnt(10)
  v_mfma_f32_16x16x32_bf16 v[228:231], v[156:159], v[56:59], 0
  v_mfma_f32_16x16x32_bf16 v[232:235], v[156:159], v[96:99], 0
  v_mfma_f32_16x16x32_bf16 v[228:231], v[160:163], v[60:63], v[228:231]
  v_mfma_f32_16x16x32_bf16 v[232:235], v[160:163], v[100:103], v[232:235]
  v_mfma_f32_16x16x32_bf16 v[228:231], v[164:167], v[64:67], v[228:231]
  v_mfma_f32_16x16x32_bf16 v[232:235], v[164:167], v[104:107], v[232:235]
  v_mfma_f32_16x16x32_bf16 v[228:231], v[168:171], v[68:71], v[228:231]
  v_mfma_f32_16x16x32_bf16 v[232:235], v[168:171], v[108:111], v[232:235]
  v_mfma_f32_16x16x32_bf16 v[228:231], v[172:175], v[72:75], v[228:231]
  v_mfma_f32_16x16x32_bf16 v[232:235], v[172:175], v[112:115], v[232:235]
  s_mov_b64 exec, s[20:21]
  ds_read_b128 v[156:159], v7 offset:8960
  ds_read_b128 v[160:163], v7 offset:9216
  ds_read_b128 v[164:167], v7 offset:9472
  ds_read_b128 v[168:171], v7 offset:9728
  ds_read_b128 v[172:175], v7 offset:9984
  s_mov_b64 exec, -1
  s_waitcnt lgkmcnt(10)
  v_mfma_f32_16x16x32_bf16 v[236:239], v[176:179], v[56:59], 0
  v_mfma_f32_16x16x32_bf16 v[240:243], v[176:179], v[96:99], 0
  v_mfma_f32_16x16x32_bf16 v[236:239], v[180:183], v[60:63], v[236:239]
  v_mfma_f32_16x16x32_bf16 v[240:243], v[180:183], v[100:103], v[240:243]
  v_mfma_f32_16x16x32_bf16 v[236:239], v[184:187], v[64:67], v[236:239]
  v_mfma_f32_16x16x32_bf16 v[240:243], v[184:187], v[104:107], v[240:243]
  v_mfma_f32_16x16x32_bf16 v[236:239], v[188:191], v[68:71], v[236:239]
  v_mfma_f32_16x16x32_bf16 v[240:243], v[188:191], v[108:111], v[240:243]
  v_mfma_f32_16x16x32_bf16 v[236:239], v[192:195], v[72:75], v[236:239]
  v_mfma_f32_16x16x32_bf16 v[240:243], v[192:195], v[112:115], v[240:243]
  s_mov_b64 exec, s[20:21]
  ds_read_b128 v[176:179], v7 offset:10240
  ds_read_b128 v[180:183], v7 offset:10496
  ds_read_b128 v[184:187], v7 offset:10752
  ds_read_b128 v[188:191], v7 offset:11008
  ds_read_b128 v[192:195], v7 offset:11264
  s_mov_b64 exec, -1
  v_add_f32 v236, v236, v10
  v_rcp_f32 v236, v236
  s_nop 0
  v_mov_b32 v237, v236
  v_pk_mul_f32 v[196:197], v[196:197], v[236:237]
  v_cvt_pk_bf16_f32 v244, v196, v197
  v_pk_mul_f32 v[198:199], v[198:199], v[236:237]
  v_cvt_pk_bf16_f32 v245, v198, v199
  v_pk_mul_f32 v[204:205], v[204:205], v[236:237]
  v_cvt_pk_bf16_f32 v246, v204, v205
  v_pk_mul_f32 v[206:207], v[206:207], v[236:237]
  v_cvt_pk_bf16_f32 v247, v206, v207
  v_pk_mul_f32 v[212:213], v[212:213], v[236:237]
  v_cvt_pk_bf16_f32 v248, v212, v213
  v_pk_mul_f32 v[214:215], v[214:215], v[236:237]
  v_cvt_pk_bf16_f32 v249, v214, v215
  v_pk_mul_f32 v[220:221], v[220:221], v[236:237]
  v_cvt_pk_bf16_f32 v250, v220, v221
  v_pk_mul_f32 v[222:223], v[222:223], v[236:237]
  v_cvt_pk_bf16_f32 v251, v222, v223
  v_pk_mul_f32 v[228:229], v[228:229], v[236:237]
  v_cvt_pk_bf16_f32 v252, v228, v229
  v_pk_mul_f32 v[230:231], v[230:231], v[236:237]
  v_cvt_pk_bf16_f32 v253, v230, v231
  ds_write_b128 v9, v[244:247] offset:0
  ds_write_b128 v9, v[248:251] offset:1024
  ds_write_b64 v9, v[252:253] offset:2048
  s_waitcnt lgkmcnt(0)
  v_add_f32 v240, v240, v10
  v_rcp_f32 v240, v240
  s_nop 0
  v_mov_b32 v241, v240
  v_pk_mul_f32 v[200:201], v[200:201], v[240:241]
  v_cvt_pk_bf16_f32 v244, v200, v201
  v_pk_mul_f32 v[202:203], v[202:203], v[240:241]
  v_cvt_pk_bf16_f32 v245, v202, v203
  v_pk_mul_f32 v[208:209], v[208:209], v[240:241]
  v_cvt_pk_bf16_f32 v246, v208, v209
  v_pk_mul_f32 v[210:211], v[210:211], v[240:241]
  v_cvt_pk_bf16_f32 v247, v210, v211
  v_pk_mul_f32 v[216:217], v[216:217], v[240:241]
  v_cvt_pk_bf16_f32 v248, v216, v217
  v_pk_mul_f32 v[218:219], v[218:219], v[240:241]
  v_cvt_pk_bf16_f32 v249, v218, v219
  v_pk_mul_f32 v[224:225], v[224:225], v[240:241]
  v_cvt_pk_bf16_f32 v250, v224, v225
  v_pk_mul_f32 v[226:227], v[226:227], v[240:241]
  v_cvt_pk_bf16_f32 v251, v226, v227
  v_pk_mul_f32 v[232:233], v[232:233], v[240:241]
  v_cvt_pk_bf16_f32 v252, v232, v233
  v_pk_mul_f32 v[234:235], v[234:235], v[240:241]
  v_cvt_pk_bf16_f32 v253, v234, v235
  ds_write_b128 v9, v[244:247] offset:20480
  ds_write_b128 v9, v[248:251] offset:21504
  ds_write_b64 v9, v[252:253] offset:22528
  s_waitcnt lgkmcnt(0)
  s_waitcnt vmcnt(8)
  s_waitcnt lgkmcnt(5)
  v_mfma_f32_16x16x32_bf16 v[196:199], v[136:139], v[76:79], 0
  v_mfma_f32_16x16x32_bf16 v[200:203], v[136:139], v[116:119], 0
  v_mfma_f32_16x16x32_bf16 v[196:199], v[140:143], v[80:83], v[196:199]
  v_mfma_f32_16x16x32_bf16 v[200:203], v[140:143], v[120:123], v[200:203]
  v_mfma_f32_16x16x32_bf16 v[196:199], v[144:147], v[84:87], v[196:199]
  v_mfma_f32_16x16x32_bf16 v[200:203], v[144:147], v[124:127], v[200:203]
  v_mfma_f32_16x16x32_bf16 v[196:199], v[148:151], v[88:91], v[196:199]
  v_mfma_f32_16x16x32_bf16 v[200:203], v[148:151], v[128:131], v[200:203]
  v_mfma_f32_16x16x32_bf16 v[196:199], v[152:155], v[92:95], v[196:199]
  v_mfma_f32_16x16x32_bf16 v[200:203], v[152:155], v[132:135], v[200:203]
  s_mov_b64 exec, s[20:21]
  ds_read_b128 v[136:139], v7 offset:11520
  ds_read_b128 v[140:143], v7 offset:11776
  ds_read_b128 v[144:147], v7 offset:12032
  ds_read_b128 v[148:151], v7 offset:12288
  ds_read_b128 v[152:155], v7 offset:12544
  s_mov_b64 exec, -1
  s_waitcnt lgkmcnt(10)
  v_mfma_f32_16x16x32_bf16 v[204:207], v[156:159], v[76:79], 0
  v_mfma_f32_16x16x32_bf16 v[208:211], v[156:159], v[116:119], 0
  v_mfma_f32_16x16x32_bf16 v[204:207], v[160:163], v[80:83], v[204:207]
  v_mfma_f32_16x16x32_bf16 v[208:211], v[160:163], v[120:123], v[208:211]
  v_mfma_f32_16x16x32_bf16 v[204:207], v[164:167], v[84:87], v[204:207]
  v_mfma_f32_16x16x32_bf16 v[208:211], v[164:167], v[124:127], v[208:211]
  v_mfma_f32_16x16x32_bf16 v[204:207], v[168:171], v[88:91], v[204:207]
  v_mfma_f32_16x16x32_bf16 v[208:211], v[168:171], v[128:131], v[208:211]
  v_mfma_f32_16x16x32_bf16 v[204:207], v[172:175], v[92:95], v[204:207]
  v_mfma_f32_16x16x32_bf16 v[208:211], v[172:175], v[132:135], v[208:211]
  s_mov_b64 exec, s[20:21]
  ds_read_b128 v[156:159], v7 offset:12800
  ds_read_b128 v[160:163], v7 offset:13056
  ds_read_b128 v[164:167], v7 offset:13312
  ds_read_b128 v[168:171], v7 offset:13568
  ds_read_b128 v[172:175], v7 offset:13824
  s_mov_b64 exec, -1
  s_waitcnt lgkmcnt(10)
  v_mfma_f32_16x16x32_bf16 v[212:215], v[176:179], v[76:79], 0
  v_mfma_f32_16x16x32_bf16 v[216:219], v[176:179], v[116:119], 0
  v_mfma_f32_16x16x32_bf16 v[212:215], v[180:183], v[80:83], v[212:215]
  v_mfma_f32_16x16x32_bf16 v[216:219], v[180:183], v[120:123], v[216:219]
  v_mfma_f32_16x16x32_bf16 v[212:215], v[184:187], v[84:87], v[212:215]
  v_mfma_f32_16x16x32_bf16 v[216:219], v[184:187], v[124:127], v[216:219]
  v_mfma_f32_16x16x32_bf16 v[212:215], v[188:191], v[88:91], v[212:215]
  v_mfma_f32_16x16x32_bf16 v[216:219], v[188:191], v[128:131], v[216:219]
  v_mfma_f32_16x16x32_bf16 v[212:215], v[192:195], v[92:95], v[212:215]
  v_mfma_f32_16x16x32_bf16 v[216:219], v[192:195], v[132:135], v[216:219]
  s_mov_b64 exec, s[20:21]
  ds_read_b128 v[176:179], v7 offset:14080
  ds_read_b128 v[180:183], v7 offset:14336
  ds_read_b128 v[184:187], v7 offset:14592
  ds_read_b128 v[188:191], v7 offset:14848
  ds_read_b128 v[192:195], v7 offset:15104
  s_mov_b64 exec, -1
  s_waitcnt lgkmcnt(10)
  v_mfma_f32_16x16x32_bf16 v[220:223], v[136:139], v[76:79], 0
  v_mfma_f32_16x16x32_bf16 v[224:227], v[136:139], v[116:119], 0
  v_mfma_f32_16x16x32_bf16 v[220:223], v[140:143], v[80:83], v[220:223]
  v_mfma_f32_16x16x32_bf16 v[224:227], v[140:143], v[120:123], v[224:227]
  v_mfma_f32_16x16x32_bf16 v[220:223], v[144:147], v[84:87], v[220:223]
  v_mfma_f32_16x16x32_bf16 v[224:227], v[144:147], v[124:127], v[224:227]
  v_mfma_f32_16x16x32_bf16 v[220:223], v[148:151], v[88:91], v[220:223]
  v_mfma_f32_16x16x32_bf16 v[224:227], v[148:151], v[128:131], v[224:227]
  v_mfma_f32_16x16x32_bf16 v[220:223], v[152:155], v[92:95], v[220:223]
  v_mfma_f32_16x16x32_bf16 v[224:227], v[152:155], v[132:135], v[224:227]
  s_waitcnt lgkmcnt(5)
  v_mfma_f32_16x16x32_bf16 v[228:231], v[156:159], v[76:79], 0
  v_mfma_f32_16x16x32_bf16 v[232:235], v[156:159], v[116:119], 0
  v_mfma_f32_16x16x32_bf16 v[228:231], v[160:163], v[80:83], v[228:231]
  v_mfma_f32_16x16x32_bf16 v[232:235], v[160:163], v[120:123], v[232:235]
  v_mfma_f32_16x16x32_bf16 v[228:231], v[164:167], v[84:87], v[228:231]
  v_mfma_f32_16x16x32_bf16 v[232:235], v[164:167], v[124:127], v[232:235]
  v_mfma_f32_16x16x32_bf16 v[228:231], v[168:171], v[88:91], v[228:231]
  v_mfma_f32_16x16x32_bf16 v[232:235], v[168:171], v[128:131], v[232:235]
  v_mfma_f32_16x16x32_bf16 v[228:231], v[172:175], v[92:95], v[228:231]
  v_mfma_f32_16x16x32_bf16 v[232:235], v[172:175], v[132:135], v[232:235]
  s_waitcnt lgkmcnt(0)
  v_mfma_f32_16x16x32_bf16 v[236:239], v[176:179], v[76:79], 0
  v_mfma_f32_16x16x32_bf16 v[240:243], v[176:179], v[116:119], 0
  v_mfma_f32_16x16x32_bf16 v[236:239], v[180:183], v[80:83], v[236:239]
  v_mfma_f32_16x16x32_bf16 v[240:243], v[180:183], v[120:123], v[240:243]
  v_mfma_f32_16x16x32_bf16 v[236:239], v[184:187], v[84:87], v[236:239]
  v_mfma_f32_16x16x32_bf16 v[240:243], v[184:187], v[124:127], v[240:243]
  v_mfma_f32_16x16x32_bf16 v[236:239], v[188:191], v[88:91], v[236:239]
  v_mfma_f32_16x16x32_bf16 v[240:243], v[188:191], v[128:131], v[240:243]
  v_mfma_f32_16x16x32_bf16 v[236:239], v[192:195], v[92:95], v[236:239]
  v_mfma_f32_16x16x32_bf16 v[240:243], v[192:195], v[132:135], v[240:243]
  s_nop 4
  v_add_f32 v236, v236, v10
  v_rcp_f32 v236, v236
  s_nop 0
  v_mov_b32 v237, v236
  v_pk_mul_f32 v[196:197], v[196:197], v[236:237]
  v_cvt_pk_bf16_f32 v246, v196, v197
  v_pk_mul_f32 v[198:199], v[198:199], v[236:237]
  v_cvt_pk_bf16_f32 v247, v198, v199
  v_pk_mul_f32 v[204:205], v[204:205], v[236:237]
  v_cvt_pk_bf16_f32 v248, v204, v205
  v_pk_mul_f32 v[206:207], v[206:207], v[236:237]
  v_cvt_pk_bf16_f32 v249, v206, v207
  v_pk_mul_f32 v[212:213], v[212:213], v[236:237]
  v_cvt_pk_bf16_f32 v250, v212, v213
  v_pk_mul_f32 v[214:215], v[214:215], v[236:237]
  v_cvt_pk_bf16_f32 v251, v214, v215
  v_pk_mul_f32 v[220:221], v[220:221], v[236:237]
  v_cvt_pk_bf16_f32 v252, v220, v221
  v_pk_mul_f32 v[222:223], v[222:223], v[236:237]
  v_cvt_pk_bf16_f32 v253, v222, v223
  v_pk_mul_f32 v[228:229], v[228:229], v[236:237]
  v_cvt_pk_bf16_f32 v254, v228, v229
  v_pk_mul_f32 v[230:231], v[230:231], v[236:237]
  v_cvt_pk_bf16_f32 v255, v230, v231
  ds_write_b64 v9, v[246:247] offset:2056
  ds_write_b128 v9, v[248:251] offset:3072
  ds_write_b128 v9, v[252:255] offset:4096
  s_waitcnt lgkmcnt(0)
  v_add_f32 v240, v240, v10
  v_rcp_f32 v240, v240
  s_nop 0
  v_mov_b32 v241, v240
  v_pk_mul_f32 v[200:201], v[200:201], v[240:241]
  v_cvt_pk_bf16_f32 v246, v200, v201
  v_pk_mul_f32 v[202:203], v[202:203], v[240:241]
  v_cvt_pk_bf16_f32 v247, v202, v203
  v_pk_mul_f32 v[208:209], v[208:209], v[240:241]
  v_cvt_pk_bf16_f32 v248, v208, v209
  v_pk_mul_f32 v[210:211], v[210:211], v[240:241]
  v_cvt_pk_bf16_f32 v249, v210, v211
  v_pk_mul_f32 v[216:217], v[216:217], v[240:241]
  v_cvt_pk_bf16_f32 v250, v216, v217
  v_pk_mul_f32 v[218:219], v[218:219], v[240:241]
  v_cvt_pk_bf16_f32 v251, v218, v219
  v_pk_mul_f32 v[224:225], v[224:225], v[240:241]
  v_cvt_pk_bf16_f32 v252, v224, v225
  v_pk_mul_f32 v[226:227], v[226:227], v[240:241]
  v_cvt_pk_bf16_f32 v253, v226, v227
  v_pk_mul_f32 v[232:233], v[232:233], v[240:241]
  v_cvt_pk_bf16_f32 v254, v232, v233
  v_pk_mul_f32 v[234:235], v[234:235], v[240:241]
  v_cvt_pk_bf16_f32 v255, v234, v235
  ds_write_b64 v9, v[246:247] offset:22536
  ds_write_b128 v9, v[248:251] offset:23552
  ds_write_b128 v9, v[252:255] offset:24576
  s_waitcnt lgkmcnt(0)
  s_branch b2f_kernel_ph2b
b2f_kernel_ph2:
  buffer_load_dwordx4 v[24:27], v2, s[4:7], s14 offen
  buffer_load_dwordx4 v[28:31], v3, s[4:7], s14 offen
  s_add_u32 s14, s14, 1024
  buffer_load_dwordx4 v[32:35], v2, s[4:7], s14 offen
  buffer_load_dwordx4 v[36:39], v3, s[4:7], s14 offen
  s_add_u32 s14, s14, 1024
  buffer_load_dwordx4 v[40:43], v2, s[4:7], s14 offen
  buffer_load_dwordx4 v[44:47], v3, s[4:7], s14 offen
  s_add_u32 s14, s14, 1024
  buffer_load_dwordx4 v[48:51], v2, s[4:7], s14 offen
  buffer_load_dwordx4 v[52:55], v3, s[4:7], s14 offen
  s_add_u32 s14, s14, 1024
b2f_kernel_ph2b:
  buffer_load_dwordx4 v[56:59], v2, s[4:7], s14 offen
  buffer_load_dwordx4 v[60:63], v3, s[4:7], s14 offen
  s_add_u32 s14, s14, 1024
  buffer_load_dwordx4 v[64:67], v2, s[4:7], s14 offen
  buffer_load_dwordx4 v[68:71], v3, s[4:7], s14 offen
  s_add_u32 s14, s14, 1024
  buffer_load_dwordx4 v[72:75], v2, s[4:7], s14 offen
  buffer_load_dwordx4 v[76:79], v3, s[4:7], s14 offen
  s_add_u32 s14, s14, 1024
  buffer_load_dwordx4 v[80:83], v2, s[4:7], s14 offen
  buffer_load_dwordx4 v[84:87], v3, s[4:7], s14 offen
  s_add_u32 s14, s14, 1024
  buffer_load_dwordx4 v[88:91], v2, s[4:7], s14 offen
  buffer_load_dwordx4 v[92:95], v3, s[4:7], s14 offen
  s_add_u32 s14, s14, 1024
  buffer_load_dwordx4 v[96:99], v2, s[4:7], s14 offen
  buffer_load_dwordx4 v[100:103], v3, s[4:7], s14 offen
  s_add_u32 s14, s14, 1024
  buffer_load_dwordx4 v[16:19], v2, s[4:7], s12 offen
  buffer_load_dwordx4 v[20:23], v3, s[4:7], s12 offen
  s_barrier
  ds_read_b128 v[136:139], v2 offset:0
  ds_read_b128 v[140:143], v3 offset:0
  ds_read_b128 v[144:147], v2 offset:1024
  ds_read_b128 v[148:151], v3 offset:1024
  ds_read_b128 v[152:155], v2 offset:2048
  ds_read_b128 v[156:159], v3 offset:2048
  s_waitcnt vmcnt(20) lgkmcnt(4)
  v_mfma_f32_16x16x32_bf16 v[168:171], v[24:27], v[136:139], 0
  v_mfma_f32_16x16x32_bf16 v[176:179], v[24:27], v[140:143], 0
  v_mfma_f32_16x16x32_bf16 v[172:175], v[28:31], v[136:139], 0
  v_mfma_f32_16x16x32_bf16 v[180:183], v[28:31], v[140:143], 0
  buffer_load_dwordx4 v[24:27], v2, s[4:7], s14 offen
  buffer_load_dwordx4 v[28:31], v3, s[4:7], s14 offen
  s_add_u32 s14, s14, 1024
  ds_read_b128 v[160:163], v2 offset:3072
  ds_read_b128 v[164:167], v3 offset:3072
  s_waitcnt vmcnt(20) lgkmcnt(4)
  v_mfma_f32_16x16x32_bf16 v[168:171], v[32:35], v[144:147], v[168:171]
  v_mfma_f32_16x16x32_bf16 v[176:179], v[32:35], v[148:151], v[176:179]
  v_mfma_f32_16x16x32_bf16 v[172:175], v[36:39], v[144:147], v[172:175]
  v_mfma_f32_16x16x32_bf16 v[180:183], v[36:39], v[148:151], v[180:183]
  buffer_load_dwordx4 v[32:35], v2, s[4:7], s14 offen
  buffer_load_dwordx4 v[36:39], v3, s[4:7], s14 offen
  s_add_u32 s14, s14, 1024
  ds_read_b128 v[136:139], v2 offset:4096
  ds_read_b128 v[140:143], v3 offset:4096
  s_waitcnt vmcnt(20) lgkmcnt(4)
  v_mfma_f32_16x16x32_bf16 v[168:171], v[40:43], v[152:155], v[168:171]
  v_mfma_f32_16x16x32_bf16 v[176:179], v[40:43], v[156:159], v[176:179]
  v_mfma_f32_16x16x32_bf16 v[172:175], v[44:47], v[152:155], v[172:175]
  v_mfma_f32_16x16x32_bf16 v[180:183], v[44:47], v[156:159], v[180:183]
  buffer_load_dwordx4 v[40:43], v2, s[4:7], s14 offen
  buffer_load_dwordx4 v[44:47], v3, s[4:7], s14 offen
  s_add_u32 s14, s14, 1024
  ds_read_b128 v[144:147], v2 offset:5120
  ds_read_b128 v[148:151], v3 offset:5120
  s_waitcnt vmcnt(20) lgkmcnt(4)
  v_mfma_f32_16x16x32_bf16 v[168:171], v[48:51], v[160:163], v[168:171]
  v_mfma_f32_16x16x32_bf16 v[176:179], v[48:51], v[164:167], v[176:179]
  v_mfma_f32_16x16x32_bf16 v[172:175], v[52:55], v[160:163], v[172:175]
  v_mfma_f32_16x16x32_bf16 v[180:183], v[52:55], v[164:167], v[180:183]
  buffer_load_dwordx4 v[48:51], v2, s[4:7], s14 offen
  buffer_load_dwordx4 v[52:55], v3, s[4:7], s14 offen
  s_add_u32 s14, s14, 1024
  ds_read_b128 v[152:155], v2 offset:6144
  ds_read_b128 v[156:159], v3 offset:6144
  s_waitcnt vmcnt(20) lgkmcnt(4)
  v_mfma_f32_16x16x32_bf16 v[168:171], v[56:59], v[136:139], v[168:171]
  v_mfma_f32_16x16x32_bf16 v[176:179], v[56:59], v[140:143], v[176:179]
  v_mfma_f32_16x16x32_bf16 v[172:175], v[60:63], v[136:139], v[172:175]
  v_mfma_f32_16x16x32_bf16 v[180:183], v[60:63], v[140:143], v[180:183]
  buffer_load_dwordx4 v[56:59], v2, s[4:7], s14 offen
  buffer_load_dwordx4 v[60:63], v3, s[4:7], s14 offen
  s_add_u32 s14, s14, 1024
  ds_read_b128 v[160:163], v2 offset:7168
  ds_read_b128 v[164:167], v3 offset:7168
  s_waitcnt vmcnt(20) lgkmcnt(4)
  v_mfma_f32_16x16x32_bf16 v[168:171], v[64:67], v[144:147], v[168:171]
  v_mfma_f32_16x16x32_bf16 v[176:179], v[64:67], v[148:151], v[176:179]
  v_mfma_f32_16x16x32_bf16 v[172:175], v[68:71], v[144:147], v[172:175]
  v_mfma_f32_16x16x32_bf16 v[180:183], v[68:71], v[148:151], v[180:183]
  buffer_load_dwordx4 v[64:67], v2, s[4:7], s14 offen
  buffer_load_dwordx4 v[68:71], v3, s[4:7], s14 offen
  s_add_u32 s14, s14, 1024
  ds_read_b128 v[136:139], v2 offset:8192
  ds_read_b128 v[140:143], v3 offset:8192
  s_waitcnt vmcnt(20) lgkmcnt(4)
  v_mfma_f32_16x16x32_bf16 v[168:171], v[72:75], v[152:155], v[168:171]
  v_mfma_f32_16x16x32_bf16 v[176:179], v[72:75], v[156:159], v[176:179]
  v_mfma_f32_16x16x32_bf16 v[172:175], v[76:79], v[152:155], v[172:175]
  v_mfma_f32_16x16x32_bf16 v[180:183], v[76:79], v[156:159], v[180:183]
  buffer_load_dwordx4 v[72:75], v2, s[4:7], s14 offen
  buffer_load_dwordx4 v[76:79], v3, s[4:7], s14 offen
  s_add_u32 s14, s14, 1024
  ds_read_b128 v[144:147], v2 offset:9216
  ds_read_b128 v[148:151], v3 offset:9216
  s_waitcnt vmcnt(20) lgkmcnt(4)
  v_mfma_f32_16x16x32_bf16 v[168:171], v[80:83], v[160:163], v[168:171]
  v_mfma_f32_16x16x32_bf16 v[176:179], v[80:83], v[164:167], v[176:179]
  v_mfma_f32_16x16x32_bf16 v[172:175], v[84:87], v[160:163], v[172:175]
  v_mfma_f32_16x16x32_bf16 v[180:183], v[84:87], v[164:167], v[180:183]
  buffer_load_dwordx4 v[80:83], v2, s[4:7], s14 offen
  buffer_load_dwordx4 v[84:87], v3, s[4:7], s14 offen
  s_add_u32 s14, s14, 1024
  ds_read_b128 v[152:155], v2 offset:10240
  ds_read_b128 v[156:159], v3 offset:10240
  s_waitcnt vmcnt(20) lgkmcnt(4)
  v_mfma_f32_16x16x32_bf16 v[168:171], v[88:91], v[136:139], v[168:171]
  v_mfma_f32_16x16x32_bf16 v[176:179], v[88:91], v[140:143], v[176:179]
  v_mfma_f32_16x16x32_bf16 v[172:175], v[92:95], v[136:139], v[172:175]
  v_mfma_f32_16x16x32_bf16 v[180:183], v[92:95], v[140:143], v[180:183]
  buffer_load_dwordx4 v[88:91], v2, s[4:7], s14 offen
  buffer_load_dwordx4 v[92:95], v3, s[4:7], s14 offen
  s_add_u32 s14, s14, 1024
  ds_read_b128 v[160:163], v2 offset:11264
  ds_read_b128 v[164:167], v3 offset:11264
  s_waitcnt vmcnt(20) lgkmcnt(4)
  v_mfma_f32_16x16x32_bf16 v[168:171], v[96:99], v[144:147], v[168:171]
  v_mfma_f32_16x16x32_bf16 v[176:179], v[96:99], v[148:151], v[176:179]
  v_mfma_f32_16x16x32_bf16 v[172:175], v[100:103], v[144:147], v[172:175]
  v_mfma_f32_16x16x32_bf16 v[180:183], v[100:103], v[148:151], v[180:183]
  buffer_load_dwordx4 v[96:99], v2, s[4:7], s14 offen
  buffer_load_dwordx4 v[100:103], v3, s[4:7], s14 offen
  s_add_u32 s14, s14, 1024
  ds_read_b128 v[136:139], v2 offset:12288
  ds_read_b128 v[140:143], v3 offset:12288
  s_waitcnt vmcnt(18) lgkmcnt(4)
  v_mfma_f32_16x16x32_bf16 v[168:171], v[24:27], v[152:155], v[168:171]
  v_mfma_f32_16x16x32_bf16 v[176:179], v[24:27], v[156:159], v[176:179]
  v_mfma_f32_16x16x32_bf16 v[172:175], v[28:31], v[152:155], v[172:175]
  v_mfma_f32_16x16x32_bf16 v[180:183], v[28:31], v[156:159], v[180:183]
  ds_read_b128 v[144:147], v2 offset:13312
  ds_read_b128 v[148:151], v3 offset:13312
  s_waitcnt vmcnt(16) lgkmcnt(4)
  v_mfma_f32_16x16x32_bf16 v[168:171], v[32:35], v[160:163], v[168:171]
  v_mfma_f32_16x16x32_bf16 v[176:179], v[32:35], v[164:167], v[176:179]
  v_mfma_f32_16x16x32_bf16 v[172:175], v[36:39], v[160:163], v[172:175]
  v_mfma_f32_16x16x32_bf16 v[180:183], v[36:39], v[164:167], v[180:183]
  ds_read_b128 v[152:155], v2 offset:14336
  ds_read_b128 v[156:159], v3 offset:14336
  s_waitcnt vmcnt(14) lgkmcnt(4)
  v_mfma_f32_16x16x32_bf16 v[168:171], v[40:43], v[136:139], v[168:171]
  v_mfma_f32_16x16x32_bf16 v[176:179], v[40:43], v[140:143], v[176:179]
  v_mfma_f32_16x16x32_bf16 v[172:175], v[44:47], v[136:139], v[172:175]
  v_mfma_f32_16x16x32_bf16 v[180:183], v[44:47], v[140:143], v[180:183]
  ds_read_b128 v[160:163], v2 offset:15360
  ds_read_b128 v[164:167], v3 offset:15360
  s_waitcnt vmcnt(12) lgkmcnt(4)
  v_mfma_f32_16x16x32_bf16 v[168:171], v[48:51], v[144:147], v[168:171]
  v_mfma_f32_16x16x32_bf16 v[176:179], v[48:51], v[148:151], v[176:179]
  v_mfma_f32_16x16x32_bf16 v[172:175], v[52:55], v[144:147], v[172:175]
  v_mfma_f32_16x16x32_bf16 v[180:183], v[52:55], v[148:151], v[180:183]
  ds_read_b128 v[136:139], v2 offset:16384
  ds_read_b128 v[140:143], v3 offset:16384
  s_waitcnt vmcnt(10) lgkmcnt(4)
  v_mfma_f32_16x16x32_bf16 v[168:171], v[56:59], v[152:155], v[168:171]
  v_mfma_f32_16x16x32_bf16 v[176:179], v[56:59], v[156:159], v[176:179]
  v_mfma_f32_16x16x32_bf16 v[172:175], v[60:63], v[152:155], v[172:175]
  v_mfma_f32_16x16x32_bf16 v[180:183], v[60:63], v[156:159], v[180:183]
  ds_read_b128 v[144:147], v2 offset:17408
  ds_read_b128 v[148:151], v3 offset:17408
  s_waitcnt vmcnt(8) lgkmcnt(4)
  v_mfma_f32_16x16x32_bf16 v[168:171], v[64:67], v[160:163], v[168:171]
  v_mfma_f32_16x16x32_bf16 v[176:179], v[64:67], v[164:167], v[176:179]
  v_mfma_f32_16x16x32_bf16 v[172:175], v[68:71], v[160:163], v[172:175]
  v_mfma_f32_16x16x32_bf16 v[180:183], v[68:71], v[164:167], v[180:183]
  ds_read_b128 v[152:155], v2 offset:18432
  ds_read_b128 v[156:159], v3 offset:18432
  s_waitcnt vmcnt(6) lgkmcnt(4)
  v_mfma_f32_16x16x32_bf16 v[168:171], v[72:75], v[136:139], v[168:171]
  v_mfma_f32_16x16x32_bf16 v[176:179], v[72:75], v[140:143], v[176:179]
  v_mfma_f32_16x16x32_bf16 v[172:175], v[76:79], v[136:139], v[172:175]
  v_mfma_f32_16x16x32_bf16 v[180:183], v[76:79], v[140:143], v[180:183]
  ds_read_b128 v[160:163], v2 offset:19456
  ds_read_b128 v[164:167], v3 offset:19456
  s_waitcnt vmcnt(4) lgkmcnt(4)
  v_mfma_f32_16x16x32_bf16 v[168:171], v[80:83], v[144:147], v[168:171]
  v_mfma_f32_16x16x32_bf16 v[176:179], v[80:83], v[148:151], v[176:179]
  v_mfma_f32_16x16x32_bf16 v[172:175], v[84:87], v[144:147], v[172:175]
  v_mfma_f32_16x16x32_bf16 v[180:183], v[84:87], v[148:151], v[180:183]
  s_waitcnt vmcnt(2) lgkmcnt(2)
  v_mfma_f32_16x16x32_bf16 v[168:171], v[88:91], v[152:155], v[168:171]
  v_mfma_f32_16x16x32_bf16 v[176:179], v[88:91], v[156:159], v[176:179]
  v_mfma_f32_16x16x32_bf16 v[172:175], v[92:95], v[152:155], v[172:175]
  v_mfma_f32_16x16x32_bf16 v[180:183], v[92:95], v[156:159], v[180:183]
  s_waitcnt vmcnt(0) lgkmcnt(0)
  v_mfma_f32_16x16x32_bf16 v[168:171], v[96:99], v[160:163], v[168:171]
  v_mfma_f32_16x16x32_bf16 v[176:179], v[96:99], v[164:167], v[176:179]
  v_mfma_f32_16x16x32_bf16 v[172:175], v[100:103], v[160:163], v[172:175]
  v_mfma_f32_16x16x32_bf16 v[180:183], v[100:103], v[164:167], v[180:183]
  s_mov_b32 s23, 0xffff0000
  v_lshlrev_b32 v10, 16, v16
  v_and_b32 v11, s23, v16
  v_pk_add_f32 v[168:169], v[168:169], v[10:11]
  v_cvt_pk_bf16_f32 v16, v168, v169
  v_lshlrev_b32 v10, 16, v17
  v_and_b32 v11, s23, v17
  v_pk_add_f32 v[170:171], v[170:171], v[10:11]
  v_cvt_pk_bf16_f32 v17, v170, v171
  v_lshlrev_b32 v10, 16, v18
  v_and_b32 v11, s23, v18
  v_pk_add_f32 v[172:173], v[172:173], v[10:11]
  v_cvt_pk_bf16_f32 v18, v172, v173
  v_lshlrev_b32 v10, 16, v19
  v_and_b32 v11, s23, v19
  v_pk_add_f32 v[174:175], v[174:175], v[10:11]
  v_cvt_pk_bf16_f32 v19, v174, v175
  v_lshlrev_b32 v10, 16, v20
  v_and_b32 v11, s23, v20
  v_pk_add_f32 v[176:177], v[176:177], v[10:11]
  v_cvt_pk_bf16_f32 v20, v176, v177
  v_lshlrev_b32 v10, 16, v21
  v_and_b32 v11, s23, v21
  v_pk_add_f32 v[178:179], v[178:179], v[10:11]
  v_cvt_pk_bf16_f32 v21, v178, v179
  v_lshlrev_b32 v10, 16, v22
  v_and_b32 v11, s23, v22
  v_pk_add_f32 v[180:181], v[180:181], v[10:11]
  v_cvt_pk_bf16_f32 v22, v180, v181
  v_lshlrev_b32 v10, 16, v23
  v_and_b32 v11, s23, v23
  v_pk_add_f32 v[182:183], v[182:183], v[10:11]
  v_cvt_pk_bf16_f32 v23, v182, v183
  s_add_u32 s12, s11, 20480
  buffer_store_dwordx4 v[16:19], v6, s[24:27], s11 offen
  buffer_store_dwordx4 v[20:23], v6, s[24:27], s12 offen
b2f_kernel_end:
  s_endpgm

.section .rodata,"a"
.p2align 6
.amdhsa_kernel prep_kernel
  .amdhsa_next_free_vgpr 248
  .amdhsa_next_free_sgpr 44
  .amdhsa_accum_offset 128
  .amdhsa_group_segment_fixed_size 0
  .amdhsa_kernarg_size 112
  .amdhsa_user_sgpr_count 2
  .amdhsa_user_sgpr_kernarg_segment_ptr 1
  .amdhsa_system_sgpr_workgroup_id_x 1
  .amdhsa_float_denorm_mode_32 3
.end_amdhsa_kernel
.text

.section .rodata,"a"
.p2align 6
.amdhsa_kernel mega0_kernel
  .amdhsa_next_free_vgpr 512
  .amdhsa_next_free_sgpr 100
  .amdhsa_accum_offset 256
  .amdhsa_group_segment_fixed_size 0
  .amdhsa_kernarg_size 112
  .amdhsa_user_sgpr_count 2
  .amdhsa_user_sgpr_kernarg_segment_ptr 1
  .amdhsa_system_sgpr_workgroup_id_x 1
  .amdhsa_float_denorm_mode_32 3
.end_amdhsa_kernel
.text

.section .rodata,"a"
.p2align 6
.amdhsa_kernel mega1_kernel
  .amdhsa_next_free_vgpr 512
  .amdhsa_next_free_sgpr 100
  .amdhsa_accum_offset 256
  .amdhsa_group_segment_fixed_size 0
  .amdhsa_kernarg_size 112
  .amdhsa_user_sgpr_count 2
  .amdhsa_user_sgpr_kernarg_segment_ptr 1
  .amdhsa_system_sgpr_workgroup_id_x 1
  .amdhsa_float_denorm_mode_32 3
.end_amdhsa_kernel
.text

.section .rodata,"a"
.p2align 6
.amdhsa_kernel b1_kernel
  .amdhsa_next_free_vgpr 256
  .amdhsa_next_free_sgpr 32
  .amdhsa_accum_offset 256
  .amdhsa_group_segment_fixed_size 0
  .amdhsa_kernarg_size 112
  .amdhsa_user_sgpr_count 2
  .amdhsa_user_sgpr_kernarg_segment_ptr 1
  .amdhsa_system_sgpr_workgroup_id_x 1
  .amdhsa_float_denorm_mode_32 3
.end_amdhsa_kernel
.text

.section .rodata,"a"
.p2align 6
.amdhsa_kernel bred_kernel
  .amdhsa_next_free_vgpr 48
  .amdhsa_next_free_sgpr 16
  .amdhsa_accum_offset 48
  .amdhsa_group_segment_fixed_size 0
  .amdhsa_kernarg_size 112
  .amdhsa_user_sgpr_count 2
  .amdhsa_user_sgpr_kernarg_segment_ptr 1
  .amdhsa_system_sgpr_workgroup_id_x 1
  .amdhsa_float_denorm_mode_32 3
.end_amdhsa_kernel
.text

.section .rodata,"a"
.p2align 6
.amdhsa_kernel b2_kernel
  .amdhsa_next_free_vgpr 256
  .amdhsa_next_free_sgpr 28
  .amdhsa_accum_offset 256
  .amdhsa_group_segment_fixed_size 0
  .amdhsa_kernarg_size 112
  .amdhsa_user_sgpr_count 2
  .amdhsa_user_sgpr_kernarg_segment_ptr 1
  .amdhsa_system_sgpr_workgroup_id_x 1
  .amdhsa_float_denorm_mode_32 3
.end_amdhsa_kernel
.text

.section .rodata,"a"
.p2align 6
.amdhsa_kernel b2f_kernel
  .amdhsa_next_free_vgpr 256
  .amdhsa_next_free_sgpr 28
  .amdhsa_accum_offset 256
  .amdhsa_group_segment_fixed_size 0
  .amdhsa_kernarg_size 112
  .amdhsa_user_sgpr_count 2
  .amdhsa_user_sgpr_kernarg_segment_ptr 1
  .amdhsa_system_sgpr_workgroup_id_x 1
  .amdhsa_float_denorm_mode_32 3
.end_amdhsa_kernel
.text
```

```asm
; @launch kernel=prep_kernel grid=(452,1,1) block=(256,1,1) lds=73728
; @launch kernel=mega0_kernel grid=(256,1,1) block=(256,1,1) lds=163840
; @launch kernel=b1_kernel grid=(256,1,1) block=(320,1,1) lds=153600
; @launch kernel=bred_kernel grid=(105,1,1) block=(256,1,1) lds=0
; @launch kernel=b2_kernel grid=(256,1,1) block=(320,1,1) lds=102400
; @launch kernel=mega1_kernel grid=(256,1,1) block=(256,1,1) lds=163840
; @launch kernel=b1_kernel grid=(256,1,1) block=(320,1,1) lds=153600
; @launch kernel=bred_kernel grid=(105,1,1) block=(256,1,1) lds=0
; @launch kernel=b2f_kernel grid=(256,1,1) block=(320,1,1) lds=102400
.amdgcn_target "amdgcn-amd-amdhsa--gfx950"
.text
.globl prep_kernel
.p2align 8
.type prep_kernel,@function
prep_kernel:
  s_load_dwordx2 s[4:5], s[0:1], 104
  s_mov_b32 s6, 0x10000000
  s_mov_b32 s7, 0x20000
  s_load_dwordx2 s[16:17], s[0:1], 32
  s_mov_b32 s18, 0x780000
  s_mov_b32 s19, 0x20000
  s_load_dwordx2 s[32:33], s[0:1], 40
  s_mov_b32 s34, 0x780000
  s_mov_b32 s35, 0x20000
  s_load_dwordx2 s[36:37], s[0:1], 0
  s_mov_b32 s38, 0x280000
  s_mov_b32 s39, 0x20000
  s_load_dwordx2 s[40:41], s[0:1], 8
  s_mov_b32 s42, 0x2800
  s_mov_b32 s43, 0x20000
  v_lshrrev_b32 v1, 6, v0
  s_nop 0
  v_readfirstlane_b32 s3, v1
  v_and_b32 v1, 63, v0
  s_waitcnt lgkmcnt(0)
  s_cmp_ge_u32 s2, 32
  s_cbranch_scc1 prep_noprobe
  s_cmp_lg_u32 s3, 0
  s_cbranch_scc1 prep_end
  s_add_u32 s20, s4, 58785791
  s_and_b32 s20, s20, 0xffe00000
  s_sub_u32 s20, s20, s4
  s_lshr_b32 s21, s2, 3
  s_lshl_b32 s21, s21, 21
  s_add_u32 s20, s20, s21
  s_lshl_b32 s21, s2, 7
  s_add_u32 s20, s20, s21
  s_add_u32 s20, s20, 1982464
  v_mov_b32 v2, 0
  s_mov_b64 exec, 1
  s_mov_b32 s24, -1
  s_mov_b32 s25, -1
  s_mov_b32 s26, 0
prep_ploop:
  s_memtime s[28:29]
  s_waitcnt lgkmcnt(0)
  buffer_store_dword v2, v2, s[4:7], s20 offen sc1
  s_waitcnt vmcnt(0)
  s_memtime s[30:31]
  s_waitcnt lgkmcnt(0)
  s_sub_u32 s30, s30, s28
  s_min_u32 s24, s24, s30
  s_add_u32 s20, s20, 8192
  s_memtime s[28:29]
  s_waitcnt lgkmcnt(0)
  buffer_store_dword v2, v2, s[4:7], s20 offen sc1
  s_waitcnt vmcnt(0)
  s_memtime s[30:31]
  s_waitcnt lgkmcnt(0)
  s_sub_u32 s30, s30, s28
  s_min_u32 s25, s25, s30
  s_sub_u32 s20, s20, 8192
  s_add_u32 s26, s26, 1
  s_cmp_lt_u32 s26, 4
  s_cbranch_scc1 prep_ploop
  s_getreg_b32 s26, hwreg(HW_REG_XCC_ID)
  s_bfe_u32 s26, s26, 0x10002
  s_cmp_lt_u32 s24, s25
  s_cselect_b32 s27, 1, 0
  s_xor_b32 s27, s27, s26
  v_mov_b32 v3, s27
  s_lshl_b32 s21, s2, 2
  s_add_u32 s21, s21, 93487104
  buffer_store_dword v3, v2, s[4:7], s21 offen
  s_endpgm
prep_noprobe:
  s_cmp_ge_u32 s2, 288
  s_cbranch_scc1 prep_nobmat
  s_sub_u32 s8, s2, 32
  s_and_b32 s9, s8, 31
  s_bfe_u32 s12, s8, 0x10005
  s_lshr_b32 s13, s8, 6
  s_mov_b32 s20, -1
  s_mov_b32 s21, 0x0fffffff
  s_lshl_b32 s14, s12, 2
  s_add_u32 s14, s14, s3
  s_mul_i32 s10, s9, 245760
  s_mul_i32 s11, s14, 160
  s_add_u32 s10, s10, s11
  s_mul_i32 s11, s3, 15360
  v_mul_u32_u24 v6, 6554, v1
  v_lshrrev_b32 v6, 16, v6
  v_mul_u32_u24 v4, 10, v6
  v_sub_u32 v4, v1, v4
  v_lshlrev_b32 v4, 4, v4
  v_mul_u32_u24 v6, 1280, v6
  v_add_u32 v4, v4, v6
  v_lshrrev_b32 v6, 4, v1
  v_mul_u32_u24 v6, 8, v6
  v_bfe_u32 v5, v1, 2, 2
  v_add_u32 v6, v6, v5
  v_mul_u32_u24 v6, 160, v6
  v_and_b32 v5, 3, v1
  v_lshl_add_u32 v5, v5, 3, v6
  v_add_u32 v5, s11, v5
  s_mov_b64 exec, s[20:21]
  s_add_u32 m0, s11, 0
  s_nop 0
  buffer_load_dwordx4 v4, s[32:35], s10 offen lds
  s_add_u32 s10, s10, 7680
  s_add_u32 m0, s11, 960
  s_nop 0
  buffer_load_dwordx4 v4, s[32:35], s10 offen lds
  s_add_u32 s10, s10, 7680
  s_add_u32 m0, s11, 1920
  s_nop 0
  buffer_load_dwordx4 v4, s[32:35], s10 offen lds
  s_add_u32 s10, s10, 7680
  s_add_u32 m0, s11, 2880
  s_nop 0
  buffer_load_dwordx4 v4, s[32:35], s10 offen lds
  s_add_u32 s10, s10, 7680
  s_add_u32 m0, s11, 3840
  s_nop 0
  buffer_load_dwordx4 v4, s[32:35], s10 offen lds
  s_add_u32 s10, s10, 7680
  s_add_u32 m0, s11, 4800
  s_nop 0
  buffer_load_dwordx4 v4, s[32:35], s10 offen lds
  s_add_u32 s10, s10, 7680
  s_add_u32 m0, s11, 5760
  s_nop 0
  buffer_load_dwordx4 v4, s[32:35], s10 offen lds
  s_add_u32 s10, s10, 7680
  s_add_u32 m0, s11, 6720
  s_nop 0
  buffer_load_dwordx4 v4, s[32:35], s10 offen lds
  s_add_u32 s10, s10, 7680
  s_add_u32 m0, s11, 7680
  s_nop 0
  buffer_load_dwordx4 v4, s[32:35], s10 offen lds
  s_add_u32 s10, s10, 7680
  s_add_u32 m0, s11, 8640
  s_nop 0
  buffer_load_dwordx4 v4, s[32:35], s10 offen lds
  s_add_u32 s10, s10, 7680
  s_add_u32 m0, s11, 9600
  s_nop 0
  buffer_load_dwordx4 v4, s[32:35], s10 offen lds
  s_add_u32 s10, s10, 7680
  s_add_u32 m0, s11, 10560
  s_nop 0
  buffer_load_dwordx4 v4, s[32:35], s10 offen lds
  s_add_u32 s10, s10, 7680
  s_add_u32 m0, s11, 11520
  s_nop 0
  buffer_load_dwordx4 v4, s[32:35], s10 offen lds
  s_add_u32 s10, s10, 7680
  s_add_u32 m0, s11, 12480
  s_nop 0
  buffer_load_dwordx4 v4, s[32:35], s10 offen lds
  s_add_u32 s10, s10, 7680
  s_add_u32 m0, s11, 13440
  s_nop 0
  buffer_load_dwordx4 v4, s[32:35], s10 offen lds
  s_add_u32 s10, s10, 7680
  s_add_u32 m0, s11, 14400
  s_nop 0
  buffer_load_dwordx4 v4, s[32:35], s10 offen lds
  s_add_u32 s10, s10, 7680
  s_mov_b64 exec, -1
  v_bfe_u32 v6, v1, 2, 1
  v_and_b32 v7, 1, v1
  v_lshl_add_u32 v6, v6, 2, v7
  v_bfe_u32 v7, v1, 3, 1
  v_bfe_u32 v2, v1, 1, 1
  v_lshl_add_u32 v7, v7, 1, v2
  v_mul_u32_u24 v2, 40, v7
  v_add_u32 v2, v2, v6
  v_lshl_add_u32 v6, v7, 3, v6
  v_lshrrev_b32 v3, 4, v1
  v_mul_u32_u24 v6, 12288, v6
  v_lshl_add_u32 v6, v3, 4, v6
  v_mul_u32_u24 v7, 12288, v2
  v_lshl_add_u32 v7, v3, 4, v7
  s_mul_i32 s15, s13, 2457600
  s_mul_i32 s22, s9, 384
  s_add_u32 s15, s15, s22
  v_lshlrev_b32 v2, 4, v1
  s_mul_i32 s22, s9, 40
  s_mul_i32 s23, s14, 5
  s_add_u32 s22, s22, s23
  s_mul_i32 s22, s22, 20
  s_mul_i32 s23, s13, 5
  s_add_u32 s22, s22, s23
  s_lshl_b32 s22, s22, 10
  s_add_u32 s22, s22, 0
  s_lshr_b32 s24, s3, 1
  s_mul_i32 s24, s24, 24576
  s_and_b32 s25, s3, 1
  s_mul_i32 s25, s25, 192
  s_add_u32 s15, s15, s24
  s_add_u32 s15, s15, s25
  s_mul_i32 s24, s3, 3072
  s_mov_b32 s26, 491520
  s_add_u32 m0, s24, 61440
  s_nop 0
  buffer_load_dwordx4 v6, s[16:19], s15 offen offset:0 lds
  s_add_u32 m0, s24, 62400
  s_nop 0
  buffer_load_dwordx4 v6, s[16:19], s15 offen offset:64 lds
  s_add_u32 m0, s24, 63360
  s_nop 0
  buffer_load_dwordx4 v6, s[16:19], s15 offen offset:128 lds
  s_add_u32 s15, s15, s26
  s_cmp_eq_u32 s13, 3
  s_cselect_b32 s26, 1966080, s26
  s_cselect_b32 s27, 7471104, 0
  s_cselect_b64 vcc, -1, 0
  s_sub_u32 s15, s15, s27
  v_cndmask_b32 v6, v6, v7, vcc
  s_waitcnt vmcnt(13)
  ds_read_b64_tr_b16 a[0:1], v5 offset:0
  ds_read_b64_tr_b16 a[2:3], v5 offset:640
  ds_read_b64_tr_b16 a[24:25], v5 offset:32
  ds_read_b64_tr_b16 a[26:27], v5 offset:672
  ds_read_b64_tr_b16 a[48:49], v5 offset:64
  ds_read_b64_tr_b16 a[50:51], v5 offset:704
  ds_read_b64_tr_b16 a[72:73], v5 offset:96
  ds_read_b64_tr_b16 a[74:75], v5 offset:736
  ds_read_b64_tr_b16 a[96:97], v5 offset:128
  ds_read_b64_tr_b16 a[98:99], v5 offset:768
  s_waitcnt lgkmcnt(0)
  s_mov_b64 exec, s[20:21]
  s_add_u32 m0, s11, 0
  s_nop 0
  buffer_load_dwordx4 v4, s[32:35], s10 offen lds
  s_add_u32 s10, s10, 7680
  s_add_u32 m0, s11, 960
  s_nop 0
  buffer_load_dwordx4 v4, s[32:35], s10 offen lds
  s_add_u32 s10, s10, 7680
  s_add_u32 m0, s11, 1920
  s_nop 0
  buffer_load_dwordx4 v4, s[32:35], s10 offen lds
  s_add_u32 s10, s10, 7680
  s_add_u32 m0, s11, 2880
  s_nop 0
  buffer_load_dwordx4 v4, s[32:35], s10 offen lds
  s_add_u32 s10, s10, 7680
  s_add_u32 m0, s11, 3840
  s_nop 0
  buffer_load_dwordx4 v4, s[32:35], s10 offen lds
  s_add_u32 s10, s10, 7680
  s_mov_b64 exec, -1
  s_waitcnt vmcnt(13)
  ds_read_b64_tr_b16 a[4:5], v5 offset:5120
  ds_read_b64_tr_b16 a[6:7], v5 offset:5760
  ds_read_b64_tr_b16 a[28:29], v5 offset:5152
  ds_read_b64_tr_b16 a[30:31], v5 offset:5792
  ds_read_b64_tr_b16 a[52:53], v5 offset:5184
  ds_read_b64_tr_b16 a[54:55], v5 offset:5824
  ds_read_b64_tr_b16 a[76:77], v5 offset:5216
  ds_read_b64_tr_b16 a[78:79], v5 offset:5856
  ds_read_b64_tr_b16 a[100:101], v5 offset:5248
  ds_read_b64_tr_b16 a[102:103], v5 offset:5888
  s_waitcnt lgkmcnt(0)
  s_mov_b64 exec, s[20:21]
  s_add_u32 m0, s11, 4800
  s_nop 0
  buffer_load_dwordx4 v4, s[32:35], s10 offen lds
  s_add_u32 s10, s10, 7680
  s_add_u32 m0, s11, 5760
  s_nop 0
  buffer_load_dwordx4 v4, s[32:35], s10 offen lds
  s_add_u32 s10, s10, 7680
  s_add_u32 m0, s11, 6720
  s_nop 0
  buffer_load_dwordx4 v4, s[32:35], s10 offen lds
  s_add_u32 s10, s10, 7680
  s_add_u32 m0, s11, 7680
  s_nop 0
  buffer_load_dwordx4 v4, s[32:35], s10 offen lds
  s_add_u32 s10, s10, 7680
  s_add_u32 m0, s11, 8640
  s_nop 0
  buffer_load_dwordx4 v4, s[32:35], s10 offen lds
  s_add_u32 s10, s10, 7680
  s_mov_b64 exec, -1
  s_waitcnt vmcnt(13)
  ds_read_b64_tr_b16 a[8:9], v5 offset:10240
  ds_read_b64_tr_b16 a[10:11], v5 offset:10880
  ds_read_b64_tr_b16 a[32:33], v5 offset:10272
  ds_read_b64_tr_b16 a[34:35], v5 offset:10912
  ds_read_b64_tr_b16 a[56:57], v5 offset:10304
  ds_read_b64_tr_b16 a[58:59], v5 offset:10944
  ds_read_b64_tr_b16 a[80:81], v5 offset:10336
  ds_read_b64_tr_b16 a[82:83], v5 offset:10976
  ds_read_b64_tr_b16 a[104:105], v5 offset:10368
  ds_read_b64_tr_b16 a[106:107], v5 offset:11008
  s_waitcnt lgkmcnt(0)
  s_mov_b64 exec, s[20:21]
  s_add_u32 m0, s11, 9600
  s_nop 0
  buffer_load_dwordx4 v4, s[32:35], s10 offen lds
  s_add_u32 s10, s10, 7680
  s_add_u32 m0, s11, 10560
  s_nop 0
  buffer_load_dwordx4 v4, s[32:35], s10 offen lds
  s_add_u32 s10, s10, 7680
  s_add_u32 m0, s11, 11520
  s_nop 0
  buffer_load_dwordx4 v4, s[32:35], s10 offen lds
  s_add_u32 s10, s10, 7680
  s_add_u32 m0, s11, 12480
  s_nop 0
  buffer_load_dwordx4 v4, s[32:35], s10 offen lds
  s_add_u32 s10, s10, 7680
  s_add_u32 m0, s11, 13440
  s_nop 0
  buffer_load_dwordx4 v4, s[32:35], s10 offen lds
  s_add_u32 s10, s10, 7680
  s_add_u32 m0, s11, 14400
  s_nop 0
  buffer_load_dwordx4 v4, s[32:35], s10 offen lds
  s_add_u32 s10, s10, 7680
  s_mov_b64 exec, -1
  s_waitcnt vmcnt(10)
  ds_read_b64_tr_b16 a[12:13], v5 offset:0
  ds_read_b64_tr_b16 a[14:15], v5 offset:640
  ds_read_b64_tr_b16 a[36:37], v5 offset:32
  ds_read_b64_tr_b16 a[38:39], v5 offset:672
  ds_read_b64_tr_b16 a[60:61], v5 offset:64
  ds_read_b64_tr_b16 a[62:63], v5 offset:704
  ds_read_b64_tr_b16 a[84:85], v5 offset:96
  ds_read_b64_tr_b16 a[86:87], v5 offset:736
  ds_read_b64_tr_b16 a[108:109], v5 offset:128
  ds_read_b64_tr_b16 a[110:111], v5 offset:768
  s_waitcnt vmcnt(5)
  ds_read_b64_tr_b16 a[16:17], v5 offset:5120
  ds_read_b64_tr_b16 a[18:19], v5 offset:5760
  ds_read_b64_tr_b16 a[40:41], v5 offset:5152
  ds_read_b64_tr_b16 a[42:43], v5 offset:5792
  ds_read_b64_tr_b16 a[64:65], v5 offset:5184
  ds_read_b64_tr_b16 a[66:67], v5 offset:5824
  ds_read_b64_tr_b16 a[88:89], v5 offset:5216
  ds_read_b64_tr_b16 a[90:91], v5 offset:5856
  ds_read_b64_tr_b16 a[112:113], v5 offset:5248
  ds_read_b64_tr_b16 a[114:115], v5 offset:5888
  s_waitcnt vmcnt(0)
  ds_read_b64_tr_b16 a[20:21], v5 offset:10240
  ds_read_b64_tr_b16 a[22:23], v5 offset:10880
  ds_read_b64_tr_b16 a[44:45], v5 offset:10272
  ds_read_b64_tr_b16 a[46:47], v5 offset:10912
  ds_read_b64_tr_b16 a[68:69], v5 offset:10304
  ds_read_b64_tr_b16 a[70:71], v5 offset:10944
  ds_read_b64_tr_b16 a[92:93], v5 offset:10336
  ds_read_b64_tr_b16 a[94:95], v5 offset:10976
  ds_read_b64_tr_b16 a[116:117], v5 offset:10368
  ds_read_b64_tr_b16 a[118:119], v5 offset:11008
  s_waitcnt lgkmcnt(0)
  s_barrier
  s_add_u32 m0, s24, 0
  s_nop 0
  buffer_load_dwordx4 v6, s[16:19], s15 offen offset:0 lds
  s_add_u32 m0, s24, 960
  s_nop 0
  buffer_load_dwordx4 v6, s[16:19], s15 offen offset:64 lds
  s_add_u32 m0, s24, 1920
  s_nop 0
  buffer_load_dwordx4 v6, s[16:19], s15 offen offset:128 lds
  s_add_u32 s15, s15, s26
  s_add_u32 m0, s24, 12288
  s_nop 0
  buffer_load_dwordx4 v6, s[16:19], s15 offen offset:0 lds
  s_add_u32 m0, s24, 13248
  s_nop 0
  buffer_load_dwordx4 v6, s[16:19], s15 offen offset:64 lds
  s_add_u32 m0, s24, 14208
  s_nop 0
  buffer_load_dwordx4 v6, s[16:19], s15 offen offset:128 lds
  s_add_u32 s15, s15, s26
  s_add_u32 m0, s24, 24576
  s_nop 0
  buffer_load_dwordx4 v6, s[16:19], s15 offen offset:0 lds
  s_add_u32 m0, s24, 25536
  s_nop 0
  buffer_load_dwordx4 v6, s[16:19], s15 offen offset:64 lds
  s_add_u32 m0, s24, 26496
  s_nop 0
  buffer_load_dwordx4 v6, s[16:19], s15 offen offset:128 lds
  s_add_u32 s15, s15, s26
  s_add_u32 m0, s24, 36864
  s_nop 0
  buffer_load_dwordx4 v6, s[16:19], s15 offen offset:0 lds
  s_add_u32 m0, s24, 37824
  s_nop 0
  buffer_load_dwordx4 v6, s[16:19], s15 offen offset:64 lds
  s_add_u32 m0, s24, 38784
  s_nop 0
  buffer_load_dwordx4 v6, s[16:19], s15 offen offset:128 lds
  s_add_u32 s15, s15, s26
  v_add_u32 v3, 61440, v2
  ds_read_b128 v[8:11], v3 offset:0
  ds_read_b128 v[12:15], v3 offset:1024
  ds_read_b128 v[16:19], v3 offset:2048
  ds_read_b128 v[20:23], v3 offset:3072
  ds_read_b128 v[24:27], v3 offset:4096
  ds_read_b128 v[28:31], v3 offset:5120
  ds_read_b128 v[32:35], v3 offset:6144
  ds_read_b128 v[36:39], v3 offset:7168
  ds_read_b128 v[40:43], v3 offset:8192
  ds_read_b128 v[44:47], v3 offset:9216
  ds_read_b128 v[48:51], v3 offset:10240
  ds_read_b128 v[52:55], v3 offset:11264
  s_waitcnt lgkmcnt(0)
  v_mfma_f32_16x16x32_bf16 v[104:107], v[8:11], a[0:3], 0
  v_mfma_f32_16x16x32_bf16 v[108:111], v[32:35], a[0:3], 0
  v_mfma_f32_16x16x32_bf16 v[104:107], v[12:15], a[4:7], v[104:107]
  v_mfma_f32_16x16x32_bf16 v[108:111], v[36:39], a[4:7], v[108:111]
  v_mfma_f32_16x16x32_bf16 v[104:107], v[16:19], a[8:11], v[104:107]
  v_mfma_f32_16x16x32_bf16 v[108:111], v[40:43], a[8:11], v[108:111]
  v_mfma_f32_16x16x32_bf16 v[104:107], v[20:23], a[12:15], v[104:107]
  v_mfma_f32_16x16x32_bf16 v[108:111], v[44:47], a[12:15], v[108:111]
  v_mfma_f32_16x16x32_bf16 v[104:107], v[24:27], a[16:19], v[104:107]
  v_mfma_f32_16x16x32_bf16 v[108:111], v[48:51], a[16:19], v[108:111]
  v_mfma_f32_16x16x32_bf16 v[104:107], v[28:31], a[20:23], v[104:107]
  v_mfma_f32_16x16x32_bf16 v[108:111], v[52:55], a[20:23], v[108:111]
  v_mfma_f32_16x16x32_bf16 v[112:115], v[8:11], a[24:27], 0
  v_mfma_f32_16x16x32_bf16 v[116:119], v[32:35], a[24:27], 0
  v_mfma_f32_16x16x32_bf16 v[112:115], v[12:15], a[28:31], v[112:115]
  v_mfma_f32_16x16x32_bf16 v[116:119], v[36:39], a[28:31], v[116:119]
  v_mfma_f32_16x16x32_bf16 v[112:115], v[16:19], a[32:35], v[112:115]
  v_mfma_f32_16x16x32_bf16 v[116:119], v[40:43], a[32:35], v[116:119]
  v_mfma_f32_16x16x32_bf16 v[112:115], v[20:23], a[36:39], v[112:115]
  v_mfma_f32_16x16x32_bf16 v[116:119], v[44:47], a[36:39], v[116:119]
  s_add_u32 s23, s22, 0
  v_cvt_pk_bf16_f32 v120, v104, v105
  v_cvt_pk_bf16_f32 v121, v106, v107
  v_cvt_pk_bf16_f32 v122, v108, v109
  v_cvt_pk_bf16_f32 v123, v110, v111
  buffer_store_dwordx4 v[120:123], v2, s[4:7], s23 offen
  v_mfma_f32_16x16x32_bf16 v[112:115], v[24:27], a[40:43], v[112:115]
  v_mfma_f32_16x16x32_bf16 v[116:119], v[48:51], a[40:43], v[116:119]
  v_mfma_f32_16x16x32_bf16 v[112:115], v[28:31], a[44:47], v[112:115]
  v_mfma_f32_16x16x32_bf16 v[116:119], v[52:55], a[44:47], v[116:119]
  v_mfma_f32_16x16x32_bf16 v[104:107], v[8:11], a[48:51], 0
  v_mfma_f32_16x16x32_bf16 v[108:111], v[32:35], a[48:51], 0
  v_mfma_f32_16x16x32_bf16 v[104:107], v[12:15], a[52:55], v[104:107]
  v_mfma_f32_16x16x32_bf16 v[108:111], v[36:39], a[52:55], v[108:111]
  v_mfma_f32_16x16x32_bf16 v[104:107], v[16:19], a[56:59], v[104:107]
  v_mfma_f32_16x16x32_bf16 v[108:111], v[40:43], a[56:59], v[108:111]
  v_mfma_f32_16x16x32_bf16 v[104:107], v[20:23], a[60:63], v[104:107]
  v_mfma_f32_16x16x32_bf16 v[108:111], v[44:47], a[60:63], v[108:111]
  s_add_u32 s23, s22, 20480
  v_cvt_pk_bf16_f32 v124, v112, v113
  v_cvt_pk_bf16_f32 v125, v114, v115
  v_cvt_pk_bf16_f32 v126, v116, v117
  v_cvt_pk_bf16_f32 v127, v118, v119
  buffer_store_dwordx4 v[124:127], v2, s[4:7], s23 offen
  v_mfma_f32_16x16x32_bf16 v[104:107], v[24:27], a[64:67], v[104:107]
  v_mfma_f32_16x16x32_bf16 v[108:111], v[48:51], a[64:67], v[108:111]
  v_mfma_f32_16x16x32_bf16 v[104:107], v[28:31], a[68:71], v[104:107]
  v_mfma_f32_16x16x32_bf16 v[108:111], v[52:55], a[68:71], v[108:111]
  v_mfma_f32_16x16x32_bf16 v[112:115], v[8:11], a[72:75], 0
  v_mfma_f32_16x16x32_bf16 v[116:119], v[32:35], a[72:75], 0
  v_mfma_f32_16x16x32_bf16 v[112:115], v[12:15], a[76:79], v[112:115]
  v_mfma_f32_16x16x32_bf16 v[116:119], v[36:39], a[76:79], v[116:119]
  v_mfma_f32_16x16x32_bf16 v[112:115], v[16:19], a[80:83], v[112:115]
  v_mfma_f32_16x16x32_bf16 v[116:119], v[40:43], a[80:83], v[116:119]
  v_mfma_f32_16x16x32_bf16 v[112:115], v[20:23], a[84:87], v[112:115]
  v_mfma_f32_16x16x32_bf16 v[116:119], v[44:47], a[84:87], v[116:119]
  s_add_u32 s23, s22, 40960
  v_cvt_pk_bf16_f32 v120, v104, v105
  v_cvt_pk_bf16_f32 v121, v106, v107
  v_cvt_pk_bf16_f32 v122, v108, v109
  v_cvt_pk_bf16_f32 v123, v110, v111
  buffer_store_dwordx4 v[120:123], v2, s[4:7], s23 offen
  v_mfma_f32_16x16x32_bf16 v[112:115], v[24:27], a[88:91], v[112:115]
  v_mfma_f32_16x16x32_bf16 v[116:119], v[48:51], a[88:91], v[116:119]
  v_mfma_f32_16x16x32_bf16 v[112:115], v[28:31], a[92:95], v[112:115]
  v_mfma_f32_16x16x32_bf16 v[116:119], v[52:55], a[92:95], v[116:119]
  s_waitcnt vmcnt(3)
  s_barrier
  ds_read_b128 v[56:59], v2 offset:0
  ds_read_b128 v[60:63], v2 offset:1024
  ds_read_b128 v[64:67], v2 offset:2048
  ds_read_b128 v[68:71], v2 offset:3072
  ds_read_b128 v[72:75], v2 offset:4096
  ds_read_b128 v[76:79], v2 offset:5120
  ds_read_b128 v[80:83], v2 offset:6144
  ds_read_b128 v[84:87], v2 offset:7168
  ds_read_b128 v[88:91], v2 offset:8192
  ds_read_b128 v[92:95], v2 offset:9216
  ds_read_b128 v[96:99], v2 offset:10240
  ds_read_b128 v[100:103], v2 offset:11264
  v_mfma_f32_16x16x32_bf16 v[104:107], v[8:11], a[96:99], 0
  v_mfma_f32_16x16x32_bf16 v[108:111], v[32:35], a[96:99], 0
  v_mfma_f32_16x16x32_bf16 v[104:107], v[12:15], a[100:103], v[104:107]
  v_mfma_f32_16x16x32_bf16 v[108:111], v[36:39], a[100:103], v[108:111]
  v_mfma_f32_16x16x32_bf16 v[104:107], v[16:19], a[104:107], v[104:107]
  v_mfma_f32_16x16x32_bf16 v[108:111], v[40:43], a[104:107], v[108:111]
  v_mfma_f32_16x16x32_bf16 v[104:107], v[20:23], a[108:111], v[104:107]
  v_mfma_f32_16x16x32_bf16 v[108:111], v[44:47], a[108:111], v[108:111]
  s_add_u32 s23, s22, 61440
  v_cvt_pk_bf16_f32 v124, v112, v113
  v_cvt_pk_bf16_f32 v125, v114, v115
  v_cvt_pk_bf16_f32 v126, v116, v117
  v_cvt_pk_bf16_f32 v127, v118, v119
  buffer_store_dwordx4 v[124:127], v2, s[4:7], s23 offen
  v_mfma_f32_16x16x32_bf16 v[104:107], v[24:27], a[112:115], v[104:107]
  v_mfma_f32_16x16x32_bf16 v[108:111], v[48:51], a[112:115], v[108:111]
  v_mfma_f32_16x16x32_bf16 v[104:107], v[28:31], a[116:119], v[104:107]
  v_mfma_f32_16x16x32_bf16 v[108:111], v[52:55], a[116:119], v[108:111]
  s_waitcnt lgkmcnt(0)
  v_mfma_f32_16x16x32_bf16 v[112:115], v[56:59], a[0:3], 0
  v_mfma_f32_16x16x32_bf16 v[116:119], v[80:83], a[0:3], 0
  v_mfma_f32_16x16x32_bf16 v[112:115], v[60:63], a[4:7], v[112:115]
  v_mfma_f32_16x16x32_bf16 v[116:119], v[84:87], a[4:7], v[116:119]
  v_mfma_f32_16x16x32_bf16 v[112:115], v[64:67], a[8:11], v[112:115]
  v_mfma_f32_16x16x32_bf16 v[116:119], v[88:91], a[8:11], v[116:119]
  v_mfma_f32_16x16x32_bf16 v[112:115], v[68:71], a[12:15], v[112:115]
  v_mfma_f32_16x16x32_bf16 v[116:119], v[92:95], a[12:15], v[116:119]
  s_add_u32 s23, s22, 81920
  v_cvt_pk_bf16_f32 v120, v104, v105
  v_cvt_pk_bf16_f32 v121, v106, v107
  v_cvt_pk_bf16_f32 v122, v108, v109
  v_cvt_pk_bf16_f32 v123, v110, v111
  buffer_store_dwordx4 v[120:123], v2, s[4:7], s23 offen
  v_mfma_f32_16x16x32_bf16 v[112:115], v[72:75], a[16:19], v[112:115]
  v_mfma_f32_16x16x32_bf16 v[116:119], v[96:99], a[16:19], v[116:119]
  v_mfma_f32_16x16x32_bf16 v[112:115], v[76:79], a[20:23], v[112:115]
  v_mfma_f32_16x16x32_bf16 v[116:119], v[100:103], a[20:23], v[116:119]
  v_mfma_f32_16x16x32_bf16 v[104:107], v[56:59], a[24:27], 0
  v_mfma_f32_16x16x32_bf16 v[108:111], v[80:83], a[24:27], 0
  v_mfma_f32_16x16x32_bf16 v[104:107], v[60:63], a[28:31], v[104:107]
  v_mfma_f32_16x16x32_bf16 v[108:111], v[84:87], a[28:31], v[108:111]
  v_mfma_f32_16x16x32_bf16 v[104:107], v[64:67], a[32:35], v[104:107]
  v_mfma_f32_16x16x32_bf16 v[108:111], v[88:91], a[32:35], v[108:111]
  v_mfma_f32_16x16x32_bf16 v[104:107], v[68:71], a[36:39], v[104:107]
  v_mfma_f32_16x16x32_bf16 v[108:111], v[92:95], a[36:39], v[108:111]
  s_add_u32 s23, s22, 1024
  v_cvt_pk_bf16_f32 v124, v112, v113
  v_cvt_pk_bf16_f32 v125, v114, v115
  v_cvt_pk_bf16_f32 v126, v116, v117
  v_cvt_pk_bf16_f32 v127, v118, v119
  buffer_store_dwordx4 v[124:127], v2, s[4:7], s23 offen
  v_mfma_f32_16x16x32_bf16 v[104:107], v[72:75], a[40:43], v[104:107]
  v_mfma_f32_16x16x32_bf16 v[108:111], v[96:99], a[40:43], v[108:111]
  v_mfma_f32_16x16x32_bf16 v[104:107], v[76:79], a[44:47], v[104:107]
  v_mfma_f32_16x16x32_bf16 v[108:111], v[100:103], a[44:47], v[108:111]
  v_mfma_f32_16x16x32_bf16 v[112:115], v[56:59], a[48:51], 0
  v_mfma_f32_16x16x32_bf16 v[116:119], v[80:83], a[48:51], 0
  v_mfma_f32_16x16x32_bf16 v[112:115], v[60:63], a[52:55], v[112:115]
  v_mfma_f32_16x16x32_bf16 v[116:119], v[84:87], a[52:55], v[116:119]
  v_mfma_f32_16x16x32_bf16 v[112:115], v[64:67], a[56:59], v[112:115]
  v_mfma_f32_16x16x32_bf16 v[116:119], v[88:91], a[56:59], v[116:119]
  v_mfma_f32_16x16x32_bf16 v[112:115], v[68:71], a[60:63], v[112:115]
  v_mfma_f32_16x16x32_bf16 v[116:119], v[92:95], a[60:63], v[116:119]
  s_add_u32 s23, s22, 21504
  v_cvt_pk_bf16_f32 v120, v104, v105
  v_cvt_pk_bf16_f32 v121, v106, v107
  v_cvt_pk_bf16_f32 v122, v108, v109
  v_cvt_pk_bf16_f32 v123, v110, v111
  buffer_store_dwordx4 v[120:123], v2, s[4:7], s23 offen
  v_mfma_f32_16x16x32_bf16 v[112:115], v[72:75], a[64:67], v[112:115]
  v_mfma_f32_16x16x32_bf16 v[116:119], v[96:99], a[64:67], v[116:119]
  v_mfma_f32_16x16x32_bf16 v[112:115], v[76:79], a[68:71], v[112:115]
  v_mfma_f32_16x16x32_bf16 v[116:119], v[100:103], a[68:71], v[116:119]
  v_mfma_f32_16x16x32_bf16 v[104:107], v[56:59], a[72:75], 0
  v_mfma_f32_16x16x32_bf16 v[108:111], v[80:83], a[72:75], 0
  v_mfma_f32_16x16x32_bf16 v[104:107], v[60:63], a[76:79], v[104:107]
  v_mfma_f32_16x16x32_bf16 v[108:111], v[84:87], a[76:79], v[108:111]
  v_mfma_f32_16x16x32_bf16 v[104:107], v[64:67], a[80:83], v[104:107]
  v_mfma_f32_16x16x32_bf16 v[108:111], v[88:91], a[80:83], v[108:111]
  v_mfma_f32_16x16x32_bf16 v[104:107], v[68:71], a[84:87], v[104:107]
  v_mfma_f32_16x16x32_bf16 v[108:111], v[92:95], a[84:87], v[108:111]
  s_add_u32 s23, s22, 41984
  v_cvt_pk_bf16_f32 v124, v112, v113
  v_cvt_pk_bf16_f32 v125, v114, v115
  v_cvt_pk_bf16_f32 v126, v116, v117
  v_cvt_pk_bf16_f32 v127, v118, v119
  buffer_store_dwordx4 v[124:127], v2, s[4:7], s23 offen
  v_mfma_f32_16x16x32_bf16 v[104:107], v[72:75], a[88:91], v[104:107]
  v_mfma_f32_16x16x32_bf16 v[108:111], v[96:99], a[88:91], v[108:111]
  v_mfma_f32_16x16x32_bf16 v[104:107], v[76:79], a[92:95], v[104:107]
  v_mfma_f32_16x16x32_bf16 v[108:111], v[100:103], a[92:95], v[108:111]
  ds_read_b128 v[8:11], v2 offset:12288
  ds_read_b128 v[12:15], v2 offset:13312
  ds_read_b128 v[16:19], v2 offset:14336
  ds_read_b128 v[20:23], v2 offset:15360
  ds_read_b128 v[24:27], v2 offset:16384
  ds_read_b128 v[28:31], v2 offset:17408
  ds_read_b128 v[32:35], v2 offset:18432
  ds_read_b128 v[36:39], v2 offset:19456
  ds_read_b128 v[40:43], v2 offset:20480
  ds_read_b128 v[44:47], v2 offset:21504
  ds_read_b128 v[48:51], v2 offset:22528
  ds_read_b128 v[52:55], v2 offset:23552
  v_mfma_f32_16x16x32_bf16 v[112:115], v[56:59], a[96:99], 0
  v_mfma_f32_16x16x32_bf16 v[116:119], v[80:83], a[96:99], 0
  v_mfma_f32_16x16x32_bf16 v[112:115], v[60:63], a[100:103], v[112:115]
  v_mfma_f32_16x16x32_bf16 v[116:119], v[84:87], a[100:103], v[116:119]
  v_mfma_f32_16x16x32_bf16 v[112:115], v[64:67], a[104:107], v[112:115]
  v_mfma_f32_16x16x32_bf16 v[116:119], v[88:91], a[104:107], v[116:119]
  v_mfma_f32_16x16x32_bf16 v[112:115], v[68:71], a[108:111], v[112:115]
  v_mfma_f32_16x16x32_bf16 v[116:119], v[92:95], a[108:111], v[116:119]
  s_add_u32 s23, s22, 62464
  v_cvt_pk_bf16_f32 v120, v104, v105
  v_cvt_pk_bf16_f32 v121, v106, v107
  v_cvt_pk_bf16_f32 v122, v108, v109
  v_cvt_pk_bf16_f32 v123, v110, v111
  buffer_store_dwordx4 v[120:123], v2, s[4:7], s23 offen
  v_mfma_f32_16x16x32_bf16 v[112:115], v[72:75], a[112:115], v[112:115]
  v_mfma_f32_16x16x32_bf16 v[116:119], v[96:99], a[112:115], v[116:119]
  v_mfma_f32_16x16x32_bf16 v[112:115], v[76:79], a[116:119], v[112:115]
  v_mfma_f32_16x16x32_bf16 v[116:119], v[100:103], a[116:119], v[116:119]
  s_waitcnt lgkmcnt(0)
  v_mfma_f32_16x16x32_bf16 v[104:107], v[8:11], a[0:3], 0
  v_mfma_f32_16x16x32_bf16 v[108:111], v[32:35], a[0:3], 0
  v_mfma_f32_16x16x32_bf16 v[104:107], v[12:15], a[4:7], v[104:107]
  v_mfma_f32_16x16x32_bf16 v[108:111], v[36:39], a[4:7], v[108:111]
  v_mfma_f32_16x16x32_bf16 v[104:107], v[16:19], a[8:11], v[104:107]
  v_mfma_f32_16x16x32_bf16 v[108:111], v[40:43], a[8:11], v[108:111]
  v_mfma_f32_16x16x32_bf16 v[104:107], v[20:23], a[12:15], v[104:107]
  v_mfma_f32_16x16x32_bf16 v[108:111], v[44:47], a[12:15], v[108:111]
  s_add_u32 s23, s22, 82944
  v_cvt_pk_bf16_f32 v124, v112, v113
  v_cvt_pk_bf16_f32 v125, v114, v115
  v_cvt_pk_bf16_f32 v126, v116, v117
  v_cvt_pk_bf16_f32 v127, v118, v119
  buffer_store_dwordx4 v[124:127], v2, s[4:7], s23 offen
  v_mfma_f32_16x16x32_bf16 v[104:107], v[24:27], a[16:19], v[104:107]
  v_mfma_f32_16x16x32_bf16 v[108:111], v[48:51], a[16:19], v[108:111]
  v_mfma_f32_16x16x32_bf16 v[104:107], v[28:31], a[20:23], v[104:107]
  v_mfma_f32_16x16x32_bf16 v[108:111], v[52:55], a[20:23], v[108:111]
  v_mfma_f32_16x16x32_bf16 v[112:115], v[8:11], a[24:27], 0
  v_mfma_f32_16x16x32_bf16 v[116:119], v[32:35], a[24:27], 0
  v_mfma_f32_16x16x32_bf16 v[112:115], v[12:15], a[28:31], v[112:115]
  v_mfma_f32_16x16x32_bf16 v[116:119], v[36:39], a[28:31], v[116:119]
  v_mfma_f32_16x16x32_bf16 v[112:115], v[16:19], a[32:35], v[112:115]
  v_mfma_f32_16x16x32_bf16 v[116:119], v[40:43], a[32:35], v[116:119]
  v_mfma_f32_16x16x32_bf16 v[112:115], v[20:23], a[36:39], v[112:115]
  v_mfma_f32_16x16x32_bf16 v[116:119], v[44:47], a[36:39], v[116:119]
  s_add_u32 s23, s22, 2048
  v_cvt_pk_bf16_f32 v120, v104, v105
  v_cvt_pk_bf16_f32 v121, v106, v107
  v_cvt_pk_bf16_f32 v122, v108, v109
  v_cvt_pk_bf16_f32 v123, v110, v111
  buffer_store_dwordx4 v[120:123], v2, s[4:7], s23 offen
  v_mfma_f32_16x16x32_bf16 v[112:115], v[24:27], a[40:43], v[112:115]
  v_mfma_f32_16x16x32_bf16 v[116:119], v[48:51], a[40:43], v[116:119]
  v_mfma_f32_16x16x32_bf16 v[112:115], v[28:31], a[44:47], v[112:115]
  v_mfma_f32_16x16x32_bf16 v[116:119], v[52:55], a[44:47], v[116:119]
  v_mfma_f32_16x16x32_bf16 v[104:107], v[8:11], a[48:51], 0
  v_mfma_f32_16x16x32_bf16 v[108:111], v[32:35], a[48:51], 0
  v_mfma_f32_16x16x32_bf16 v[104:107], v[12:15], a[52:55], v[104:107]
  v_mfma_f32_16x16x32_bf16 v[108:111], v[36:39], a[52:55], v[108:111]
  v_mfma_f32_16x16x32_bf16 v[104:107], v[16:19], a[56:59], v[104:107]
  v_mfma_f32_16x16x32_bf16 v[108:111], v[40:43], a[56:59], v[108:111]
  v_mfma_f32_16x16x32_bf16 v[104:107], v[20:23], a[60:63], v[104:107]
  v_mfma_f32_16x16x32_bf16 v[108:111], v[44:47], a[60:63], v[108:111]
  s_add_u32 s23, s22, 22528
  v_cvt_pk_bf16_f32 v124, v112, v113
  v_cvt_pk_bf16_f32 v125, v114, v115
  v_cvt_pk_bf16_f32 v126, v116, v117
  v_cvt_pk_bf16_f32 v127, v118, v119
  buffer_store_dwordx4 v[124:127], v2, s[4:7], s23 offen
  v_mfma_f32_16x16x32_bf16 v[104:107], v[24:27], a[64:67], v[104:107]
  v_mfma_f32_16x16x32_bf16 v[108:111], v[48:51], a[64:67], v[108:111]
  v_mfma_f32_16x16x32_bf16 v[104:107], v[28:31], a[68:71], v[104:107]
  v_mfma_f32_16x16x32_bf16 v[108:111], v[52:55], a[68:71], v[108:111]
  v_mfma_f32_16x16x32_bf16 v[112:115], v[8:11], a[72:75], 0
  v_mfma_f32_16x16x32_bf16 v[116:119], v[32:35], a[72:75], 0
  v_mfma_f32_16x16x32_bf16 v[112:115], v[12:15], a[76:79], v[112:115]
  v_mfma_f32_16x16x32_bf16 v[116:119], v[36:39], a[76:79], v[116:119]
  v_mfma_f32_16x16x32_bf16 v[112:115], v[16:19], a[80:83], v[112:115]
  v_mfma_f32_16x16x32_bf16 v[116:119], v[40:43], a[80:83], v[116:119]
  v_mfma_f32_16x16x32_bf16 v[112:115], v[20:23], a[84:87], v[112:115]
  v_mfma_f32_16x16x32_bf16 v[116:119], v[44:47], a[84:87], v[116:119]
  s_add_u32 s23, s22, 43008
  v_cvt_pk_bf16_f32 v120, v104, v105
  v_cvt_pk_bf16_f32 v121, v106, v107
  v_cvt_pk_bf16_f32 v122, v108, v109
  v_cvt_pk_bf16_f32 v123, v110, v111
  buffer_store_dwordx4 v[120:123], v2, s[4:7], s23 offen
  v_mfma_f32_16x16x32_bf16 v[112:115], v[24:27], a[88:91], v[112:115]
  v_mfma_f32_16x16x32_bf16 v[116:119], v[48:51], a[88:91], v[116:119]
  v_mfma_f32_16x16x32_bf16 v[112:115], v[28:31], a[92:95], v[112:115]
  v_mfma_f32_16x16x32_bf16 v[116:119], v[52:55], a[92:95], v[116:119]
  ds_read_b128 v[56:59], v2 offset:24576
  ds_read_b128 v[60:63], v2 offset:25600
  ds_read_b128 v[64:67], v2 offset:26624
  ds_read_b128 v[68:71], v2 offset:27648
  ds_read_b128 v[72:75], v2 offset:28672
  ds_read_b128 v[76:79], v2 offset:29696
  ds_read_b128 v[80:83], v2 offset:30720
  ds_read_b128 v[84:87], v2 offset:31744
  ds_read_b128 v[88:91], v2 offset:32768
  ds_read_b128 v[92:95], v2 offset:33792
  ds_read_b128 v[96:99], v2 offset:34816
  ds_read_b128 v[100:103], v2 offset:35840
  v_mfma_f32_16x16x32_bf16 v[104:107], v[8:11], a[96:99], 0
  v_mfma_f32_16x16x32_bf16 v[108:111], v[32:35], a[96:99], 0
  v_mfma_f32_16x16x32_bf16 v[104:107], v[12:15], a[100:103], v[104:107]
  v_mfma_f32_16x16x32_bf16 v[108:111], v[36:39], a[100:103], v[108:111]
  v_mfma_f32_16x16x32_bf16 v[104:107], v[16:19], a[104:107], v[104:107]
  v_mfma_f32_16x16x32_bf16 v[108:111], v[40:43], a[104:107], v[108:111]
  v_mfma_f32_16x16x32_bf16 v[104:107], v[20:23], a[108:111], v[104:107]
  v_mfma_f32_16x16x32_bf16 v[108:111], v[44:47], a[108:111], v[108:111]
  s_add_u32 s23, s22, 63488
  v_cvt_pk_bf16_f32 v124, v112, v113
  v_cvt_pk_bf16_f32 v125, v114, v115
  v_cvt_pk_bf16_f32 v126, v116, v117
  v_cvt_pk_bf16_f32 v127, v118, v119
  buffer_store_dwordx4 v[124:127], v2, s[4:7], s23 offen
  v_mfma_f32_16x16x32_bf16 v[104:107], v[24:27], a[112:115], v[104:107]
  v_mfma_f32_16x16x32_bf16 v[108:111], v[48:51], a[112:115], v[108:111]
  v_mfma_f32_16x16x32_bf16 v[104:107], v[28:31], a[116:119], v[104:107]
  v_mfma_f32_16x16x32_bf16 v[108:111], v[52:55], a[116:119], v[108:111]
  s_waitcnt lgkmcnt(0)
  v_mfma_f32_16x16x32_bf16 v[112:115], v[56:59], a[0:3], 0
  v_mfma_f32_16x16x32_bf16 v[116:119], v[80:83], a[0:3], 0
  v_mfma_f32_16x16x32_bf16 v[112:115], v[60:63], a[4:7], v[112:115]
  v_mfma_f32_16x16x32_bf16 v[116:119], v[84:87], a[4:7], v[116:119]
  v_mfma_f32_16x16x32_bf16 v[112:115], v[64:67], a[8:11], v[112:115]
  v_mfma_f32_16x16x32_bf16 v[116:119], v[88:91], a[8:11], v[116:119]
  v_mfma_f32_16x16x32_bf16 v[112:115], v[68:71], a[12:15], v[112:115]
  v_mfma_f32_16x16x32_bf16 v[116:119], v[92:95], a[12:15], v[116:119]
  s_add_u32 s23, s22, 83968
  v_cvt_pk_bf16_f32 v120, v104, v105
  v_cvt_pk_bf16_f32 v121, v106, v107
  v_cvt_pk_bf16_f32 v122, v108, v109
  v_cvt_pk_bf16_f32 v123, v110, v111
  buffer_store_dwordx4 v[120:123], v2, s[4:7], s23 offen
  v_mfma_f32_16x16x32_bf16 v[112:115], v[72:75], a[16:19], v[112:115]
  v_mfma_f32_16x16x32_bf16 v[116:119], v[96:99], a[16:19], v[116:119]
  v_mfma_f32_16x16x32_bf16 v[112:115], v[76:79], a[20:23], v[112:115]
  v_mfma_f32_16x16x32_bf16 v[116:119], v[100:103], a[20:23], v[116:119]
  v_mfma_f32_16x16x32_bf16 v[104:107], v[56:59], a[24:27], 0
  v_mfma_f32_16x16x32_bf16 v[108:111], v[80:83], a[24:27], 0
  v_mfma_f32_16x16x32_bf16 v[104:107], v[60:63], a[28:31], v[104:107]
  v_mfma_f32_16x16x32_bf16 v[108:111], v[84:87], a[28:31], v[108:111]
  v_mfma_f32_16x16x32_bf16 v[104:107], v[64:67], a[32:35], v[104:107]
  v_mfma_f32_16x16x32_bf16 v[108:111], v[88:91], a[32:35], v[108:111]
  v_mfma_f32_16x16x32_bf16 v[104:107], v[68:71], a[36:39], v[104:107]
  v_mfma_f32_16x16x32_bf16 v[108:111], v[92:95], a[36:39], v[108:111]
  s_add_u32 s23, s22, 3072
  v_cvt_pk_bf16_f32 v124, v112, v113
  v_cvt_pk_bf16_f32 v125, v114, v115
  v_cvt_pk_bf16_f32 v126, v116, v117
  v_cvt_pk_bf16_f32 v127, v118, v119
  buffer_store_dwordx4 v[124:127], v2, s[4:7], s23 offen
  v_mfma_f32_16x16x32_bf16 v[104:107], v[72:75], a[40:43], v[104:107]
  v_mfma_f32_16x16x32_bf16 v[108:111], v[96:99], a[40:43], v[108:111]
  v_mfma_f32_16x16x32_bf16 v[104:107], v[76:79], a[44:47], v[104:107]
  v_mfma_f32_16x16x32_bf16 v[108:111], v[100:103], a[44:47], v[108:111]
  v_mfma_f32_16x16x32_bf16 v[112:115], v[56:59], a[48:51], 0
  v_mfma_f32_16x16x32_bf16 v[116:119], v[80:83], a[48:51], 0
  v_mfma_f32_16x16x32_bf16 v[112:115], v[60:63], a[52:55], v[112:115]
  v_mfma_f32_16x16x32_bf16 v[116:119], v[84:87], a[52:55], v[116:119]
  v_mfma_f32_16x16x32_bf16 v[112:115], v[64:67], a[56:59], v[112:115]
  v_mfma_f32_16x16x32_bf16 v[116:119], v[88:91], a[56:59], v[116:119]
  v_mfma_f32_16x16x32_bf16 v[112:115], v[68:71], a[60:63], v[112:115]
  v_mfma_f32_16x16x32_bf16 v[116:119], v[92:95], a[60:63], v[116:119]
  s_add_u32 s23, s22, 23552
  v_cvt_pk_bf16_f32 v120, v104, v105
  v_cvt_pk_bf16_f32 v121, v106, v107
  v_cvt_pk_bf16_f32 v122, v108, v109
  v_cvt_pk_bf16_f32 v123, v110, v111
  buffer_store_dwordx4 v[120:123], v2, s[4:7], s23 offen
  v_mfma_f32_16x16x32_bf16 v[112:115], v[72:75], a[64:67], v[112:115]
  v_mfma_f32_16x16x32_bf16 v[116:119], v[96:99], a[64:67], v[116:119]
  v_mfma_f32_16x16x32_bf16 v[112:115], v[76:79], a[68:71], v[112:115]
  v_mfma_f32_16x16x32_bf16 v[116:119], v[100:103], a[68:71], v[116:119]
  v_mfma_f32_16x16x32_bf16 v[104:107], v[56:59], a[72:75], 0
  v_mfma_f32_16x16x32_bf16 v[108:111], v[80:83], a[72:75], 0
  v_mfma_f32_16x16x32_bf16 v[104:107], v[60:63], a[76:79], v[104:107]
  v_mfma_f32_16x16x32_bf16 v[108:111], v[84:87], a[76:79], v[108:111]
  v_mfma_f32_16x16x32_bf16 v[104:107], v[64:67], a[80:83], v[104:107]
  v_mfma_f32_16x16x32_bf16 v[108:111], v[88:91], a[80:83], v[108:111]
  v_mfma_f32_16x16x32_bf16 v[104:107], v[68:71], a[84:87], v[104:107]
  v_mfma_f32_16x16x32_bf16 v[108:111], v[92:95], a[84:87], v[108:111]
  s_add_u32 s23, s22, 44032
  v_cvt_pk_bf16_f32 v124, v112, v113
  v_cvt_pk_bf16_f32 v125, v114, v115
  v_cvt_pk_bf16_f32 v126, v116, v117
  v_cvt_pk_bf16_f32 v127, v118, v119
  buffer_store_dwordx4 v[124:127], v2, s[4:7], s23 offen
  v_mfma_f32_16x16x32_bf16 v[104:107], v[72:75], a[88:91], v[104:107]
  v_mfma_f32_16x16x32_bf16 v[108:111], v[96:99], a[88:91], v[108:111]
  v_mfma_f32_16x16x32_bf16 v[104:107], v[76:79], a[92:95], v[104:107]
  v_mfma_f32_16x16x32_bf16 v[108:111], v[100:103], a[92:95], v[108:111]
  ds_read_b128 v[8:11], v2 offset:36864
  ds_read_b128 v[12:15], v2 offset:37888
  ds_read_b128 v[16:19], v2 offset:38912
  ds_read_b128 v[20:23], v2 offset:39936
  ds_read_b128 v[24:27], v2 offset:40960
  ds_read_b128 v[28:31], v2 offset:41984
  ds_read_b128 v[32:35], v2 offset:43008
  ds_read_b128 v[36:39], v2 offset:44032
  ds_read_b128 v[40:43], v2 offset:45056
  ds_read_b128 v[44:47], v2 offset:46080
  ds_read_b128 v[48:51], v2 offset:47104
  ds_read_b128 v[52:55], v2 offset:48128
  v_mfma_f32_16x16x32_bf16 v[112:115], v[56:59], a[96:99], 0
  v_mfma_f32_16x16x32_bf16 v[116:119], v[80:83], a[96:99], 0
  v_mfma_f32_16x16x32_bf16 v[112:115], v[60:63], a[100:103], v[112:115]
  v_mfma_f32_16x16x32_bf16 v[116:119], v[84:87], a[100:103], v[116:119]
  v_mfma_f32_16x16x32_bf16 v[112:115], v[64:67], a[104:107], v[112:115]
  v_mfma_f32_16x16x32_bf16 v[116:119], v[88:91], a[104:107], v[116:119]
  v_mfma_f32_16x16x32_bf16 v[112:115], v[68:71], a[108:111], v[112:115]
  v_mfma_f32_16x16x32_bf16 v[116:119], v[92:95], a[108:111], v[116:119]
  s_add_u32 s23, s22, 64512
  v_cvt_pk_bf16_f32 v120, v104, v105
  v_cvt_pk_bf16_f32 v121, v106, v107
  v_cvt_pk_bf16_f32 v122, v108, v109
  v_cvt_pk_bf16_f32 v123, v110, v111
  buffer_store_dwordx4 v[120:123], v2, s[4:7], s23 offen
  v_mfma_f32_16x16x32_bf16 v[112:115], v[72:75], a[112:115], v[112:115]
  v_mfma_f32_16x16x32_bf16 v[116:119], v[96:99], a[112:115], v[116:119]
  v_mfma_f32_16x16x32_bf16 v[112:115], v[76:79], a[116:119], v[112:115]
  v_mfma_f32_16x16x32_bf16 v[116:119], v[100:103], a[116:119], v[116:119]
  s_waitcnt lgkmcnt(0)
  v_mfma_f32_16x16x32_bf16 v[104:107], v[8:11], a[0:3], 0
  v_mfma_f32_16x16x32_bf16 v[108:111], v[32:35], a[0:3], 0
  v_mfma_f32_16x16x32_bf16 v[104:107], v[12:15], a[4:7], v[104:107]
  v_mfma_f32_16x16x32_bf16 v[108:111], v[36:39], a[4:7], v[108:111]
  v_mfma_f32_16x16x32_bf16 v[104:107], v[16:19], a[8:11], v[104:107]
  v_mfma_f32_16x16x32_bf16 v[108:111], v[40:43], a[8:11], v[108:111]
  v_mfma_f32_16x16x32_bf16 v[104:107], v[20:23], a[12:15], v[104:107]
  v_mfma_f32_16x16x32_bf16 v[108:111], v[44:47], a[12:15], v[108:111]
  s_add_u32 s23, s22, 84992
  v_cvt_pk_bf16_f32 v124, v112, v113
  v_cvt_pk_bf16_f32 v125, v114, v115
  v_cvt_pk_bf16_f32 v126, v116, v117
  v_cvt_pk_bf16_f32 v127, v118, v119
  buffer_store_dwordx4 v[124:127], v2, s[4:7], s23 offen
  v_mfma_f32_16x16x32_bf16 v[104:107], v[24:27], a[16:19], v[104:107]
  v_mfma_f32_16x16x32_bf16 v[108:111], v[48:51], a[16:19], v[108:111]
  v_mfma_f32_16x16x32_bf16 v[104:107], v[28:31], a[20:23], v[104:107]
  v_mfma_f32_16x16x32_bf16 v[108:111], v[52:55], a[20:23], v[108:111]
  v_mfma_f32_16x16x32_bf16 v[112:115], v[8:11], a[24:27], 0
  v_mfma_f32_16x16x32_bf16 v[116:119], v[32:35], a[24:27], 0
  v_mfma_f32_16x16x32_bf16 v[112:115], v[12:15], a[28:31], v[112:115]
  v_mfma_f32_16x16x32_bf16 v[116:119], v[36:39], a[28:31], v[116:119]
  v_mfma_f32_16x16x32_bf16 v[112:115], v[16:19], a[32:35], v[112:115]
  v_mfma_f32_16x16x32_bf16 v[116:119], v[40:43], a[32:35], v[116:119]
  v_mfma_f32_16x16x32_bf16 v[112:115], v[20:23], a[36:39], v[112:115]
  v_mfma_f32_16x16x32_bf16 v[116:119], v[44:47], a[36:39], v[116:119]
  s_add_u32 s23, s22, 4096
  v_cvt_pk_bf16_f32 v120, v104, v105
  v_cvt_pk_bf16_f32 v121, v106, v107
  v_cvt_pk_bf16_f32 v122, v108, v109
  v_cvt_pk_bf16_f32 v123, v110, v111
  buffer_store_dwordx4 v[120:123], v2, s[4:7], s23 offen
  v_mfma_f32_16x16x32_bf16 v[112:115], v[24:27], a[40:43], v[112:115]
  v_mfma_f32_16x16x32_bf16 v[116:119], v[48:51], a[40:43], v[116:119]
  v_mfma_f32_16x16x32_bf16 v[112:115], v[28:31], a[44:47], v[112:115]
  v_mfma_f32_16x16x32_bf16 v[116:119], v[52:55], a[44:47], v[116:119]
  v_mfma_f32_16x16x32_bf16 v[104:107], v[8:11], a[48:51], 0
  v_mfma_f32_16x16x32_bf16 v[108:111], v[32:35], a[48:51], 0
  v_mfma_f32_16x16x32_bf16 v[104:107], v[12:15], a[52:55], v[104:107]
  v_mfma_f32_16x16x32_bf16 v[108:111], v[36:39], a[52:55], v[108:111]
  v_mfma_f32_16x16x32_bf16 v[104:107], v[16:19], a[56:59], v[104:107]
  v_mfma_f32_16x16x32_bf16 v[108:111], v[40:43], a[56:59], v[108:111]
  v_mfma_f32_16x16x32_bf16 v[104:107], v[20:23], a[60:63], v[104:107]
  v_mfma_f32_16x16x32_bf16 v[108:111], v[44:47], a[60:63], v[108:111]
  s_add_u32 s23, s22, 24576
  v_cvt_pk_bf16_f32 v124, v112, v113
  v_cvt_pk_bf16_f32 v125, v114, v115
  v_cvt_pk_bf16_f32 v126, v116, v117
  v_cvt_pk_bf16_f32 v127, v118, v119
  buffer_store_dwordx4 v[124:127], v2, s[4:7], s23 offen
  v_mfma_f32_16x16x32_bf16 v[104:107], v[24:27], a[64:67], v[104:107]
  v_mfma_f32_16x16x32_bf16 v[108:111], v[48:51], a[64:67], v[108:111]
  v_mfma_f32_16x16x32_bf16 v[104:107], v[28:31], a[68:71], v[104:107]
  v_mfma_f32_16x16x32_bf16 v[108:111], v[52:55], a[68:71], v[108:111]
  v_mfma_f32_16x16x32_bf16 v[112:115], v[8:11], a[72:75], 0
  v_mfma_f32_16x16x32_bf16 v[116:119], v[32:35], a[72:75], 0
  v_mfma_f32_16x16x32_bf16 v[112:115], v[12:15], a[76:79], v[112:115]
  v_mfma_f32_16x16x32_bf16 v[116:119], v[36:39], a[76:79], v[116:119]
  v_mfma_f32_16x16x32_bf16 v[112:115], v[16:19], a[80:83], v[112:115]
  v_mfma_f32_16x16x32_bf16 v[116:119], v[40:43], a[80:83], v[116:119]
  v_mfma_f32_16x16x32_bf16 v[112:115], v[20:23], a[84:87], v[112:115]
  v_mfma_f32_16x16x32_bf16 v[116:119], v[44:47], a[84:87], v[116:119]
  s_add_u32 s23, s22, 45056
  v_cvt_pk_bf16_f32 v120, v104, v105
  v_cvt_pk_bf16_f32 v121, v106, v107
  v_cvt_pk_bf16_f32 v122, v108, v109
  v_cvt_pk_bf16_f32 v123, v110, v111
  buffer_store_dwordx4 v[120:123], v2, s[4:7], s23 offen
  v_mfma_f32_16x16x32_bf16 v[112:115], v[24:27], a[88:91], v[112:115]
  v_mfma_f32_16x16x32_bf16 v[116:119], v[48:51], a[88:91], v[116:119]
  v_mfma_f32_16x16x32_bf16 v[112:115], v[28:31], a[92:95], v[112:115]
  v_mfma_f32_16x16x32_bf16 v[116:119], v[52:55], a[92:95], v[116:119]
  v_mfma_f32_16x16x32_bf16 v[104:107], v[8:11], a[96:99], 0
  v_mfma_f32_16x16x32_bf16 v[108:111], v[32:35], a[96:99], 0
  v_mfma_f32_16x16x32_bf16 v[104:107], v[12:15], a[100:103], v[104:107]
  v_mfma_f32_16x16x32_bf16 v[108:111], v[36:39], a[100:103], v[108:111]
  v_mfma_f32_16x16x32_bf16 v[104:107], v[16:19], a[104:107], v[104:107]
  v_mfma_f32_16x16x32_bf16 v[108:111], v[40:43], a[104:107], v[108:111]
  v_mfma_f32_16x16x32_bf16 v[104:107], v[20:23], a[108:111], v[104:107]
  v_mfma_f32_16x16x32_bf16 v[108:111], v[44:47], a[108:111], v[108:111]
  s_add_u32 s23, s22, 65536
  v_cvt_pk_bf16_f32 v124, v112, v113
  v_cvt_pk_bf16_f32 v125, v114, v115
  v_cvt_pk_bf16_f32 v126, v116, v117
  v_cvt_pk_bf16_f32 v127, v118, v119
  buffer_store_dwordx4 v[124:127], v2, s[4:7], s23 offen
  v_mfma_f32_16x16x32_bf16 v[104:107], v[24:27], a[112:115], v[104:107]
  v_mfma_f32_16x16x32_bf16 v[108:111], v[48:51], a[112:115], v[108:111]
  v_mfma_f32_16x16x32_bf16 v[104:107], v[28:31], a[116:119], v[104:107]
  v_mfma_f32_16x16x32_bf16 v[108:111], v[52:55], a[116:119], v[108:111]
  s_add_u32 s23, s22, 86016
  s_nop 3
  v_cvt_pk_bf16_f32 v120, v104, v105
  v_cvt_pk_bf16_f32 v121, v106, v107
  s_nop 0
  v_cvt_pk_bf16_f32 v122, v108, v109
  v_cvt_pk_bf16_f32 v123, v110, v111
  buffer_store_dwordx4 v[120:123], v2, s[4:7], s23 offen
  s_endpgm
prep_nobmat:
  s_sub_u32 s2, s2, 288
  s_lshl_b32 s2, s2, 2
  s_add_u32 s2, s2, s3
  s_cmp_ge_u32 s2, 512
  s_cbranch_scc1 prep_noto2
  v_and_b32 v2, 15, v1
  v_lshrrev_b32 v3, 4, v1
  v_mul_u32_u24 v4, 1280, v3
  v_lshl_add_u32 v4, v2, 4, v4
  s_mul_i32 s20, s2, 5120
  buffer_load_dwordx4 v[8:11], v4, s[36:39], s20 offen offset:0
  buffer_load_dwordx4 v[12:15], v4, s[36:39], s20 offen offset:256
  buffer_load_dwordx4 v[16:19], v4, s[36:39], s20 offen offset:512
  buffer_load_dwordx4 v[20:23], v4, s[36:39], s20 offen offset:768
  buffer_load_dwordx4 v[24:27], v4, s[36:39], s20 offen offset:1024
  v_lshrrev_b32 v5, 2, v2
  v_lshlrev_b32 v5, 10, v5
  v_and_b32 v6, 3, v2
  v_lshl_add_u32 v5, v6, 8, v5
  v_lshl_add_u32 v5, v3, 4, v5
  s_lshr_b32 s21, s2, 2
  s_mul_i32 s21, s21, 20480
  s_and_b32 s22, s2, 3
  s_lshl_b32 s22, s22, 6
  s_add_u32 s21, s21, s22
  s_add_u32 s21, s21, 26214400
  s_mov_b32 s30, 0xffff0000
  s_waitcnt vmcnt(0)
  v_lshlrev_b32 v32, 16, v8
  v_and_b32 v33, s30, v8
  v_lshlrev_b32 v34, 16, v9
  v_and_b32 v35, s30, v9
  v_pk_add_f32 v[6:7], v[32:33], v[34:35]
  v_lshlrev_b32 v36, 16, v10
  v_and_b32 v37, s30, v10
  v_pk_add_f32 v[6:7], v[6:7], v[36:37]
  v_lshlrev_b32 v38, 16, v11
  v_and_b32 v39, s30, v11
  v_pk_add_f32 v[6:7], v[6:7], v[38:39]
  v_lshlrev_b32 v40, 16, v12
  v_and_b32 v41, s30, v12
  v_pk_add_f32 v[6:7], v[6:7], v[40:41]
  v_lshlrev_b32 v42, 16, v13
  v_and_b32 v43, s30, v13
  v_pk_add_f32 v[6:7], v[6:7], v[42:43]
  v_lshlrev_b32 v44, 16, v14
  v_and_b32 v45, s30, v14
  v_pk_add_f32 v[6:7], v[6:7], v[44:45]
  v_lshlrev_b32 v46, 16, v15
  v_and_b32 v47, s30, v15
  v_pk_add_f32 v[6:7], v[6:7], v[46:47]
  v_lshlrev_b32 v48, 16, v16
  v_and_b32 v49, s30, v16
  v_pk_add_f32 v[6:7], v[6:7], v[48:49]
  v_lshlrev_b32 v50, 16, v17
  v_and_b32 v51, s30, v17
  v_pk_add_f32 v[6:7], v[6:7], v[50:51]
  v_lshlrev_b32 v52, 16, v18
  v_and_b32 v53, s30, v18
  v_pk_add_f32 v[6:7], v[6:7], v[52:53]
  v_lshlrev_b32 v54, 16, v19
  v_and_b32 v55, s30, v19
  v_pk_add_f32 v[6:7], v[6:7], v[54:55]
  v_lshlrev_b32 v56, 16, v20
  v_and_b32 v57, s30, v20
  v_pk_add_f32 v[6:7], v[6:7], v[56:57]
  v_lshlrev_b32 v58, 16, v21
  v_and_b32 v59, s30, v21
  v_pk_add_f32 v[6:7], v[6:7], v[58:59]
  v_lshlrev_b32 v60, 16, v22
  v_and_b32 v61, s30, v22
  v_pk_add_f32 v[6:7], v[6:7], v[60:61]
  v_lshlrev_b32 v62, 16, v23
  v_and_b32 v63, s30, v23
  v_pk_add_f32 v[6:7], v[6:7], v[62:63]
  v_lshlrev_b32 v64, 16, v24
  v_and_b32 v65, s30, v24
  v_pk_add_f32 v[6:7], v[6:7], v[64:65]
  v_lshlrev_b32 v66, 16, v25
  v_and_b32 v67, s30, v25
  v_pk_add_f32 v[6:7], v[6:7], v[66:67]
  v_lshlrev_b32 v68, 16, v26
  v_and_b32 v69, s30, v26
  v_pk_add_f32 v[6:7], v[6:7], v[68:69]
  v_lshlrev_b32 v70, 16, v27
  v_and_b32 v71, s30, v27
  v_pk_add_f32 v[6:7], v[6:7], v[70:71]
  v_add_f32 v6, v6, v7
  s_nop 1
  v_add_f32_dpp v6, v6, v6 row_ror:8 row_mask:0xf bank_mask:0xf
  s_nop 1
  v_add_f32_dpp v6, v6, v6 row_ror:4 row_mask:0xf bank_mask:0xf
  s_nop 1
  v_add_f32_dpp v6, v6, v6 row_ror:2 row_mask:0xf bank_mask:0xf
  s_nop 1
  v_add_f32_dpp v6, v6, v6 row_ror:1 row_mask:0xf bank_mask:0xf
  v_mul_f32 v6, 0xbacccccd, v6
  v_mov_b32 v7, v6
  v_pk_add_f32 v[32:33], v[32:33], v[6:7]
  v_pk_mul_f32 v[28:29], v[32:33], v[32:33]
  v_pk_add_f32 v[34:35], v[34:35], v[6:7]
  v_pk_fma_f32 v[28:29], v[34:35], v[34:35], v[28:29]
  v_pk_add_f32 v[36:37], v[36:37], v[6:7]
  v_pk_fma_f32 v[28:29], v[36:37], v[36:37], v[28:29]
  v_pk_add_f32 v[38:39], v[38:39], v[6:7]
  v_pk_fma_f32 v[28:29], v[38:39], v[38:39], v[28:29]
  v_pk_add_f32 v[40:41], v[40:41], v[6:7]
  v_pk_fma_f32 v[28:29], v[40:41], v[40:41], v[28:29]
  v_pk_add_f32 v[42:43], v[42:43], v[6:7]
  v_pk_fma_f32 v[28:29], v[42:43], v[42:43], v[28:29]
  v_pk_add_f32 v[44:45], v[44:45], v[6:7]
  v_pk_fma_f32 v[28:29], v[44:45], v[44:45], v[28:29]
  v_pk_add_f32 v[46:47], v[46:47], v[6:7]
  v_pk_fma_f32 v[28:29], v[46:47], v[46:47], v[28:29]
  v_pk_add_f32 v[48:49], v[48:49], v[6:7]
  v_pk_fma_f32 v[28:29], v[48:49], v[48:49], v[28:29]
  v_pk_add_f32 v[50:51], v[50:51], v[6:7]
  v_pk_fma_f32 v[28:29], v[50:51], v[50:51], v[28:29]
  v_pk_add_f32 v[52:53], v[52:53], v[6:7]
  v_pk_fma_f32 v[28:29], v[52:53], v[52:53], v[28:29]
  v_pk_add_f32 v[54:55], v[54:55], v[6:7]
  v_pk_fma_f32 v[28:29], v[54:55], v[54:55], v[28:29]
  v_pk_add_f32 v[56:57], v[56:57], v[6:7]
  v_pk_fma_f32 v[28:29], v[56:57], v[56:57], v[28:29]
  v_pk_add_f32 v[58:59], v[58:59], v[6:7]
  v_pk_fma_f32 v[28:29], v[58:59], v[58:59], v[28:29]
  v_pk_add_f32 v[60:61], v[60:61], v[6:7]
  v_pk_fma_f32 v[28:29], v[60:61], v[60:61], v[28:29]
  v_pk_add_f32 v[62:63], v[62:63], v[6:7]
  v_pk_fma_f32 v[28:29], v[62:63], v[62:63], v[28:29]
  v_pk_add_f32 v[64:65], v[64:65], v[6:7]
  v_pk_fma_f32 v[28:29], v[64:65], v[64:65], v[28:29]
  v_pk_add_f32 v[66:67], v[66:67], v[6:7]
  v_pk_fma_f32 v[28:29], v[66:67], v[66:67], v[28:29]
  v_pk_add_f32 v[68:69], v[68:69], v[6:7]
  v_pk_fma_f32 v[28:29], v[68:69], v[68:69], v[28:29]
  v_pk_add_f32 v[70:71], v[70:71], v[6:7]
  v_pk_fma_f32 v[28:29], v[70:71], v[70:71], v[28:29]
  v_add_f32 v28, v28, v29
  s_nop 1
  v_add_f32_dpp v28, v28, v28 row_ror:8 row_mask:0xf bank_mask:0xf
  s_nop 1
  v_add_f32_dpp v28, v28, v28 row_ror:4 row_mask:0xf bank_mask:0xf
  s_nop 1
  v_add_f32_dpp v28, v28, v28 row_ror:2 row_mask:0xf bank_mask:0xf
  s_nop 1
  v_add_f32_dpp v28, v28, v28 row_ror:1 row_mask:0xf bank_mask:0xf
  v_mov_b32 v6, 0x3727c5ac
  v_fmac_f32 v6, 0x3acccccd, v28
  v_rsq_f32 v6, v6
  s_nop 0
  v_mov_b32 v7, v6
  v_pk_mul_f32 v[32:33], v[32:33], v[6:7]
  v_cvt_pk_bf16_f32 v8, v32, v33
  v_pk_mul_f32 v[34:35], v[34:35], v[6:7]
  v_cvt_pk_bf16_f32 v9, v34, v35
  v_pk_mul_f32 v[36:37], v[36:37], v[6:7]
  v_cvt_pk_bf16_f32 v10, v36, v37
  v_pk_mul_f32 v[38:39], v[38:39], v[6:7]
  v_cvt_pk_bf16_f32 v11, v38, v39
  buffer_store_dwordx4 v[8:11], v5, s[4:7], s21 offen
  s_add_u32 s21, s21, 4096
  v_pk_mul_f32 v[40:41], v[40:41], v[6:7]
  v_cvt_pk_bf16_f32 v12, v40, v41
  v_pk_mul_f32 v[42:43], v[42:43], v[6:7]
  v_cvt_pk_bf16_f32 v13, v42, v43
  v_pk_mul_f32 v[44:45], v[44:45], v[6:7]
  v_cvt_pk_bf16_f32 v14, v44, v45
  v_pk_mul_f32 v[46:47], v[46:47], v[6:7]
  v_cvt_pk_bf16_f32 v15, v46, v47
  buffer_store_dwordx4 v[12:15], v5, s[4:7], s21 offen
  s_add_u32 s21, s21, 4096
  v_pk_mul_f32 v[48:49], v[48:49], v[6:7]
  v_cvt_pk_bf16_f32 v16, v48, v49
  v_pk_mul_f32 v[50:51], v[50:51], v[6:7]
  v_cvt_pk_bf16_f32 v17, v50, v51
  v_pk_mul_f32 v[52:53], v[52:53], v[6:7]
  v_cvt_pk_bf16_f32 v18, v52, v53
  v_pk_mul_f32 v[54:55], v[54:55], v[6:7]
  v_cvt_pk_bf16_f32 v19, v54, v55
  buffer_store_dwordx4 v[16:19], v5, s[4:7], s21 offen
  s_add_u32 s21, s21, 4096
  v_pk_mul_f32 v[56:57], v[56:57], v[6:7]
  v_cvt_pk_bf16_f32 v20, v56, v57
  v_pk_mul_f32 v[58:59], v[58:59], v[6:7]
  v_cvt_pk_bf16_f32 v21, v58, v59
  v_pk_mul_f32 v[60:61], v[60:61], v[6:7]
  v_cvt_pk_bf16_f32 v22, v60, v61
  v_pk_mul_f32 v[62:63], v[62:63], v[6:7]
  v_cvt_pk_bf16_f32 v23, v62, v63
  buffer_store_dwordx4 v[20:23], v5, s[4:7], s21 offen
  s_add_u32 s21, s21, 4096
  v_pk_mul_f32 v[64:65], v[64:65], v[6:7]
  v_cvt_pk_bf16_f32 v24, v64, v65
  v_pk_mul_f32 v[66:67], v[66:67], v[6:7]
  v_cvt_pk_bf16_f32 v25, v66, v67
  v_pk_mul_f32 v[68:69], v[68:69], v[6:7]
  v_cvt_pk_bf16_f32 v26, v68, v69
  v_pk_mul_f32 v[70:71], v[70:71], v[6:7]
  v_cvt_pk_bf16_f32 v27, v70, v71
  buffer_store_dwordx4 v[24:27], v5, s[4:7], s21 offen
  s_add_u32 s21, s21, 4096
  s_endpgm
prep_noto2:
  v_lshlrev_b32 v3, 4, v1
  v_mov_b32 v4, -1
  v_mov_b32 v5, -1
  v_mov_b32 v6, -1
  v_mov_b32 v7, -1
  s_cmp_ge_u32 s2, 528
  s_cbranch_scc1 prep_notinit
  s_sub_u32 s2, s2, 512
  v_bfe_u32 v2, v1, 2, 2
  v_and_b32 v48, 1, v1
  v_lshl_add_u32 v2, v2, 1, v48
  v_mul_u32_u24 v2, 1280, v2
  v_bfe_u32 v48, v1, 1, 1
  v_lshrrev_b32 v49, 4, v1
  v_lshl_add_u32 v50, v49, 1, v48
  v_mul_u32_u24 v50, 80, v50
  v_add_u32 v50, v50, v2
  v_lshl_add_u32 v2, v48, 4, v2
  v_and_b32 v48, 1, v49
  v_lshl_add_u32 v2, v48, 5, v2
  v_lshrrev_b32 v48, 1, v49
  v_mul_u32_u24 v48, 80, v48
  v_add_u32 v2, v2, v48
  buffer_load_dwordx4 v[8:11], v2, s[40:43], 0 offen offset:0
  buffer_load_dwordx4 v[12:15], v2, s[40:43], 0 offen offset:160
  buffer_load_dwordx4 v[16:19], v2, s[40:43], 0 offen offset:320
  buffer_load_dwordx4 v[20:23], v2, s[40:43], 0 offen offset:480
  buffer_load_dwordx4 v[24:27], v2, s[40:43], 0 offen offset:640
  buffer_load_dwordx4 v[28:31], v2, s[40:43], 0 offen offset:800
  buffer_load_dwordx4 v[32:35], v2, s[40:43], 0 offen offset:960
  buffer_load_dwordx4 v[36:39], v2, s[40:43], 0 offen offset:1120
  buffer_load_dwordx4 v[40:43], v50, s[40:43], 0 offen offset:64
  buffer_load_dwordx4 v[44:47], v50, s[40:43], 0 offen offset:704
  s_mul_i32 s20, s2, 20480
  s_add_u32 s20, s20, 56033280
  s_add_u32 s21, s20, 10240
  s_waitcnt vmcnt(0)
  v_min_u32 v8, -2, v8
  v_min_u32 v9, -2, v9
  v_min_u32 v10, -2, v10
  v_min_u32 v11, -2, v11
  v_min_u32 v12, -2, v12
  v_min_u32 v13, -2, v13
  v_min_u32 v14, -2, v14
  v_min_u32 v15, -2, v15
  v_min_u32 v16, -2, v16
  v_min_u32 v17, -2, v17
  v_min_u32 v18, -2, v18
  v_min_u32 v19, -2, v19
  v_min_u32 v20, -2, v20
  v_min_u32 v21, -2, v21
  v_min_u32 v22, -2, v22
  v_min_u32 v23, -2, v23
  v_min_u32 v24, -2, v24
  v_min_u32 v25, -2, v25
  v_min_u32 v26, -2, v26
  v_min_u32 v27, -2, v27
  v_min_u32 v28, -2, v28
  v_min_u32 v29, -2, v29
  v_min_u32 v30, -2, v30
  v_min_u32 v31, -2, v31
  v_min_u32 v32, -2, v32
  v_min_u32 v33, -2, v33
  v_min_u32 v34, -2, v34
  v_min_u32 v35, -2, v35
  v_min_u32 v36, -2, v36
  v_min_u32 v37, -2, v37
  v_min_u32 v38, -2, v38
  v_min_u32 v39, -2, v39
  v_min_u32 v40, -2, v40
  v_min_u32 v41, -2, v41
  v_min_u32 v42, -2, v42
  v_min_u32 v43, -2, v43
  v_min_u32 v44, -2, v44
  v_min_u32 v45, -2, v45
  v_min_u32 v46, -2, v46
  v_min_u32 v47, -2, v47
  buffer_store_dwordx4 v[8:11], v3, s[4:7], s20 offen offset:0
  buffer_store_dwordx4 v[4:7], v3, s[4:7], s21 offen offset:0
  buffer_store_dwordx4 v[12:15], v3, s[4:7], s20 offen offset:1024
  buffer_store_dwordx4 v[4:7], v3, s[4:7], s21 offen offset:1024
  buffer_store_dwordx4 v[16:19], v3, s[4:7], s20 offen offset:2048
  buffer_store_dwordx4 v[4:7], v3, s[4:7], s21 offen offset:2048
  buffer_store_dwordx4 v[20:23], v3, s[4:7], s20 offen offset:3072
  buffer_store_dwordx4 v[4:7], v3, s[4:7], s21 offen offset:3072
  s_add_u32 s20, s20, 4096
  s_add_u32 s21, s21, 4096
  buffer_store_dwordx4 v[24:27], v3, s[4:7], s20 offen offset:0
  buffer_store_dwordx4 v[4:7], v3, s[4:7], s21 offen offset:0
  buffer_store_dwordx4 v[28:31], v3, s[4:7], s20 offen offset:1024
  buffer_store_dwordx4 v[4:7], v3, s[4:7], s21 offen offset:1024
  buffer_store_dwordx4 v[32:35], v3, s[4:7], s20 offen offset:2048
  buffer_store_dwordx4 v[4:7], v3, s[4:7], s21 offen offset:2048
  buffer_store_dwordx4 v[36:39], v3, s[4:7], s20 offen offset:3072
  buffer_store_dwordx4 v[4:7], v3, s[4:7], s21 offen offset:3072
  s_add_u32 s20, s20, 4096
  s_add_u32 s21, s21, 4096
  buffer_store_dwordx4 v[40:43], v3, s[4:7], s20 offen offset:0
  buffer_store_dwordx4 v[4:7], v3, s[4:7], s21 offen offset:0
  buffer_store_dwordx4 v[44:47], v3, s[4:7], s20 offen offset:1024
  buffer_store_dwordx4 v[4:7], v3, s[4:7], s21 offen offset:1024
  s_endpgm
prep_notinit:
  s_cmp_ge_u32 s2, 608
  s_cbranch_scc1 prep_nothb
  s_sub_u32 s2, s2, 528
  s_add_u32 s20, s4, 58785791
  s_and_b32 s20, s20, 0xffe00000
  s_sub_u32 s20, s20, s4
  s_and_b32 s21, s2, 3
  s_mul_i32 s21, s21, 2260992
  s_add_u32 s20, s20, s21
  s_lshr_b32 s21, s2, 2
  s_lshl_b32 s21, s21, 14
  s_add_u32 s20, s20, s21
  buffer_store_dwordx4 v[4:7], v3, s[4:7], s20 offen offset:0
  buffer_store_dwordx4 v[4:7], v3, s[4:7], s20 offen offset:1024
  buffer_store_dwordx4 v[4:7], v3, s[4:7], s20 offen offset:2048
  buffer_store_dwordx4 v[4:7], v3, s[4:7], s20 offen offset:3072
  s_add_u32 s20, s20, 4096
  buffer_store_dwordx4 v[4:7], v3, s[4:7], s20 offen offset:0
  buffer_store_dwordx4 v[4:7], v3, s[4:7], s20 offen offset:1024
  buffer_store_dwordx4 v[4:7], v3, s[4:7], s20 offen offset:2048
  buffer_store_dwordx4 v[4:7], v3, s[4:7], s20 offen offset:3072
  s_add_u32 s20, s20, 4096
  buffer_store_dwordx4 v[4:7], v3, s[4:7], s20 offen offset:0
  buffer_store_dwordx4 v[4:7], v3, s[4:7], s20 offen offset:1024
  buffer_store_dwordx4 v[4:7], v3, s[4:7], s20 offen offset:2048
  buffer_store_dwordx4 v[4:7], v3, s[4:7], s20 offen offset:3072
  s_add_u32 s20, s20, 4096
  buffer_store_dwordx4 v[4:7], v3, s[4:7], s20 offen offset:0
  buffer_store_dwordx4 v[4:7], v3, s[4:7], s20 offen offset:1024
  buffer_store_dwordx4 v[4:7], v3, s[4:7], s20 offen offset:2048
  buffer_store_dwordx4 v[4:7], v3, s[4:7], s20 offen offset:3072
  s_endpgm
prep_nothb:
  s_cmp_ge_u32 s2, 654
  s_cbranch_scc1 prep_end
  s_sub_u32 s2, s2, 608
  s_lshl_b32 s20, s2, 14
  s_add_u32 s21, s20, 56360960
  s_add_u32 s22, s20, 96501760
  s_add_u32 s23, s20, 66519040
  s_cmp_lt_u32 s2, 20
  s_cselect_b32 s20, s21, s22
  s_cmp_lt_u32 s2, 40
  s_cselect_b32 s20, s20, s23
  s_cselect_b32 s21, -1, 0
  v_mov_b32 v4, s21
  v_mov_b32 v5, s21
  v_mov_b32 v6, s21
  v_mov_b32 v7, s21
  buffer_store_dwordx4 v[4:7], v3, s[4:7], s20 offen offset:0
  buffer_store_dwordx4 v[4:7], v3, s[4:7], s20 offen offset:1024
  buffer_store_dwordx4 v[4:7], v3, s[4:7], s20 offen offset:2048
  buffer_store_dwordx4 v[4:7], v3, s[4:7], s20 offen offset:3072
  s_add_u32 s20, s20, 4096
  buffer_store_dwordx4 v[4:7], v3, s[4:7], s20 offen offset:0
  buffer_store_dwordx4 v[4:7], v3, s[4:7], s20 offen offset:1024
  buffer_store_dwordx4 v[4:7], v3, s[4:7], s20 offen offset:2048
  buffer_store_dwordx4 v[4:7], v3, s[4:7], s20 offen offset:3072
  s_add_u32 s20, s20, 4096
  buffer_store_dwordx4 v[4:7], v3, s[4:7], s20 offen offset:0
  buffer_store_dwordx4 v[4:7], v3, s[4:7], s20 offen offset:1024
  buffer_store_dwordx4 v[4:7], v3, s[4:7], s20 offen offset:2048
  buffer_store_dwordx4 v[4:7], v3, s[4:7], s20 offen offset:3072
  s_add_u32 s20, s20, 4096
  buffer_store_dwordx4 v[4:7], v3, s[4:7], s20 offen offset:0
  buffer_store_dwordx4 v[4:7], v3, s[4:7], s20 offen offset:1024
  buffer_store_dwordx4 v[4:7], v3, s[4:7], s20 offen offset:2048
  buffer_store_dwordx4 v[4:7], v3, s[4:7], s20 offen offset:3072
prep_end:
  s_endpgm

.globl mega0_kernel
.p2align 8
.type mega0_kernel,@function
mega0_kernel:
  s_mov_b32 s70, 0
mega_common:
  s_load_dwordx2 s[4:5], s[0:1], 104
  s_mov_b32 s6, 0x10000000
  s_mov_b32 s7, 0x20000
  s_load_dwordx2 s[44:45], s[0:1], 96
  s_mov_b32 s46, 0x100
  s_mov_b32 s47, 0x20000
  s_load_dwordx2 s[84:85], s[0:1], 0
  s_mov_b32 s86, 0x280000
  s_mov_b32 s87, 0x20000
  s_load_dwordx8 s[8:15], s[0:1], 16
  s_mov_b32 s94, 0x780000
  s_mov_b32 s95, 0x20000
  s_mov_b32 s98, 0x780000
  s_mov_b32 s99, 0x20000
  s_mov_b32 s82, -1
  s_mov_b32 s83, 0x0fffffff
  v_lshrrev_b32 v1, 6, v0
  s_nop 0
  v_readfirstlane_b32 s3, v1
  v_and_b32 v1, 63, v0
  s_mov_b32 s79, s2
  s_cmp_ge_u32 s2, 256
  s_cbranch_scc1 mega_end
  s_mul_i32 s71, s70, 49152
  s_add_u32 s71, s71, 67174400
  s_and_b32 s68, s2, 7
  s_waitcnt lgkmcnt(0)
  s_add_u32 s16, s4, 50790400
  s_addc_u32 s17, s5, 0
  s_cmp_eq_u32 s70, 0
  s_cselect_b32 s84, s84, s16
  s_cselect_b32 s85, s85, s17
  s_bfe_u32 s81, s2, 0x20005
  s_mov_b64 s[92:93], s[8:9]
  s_mov_b64 s[96:97], s[10:11]
  s_cmp_lt_u32 s2, 128
  s_cselect_b32 s16, 2, s81
  s_cmp_eq_u32 s16, 0
  s_cselect_b64 s[92:93], s[10:11], s[92:93]
  s_cmp_eq_u32 s16, 1
  s_cselect_b64 s[92:93], s[12:13], s[92:93]
  s_cmp_eq_u32 s16, 3
  s_cselect_b64 s[92:93], s[14:15], s[92:93]
  s_getreg_b32 s27, hwreg(HW_REG_XCC_ID)
  s_and_b32 s27, s27, 7
  s_mul_i32 s28, s27, s27
  s_lshl_b32 s28, s28, 14
  s_lshl_b32 s27, s27, 6
  s_add_u32 s27, s27, s28
  s_add_u32 s27, s27, 1
  s_lshl_b32 s69, s27, 5
  s_lshl_b32 s29, s68, 2
  s_cmp_lg_u32 s3, 0
  s_cbranch_scc1 mega_noatom
  v_mov_b32 v15, 0
  v_mov_b32 v14, s27
  s_mov_b64 exec, 1
  buffer_atomic_add v14, v15, s[44:47], s29 offen sc1
  s_mov_b64 exec, -1
mega_noatom:
  s_cmp_lt_u32 s2, 128
  s_cbranch_scc1 mega_rec
  s_lshl_b32 s8, s68, 2
  s_bfe_u32 s9, s2, 0x20003
  s_add_u32 s80, s8, s9
  s_mul_i32 s78, s68, 1302528
  s_add_u32 s78, s78, 28835840
  s_cmp_eq_u32 s81, 2
  s_cbranch_scc1 mega_qrole
  s_cmp_eq_u32 s81, 3
  s_cbranch_scc1 mega_urole
  v_lshlrev_b32 v2, 4, v1
  v_mov_b32 v7, 0
  s_mul_i32 s10, s80, 384
  s_mul_i32 s11, s3, 96
  s_add_u32 s10, s10, s11
  s_mul_i32 s11, s3, 30720
  s_add_u32 s11, s11, 40960
  v_mul_u32_u24 v18, 10923, v1
  v_lshrrev_b32 v18, 16, v18
  v_mul_u32_u24 v16, 6, v18
  v_sub_u32 v16, v1, v16
  v_lshlrev_b32 v16, 4, v16
  v_mul_u32_u24 v18, 12288, v18
  v_add_u32 v16, v16, v18
  v_lshrrev_b32 v18, 4, v1
  v_mul_u32_u24 v18, 8, v18
  v_bfe_u32 v17, v1, 2, 2
  v_add_u32 v18, v18, v17
  v_mul_u32_u24 v18, 96, v18
  v_and_b32 v17, 3, v1
  v_lshl_add_u32 v17, v17, 3, v18
  v_add_u32 v17, s11, v17
  s_mul_i32 s13, s3, 10240
  s_add_u32 s12, s13, 26214400
  s_lshl_b32 s15, s3, 10
  v_add_u32 v3, s15, v2
  s_and_b32 s9, s80, 3
  s_add_u32 m0, s13, 0
  s_add_u32 s18, s12, 0
  buffer_load_dwordx4 v2, s[4:7], s18 offen offset:0 lds
  buffer_load_dwordx4 v2, s[4:7], s18 offen offset:1024 lds
  buffer_load_dwordx4 v2, s[4:7], s18 offen offset:2048 lds
  buffer_load_dwordx4 v2, s[4:7], s18 offen offset:3072 lds
  s_add_u32 m0, s13, 4096
  s_add_u32 s18, s12, 4096
  buffer_load_dwordx4 v2, s[4:7], s18 offen offset:0 lds
  buffer_load_dwordx4 v2, s[4:7], s18 offen offset:1024 lds
  buffer_load_dwordx4 v2, s[4:7], s18 offen offset:2048 lds
  buffer_load_dwordx4 v2, s[4:7], s18 offen offset:3072 lds
  s_add_u32 m0, s13, 8192
  s_add_u32 s18, s12, 8192
  buffer_load_dwordx4 v2, s[4:7], s18 offen offset:0 lds
  buffer_load_dwordx4 v2, s[4:7], s18 offen offset:1024 lds
  s_add_u32 s12, s12, 40960
  s_add_u32 s13, s13, 40960
  s_mov_b32 s19, 40960
  s_mov_b64 exec, s[82:83]
  s_add_u32 m0, s11, 0
  s_nop 0
  buffer_load_dwordx4 v16, s[92:95], s10 offen lds
  s_add_u32 s10, s10, 122880
  s_add_u32 m0, s11, 960
  s_nop 0
  buffer_load_dwordx4 v16, s[92:95], s10 offen lds
  s_add_u32 s10, s10, 122880
  s_add_u32 m0, s11, 1920
  s_nop 0
  buffer_load_dwordx4 v16, s[92:95], s10 offen lds
  s_add_u32 s10, s10, 122880
  s_add_u32 m0, s11, 2880
  s_nop 0
  buffer_load_dwordx4 v16, s[92:95], s10 offen lds
  s_add_u32 s10, s10, 122880
  s_add_u32 m0, s11, 3840
  s_nop 0
  buffer_load_dwordx4 v16, s[92:95], s10 offen lds
  s_add_u32 s10, s10, 122880
  s_add_u32 m0, s11, 4800
  s_nop 0
  buffer_load_dwordx4 v16, s[92:95], s10 offen lds
  s_add_u32 s10, s10, 122880
  s_add_u32 m0, s11, 5760
  s_nop 0
  buffer_load_dwordx4 v16, s[92:95], s10 offen lds
  s_add_u32 s10, s10, 122880
  s_add_u32 m0, s11, 6720
  s_nop 0
  buffer_load_dwordx4 v16, s[92:95], s10 offen lds
  s_add_u32 s10, s10, 122880
  s_add_u32 m0, s11, 7680
  s_nop 0
  buffer_load_dwordx4 v16, s[92:95], s10 offen lds
  s_add_u32 s10, s10, 122880
  s_add_u32 m0, s11, 8640
  s_nop 0
  buffer_load_dwordx4 v16, s[92:95], s10 offen lds
  s_add_u32 s10, s10, 122880
  s_add_u32 m0, s11, 9600
  s_nop 0
  buffer_load_dwordx4 v16, s[92:95], s10 offen lds
  s_add_u32 s10, s10, 122880
  s_add_u32 m0, s11, 10560
  s_nop 0
  buffer_load_dwordx4 v16, s[92:95], s10 offen lds
  s_add_u32 s10, s10, 122880
  s_add_u32 m0, s11, 11520
  s_nop 0
  buffer_load_dwordx4 v16, s[92:95], s10 offen lds
  s_add_u32 s10, s10, 122880
  s_add_u32 m0, s11, 12480
  s_nop 0
  buffer_load_dwordx4 v16, s[92:95], s10 offen lds
  s_add_u32 s10, s10, 122880
  s_add_u32 m0, s11, 13440
  s_nop 0
  buffer_load_dwordx4 v16, s[92:95], s10 offen lds
  s_add_u32 s10, s10, 122880
  s_add_u32 m0, s11, 14400
  s_nop 0
  buffer_load_dwordx4 v16, s[92:95], s10 offen lds
  s_add_u32 s10, s10, 122880
  s_add_u32 m0, s11, 15360
  s_nop 0
  buffer_load_dwordx4 v16, s[92:95], s10 offen lds
  s_add_u32 s10, s10, 122880
  s_add_u32 m0, s11, 16320
  s_nop 0
  buffer_load_dwordx4 v16, s[92:95], s10 offen lds
  s_add_u32 s10, s10, 122880
  s_add_u32 m0, s11, 17280
  s_nop 0
  buffer_load_dwordx4 v16, s[92:95], s10 offen lds
  s_add_u32 s10, s10, 122880
  s_add_u32 m0, s11, 18240
  s_nop 0
  buffer_load_dwordx4 v16, s[92:95], s10 offen lds
  s_add_u32 s10, s10, 122880
  s_add_u32 m0, s11, 19200
  s_nop 0
  buffer_load_dwordx4 v16, s[92:95], s10 offen lds
  s_add_u32 s10, s10, 122880
  s_add_u32 m0, s11, 20160
  s_nop 0
  buffer_load_dwordx4 v16, s[92:95], s10 offen lds
  s_add_u32 s10, s10, 122880
  s_add_u32 m0, s11, 21120
  s_nop 0
  buffer_load_dwordx4 v16, s[92:95], s10 offen lds
  s_add_u32 s10, s10, 122880
  s_add_u32 m0, s11, 22080
  s_nop 0
  buffer_load_dwordx4 v16, s[92:95], s10 offen lds
  s_add_u32 s10, s10, 122880
  s_add_u32 m0, s11, 23040
  s_nop 0
  buffer_load_dwordx4 v16, s[92:95], s10 offen lds
  s_add_u32 s10, s10, 122880
  s_add_u32 m0, s11, 24000
  s_nop 0
  buffer_load_dwordx4 v16, s[92:95], s10 offen lds
  s_add_u32 s10, s10, 122880
  s_add_u32 m0, s11, 24960
  s_nop 0
  buffer_load_dwordx4 v16, s[92:95], s10 offen lds
  s_add_u32 s10, s10, 122880
  s_add_u32 m0, s11, 25920
  s_nop 0
  buffer_load_dwordx4 v16, s[92:95], s10 offen lds
  s_add_u32 s10, s10, 122880
  s_add_u32 m0, s11, 26880
  s_nop 0
  buffer_load_dwordx4 v16, s[92:95], s10 offen lds
  s_add_u32 s10, s10, 122880
  s_add_u32 m0, s11, 27840
  s_nop 0
  buffer_load_dwordx4 v16, s[92:95], s10 offen lds
  s_add_u32 s10, s10, 122880
  s_add_u32 m0, s11, 28800
  s_nop 0
  buffer_load_dwordx4 v16, s[92:95], s10 offen lds
  s_add_u32 s10, s10, 122880
  s_add_u32 m0, s11, 29760
  s_nop 0
  buffer_load_dwordx4 v16, s[92:95], s10 offen lds
  s_add_u32 s10, s10, 122880
  s_mov_b64 exec, -1
  s_waitcnt vmcnt(28)
  ds_read_b64_tr_b16 a[0:1], v17 offset:0
  ds_read_b64_tr_b16 a[2:3], v17 offset:384
  ds_read_b64_tr_b16 a[80:81], v17 offset:32
  ds_read_b64_tr_b16 a[82:83], v17 offset:416
  ds_read_b64_tr_b16 a[160:161], v17 offset:64
  ds_read_b64_tr_b16 a[162:163], v17 offset:448
  s_waitcnt lgkmcnt(0)
  s_mov_b64 exec, s[82:83]
  s_add_u32 m0, s11, 0
  s_nop 0
  buffer_load_dwordx4 v16, s[92:95], s10 offen lds
  s_add_u32 s10, s10, 122880
  s_add_u32 m0, s11, 960
  s_nop 0
  buffer_load_dwordx4 v16, s[92:95], s10 offen lds
  s_add_u32 s10, s10, 122880
  s_add_u32 m0, s11, 1920
  s_nop 0
  buffer_load_dwordx4 v16, s[92:95], s10 offen lds
  s_add_u32 s10, s10, 122880
  s_mov_b64 exec, -1
  s_waitcnt vmcnt(28)
  ds_read_b64_tr_b16 a[4:5], v17 offset:3072
  ds_read_b64_tr_b16 a[6:7], v17 offset:3456
  ds_read_b64_tr_b16 a[84:85], v17 offset:3104
  ds_read_b64_tr_b16 a[86:87], v17 offset:3488
  ds_read_b64_tr_b16 a[164:165], v17 offset:3136
  ds_read_b64_tr_b16 a[166:167], v17 offset:3520
  s_waitcnt lgkmcnt(0)
  s_mov_b64 exec, s[82:83]
  s_add_u32 m0, s11, 2880
  s_nop 0
  buffer_load_dwordx4 v16, s[92:95], s10 offen lds
  s_add_u32 s10, s10, 122880
  s_add_u32 m0, s11, 3840
  s_nop 0
  buffer_load_dwordx4 v16, s[92:95], s10 offen lds
  s_add_u32 s10, s10, 122880
  s_add_u32 m0, s11, 4800
  s_nop 0
  buffer_load_dwordx4 v16, s[92:95], s10 offen lds
  s_add_u32 s10, s10, 122880
  s_mov_b64 exec, -1
  s_waitcnt vmcnt(28)
  ds_read_b64_tr_b16 a[8:9], v17 offset:6144
  ds_read_b64_tr_b16 a[10:11], v17 offset:6528
  ds_read_b64_tr_b16 a[88:89], v17 offset:6176
  ds_read_b64_tr_b16 a[90:91], v17 offset:6560
  ds_read_b64_tr_b16 a[168:169], v17 offset:6208
  ds_read_b64_tr_b16 a[170:171], v17 offset:6592
  s_waitcnt lgkmcnt(0)
  s_mov_b64 exec, s[82:83]
  s_add_u32 m0, s11, 5760
  s_nop 0
  buffer_load_dwordx4 v16, s[92:95], s10 offen lds
  s_add_u32 s10, s10, 122880
  s_add_u32 m0, s11, 6720
  s_nop 0
  buffer_load_dwordx4 v16, s[92:95], s10 offen lds
  s_add_u32 s10, s10, 122880
  s_add_u32 m0, s11, 7680
  s_nop 0
  buffer_load_dwordx4 v16, s[92:95], s10 offen lds
  s_add_u32 s10, s10, 122880
  s_mov_b64 exec, -1
  s_waitcnt vmcnt(28)
  ds_read_b64_tr_b16 a[12:13], v17 offset:9216
  ds_read_b64_tr_b16 a[14:15], v17 offset:9600
  ds_read_b64_tr_b16 a[92:93], v17 offset:9248
  ds_read_b64_tr_b16 a[94:95], v17 offset:9632
  ds_read_b64_tr_b16 a[172:173], v17 offset:9280
  ds_read_b64_tr_b16 a[174:175], v17 offset:9664
  s_waitcnt lgkmcnt(0)
  s_mov_b64 exec, s[82:83]
  s_add_u32 m0, s11, 8640
  s_nop 0
  buffer_load_dwordx4 v16, s[92:95], s10 offen lds
  s_add_u32 s10, s10, 122880
  s_add_u32 m0, s11, 9600
  s_nop 0
  buffer_load_dwordx4 v16, s[92:95], s10 offen lds
  s_add_u32 s10, s10, 122880
  s_add_u32 m0, s11, 10560
  s_nop 0
  buffer_load_dwordx4 v16, s[92:95], s10 offen lds
  s_add_u32 s10, s10, 122880
  s_mov_b64 exec, -1
  s_waitcnt vmcnt(28)
  ds_read_b64_tr_b16 a[16:17], v17 offset:12288
  ds_read_b64_tr_b16 a[18:19], v17 offset:12672
  ds_read_b64_tr_b16 a[96:97], v17 offset:12320
  ds_read_b64_tr_b16 a[98:99], v17 offset:12704
  ds_read_b64_tr_b16 a[176:177], v17 offset:12352
  ds_read_b64_tr_b16 a[178:179], v17 offset:12736
  s_waitcnt lgkmcnt(0)
  s_mov_b64 exec, s[82:83]
  s_add_u32 m0, s11, 11520
  s_nop 0
  buffer_load_dwordx4 v16, s[92:95], s10 offen lds
  s_add_u32 s10, s10, 122880
  s_add_u32 m0, s11, 12480
  s_nop 0
  buffer_load_dwordx4 v16, s[92:95], s10 offen lds
  s_add_u32 s10, s10, 122880
  s_add_u32 m0, s11, 13440
  s_nop 0
  buffer_load_dwordx4 v16, s[92:95], s10 offen lds
  s_add_u32 s10, s10, 122880
  s_add_u32 m0, s11, 14400
  s_nop 0
  buffer_load_dwordx4 v16, s[92:95], s10 offen lds
  s_add_u32 s10, s10, 122880
  s_mov_b64 exec, -1
  s_waitcnt vmcnt(28)
  ds_read_b64_tr_b16 a[20:21], v17 offset:15360
  ds_read_b64_tr_b16 a[22:23], v17 offset:15744
  ds_read_b64_tr_b16 a[100:101], v17 offset:15392
  ds_read_b64_tr_b16 a[102:103], v17 offset:15776
  ds_read_b64_tr_b16 a[180:181], v17 offset:15424
  ds_read_b64_tr_b16 a[182:183], v17 offset:15808
  s_waitcnt lgkmcnt(0)
  s_mov_b64 exec, s[82:83]
  s_add_u32 m0, s11, 15360
  s_nop 0
  buffer_load_dwordx4 v16, s[92:95], s10 offen lds
  s_add_u32 s10, s10, 122880
  s_add_u32 m0, s11, 16320
  s_nop 0
  buffer_load_dwordx4 v16, s[92:95], s10 offen lds
  s_add_u32 s10, s10, 122880
  s_add_u32 m0, s11, 17280
  s_nop 0
  buffer_load_dwordx4 v16, s[92:95], s10 offen lds
  s_add_u32 s10, s10, 122880
  s_mov_b64 exec, -1
  s_waitcnt vmcnt(28)
  ds_read_b64_tr_b16 a[24:25], v17 offset:18432
  ds_read_b64_tr_b16 a[26:27], v17 offset:18816
  ds_read_b64_tr_b16 a[104:105], v17 offset:18464
  ds_read_b64_tr_b16 a[106:107], v17 offset:18848
  ds_read_b64_tr_b16 a[184:185], v17 offset:18496
  ds_read_b64_tr_b16 a[186:187], v17 offset:18880
  s_waitcnt lgkmcnt(0)
  s_mov_b64 exec, s[82:83]
  s_add_u32 m0, s11, 18240
  s_nop 0
  buffer_load_dwordx4 v16, s[92:95], s10 offen lds
  s_add_u32 s10, s10, 122880
  s_add_u32 m0, s11, 19200
  s_nop 0
  buffer_load_dwordx4 v16, s[92:95], s10 offen lds
  s_add_u32 s10, s10, 122880
  s_add_u32 m0, s11, 20160
  s_nop 0
  buffer_load_dwordx4 v16, s[92:95], s10 offen lds
  s_add_u32 s10, s10, 122880
  s_mov_b64 exec, -1
  s_waitcnt vmcnt(28)
  ds_read_b64_tr_b16 a[28:29], v17 offset:21504
  ds_read_b64_tr_b16 a[30:31], v17 offset:21888
  ds_read_b64_tr_b16 a[108:109], v17 offset:21536
  ds_read_b64_tr_b16 a[110:111], v17 offset:21920
  ds_read_b64_tr_b16 a[188:189], v17 offset:21568
  ds_read_b64_tr_b16 a[190:191], v17 offset:21952
  s_waitcnt lgkmcnt(0)
  s_mov_b64 exec, s[82:83]
  s_add_u32 m0, s11, 21120
  s_nop 0
  buffer_load_dwordx4 v16, s[92:95], s10 offen lds
  s_add_u32 s10, s10, 122880
  s_add_u32 m0, s11, 22080
  s_nop 0
  buffer_load_dwordx4 v16, s[92:95], s10 offen lds
  s_add_u32 s10, s10, 122880
  s_add_u32 m0, s11, 23040
  s_nop 0
  buffer_load_dwordx4 v16, s[92:95], s10 offen lds
  s_add_u32 s10, s10, 122880
  s_mov_b64 exec, -1
  s_waitcnt vmcnt(28)
  ds_read_b64_tr_b16 a[32:33], v17 offset:24576
  ds_read_b64_tr_b16 a[34:35], v17 offset:24960
  ds_read_b64_tr_b16 a[112:113], v17 offset:24608
  ds_read_b64_tr_b16 a[114:115], v17 offset:24992
  ds_read_b64_tr_b16 a[192:193], v17 offset:24640
  ds_read_b64_tr_b16 a[194:195], v17 offset:25024
  s_waitcnt lgkmcnt(0)
  s_mov_b64 exec, s[82:83]
  s_add_u32 m0, s11, 24000
  s_nop 0
  buffer_load_dwordx4 v16, s[92:95], s10 offen lds
  s_add_u32 s10, s10, 122880
  s_add_u32 m0, s11, 24960
  s_nop 0
  buffer_load_dwordx4 v16, s[92:95], s10 offen lds
  s_add_u32 s10, s10, 122880
  s_add_u32 m0, s11, 25920
  s_nop 0
  buffer_load_dwordx4 v16, s[92:95], s10 offen lds
  s_add_u32 s10, s10, 122880
  s_mov_b64 exec, -1
  s_waitcnt vmcnt(28)
  ds_read_b64_tr_b16 a[36:37], v17 offset:27648
  ds_read_b64_tr_b16 a[38:39], v17 offset:28032
  ds_read_b64_tr_b16 a[116:117], v17 offset:27680
  ds_read_b64_tr_b16 a[118:119], v17 offset:28064
  ds_read_b64_tr_b16 a[196:197], v17 offset:27712
  ds_read_b64_tr_b16 a[198:199], v17 offset:28096
  s_waitcnt lgkmcnt(0)
  s_mov_b64 exec, s[82:83]
  s_add_u32 m0, s11, 26880
  s_nop 0
  buffer_load_dwordx4 v16, s[92:95], s10 offen lds
  s_add_u32 s10, s10, 122880
  s_add_u32 m0, s11, 27840
  s_nop 0
  buffer_load_dwordx4 v16, s[92:95], s10 offen lds
  s_add_u32 s10, s10, 122880
  s_add_u32 m0, s11, 28800
  s_nop 0
  buffer_load_dwordx4 v16, s[92:95], s10 offen lds
  s_add_u32 s10, s10, 122880
  s_add_u32 m0, s11, 29760
  s_nop 0
  buffer_load_dwordx4 v16, s[92:95], s10 offen lds
  s_add_u32 s10, s10, 122880
  s_mov_b64 exec, -1
  s_waitcnt vmcnt(28)
  ds_read_b64_tr_b16 a[40:41], v17 offset:0
  ds_read_b64_tr_b16 a[42:43], v17 offset:384
  ds_read_b64_tr_b16 a[120:121], v17 offset:32
  ds_read_b64_tr_b16 a[122:123], v17 offset:416
  ds_read_b64_tr_b16 a[200:201], v17 offset:64
  ds_read_b64_tr_b16 a[202:203], v17 offset:448
  s_waitcnt vmcnt(25)
  ds_read_b64_tr_b16 a[44:45], v17 offset:3072
  ds_read_b64_tr_b16 a[46:47], v17 offset:3456
  ds_read_b64_tr_b16 a[124:125], v17 offset:3104
  ds_read_b64_tr_b16 a[126:127], v17 offset:3488
  ds_read_b64_tr_b16 a[204:205], v17 offset:3136
  ds_read_b64_tr_b16 a[206:207], v17 offset:3520
  s_waitcnt vmcnt(22)
  ds_read_b64_tr_b16 a[48:49], v17 offset:6144
  ds_read_b64_tr_b16 a[50:51], v17 offset:6528
  ds_read_b64_tr_b16 a[128:129], v17 offset:6176
  ds_read_b64_tr_b16 a[130:131], v17 offset:6560
  ds_read_b64_tr_b16 a[208:209], v17 offset:6208
  ds_read_b64_tr_b16 a[210:211], v17 offset:6592
  s_waitcnt vmcnt(19)
  ds_read_b64_tr_b16 a[52:53], v17 offset:9216
  ds_read_b64_tr_b16 a[54:55], v17 offset:9600
  ds_read_b64_tr_b16 a[132:133], v17 offset:9248
  ds_read_b64_tr_b16 a[134:135], v17 offset:9632
  ds_read_b64_tr_b16 a[212:213], v17 offset:9280
  ds_read_b64_tr_b16 a[214:215], v17 offset:9664
  s_waitcnt vmcnt(16)
  ds_read_b64_tr_b16 a[56:57], v17 offset:12288
  ds_read_b64_tr_b16 a[58:59], v17 offset:12672
  ds_read_b64_tr_b16 a[136:137], v17 offset:12320
  ds_read_b64_tr_b16 a[138:139], v17 offset:12704
  ds_read_b64_tr_b16 a[216:217], v17 offset:12352
  ds_read_b64_tr_b16 a[218:219], v17 offset:12736
  s_waitcnt vmcnt(12)
  ds_read_b64_tr_b16 a[60:61], v17 offset:15360
  ds_read_b64_tr_b16 a[62:63], v17 offset:15744
  ds_read_b64_tr_b16 a[140:141], v17 offset:15392
  ds_read_b64_tr_b16 a[142:143], v17 offset:15776
  ds_read_b64_tr_b16 a[220:221], v17 offset:15424
  ds_read_b64_tr_b16 a[222:223], v17 offset:15808
  s_waitcnt vmcnt(9)
  ds_read_b64_tr_b16 a[64:65], v17 offset:18432
  ds_read_b64_tr_b16 a[66:67], v17 offset:18816
  ds_read_b64_tr_b16 a[144:145], v17 offset:18464
  ds_read_b64_tr_b16 a[146:147], v17 offset:18848
  ds_read_b64_tr_b16 a[224:225], v17 offset:18496
  ds_read_b64_tr_b16 a[226:227], v17 offset:18880
  s_waitcnt vmcnt(6)
  ds_read_b64_tr_b16 a[68:69], v17 offset:21504
  ds_read_b64_tr_b16 a[70:71], v17 offset:21888
  ds_read_b64_tr_b16 a[148:149], v17 offset:21536
  ds_read_b64_tr_b16 a[150:151], v17 offset:21920
  ds_read_b64_tr_b16 a[228:229], v17 offset:21568
  ds_read_b64_tr_b16 a[230:231], v17 offset:21952
  s_waitcnt vmcnt(3)
  ds_read_b64_tr_b16 a[72:73], v17 offset:24576
  ds_read_b64_tr_b16 a[74:75], v17 offset:24960
  ds_read_b64_tr_b16 a[152:153], v17 offset:24608
  ds_read_b64_tr_b16 a[154:155], v17 offset:24992
  ds_read_b64_tr_b16 a[232:233], v17 offset:24640
  ds_read_b64_tr_b16 a[234:235], v17 offset:25024
  s_waitcnt vmcnt(0)
  ds_read_b64_tr_b16 a[76:77], v17 offset:27648
  ds_read_b64_tr_b16 a[78:79], v17 offset:28032
  ds_read_b64_tr_b16 a[156:157], v17 offset:27680
  ds_read_b64_tr_b16 a[158:159], v17 offset:28064
  ds_read_b64_tr_b16 a[236:237], v17 offset:27712
  ds_read_b64_tr_b16 a[238:239], v17 offset:28096
  s_waitcnt lgkmcnt(0)
  s_lshl_b32 s28, s68, 2
  v_mov_b32 v17, s28
  s_mov_b32 s28, 0
mega0_kernel_cen1:
  buffer_load_dword v16, v17, s[44:47], 0 offen sc1
  s_waitcnt vmcnt(0)
  v_readfirstlane_b32 s26, v16
  s_nop 0
  s_and_b32 s27, s26, 63
  s_cmp_eq_u32 s27, 32
  s_cbranch_scc1 mega0_kernel_cen1_done
  s_sleep 4
  s_add_u32 s28, s28, 1
  s_cmp_lt_u32 s28, 262144
  s_cbranch_scc1 mega0_kernel_cen1
  s_branch mega_fail
mega0_kernel_cen1_done:
  s_cmp_eq_u32 s26, s69
  s_cselect_b32 s69, 0, 1
  v_mov_b32 v5, v2
  s_mov_b32 s24, 0
  v_add_u32 v4, 4096, v3
  v_add_u32 v9, 8192, v3
  s_mul_i32 s14, s81, 49152
  s_mul_i32 s15, s9, 12288
  s_add_u32 s14, s14, s15
  s_add_u32 s14, s14, s78
  s_add_u32 s14, s14, 204800
  s_mov_b32 s20, 0
  s_mul_i32 s48, s81, 976896
  s_lshl_b32 s25, s81, 12
  s_lshl_b32 s15, s80, 7
  s_add_u32 s25, s25, s15
  s_lshl_b32 s15, s3, 2
  s_add_u32 s25, s25, s15
  s_add_u32 s25, s25, s71
  s_mul_i32 s23, s3, 3072
  s_add_u32 s29, s23, s78
  s_add_u32 s29, s29, 315392
  s_add_u32 s23, s23, 81920
  s_mul_i32 s15, s81, 3
  s_add_u32 s15, s15, s3
  s_lshl_b32 s16, s81, 1
  s_add_u32 s16, s16, 3
  s_mul_i32 s26, s9, 5
  s_add_u32 s26, s26, s15
  s_add_u32 s49, s81, 4
  s_cmp_lt_u32 s15, s16
  s_cselect_b32 s21, s49, 64
  s_cselect_b32 s22, 1, 0
  s_lshl_b32 s16, s9, 3
  s_add_u32 s16, s16, s15
  s_cmp_eq_u32 s16, 6
  s_cselect_b32 s27, 4, s9
  s_cselect_b32 s15, 5, s15
  s_cmp_eq_u32 s15, 5
  s_cselect_b32 s21, 10, s21
  s_cselect_b32 s22, 2, s22
mega_kv_loop:
  s_barrier
  ds_read_b128 v[16:19], v5 offset:0
  ds_read_b128 v[20:23], v5 offset:20480
  ds_read_b128 v[24:27], v5 offset:1024
  ds_read_b128 v[28:31], v5 offset:21504
  ds_read_b128 v[32:35], v5 offset:2048
  ds_read_b128 v[36:39], v5 offset:22528
  s_waitcnt lgkmcnt(4)
  v_mfma_f32_16x16x32_bf16 v[48:51], a[0:3], v[16:19], 0
  ds_read_b128 v[40:43], v5 offset:3072
  v_mfma_f32_16x16x32_bf16 v[52:55], a[80:83], v[16:19], 0
  s_mov_b32 m0, s23
  s_add_u32 s18, s29, s48
  buffer_load_dwordx4 v2, s[4:7], s18 offen sc1 lds
  v_mfma_f32_16x16x32_bf16 v[56:59], a[160:163], v[16:19], 0
  v_mfma_f32_16x16x32_bf16 v[60:63], a[0:3], v[20:23], 0
  ds_read_b128 v[44:47], v5 offset:23552
  v_mfma_f32_16x16x32_bf16 v[64:67], a[80:83], v[20:23], 0
  s_add_u32 s17, s14, s20
  buffer_load_dwordx4 v2, s[4:7], s18 offen offset:1024 sc1 lds
  v_mfma_f32_16x16x32_bf16 v[68:71], a[160:163], v[20:23], 0
  s_waitcnt lgkmcnt(4)
  v_mfma_f32_16x16x32_bf16 v[48:51], a[4:7], v[24:27], v[48:51]
  ds_read_b128 v[16:19], v5 offset:4096
  v_mfma_f32_16x16x32_bf16 v[52:55], a[84:87], v[24:27], v[52:55]
  buffer_load_dwordx4 v2, s[4:7], s18 offen offset:2048 sc1 lds
  v_mfma_f32_16x16x32_bf16 v[56:59], a[164:167], v[24:27], v[56:59]
  v_mfma_f32_16x16x32_bf16 v[60:63], a[4:7], v[28:31], v[60:63]
  ds_read_b128 v[20:23], v5 offset:24576
  v_mfma_f32_16x16x32_bf16 v[64:67], a[84:87], v[28:31], v[64:67]
  v_mfma_f32_16x16x32_bf16 v[68:71], a[164:167], v[28:31], v[68:71]
  s_waitcnt lgkmcnt(4)
  v_mfma_f32_16x16x32_bf16 v[48:51], a[8:11], v[32:35], v[48:51]
  ds_read_b128 v[24:27], v5 offset:5120
  v_mfma_f32_16x16x32_bf16 v[52:55], a[88:91], v[32:35], v[52:55]
  v_mfma_f32_16x16x32_bf16 v[56:59], a[168:171], v[32:35], v[56:59]
  v_mfma_f32_16x16x32_bf16 v[60:63], a[8:11], v[36:39], v[60:63]
  ds_read_b128 v[28:31], v5 offset:25600
  v_mfma_f32_16x16x32_bf16 v[64:67], a[88:91], v[36:39], v[64:67]
  v_mfma_f32_16x16x32_bf16 v[68:71], a[168:171], v[36:39], v[68:71]
  s_waitcnt lgkmcnt(4)
  v_mfma_f32_16x16x32_bf16 v[48:51], a[12:15], v[40:43], v[48:51]
  ds_read_b128 v[32:35], v5 offset:6144
  v_mfma_f32_16x16x32_bf16 v[52:55], a[92:95], v[40:43], v[52:55]
  v_mfma_f32_16x16x32_bf16 v[56:59], a[172:175], v[40:43], v[56:59]
  v_mfma_f32_16x16x32_bf16 v[60:63], a[12:15], v[44:47], v[60:63]
  ds_read_b128 v[36:39], v5 offset:26624
  v_mfma_f32_16x16x32_bf16 v[64:67], a[92:95], v[44:47], v[64:67]
  v_mfma_f32_16x16x32_bf16 v[68:71], a[172:175], v[44:47], v[68:71]
  s_waitcnt lgkmcnt(4)
  v_mfma_f32_16x16x32_bf16 v[48:51], a[16:19], v[16:19], v[48:51]
  ds_read_b128 v[40:43], v5 offset:7168
  v_mfma_f32_16x16x32_bf16 v[52:55], a[96:99], v[16:19], v[52:55]
  v_mfma_f32_16x16x32_bf16 v[56:59], a[176:179], v[16:19], v[56:59]
  v_mfma_f32_16x16x32_bf16 v[60:63], a[16:19], v[20:23], v[60:63]
  ds_read_b128 v[44:47], v5 offset:27648
  v_mfma_f32_16x16x32_bf16 v[64:67], a[96:99], v[20:23], v[64:67]
  v_mfma_f32_16x16x32_bf16 v[68:71], a[176:179], v[20:23], v[68:71]
  s_waitcnt lgkmcnt(4)
  v_mfma_f32_16x16x32_bf16 v[48:51], a[20:23], v[24:27], v[48:51]
  ds_read_b128 v[16:19], v5 offset:8192
  v_mfma_f32_16x16x32_bf16 v[52:55], a[100:103], v[24:27], v[52:55]
  v_mfma_f32_16x16x32_bf16 v[56:59], a[180:183], v[24:27], v[56:59]
  v_mfma_f32_16x16x32_bf16 v[60:63], a[20:23], v[28:31], v[60:63]
  ds_read_b128 v[20:23], v5 offset:28672
  v_mfma_f32_16x16x32_bf16 v[64:67], a[100:103], v[28:31], v[64:67]
  v_mfma_f32_16x16x32_bf16 v[68:71], a[180:183], v[28:31], v[68:71]
  s_waitcnt lgkmcnt(4)
  v_mfma_f32_16x16x32_bf16 v[48:51], a[24:27], v[32:35], v[48:51]
  ds_read_b128 v[24:27], v5 offset:9216
  v_mfma_f32_16x16x32_bf16 v[52:55], a[104:107], v[32:35], v[52:55]
  v_mfma_f32_16x16x32_bf16 v[56:59], a[184:187], v[32:35], v[56:59]
  v_mfma_f32_16x16x32_bf16 v[60:63], a[24:27], v[36:39], v[60:63]
  ds_read_b128 v[28:31], v5 offset:29696
  v_mfma_f32_16x16x32_bf16 v[64:67], a[104:107], v[36:39], v[64:67]
  v_mfma_f32_16x16x32_bf16 v[68:71], a[184:187], v[36:39], v[68:71]
  s_waitcnt lgkmcnt(4)
  v_mfma_f32_16x16x32_bf16 v[48:51], a[28:31], v[40:43], v[48:51]
  ds_read_b128 v[32:35], v5 offset:10240
  v_mfma_f32_16x16x32_bf16 v[52:55], a[108:111], v[40:43], v[52:55]
  s_add_u32 m0, s13, 0
  s_add_u32 s18, s12, 0
  buffer_load_dwordx4 v2, s[4:7], s18 offen offset:0 lds
  v_mfma_f32_16x16x32_bf16 v[56:59], a[188:191], v[40:43], v[56:59]
  v_mfma_f32_16x16x32_bf16 v[60:63], a[28:31], v[44:47], v[60:63]
  ds_read_b128 v[36:39], v5 offset:30720
  v_mfma_f32_16x16x32_bf16 v[64:67], a[108:111], v[44:47], v[64:67]
  buffer_load_dwordx4 v2, s[4:7], s18 offen offset:1024 lds
  v_mfma_f32_16x16x32_bf16 v[68:71], a[188:191], v[44:47], v[68:71]
  s_waitcnt lgkmcnt(4)
  v_mfma_f32_16x16x32_bf16 v[48:51], a[32:35], v[16:19], v[48:51]
  ds_read_b128 v[40:43], v5 offset:11264
  v_mfma_f32_16x16x32_bf16 v[52:55], a[112:115], v[16:19], v[52:55]
  v_mfma_f32_16x16x32_bf16 v[56:59], a[192:195], v[16:19], v[56:59]
  buffer_load_dwordx4 v2, s[4:7], s18 offen offset:2048 lds
  v_mfma_f32_16x16x32_bf16 v[60:63], a[32:35], v[20:23], v[60:63]
  ds_read_b128 v[44:47], v5 offset:31744
  v_mfma_f32_16x16x32_bf16 v[64:67], a[112:115], v[20:23], v[64:67]
  v_mfma_f32_16x16x32_bf16 v[68:71], a[192:195], v[20:23], v[68:71]
  s_waitcnt lgkmcnt(4)
  v_mfma_f32_16x16x32_bf16 v[48:51], a[36:39], v[24:27], v[48:51]
  ds_read_b128 v[16:19], v5 offset:12288
  v_mfma_f32_16x16x32_bf16 v[52:55], a[116:119], v[24:27], v[52:55]
  buffer_load_dwordx4 v2, s[4:7], s18 offen offset:3072 lds
  v_mfma_f32_16x16x32_bf16 v[56:59], a[196:199], v[24:27], v[56:59]
  v_mfma_f32_16x16x32_bf16 v[60:63], a[36:39], v[28:31], v[60:63]
  ds_read_b128 v[20:23], v5 offset:32768
  v_mfma_f32_16x16x32_bf16 v[64:67], a[116:119], v[28:31], v[64:67]
  v_mfma_f32_16x16x32_bf16 v[68:71], a[196:199], v[28:31], v[68:71]
  s_add_u32 m0, s13, 4096
  s_add_u32 s18, s12, 4096
  buffer_load_dwordx4 v2, s[4:7], s18 offen offset:0 lds
  s_waitcnt vmcnt(5)
  s_barrier
  s_waitcnt lgkmcnt(4)
  v_mfma_f32_16x16x32_bf16 v[48:51], a[40:43], v[32:35], v[48:51]
  ds_read_b128 v[24:27], v5 offset:13312
  v_mfma_f32_16x16x32_bf16 v[52:55], a[120:123], v[32:35], v[52:55]
  v_mfma_f32_16x16x32_bf16 v[56:59], a[200:203], v[32:35], v[56:59]
  v_mfma_f32_16x16x32_bf16 v[60:63], a[40:43], v[36:39], v[60:63]
  ds_read_b128 v[28:31], v5 offset:33792
  v_mfma_f32_16x16x32_bf16 v[64:67], a[120:123], v[36:39], v[64:67]
  buffer_load_dwordx4 v2, s[4:7], s18 offen offset:1024 lds
  v_mfma_f32_16x16x32_bf16 v[68:71], a[200:203], v[36:39], v[68:71]
  s_waitcnt lgkmcnt(4)
  v_mfma_f32_16x16x32_bf16 v[48:51], a[44:47], v[40:43], v[48:51]
  ds_read_b128 v[32:35], v5 offset:14336
  v_mfma_f32_16x16x32_bf16 v[52:55], a[124:127], v[40:43], v[52:55]
  buffer_load_dwordx4 v2, s[4:7], s18 offen offset:2048 lds
  v_mfma_f32_16x16x32_bf16 v[56:59], a[204:207], v[40:43], v[56:59]
  v_mfma_f32_16x16x32_bf16 v[60:63], a[44:47], v[44:47], v[60:63]
  ds_read_b128 v[36:39], v5 offset:34816
  v_mfma_f32_16x16x32_bf16 v[64:67], a[124:127], v[44:47], v[64:67]
  v_mfma_f32_16x16x32_bf16 v[68:71], a[204:207], v[44:47], v[68:71]
  buffer_load_dwordx4 v2, s[4:7], s18 offen offset:3072 lds
  s_waitcnt lgkmcnt(4)
  v_mfma_f32_16x16x32_bf16 v[48:51], a[48:51], v[16:19], v[48:51]
  ds_read_b128 v[40:43], v5 offset:15360
  v_mfma_f32_16x16x32_bf16 v[52:55], a[128:131], v[16:19], v[52:55]
  v_mfma_f32_16x16x32_bf16 v[56:59], a[208:211], v[16:19], v[56:59]
  v_mfma_f32_16x16x32_bf16 v[60:63], a[48:51], v[20:23], v[60:63]
  ds_read_b128 v[44:47], v5 offset:35840
  v_mfma_f32_16x16x32_bf16 v[64:67], a[128:131], v[20:23], v[64:67]
  s_add_u32 m0, s13, 8192
  s_add_u32 s18, s12, 8192
  buffer_load_dwordx4 v2, s[4:7], s18 offen offset:0 lds
  v_mfma_f32_16x16x32_bf16 v[68:71], a[208:211], v[20:23], v[68:71]
  s_waitcnt lgkmcnt(4)
  v_mfma_f32_16x16x32_bf16 v[48:51], a[52:55], v[24:27], v[48:51]
  ds_read_b128 v[16:19], v5 offset:16384
  v_mfma_f32_16x16x32_bf16 v[52:55], a[132:135], v[24:27], v[52:55]
  v_mfma_f32_16x16x32_bf16 v[56:59], a[212:215], v[24:27], v[56:59]
  buffer_load_dwordx4 v2, s[4:7], s18 offen offset:1024 lds
  v_mfma_f32_16x16x32_bf16 v[60:63], a[52:55], v[28:31], v[60:63]
  ds_read_b128 v[20:23], v5 offset:36864
  v_mfma_f32_16x16x32_bf16 v[64:67], a[132:135], v[28:31], v[64:67]
  v_mfma_f32_16x16x32_bf16 v[68:71], a[212:215], v[28:31], v[68:71]
  s_waitcnt lgkmcnt(4)
  v_mfma_f32_16x16x32_bf16 v[48:51], a[56:59], v[32:35], v[48:51]
  ds_read_b128 v[24:27], v5 offset:17408
  v_mfma_f32_16x16x32_bf16 v[52:55], a[136:139], v[32:35], v[52:55]
  v_mfma_f32_16x16x32_bf16 v[56:59], a[216:219], v[32:35], v[56:59]
  v_mfma_f32_16x16x32_bf16 v[60:63], a[56:59], v[36:39], v[60:63]
  ds_read_b128 v[28:31], v5 offset:37888
  v_mfma_f32_16x16x32_bf16 v[64:67], a[136:139], v[36:39], v[64:67]
  v_mfma_f32_16x16x32_bf16 v[68:71], a[216:219], v[36:39], v[68:71]
  s_waitcnt lgkmcnt(4)
  v_mfma_f32_16x16x32_bf16 v[48:51], a[60:63], v[40:43], v[48:51]
  ds_read_b128 v[32:35], v5 offset:18432
  v_mfma_f32_16x16x32_bf16 v[52:55], a[140:143], v[40:43], v[52:55]
  v_mfma_f32_16x16x32_bf16 v[56:59], a[220:223], v[40:43], v[56:59]
  v_mfma_f32_16x16x32_bf16 v[60:63], a[60:63], v[44:47], v[60:63]
  ds_read_b128 v[36:39], v5 offset:38912
  v_mfma_f32_16x16x32_bf16 v[64:67], a[140:143], v[44:47], v[64:67]
  v_mfma_f32_16x16x32_bf16 v[68:71], a[220:223], v[44:47], v[68:71]
  s_waitcnt lgkmcnt(4)
  v_mfma_f32_16x16x32_bf16 v[48:51], a[64:67], v[16:19], v[48:51]
  ds_read_b128 v[40:43], v5 offset:19456
  v_mfma_f32_16x16x32_bf16 v[52:55], a[144:147], v[16:19], v[52:55]
  v_mfma_f32_16x16x32_bf16 v[56:59], a[224:227], v[16:19], v[56:59]
  v_mfma_f32_16x16x32_bf16 v[60:63], a[64:67], v[20:23], v[60:63]
  ds_read_b128 v[44:47], v5 offset:39936
  v_mfma_f32_16x16x32_bf16 v[64:67], a[144:147], v[20:23], v[64:67]
  v_mfma_f32_16x16x32_bf16 v[68:71], a[224:227], v[20:23], v[68:71]
  s_waitcnt lgkmcnt(4)
  v_mfma_f32_16x16x32_bf16 v[48:51], a[68:71], v[24:27], v[48:51]
  v_mfma_f32_16x16x32_bf16 v[52:55], a[148:151], v[24:27], v[52:55]
  v_mfma_f32_16x16x32_bf16 v[56:59], a[228:231], v[24:27], v[56:59]
  v_mfma_f32_16x16x32_bf16 v[60:63], a[68:71], v[28:31], v[60:63]
  v_mfma_f32_16x16x32_bf16 v[64:67], a[148:151], v[28:31], v[64:67]
  v_mfma_f32_16x16x32_bf16 v[68:71], a[228:231], v[28:31], v[68:71]
  s_waitcnt lgkmcnt(2)
  v_mfma_f32_16x16x32_bf16 v[48:51], a[72:75], v[32:35], v[48:51]
  v_mfma_f32_16x16x32_bf16 v[52:55], a[152:155], v[32:35], v[52:55]
  v_mfma_f32_16x16x32_bf16 v[56:59], a[232:235], v[32:35], v[56:59]
  v_mfma_f32_16x16x32_bf16 v[60:63], a[72:75], v[36:39], v[60:63]
  v_mfma_f32_16x16x32_bf16 v[64:67], a[152:155], v[36:39], v[64:67]
  v_mfma_f32_16x16x32_bf16 v[68:71], a[232:235], v[36:39], v[68:71]
  s_waitcnt lgkmcnt(0)
  v_mfma_f32_16x16x32_bf16 v[48:51], a[76:79], v[40:43], v[48:51]
  v_mfma_f32_16x16x32_bf16 v[52:55], a[156:159], v[40:43], v[52:55]
  v_mfma_f32_16x16x32_bf16 v[56:59], a[236:239], v[40:43], v[56:59]
  v_mfma_f32_16x16x32_bf16 v[60:63], a[76:79], v[44:47], v[60:63]
  v_mfma_f32_16x16x32_bf16 v[64:67], a[156:159], v[44:47], v[64:67]
  v_mfma_f32_16x16x32_bf16 v[68:71], a[236:239], v[44:47], v[68:71]
  v_add_u32 v5, s19, v5
  s_sub_u32 s13, s13, s19
  s_sub_u32 s19, 0, s19
  s_add_u32 s12, s12, 40960
  s_add_u32 s24, s24, 1
  v_cvt_pk_bf16_f32 v72, v48, v49
  v_cvt_pk_bf16_f32 v73, v50, v51
  v_cvt_pk_bf16_f32 v74, v52, v53
  v_cvt_pk_bf16_f32 v75, v54, v55
  v_cvt_pk_bf16_f32 v80, v56, v57
  v_cvt_pk_bf16_f32 v81, v58, v59
  buffer_store_dwordx4 v[72:75], v3, s[4:7], s17 offen
  v_cvt_pk_bf16_f32 v76, v60, v61
  v_cvt_pk_bf16_f32 v77, v62, v63
  v_cvt_pk_bf16_f32 v78, v64, v65
  v_cvt_pk_bf16_f32 v79, v66, v67
  v_cvt_pk_bf16_f32 v82, v68, v69
  v_cvt_pk_bf16_f32 v83, v70, v71
  buffer_store_dwordx4 v[76:79], v4, s[4:7], s17 offen
  buffer_store_dwordx4 v[80:83], v9, s[4:7], s17 offen
  s_waitcnt vmcnt(0)
  v_mov_b32 v8, s24
  s_mov_b64 exec, 1
  s_cmp_lg_u32 s69, 0
  s_cbranch_scc1 mega0_kernel_pf2
  buffer_store_dword v8, v7, s[4:7], s25 offen
mega0_kernel_pf2_b:
  s_mov_b64 exec, -1
  s_add_u32 s20, s20, 325632
  s_cmp_ge_u32 s20, 1302528
  s_cselect_b32 s20, 0, s20
  s_add_u32 s48, s48, 325632
  s_cmp_ge_u32 s48, 1302528
  s_cselect_b32 s48, 0, s48
  s_cmp_lt_u32 s24, s21
  s_cbranch_scc1 mega_kv_loop
  s_cmp_eq_u32 s22, 2
  s_cbranch_scc1 mega_kv_red
  s_cmp_eq_u32 s22, 1
  s_cbranch_scc1 mega_kv_tout
  s_endpgm
mega_kv_tout:
  v_and_b32 v84, 15, v1
  v_and_b32 v86, 3, v1
  v_bfe_u32 v85, v1, 2, 1
  v_lshl_add_u32 v85, v85, 3, v86
  v_lshlrev_b32 v85, 4, v85
  v_bfe_u32 v87, v1, 3, 1
  v_lshl_add_u32 v85, v87, 10, v85
  v_lshrrev_b32 v87, 4, v1
  v_lshl_add_u32 v10, v87, 8, v85
  v_add_u32 v15, 20480, v2
  v_lshrrev_b32 v85, 2, v84
  v_lshlrev_b32 v85, 7, v85
  v_lshl_add_u32 v85, v86, 2, v85
  s_lshl_b32 s15, s68, 9
  v_add_u32 v85, s15, v85
  v_add_u32 v86, 8192, v85
  v_add_u32 v87, 16400, v85
  s_lshl_b32 s15, s80, 7
  s_add_u32 s15, s15, 16384
  v_mov_b32 v85, s15
  v_cmp_gt_u32 vcc, 16, v1
  s_nop 1
  v_cndmask_b32 v11, v85, v86, vcc
  v_cndmask_b32 v12, v87, v86, vcc
  v_cndmask_b32 v13, 0, 1, vcc
  s_lshl_b32 s28, s26, 11
  s_add_u32 s28, s28, s78
  s_add_u32 s16, s78, 315392
  v_add_u32 v84, 81920, v2
  s_mul_i32 s31, s68, 40
  s_add_u32 s31, s31, s26
  s_lshl_b32 s31, s31, 10
  s_add_u32 s31, s31, 67272704
  s_mov_b32 s32, 0x40000000
  s_lshl_b32 s33, s26, 3
  s_add_u32 s33, s33, s68
  s_lshl_b32 s33, s33, 7
  s_add_u32 s33, s33, s71
  s_add_u32 s33, s33, 20480
  s_mov_b32 s34, 0
  s_add_u32 s51, s25, 16
  v_mov_b32 v14, 0
mega_kv_tl:
  s_add_u32 s36, s28, s48
  s_add_u32 s37, s36, 40960
  s_add_u32 s38, s36, 81920
  s_add_u32 s39, s36, 122880
  s_add_u32 s40, s36, 163840
  s_add_u32 s35, s34, 2
  s_add_u32 s50, s34, 1
  s_mov_b32 s30, 0
  s_branch mega0_kernel_pv3_t
mega0_kernel_pv3:
  buffer_load_dword v14, v11, s[4:7], s71 offen sc1
  s_waitcnt vmcnt(0)
mega0_kernel_pv3_t:
  v_add_u32 v14, v14, v13
  v_cmp_gt_u32 vcc, s35, v14
  s_nop 0
  s_cbranch_vccz mega0_kernel_pv3_ok
  s_sleep 2
  s_add_u32 s30, s30, 1
  s_cmp_lt_u32 s30, 262144
  s_cbranch_scc1 mega0_kernel_pv3
  s_branch mega_fail
mega0_kernel_pv3_ok:
  s_barrier
  ds_read_b128 v[16:19], v5 offset:0
  ds_read_b128 v[20:23], v5 offset:20480
  ds_read_b128 v[24:27], v5 offset:1024
  ds_read_b128 v[28:31], v5 offset:21504
  ds_read_b128 v[32:35], v5 offset:2048
  ds_read_b128 v[36:39], v5 offset:22528
  s_waitcnt lgkmcnt(4)
  v_mfma_f32_16x16x32_bf16 v[48:51], a[0:3], v[16:19], 0
  ds_read_b128 v[40:43], v5 offset:3072
  v_mfma_f32_16x16x32_bf16 v[52:55], a[80:83], v[16:19], 0
  s_mov_b32 m0, s23
  s_add_u32 s18, s29, s48
  buffer_load_dwordx4 v2, s[4:7], s18 offen sc1 lds
  v_mfma_f32_16x16x32_bf16 v[56:59], a[160:163], v[16:19], 0
  v_mfma_f32_16x16x32_bf16 v[60:63], a[0:3], v[20:23], 0
  ds_read_b128 v[44:47], v5 offset:23552
  v_mfma_f32_16x16x32_bf16 v[64:67], a[80:83], v[20:23], 0
  s_add_u32 s17, s14, s20
  buffer_load_dwordx4 v2, s[4:7], s18 offen offset:1024 sc1 lds
  v_mfma_f32_16x16x32_bf16 v[68:71], a[160:163], v[20:23], 0
  s_waitcnt lgkmcnt(4)
  v_mfma_f32_16x16x32_bf16 v[48:51], a[4:7], v[24:27], v[48:51]
  ds_read_b128 v[16:19], v5 offset:4096
  v_mfma_f32_16x16x32_bf16 v[52:55], a[84:87], v[24:27], v[52:55]
  buffer_load_dwordx4 v2, s[4:7], s18 offen offset:2048 sc1 lds
  v_mfma_f32_16x16x32_bf16 v[56:59], a[164:167], v[24:27], v[56:59]
  v_mfma_f32_16x16x32_bf16 v[60:63], a[4:7], v[28:31], v[60:63]
  ds_read_b128 v[20:23], v5 offset:24576
  v_mfma_f32_16x16x32_bf16 v[64:67], a[84:87], v[28:31], v[64:67]
  buffer_load_dwordx4 v[96:99], v10, s[4:7], s36 offen offset:0 sc1
  v_mfma_f32_16x16x32_bf16 v[68:71], a[164:167], v[28:31], v[68:71]
  s_waitcnt lgkmcnt(4)
  v_mfma_f32_16x16x32_bf16 v[48:51], a[8:11], v[32:35], v[48:51]
  ds_read_b128 v[24:27], v5 offset:5120
  v_mfma_f32_16x16x32_bf16 v[52:55], a[88:91], v[32:35], v[52:55]
  buffer_load_dwordx4 v[100:103], v10, s[4:7], s36 offen offset:64 sc1
  v_mfma_f32_16x16x32_bf16 v[56:59], a[168:171], v[32:35], v[56:59]
  v_mfma_f32_16x16x32_bf16 v[60:63], a[8:11], v[36:39], v[60:63]
  ds_read_b128 v[28:31], v5 offset:25600
  v_mfma_f32_16x16x32_bf16 v[64:67], a[88:91], v[36:39], v[64:67]
  buffer_load_dwordx4 v[104:107], v10, s[4:7], s37 offen offset:0 sc1
  v_mfma_f32_16x16x32_bf16 v[68:71], a[168:171], v[36:39], v[68:71]
  s_waitcnt lgkmcnt(4)
  v_mfma_f32_16x16x32_bf16 v[48:51], a[12:15], v[40:43], v[48:51]
  ds_read_b128 v[32:35], v5 offset:6144
  v_mfma_f32_16x16x32_bf16 v[52:55], a[92:95], v[40:43], v[52:55]
  buffer_load_dwordx4 v[108:111], v10, s[4:7], s37 offen offset:64 sc1
  v_mfma_f32_16x16x32_bf16 v[56:59], a[172:175], v[40:43], v[56:59]
  v_mfma_f32_16x16x32_bf16 v[60:63], a[12:15], v[44:47], v[60:63]
  ds_read_b128 v[36:39], v5 offset:26624
  v_mfma_f32_16x16x32_bf16 v[64:67], a[92:95], v[44:47], v[64:67]
  v_mfma_f32_16x16x32_bf16 v[68:71], a[172:175], v[44:47], v[68:71]
  buffer_load_dwordx4 v[112:115], v10, s[4:7], s38 offen offset:0 sc1
  s_waitcnt lgkmcnt(4)
  v_mfma_f32_16x16x32_bf16 v[48:51], a[16:19], v[16:19], v[48:51]
  ds_read_b128 v[40:43], v5 offset:7168
  v_mfma_f32_16x16x32_bf16 v[52:55], a[96:99], v[16:19], v[52:55]
  v_mfma_f32_16x16x32_bf16 v[56:59], a[176:179], v[16:19], v[56:59]
  buffer_load_dwordx4 v[116:119], v10, s[4:7], s38 offen offset:64 sc1
  v_mfma_f32_16x16x32_bf16 v[60:63], a[16:19], v[20:23], v[60:63]
  ds_read_b128 v[44:47], v5 offset:27648
  v_mfma_f32_16x16x32_bf16 v[64:67], a[96:99], v[20:23], v[64:67]
  v_mfma_f32_16x16x32_bf16 v[68:71], a[176:179], v[20:23], v[68:71]
  buffer_load_dwordx4 v[120:123], v10, s[4:7], s39 offen offset:0 sc1
  s_waitcnt lgkmcnt(4)
  v_mfma_f32_16x16x32_bf16 v[48:51], a[20:23], v[24:27], v[48:51]
  ds_read_b128 v[16:19], v5 offset:8192
  v_mfma_f32_16x16x32_bf16 v[52:55], a[100:103], v[24:27], v[52:55]
  v_mfma_f32_16x16x32_bf16 v[56:59], a[180:183], v[24:27], v[56:59]
  buffer_load_dwordx4 v[124:127], v10, s[4:7], s39 offen offset:64 sc1
  v_mfma_f32_16x16x32_bf16 v[60:63], a[20:23], v[28:31], v[60:63]
  ds_read_b128 v[20:23], v5 offset:28672
  v_mfma_f32_16x16x32_bf16 v[64:67], a[100:103], v[28:31], v[64:67]
  v_mfma_f32_16x16x32_bf16 v[68:71], a[180:183], v[28:31], v[68:71]
  buffer_load_dwordx4 v[128:131], v10, s[4:7], s40 offen offset:0 sc1
  s_waitcnt lgkmcnt(4)
  v_mfma_f32_16x16x32_bf16 v[48:51], a[24:27], v[32:35], v[48:51]
  ds_read_b128 v[24:27], v5 offset:9216
  v_mfma_f32_16x16x32_bf16 v[52:55], a[104:107], v[32:35], v[52:55]
  v_mfma_f32_16x16x32_bf16 v[56:59], a[184:187], v[32:35], v[56:59]
  buffer_load_dwordx4 v[132:135], v10, s[4:7], s40 offen offset:64 sc1
  v_mfma_f32_16x16x32_bf16 v[60:63], a[24:27], v[36:39], v[60:63]
  ds_read_b128 v[28:31], v5 offset:29696
  v_mfma_f32_16x16x32_bf16 v[64:67], a[104:107], v[36:39], v[64:67]
  v_mfma_f32_16x16x32_bf16 v[68:71], a[184:187], v[36:39], v[68:71]
  s_waitcnt lgkmcnt(4)
  v_mfma_f32_16x16x32_bf16 v[48:51], a[28:31], v[40:43], v[48:51]
  ds_read_b128 v[32:35], v5 offset:10240
  v_mfma_f32_16x16x32_bf16 v[52:55], a[108:111], v[40:43], v[52:55]
  s_add_u32 m0, s13, 0
  s_add_u32 s18, s12, 0
  buffer_load_dwordx4 v2, s[4:7], s18 offen offset:0 lds
  v_mfma_f32_16x16x32_bf16 v[56:59], a[188:191], v[40:43], v[56:59]
  v_mfma_f32_16x16x32_bf16 v[60:63], a[28:31], v[44:47], v[60:63]
  ds_read_b128 v[36:39], v5 offset:30720
  v_mfma_f32_16x16x32_bf16 v[64:67], a[108:111], v[44:47], v[64:67]
  buffer_load_dwordx4 v2, s[4:7], s18 offen offset:1024 lds
  v_mfma_f32_16x16x32_bf16 v[68:71], a[188:191], v[44:47], v[68:71]
  s_waitcnt lgkmcnt(4)
  v_mfma_f32_16x16x32_bf16 v[48:51], a[32:35], v[16:19], v[48:51]
  ds_read_b128 v[40:43], v5 offset:11264
  v_mfma_f32_16x16x32_bf16 v[52:55], a[112:115], v[16:19], v[52:55]
  v_mfma_f32_16x16x32_bf16 v[56:59], a[192:195], v[16:19], v[56:59]
  buffer_load_dwordx4 v2, s[4:7], s18 offen offset:2048 lds
  v_mfma_f32_16x16x32_bf16 v[60:63], a[32:35], v[20:23], v[60:63]
  ds_read_b128 v[44:47], v5 offset:31744
  v_mfma_f32_16x16x32_bf16 v[64:67], a[112:115], v[20:23], v[64:67]
  v_mfma_f32_16x16x32_bf16 v[68:71], a[192:195], v[20:23], v[68:71]
  s_waitcnt lgkmcnt(4)
  v_mfma_f32_16x16x32_bf16 v[48:51], a[36:39], v[24:27], v[48:51]
  ds_read_b128 v[16:19], v5 offset:12288
  v_mfma_f32_16x16x32_bf16 v[52:55], a[116:119], v[24:27], v[52:55]
  buffer_load_dwordx4 v2, s[4:7], s18 offen offset:3072 lds
  v_mfma_f32_16x16x32_bf16 v[56:59], a[196:199], v[24:27], v[56:59]
  v_mfma_f32_16x16x32_bf16 v[60:63], a[36:39], v[28:31], v[60:63]
  ds_read_b128 v[20:23], v5 offset:32768
  v_mfma_f32_16x16x32_bf16 v[64:67], a[116:119], v[28:31], v[64:67]
  v_mfma_f32_16x16x32_bf16 v[68:71], a[196:199], v[28:31], v[68:71]
  s_add_u32 m0, s13, 4096
  s_add_u32 s18, s12, 4096
  buffer_load_dwordx4 v2, s[4:7], s18 offen offset:0 lds
  s_waitcnt vmcnt(5)
  s_barrier
  v_mov_b32 v8, s50
  s_mov_b64 exec, 1
  s_cmp_lg_u32 s69, 0
  s_cbranch_scc1 mega0_kernel_pf4
  buffer_store_dword v8, v7, s[4:7], s51 offen
mega0_kernel_pf4_b:
  s_mov_b64 exec, -1
  s_waitcnt lgkmcnt(4)
  v_mfma_f32_16x16x32_bf16 v[48:51], a[40:43], v[32:35], v[48:51]
  ds_read_b128 v[24:27], v5 offset:13312
  v_mfma_f32_16x16x32_bf16 v[52:55], a[120:123], v[32:35], v[52:55]
  v_mfma_f32_16x16x32_bf16 v[56:59], a[200:203], v[32:35], v[56:59]
  v_mfma_f32_16x16x32_bf16 v[60:63], a[40:43], v[36:39], v[60:63]
  ds_read_b128 v[28:31], v5 offset:33792
  v_mfma_f32_16x16x32_bf16 v[64:67], a[120:123], v[36:39], v[64:67]
  buffer_load_dwordx4 v2, s[4:7], s18 offen offset:1024 lds
  v_mfma_f32_16x16x32_bf16 v[68:71], a[200:203], v[36:39], v[68:71]
  s_waitcnt lgkmcnt(4)
  v_mfma_f32_16x16x32_bf16 v[48:51], a[44:47], v[40:43], v[48:51]
  ds_read_b128 v[32:35], v5 offset:14336
  v_mfma_f32_16x16x32_bf16 v[52:55], a[124:127], v[40:43], v[52:55]
  buffer_load_dwordx4 v2, s[4:7], s18 offen offset:2048 lds
  v_mfma_f32_16x16x32_bf16 v[56:59], a[204:207], v[40:43], v[56:59]
  v_mfma_f32_16x16x32_bf16 v[60:63], a[44:47], v[44:47], v[60:63]
  ds_read_b128 v[36:39], v5 offset:34816
  v_mfma_f32_16x16x32_bf16 v[64:67], a[124:127], v[44:47], v[64:67]
  v_mfma_f32_16x16x32_bf16 v[68:71], a[204:207], v[44:47], v[68:71]
  buffer_load_dwordx4 v2, s[4:7], s18 offen offset:3072 lds
  s_waitcnt lgkmcnt(4)
  v_mfma_f32_16x16x32_bf16 v[48:51], a[48:51], v[16:19], v[48:51]
  ds_read_b128 v[40:43], v5 offset:15360
  v_mfma_f32_16x16x32_bf16 v[52:55], a[128:131], v[16:19], v[52:55]
  v_mfma_f32_16x16x32_bf16 v[56:59], a[208:211], v[16:19], v[56:59]
  v_mfma_f32_16x16x32_bf16 v[60:63], a[48:51], v[20:23], v[60:63]
  ds_read_b128 v[44:47], v5 offset:35840
  v_mfma_f32_16x16x32_bf16 v[64:67], a[128:131], v[20:23], v[64:67]
  s_add_u32 m0, s13, 8192
  s_add_u32 s18, s12, 8192
  buffer_load_dwordx4 v2, s[4:7], s18 offen offset:0 lds
  v_mfma_f32_16x16x32_bf16 v[68:71], a[208:211], v[20:23], v[68:71]
  s_waitcnt lgkmcnt(4)
  v_mfma_f32_16x16x32_bf16 v[48:51], a[52:55], v[24:27], v[48:51]
  ds_read_b128 v[16:19], v5 offset:16384
  v_mfma_f32_16x16x32_bf16 v[52:55], a[132:135], v[24:27], v[52:55]
  v_mfma_f32_16x16x32_bf16 v[56:59], a[212:215], v[24:27], v[56:59]
  buffer_load_dwordx4 v2, s[4:7], s18 offen offset:1024 lds
  v_mfma_f32_16x16x32_bf16 v[60:63], a[52:55], v[28:31], v[60:63]
  ds_read_b128 v[20:23], v5 offset:36864
  v_mfma_f32_16x16x32_bf16 v[64:67], a[132:135], v[28:31], v[64:67]
  v_mfma_f32_16x16x32_bf16 v[68:71], a[212:215], v[28:31], v[68:71]
  s_waitcnt lgkmcnt(4)
  v_mfma_f32_16x16x32_bf16 v[48:51], a[56:59], v[32:35], v[48:51]
  ds_read_b128 v[24:27], v5 offset:17408
  v_mfma_f32_16x16x32_bf16 v[52:55], a[136:139], v[32:35], v[52:55]
  buffer_store_dwordx4 v[192:195], v2, s[4:7], s32 offen sc1
  v_mfma_f32_16x16x32_bf16 v[56:59], a[216:219], v[32:35], v[56:59]
  buffer_store_dwordx4 v[196:199], v15, s[4:7], s32 offen sc1
  v_mfma_f32_16x16x32_bf16 v[60:63], a[56:59], v[36:39], v[60:63]
  ds_read_b128 v[28:31], v5 offset:37888
  v_mfma_f32_16x16x32_bf16 v[64:67], a[136:139], v[36:39], v[64:67]
  s_add_i32 s15, s34, -1
  s_max_i32 s15, s15, 0
  v_mov_b32 v8, s15
  s_mov_b64 exec, 1
  buffer_store_dword v8, v7, s[4:7], s33 offen sc1
  s_mov_b64 exec, -1
  v_mfma_f32_16x16x32_bf16 v[68:71], a[216:219], v[36:39], v[68:71]
  s_waitcnt lgkmcnt(4)
  v_mfma_f32_16x16x32_bf16 v[48:51], a[60:63], v[40:43], v[48:51]
  ds_read_b128 v[32:35], v5 offset:18432
  v_mfma_f32_16x16x32_bf16 v[52:55], a[140:143], v[40:43], v[52:55]
  v_mfma_f32_16x16x32_bf16 v[56:59], a[220:223], v[40:43], v[56:59]
  v_mfma_f32_16x16x32_bf16 v[60:63], a[60:63], v[44:47], v[60:63]
  ds_read_b128 v[36:39], v5 offset:38912
  v_mfma_f32_16x16x32_bf16 v[64:67], a[140:143], v[44:47], v[64:67]
  v_mfma_f32_16x16x32_bf16 v[68:71], a[220:223], v[44:47], v[68:71]
  s_waitcnt lgkmcnt(4)
  v_mfma_f32_16x16x32_bf16 v[48:51], a[64:67], v[16:19], v[48:51]
  ds_read_b128 v[40:43], v5 offset:19456
  v_mfma_f32_16x16x32_bf16 v[52:55], a[144:147], v[16:19], v[52:55]
  v_mfma_f32_16x16x32_bf16 v[56:59], a[224:227], v[16:19], v[56:59]
  v_mfma_f32_16x16x32_bf16 v[60:63], a[64:67], v[20:23], v[60:63]
  ds_read_b128 v[44:47], v5 offset:39936
  v_mfma_f32_16x16x32_bf16 v[64:67], a[144:147], v[20:23], v[64:67]
  v_mfma_f32_16x16x32_bf16 v[68:71], a[224:227], v[20:23], v[68:71]
  s_waitcnt lgkmcnt(4)
  v_mfma_f32_16x16x32_bf16 v[48:51], a[68:71], v[24:27], v[48:51]
  ds_read_b128 v[136:139], v84 offset:0
  v_mfma_f32_16x16x32_bf16 v[52:55], a[148:151], v[24:27], v[52:55]
  ds_read_b128 v[140:143], v84 offset:5120
  v_mfma_f32_16x16x32_bf16 v[56:59], a[228:231], v[24:27], v[56:59]
  ds_read_b128 v[144:147], v84 offset:1024
  v_mfma_f32_16x16x32_bf16 v[60:63], a[68:71], v[28:31], v[60:63]
  ds_read_b128 v[148:151], v84 offset:6144
  v_mfma_f32_16x16x32_bf16 v[64:67], a[148:151], v[28:31], v[64:67]
  ds_read_b128 v[152:155], v84 offset:2048
  v_mfma_f32_16x16x32_bf16 v[68:71], a[228:231], v[28:31], v[68:71]
  ds_read_b128 v[156:159], v84 offset:7168
  s_waitcnt lgkmcnt(8)
  v_mfma_f32_16x16x32_bf16 v[48:51], a[72:75], v[32:35], v[48:51]
  ds_read_b128 v[160:163], v84 offset:3072
  v_mfma_f32_16x16x32_bf16 v[52:55], a[152:155], v[32:35], v[52:55]
  ds_read_b128 v[164:167], v84 offset:8192
  v_mfma_f32_16x16x32_bf16 v[56:59], a[232:235], v[32:35], v[56:59]
  ds_read_b128 v[168:171], v84 offset:4096
  v_mfma_f32_16x16x32_bf16 v[60:63], a[72:75], v[36:39], v[60:63]
  ds_read_b128 v[172:175], v84 offset:9216
  v_mfma_f32_16x16x32_bf16 v[64:67], a[152:155], v[36:39], v[64:67]
  v_mfma_f32_16x16x32_bf16 v[68:71], a[232:235], v[36:39], v[68:71]
  s_waitcnt lgkmcnt(10)
  v_mfma_f32_16x16x32_bf16 v[48:51], a[76:79], v[40:43], v[48:51]
  v_mfma_f32_16x16x32_bf16 v[52:55], a[156:159], v[40:43], v[52:55]
  v_mfma_f32_16x16x32_bf16 v[56:59], a[236:239], v[40:43], v[56:59]
  v_mfma_f32_16x16x32_bf16 v[60:63], a[76:79], v[44:47], v[60:63]
  v_mfma_f32_16x16x32_bf16 v[64:67], a[156:159], v[44:47], v[64:67]
  v_mfma_f32_16x16x32_bf16 v[68:71], a[236:239], v[44:47], v[68:71]
  v_add_u32 v5, s19, v5
  s_sub_u32 s13, s13, s19
  s_sub_u32 s19, 0, s19
  s_add_u32 s12, s12, 40960
  s_add_u32 s24, s24, 1
  s_waitcnt lgkmcnt(0)
  v_mfma_f32_16x16x32_bf16 v[176:179], v[96:99], v[136:139], 0
  v_cvt_pk_bf16_f32 v72, v48, v49
  v_cvt_pk_bf16_f32 v73, v50, v51
  v_mfma_f32_16x16x32_bf16 v[184:187], v[96:99], v[140:143], 0
  v_cvt_pk_bf16_f32 v74, v52, v53
  v_cvt_pk_bf16_f32 v75, v54, v55
  v_mfma_f32_16x16x32_bf16 v[180:183], v[100:103], v[136:139], 0
  v_cvt_pk_bf16_f32 v80, v56, v57
  v_cvt_pk_bf16_f32 v81, v58, v59
  v_mfma_f32_16x16x32_bf16 v[188:191], v[100:103], v[140:143], 0
  buffer_store_dwordx4 v[72:75], v3, s[4:7], s17 offen
  v_cvt_pk_bf16_f32 v76, v60, v61
  v_mfma_f32_16x16x32_bf16 v[176:179], v[104:107], v[144:147], v[176:179]
  v_cvt_pk_bf16_f32 v77, v62, v63
  v_cvt_pk_bf16_f32 v78, v64, v65
  v_mfma_f32_16x16x32_bf16 v[184:187], v[104:107], v[148:151], v[184:187]
  v_cvt_pk_bf16_f32 v79, v66, v67
  v_cvt_pk_bf16_f32 v82, v68, v69
  v_mfma_f32_16x16x32_bf16 v[180:183], v[108:111], v[144:147], v[180:183]
  v_cvt_pk_bf16_f32 v83, v70, v71
  buffer_store_dwordx4 v[76:79], v4, s[4:7], s17 offen
  v_mfma_f32_16x16x32_bf16 v[188:191], v[108:111], v[148:151], v[188:191]
  buffer_store_dwordx4 v[80:83], v9, s[4:7], s17 offen
  buffer_load_dword v14, v11, s[4:7], s71 offen sc1
  v_mfma_f32_16x16x32_bf16 v[176:179], v[112:115], v[152:155], v[176:179]
  v_mfma_f32_16x16x32_bf16 v[184:187], v[112:115], v[156:159], v[184:187]
  v_mfma_f32_16x16x32_bf16 v[180:183], v[116:119], v[152:155], v[180:183]
  v_mfma_f32_16x16x32_bf16 v[188:191], v[116:119], v[156:159], v[188:191]
  v_mfma_f32_16x16x32_bf16 v[176:179], v[120:123], v[160:163], v[176:179]
  v_mfma_f32_16x16x32_bf16 v[184:187], v[120:123], v[164:167], v[184:187]
  v_mfma_f32_16x16x32_bf16 v[180:183], v[124:127], v[160:163], v[180:183]
  v_mfma_f32_16x16x32_bf16 v[188:191], v[124:127], v[164:167], v[188:191]
  v_mfma_f32_16x16x32_bf16 v[176:179], v[128:131], v[168:171], v[176:179]
  v_mfma_f32_16x16x32_bf16 v[184:187], v[128:131], v[172:175], v[184:187]
  v_mfma_f32_16x16x32_bf16 v[180:183], v[132:135], v[168:171], v[180:183]
  v_mfma_f32_16x16x32_bf16 v[188:191], v[132:135], v[172:175], v[188:191]
  v_cvt_pk_bf16_f32 v192, v176, v177
  v_cvt_pk_bf16_f32 v193, v178, v179
  s_nop 2
  v_cvt_pk_bf16_f32 v194, v180, v181
  v_cvt_pk_bf16_f32 v195, v182, v183
  v_cvt_pk_bf16_f32 v196, v184, v185
  v_cvt_pk_bf16_f32 v197, v186, v187
  v_cvt_pk_bf16_f32 v198, v188, v189
  v_cvt_pk_bf16_f32 v199, v190, v191
  s_mov_b32 s32, s31
  s_add_u32 s31, s31, 327680
  s_add_u32 s34, s34, 1
  s_waitcnt vmcnt(0)
  v_mov_b32 v8, s24
  s_mov_b64 exec, 1
  s_cmp_lg_u32 s69, 0
  s_cbranch_scc1 mega0_kernel_pf5
  buffer_store_dword v8, v7, s[4:7], s25 offen
mega0_kernel_pf5_b:
  s_mov_b64 exec, -1
  s_add_u32 s20, s20, 325632
  s_cmp_ge_u32 s20, 1302528
  s_cselect_b32 s20, 0, s20
  s_add_u32 s48, s48, 325632
  s_cmp_ge_u32 s48, 1302528
  s_cselect_b32 s48, 0, s48
  s_cmp_lt_u32 s24, 64
  s_cbranch_scc1 mega_kv_tl
mega_kv_tt:
  buffer_store_dwordx4 v[192:195], v2, s[4:7], s32 offen sc1
  buffer_store_dwordx4 v[196:199], v15, s[4:7], s32 offen sc1
  s_cmp_eq_u32 s34, 64
  s_cbranch_scc1 mega_kv_te
  s_add_u32 s36, s28, s48
  s_add_u32 s37, s36, 40960
  s_add_u32 s38, s36, 81920
  s_add_u32 s39, s36, 122880
  s_add_u32 s40, s36, 163840
  s_add_u32 s41, s16, s48
  s_add_u32 s42, s41, 4096
  s_add_u32 s43, s41, 8192
  s_add_u32 s35, s34, 2
  s_add_u32 s50, s34, 1
  buffer_load_dwordx4 v[96:99], v10, s[4:7], s36 offen offset:0 sc1
  buffer_load_dwordx4 v[100:103], v10, s[4:7], s36 offen offset:64 sc1
  buffer_load_dwordx4 v[104:107], v10, s[4:7], s37 offen offset:0 sc1
  buffer_load_dwordx4 v[108:111], v10, s[4:7], s37 offen offset:64 sc1
  buffer_load_dwordx4 v[112:115], v10, s[4:7], s38 offen offset:0 sc1
  buffer_load_dwordx4 v[116:119], v10, s[4:7], s38 offen offset:64 sc1
  buffer_load_dwordx4 v[120:123], v10, s[4:7], s39 offen offset:0 sc1
  buffer_load_dwordx4 v[124:127], v10, s[4:7], s39 offen offset:64 sc1
  s_waitcnt vmcnt(8)
  s_add_i32 s15, s34, 0
  s_max_i32 s15, s15, 0
  v_mov_b32 v8, s15
  s_mov_b64 exec, 1
  buffer_store_dword v8, v7, s[4:7], s33 offen sc1
  s_mov_b64 exec, -1
  s_cmp_ge_u32 s34, 62
  s_cselect_b64 vcc, -1, 0
  v_cndmask_b32 v11, v11, v12, vcc
  v_cndmask_b32 v13, v13, 1, vcc
  s_mov_b32 s30, 0
mega0_kernel_pv6:
  buffer_load_dword v14, v11, s[4:7], s71 offen sc1
  s_waitcnt vmcnt(0)
mega0_kernel_pv6_t:
  v_add_u32 v14, v14, v13
  v_cmp_gt_u32 vcc, s35, v14
  s_nop 0
  s_cbranch_vccz mega0_kernel_pv6_ok
  s_sleep 1
  s_add_u32 s30, s30, 1
  s_cmp_lt_u32 s30, 262144
  s_cbranch_scc1 mega0_kernel_pv6
  s_branch mega_fail
mega0_kernel_pv6_ok:
  buffer_load_dwordx4 v[136:139], v2, s[4:7], s41 offen offset:0 sc1
  buffer_load_dwordx4 v[140:143], v2, s[4:7], s42 offen offset:1024 sc1
  buffer_load_dwordx4 v[144:147], v2, s[4:7], s41 offen offset:1024 sc1
  buffer_load_dwordx4 v[148:151], v2, s[4:7], s42 offen offset:2048 sc1
  buffer_load_dwordx4 v[152:155], v2, s[4:7], s41 offen offset:2048 sc1
  buffer_load_dwordx4 v[156:159], v2, s[4:7], s42 offen offset:3072 sc1
  buffer_load_dwordx4 v[160:163], v2, s[4:7], s41 offen offset:3072 sc1
  buffer_load_dwordx4 v[164:167], v2, s[4:7], s43 offen offset:0 sc1
  buffer_load_dwordx4 v[168:171], v2, s[4:7], s42 offen offset:0 sc1
  buffer_load_dwordx4 v[172:175], v2, s[4:7], s43 offen offset:1024 sc1
  buffer_load_dwordx4 v[128:131], v10, s[4:7], s40 offen offset:0 sc1
  buffer_load_dwordx4 v[132:135], v10, s[4:7], s40 offen offset:64 sc1
  s_waitcnt vmcnt(10)
  v_mfma_f32_16x16x32_bf16 v[176:179], v[96:99], v[136:139], 0
  v_mfma_f32_16x16x32_bf16 v[184:187], v[96:99], v[140:143], 0
  v_mfma_f32_16x16x32_bf16 v[180:183], v[100:103], v[136:139], 0
  v_mfma_f32_16x16x32_bf16 v[188:191], v[100:103], v[140:143], 0
  s_waitcnt vmcnt(8)
  v_mfma_f32_16x16x32_bf16 v[176:179], v[104:107], v[144:147], v[176:179]
  v_mfma_f32_16x16x32_bf16 v[184:187], v[104:107], v[148:151], v[184:187]
  v_mfma_f32_16x16x32_bf16 v[180:183], v[108:111], v[144:147], v[180:183]
  v_mfma_f32_16x16x32_bf16 v[188:191], v[108:111], v[148:151], v[188:191]
  s_waitcnt vmcnt(6)
  v_mfma_f32_16x16x32_bf16 v[176:179], v[112:115], v[152:155], v[176:179]
  v_mfma_f32_16x16x32_bf16 v[184:187], v[112:115], v[156:159], v[184:187]
  v_mfma_f32_16x16x32_bf16 v[180:183], v[116:119], v[152:155], v[180:183]
  v_mfma_f32_16x16x32_bf16 v[188:191], v[116:119], v[156:159], v[188:191]
  s_waitcnt vmcnt(4)
  v_mfma_f32_16x16x32_bf16 v[176:179], v[120:123], v[160:163], v[176:179]
  v_mfma_f32_16x16x32_bf16 v[184:187], v[120:123], v[164:167], v[184:187]
  v_mfma_f32_16x16x32_bf16 v[180:183], v[124:127], v[160:163], v[180:183]
  v_mfma_f32_16x16x32_bf16 v[188:191], v[124:127], v[164:167], v[188:191]
  s_waitcnt vmcnt(0)
  v_mfma_f32_16x16x32_bf16 v[176:179], v[128:131], v[168:171], v[176:179]
  v_mfma_f32_16x16x32_bf16 v[184:187], v[128:131], v[172:175], v[184:187]
  v_mfma_f32_16x16x32_bf16 v[180:183], v[132:135], v[168:171], v[180:183]
  v_mfma_f32_16x16x32_bf16 v[188:191], v[132:135], v[172:175], v[188:191]
  v_mov_b32 v8, s50
  s_mov_b64 exec, 1
  s_cmp_lg_u32 s69, 0
  s_cbranch_scc1 mega0_kernel_pf7
  buffer_store_dword v8, v7, s[4:7], s51 offen
mega0_kernel_pf7_b:
  s_mov_b64 exec, -1
  s_add_u32 s48, s48, 325632
  s_cmp_ge_u32 s48, 1302528
  s_cselect_b32 s48, 0, s48
  v_cvt_pk_bf16_f32 v192, v176, v177
  v_cvt_pk_bf16_f32 v193, v178, v179
  v_cvt_pk_bf16_f32 v194, v180, v181
  v_cvt_pk_bf16_f32 v195, v182, v183
  v_cvt_pk_bf16_f32 v196, v184, v185
  v_cvt_pk_bf16_f32 v197, v186, v187
  v_cvt_pk_bf16_f32 v198, v188, v189
  v_cvt_pk_bf16_f32 v199, v190, v191
  s_mov_b32 s32, s31
  s_add_u32 s31, s31, 327680
  s_add_u32 s34, s34, 1
  s_branch mega_kv_tt
mega_kv_te:
  s_waitcnt vmcnt(0)
  s_add_i32 s15, s34, 0
  s_max_i32 s15, s15, 0
  v_mov_b32 v8, s15
  s_mov_b64 exec, 1
  buffer_store_dword v8, v7, s[4:7], s33 offen sc1
  s_mov_b64 exec, -1
  s_endpgm
mega_kv_red:
  s_mul_i32 s26, s68, 5
  s_add_u32 s26, s26, s27
  s_cmp_ge_u32 s26, 20
  s_cselect_b32 s15, 20, 0
  s_cselect_b32 s16, 20480, 0
  s_sub_u32 s27, s26, s15
  s_lshl_b32 s28, s26, 10
  s_add_u32 s31, s28, 67272704
  s_add_u32 s32, s28, 50790400
  s_lshl_b32 s15, s27, 6
  s_add_u32 s16, s16, s15
  s_cmp_eq_u32 s70, 0
  s_cselect_b32 s33, s16, s28
  s_cselect_b64 vcc, -1, 0
  v_and_b32 v84, 15, v1
  v_mul_u32_u24 v84, 1280, v84
  v_lshrrev_b32 v85, 4, v1
  v_lshl_add_u32 v84, v85, 4, v84
  v_cndmask_b32 v10, v2, v84, vcc
  v_lshrrev_b32 v84, 3, v1
  v_lshlrev_b32 v84, 7, v84
  s_lshl_b32 s15, s27, 10
  s_add_u32 s15, s15, 20480
  v_add_u32 v11, s15, v84
  s_mov_b32 s35, 1
  s_mov_b32 s34, 0xffff0000
  v_mov_b32 v14, 0
  s_mov_b32 s36, 0x40000000
mega_kv_rl:
  s_mov_b32 s30, 0
  s_branch mega0_kernel_pv8_t
mega0_kernel_pv8:
  buffer_load_dword v14, v11, s[4:7], s71 offen sc1
  s_waitcnt vmcnt(0)
mega0_kernel_pv8_t:
  v_cmp_gt_u32 vcc, s35, v14
  s_nop 0
  s_cbranch_vccz mega0_kernel_pv8_ok
  s_sleep 2
  s_add_u32 s30, s30, 1
  s_cmp_lt_u32 s30, 262144
  s_cbranch_scc1 mega0_kernel_pv8
  s_branch mega_fail
mega0_kernel_pv8_ok:
  v_mov_b32 v96, v152
  v_mov_b32 v97, v153
  v_mov_b32 v98, v154
  v_mov_b32 v99, v155
  v_mov_b32 v100, v156
  v_mov_b32 v101, v157
  v_mov_b32 v102, v158
  v_mov_b32 v103, v159
  v_mov_b32 v104, v160
  v_mov_b32 v105, v161
  v_mov_b32 v106, v162
  v_mov_b32 v107, v163
  v_mov_b32 v108, v164
  v_mov_b32 v109, v165
  v_mov_b32 v110, v166
  v_mov_b32 v111, v167
  v_mov_b32 v112, v168
  v_mov_b32 v113, v169
  v_mov_b32 v114, v170
  v_mov_b32 v115, v171
  v_mov_b32 v116, v172
  v_mov_b32 v117, v173
  v_mov_b32 v118, v174
  v_mov_b32 v119, v175
  v_mov_b32 v120, v176
  v_mov_b32 v121, v177
  v_mov_b32 v122, v178
  v_mov_b32 v123, v179
  v_mov_b32 v124, v180
  v_mov_b32 v125, v181
  v_mov_b32 v126, v182
  v_mov_b32 v127, v183
  v_mov_b32 v128, v184
  v_mov_b32 v129, v185
  v_mov_b32 v130, v186
  v_mov_b32 v131, v187
  s_barrier
  ds_read_b128 v[16:19], v5 offset:0
  ds_read_b128 v[20:23], v5 offset:20480
  ds_read_b128 v[24:27], v5 offset:1024
  ds_read_b128 v[28:31], v5 offset:21504
  ds_read_b128 v[32:35], v5 offset:2048
  ds_read_b128 v[36:39], v5 offset:22528
  s_waitcnt lgkmcnt(4)
  v_mfma_f32_16x16x32_bf16 v[48:51], a[0:3], v[16:19], 0
  ds_read_b128 v[40:43], v5 offset:3072
  v_lshlrev_b32 v132, 16, v96
  v_mfma_f32_16x16x32_bf16 v[52:55], a[80:83], v[16:19], 0
  s_mov_b32 m0, s23
  s_add_u32 s18, s29, s48
  buffer_load_dwordx4 v2, s[4:7], s18 offen sc1 lds
  v_mfma_f32_16x16x32_bf16 v[56:59], a[160:163], v[16:19], 0
  v_and_b32 v133, s34, v96
  v_lshlrev_b32 v134, 16, v97
  v_mfma_f32_16x16x32_bf16 v[60:63], a[0:3], v[20:23], 0
  ds_read_b128 v[44:47], v5 offset:23552
  v_and_b32 v135, s34, v97
  v_mfma_f32_16x16x32_bf16 v[64:67], a[80:83], v[20:23], 0
  s_add_u32 s17, s14, s20
  buffer_load_dwordx4 v2, s[4:7], s18 offen offset:1024 sc1 lds
  v_mfma_f32_16x16x32_bf16 v[68:71], a[160:163], v[20:23], 0
  v_lshlrev_b32 v136, 16, v98
  v_and_b32 v137, s34, v98
  s_waitcnt lgkmcnt(4)
  v_mfma_f32_16x16x32_bf16 v[48:51], a[4:7], v[24:27], v[48:51]
  ds_read_b128 v[16:19], v5 offset:4096
  v_lshlrev_b32 v138, 16, v99
  v_mfma_f32_16x16x32_bf16 v[52:55], a[84:87], v[24:27], v[52:55]
  buffer_load_dwordx4 v2, s[4:7], s18 offen offset:2048 sc1 lds
  v_mfma_f32_16x16x32_bf16 v[56:59], a[164:167], v[24:27], v[56:59]
  v_and_b32 v139, s34, v99
  v_lshlrev_b32 v140, 16, v100
  v_mfma_f32_16x16x32_bf16 v[60:63], a[4:7], v[28:31], v[60:63]
  ds_read_b128 v[20:23], v5 offset:24576
  v_and_b32 v141, s34, v100
  v_mfma_f32_16x16x32_bf16 v[64:67], a[84:87], v[28:31], v[64:67]
  v_add_f32 v132, v132, v140
  v_add_f32 v133, v133, v141
  v_mfma_f32_16x16x32_bf16 v[68:71], a[164:167], v[28:31], v[68:71]
  v_lshlrev_b32 v142, 16, v101
  v_and_b32 v143, s34, v101
  s_waitcnt lgkmcnt(4)
  v_mfma_f32_16x16x32_bf16 v[48:51], a[8:11], v[32:35], v[48:51]
  ds_read_b128 v[24:27], v5 offset:5120
  v_add_f32 v134, v134, v142
  v_mfma_f32_16x16x32_bf16 v[52:55], a[88:91], v[32:35], v[52:55]
  v_add_f32 v135, v135, v143
  v_lshlrev_b32 v140, 16, v102
  v_mfma_f32_16x16x32_bf16 v[56:59], a[168:171], v[32:35], v[56:59]
  v_and_b32 v141, s34, v102
  v_add_f32 v136, v136, v140
  v_mfma_f32_16x16x32_bf16 v[60:63], a[8:11], v[36:39], v[60:63]
  ds_read_b128 v[28:31], v5 offset:25600
  v_add_f32 v137, v137, v141
  v_mfma_f32_16x16x32_bf16 v[64:67], a[88:91], v[36:39], v[64:67]
  v_lshlrev_b32 v142, 16, v103
  v_and_b32 v143, s34, v103
  v_mfma_f32_16x16x32_bf16 v[68:71], a[168:171], v[36:39], v[68:71]
  v_add_f32 v138, v138, v142
  v_add_f32 v139, v139, v143
  s_waitcnt lgkmcnt(4)
  v_mfma_f32_16x16x32_bf16 v[48:51], a[12:15], v[40:43], v[48:51]
  ds_read_b128 v[32:35], v5 offset:6144
  v_lshlrev_b32 v140, 16, v104
  v_mfma_f32_16x16x32_bf16 v[52:55], a[92:95], v[40:43], v[52:55]
  v_and_b32 v141, s34, v104
  v_add_f32 v132, v132, v140
  v_mfma_f32_16x16x32_bf16 v[56:59], a[172:175], v[40:43], v[56:59]
  v_add_f32 v133, v133, v141
  v_lshlrev_b32 v142, 16, v105
  v_mfma_f32_16x16x32_bf16 v[60:63], a[12:15], v[44:47], v[60:63]
  ds_read_b128 v[36:39], v5 offset:26624
  v_and_b32 v143, s34, v105
  v_mfma_f32_16x16x32_bf16 v[64:67], a[92:95], v[44:47], v[64:67]
  v_add_f32 v134, v134, v142
  v_add_f32 v135, v135, v143
  v_mfma_f32_16x16x32_bf16 v[68:71], a[172:175], v[44:47], v[68:71]
  v_lshlrev_b32 v140, 16, v106
  v_and_b32 v141, s34, v106
  s_waitcnt lgkmcnt(4)
  v_mfma_f32_16x16x32_bf16 v[48:51], a[16:19], v[16:19], v[48:51]
  ds_read_b128 v[40:43], v5 offset:7168
  v_add_f32 v136, v136, v140
  v_mfma_f32_16x16x32_bf16 v[52:55], a[96:99], v[16:19], v[52:55]
  v_add_f32 v137, v137, v141
  v_lshlrev_b32 v142, 16, v107
  v_mfma_f32_16x16x32_bf16 v[56:59], a[176:179], v[16:19], v[56:59]
  v_and_b32 v143, s34, v107
  v_add_f32 v138, v138, v142
  v_mfma_f32_16x16x32_bf16 v[60:63], a[16:19], v[20:23], v[60:63]
  ds_read_b128 v[44:47], v5 offset:27648
  v_add_f32 v139, v139, v143
  v_mfma_f32_16x16x32_bf16 v[64:67], a[96:99], v[20:23], v[64:67]
  v_lshlrev_b32 v140, 16, v108
  v_and_b32 v141, s34, v108
  v_mfma_f32_16x16x32_bf16 v[68:71], a[176:179], v[20:23], v[68:71]
  v_add_f32 v132, v132, v140
  v_add_f32 v133, v133, v141
  s_waitcnt lgkmcnt(4)
  v_mfma_f32_16x16x32_bf16 v[48:51], a[20:23], v[24:27], v[48:51]
  ds_read_b128 v[16:19], v5 offset:8192
  v_lshlrev_b32 v142, 16, v109
  v_mfma_f32_16x16x32_bf16 v[52:55], a[100:103], v[24:27], v[52:55]
  v_and_b32 v143, s34, v109
  v_add_f32 v134, v134, v142
  v_mfma_f32_16x16x32_bf16 v[56:59], a[180:183], v[24:27], v[56:59]
  v_add_f32 v135, v135, v143
  v_lshlrev_b32 v140, 16, v110
  v_mfma_f32_16x16x32_bf16 v[60:63], a[20:23], v[28:31], v[60:63]
  ds_read_b128 v[20:23], v5 offset:28672
  v_and_b32 v141, s34, v110
  v_mfma_f32_16x16x32_bf16 v[64:67], a[100:103], v[28:31], v[64:67]
  v_add_f32 v136, v136, v140
  v_add_f32 v137, v137, v141
  v_mfma_f32_16x16x32_bf16 v[68:71], a[180:183], v[28:31], v[68:71]
  v_lshlrev_b32 v142, 16, v111
  v_and_b32 v143, s34, v111
  s_waitcnt lgkmcnt(4)
  v_mfma_f32_16x16x32_bf16 v[48:51], a[24:27], v[32:35], v[48:51]
  ds_read_b128 v[24:27], v5 offset:9216
  v_add_f32 v138, v138, v142
  v_mfma_f32_16x16x32_bf16 v[52:55], a[104:107], v[32:35], v[52:55]
  v_add_f32 v139, v139, v143
  v_lshlrev_b32 v140, 16, v112
  v_mfma_f32_16x16x32_bf16 v[56:59], a[184:187], v[32:35], v[56:59]
  v_and_b32 v141, s34, v112
  v_add_f32 v132, v132, v140
  v_mfma_f32_16x16x32_bf16 v[60:63], a[24:27], v[36:39], v[60:63]
  ds_read_b128 v[28:31], v5 offset:29696
  v_add_f32 v133, v133, v141
  v_mfma_f32_16x16x32_bf16 v[64:67], a[104:107], v[36:39], v[64:67]
  v_lshlrev_b32 v142, 16, v113
  v_and_b32 v143, s34, v113
  v_mfma_f32_16x16x32_bf16 v[68:71], a[184:187], v[36:39], v[68:71]
  v_add_f32 v134, v134, v142
  v_add_f32 v135, v135, v143
  s_waitcnt lgkmcnt(4)
  v_mfma_f32_16x16x32_bf16 v[48:51], a[28:31], v[40:43], v[48:51]
  ds_read_b128 v[32:35], v5 offset:10240
  v_lshlrev_b32 v140, 16, v114
  v_mfma_f32_16x16x32_bf16 v[52:55], a[108:111], v[40:43], v[52:55]
  s_add_u32 m0, s13, 0
  s_add_u32 s18, s12, 0
  buffer_load_dwordx4 v2, s[4:7], s18 offen offset:0 lds
  v_mfma_f32_16x16x32_bf16 v[56:59], a[188:191], v[40:43], v[56:59]
  v_and_b32 v141, s34, v114
  v_add_f32 v136, v136, v140
  v_mfma_f32_16x16x32_bf16 v[60:63], a[28:31], v[44:47], v[60:63]
  ds_read_b128 v[36:39], v5 offset:30720
  v_add_f32 v137, v137, v141
  v_mfma_f32_16x16x32_bf16 v[64:67], a[108:111], v[44:47], v[64:67]
  buffer_load_dwordx4 v2, s[4:7], s18 offen offset:1024 lds
  v_mfma_f32_16x16x32_bf16 v[68:71], a[188:191], v[44:47], v[68:71]
  v_lshlrev_b32 v142, 16, v115
  v_and_b32 v143, s34, v115
  s_waitcnt lgkmcnt(4)
  v_mfma_f32_16x16x32_bf16 v[48:51], a[32:35], v[16:19], v[48:51]
  ds_read_b128 v[40:43], v5 offset:11264
  v_add_f32 v138, v138, v142
  v_mfma_f32_16x16x32_bf16 v[52:55], a[112:115], v[16:19], v[52:55]
  v_add_f32 v139, v139, v143
  v_lshlrev_b32 v140, 16, v116
  v_mfma_f32_16x16x32_bf16 v[56:59], a[192:195], v[16:19], v[56:59]
  buffer_load_dwordx4 v2, s[4:7], s18 offen offset:2048 lds
  v_mfma_f32_16x16x32_bf16 v[60:63], a[32:35], v[20:23], v[60:63]
  ds_read_b128 v[44:47], v5 offset:31744
  v_and_b32 v141, s34, v116
  v_mfma_f32_16x16x32_bf16 v[64:67], a[112:115], v[20:23], v[64:67]
  v_add_f32 v132, v132, v140
  v_add_f32 v133, v133, v141
  v_mfma_f32_16x16x32_bf16 v[68:71], a[192:195], v[20:23], v[68:71]
  v_lshlrev_b32 v142, 16, v117
  v_and_b32 v143, s34, v117
  s_waitcnt lgkmcnt(4)
  v_mfma_f32_16x16x32_bf16 v[48:51], a[36:39], v[24:27], v[48:51]
  ds_read_b128 v[16:19], v5 offset:12288
  v_add_f32 v134, v134, v142
  v_mfma_f32_16x16x32_bf16 v[52:55], a[116:119], v[24:27], v[52:55]
  buffer_load_dwordx4 v2, s[4:7], s18 offen offset:3072 lds
  v_mfma_f32_16x16x32_bf16 v[56:59], a[196:199], v[24:27], v[56:59]
  v_add_f32 v135, v135, v143
  v_lshlrev_b32 v140, 16, v118
  v_mfma_f32_16x16x32_bf16 v[60:63], a[36:39], v[28:31], v[60:63]
  ds_read_b128 v[20:23], v5 offset:32768
  v_and_b32 v141, s34, v118
  v_mfma_f32_16x16x32_bf16 v[64:67], a[116:119], v[28:31], v[64:67]
  v_add_f32 v136, v136, v140
  v_add_f32 v137, v137, v141
  v_mfma_f32_16x16x32_bf16 v[68:71], a[196:199], v[28:31], v[68:71]
  s_add_u32 m0, s13, 4096
  s_add_u32 s18, s12, 4096
  buffer_load_dwordx4 v2, s[4:7], s18 offen offset:0 lds
  s_waitcnt vmcnt(5)
  s_barrier
  s_waitcnt lgkmcnt(4)
  v_mfma_f32_16x16x32_bf16 v[48:51], a[40:43], v[32:35], v[48:51]
  ds_read_b128 v[24:27], v5 offset:13312
  v_lshlrev_b32 v142, 16, v119
  v_mfma_f32_16x16x32_bf16 v[52:55], a[120:123], v[32:35], v[52:55]
  v_and_b32 v143, s34, v119
  v_add_f32 v138, v138, v142
  v_mfma_f32_16x16x32_bf16 v[56:59], a[200:203], v[32:35], v[56:59]
  v_add_f32 v139, v139, v143
  v_lshlrev_b32 v140, 16, v120
  v_mfma_f32_16x16x32_bf16 v[60:63], a[40:43], v[36:39], v[60:63]
  ds_read_b128 v[28:31], v5 offset:33792
  v_and_b32 v141, s34, v120
  v_mfma_f32_16x16x32_bf16 v[64:67], a[120:123], v[36:39], v[64:67]
  buffer_load_dwordx4 v2, s[4:7], s18 offen offset:1024 lds
  v_mfma_f32_16x16x32_bf16 v[68:71], a[200:203], v[36:39], v[68:71]
  v_add_f32 v132, v132, v140
  v_add_f32 v133, v133, v141
  s_waitcnt lgkmcnt(4)
  v_mfma_f32_16x16x32_bf16 v[48:51], a[44:47], v[40:43], v[48:51]
  ds_read_b128 v[32:35], v5 offset:14336
  v_lshlrev_b32 v142, 16, v121
  v_mfma_f32_16x16x32_bf16 v[52:55], a[124:127], v[40:43], v[52:55]
  buffer_load_dwordx4 v2, s[4:7], s18 offen offset:2048 lds
  v_mfma_f32_16x16x32_bf16 v[56:59], a[204:207], v[40:43], v[56:59]
  v_and_b32 v143, s34, v121
  v_add_f32 v134, v134, v142
  v_mfma_f32_16x16x32_bf16 v[60:63], a[44:47], v[44:47], v[60:63]
  ds_read_b128 v[36:39], v5 offset:34816
  v_add_f32 v135, v135, v143
  v_mfma_f32_16x16x32_bf16 v[64:67], a[124:127], v[44:47], v[64:67]
  v_lshlrev_b32 v140, 16, v122
  v_and_b32 v141, s34, v122
  v_mfma_f32_16x16x32_bf16 v[68:71], a[204:207], v[44:47], v[68:71]
  buffer_load_dwordx4 v2, s[4:7], s18 offen offset:3072 lds
  s_waitcnt lgkmcnt(4)
  v_mfma_f32_16x16x32_bf16 v[48:51], a[48:51], v[16:19], v[48:51]
  ds_read_b128 v[40:43], v5 offset:15360
  v_add_f32 v136, v136, v140
  v_mfma_f32_16x16x32_bf16 v[52:55], a[128:131], v[16:19], v[52:55]
  v_add_f32 v137, v137, v141
  v_lshlrev_b32 v142, 16, v123
  v_mfma_f32_16x16x32_bf16 v[56:59], a[208:211], v[16:19], v[56:59]
  v_and_b32 v143, s34, v123
  v_add_f32 v138, v138, v142
  v_mfma_f32_16x16x32_bf16 v[60:63], a[48:51], v[20:23], v[60:63]
  ds_read_b128 v[44:47], v5 offset:35840
  v_add_f32 v139, v139, v143
  v_mfma_f32_16x16x32_bf16 v[64:67], a[128:131], v[20:23], v[64:67]
  s_add_u32 m0, s13, 8192
  s_add_u32 s18, s12, 8192
  buffer_load_dwordx4 v2, s[4:7], s18 offen offset:0 lds
  v_mfma_f32_16x16x32_bf16 v[68:71], a[208:211], v[20:23], v[68:71]
  v_lshlrev_b32 v140, 16, v124
  v_and_b32 v141, s34, v124
  s_waitcnt lgkmcnt(4)
  v_mfma_f32_16x16x32_bf16 v[48:51], a[52:55], v[24:27], v[48:51]
  ds_read_b128 v[16:19], v5 offset:16384
  v_add_f32 v132, v132, v140
  v_mfma_f32_16x16x32_bf16 v[52:55], a[132:135], v[24:27], v[52:55]
  v_add_f32 v133, v133, v141
  v_lshlrev_b32 v142, 16, v125
  v_mfma_f32_16x16x32_bf16 v[56:59], a[212:215], v[24:27], v[56:59]
  buffer_load_dwordx4 v2, s[4:7], s18 offen offset:1024 lds
  v_mfma_f32_16x16x32_bf16 v[60:63], a[52:55], v[28:31], v[60:63]
  ds_read_b128 v[20:23], v5 offset:36864
  v_and_b32 v143, s34, v125
  v_mfma_f32_16x16x32_bf16 v[64:67], a[132:135], v[28:31], v[64:67]
  v_add_f32 v134, v134, v142
  v_add_f32 v135, v135, v143
  v_mfma_f32_16x16x32_bf16 v[68:71], a[212:215], v[28:31], v[68:71]
  v_lshlrev_b32 v140, 16, v126
  v_and_b32 v141, s34, v126
  s_waitcnt lgkmcnt(4)
  v_mfma_f32_16x16x32_bf16 v[48:51], a[56:59], v[32:35], v[48:51]
  ds_read_b128 v[24:27], v5 offset:17408
  v_add_f32 v136, v136, v140
  v_mfma_f32_16x16x32_bf16 v[52:55], a[136:139], v[32:35], v[52:55]
  buffer_load_dwordx4 v[152:155], v2, s[4:7], s31 offen sc1
  s_add_u32 s31, s31, 40960
  v_mfma_f32_16x16x32_bf16 v[56:59], a[216:219], v[32:35], v[56:59]
  buffer_load_dwordx4 v[156:159], v2, s[4:7], s31 offen sc1
  s_add_u32 s31, s31, 40960
  v_mfma_f32_16x16x32_bf16 v[60:63], a[56:59], v[36:39], v[60:63]
  ds_read_b128 v[28:31], v5 offset:37888
  v_add_f32 v137, v137, v141
  v_mfma_f32_16x16x32_bf16 v[64:67], a[136:139], v[36:39], v[64:67]
  buffer_load_dwordx4 v[160:163], v2, s[4:7], s31 offen sc1
  s_add_u32 s31, s31, 40960
  v_mfma_f32_16x16x32_bf16 v[68:71], a[216:219], v[36:39], v[68:71]
  buffer_load_dwordx4 v[164:167], v2, s[4:7], s31 offen sc1
  s_add_u32 s31, s31, 40960
  s_waitcnt lgkmcnt(4)
  v_mfma_f32_16x16x32_bf16 v[48:51], a[60:63], v[40:43], v[48:51]
  ds_read_b128 v[32:35], v5 offset:18432
  v_lshlrev_b32 v142, 16, v127
  v_mfma_f32_16x16x32_bf16 v[52:55], a[140:143], v[40:43], v[52:55]
  buffer_load_dwordx4 v[168:171], v2, s[4:7], s31 offen sc1
  s_add_u32 s31, s31, 40960
  v_mfma_f32_16x16x32_bf16 v[56:59], a[220:223], v[40:43], v[56:59]
  buffer_load_dwordx4 v[172:175], v2, s[4:7], s31 offen sc1
  s_add_u32 s31, s31, 40960
  v_mfma_f32_16x16x32_bf16 v[60:63], a[60:63], v[44:47], v[60:63]
  ds_read_b128 v[36:39], v5 offset:38912
  v_and_b32 v143, s34, v127
  v_mfma_f32_16x16x32_bf16 v[64:67], a[140:143], v[44:47], v[64:67]
  buffer_load_dwordx4 v[176:179], v2, s[4:7], s31 offen sc1
  s_add_u32 s31, s31, 40960
  v_mfma_f32_16x16x32_bf16 v[68:71], a[220:223], v[44:47], v[68:71]
  buffer_load_dwordx4 v[180:183], v2, s[4:7], s31 offen sc1
  s_add_u32 s31, s31, 40960
  s_waitcnt lgkmcnt(4)
  v_mfma_f32_16x16x32_bf16 v[48:51], a[64:67], v[16:19], v[48:51]
  ds_read_b128 v[40:43], v5 offset:19456
  v_add_f32 v138, v138, v142
  v_mfma_f32_16x16x32_bf16 v[52:55], a[144:147], v[16:19], v[52:55]
  buffer_load_dwordx4 v[184:187], v10, s[84:87], s33 offen
  s_add_u32 s33, s33, 40960
  v_mfma_f32_16x16x32_bf16 v[56:59], a[224:227], v[16:19], v[56:59]
  buffer_load_dword v14, v11, s[4:7], s71 offen sc1
  v_mfma_f32_16x16x32_bf16 v[60:63], a[64:67], v[20:23], v[60:63]
  ds_read_b128 v[44:47], v5 offset:39936
  v_add_f32 v139, v139, v143
  v_mfma_f32_16x16x32_bf16 v[64:67], a[144:147], v[20:23], v[64:67]
  v_lshlrev_b32 v140, 16, v128
  v_and_b32 v141, s34, v128
  v_mfma_f32_16x16x32_bf16 v[68:71], a[224:227], v[20:23], v[68:71]
  v_add_f32 v132, v132, v140
  v_add_f32 v133, v133, v141
  s_waitcnt lgkmcnt(4)
  v_mfma_f32_16x16x32_bf16 v[48:51], a[68:71], v[24:27], v[48:51]
  v_lshlrev_b32 v142, 16, v129
  v_mfma_f32_16x16x32_bf16 v[52:55], a[148:151], v[24:27], v[52:55]
  v_and_b32 v143, s34, v129
  v_add_f32 v134, v134, v142
  v_mfma_f32_16x16x32_bf16 v[56:59], a[228:231], v[24:27], v[56:59]
  v_add_f32 v135, v135, v143
  v_lshlrev_b32 v140, 16, v130
  v_mfma_f32_16x16x32_bf16 v[60:63], a[68:71], v[28:31], v[60:63]
  v_and_b32 v141, s34, v130
  v_mfma_f32_16x16x32_bf16 v[64:67], a[148:151], v[28:31], v[64:67]
  v_add_f32 v136, v136, v140
  v_add_f32 v137, v137, v141
  v_mfma_f32_16x16x32_bf16 v[68:71], a[228:231], v[28:31], v[68:71]
  v_lshlrev_b32 v142, 16, v131
  v_and_b32 v143, s34, v131
  s_waitcnt lgkmcnt(2)
  v_mfma_f32_16x16x32_bf16 v[48:51], a[72:75], v[32:35], v[48:51]
  v_add_f32 v138, v138, v142
  v_mfma_f32_16x16x32_bf16 v[52:55], a[152:155], v[32:35], v[52:55]
  v_add_f32 v139, v139, v143
  v_cvt_pk_bf16_f32 v144, v132, v133
  v_mfma_f32_16x16x32_bf16 v[56:59], a[232:235], v[32:35], v[56:59]
  v_cvt_pk_bf16_f32 v145, v134, v135
  v_cvt_pk_bf16_f32 v146, v136, v137
  v_mfma_f32_16x16x32_bf16 v[60:63], a[72:75], v[36:39], v[60:63]
  v_cvt_pk_bf16_f32 v147, v138, v139
  v_mfma_f32_16x16x32_bf16 v[64:67], a[152:155], v[36:39], v[64:67]
  v_mfma_f32_16x16x32_bf16 v[68:71], a[232:235], v[36:39], v[68:71]
  s_waitcnt lgkmcnt(0)
  v_mfma_f32_16x16x32_bf16 v[48:51], a[76:79], v[40:43], v[48:51]
  v_mfma_f32_16x16x32_bf16 v[52:55], a[156:159], v[40:43], v[52:55]
  v_mfma_f32_16x16x32_bf16 v[56:59], a[236:239], v[40:43], v[56:59]
  v_mfma_f32_16x16x32_bf16 v[60:63], a[76:79], v[44:47], v[60:63]
  v_mfma_f32_16x16x32_bf16 v[64:67], a[156:159], v[44:47], v[64:67]
  v_mfma_f32_16x16x32_bf16 v[68:71], a[236:239], v[44:47], v[68:71]
  v_add_u32 v5, s19, v5
  s_sub_u32 s13, s13, s19
  s_sub_u32 s19, 0, s19
  s_add_u32 s12, s12, 40960
  s_add_u32 s24, s24, 1
  v_cvt_pk_bf16_f32 v72, v48, v49
  v_cvt_pk_bf16_f32 v73, v50, v51
  v_cvt_pk_bf16_f32 v74, v52, v53
  v_cvt_pk_bf16_f32 v75, v54, v55
  v_cvt_pk_bf16_f32 v80, v56, v57
  v_cvt_pk_bf16_f32 v81, v58, v59
  buffer_store_dwordx4 v[72:75], v3, s[4:7], s17 offen
  v_cvt_pk_bf16_f32 v76, v60, v61
  v_cvt_pk_bf16_f32 v77, v62, v63
  v_cvt_pk_bf16_f32 v78, v64, v65
  v_cvt_pk_bf16_f32 v79, v66, v67
  v_cvt_pk_bf16_f32 v82, v68, v69
  v_cvt_pk_bf16_f32 v83, v70, v71
  buffer_store_dwordx4 v[76:79], v4, s[4:7], s17 offen
  buffer_store_dwordx4 v[80:83], v9, s[4:7], s17 offen
  buffer_store_dwordx4 v[144:147], v2, s[4:7], s36 offen
  s_mov_b32 s36, s32
  s_add_u32 s32, s32, 40960
  s_add_u32 s35, s35, 1
  s_waitcnt vmcnt(0)
  v_mov_b32 v8, s24
  s_mov_b64 exec, 1
  s_cmp_lg_u32 s69, 0
  s_cbranch_scc1 mega0_kernel_pf9
  buffer_store_dword v8, v7, s[4:7], s25 offen
mega0_kernel_pf9_b:
  s_mov_b64 exec, -1
  s_add_u32 s20, s20, 325632
  s_cmp_ge_u32 s20, 1302528
  s_cselect_b32 s20, 0, s20
  s_add_u32 s48, s48, 325632
  s_cmp_ge_u32 s48, 1302528
  s_cselect_b32 s48, 0, s48
  s_cmp_lt_u32 s24, 64
  s_cbranch_scc1 mega_kv_rl
mega_kv_rt:
  v_mov_b32 v96, v152
  v_mov_b32 v97, v153
  v_mov_b32 v98, v154
  v_mov_b32 v99, v155
  v_mov_b32 v100, v156
  v_mov_b32 v101, v157
  v_mov_b32 v102, v158
  v_mov_b32 v103, v159
  v_mov_b32 v104, v160
  v_mov_b32 v105, v161
  v_mov_b32 v106, v162
  v_mov_b32 v107, v163
  v_mov_b32 v108, v164
  v_mov_b32 v109, v165
  v_mov_b32 v110, v166
  v_mov_b32 v111, v167
  v_mov_b32 v112, v168
  v_mov_b32 v113, v169
  v_mov_b32 v114, v170
  v_mov_b32 v115, v171
  v_mov_b32 v116, v172
  v_mov_b32 v117, v173
  v_mov_b32 v118, v174
  v_mov_b32 v119, v175
  v_mov_b32 v120, v176
  v_mov_b32 v121, v177
  v_mov_b32 v122, v178
  v_mov_b32 v123, v179
  v_mov_b32 v124, v180
  v_mov_b32 v125, v181
  v_mov_b32 v126, v182
  v_mov_b32 v127, v183
  v_mov_b32 v128, v184
  v_mov_b32 v129, v185
  v_mov_b32 v130, v186
  v_mov_b32 v131, v187
  v_cmp_gt_u32 vcc, s35, v14
  s_nop 0
  s_cbranch_vccnz mega_kv_rw
  buffer_load_dwordx4 v[152:155], v2, s[4:7], s31 offen sc1
  s_add_u32 s31, s31, 40960
  buffer_load_dwordx4 v[156:159], v2, s[4:7], s31 offen sc1
  s_add_u32 s31, s31, 40960
  buffer_load_dwordx4 v[160:163], v2, s[4:7], s31 offen sc1
  s_add_u32 s31, s31, 40960
  buffer_load_dwordx4 v[164:167], v2, s[4:7], s31 offen sc1
  s_add_u32 s31, s31, 40960
  buffer_load_dwordx4 v[168:171], v2, s[4:7], s31 offen sc1
  s_add_u32 s31, s31, 40960
  buffer_load_dwordx4 v[172:175], v2, s[4:7], s31 offen sc1
  s_add_u32 s31, s31, 40960
  buffer_load_dwordx4 v[176:179], v2, s[4:7], s31 offen sc1
  s_add_u32 s31, s31, 40960
  buffer_load_dwordx4 v[180:183], v2, s[4:7], s31 offen sc1
  s_add_u32 s31, s31, 40960
  buffer_load_dwordx4 v[184:187], v10, s[84:87], s33 offen
  s_add_u32 s33, s33, 40960
  v_lshlrev_b32 v132, 16, v96
  v_and_b32 v133, s34, v96
  v_lshlrev_b32 v134, 16, v97
  v_and_b32 v135, s34, v97
  v_lshlrev_b32 v136, 16, v98
  v_and_b32 v137, s34, v98
  v_lshlrev_b32 v138, 16, v99
  v_and_b32 v139, s34, v99
  v_lshlrev_b32 v140, 16, v100
  v_and_b32 v141, s34, v100
  v_add_f32 v132, v132, v140
  v_add_f32 v133, v133, v141
  v_lshlrev_b32 v142, 16, v101
  v_and_b32 v143, s34, v101
  v_add_f32 v134, v134, v142
  v_add_f32 v135, v135, v143
  v_lshlrev_b32 v140, 16, v102
  v_and_b32 v141, s34, v102
  v_add_f32 v136, v136, v140
  v_add_f32 v137, v137, v141
  v_lshlrev_b32 v142, 16, v103
  v_and_b32 v143, s34, v103
  v_add_f32 v138, v138, v142
  v_add_f32 v139, v139, v143
  v_lshlrev_b32 v140, 16, v104
  v_and_b32 v141, s34, v104
  v_add_f32 v132, v132, v140
  v_add_f32 v133, v133, v141
  v_lshlrev_b32 v142, 16, v105
  v_and_b32 v143, s34, v105
  v_add_f32 v134, v134, v142
  v_add_f32 v135, v135, v143
  v_lshlrev_b32 v140, 16, v106
  v_and_b32 v141, s34, v106
  v_add_f32 v136, v136, v140
  v_add_f32 v137, v137, v141
  v_lshlrev_b32 v142, 16, v107
  v_and_b32 v143, s34, v107
  v_add_f32 v138, v138, v142
  v_add_f32 v139, v139, v143
  v_lshlrev_b32 v140, 16, v108
  v_and_b32 v141, s34, v108
  v_add_f32 v132, v132, v140
  v_add_f32 v133, v133, v141
  v_lshlrev_b32 v142, 16, v109
  v_and_b32 v143, s34, v109
  v_add_f32 v134, v134, v142
  v_add_f32 v135, v135, v143
  v_lshlrev_b32 v140, 16, v110
  v_and_b32 v141, s34, v110
  v_add_f32 v136, v136, v140
  v_add_f32 v137, v137, v141
  v_lshlrev_b32 v142, 16, v111
  v_and_b32 v143, s34, v111
  v_add_f32 v138, v138, v142
  v_add_f32 v139, v139, v143
  v_lshlrev_b32 v140, 16, v112
  v_and_b32 v141, s34, v112
  v_add_f32 v132, v132, v140
  v_add_f32 v133, v133, v141
  v_lshlrev_b32 v142, 16, v113
  v_and_b32 v143, s34, v113
  v_add_f32 v134, v134, v142
  v_add_f32 v135, v135, v143
  v_lshlrev_b32 v140, 16, v114
  v_and_b32 v141, s34, v114
  v_add_f32 v136, v136, v140
  v_add_f32 v137, v137, v141
  v_lshlrev_b32 v142, 16, v115
  v_and_b32 v143, s34, v115
  v_add_f32 v138, v138, v142
  v_add_f32 v139, v139, v143
  v_lshlrev_b32 v140, 16, v116
  v_and_b32 v141, s34, v116
  v_add_f32 v132, v132, v140
  v_add_f32 v133, v133, v141
  v_lshlrev_b32 v142, 16, v117
  v_and_b32 v143, s34, v117
  v_add_f32 v134, v134, v142
  v_add_f32 v135, v135, v143
  v_lshlrev_b32 v140, 16, v118
  v_and_b32 v141, s34, v118
  v_add_f32 v136, v136, v140
  v_add_f32 v137, v137, v141
  v_lshlrev_b32 v142, 16, v119
  v_and_b32 v143, s34, v119
  v_add_f32 v138, v138, v142
  v_add_f32 v139, v139, v143
  v_lshlrev_b32 v140, 16, v120
  v_and_b32 v141, s34, v120
  v_add_f32 v132, v132, v140
  v_add_f32 v133, v133, v141
  v_lshlrev_b32 v142, 16, v121
  v_and_b32 v143, s34, v121
  v_add_f32 v134, v134, v142
  v_add_f32 v135, v135, v143
  v_lshlrev_b32 v140, 16, v122
  v_and_b32 v141, s34, v122
  v_add_f32 v136, v136, v140
  v_add_f32 v137, v137, v141
  v_lshlrev_b32 v142, 16, v123
  v_and_b32 v143, s34, v123
  v_add_f32 v138, v138, v142
  v_add_f32 v139, v139, v143
  v_lshlrev_b32 v140, 16, v124
  v_and_b32 v141, s34, v124
  v_add_f32 v132, v132, v140
  v_add_f32 v133, v133, v141
  v_lshlrev_b32 v142, 16, v125
  v_and_b32 v143, s34, v125
  v_add_f32 v134, v134, v142
  v_add_f32 v135, v135, v143
  v_lshlrev_b32 v140, 16, v126
  v_and_b32 v141, s34, v126
  v_add_f32 v136, v136, v140
  v_add_f32 v137, v137, v141
  v_lshlrev_b32 v142, 16, v127
  v_and_b32 v143, s34, v127
  v_add_f32 v138, v138, v142
  v_add_f32 v139, v139, v143
  v_lshlrev_b32 v140, 16, v128
  v_and_b32 v141, s34, v128
  v_add_f32 v132, v132, v140
  v_add_f32 v133, v133, v141
  v_lshlrev_b32 v142, 16, v129
  v_and_b32 v143, s34, v129
  v_add_f32 v134, v134, v142
  v_add_f32 v135, v135, v143
  v_lshlrev_b32 v140, 16, v130
  v_and_b32 v141, s34, v130
  v_add_f32 v136, v136, v140
  v_add_f32 v137, v137, v141
  v_lshlrev_b32 v142, 16, v131
  v_and_b32 v143, s34, v131
  v_add_f32 v138, v138, v142
  v_add_f32 v139, v139, v143
  v_cvt_pk_bf16_f32 v144, v132, v133
  v_cvt_pk_bf16_f32 v145, v134, v135
  v_cvt_pk_bf16_f32 v146, v136, v137
  v_cvt_pk_bf16_f32 v147, v138, v139
  buffer_store_dwordx4 v[144:147], v2, s[4:7], s36 offen
  s_branch mega_kv_rn
mega_kv_rw:
  v_lshlrev_b32 v132, 16, v96
  v_and_b32 v133, s34, v96
  v_lshlrev_b32 v134, 16, v97
  v_and_b32 v135, s34, v97
  v_lshlrev_b32 v136, 16, v98
  v_and_b32 v137, s34, v98
  v_lshlrev_b32 v138, 16, v99
  v_and_b32 v139, s34, v99
  v_lshlrev_b32 v140, 16, v100
  v_and_b32 v141, s34, v100
  v_add_f32 v132, v132, v140
  v_add_f32 v133, v133, v141
  v_lshlrev_b32 v142, 16, v101
  v_and_b32 v143, s34, v101
  v_add_f32 v134, v134, v142
  v_add_f32 v135, v135, v143
  v_lshlrev_b32 v140, 16, v102
  v_and_b32 v141, s34, v102
  v_add_f32 v136, v136, v140
  v_add_f32 v137, v137, v141
  v_lshlrev_b32 v142, 16, v103
  v_and_b32 v143, s34, v103
  v_add_f32 v138, v138, v142
  v_add_f32 v139, v139, v143
  v_lshlrev_b32 v140, 16, v104
  v_and_b32 v141, s34, v104
  v_add_f32 v132, v132, v140
  v_add_f32 v133, v133, v141
  v_lshlrev_b32 v142, 16, v105
  v_and_b32 v143, s34, v105
  v_add_f32 v134, v134, v142
  v_add_f32 v135, v135, v143
  v_lshlrev_b32 v140, 16, v106
  v_and_b32 v141, s34, v106
  v_add_f32 v136, v136, v140
  v_add_f32 v137, v137, v141
  v_lshlrev_b32 v142, 16, v107
  v_and_b32 v143, s34, v107
  v_add_f32 v138, v138, v142
  v_add_f32 v139, v139, v143
  v_lshlrev_b32 v140, 16, v108
  v_and_b32 v141, s34, v108
  v_add_f32 v132, v132, v140
  v_add_f32 v133, v133, v141
  v_lshlrev_b32 v142, 16, v109
  v_and_b32 v143, s34, v109
  v_add_f32 v134, v134, v142
  v_add_f32 v135, v135, v143
  v_lshlrev_b32 v140, 16, v110
  v_and_b32 v141, s34, v110
  v_add_f32 v136, v136, v140
  v_add_f32 v137, v137, v141
  v_lshlrev_b32 v142, 16, v111
  v_and_b32 v143, s34, v111
  v_add_f32 v138, v138, v142
  v_add_f32 v139, v139, v143
  v_lshlrev_b32 v140, 16, v112
  v_and_b32 v141, s34, v112
  v_add_f32 v132, v132, v140
  v_add_f32 v133, v133, v141
  v_lshlrev_b32 v142, 16, v113
  v_and_b32 v143, s34, v113
  v_add_f32 v134, v134, v142
  v_add_f32 v135, v135, v143
  v_lshlrev_b32 v140, 16, v114
  v_and_b32 v141, s34, v114
  v_add_f32 v136, v136, v140
  v_add_f32 v137, v137, v141
  v_lshlrev_b32 v142, 16, v115
  v_and_b32 v143, s34, v115
  v_add_f32 v138, v138, v142
  v_add_f32 v139, v139, v143
  v_lshlrev_b32 v140, 16, v116
  v_and_b32 v141, s34, v116
  v_add_f32 v132, v132, v140
  v_add_f32 v133, v133, v141
  v_lshlrev_b32 v142, 16, v117
  v_and_b32 v143, s34, v117
  v_add_f32 v134, v134, v142
  v_add_f32 v135, v135, v143
  v_lshlrev_b32 v140, 16, v118
  v_and_b32 v141, s34, v118
  v_add_f32 v136, v136, v140
  v_add_f32 v137, v137, v141
  v_lshlrev_b32 v142, 16, v119
  v_and_b32 v143, s34, v119
  v_add_f32 v138, v138, v142
  v_add_f32 v139, v139, v143
  v_lshlrev_b32 v140, 16, v120
  v_and_b32 v141, s34, v120
  v_add_f32 v132, v132, v140
  v_add_f32 v133, v133, v141
  v_lshlrev_b32 v142, 16, v121
  v_and_b32 v143, s34, v121
  v_add_f32 v134, v134, v142
  v_add_f32 v135, v135, v143
  v_lshlrev_b32 v140, 16, v122
  v_and_b32 v141, s34, v122
  v_add_f32 v136, v136, v140
  v_add_f32 v137, v137, v141
  v_lshlrev_b32 v142, 16, v123
  v_and_b32 v143, s34, v123
  v_add_f32 v138, v138, v142
  v_add_f32 v139, v139, v143
  v_lshlrev_b32 v140, 16, v124
  v_and_b32 v141, s34, v124
  v_add_f32 v132, v132, v140
  v_add_f32 v133, v133, v141
  v_lshlrev_b32 v142, 16, v125
  v_and_b32 v143, s34, v125
  v_add_f32 v134, v134, v142
  v_add_f32 v135, v135, v143
  v_lshlrev_b32 v140, 16, v126
  v_and_b32 v141, s34, v126
  v_add_f32 v136, v136, v140
  v_add_f32 v137, v137, v141
  v_lshlrev_b32 v142, 16, v127
  v_and_b32 v143, s34, v127
  v_add_f32 v138, v138, v142
  v_add_f32 v139, v139, v143
  v_lshlrev_b32 v140, 16, v128
  v_and_b32 v141, s34, v128
  v_add_f32 v132, v132, v140
  v_add_f32 v133, v133, v141
  v_lshlrev_b32 v142, 16, v129
  v_and_b32 v143, s34, v129
  v_add_f32 v134, v134, v142
  v_add_f32 v135, v135, v143
  v_lshlrev_b32 v140, 16, v130
  v_and_b32 v141, s34, v130
  v_add_f32 v136, v136, v140
  v_add_f32 v137, v137, v141
  v_lshlrev_b32 v142, 16, v131
  v_and_b32 v143, s34, v131
  v_add_f32 v138, v138, v142
  v_add_f32 v139, v139, v143
  v_cvt_pk_bf16_f32 v144, v132, v133
  v_cvt_pk_bf16_f32 v145, v134, v135
  v_cvt_pk_bf16_f32 v146, v136, v137
  v_cvt_pk_bf16_f32 v147, v138, v139
  buffer_store_dwordx4 v[144:147], v2, s[4:7], s36 offen
  s_cmp_gt_u32 s35, 64
  s_cbranch_scc1 mega_kv_re
  s_mov_b32 s30, 0
mega0_kernel_pv10:
  buffer_load_dword v14, v11, s[4:7], s71 offen sc1
  s_waitcnt vmcnt(0)
mega0_kernel_pv10_t:
  v_cmp_gt_u32 vcc, s35, v14
  s_nop 0
  s_cbranch_vccz mega0_kernel_pv10_ok
  s_sleep 1
  s_add_u32 s30, s30, 1
  s_cmp_lt_u32 s30, 262144
  s_cbranch_scc1 mega0_kernel_pv10
  s_branch mega_fail
mega0_kernel_pv10_ok:
  buffer_load_dwordx4 v[152:155], v2, s[4:7], s31 offen sc1
  s_add_u32 s31, s31, 40960
  buffer_load_dwordx4 v[156:159], v2, s[4:7], s31 offen sc1
  s_add_u32 s31, s31, 40960
  buffer_load_dwordx4 v[160:163], v2, s[4:7], s31 offen sc1
  s_add_u32 s31, s31, 40960
  buffer_load_dwordx4 v[164:167], v2, s[4:7], s31 offen sc1
  s_add_u32 s31, s31, 40960
  buffer_load_dwordx4 v[168:171], v2, s[4:7], s31 offen sc1
  s_add_u32 s31, s31, 40960
  buffer_load_dwordx4 v[172:175], v2, s[4:7], s31 offen sc1
  s_add_u32 s31, s31, 40960
  buffer_load_dwordx4 v[176:179], v2, s[4:7], s31 offen sc1
  s_add_u32 s31, s31, 40960
  buffer_load_dwordx4 v[180:183], v2, s[4:7], s31 offen sc1
  s_add_u32 s31, s31, 40960
  buffer_load_dwordx4 v[184:187], v10, s[84:87], s33 offen
  s_add_u32 s33, s33, 40960
mega_kv_rn:
  s_mov_b32 s36, s32
  s_add_u32 s32, s32, 40960
  s_add_u32 s35, s35, 1
  s_waitcnt vmcnt(0)
  s_branch mega_kv_rt
mega_kv_re:
  s_endpgm
mega_urole:
  v_lshlrev_b32 v2, 4, v1
  v_mov_b32 v7, 0
  s_mul_i32 s10, s80, 245760
  s_mul_i32 s11, s3, 320
  s_add_u32 s10, s10, s11
  s_mul_i32 s11, s3, 30720
  v_mul_u32_u24 v18, 3277, v1
  v_lshrrev_b32 v18, 16, v18
  v_mul_u32_u24 v16, 20, v18
  v_sub_u32 v16, v1, v16
  v_lshlrev_b32 v16, 4, v16
  v_mul_u32_u24 v18, 1280, v18
  v_add_u32 v16, v16, v18
  v_lshrrev_b32 v18, 4, v1
  v_mul_u32_u24 v18, 4, v18
  v_bfe_u32 v17, v1, 2, 2
  v_add_u32 v18, v18, v17
  v_mul_u32_u24 v18, 320, v18
  v_and_b32 v17, 3, v1
  v_lshl_add_u32 v17, v17, 3, v18
  v_add_u32 v17, s11, v17
  s_mov_b64 exec, s[82:83]
  s_add_u32 m0, s11, 0
  s_nop 0
  buffer_load_dwordx4 v16, s[92:95], s10 offen lds
  s_add_u32 s10, s10, 3840
  s_add_u32 m0, s11, 960
  s_nop 0
  buffer_load_dwordx4 v16, s[92:95], s10 offen lds
  s_add_u32 s10, s10, 3840
  s_add_u32 m0, s11, 1920
  s_nop 0
  buffer_load_dwordx4 v16, s[92:95], s10 offen lds
  s_add_u32 s10, s10, 3840
  s_add_u32 m0, s11, 2880
  s_nop 0
  buffer_load_dwordx4 v16, s[92:95], s10 offen lds
  s_add_u32 s10, s10, 3840
  s_add_u32 m0, s11, 3840
  s_nop 0
  buffer_load_dwordx4 v16, s[92:95], s10 offen lds
  s_add_u32 s10, s10, 3840
  s_add_u32 m0, s11, 4800
  s_nop 0
  buffer_load_dwordx4 v16, s[92:95], s10 offen lds
  s_add_u32 s10, s10, 3840
  s_add_u32 m0, s11, 5760
  s_nop 0
  buffer_load_dwordx4 v16, s[92:95], s10 offen lds
  s_add_u32 s10, s10, 3840
  s_add_u32 m0, s11, 6720
  s_nop 0
  buffer_load_dwordx4 v16, s[92:95], s10 offen lds
  s_add_u32 s10, s10, 3840
  s_add_u32 m0, s11, 7680
  s_nop 0
  buffer_load_dwordx4 v16, s[92:95], s10 offen lds
  s_add_u32 s10, s10, 3840
  s_add_u32 m0, s11, 8640
  s_nop 0
  buffer_load_dwordx4 v16, s[92:95], s10 offen lds
  s_add_u32 s10, s10, 3840
  s_add_u32 m0, s11, 9600
  s_nop 0
  buffer_load_dwordx4 v16, s[92:95], s10 offen lds
  s_add_u32 s10, s10, 3840
  s_add_u32 m0, s11, 10560
  s_nop 0
  buffer_load_dwordx4 v16, s[92:95], s10 offen lds
  s_add_u32 s10, s10, 3840
  s_add_u32 m0, s11, 11520
  s_nop 0
  buffer_load_dwordx4 v16, s[92:95], s10 offen lds
  s_add_u32 s10, s10, 3840
  s_add_u32 m0, s11, 12480
  s_nop 0
  buffer_load_dwordx4 v16, s[92:95], s10 offen lds
  s_add_u32 s10, s10, 3840
  s_add_u32 m0, s11, 13440
  s_nop 0
  buffer_load_dwordx4 v16, s[92:95], s10 offen lds
  s_add_u32 s10, s10, 3840
  s_add_u32 m0, s11, 14400
  s_nop 0
  buffer_load_dwordx4 v16, s[92:95], s10 offen lds
  s_add_u32 s10, s10, 3840
  s_add_u32 m0, s11, 15360
  s_nop 0
  buffer_load_dwordx4 v16, s[92:95], s10 offen lds
  s_add_u32 s10, s10, 3840
  s_add_u32 m0, s11, 16320
  s_nop 0
  buffer_load_dwordx4 v16, s[92:95], s10 offen lds
  s_add_u32 s10, s10, 3840
  s_add_u32 m0, s11, 17280
  s_nop 0
  buffer_load_dwordx4 v16, s[92:95], s10 offen lds
  s_add_u32 s10, s10, 3840
  s_add_u32 m0, s11, 18240
  s_nop 0
  buffer_load_dwordx4 v16, s[92:95], s10 offen lds
  s_add_u32 s10, s10, 3840
  s_add_u32 m0, s11, 19200
  s_nop 0
  buffer_load_dwordx4 v16, s[92:95], s10 offen lds
  s_add_u32 s10, s10, 3840
  s_add_u32 m0, s11, 20160
  s_nop 0
  buffer_load_dwordx4 v16, s[92:95], s10 offen lds
  s_add_u32 s10, s10, 3840
  s_add_u32 m0, s11, 21120
  s_nop 0
  buffer_load_dwordx4 v16, s[92:95], s10 offen lds
  s_add_u32 s10, s10, 3840
  s_add_u32 m0, s11, 22080
  s_nop 0
  buffer_load_dwordx4 v16, s[92:95], s10 offen lds
  s_add_u32 s10, s10, 3840
  s_add_u32 m0, s11, 23040
  s_nop 0
  buffer_load_dwordx4 v16, s[92:95], s10 offen lds
  s_add_u32 s10, s10, 3840
  s_add_u32 m0, s11, 24000
  s_nop 0
  buffer_load_dwordx4 v16, s[92:95], s10 offen lds
  s_add_u32 s10, s10, 3840
  s_add_u32 m0, s11, 24960
  s_nop 0
  buffer_load_dwordx4 v16, s[92:95], s10 offen lds
  s_add_u32 s10, s10, 3840
  s_add_u32 m0, s11, 25920
  s_nop 0
  buffer_load_dwordx4 v16, s[92:95], s10 offen lds
  s_add_u32 s10, s10, 3840
  s_add_u32 m0, s11, 26880
  s_nop 0
  buffer_load_dwordx4 v16, s[92:95], s10 offen lds
  s_add_u32 s10, s10, 3840
  s_add_u32 m0, s11, 27840
  s_nop 0
  buffer_load_dwordx4 v16, s[92:95], s10 offen lds
  s_add_u32 s10, s10, 3840
  s_add_u32 m0, s11, 28800
  s_nop 0
  buffer_load_dwordx4 v16, s[92:95], s10 offen lds
  s_add_u32 s10, s10, 3840
  s_add_u32 m0, s11, 29760
  s_nop 0
  buffer_load_dwordx4 v16, s[92:95], s10 offen lds
  s_add_u32 s10, s10, 3840
  s_mov_b64 exec, -1
  s_waitcnt vmcnt(26)
  ds_read_b64_tr_b16 a[0:1], v17 offset:0
  ds_read_b64_tr_b16 a[24:25], v17 offset:32
  ds_read_b64_tr_b16 a[48:49], v17 offset:64
  ds_read_b64_tr_b16 a[72:73], v17 offset:96
  ds_read_b64_tr_b16 a[96:97], v17 offset:128
  ds_read_b64_tr_b16 a[120:121], v17 offset:160
  ds_read_b64_tr_b16 a[144:145], v17 offset:192
  ds_read_b64_tr_b16 a[168:169], v17 offset:224
  ds_read_b64_tr_b16 a[192:193], v17 offset:256
  ds_read_b64_tr_b16 a[216:217], v17 offset:288
  s_waitcnt lgkmcnt(0)
  s_mov_b64 exec, s[82:83]
  s_add_u32 m0, s11, 0
  s_nop 0
  buffer_load_dwordx4 v16, s[92:95], s10 offen lds
  s_add_u32 s10, s10, 3840
  s_add_u32 m0, s11, 960
  s_nop 0
  buffer_load_dwordx4 v16, s[92:95], s10 offen lds
  s_add_u32 s10, s10, 3840
  s_add_u32 m0, s11, 1920
  s_nop 0
  buffer_load_dwordx4 v16, s[92:95], s10 offen lds
  s_add_u32 s10, s10, 3840
  s_add_u32 m0, s11, 2880
  s_nop 0
  buffer_load_dwordx4 v16, s[92:95], s10 offen lds
  s_add_u32 s10, s10, 3840
  s_add_u32 m0, s11, 3840
  s_nop 0
  buffer_load_dwordx4 v16, s[92:95], s10 offen lds
  s_add_u32 s10, s10, 3840
  s_mov_b64 exec, -1
  s_waitcnt vmcnt(26)
  ds_read_b64_tr_b16 a[2:3], v17 offset:5120
  ds_read_b64_tr_b16 a[26:27], v17 offset:5152
  ds_read_b64_tr_b16 a[50:51], v17 offset:5184
  ds_read_b64_tr_b16 a[74:75], v17 offset:5216
  ds_read_b64_tr_b16 a[98:99], v17 offset:5248
  ds_read_b64_tr_b16 a[122:123], v17 offset:5280
  ds_read_b64_tr_b16 a[146:147], v17 offset:5312
  ds_read_b64_tr_b16 a[170:171], v17 offset:5344
  ds_read_b64_tr_b16 a[194:195], v17 offset:5376
  ds_read_b64_tr_b16 a[218:219], v17 offset:5408
  s_waitcnt lgkmcnt(0)
  s_mov_b64 exec, s[82:83]
  s_add_u32 m0, s11, 4800
  s_nop 0
  buffer_load_dwordx4 v16, s[92:95], s10 offen lds
  s_add_u32 s10, s10, 3840
  s_add_u32 m0, s11, 5760
  s_nop 0
  buffer_load_dwordx4 v16, s[92:95], s10 offen lds
  s_add_u32 s10, s10, 3840
  s_add_u32 m0, s11, 6720
  s_nop 0
  buffer_load_dwordx4 v16, s[92:95], s10 offen lds
  s_add_u32 s10, s10, 3840
  s_add_u32 m0, s11, 7680
  s_nop 0
  buffer_load_dwordx4 v16, s[92:95], s10 offen lds
  s_add_u32 s10, s10, 3840
  s_add_u32 m0, s11, 8640
  s_nop 0
  buffer_load_dwordx4 v16, s[92:95], s10 offen lds
  s_add_u32 s10, s10, 3840
  s_mov_b64 exec, -1
  s_waitcnt vmcnt(26)
  ds_read_b64_tr_b16 a[16:17], v17 offset:10240
  ds_read_b64_tr_b16 a[40:41], v17 offset:10272
  ds_read_b64_tr_b16 a[64:65], v17 offset:10304
  ds_read_b64_tr_b16 a[88:89], v17 offset:10336
  ds_read_b64_tr_b16 a[112:113], v17 offset:10368
  ds_read_b64_tr_b16 a[136:137], v17 offset:10400
  ds_read_b64_tr_b16 a[160:161], v17 offset:10432
  ds_read_b64_tr_b16 a[184:185], v17 offset:10464
  ds_read_b64_tr_b16 a[208:209], v17 offset:10496
  ds_read_b64_tr_b16 a[232:233], v17 offset:10528
  s_waitcnt lgkmcnt(0)
  s_mov_b64 exec, s[82:83]
  s_add_u32 m0, s11, 9600
  s_nop 0
  buffer_load_dwordx4 v16, s[92:95], s10 offen lds
  s_add_u32 s10, s10, 3840
  s_add_u32 m0, s11, 10560
  s_nop 0
  buffer_load_dwordx4 v16, s[92:95], s10 offen lds
  s_add_u32 s10, s10, 3840
  s_add_u32 m0, s11, 11520
  s_nop 0
  buffer_load_dwordx4 v16, s[92:95], s10 offen lds
  s_add_u32 s10, s10, 3840
  s_add_u32 m0, s11, 12480
  s_nop 0
  buffer_load_dwordx4 v16, s[92:95], s10 offen lds
  s_add_u32 s10, s10, 3840
  s_add_u32 m0, s11, 13440
  s_nop 0
  buffer_load_dwordx4 v16, s[92:95], s10 offen lds
  s_add_u32 s10, s10, 3840
  s_add_u32 m0, s11, 14400
  s_nop 0
  buffer_load_dwordx4 v16, s[92:95], s10 offen lds
  s_add_u32 s10, s10, 3840
  s_mov_b64 exec, -1
  s_waitcnt vmcnt(26)
  ds_read_b64_tr_b16 a[4:5], v17 offset:15360
  ds_read_b64_tr_b16 a[28:29], v17 offset:15392
  ds_read_b64_tr_b16 a[52:53], v17 offset:15424
  ds_read_b64_tr_b16 a[76:77], v17 offset:15456
  ds_read_b64_tr_b16 a[100:101], v17 offset:15488
  ds_read_b64_tr_b16 a[124:125], v17 offset:15520
  ds_read_b64_tr_b16 a[148:149], v17 offset:15552
  ds_read_b64_tr_b16 a[172:173], v17 offset:15584
  ds_read_b64_tr_b16 a[196:197], v17 offset:15616
  ds_read_b64_tr_b16 a[220:221], v17 offset:15648
  s_waitcnt lgkmcnt(0)
  s_mov_b64 exec, s[82:83]
  s_add_u32 m0, s11, 15360
  s_nop 0
  buffer_load_dwordx4 v16, s[92:95], s10 offen lds
  s_add_u32 s10, s10, 3840
  s_add_u32 m0, s11, 16320
  s_nop 0
  buffer_load_dwordx4 v16, s[92:95], s10 offen lds
  s_add_u32 s10, s10, 3840
  s_add_u32 m0, s11, 17280
  s_nop 0
  buffer_load_dwordx4 v16, s[92:95], s10 offen lds
  s_add_u32 s10, s10, 3840
  s_add_u32 m0, s11, 18240
  s_nop 0
  buffer_load_dwordx4 v16, s[92:95], s10 offen lds
  s_add_u32 s10, s10, 3840
  s_add_u32 m0, s11, 19200
  s_nop 0
  buffer_load_dwordx4 v16, s[92:95], s10 offen lds
  s_add_u32 s10, s10, 3840
  s_mov_b64 exec, -1
  s_waitcnt vmcnt(26)
  ds_read_b64_tr_b16 a[6:7], v17 offset:20480
  ds_read_b64_tr_b16 a[30:31], v17 offset:20512
  ds_read_b64_tr_b16 a[54:55], v17 offset:20544
  ds_read_b64_tr_b16 a[78:79], v17 offset:20576
  ds_read_b64_tr_b16 a[102:103], v17 offset:20608
  ds_read_b64_tr_b16 a[126:127], v17 offset:20640
  ds_read_b64_tr_b16 a[150:151], v17 offset:20672
  ds_read_b64_tr_b16 a[174:175], v17 offset:20704
  ds_read_b64_tr_b16 a[198:199], v17 offset:20736
  ds_read_b64_tr_b16 a[222:223], v17 offset:20768
  s_waitcnt lgkmcnt(0)
  s_mov_b64 exec, s[82:83]
  s_add_u32 m0, s11, 20160
  s_nop 0
  buffer_load_dwordx4 v16, s[92:95], s10 offen lds
  s_add_u32 s10, s10, 3840
  s_add_u32 m0, s11, 21120
  s_nop 0
  buffer_load_dwordx4 v16, s[92:95], s10 offen lds
  s_add_u32 s10, s10, 3840
  s_add_u32 m0, s11, 22080
  s_nop 0
  buffer_load_dwordx4 v16, s[92:95], s10 offen lds
  s_add_u32 s10, s10, 3840
  s_add_u32 m0, s11, 23040
  s_nop 0
  buffer_load_dwordx4 v16, s[92:95], s10 offen lds
  s_add_u32 s10, s10, 3840
  s_add_u32 m0, s11, 24000
  s_nop 0
  buffer_load_dwordx4 v16, s[92:95], s10 offen lds
  s_add_u32 s10, s10, 3840
  s_mov_b64 exec, -1
  s_waitcnt vmcnt(26)
  ds_read_b64_tr_b16 a[18:19], v17 offset:25600
  ds_read_b64_tr_b16 a[42:43], v17 offset:25632
  ds_read_b64_tr_b16 a[66:67], v17 offset:25664
  ds_read_b64_tr_b16 a[90:91], v17 offset:25696
  ds_read_b64_tr_b16 a[114:115], v17 offset:25728
  ds_read_b64_tr_b16 a[138:139], v17 offset:25760
  ds_read_b64_tr_b16 a[162:163], v17 offset:25792
  ds_read_b64_tr_b16 a[186:187], v17 offset:25824
  ds_read_b64_tr_b16 a[210:211], v17 offset:25856
  ds_read_b64_tr_b16 a[234:235], v17 offset:25888
  s_waitcnt lgkmcnt(0)
  s_mov_b64 exec, s[82:83]
  s_add_u32 m0, s11, 24960
  s_nop 0
  buffer_load_dwordx4 v16, s[92:95], s10 offen lds
  s_add_u32 s10, s10, 3840
  s_add_u32 m0, s11, 25920
  s_nop 0
  buffer_load_dwordx4 v16, s[92:95], s10 offen lds
  s_add_u32 s10, s10, 3840
  s_add_u32 m0, s11, 26880
  s_nop 0
  buffer_load_dwordx4 v16, s[92:95], s10 offen lds
  s_add_u32 s10, s10, 3840
  s_add_u32 m0, s11, 27840
  s_nop 0
  buffer_load_dwordx4 v16, s[92:95], s10 offen lds
  s_add_u32 s10, s10, 3840
  s_add_u32 m0, s11, 28800
  s_nop 0
  buffer_load_dwordx4 v16, s[92:95], s10 offen lds
  s_add_u32 s10, s10, 3840
  s_add_u32 m0, s11, 29760
  s_nop 0
  buffer_load_dwordx4 v16, s[92:95], s10 offen lds
  s_add_u32 s10, s10, 3840
  s_mov_b64 exec, -1
  s_waitcnt vmcnt(26)
  ds_read_b64_tr_b16 a[8:9], v17 offset:0
  ds_read_b64_tr_b16 a[32:33], v17 offset:32
  ds_read_b64_tr_b16 a[56:57], v17 offset:64
  ds_read_b64_tr_b16 a[80:81], v17 offset:96
  ds_read_b64_tr_b16 a[104:105], v17 offset:128
  ds_read_b64_tr_b16 a[128:129], v17 offset:160
  ds_read_b64_tr_b16 a[152:153], v17 offset:192
  ds_read_b64_tr_b16 a[176:177], v17 offset:224
  ds_read_b64_tr_b16 a[200:201], v17 offset:256
  ds_read_b64_tr_b16 a[224:225], v17 offset:288
  s_waitcnt vmcnt(21)
  ds_read_b64_tr_b16 a[10:11], v17 offset:5120
  ds_read_b64_tr_b16 a[34:35], v17 offset:5152
  ds_read_b64_tr_b16 a[58:59], v17 offset:5184
  ds_read_b64_tr_b16 a[82:83], v17 offset:5216
  ds_read_b64_tr_b16 a[106:107], v17 offset:5248
  ds_read_b64_tr_b16 a[130:131], v17 offset:5280
  ds_read_b64_tr_b16 a[154:155], v17 offset:5312
  ds_read_b64_tr_b16 a[178:179], v17 offset:5344
  ds_read_b64_tr_b16 a[202:203], v17 offset:5376
  ds_read_b64_tr_b16 a[226:227], v17 offset:5408
  s_waitcnt vmcnt(16)
  ds_read_b64_tr_b16 a[20:21], v17 offset:10240
  ds_read_b64_tr_b16 a[44:45], v17 offset:10272
  ds_read_b64_tr_b16 a[68:69], v17 offset:10304
  ds_read_b64_tr_b16 a[92:93], v17 offset:10336
  ds_read_b64_tr_b16 a[116:117], v17 offset:10368
  ds_read_b64_tr_b16 a[140:141], v17 offset:10400
  ds_read_b64_tr_b16 a[164:165], v17 offset:10432
  ds_read_b64_tr_b16 a[188:189], v17 offset:10464
  ds_read_b64_tr_b16 a[212:213], v17 offset:10496
  ds_read_b64_tr_b16 a[236:237], v17 offset:10528
  s_waitcnt vmcnt(10)
  ds_read_b64_tr_b16 a[12:13], v17 offset:15360
  ds_read_b64_tr_b16 a[36:37], v17 offset:15392
  ds_read_b64_tr_b16 a[60:61], v17 offset:15424
  ds_read_b64_tr_b16 a[84:85], v17 offset:15456
  ds_read_b64_tr_b16 a[108:109], v17 offset:15488
  ds_read_b64_tr_b16 a[132:133], v17 offset:15520
  ds_read_b64_tr_b16 a[156:157], v17 offset:15552
  ds_read_b64_tr_b16 a[180:181], v17 offset:15584
  ds_read_b64_tr_b16 a[204:205], v17 offset:15616
  ds_read_b64_tr_b16 a[228:229], v17 offset:15648
  s_waitcnt vmcnt(5)
  ds_read_b64_tr_b16 a[14:15], v17 offset:20480
  ds_read_b64_tr_b16 a[38:39], v17 offset:20512
  ds_read_b64_tr_b16 a[62:63], v17 offset:20544
  ds_read_b64_tr_b16 a[86:87], v17 offset:20576
  ds_read_b64_tr_b16 a[110:111], v17 offset:20608
  ds_read_b64_tr_b16 a[134:135], v17 offset:20640
  ds_read_b64_tr_b16 a[158:159], v17 offset:20672
  ds_read_b64_tr_b16 a[182:183], v17 offset:20704
  ds_read_b64_tr_b16 a[206:207], v17 offset:20736
  ds_read_b64_tr_b16 a[230:231], v17 offset:20768
  s_waitcnt vmcnt(0)
  ds_read_b64_tr_b16 a[22:23], v17 offset:25600
  ds_read_b64_tr_b16 a[46:47], v17 offset:25632
  ds_read_b64_tr_b16 a[70:71], v17 offset:25664
  ds_read_b64_tr_b16 a[94:95], v17 offset:25696
  ds_read_b64_tr_b16 a[118:119], v17 offset:25728
  ds_read_b64_tr_b16 a[142:143], v17 offset:25760
  ds_read_b64_tr_b16 a[166:167], v17 offset:25792
  ds_read_b64_tr_b16 a[190:191], v17 offset:25824
  ds_read_b64_tr_b16 a[214:215], v17 offset:25856
  ds_read_b64_tr_b16 a[238:239], v17 offset:25888
  s_waitcnt lgkmcnt(0)
  s_lshl_b32 s28, s68, 2
  v_mov_b32 v17, s28
  s_mov_b32 s28, 0
mega0_kernel_cen11:
  buffer_load_dword v16, v17, s[44:47], 0 offen sc1
  s_waitcnt vmcnt(0)
  v_readfirstlane_b32 s26, v16
  s_nop 0
  s_and_b32 s27, s26, 63
  s_cmp_eq_u32 s27, 32
  s_cbranch_scc1 mega0_kernel_cen11_done
  s_sleep 4
  s_add_u32 s28, s28, 1
  s_cmp_lt_u32 s28, 262144
  s_cbranch_scc1 mega0_kernel_cen11
  s_branch mega_fail
mega0_kernel_cen11_done:
  s_cmp_eq_u32 s26, s69
  s_cselect_b32 s69, 0, 1
  s_and_b32 s9, s80, 3
  s_mul_i32 s12, s9, 12288
  s_lshl_b32 s13, s3, 10
  s_add_u32 s12, s12, s13
  s_add_u32 s12, s12, s78
  s_add_u32 s12, s12, 253952
  s_add_u32 s13, s13, 122880
  v_add_u32 v5, 122880, v2
  s_mov_b32 s19, 12288
  s_mul_i32 s14, s9, 40960
  s_mul_i32 s15, s3, 10240
  s_add_u32 s14, s14, s15
  s_add_u32 s14, s14, s78
  s_lshl_b32 s21, s80, 7
  s_add_u32 s21, s21, s71
  s_lshl_b32 s15, s3, 2
  s_add_u32 s21, s21, s15
  s_add_u32 s21, s21, 12288
  v_bfe_u32 v8, v1, 4, 1
  v_sub_u32 v9, 2, v8
  v_and_b32 v6, 3, v1
  v_min_u32 v9, v9, v6
  v_lshlrev_b32 v9, 2, v9
  v_lshl_add_u32 v9, v8, 12, v9
  v_bfe_u32 v8, v1, 2, 2
  v_lshl_add_u32 v9, v8, 7, v9
  s_lshl_b32 s15, s68, 9
  s_add_u32 s15, s15, 16
  v_add_u32 v9, s15, v9
  v_mov_b32 v10, 4
  v_lshlrev_b32 v6, 2, v6
  s_lshl_b32 s15, s80, 7
  s_add_u32 s15, s15, 4096
  v_add_u32 v6, s15, v6
  s_add_u32 s64, s4, 93487104
  s_addc_u32 s65, s5, 0
  s_mov_b32 s25, 0
  s_load_dwordx16 s[48:63], s[64:65], 0
  s_waitcnt lgkmcnt(0)
  s_add_u32 s48, s48, s49
  s_add_u32 s48, s48, s50
  s_add_u32 s48, s48, s51
  s_add_u32 s48, s48, s52
  s_add_u32 s48, s48, s53
  s_add_u32 s48, s48, s54
  s_add_u32 s48, s48, s55
  s_cmp_ge_u32 s48, 4
  s_cselect_b32 s48, 0, 1
  s_or_b32 s25, s25, s48
  s_add_u32 s56, s56, s57
  s_add_u32 s56, s56, s58
  s_add_u32 s56, s56, s59
  s_add_u32 s56, s56, s60
  s_add_u32 s56, s56, s61
  s_add_u32 s56, s56, s62
  s_add_u32 s56, s56, s63
  s_cmp_ge_u32 s56, 4
  s_cselect_b32 s56, 0, 2
  s_or_b32 s25, s25, s56
  s_load_dwordx16 s[48:63], s[64:65], 64
  s_waitcnt lgkmcnt(0)
  s_add_u32 s48, s48, s49
  s_add_u32 s48, s48, s50
  s_add_u32 s48, s48, s51
  s_add_u32 s48, s48, s52
  s_add_u32 s48, s48, s53
  s_add_u32 s48, s48, s54
  s_add_u32 s48, s48, s55
  s_cmp_ge_u32 s48, 4
  s_cselect_b32 s48, 0, 4
  s_or_b32 s25, s25, s48
  s_add_u32 s56, s56, s57
  s_add_u32 s56, s56, s58
  s_add_u32 s56, s56, s59
  s_add_u32 s56, s56, s60
  s_add_u32 s56, s56, s61
  s_add_u32 s56, s56, s62
  s_add_u32 s56, s56, s63
  s_cmp_ge_u32 s56, 4
  s_cselect_b32 s56, 0, 8
  s_or_b32 s25, s25, s56
  s_and_b32 s26, s68, 3
  s_lshr_b32 s25, s25, s26
  s_lshr_b32 s27, s68, 2
  s_xor_b32 s25, s25, s27
  s_and_b32 s25, s25, 1
  s_lshl_b32 s25, s25, 13
  s_mul_i32 s26, s26, 2260992
  s_add_u32 s25, s25, s26
  s_add_u32 s26, s4, 58785791
  s_and_b32 s26, s26, 0xffe00000
  s_sub_u32 s26, s26, s4
  s_add_u32 s25, s25, s26
  s_lshl_b32 s26, s9, 2
  s_add_u32 s26, s26, s3
  s_lshr_b32 s27, s26, 3
  s_lshl_b32 s27, s27, 14
  s_and_b32 s26, s26, 7
  s_lshl_b32 s26, s26, 10
  s_add_u32 s25, s25, s26
  s_add_u32 s25, s25, s27
  s_mul_i32 s26, s70, 63
  s_add_u32 s26, s26, 2
  v_mov_b32 v12, -1
  v_mov_b32 v13, -1
  v_mov_b32 v14, -1
  v_mov_b32 v15, -1
  s_mov_b32 s20, 0
  s_mov_b32 s24, 1
mega_u_loop:
  s_mov_b32 s30, 0
mega0_kernel_pv12:
  buffer_load_dword v8, v6, s[4:7], s71 offen sc1
  s_waitcnt vmcnt(0)
mega0_kernel_pv12_t:
  v_cmp_gt_u32 vcc, s24, v8
  s_nop 0
  s_cbranch_vccz mega0_kernel_pv12_ok
  s_sleep 1
  s_add_u32 s30, s30, 1
  s_cmp_lt_u32 s30, 262144
  s_cbranch_scc1 mega0_kernel_pv12
  s_branch mega_fail
mega0_kernel_pv12_ok:
  s_add_u32 s15, s12, s20
  s_add_u32 m0, s13, 0
  s_add_u32 s22, s15, 0
  buffer_load_dwordx4 v2, s[4:7], s22 offen sc1 lds
  s_add_u32 m0, s13, 4096
  s_add_u32 s22, s15, 4096
  buffer_load_dwordx4 v2, s[4:7], s22 offen sc1 lds
  s_add_u32 m0, s13, 8192
  s_add_u32 s22, s15, 8192
  buffer_load_dwordx4 v2, s[4:7], s22 offen sc1 lds
  s_waitcnt vmcnt(0)
mega_u_have:
  s_barrier
  ds_read_b128 v[16:19], v5 offset:0
  ds_read_b128 v[40:43], v5 offset:4096
  ds_read_b128 v[20:23], v5 offset:1024
  ds_read_b128 v[44:47], v5 offset:5120
  ds_read_b128 v[24:27], v5 offset:2048
  ds_read_b128 v[48:51], v5 offset:6144
  ds_read_b128 v[28:31], v5 offset:3072
  ds_read_b128 v[52:55], v5 offset:7168
  ds_read_b64 v[32:33], v5 offset:8192
  ds_read_b64 v[34:35], v5 offset:9216
  ds_read_b64 v[56:57], v5 offset:8200
  ds_read_b64 v[58:59], v5 offset:9224
  ds_read_b64 v[36:37], v5 offset:10240
  ds_read_b64 v[38:39], v5 offset:11264
  s_waitcnt lgkmcnt(12)
  ds_read_b64 v[60:61], v5 offset:10248
  ds_read_b64 v[62:63], v5 offset:11272
  s_mov_b32 s30, 0
mega0_kernel_pv13:
  buffer_load_dword v8, v9, s[4:7], s71 offen sc1
  s_waitcnt vmcnt(0)
mega0_kernel_pv13_t:
  v_add_u32 v8, v8, v10
  v_cmp_gt_u32 vcc, s24, v8
  s_nop 0
  s_cbranch_vccz mega0_kernel_pv13_ok
  s_sleep 1
  s_add_u32 s30, s30, 1
  s_cmp_lt_u32 s30, 262144
  s_cbranch_scc1 mega0_kernel_pv13
  s_branch mega_fail
mega0_kernel_pv13_ok:
  s_waitcnt lgkmcnt(14)
  v_mfma_f32_16x16x32_bf16 v[112:115], v[16:19], a[0:3], 0
  s_add_u32 s16, s14, s20
  v_mfma_f32_16x16x32_bf16 v[116:119], v[40:43], a[0:3], 0
  s_add_u32 s17, s16, 4096
  s_waitcnt lgkmcnt(12)
  v_mfma_f32_16x16x32_bf16 v[112:115], v[20:23], a[4:7], v[112:115]
  s_add_u32 s18, s16, 8192
  v_mfma_f32_16x16x32_bf16 v[116:119], v[44:47], a[4:7], v[116:119]
  s_and_b32 s27, s26, 7
  s_waitcnt lgkmcnt(10)
  v_mfma_f32_16x16x32_bf16 v[112:115], v[24:27], a[8:11], v[112:115]
  s_mul_i32 s27, s27, 163840
  v_mfma_f32_16x16x32_bf16 v[116:119], v[48:51], a[8:11], v[116:119]
  s_add_u32 s27, s27, s25
  s_waitcnt lgkmcnt(8)
  v_mfma_f32_16x16x32_bf16 v[112:115], v[28:31], a[12:15], v[112:115]
  s_add_u32 s26, s26, 1
  v_mfma_f32_16x16x32_bf16 v[116:119], v[52:55], a[12:15], v[116:119]
  s_add_u32 s23, s24, 1
  s_waitcnt lgkmcnt(4)
  v_mfma_f32_16x16x32_bf16 v[112:115], v[32:35], a[16:19], v[112:115]
  v_add_u32 v5, s19, v5
  v_mfma_f32_16x16x32_bf16 v[116:119], v[56:59], a[16:19], v[116:119]
  s_waitcnt lgkmcnt(0)
  v_mfma_f32_16x16x32_bf16 v[112:115], v[36:39], a[20:23], v[112:115]
  buffer_store_dwordx4 v[12:15], v2, s[4:7], s27 offen sc1
  v_mfma_f32_16x16x32_bf16 v[116:119], v[60:63], a[20:23], v[116:119]
  s_add_u32 s27, s27, 32768
  v_mfma_f32_16x16x32_bf16 v[120:123], v[16:19], a[24:27], 0
  v_mfma_f32_16x16x32_bf16 v[124:127], v[40:43], a[24:27], 0
  s_add_u32 s13, s13, s19
  s_sub_u32 s19, 0, s19
  s_add_u32 s20, s20, 325632
  s_cmp_ge_u32 s20, 1302528
  s_cselect_b32 s20, 0, s20
  v_mfma_f32_16x16x32_bf16 v[120:123], v[20:23], a[28:31], v[120:123]
  v_mfma_f32_16x16x32_bf16 v[124:127], v[44:47], a[28:31], v[124:127]
  v_mfma_f32_16x16x32_bf16 v[120:123], v[24:27], a[32:35], v[120:123]
  v_cvt_pk_bf16_f32 v128, v112, v113
  v_mfma_f32_16x16x32_bf16 v[124:127], v[48:51], a[32:35], v[124:127]
  v_cvt_pk_bf16_f32 v129, v114, v115
  v_mfma_f32_16x16x32_bf16 v[120:123], v[28:31], a[36:39], v[120:123]
  v_cvt_pk_bf16_f32 v130, v116, v117
  v_mfma_f32_16x16x32_bf16 v[124:127], v[52:55], a[36:39], v[124:127]
  v_cvt_pk_bf16_f32 v131, v118, v119
  v_mfma_f32_16x16x32_bf16 v[120:123], v[32:35], a[40:43], v[120:123]
  buffer_store_dwordx4 v[128:131], v2, s[4:7], s16 offen offset:0
  v_mfma_f32_16x16x32_bf16 v[124:127], v[56:59], a[40:43], v[124:127]
  v_mfma_f32_16x16x32_bf16 v[120:123], v[36:39], a[44:47], v[120:123]
  buffer_store_dwordx4 v[12:15], v2, s[4:7], s27 offen sc1
  v_mfma_f32_16x16x32_bf16 v[124:127], v[60:63], a[44:47], v[124:127]
  s_add_u32 s27, s27, 32768
  v_mfma_f32_16x16x32_bf16 v[112:115], v[16:19], a[48:51], 0
  v_mfma_f32_16x16x32_bf16 v[116:119], v[40:43], a[48:51], 0
  v_mfma_f32_16x16x32_bf16 v[112:115], v[20:23], a[52:55], v[112:115]
  v_mfma_f32_16x16x32_bf16 v[116:119], v[44:47], a[52:55], v[116:119]
  v_mfma_f32_16x16x32_bf16 v[112:115], v[24:27], a[56:59], v[112:115]
  v_cvt_pk_bf16_f32 v132, v120, v121
  v_mfma_f32_16x16x32_bf16 v[116:119], v[48:51], a[56:59], v[116:119]
  v_cvt_pk_bf16_f32 v133, v122, v123
  v_mfma_f32_16x16x32_bf16 v[112:115], v[28:31], a[60:63], v[112:115]
  v_cvt_pk_bf16_f32 v134, v124, v125
  v_mfma_f32_16x16x32_bf16 v[116:119], v[52:55], a[60:63], v[116:119]
  v_cvt_pk_bf16_f32 v135, v126, v127
  v_mfma_f32_16x16x32_bf16 v[112:115], v[32:35], a[64:67], v[112:115]
  buffer_store_dwordx4 v[132:135], v2, s[4:7], s16 offen offset:1024
  v_mfma_f32_16x16x32_bf16 v[116:119], v[56:59], a[64:67], v[116:119]
  v_mfma_f32_16x16x32_bf16 v[112:115], v[36:39], a[68:71], v[112:115]
  buffer_store_dwordx4 v[12:15], v2, s[4:7], s27 offen sc1
  v_mfma_f32_16x16x32_bf16 v[116:119], v[60:63], a[68:71], v[116:119]
  s_add_u32 s27, s27, 32768
  v_mfma_f32_16x16x32_bf16 v[120:123], v[16:19], a[72:75], 0
  v_mfma_f32_16x16x32_bf16 v[124:127], v[40:43], a[72:75], 0
  v_mfma_f32_16x16x32_bf16 v[120:123], v[20:23], a[76:79], v[120:123]
  v_mfma_f32_16x16x32_bf16 v[124:127], v[44:47], a[76:79], v[124:127]
  v_mfma_f32_16x16x32_bf16 v[120:123], v[24:27], a[80:83], v[120:123]
  v_cvt_pk_bf16_f32 v128, v112, v113
  v_mfma_f32_16x16x32_bf16 v[124:127], v[48:51], a[80:83], v[124:127]
  v_cvt_pk_bf16_f32 v129, v114, v115
  v_mfma_f32_16x16x32_bf16 v[120:123], v[28:31], a[84:87], v[120:123]
  v_cvt_pk_bf16_f32 v130, v116, v117
  v_mfma_f32_16x16x32_bf16 v[124:127], v[52:55], a[84:87], v[124:127]
  v_cvt_pk_bf16_f32 v131, v118, v119
  v_mfma_f32_16x16x32_bf16 v[120:123], v[32:35], a[88:91], v[120:123]
  buffer_store_dwordx4 v[128:131], v2, s[4:7], s16 offen offset:2048
  v_mfma_f32_16x16x32_bf16 v[124:127], v[56:59], a[88:91], v[124:127]
  v_mfma_f32_16x16x32_bf16 v[120:123], v[36:39], a[92:95], v[120:123]
  buffer_store_dwordx4 v[12:15], v2, s[4:7], s27 offen sc1
  v_mfma_f32_16x16x32_bf16 v[124:127], v[60:63], a[92:95], v[124:127]
  s_add_u32 s27, s27, 32768
  v_mfma_f32_16x16x32_bf16 v[112:115], v[16:19], a[96:99], 0
  v_mfma_f32_16x16x32_bf16 v[116:119], v[40:43], a[96:99], 0
  v_mfma_f32_16x16x32_bf16 v[112:115], v[20:23], a[100:103], v[112:115]
  v_mfma_f32_16x16x32_bf16 v[116:119], v[44:47], a[100:103], v[116:119]
  v_mfma_f32_16x16x32_bf16 v[112:115], v[24:27], a[104:107], v[112:115]
  v_cvt_pk_bf16_f32 v132, v120, v121
  v_mfma_f32_16x16x32_bf16 v[116:119], v[48:51], a[104:107], v[116:119]
  v_cvt_pk_bf16_f32 v133, v122, v123
  v_mfma_f32_16x16x32_bf16 v[112:115], v[28:31], a[108:111], v[112:115]
  v_cvt_pk_bf16_f32 v134, v124, v125
  v_mfma_f32_16x16x32_bf16 v[116:119], v[52:55], a[108:111], v[116:119]
  v_cvt_pk_bf16_f32 v135, v126, v127
  v_mfma_f32_16x16x32_bf16 v[112:115], v[32:35], a[112:115], v[112:115]
  buffer_store_dwordx4 v[132:135], v2, s[4:7], s16 offen offset:3072
  v_mfma_f32_16x16x32_bf16 v[116:119], v[56:59], a[112:115], v[116:119]
  v_mfma_f32_16x16x32_bf16 v[112:115], v[36:39], a[116:119], v[112:115]
  buffer_store_dwordx4 v[12:15], v2, s[4:7], s27 offen sc1
  v_mfma_f32_16x16x32_bf16 v[116:119], v[60:63], a[116:119], v[116:119]
  s_add_u32 s27, s27, 32768
  v_mfma_f32_16x16x32_bf16 v[120:123], v[16:19], a[120:123], 0
  v_mfma_f32_16x16x32_bf16 v[124:127], v[40:43], a[120:123], 0
  v_mfma_f32_16x16x32_bf16 v[120:123], v[20:23], a[124:127], v[120:123]
  v_mfma_f32_16x16x32_bf16 v[124:127], v[44:47], a[124:127], v[124:127]
  v_mfma_f32_16x16x32_bf16 v[120:123], v[24:27], a[128:131], v[120:123]
  v_cvt_pk_bf16_f32 v128, v112, v113
  v_mfma_f32_16x16x32_bf16 v[124:127], v[48:51], a[128:131], v[124:127]
  v_cvt_pk_bf16_f32 v129, v114, v115
  v_mfma_f32_16x16x32_bf16 v[120:123], v[28:31], a[132:135], v[120:123]
  v_cvt_pk_bf16_f32 v130, v116, v117
  v_mfma_f32_16x16x32_bf16 v[124:127], v[52:55], a[132:135], v[124:127]
  v_cvt_pk_bf16_f32 v131, v118, v119
  v_mfma_f32_16x16x32_bf16 v[120:123], v[32:35], a[136:139], v[120:123]
  buffer_store_dwordx4 v[128:131], v2, s[4:7], s17 offen offset:0
  v_mfma_f32_16x16x32_bf16 v[124:127], v[56:59], a[136:139], v[124:127]
  v_mfma_f32_16x16x32_bf16 v[120:123], v[36:39], a[140:143], v[120:123]
  buffer_load_dword v8, v6, s[4:7], s71 offen sc1
  v_mfma_f32_16x16x32_bf16 v[124:127], v[60:63], a[140:143], v[124:127]
  v_mfma_f32_16x16x32_bf16 v[112:115], v[16:19], a[144:147], 0
  v_mfma_f32_16x16x32_bf16 v[116:119], v[40:43], a[144:147], 0
  v_mfma_f32_16x16x32_bf16 v[112:115], v[20:23], a[148:151], v[112:115]
  v_mfma_f32_16x16x32_bf16 v[116:119], v[44:47], a[148:151], v[116:119]
  v_mfma_f32_16x16x32_bf16 v[112:115], v[24:27], a[152:155], v[112:115]
  v_cvt_pk_bf16_f32 v132, v120, v121
  v_mfma_f32_16x16x32_bf16 v[116:119], v[48:51], a[152:155], v[116:119]
  v_cvt_pk_bf16_f32 v133, v122, v123
  v_mfma_f32_16x16x32_bf16 v[112:115], v[28:31], a[156:159], v[112:115]
  v_cvt_pk_bf16_f32 v134, v124, v125
  v_mfma_f32_16x16x32_bf16 v[116:119], v[52:55], a[156:159], v[116:119]
  v_cvt_pk_bf16_f32 v135, v126, v127
  v_mfma_f32_16x16x32_bf16 v[112:115], v[32:35], a[160:163], v[112:115]
  buffer_store_dwordx4 v[132:135], v2, s[4:7], s17 offen offset:1024
  v_mfma_f32_16x16x32_bf16 v[116:119], v[56:59], a[160:163], v[116:119]
  v_mfma_f32_16x16x32_bf16 v[112:115], v[36:39], a[164:167], v[112:115]
  v_mfma_f32_16x16x32_bf16 v[116:119], v[60:63], a[164:167], v[116:119]
  v_mfma_f32_16x16x32_bf16 v[120:123], v[16:19], a[168:171], 0
  v_mfma_f32_16x16x32_bf16 v[124:127], v[40:43], a[168:171], 0
  v_mfma_f32_16x16x32_bf16 v[120:123], v[20:23], a[172:175], v[120:123]
  v_mfma_f32_16x16x32_bf16 v[124:127], v[44:47], a[172:175], v[124:127]
  v_mfma_f32_16x16x32_bf16 v[120:123], v[24:27], a[176:179], v[120:123]
  v_cvt_pk_bf16_f32 v128, v112, v113
  v_mfma_f32_16x16x32_bf16 v[124:127], v[48:51], a[176:179], v[124:127]
  v_cvt_pk_bf16_f32 v129, v114, v115
  v_mfma_f32_16x16x32_bf16 v[120:123], v[28:31], a[180:183], v[120:123]
  v_cvt_pk_bf16_f32 v130, v116, v117
  v_mfma_f32_16x16x32_bf16 v[124:127], v[52:55], a[180:183], v[124:127]
  v_cvt_pk_bf16_f32 v131, v118, v119
  v_mfma_f32_16x16x32_bf16 v[120:123], v[32:35], a[184:187], v[120:123]
  buffer_store_dwordx4 v[128:131], v2, s[4:7], s17 offen offset:2048
  v_mfma_f32_16x16x32_bf16 v[124:127], v[56:59], a[184:187], v[124:127]
  v_mfma_f32_16x16x32_bf16 v[120:123], v[36:39], a[188:191], v[120:123]
  v_mfma_f32_16x16x32_bf16 v[124:127], v[60:63], a[188:191], v[124:127]
  v_mfma_f32_16x16x32_bf16 v[112:115], v[16:19], a[192:195], 0
  v_mfma_f32_16x16x32_bf16 v[116:119], v[40:43], a[192:195], 0
  v_mfma_f32_16x16x32_bf16 v[112:115], v[20:23], a[196:199], v[112:115]
  v_mfma_f32_16x16x32_bf16 v[116:119], v[44:47], a[196:199], v[116:119]
  v_mfma_f32_16x16x32_bf16 v[112:115], v[24:27], a[200:203], v[112:115]
  v_cvt_pk_bf16_f32 v132, v120, v121
  v_mfma_f32_16x16x32_bf16 v[116:119], v[48:51], a[200:203], v[116:119]
  v_cvt_pk_bf16_f32 v133, v122, v123
  v_mfma_f32_16x16x32_bf16 v[112:115], v[28:31], a[204:207], v[112:115]
  v_cvt_pk_bf16_f32 v134, v124, v125
  v_mfma_f32_16x16x32_bf16 v[116:119], v[52:55], a[204:207], v[116:119]
  v_cvt_pk_bf16_f32 v135, v126, v127
  v_mfma_f32_16x16x32_bf16 v[112:115], v[32:35], a[208:211], v[112:115]
  buffer_store_dwordx4 v[132:135], v2, s[4:7], s17 offen offset:3072
  v_mfma_f32_16x16x32_bf16 v[116:119], v[56:59], a[208:211], v[116:119]
  v_mfma_f32_16x16x32_bf16 v[112:115], v[36:39], a[212:215], v[112:115]
  v_mfma_f32_16x16x32_bf16 v[116:119], v[60:63], a[212:215], v[116:119]
  s_waitcnt vmcnt(3)
  v_cmp_gt_u32 vcc, s23, v8
  s_mov_b32 s28, 0
  s_cbranch_vccnz mega_u_nov
  s_add_u32 s15, s12, s20
  s_add_u32 m0, s13, 0
  s_add_u32 s22, s15, 0
  buffer_load_dwordx4 v2, s[4:7], s22 offen sc1 lds
  s_add_u32 m0, s13, 4096
  s_add_u32 s22, s15, 4096
  buffer_load_dwordx4 v2, s[4:7], s22 offen sc1 lds
  s_add_u32 m0, s13, 8192
  s_add_u32 s22, s15, 8192
  buffer_load_dwordx4 v2, s[4:7], s22 offen sc1 lds
  s_mov_b32 s28, 1
mega_u_nov:
  v_mfma_f32_16x16x32_bf16 v[120:123], v[16:19], a[216:219], 0
  v_mfma_f32_16x16x32_bf16 v[124:127], v[40:43], a[216:219], 0
  v_mfma_f32_16x16x32_bf16 v[120:123], v[20:23], a[220:223], v[120:123]
  v_mfma_f32_16x16x32_bf16 v[124:127], v[44:47], a[220:223], v[124:127]
  v_mfma_f32_16x16x32_bf16 v[120:123], v[24:27], a[224:227], v[120:123]
  v_cvt_pk_bf16_f32 v128, v112, v113
  v_mfma_f32_16x16x32_bf16 v[124:127], v[48:51], a[224:227], v[124:127]
  v_cvt_pk_bf16_f32 v129, v114, v115
  v_mfma_f32_16x16x32_bf16 v[120:123], v[28:31], a[228:231], v[120:123]
  v_cvt_pk_bf16_f32 v130, v116, v117
  v_mfma_f32_16x16x32_bf16 v[124:127], v[52:55], a[228:231], v[124:127]
  v_cvt_pk_bf16_f32 v131, v118, v119
  v_mfma_f32_16x16x32_bf16 v[120:123], v[32:35], a[232:235], v[120:123]
  buffer_store_dwordx4 v[128:131], v2, s[4:7], s18 offen offset:0
  v_mfma_f32_16x16x32_bf16 v[124:127], v[56:59], a[232:235], v[124:127]
  v_mfma_f32_16x16x32_bf16 v[120:123], v[36:39], a[236:239], v[120:123]
  v_mfma_f32_16x16x32_bf16 v[124:127], v[60:63], a[236:239], v[124:127]
  s_nop 4
  v_cvt_pk_bf16_f32 v132, v120, v121
  v_cvt_pk_bf16_f32 v133, v122, v123
  s_nop 0
  v_cvt_pk_bf16_f32 v134, v124, v125
  v_cvt_pk_bf16_f32 v135, v126, v127
  buffer_store_dwordx4 v[132:135], v2, s[4:7], s18 offen offset:1024
  s_waitcnt vmcnt(0)
  v_mov_b32 v8, s24
  s_mov_b64 exec, 1
  s_cmp_lg_u32 s69, 0
  s_cbranch_scc1 mega0_kernel_pf14
  buffer_store_dword v8, v7, s[4:7], s21 offen
mega0_kernel_pf14_b:
  s_mov_b64 exec, -1
  s_add_u32 s24, s24, 1
  s_cmp_eq_u32 s28, 1
  s_cbranch_scc1 mega_u_have
  s_cmp_le_u32 s24, 64
  s_cbranch_scc1 mega_u_loop
  s_cmp_lg_u32 s70, 0
  s_cbranch_scc1 mega_end
  s_lshl_b32 s73, s80, 2
  s_add_u32 s73, s73, s3
  s_add_u32 s73, s73, 512
mega_bjobs:
  s_load_dwordx2 s[52:53], s[0:1], 64
  s_mov_b32 s54, 0x258000
  s_mov_b32 s55, 0x20000
  s_load_dwordx2 s[56:57], s[0:1], 72
  s_mov_b32 s58, 0x6400
  s_mov_b32 s59, 0x20000
  s_load_dwordx2 s[60:61], s[0:1], 80
  s_mov_b32 s62, 0xc8000
  s_mov_b32 s63, 0x20000
  s_waitcnt lgkmcnt(0)
mega_bj:
  s_cmp_ge_u32 s73, 520
  s_cbranch_scc1 mega_bjdone
  s_mov_b32 s2, s73
  s_add_u32 s73, s73, 1024
  s_cmp_ge_u32 s2, 320
  s_cbranch_scc1 mega_bj1
  s_and_b32 s72, s2, 3
  s_lshr_b32 s2, s2, 2
  s_mul_hi_u32 s64, s2, 0x6666667
  s_mul_i32 s65, s64, 40
  s_sub_u32 s65, s2, s65
  s_mul_hi_u32 s66, s65, 0x33333334
  s_mul_i32 s67, s66, 5
  s_sub_u32 s67, s65, s67
  v_and_b32 v2, 15, v1
  v_lshrrev_b32 v3, 4, v1
  v_lshrrev_b32 v4, 2, v2
  v_and_b32 v5, 3, v2
  v_lshlrev_b32 v6, 3, v3
  v_mul_u32_u24 v7, 20, v4
  v_sub_u32 v6, v6, v7
  v_mul_i32_i24 v7, 40, v6
  v_mul_u32_u24 v8, 800, v4
  v_add_u32 v7, v7, v8
  v_lshl_add_u32 v7, v5, 1, v7
  s_mul_i32 s20, s66, 3200
  s_lshl_b32 s21, s67, 3
  s_add_u32 s20, s20, s21
  v_mov_b32 v9, 0x100000
  v_add_u32 v10, 0, v6
  v_cmp_gt_u32 vcc, 20, v10
  v_add_u32 v11, 0, v7
  s_nop 0
  v_cndmask_b32 v11, v9, v11, vcc
  buffer_load_ushort v32, v11, s[56:59], s20 offen
  v_add_u32 v10, 1, v6
  v_cmp_gt_u32 vcc, 20, v10
  v_add_u32 v11, 40, v7
  s_nop 0
  v_cndmask_b32 v11, v9, v11, vcc
  buffer_load_ushort v33, v11, s[56:59], s20 offen
  v_add_u32 v10, 2, v6
  v_cmp_gt_u32 vcc, 20, v10
  v_add_u32 v11, 80, v7
  s_nop 0
  v_cndmask_b32 v11, v9, v11, vcc
  buffer_load_ushort v34, v11, s[56:59], s20 offen
  v_add_u32 v10, 3, v6
  v_cmp_gt_u32 vcc, 20, v10
  v_add_u32 v11, 120, v7
  s_nop 0
  v_cndmask_b32 v11, v9, v11, vcc
  buffer_load_ushort v35, v11, s[56:59], s20 offen
  v_add_u32 v10, 4, v6
  v_cmp_gt_u32 vcc, 20, v10
  v_add_u32 v11, 160, v7
  s_nop 0
  v_cndmask_b32 v11, v9, v11, vcc
  buffer_load_ushort v36, v11, s[56:59], s20 offen
  v_add_u32 v10, 5, v6
  v_cmp_gt_u32 vcc, 20, v10
  v_add_u32 v11, 200, v7
  s_nop 0
  v_cndmask_b32 v11, v9, v11, vcc
  buffer_load_ushort v37, v11, s[56:59], s20 offen
  v_add_u32 v10, 6, v6
  v_cmp_gt_u32 vcc, 20, v10
  v_add_u32 v11, 240, v7
  s_nop 0
  v_cndmask_b32 v11, v9, v11, vcc
  buffer_load_ushort v38, v11, s[56:59], s20 offen
  v_add_u32 v10, 7, v6
  v_cmp_gt_u32 vcc, 20, v10
  v_add_u32 v11, 280, v7
  s_nop 0
  v_cndmask_b32 v11, v9, v11, vcc
  buffer_load_ushort v39, v11, s[56:59], s20 offen
  v_add_u32 v10, 32, v6
  v_cmp_gt_u32 vcc, 20, v10
  v_add_u32 v11, 1280, v7
  s_nop 0
  v_cndmask_b32 v11, v9, v11, vcc
  buffer_load_ushort v40, v11, s[56:59], s20 offen
  v_add_u32 v10, 33, v6
  v_cmp_gt_u32 vcc, 20, v10
  v_add_u32 v11, 1320, v7
  s_nop 0
  v_cndmask_b32 v11, v9, v11, vcc
  buffer_load_ushort v41, v11, s[56:59], s20 offen
  v_add_u32 v10, 34, v6
  v_cmp_gt_u32 vcc, 20, v10
  v_add_u32 v11, 1360, v7
  s_nop 0
  v_cndmask_b32 v11, v9, v11, vcc
  buffer_load_ushort v42, v11, s[56:59], s20 offen
  v_add_u32 v10, 35, v6
  v_cmp_gt_u32 vcc, 20, v10
  v_add_u32 v11, 1400, v7
  s_nop 0
  v_cndmask_b32 v11, v9, v11, vcc
  buffer_load_ushort v43, v11, s[56:59], s20 offen
  v_add_u32 v10, 36, v6
  v_cmp_gt_u32 vcc, 20, v10
  v_add_u32 v11, 1440, v7
  s_nop 0
  v_cndmask_b32 v11, v9, v11, vcc
  buffer_load_ushort v44, v11, s[56:59], s20 offen
  v_add_u32 v10, 37, v6
  v_cmp_gt_u32 vcc, 20, v10
  v_add_u32 v11, 1480, v7
  s_nop 0
  v_cndmask_b32 v11, v9, v11, vcc
  buffer_load_ushort v45, v11, s[56:59], s20 offen
  v_add_u32 v10, 38, v6
  v_cmp_gt_u32 vcc, 20, v10
  v_add_u32 v11, 1520, v7
  s_nop 0
  v_cndmask_b32 v11, v9, v11, vcc
  buffer_load_ushort v46, v11, s[56:59], s20 offen
  v_add_u32 v10, 39, v6
  v_cmp_gt_u32 vcc, 20, v10
  v_add_u32 v11, 1560, v7
  s_nop 0
  v_cndmask_b32 v11, v9, v11, vcc
  buffer_load_ushort v47, v11, s[56:59], s20 offen
  v_add_u32 v10, 64, v6
  v_cmp_gt_u32 vcc, 20, v10
  v_add_u32 v11, 2560, v7
  s_nop 0
  v_cndmask_b32 v11, v9, v11, vcc
  buffer_load_ushort v48, v11, s[56:59], s20 offen
  v_add_u32 v10, 65, v6
  v_cmp_gt_u32 vcc, 20, v10
  v_add_u32 v11, 2600, v7
  s_nop 0
  v_cndmask_b32 v11, v9, v11, vcc
  buffer_load_ushort v49, v11, s[56:59], s20 offen
  v_add_u32 v10, 66, v6
  v_cmp_gt_u32 vcc, 20, v10
  v_add_u32 v11, 2640, v7
  s_nop 0
  v_cndmask_b32 v11, v9, v11, vcc
  buffer_load_ushort v50, v11, s[56:59], s20 offen
  v_add_u32 v10, 67, v6
  v_cmp_gt_u32 vcc, 20, v10
  v_add_u32 v11, 2680, v7
  s_nop 0
  v_cndmask_b32 v11, v9, v11, vcc
  buffer_load_ushort v51, v11, s[56:59], s20 offen
  v_add_u32 v10, 68, v6
  v_cmp_gt_u32 vcc, 20, v10
  v_add_u32 v11, 2720, v7
  s_nop 0
  v_cndmask_b32 v11, v9, v11, vcc
  buffer_load_ushort v52, v11, s[56:59], s20 offen
  v_add_u32 v10, 69, v6
  v_cmp_gt_u32 vcc, 20, v10
  v_add_u32 v11, 2760, v7
  s_nop 0
  v_cndmask_b32 v11, v9, v11, vcc
  buffer_load_ushort v53, v11, s[56:59], s20 offen
  v_add_u32 v10, 70, v6
  v_cmp_gt_u32 vcc, 20, v10
  v_add_u32 v11, 2800, v7
  s_nop 0
  v_cndmask_b32 v11, v9, v11, vcc
  buffer_load_ushort v54, v11, s[56:59], s20 offen
  v_add_u32 v10, 71, v6
  v_cmp_gt_u32 vcc, 20, v10
  v_add_u32 v11, 2840, v7
  s_nop 0
  v_cndmask_b32 v11, v9, v11, vcc
  buffer_load_ushort v55, v11, s[56:59], s20 offen
  v_lshl_add_u32 v10, v4, 3, v5
  v_mul_u32_u24 v10, 3840, v10
  v_lshl_add_u32 v10, v3, 4, v10
  v_add_u32 v11, 15360, v10
  s_mul_i32 s21, s64, 1280
  s_mul_i32 s22, s66, 160
  s_add_u32 s21, s21, s22
  s_mul_i32 s22, s72, 614400
  s_add_u32 s21, s21, s22
  s_mul_i32 s22, s66, 307200
  s_mul_i32 s23, s64, 5
  s_add_u32 s23, s23, s67
  s_lshl_b32 s23, s23, 10
  s_add_u32 s22, s22, s23
  s_add_u32 s22, s22, 93491200
  s_mul_i32 s23, s72, 76800
  s_add_u32 s22, s22, s23
  v_lshlrev_b32 v12, 4, v1
  buffer_load_dwordx4 a[0:3], v10, s[52:55], s21 offen offset:0
  buffer_load_dwordx4 a[4:7], v10, s[52:55], s21 offen offset:64
  buffer_load_dwordx4 a[8:11], v10, s[52:55], s21 offen offset:128
  buffer_load_dwordx4 a[12:15], v11, s[52:55], s21 offen offset:0
  buffer_load_dwordx4 a[16:19], v11, s[52:55], s21 offen offset:64
  buffer_load_dwordx4 a[20:23], v11, s[52:55], s21 offen offset:128
  s_add_u32 s21, s21, 122880
  buffer_load_dwordx4 a[24:27], v10, s[52:55], s21 offen offset:0
  buffer_load_dwordx4 a[28:31], v10, s[52:55], s21 offen offset:64
  buffer_load_dwordx4 a[32:35], v10, s[52:55], s21 offen offset:128
  buffer_load_dwordx4 a[36:39], v11, s[52:55], s21 offen offset:0
  buffer_load_dwordx4 a[40:43], v11, s[52:55], s21 offen offset:64
  buffer_load_dwordx4 a[44:47], v11, s[52:55], s21 offen offset:128
  s_add_u32 s21, s21, 122880
  buffer_load_dwordx4 a[48:51], v10, s[52:55], s21 offen offset:0
  buffer_load_dwordx4 a[52:55], v10, s[52:55], s21 offen offset:64
  buffer_load_dwordx4 a[56:59], v10, s[52:55], s21 offen offset:128
  buffer_load_dwordx4 a[60:63], v11, s[52:55], s21 offen offset:0
  buffer_load_dwordx4 a[64:67], v11, s[52:55], s21 offen offset:64
  buffer_load_dwordx4 a[68:71], v11, s[52:55], s21 offen offset:128
  s_add_u32 s21, s21, 122880
  buffer_load_dwordx4 a[72:75], v10, s[52:55], s21 offen offset:0
  buffer_load_dwordx4 a[76:79], v10, s[52:55], s21 offen offset:64
  buffer_load_dwordx4 a[80:83], v10, s[52:55], s21 offen offset:128
  buffer_load_dwordx4 a[84:87], v11, s[52:55], s21 offen offset:0
  buffer_load_dwordx4 a[88:91], v11, s[52:55], s21 offen offset:64
  buffer_load_dwordx4 a[92:95], v11, s[52:55], s21 offen offset:128
  s_add_u32 s21, s21, 122880
  buffer_load_dwordx4 a[96:99], v10, s[52:55], s21 offen offset:0
  buffer_load_dwordx4 a[100:103], v10, s[52:55], s21 offen offset:64
  buffer_load_dwordx4 a[104:107], v10, s[52:55], s21 offen offset:128
  buffer_load_dwordx4 a[108:111], v11, s[52:55], s21 offen offset:0
  buffer_load_dwordx4 a[112:115], v11, s[52:55], s21 offen offset:64
  buffer_load_dwordx4 a[116:119], v11, s[52:55], s21 offen offset:128
  s_add_u32 s21, s21, 122880
  s_waitcnt vmcnt(30)
  v_lshl_or_b32 v16, v33, 16, v32
  v_lshl_or_b32 v17, v35, 16, v34
  v_lshl_or_b32 v18, v37, 16, v36
  v_lshl_or_b32 v19, v39, 16, v38
  v_lshl_or_b32 v20, v41, 16, v40
  v_lshl_or_b32 v21, v43, 16, v42
  v_lshl_or_b32 v22, v45, 16, v44
  v_lshl_or_b32 v23, v47, 16, v46
  v_lshl_or_b32 v24, v49, 16, v48
  v_lshl_or_b32 v25, v51, 16, v50
  v_lshl_or_b32 v26, v53, 16, v52
  v_lshl_or_b32 v27, v55, 16, v54
  s_waitcnt vmcnt(24)
  v_mfma_f32_16x16x32_bf16 v[56:59], a[0:3], v[16:19], 0
  v_mfma_f32_16x16x32_bf16 v[56:59], a[4:7], v[20:23], v[56:59]
  v_mfma_f32_16x16x32_bf16 v[56:59], a[8:11], v[24:27], v[56:59]
  v_mfma_f32_16x16x32_bf16 v[60:63], a[12:15], v[16:19], 0
  v_mfma_f32_16x16x32_bf16 v[60:63], a[16:19], v[20:23], v[60:63]
  v_mfma_f32_16x16x32_bf16 v[60:63], a[20:23], v[24:27], v[60:63]
  s_waitcnt vmcnt(18)
  v_mfma_f32_16x16x32_bf16 v[64:67], a[24:27], v[16:19], 0
  v_mfma_f32_16x16x32_bf16 v[64:67], a[28:31], v[20:23], v[64:67]
  v_mfma_f32_16x16x32_bf16 v[64:67], a[32:35], v[24:27], v[64:67]
  v_mfma_f32_16x16x32_bf16 v[68:71], a[36:39], v[16:19], 0
  v_mfma_f32_16x16x32_bf16 v[68:71], a[40:43], v[20:23], v[68:71]
  v_mfma_f32_16x16x32_bf16 v[68:71], a[44:47], v[24:27], v[68:71]
  s_waitcnt vmcnt(12)
  v_mfma_f32_16x16x32_bf16 v[72:75], a[48:51], v[16:19], 0
  v_mfma_f32_16x16x32_bf16 v[72:75], a[52:55], v[20:23], v[72:75]
  v_mfma_f32_16x16x32_bf16 v[72:75], a[56:59], v[24:27], v[72:75]
  v_mfma_f32_16x16x32_bf16 v[76:79], a[60:63], v[16:19], 0
  v_mfma_f32_16x16x32_bf16 v[76:79], a[64:67], v[20:23], v[76:79]
  v_mfma_f32_16x16x32_bf16 v[76:79], a[68:71], v[24:27], v[76:79]
  s_waitcnt vmcnt(6)
  v_mfma_f32_16x16x32_bf16 v[80:83], a[72:75], v[16:19], 0
  v_mfma_f32_16x16x32_bf16 v[80:83], a[76:79], v[20:23], v[80:83]
  v_mfma_f32_16x16x32_bf16 v[80:83], a[80:83], v[24:27], v[80:83]
  v_mfma_f32_16x16x32_bf16 v[84:87], a[84:87], v[16:19], 0
  v_mfma_f32_16x16x32_bf16 v[84:87], a[88:91], v[20:23], v[84:87]
  v_mfma_f32_16x16x32_bf16 v[84:87], a[92:95], v[24:27], v[84:87]
  s_waitcnt vmcnt(0)
  v_mfma_f32_16x16x32_bf16 v[88:91], a[96:99], v[16:19], 0
  v_mfma_f32_16x16x32_bf16 v[88:91], a[100:103], v[20:23], v[88:91]
  v_mfma_f32_16x16x32_bf16 v[88:91], a[104:107], v[24:27], v[88:91]
  v_mfma_f32_16x16x32_bf16 v[92:95], a[108:111], v[16:19], 0
  v_mfma_f32_16x16x32_bf16 v[92:95], a[112:115], v[20:23], v[92:95]
  v_mfma_f32_16x16x32_bf16 v[92:95], a[116:119], v[24:27], v[92:95]
  v_cvt_pk_bf16_f32 v56, v56, v57
  v_cvt_pk_bf16_f32 v57, v58, v59
  v_cvt_pk_bf16_f32 v58, v60, v61
  v_cvt_pk_bf16_f32 v59, v62, v63
  buffer_store_dwordx4 v[56:59], v12, s[4:7], s22 offen
  s_add_u32 s22, s22, 15360
  v_cvt_pk_bf16_f32 v64, v64, v65
  v_cvt_pk_bf16_f32 v65, v66, v67
  v_cvt_pk_bf16_f32 v66, v68, v69
  v_cvt_pk_bf16_f32 v67, v70, v71
  buffer_store_dwordx4 v[64:67], v12, s[4:7], s22 offen
  s_add_u32 s22, s22, 15360
  v_cvt_pk_bf16_f32 v72, v72, v73
  v_cvt_pk_bf16_f32 v73, v74, v75
  v_cvt_pk_bf16_f32 v74, v76, v77
  v_cvt_pk_bf16_f32 v75, v78, v79
  buffer_store_dwordx4 v[72:75], v12, s[4:7], s22 offen
  s_add_u32 s22, s22, 15360
  v_cvt_pk_bf16_f32 v80, v80, v81
  v_cvt_pk_bf16_f32 v81, v82, v83
  v_cvt_pk_bf16_f32 v82, v84, v85
  v_cvt_pk_bf16_f32 v83, v86, v87
  buffer_store_dwordx4 v[80:83], v12, s[4:7], s22 offen
  s_add_u32 s22, s22, 15360
  v_cvt_pk_bf16_f32 v88, v88, v89
  v_cvt_pk_bf16_f32 v89, v90, v91
  v_cvt_pk_bf16_f32 v90, v92, v93
  v_cvt_pk_bf16_f32 v91, v94, v95
  buffer_store_dwordx4 v[88:91], v12, s[4:7], s22 offen
  s_add_u32 s22, s22, 15360
  s_branch mega_bj
mega_bj1:
  s_cmp_ge_u32 s2, 420
  s_cbranch_scc1 mega_bj2
  s_sub_u32 s2, s2, 320
  s_mul_hi_u32 s66, s2, 0x33333334
  s_mul_i32 s67, s66, 5
  s_sub_u32 s67, s2, s67
  s_mul_i32 s20, s66, 122880
  s_lshl_b32 s68, s67, 8
  s_add_u32 s20, s20, s68
  s_add_u32 s20, s20, 2560
  s_mov_b32 s21, 30720
  s_mov_b32 s22, 15360
  s_mov_b32 s23, 3840
  s_mul_i32 s24, s66, 15360
  s_add_u32 s24, s24, 93501440
  s_lshl_b32 s25, s67, 3
  v_lshlrev_b32 v2, 2, v1
  v_lshrrev_b32 v3, 3, v1
  v_add_u32 v3, s25, v3
  v_mul_u32_u24 v4, 205, v3
  v_lshrrev_b32 v4, 10, v4
  v_mul_u32_u24 v5, 5, v4
  v_sub_u32 v3, v3, v5
  v_lshlrev_b32 v3, 10, v3
  v_mul_u32_u24 v4, 307200, v4
  v_add_u32 v3, v3, v4
  v_and_b32 v4, 7, v1
  v_lshl_add_u32 v3, v4, 5, v3
  s_mov_b32 s26, 0x05040100
  s_mov_b32 s27, 0x07060302
  s_mov_b32 s28, s20
  buffer_load_dword v8, v2, s[52:55], s28 offen
  s_add_u32 s28, s28, s23
  buffer_load_dword v9, v2, s[52:55], s28 offen
  s_add_u32 s28, s28, s23
  buffer_load_dword v10, v2, s[52:55], s28 offen
  s_add_u32 s28, s28, s23
  buffer_load_dword v11, v2, s[52:55], s28 offen
  s_add_u32 s28, s20, s22
  buffer_load_dword v12, v2, s[52:55], s28 offen
  s_add_u32 s28, s28, s23
  buffer_load_dword v13, v2, s[52:55], s28 offen
  s_add_u32 s28, s28, s23
  buffer_load_dword v14, v2, s[52:55], s28 offen
  s_add_u32 s28, s28, s23
  buffer_load_dword v15, v2, s[52:55], s28 offen
  s_add_u32 s20, s20, s21
  s_mov_b32 s28, s20
  buffer_load_dword v16, v2, s[52:55], s28 offen
  s_add_u32 s28, s28, s23
  buffer_load_dword v17, v2, s[52:55], s28 offen
  s_add_u32 s28, s28, s23
  buffer_load_dword v18, v2, s[52:55], s28 offen
  s_add_u32 s28, s28, s23
  buffer_load_dword v19, v2, s[52:55], s28 offen
  s_add_u32 s28, s20, s22
  buffer_load_dword v20, v2, s[52:55], s28 offen
  s_add_u32 s28, s28, s23
  buffer_load_dword v21, v2, s[52:55], s28 offen
  s_add_u32 s28, s28, s23
  buffer_load_dword v22, v2, s[52:55], s28 offen
  s_add_u32 s28, s28, s23
  buffer_load_dword v23, v2, s[52:55], s28 offen
  s_add_u32 s20, s20, s21
  s_mov_b32 s28, s20
  buffer_load_dword v24, v2, s[52:55], s28 offen
  s_add_u32 s28, s28, s23
  buffer_load_dword v25, v2, s[52:55], s28 offen
  s_add_u32 s28, s28, s23
  buffer_load_dword v26, v2, s[52:55], s28 offen
  s_add_u32 s28, s28, s23
  buffer_load_dword v27, v2, s[52:55], s28 offen
  s_add_u32 s28, s20, s22
  buffer_load_dword v28, v2, s[52:55], s28 offen
  s_add_u32 s28, s28, s23
  buffer_load_dword v29, v2, s[52:55], s28 offen
  s_add_u32 s28, s28, s23
  buffer_load_dword v30, v2, s[52:55], s28 offen
  s_add_u32 s28, s28, s23
  buffer_load_dword v31, v2, s[52:55], s28 offen
  s_add_u32 s20, s20, s21
  s_mov_b32 s28, s20
  buffer_load_dword v32, v2, s[52:55], s28 offen
  s_add_u32 s28, s28, s23
  buffer_load_dword v33, v2, s[52:55], s28 offen
  s_add_u32 s28, s28, s23
  buffer_load_dword v34, v2, s[52:55], s28 offen
  s_add_u32 s28, s28, s23
  buffer_load_dword v35, v2, s[52:55], s28 offen
  s_add_u32 s28, s20, s22
  buffer_load_dword v36, v2, s[52:55], s28 offen
  s_add_u32 s28, s28, s23
  buffer_load_dword v37, v2, s[52:55], s28 offen
  s_add_u32 s28, s28, s23
  buffer_load_dword v38, v2, s[52:55], s28 offen
  s_add_u32 s28, s28, s23
  buffer_load_dword v39, v2, s[52:55], s28 offen
  s_waitcnt vmcnt(24)
  v_perm_b32 v40, v9, v8, s26
  v_perm_b32 v44, v9, v8, s27
  v_perm_b32 v41, v11, v10, s26
  v_perm_b32 v45, v11, v10, s27
  v_perm_b32 v42, v13, v12, s26
  v_perm_b32 v46, v13, v12, s27
  v_perm_b32 v43, v15, v14, s26
  v_perm_b32 v47, v15, v14, s27
  buffer_store_dwordx4 v[40:43], v3, s[4:7], s24 offen offset:0
  buffer_store_dwordx4 v[44:47], v3, s[4:7], s24 offen offset:16
  s_waitcnt vmcnt(18)
  v_perm_b32 v48, v17, v16, s26
  v_perm_b32 v52, v17, v16, s27
  v_perm_b32 v49, v19, v18, s26
  v_perm_b32 v53, v19, v18, s27
  v_perm_b32 v50, v21, v20, s26
  v_perm_b32 v54, v21, v20, s27
  v_perm_b32 v51, v23, v22, s26
  v_perm_b32 v55, v23, v22, s27
  buffer_store_dwordx4 v[48:51], v3, s[4:7], s24 offen offset:256
  buffer_store_dwordx4 v[52:55], v3, s[4:7], s24 offen offset:272
  s_waitcnt vmcnt(12)
  v_perm_b32 v56, v25, v24, s26
  v_perm_b32 v60, v25, v24, s27
  v_perm_b32 v57, v27, v26, s26
  v_perm_b32 v61, v27, v26, s27
  v_perm_b32 v58, v29, v28, s26
  v_perm_b32 v62, v29, v28, s27
  v_perm_b32 v59, v31, v30, s26
  v_perm_b32 v63, v31, v30, s27
  buffer_store_dwordx4 v[56:59], v3, s[4:7], s24 offen offset:512
  buffer_store_dwordx4 v[60:63], v3, s[4:7], s24 offen offset:528
  s_waitcnt vmcnt(6)
  v_perm_b32 v64, v33, v32, s26
  v_perm_b32 v68, v33, v32, s27
  v_perm_b32 v65, v35, v34, s26
  v_perm_b32 v69, v35, v34, s27
  v_perm_b32 v66, v37, v36, s26
  v_perm_b32 v70, v37, v36, s27
  v_perm_b32 v67, v39, v38, s26
  v_perm_b32 v71, v39, v38, s27
  buffer_store_dwordx4 v[64:67], v3, s[4:7], s24 offen offset:768
  buffer_store_dwordx4 v[68:71], v3, s[4:7], s24 offen offset:784
  s_branch mega_bj
mega_bj2:
  s_sub_u32 s2, s2, 420
  s_mul_hi_u32 s66, s2, 0x33333334
  s_mul_i32 s67, s66, 5
  s_sub_u32 s67, s2, s67
  s_mul_hi_u32 s64, s66, 0x33333334
  s_mul_i32 s65, s64, 5
  s_sub_u32 s65, s66, s65
  s_lshl_b32 s68, s65, 3
  s_add_u32 s69, s68, 60
  s_cmp_lt_u32 s65, 3
  s_cselect_b32 s68, s68, s69
  s_cmp_eq_u32 s65, 2
  s_cselect_b32 s22, 64, 4
  s_mul_i32 s22, s22, 1280
  s_mul_i32 s69, s64, 160
  s_add_u32 s68, s68, s69
  s_mul_i32 s20, s68, 1280
  s_lshl_b32 s68, s67, 8
  s_add_u32 s20, s20, s68
  s_mov_b32 s21, 25600
  s_mov_b32 s23, 1280
  s_mul_i32 s24, s67, 163840
  s_lshl_b32 s68, s66, 10
  s_add_u32 s24, s24, s68
  s_add_u32 s24, s24, 95948800
  v_lshlrev_b32 v2, 2, v1
  v_lshrrev_b32 v3, 4, v1
  v_lshlrev_b32 v3, 1, v3
  v_bfe_u32 v4, v1, 1, 1
  v_add_u32 v3, v3, v4
  v_mul_u32_u24 v3, 20480, v3
  v_bfe_u32 v4, v1, 2, 2
  v_lshl_add_u32 v3, v4, 6, v3
  v_and_b32 v4, 1, v1
  v_lshl_add_u32 v3, v4, 5, v3
  s_mov_b32 s26, 0x05040100
  s_mov_b32 s27, 0x07060302
  s_mov_b32 s28, s20
  buffer_load_dword v8, v2, s[60:63], s28 offen
  s_add_u32 s28, s28, s23
  buffer_load_dword v9, v2, s[60:63], s28 offen
  s_add_u32 s28, s28, s23
  buffer_load_dword v10, v2, s[60:63], s28 offen
  s_add_u32 s28, s28, s23
  buffer_load_dword v11, v2, s[60:63], s28 offen
  s_add_u32 s28, s20, s22
  buffer_load_dword v12, v2, s[60:63], s28 offen
  s_add_u32 s28, s28, s23
  buffer_load_dword v13, v2, s[60:63], s28 offen
  s_add_u32 s28, s28, s23
  buffer_load_dword v14, v2, s[60:63], s28 offen
  s_add_u32 s28, s28, s23
  buffer_load_dword v15, v2, s[60:63], s28 offen
  s_add_u32 s20, s20, s21
  s_mov_b32 s28, s20
  buffer_load_dword v16, v2, s[60:63], s28 offen
  s_add_u32 s28, s28, s23
  buffer_load_dword v17, v2, s[60:63], s28 offen
  s_add_u32 s28, s28, s23
  buffer_load_dword v18, v2, s[60:63], s28 offen
  s_add_u32 s28, s28, s23
  buffer_load_dword v19, v2, s[60:63], s28 offen
  s_add_u32 s28, s20, s22
  buffer_load_dword v20, v2, s[60:63], s28 offen
  s_add_u32 s28, s28, s23
  buffer_load_dword v21, v2, s[60:63], s28 offen
  s_add_u32 s28, s28, s23
  buffer_load_dword v22, v2, s[60:63], s28 offen
  s_add_u32 s28, s28, s23
  buffer_load_dword v23, v2, s[60:63], s28 offen
  s_add_u32 s20, s20, s21
  s_mov_b32 s28, s20
  buffer_load_dword v24, v2, s[60:63], s28 offen
  s_add_u32 s28, s28, s23
  buffer_load_dword v25, v2, s[60:63], s28 offen
  s_add_u32 s28, s28, s23
  buffer_load_dword v26, v2, s[60:63], s28 offen
  s_add_u32 s28, s28, s23
  buffer_load_dword v27, v2, s[60:63], s28 offen
  s_add_u32 s28, s20, s22
  buffer_load_dword v28, v2, s[60:63], s28 offen
  s_add_u32 s28, s28, s23
  buffer_load_dword v29, v2, s[60:63], s28 offen
  s_add_u32 s28, s28, s23
  buffer_load_dword v30, v2, s[60:63], s28 offen
  s_add_u32 s28, s28, s23
  buffer_load_dword v31, v2, s[60:63], s28 offen
  s_add_u32 s20, s20, s21
  s_mov_b32 s28, s20
  buffer_load_dword v32, v2, s[60:63], s28 offen
  s_add_u32 s28, s28, s23
  buffer_load_dword v33, v2, s[60:63], s28 offen
  s_add_u32 s28, s28, s23
  buffer_load_dword v34, v2, s[60:63], s28 offen
  s_add_u32 s28, s28, s23
  buffer_load_dword v35, v2, s[60:63], s28 offen
  s_add_u32 s28, s20, s22
  buffer_load_dword v36, v2, s[60:63], s28 offen
  s_add_u32 s28, s28, s23
  buffer_load_dword v37, v2, s[60:63], s28 offen
  s_add_u32 s28, s28, s23
  buffer_load_dword v38, v2, s[60:63], s28 offen
  s_add_u32 s28, s28, s23
  buffer_load_dword v39, v2, s[60:63], s28 offen
  s_waitcnt vmcnt(24)
  v_perm_b32 v40, v9, v8, s26
  v_perm_b32 v44, v9, v8, s27
  v_perm_b32 v41, v11, v10, s26
  v_perm_b32 v45, v11, v10, s27
  v_perm_b32 v42, v13, v12, s26
  v_perm_b32 v46, v13, v12, s27
  v_perm_b32 v43, v15, v14, s26
  v_perm_b32 v47, v15, v14, s27
  buffer_store_dwordx4 v[40:43], v3, s[4:7], s24 offen offset:0
  buffer_store_dwordx4 v[44:47], v3, s[4:7], s24 offen offset:16
  s_waitcnt vmcnt(18)
  v_perm_b32 v48, v17, v16, s26
  v_perm_b32 v52, v17, v16, s27
  v_perm_b32 v49, v19, v18, s26
  v_perm_b32 v53, v19, v18, s27
  v_perm_b32 v50, v21, v20, s26
  v_perm_b32 v54, v21, v20, s27
  v_perm_b32 v51, v23, v22, s26
  v_perm_b32 v55, v23, v22, s27
  buffer_store_dwordx4 v[48:51], v3, s[4:7], s24 offen offset:256
  buffer_store_dwordx4 v[52:55], v3, s[4:7], s24 offen offset:272
  s_waitcnt vmcnt(12)
  v_perm_b32 v56, v25, v24, s26
  v_perm_b32 v60, v25, v24, s27
  v_perm_b32 v57, v27, v26, s26
  v_perm_b32 v61, v27, v26, s27
  v_perm_b32 v58, v29, v28, s26
  v_perm_b32 v62, v29, v28, s27
  v_perm_b32 v59, v31, v30, s26
  v_perm_b32 v63, v31, v30, s27
  buffer_store_dwordx4 v[56:59], v3, s[4:7], s24 offen offset:512
  buffer_store_dwordx4 v[60:63], v3, s[4:7], s24 offen offset:528
  s_waitcnt vmcnt(6)
  v_perm_b32 v64, v33, v32, s26
  v_perm_b32 v68, v33, v32, s27
  v_perm_b32 v65, v35, v34, s26
  v_perm_b32 v69, v35, v34, s27
  v_perm_b32 v66, v37, v36, s26
  v_perm_b32 v70, v37, v36, s27
  v_perm_b32 v67, v39, v38, s26
  v_perm_b32 v71, v39, v38, s27
  buffer_store_dwordx4 v[64:67], v3, s[4:7], s24 offen offset:768
  buffer_store_dwordx4 v[68:71], v3, s[4:7], s24 offen offset:784
  s_branch mega_bj
mega_bjdone:
  s_endpgm
mega_qrole:
  v_lshlrev_b32 v2, 4, v1
  v_mov_b32 v7, 0
  s_mul_i32 s10, s80, 384
  s_mul_i32 s11, s3, 96
  s_add_u32 s10, s10, s11
  s_mul_i32 s11, s3, 30720
  s_add_u32 s11, s11, 40960
  v_mul_u32_u24 v18, 10923, v1
  v_lshrrev_b32 v18, 16, v18
  v_mul_u32_u24 v16, 6, v18
  v_sub_u32 v16, v1, v16
  v_lshlrev_b32 v16, 4, v16
  v_mul_u32_u24 v18, 12288, v18
  v_add_u32 v16, v16, v18
  v_lshrrev_b32 v18, 4, v1
  v_mul_u32_u24 v18, 8, v18
  v_bfe_u32 v17, v1, 2, 2
  v_add_u32 v18, v18, v17
  v_mul_u32_u24 v18, 96, v18
  v_and_b32 v17, 3, v1
  v_lshl_add_u32 v17, v17, 3, v18
  v_add_u32 v17, s11, v17
  s_mul_i32 s13, s3, 10240
  s_add_u32 s12, s13, 26214400
  s_lshl_b32 s15, s3, 10
  v_add_u32 v3, s15, v2
  s_and_b32 s9, s80, 3
  s_sleep 100
  s_sleep 100
  s_add_u32 m0, s13, 0
  s_add_u32 s18, s12, 0
  buffer_load_dwordx4 v2, s[4:7], s18 offen offset:0 lds
  buffer_load_dwordx4 v2, s[4:7], s18 offen offset:1024 lds
  buffer_load_dwordx4 v2, s[4:7], s18 offen offset:2048 lds
  buffer_load_dwordx4 v2, s[4:7], s18 offen offset:3072 lds
  s_add_u32 m0, s13, 4096
  s_add_u32 s18, s12, 4096
  buffer_load_dwordx4 v2, s[4:7], s18 offen offset:0 lds
  buffer_load_dwordx4 v2, s[4:7], s18 offen offset:1024 lds
  buffer_load_dwordx4 v2, s[4:7], s18 offen offset:2048 lds
  buffer_load_dwordx4 v2, s[4:7], s18 offen offset:3072 lds
  s_add_u32 m0, s13, 8192
  s_add_u32 s18, s12, 8192
  buffer_load_dwordx4 v2, s[4:7], s18 offen offset:0 lds
  buffer_load_dwordx4 v2, s[4:7], s18 offen offset:1024 lds
  s_add_u32 s12, s12, 40960
  s_add_u32 s13, s13, 40960
  s_mov_b32 s19, 40960
  s_mov_b64 exec, s[82:83]
  s_add_u32 m0, s11, 0
  s_nop 0
  buffer_load_dwordx4 v16, s[92:95], s10 offen lds
  s_add_u32 s10, s10, 122880
  s_add_u32 m0, s11, 960
  s_nop 0
  buffer_load_dwordx4 v16, s[92:95], s10 offen lds
  s_add_u32 s10, s10, 122880
  s_add_u32 m0, s11, 1920
  s_nop 0
  buffer_load_dwordx4 v16, s[92:95], s10 offen lds
  s_add_u32 s10, s10, 122880
  s_add_u32 m0, s11, 2880
  s_nop 0
  buffer_load_dwordx4 v16, s[92:95], s10 offen lds
  s_add_u32 s10, s10, 122880
  s_add_u32 m0, s11, 3840
  s_nop 0
  buffer_load_dwordx4 v16, s[92:95], s10 offen lds
  s_add_u32 s10, s10, 122880
  s_add_u32 m0, s11, 4800
  s_nop 0
  buffer_load_dwordx4 v16, s[92:95], s10 offen lds
  s_add_u32 s10, s10, 122880
  s_add_u32 m0, s11, 5760
  s_nop 0
  buffer_load_dwordx4 v16, s[92:95], s10 offen lds
  s_add_u32 s10, s10, 122880
  s_add_u32 m0, s11, 6720
  s_nop 0
  buffer_load_dwordx4 v16, s[92:95], s10 offen lds
  s_add_u32 s10, s10, 122880
  s_add_u32 m0, s11, 7680
  s_nop 0
  buffer_load_dwordx4 v16, s[92:95], s10 offen lds
  s_add_u32 s10, s10, 122880
  s_add_u32 m0, s11, 8640
  s_nop 0
  buffer_load_dwordx4 v16, s[92:95], s10 offen lds
  s_add_u32 s10, s10, 122880
  s_add_u32 m0, s11, 9600
  s_nop 0
  buffer_load_dwordx4 v16, s[92:95], s10 offen lds
  s_add_u32 s10, s10, 122880
  s_add_u32 m0, s11, 10560
  s_nop 0
  buffer_load_dwordx4 v16, s[92:95], s10 offen lds
  s_add_u32 s10, s10, 122880
  s_add_u32 m0, s11, 11520
  s_nop 0
  buffer_load_dwordx4 v16, s[92:95], s10 offen lds
  s_add_u32 s10, s10, 122880
  s_add_u32 m0, s11, 12480
  s_nop 0
  buffer_load_dwordx4 v16, s[92:95], s10 offen lds
  s_add_u32 s10, s10, 122880
  s_add_u32 m0, s11, 13440
  s_nop 0
  buffer_load_dwordx4 v16, s[92:95], s10 offen lds
  s_add_u32 s10, s10, 122880
  s_add_u32 m0, s11, 14400
  s_nop 0
  buffer_load_dwordx4 v16, s[92:95], s10 offen lds
  s_add_u32 s10, s10, 122880
  s_add_u32 m0, s11, 15360
  s_nop 0
  buffer_load_dwordx4 v16, s[92:95], s10 offen lds
  s_add_u32 s10, s10, 122880
  s_add_u32 m0, s11, 16320
  s_nop 0
  buffer_load_dwordx4 v16, s[92:95], s10 offen lds
  s_add_u32 s10, s10, 122880
  s_add_u32 m0, s11, 17280
  s_nop 0
  buffer_load_dwordx4 v16, s[92:95], s10 offen lds
  s_add_u32 s10, s10, 122880
  s_add_u32 m0, s11, 18240
  s_nop 0
  buffer_load_dwordx4 v16, s[92:95], s10 offen lds
  s_add_u32 s10, s10, 122880
  s_add_u32 m0, s11, 19200
  s_nop 0
  buffer_load_dwordx4 v16, s[92:95], s10 offen lds
  s_add_u32 s10, s10, 122880
  s_add_u32 m0, s11, 20160
  s_nop 0
  buffer_load_dwordx4 v16, s[92:95], s10 offen lds
  s_add_u32 s10, s10, 122880
  s_add_u32 m0, s11, 21120
  s_nop 0
  buffer_load_dwordx4 v16, s[92:95], s10 offen lds
  s_add_u32 s10, s10, 122880
  s_add_u32 m0, s11, 22080
  s_nop 0
  buffer_load_dwordx4 v16, s[92:95], s10 offen lds
  s_add_u32 s10, s10, 122880
  s_add_u32 m0, s11, 23040
  s_nop 0
  buffer_load_dwordx4 v16, s[92:95], s10 offen lds
  s_add_u32 s10, s10, 122880
  s_add_u32 m0, s11, 24000
  s_nop 0
  buffer_load_dwordx4 v16, s[92:95], s10 offen lds
  s_add_u32 s10, s10, 122880
  s_add_u32 m0, s11, 24960
  s_nop 0
  buffer_load_dwordx4 v16, s[92:95], s10 offen lds
  s_add_u32 s10, s10, 122880
  s_add_u32 m0, s11, 25920
  s_nop 0
  buffer_load_dwordx4 v16, s[92:95], s10 offen lds
  s_add_u32 s10, s10, 122880
  s_add_u32 m0, s11, 26880
  s_nop 0
  buffer_load_dwordx4 v16, s[92:95], s10 offen lds
  s_add_u32 s10, s10, 122880
  s_add_u32 m0, s11, 27840
  s_nop 0
  buffer_load_dwordx4 v16, s[92:95], s10 offen lds
  s_add_u32 s10, s10, 122880
  s_add_u32 m0, s11, 28800
  s_nop 0
  buffer_load_dwordx4 v16, s[92:95], s10 offen lds
  s_add_u32 s10, s10, 122880
  s_add_u32 m0, s11, 29760
  s_nop 0
  buffer_load_dwordx4 v16, s[92:95], s10 offen lds
  s_add_u32 s10, s10, 122880
  s_mov_b64 exec, -1
  s_waitcnt vmcnt(28)
  ds_read_b64_tr_b16 a[0:1], v17 offset:0
  ds_read_b64_tr_b16 a[2:3], v17 offset:384
  ds_read_b64_tr_b16 a[80:81], v17 offset:32
  ds_read_b64_tr_b16 a[82:83], v17 offset:416
  ds_read_b64_tr_b16 a[160:161], v17 offset:64
  ds_read_b64_tr_b16 a[162:163], v17 offset:448
  s_waitcnt lgkmcnt(0)
  s_mov_b64 exec, s[82:83]
  s_add_u32 m0, s11, 0
  s_nop 0
  buffer_load_dwordx4 v16, s[92:95], s10 offen lds
  s_add_u32 s10, s10, 122880
  s_add_u32 m0, s11, 960
  s_nop 0
  buffer_load_dwordx4 v16, s[92:95], s10 offen lds
  s_add_u32 s10, s10, 122880
  s_add_u32 m0, s11, 1920
  s_nop 0
  buffer_load_dwordx4 v16, s[92:95], s10 offen lds
  s_add_u32 s10, s10, 122880
  s_mov_b64 exec, -1
  s_waitcnt vmcnt(28)
  ds_read_b64_tr_b16 a[4:5], v17 offset:3072
  ds_read_b64_tr_b16 a[6:7], v17 offset:3456
  ds_read_b64_tr_b16 a[84:85], v17 offset:3104
  ds_read_b64_tr_b16 a[86:87], v17 offset:3488
  ds_read_b64_tr_b16 a[164:165], v17 offset:3136
  ds_read_b64_tr_b16 a[166:167], v17 offset:3520
  s_waitcnt lgkmcnt(0)
  s_mov_b64 exec, s[82:83]
  s_add_u32 m0, s11, 2880
  s_nop 0
  buffer_load_dwordx4 v16, s[92:95], s10 offen lds
  s_add_u32 s10, s10, 122880
  s_add_u32 m0, s11, 3840
  s_nop 0
  buffer_load_dwordx4 v16, s[92:95], s10 offen lds
  s_add_u32 s10, s10, 122880
  s_add_u32 m0, s11, 4800
  s_nop 0
  buffer_load_dwordx4 v16, s[92:95], s10 offen lds
  s_add_u32 s10, s10, 122880
  s_mov_b64 exec, -1
  s_waitcnt vmcnt(28)
  ds_read_b64_tr_b16 a[8:9], v17 offset:6144
  ds_read_b64_tr_b16 a[10:11], v17 offset:6528
  ds_read_b64_tr_b16 a[88:89], v17 offset:6176
  ds_read_b64_tr_b16 a[90:91], v17 offset:6560
  ds_read_b64_tr_b16 a[168:169], v17 offset:6208
  ds_read_b64_tr_b16 a[170:171], v17 offset:6592
  s_waitcnt lgkmcnt(0)
  s_mov_b64 exec, s[82:83]
  s_add_u32 m0, s11, 5760
  s_nop 0
  buffer_load_dwordx4 v16, s[92:95], s10 offen lds
  s_add_u32 s10, s10, 122880
  s_add_u32 m0, s11, 6720
  s_nop 0
  buffer_load_dwordx4 v16, s[92:95], s10 offen lds
  s_add_u32 s10, s10, 122880
  s_add_u32 m0, s11, 7680
  s_nop 0
  buffer_load_dwordx4 v16, s[92:95], s10 offen lds
  s_add_u32 s10, s10, 122880
  s_mov_b64 exec, -1
  s_waitcnt vmcnt(28)
  ds_read_b64_tr_b16 a[12:13], v17 offset:9216
  ds_read_b64_tr_b16 a[14:15], v17 offset:9600
  ds_read_b64_tr_b16 a[92:93], v17 offset:9248
  ds_read_b64_tr_b16 a[94:95], v17 offset:9632
  ds_read_b64_tr_b16 a[172:173], v17 offset:9280
  ds_read_b64_tr_b16 a[174:175], v17 offset:9664
  s_waitcnt lgkmcnt(0)
  s_mov_b64 exec, s[82:83]
  s_add_u32 m0, s11, 8640
  s_nop 0
  buffer_load_dwordx4 v16, s[92:95], s10 offen lds
  s_add_u32 s10, s10, 122880
  s_add_u32 m0, s11, 9600
  s_nop 0
  buffer_load_dwordx4 v16, s[92:95], s10 offen lds
  s_add_u32 s10, s10, 122880
  s_add_u32 m0, s11, 10560
  s_nop 0
  buffer_load_dwordx4 v16, s[92:95], s10 offen lds
  s_add_u32 s10, s10, 122880
  s_mov_b64 exec, -1
  s_waitcnt vmcnt(28)
  ds_read_b64_tr_b16 a[16:17], v17 offset:12288
  ds_read_b64_tr_b16 a[18:19], v17 offset:12672
  ds_read_b64_tr_b16 a[96:97], v17 offset:12320
  ds_read_b64_tr_b16 a[98:99], v17 offset:12704
  ds_read_b64_tr_b16 a[176:177], v17 offset:12352
  ds_read_b64_tr_b16 a[178:179], v17 offset:12736
  s_waitcnt lgkmcnt(0)
  s_mov_b64 exec, s[82:83]
  s_add_u32 m0, s11, 11520
  s_nop 0
  buffer_load_dwordx4 v16, s[92:95], s10 offen lds
  s_add_u32 s10, s10, 122880
  s_add_u32 m0, s11, 12480
  s_nop 0
  buffer_load_dwordx4 v16, s[92:95], s10 offen lds
  s_add_u32 s10, s10, 122880
  s_add_u32 m0, s11, 13440
  s_nop 0
  buffer_load_dwordx4 v16, s[92:95], s10 offen lds
  s_add_u32 s10, s10, 122880
  s_add_u32 m0, s11, 14400
  s_nop 0
  buffer_load_dwordx4 v16, s[92:95], s10 offen lds
  s_add_u32 s10, s10, 122880
  s_mov_b64 exec, -1
  s_waitcnt vmcnt(28)
  ds_read_b64_tr_b16 a[20:21], v17 offset:15360
  ds_read_b64_tr_b16 a[22:23], v17 offset:15744
  ds_read_b64_tr_b16 a[100:101], v17 offset:15392
  ds_read_b64_tr_b16 a[102:103], v17 offset:15776
  ds_read_b64_tr_b16 a[180:181], v17 offset:15424
  ds_read_b64_tr_b16 a[182:183], v17 offset:15808
  s_waitcnt lgkmcnt(0)
  s_mov_b64 exec, s[82:83]
  s_add_u32 m0, s11, 15360
  s_nop 0
  buffer_load_dwordx4 v16, s[92:95], s10 offen lds
  s_add_u32 s10, s10, 122880
  s_add_u32 m0, s11, 16320
  s_nop 0
  buffer_load_dwordx4 v16, s[92:95], s10 offen lds
  s_add_u32 s10, s10, 122880
  s_add_u32 m0, s11, 17280
  s_nop 0
  buffer_load_dwordx4 v16, s[92:95], s10 offen lds
  s_add_u32 s10, s10, 122880
  s_mov_b64 exec, -1
  s_waitcnt vmcnt(28)
  ds_read_b64_tr_b16 a[24:25], v17 offset:18432
  ds_read_b64_tr_b16 a[26:27], v17 offset:18816
  ds_read_b64_tr_b16 a[104:105], v17 offset:18464
  ds_read_b64_tr_b16 a[106:107], v17 offset:18848
  ds_read_b64_tr_b16 a[184:185], v17 offset:18496
  ds_read_b64_tr_b16 a[186:187], v17 offset:18880
  s_waitcnt lgkmcnt(0)
  s_mov_b64 exec, s[82:83]
  s_add_u32 m0, s11, 18240
  s_nop 0
  buffer_load_dwordx4 v16, s[92:95], s10 offen lds
  s_add_u32 s10, s10, 122880
  s_add_u32 m0, s11, 19200
  s_nop 0
  buffer_load_dwordx4 v16, s[92:95], s10 offen lds
  s_add_u32 s10, s10, 122880
  s_add_u32 m0, s11, 20160
  s_nop 0
  buffer_load_dwordx4 v16, s[92:95], s10 offen lds
  s_add_u32 s10, s10, 122880
  s_mov_b64 exec, -1
  s_waitcnt vmcnt(28)
  ds_read_b64_tr_b16 a[28:29], v17 offset:21504
  ds_read_b64_tr_b16 a[30:31], v17 offset:21888
  ds_read_b64_tr_b16 a[108:109], v17 offset:21536
  ds_read_b64_tr_b16 a[110:111], v17 offset:21920
  ds_read_b64_tr_b16 a[188:189], v17 offset:21568
  ds_read_b64_tr_b16 a[190:191], v17 offset:21952
  s_waitcnt lgkmcnt(0)
  s_mov_b64 exec, s[82:83]
  s_add_u32 m0, s11, 21120
  s_nop 0
  buffer_load_dwordx4 v16, s[92:95], s10 offen lds
  s_add_u32 s10, s10, 122880
  s_add_u32 m0, s11, 22080
  s_nop 0
  buffer_load_dwordx4 v16, s[92:95], s10 offen lds
  s_add_u32 s10, s10, 122880
  s_add_u32 m0, s11, 23040
  s_nop 0
  buffer_load_dwordx4 v16, s[92:95], s10 offen lds
  s_add_u32 s10, s10, 122880
  s_mov_b64 exec, -1
  s_waitcnt vmcnt(28)
  ds_read_b64_tr_b16 a[32:33], v17 offset:24576
  ds_read_b64_tr_b16 a[34:35], v17 offset:24960
  ds_read_b64_tr_b16 a[112:113], v17 offset:24608
  ds_read_b64_tr_b16 a[114:115], v17 offset:24992
  ds_read_b64_tr_b16 a[192:193], v17 offset:24640
  ds_read_b64_tr_b16 a[194:195], v17 offset:25024
  s_waitcnt lgkmcnt(0)
  s_mov_b64 exec, s[82:83]
  s_add_u32 m0, s11, 24000
  s_nop 0
  buffer_load_dwordx4 v16, s[92:95], s10 offen lds
  s_add_u32 s10, s10, 122880
  s_add_u32 m0, s11, 24960
  s_nop 0
  buffer_load_dwordx4 v16, s[92:95], s10 offen lds
  s_add_u32 s10, s10, 122880
  s_add_u32 m0, s11, 25920
  s_nop 0
  buffer_load_dwordx4 v16, s[92:95], s10 offen lds
  s_add_u32 s10, s10, 122880
  s_mov_b64 exec, -1
  s_waitcnt vmcnt(28)
  ds_read_b64_tr_b16 a[36:37], v17 offset:27648
  ds_read_b64_tr_b16 a[38:39], v17 offset:28032
  ds_read_b64_tr_b16 a[116:117], v17 offset:27680
  ds_read_b64_tr_b16 a[118:119], v17 offset:28064
  ds_read_b64_tr_b16 a[196:197], v17 offset:27712
  ds_read_b64_tr_b16 a[198:199], v17 offset:28096
  s_waitcnt lgkmcnt(0)
  s_mov_b64 exec, s[82:83]
  s_add_u32 m0, s11, 26880
  s_nop 0
  buffer_load_dwordx4 v16, s[92:95], s10 offen lds
  s_add_u32 s10, s10, 122880
  s_add_u32 m0, s11, 27840
  s_nop 0
  buffer_load_dwordx4 v16, s[92:95], s10 offen lds
  s_add_u32 s10, s10, 122880
  s_add_u32 m0, s11, 28800
  s_nop 0
  buffer_load_dwordx4 v16, s[92:95], s10 offen lds
  s_add_u32 s10, s10, 122880
  s_add_u32 m0, s11, 29760
  s_nop 0
  buffer_load_dwordx4 v16, s[92:95], s10 offen lds
  s_add_u32 s10, s10, 122880
  s_mov_b64 exec, -1
  s_waitcnt vmcnt(28)
  ds_read_b64_tr_b16 a[40:41], v17 offset:0
  ds_read_b64_tr_b16 a[42:43], v17 offset:384
  ds_read_b64_tr_b16 a[120:121], v17 offset:32
  ds_read_b64_tr_b16 a[122:123], v17 offset:416
  ds_read_b64_tr_b16 a[200:201], v17 offset:64
  ds_read_b64_tr_b16 a[202:203], v17 offset:448
  s_waitcnt vmcnt(25)
  ds_read_b64_tr_b16 a[44:45], v17 offset:3072
  ds_read_b64_tr_b16 a[46:47], v17 offset:3456
  ds_read_b64_tr_b16 a[124:125], v17 offset:3104
  ds_read_b64_tr_b16 a[126:127], v17 offset:3488
  ds_read_b64_tr_b16 a[204:205], v17 offset:3136
  ds_read_b64_tr_b16 a[206:207], v17 offset:3520
  s_waitcnt vmcnt(22)
  ds_read_b64_tr_b16 a[48:49], v17 offset:6144
  ds_read_b64_tr_b16 a[50:51], v17 offset:6528
  ds_read_b64_tr_b16 a[128:129], v17 offset:6176
  ds_read_b64_tr_b16 a[130:131], v17 offset:6560
  ds_read_b64_tr_b16 a[208:209], v17 offset:6208
  ds_read_b64_tr_b16 a[210:211], v17 offset:6592
  s_waitcnt vmcnt(19)
  ds_read_b64_tr_b16 a[52:53], v17 offset:9216
  ds_read_b64_tr_b16 a[54:55], v17 offset:9600
  ds_read_b64_tr_b16 a[132:133], v17 offset:9248
  ds_read_b64_tr_b16 a[134:135], v17 offset:9632
  ds_read_b64_tr_b16 a[212:213], v17 offset:9280
  ds_read_b64_tr_b16 a[214:215], v17 offset:9664
  s_waitcnt vmcnt(16)
  ds_read_b64_tr_b16 a[56:57], v17 offset:12288
  ds_read_b64_tr_b16 a[58:59], v17 offset:12672
  ds_read_b64_tr_b16 a[136:137], v17 offset:12320
  ds_read_b64_tr_b16 a[138:139], v17 offset:12704
  ds_read_b64_tr_b16 a[216:217], v17 offset:12352
  ds_read_b64_tr_b16 a[218:219], v17 offset:12736
  s_waitcnt vmcnt(12)
  ds_read_b64_tr_b16 a[60:61], v17 offset:15360
  ds_read_b64_tr_b16 a[62:63], v17 offset:15744
  ds_read_b64_tr_b16 a[140:141], v17 offset:15392
  ds_read_b64_tr_b16 a[142:143], v17 offset:15776
  ds_read_b64_tr_b16 a[220:221], v17 offset:15424
  ds_read_b64_tr_b16 a[222:223], v17 offset:15808
  s_waitcnt vmcnt(9)
  ds_read_b64_tr_b16 a[64:65], v17 offset:18432
  ds_read_b64_tr_b16 a[66:67], v17 offset:18816
  ds_read_b64_tr_b16 a[144:145], v17 offset:18464
  ds_read_b64_tr_b16 a[146:147], v17 offset:18848
  ds_read_b64_tr_b16 a[224:225], v17 offset:18496
  ds_read_b64_tr_b16 a[226:227], v17 offset:18880
  s_waitcnt vmcnt(6)
  ds_read_b64_tr_b16 a[68:69], v17 offset:21504
  ds_read_b64_tr_b16 a[70:71], v17 offset:21888
  ds_read_b64_tr_b16 a[148:149], v17 offset:21536
  ds_read_b64_tr_b16 a[150:151], v17 offset:21920
  ds_read_b64_tr_b16 a[228:229], v17 offset:21568
  ds_read_b64_tr_b16 a[230:231], v17 offset:21952
  s_waitcnt vmcnt(3)
  ds_read_b64_tr_b16 a[72:73], v17 offset:24576
  ds_read_b64_tr_b16 a[74:75], v17 offset:24960
  ds_read_b64_tr_b16 a[152:153], v17 offset:24608
  ds_read_b64_tr_b16 a[154:155], v17 offset:24992
  ds_read_b64_tr_b16 a[232:233], v17 offset:24640
  ds_read_b64_tr_b16 a[234:235], v17 offset:25024
  s_waitcnt vmcnt(0)
  ds_read_b64_tr_b16 a[76:77], v17 offset:27648
  ds_read_b64_tr_b16 a[78:79], v17 offset:28032
  ds_read_b64_tr_b16 a[156:157], v17 offset:27680
  ds_read_b64_tr_b16 a[158:159], v17 offset:28064
  ds_read_b64_tr_b16 a[236:237], v17 offset:27712
  ds_read_b64_tr_b16 a[238:239], v17 offset:28096
  s_waitcnt lgkmcnt(0)
  s_lshl_b32 s28, s68, 2
  v_mov_b32 v17, s28
  s_mov_b32 s28, 0
mega0_kernel_cen15:
  buffer_load_dword v16, v17, s[44:47], 0 offen sc1
  s_waitcnt vmcnt(0)
  v_readfirstlane_b32 s26, v16
  s_nop 0
  s_and_b32 s27, s26, 63
  s_cmp_eq_u32 s27, 32
  s_cbranch_scc1 mega0_kernel_cen15_done
  s_sleep 4
  s_add_u32 s28, s28, 1
  s_cmp_lt_u32 s28, 262144
  s_cbranch_scc1 mega0_kernel_cen15
  s_branch mega_fail
mega0_kernel_cen15_done:
  s_cmp_eq_u32 s26, s69
  s_cselect_b32 s69, 0, 1
  v_mov_b32 v5, v2
  s_mov_b32 s24, 0
  s_lshr_b32 s15, s3, 1
  s_add_u32 s15, s15, 4
  s_lshl_b32 s15, s15, 10
  s_and_b32 s16, s3, 1
  s_lshl_b32 s16, s16, 3
  s_add_u32 s15, s15, s16
  v_add_u32 v4, s15, v2
  v_and_b32 v9, 15, v1
  v_lshrrev_b32 v10, 4, v1
  v_and_b32 v11, 7, v1
  v_lshlrev_b32 v11, 4, v11
  v_lshl_add_u32 v11, v10, 7, v11
  v_lshrrev_b32 v8, 1, v11
  v_add_u32 v3, 122880, v3
  v_add_u32 v4, 122880, v4
  s_mul_i32 s26, s3, 6144
  s_add_u32 s26, s26, 122880
  v_add_u32 v12, s26, v2
  v_mov_b32 v13, 0xd04e79ff
  v_lshlrev_b32 v14, 2, v10
  v_add_u32 v15, 0, v14
  v_cmp_le_u32 s[32:33], v15, v9
  v_add_u32 v15, 1, v14
  v_cmp_le_u32 s[34:35], v15, v9
  v_add_u32 v15, 2, v14
  v_cmp_le_u32 s[36:37], v15, v9
  v_add_u32 v15, 3, v14
  v_cmp_le_u32 s[38:39], v15, v9
  s_mov_b32 s40, -1
  s_mov_b32 s41, 0
  s_mov_b32 s42, 0x3dd53b95
  s_lshr_b32 s31, s3, 1
  s_mul_i32 s20, s31, 325632
  s_add_u32 s60, s31, 1
  s_mul_i32 s26, s9, 12288
  s_add_u32 s26, s26, s78
  s_add_u32 s26, s26, 204800
  s_mul_i32 s27, s9, 3072
  s_add_u32 s27, s27, s78
  s_add_u32 s27, s27, 303104
  s_and_b32 s28, s3, 1
  s_mul_i32 s28, s28, 5120
  s_add_u32 s28, s28, s78
  s_add_u32 s28, s28, 315392
  s_lshl_b32 s29, s9, 10
  v_add_u32 v14, s29, v2
  s_lshl_b32 s29, s9, 8
  s_add_u32 s29, s29, 4096
  v_lshlrev_b32 v15, 3, v10
  v_lshl_add_u32 v15, v9, 4, v15
  v_add_u32 v15, s29, v15
  s_lshl_b32 s48, s80, 7
  v_and_b32 v84, 3, v1
  v_lshlrev_b32 v84, 2, v84
  v_add_u32 v84, s48, v84
  v_add_u32 v85, 16384, v84
  s_lshl_b32 s50, s3, 2
  s_add_u32 s50, s50, s48
  s_add_u32 s50, s50, s71
  s_add_u32 s50, s50, 8192
  s_mov_b32 s62, 0
  s_barrier
  ds_read_b128 v[16:19], v5 offset:0
  ds_read_b128 v[20:23], v5 offset:20480
  ds_read_b128 v[24:27], v5 offset:1024
  ds_read_b128 v[28:31], v5 offset:21504
  ds_read_b128 v[32:35], v5 offset:2048
  ds_read_b128 v[36:39], v5 offset:22528
  s_waitcnt lgkmcnt(4)
  v_mfma_f32_16x16x32_bf16 v[48:51], a[0:3], v[16:19], 0
  ds_read_b128 v[40:43], v5 offset:3072
  v_mfma_f32_16x16x32_bf16 v[52:55], a[80:83], v[16:19], 0
  s_add_u32 m0, s13, 0
  s_add_u32 s18, s12, 0
  buffer_load_dwordx4 v2, s[4:7], s18 offen offset:0 lds
  v_mfma_f32_16x16x32_bf16 v[56:59], a[160:163], v[16:19], 0
  v_mfma_f32_16x16x32_bf16 v[60:63], a[0:3], v[20:23], 0
  ds_read_b128 v[44:47], v5 offset:23552
  v_mfma_f32_16x16x32_bf16 v[64:67], a[80:83], v[20:23], 0
  v_mfma_f32_16x16x32_bf16 v[68:71], a[160:163], v[20:23], 0
  s_waitcnt lgkmcnt(4)
  v_mfma_f32_16x16x32_bf16 v[48:51], a[4:7], v[24:27], v[48:51]
  ds_read_b128 v[16:19], v5 offset:4096
  v_mfma_f32_16x16x32_bf16 v[52:55], a[84:87], v[24:27], v[52:55]
  v_mfma_f32_16x16x32_bf16 v[56:59], a[164:167], v[24:27], v[56:59]
  buffer_load_dwordx4 v2, s[4:7], s18 offen offset:1024 lds
  v_mfma_f32_16x16x32_bf16 v[60:63], a[4:7], v[28:31], v[60:63]
  ds_read_b128 v[20:23], v5 offset:24576
  v_mfma_f32_16x16x32_bf16 v[64:67], a[84:87], v[28:31], v[64:67]
  v_mfma_f32_16x16x32_bf16 v[68:71], a[164:167], v[28:31], v[68:71]
  s_waitcnt lgkmcnt(4)
  v_mfma_f32_16x16x32_bf16 v[48:51], a[8:11], v[32:35], v[48:51]
  ds_read_b128 v[24:27], v5 offset:5120
  v_mfma_f32_16x16x32_bf16 v[52:55], a[88:91], v[32:35], v[52:55]
  v_mfma_f32_16x16x32_bf16 v[56:59], a[168:171], v[32:35], v[56:59]
  v_mfma_f32_16x16x32_bf16 v[60:63], a[8:11], v[36:39], v[60:63]
  ds_read_b128 v[28:31], v5 offset:25600
  v_mfma_f32_16x16x32_bf16 v[64:67], a[88:91], v[36:39], v[64:67]
  v_mfma_f32_16x16x32_bf16 v[68:71], a[168:171], v[36:39], v[68:71]
  buffer_load_dwordx4 v2, s[4:7], s18 offen offset:2048 lds
  s_waitcnt lgkmcnt(4)
  v_mfma_f32_16x16x32_bf16 v[48:51], a[12:15], v[40:43], v[48:51]
  ds_read_b128 v[32:35], v5 offset:6144
  v_mfma_f32_16x16x32_bf16 v[52:55], a[92:95], v[40:43], v[52:55]
  v_mfma_f32_16x16x32_bf16 v[56:59], a[172:175], v[40:43], v[56:59]
  v_mfma_f32_16x16x32_bf16 v[60:63], a[12:15], v[44:47], v[60:63]
  ds_read_b128 v[36:39], v5 offset:26624
  v_mfma_f32_16x16x32_bf16 v[64:67], a[92:95], v[44:47], v[64:67]
  v_mfma_f32_16x16x32_bf16 v[68:71], a[172:175], v[44:47], v[68:71]
  s_waitcnt lgkmcnt(4)
  v_mfma_f32_16x16x32_bf16 v[48:51], a[16:19], v[16:19], v[48:51]
  ds_read_b128 v[40:43], v5 offset:7168
  v_mfma_f32_16x16x32_bf16 v[52:55], a[96:99], v[16:19], v[52:55]
  buffer_load_dwordx4 v2, s[4:7], s18 offen offset:3072 lds
  v_mfma_f32_16x16x32_bf16 v[56:59], a[176:179], v[16:19], v[56:59]
  v_mfma_f32_16x16x32_bf16 v[60:63], a[16:19], v[20:23], v[60:63]
  ds_read_b128 v[44:47], v5 offset:27648
  v_mfma_f32_16x16x32_bf16 v[64:67], a[96:99], v[20:23], v[64:67]
  v_mfma_f32_16x16x32_bf16 v[68:71], a[176:179], v[20:23], v[68:71]
  s_waitcnt lgkmcnt(4)
  v_mfma_f32_16x16x32_bf16 v[48:51], a[20:23], v[24:27], v[48:51]
  ds_read_b128 v[16:19], v5 offset:8192
  v_mfma_f32_16x16x32_bf16 v[52:55], a[100:103], v[24:27], v[52:55]
  v_mfma_f32_16x16x32_bf16 v[56:59], a[180:183], v[24:27], v[56:59]
  v_mfma_f32_16x16x32_bf16 v[60:63], a[20:23], v[28:31], v[60:63]
  ds_read_b128 v[20:23], v5 offset:28672
  v_mfma_f32_16x16x32_bf16 v[64:67], a[100:103], v[28:31], v[64:67]
  s_add_u32 m0, s13, 4096
  s_add_u32 s18, s12, 4096
  buffer_load_dwordx4 v2, s[4:7], s18 offen offset:0 lds
  v_mfma_f32_16x16x32_bf16 v[68:71], a[180:183], v[28:31], v[68:71]
  s_waitcnt lgkmcnt(4)
  v_mfma_f32_16x16x32_bf16 v[48:51], a[24:27], v[32:35], v[48:51]
  ds_read_b128 v[24:27], v5 offset:9216
  v_mfma_f32_16x16x32_bf16 v[52:55], a[104:107], v[32:35], v[52:55]
  v_mfma_f32_16x16x32_bf16 v[56:59], a[184:187], v[32:35], v[56:59]
  v_mfma_f32_16x16x32_bf16 v[60:63], a[24:27], v[36:39], v[60:63]
  ds_read_b128 v[28:31], v5 offset:29696
  v_mfma_f32_16x16x32_bf16 v[64:67], a[104:107], v[36:39], v[64:67]
  v_mfma_f32_16x16x32_bf16 v[68:71], a[184:187], v[36:39], v[68:71]
  s_waitcnt lgkmcnt(4)
  v_mfma_f32_16x16x32_bf16 v[48:51], a[28:31], v[40:43], v[48:51]
  ds_read_b128 v[32:35], v5 offset:10240
  v_mfma_f32_16x16x32_bf16 v[52:55], a[108:111], v[40:43], v[52:55]
  buffer_load_dwordx4 v2, s[4:7], s18 offen offset:1024 lds
  v_mfma_f32_16x16x32_bf16 v[56:59], a[188:191], v[40:43], v[56:59]
  v_mfma_f32_16x16x32_bf16 v[60:63], a[28:31], v[44:47], v[60:63]
  ds_read_b128 v[36:39], v5 offset:30720
  v_mfma_f32_16x16x32_bf16 v[64:67], a[108:111], v[44:47], v[64:67]
  v_mfma_f32_16x16x32_bf16 v[68:71], a[188:191], v[44:47], v[68:71]
  s_waitcnt lgkmcnt(4)
  v_mfma_f32_16x16x32_bf16 v[48:51], a[32:35], v[16:19], v[48:51]
  ds_read_b128 v[40:43], v5 offset:11264
  v_mfma_f32_16x16x32_bf16 v[52:55], a[112:115], v[16:19], v[52:55]
  v_mfma_f32_16x16x32_bf16 v[56:59], a[192:195], v[16:19], v[56:59]
  buffer_load_dwordx4 v2, s[4:7], s18 offen offset:2048 lds
  v_mfma_f32_16x16x32_bf16 v[60:63], a[32:35], v[20:23], v[60:63]
  ds_read_b128 v[44:47], v5 offset:31744
  v_mfma_f32_16x16x32_bf16 v[64:67], a[112:115], v[20:23], v[64:67]
  v_mfma_f32_16x16x32_bf16 v[68:71], a[192:195], v[20:23], v[68:71]
  s_waitcnt lgkmcnt(4)
  v_mfma_f32_16x16x32_bf16 v[48:51], a[36:39], v[24:27], v[48:51]
  ds_read_b128 v[16:19], v5 offset:12288
  v_mfma_f32_16x16x32_bf16 v[52:55], a[116:119], v[24:27], v[52:55]
  v_mfma_f32_16x16x32_bf16 v[56:59], a[196:199], v[24:27], v[56:59]
  v_mfma_f32_16x16x32_bf16 v[60:63], a[36:39], v[28:31], v[60:63]
  ds_read_b128 v[20:23], v5 offset:32768
  v_mfma_f32_16x16x32_bf16 v[64:67], a[116:119], v[28:31], v[64:67]
  v_mfma_f32_16x16x32_bf16 v[68:71], a[196:199], v[28:31], v[68:71]
  buffer_load_dwordx4 v2, s[4:7], s18 offen offset:3072 lds
  s_waitcnt lgkmcnt(4)
  v_mfma_f32_16x16x32_bf16 v[48:51], a[40:43], v[32:35], v[48:51]
  ds_read_b128 v[24:27], v5 offset:13312
  v_mfma_f32_16x16x32_bf16 v[52:55], a[120:123], v[32:35], v[52:55]
  v_mfma_f32_16x16x32_bf16 v[56:59], a[200:203], v[32:35], v[56:59]
  v_mfma_f32_16x16x32_bf16 v[60:63], a[40:43], v[36:39], v[60:63]
  ds_read_b128 v[28:31], v5 offset:33792
  v_mfma_f32_16x16x32_bf16 v[64:67], a[120:123], v[36:39], v[64:67]
  v_mfma_f32_16x16x32_bf16 v[68:71], a[200:203], v[36:39], v[68:71]
  s_waitcnt lgkmcnt(4)
  v_mfma_f32_16x16x32_bf16 v[48:51], a[44:47], v[40:43], v[48:51]
  ds_read_b128 v[32:35], v5 offset:14336
  v_mfma_f32_16x16x32_bf16 v[52:55], a[124:127], v[40:43], v[52:55]
  s_add_u32 m0, s13, 8192
  s_add_u32 s18, s12, 8192
  buffer_load_dwordx4 v2, s[4:7], s18 offen offset:0 lds
  v_mfma_f32_16x16x32_bf16 v[56:59], a[204:207], v[40:43], v[56:59]
  v_mfma_f32_16x16x32_bf16 v[60:63], a[44:47], v[44:47], v[60:63]
  ds_read_b128 v[36:39], v5 offset:34816
  v_mfma_f32_16x16x32_bf16 v[64:67], a[124:127], v[44:47], v[64:67]
  v_mfma_f32_16x16x32_bf16 v[68:71], a[204:207], v[44:47], v[68:71]
  s_waitcnt lgkmcnt(4)
  v_mfma_f32_16x16x32_bf16 v[48:51], a[48:51], v[16:19], v[48:51]
  ds_read_b128 v[40:43], v5 offset:15360
  v_mfma_f32_16x16x32_bf16 v[52:55], a[128:131], v[16:19], v[52:55]
  v_mfma_f32_16x16x32_bf16 v[56:59], a[208:211], v[16:19], v[56:59]
  v_mfma_f32_16x16x32_bf16 v[60:63], a[48:51], v[20:23], v[60:63]
  ds_read_b128 v[44:47], v5 offset:35840
  v_mfma_f32_16x16x32_bf16 v[64:67], a[128:131], v[20:23], v[64:67]
  buffer_load_dwordx4 v2, s[4:7], s18 offen offset:1024 lds
  v_mfma_f32_16x16x32_bf16 v[68:71], a[208:211], v[20:23], v[68:71]
  s_waitcnt lgkmcnt(4)
  v_mfma_f32_16x16x32_bf16 v[48:51], a[52:55], v[24:27], v[48:51]
  ds_read_b128 v[16:19], v5 offset:16384
  v_mfma_f32_16x16x32_bf16 v[52:55], a[132:135], v[24:27], v[52:55]
  v_mfma_f32_16x16x32_bf16 v[56:59], a[212:215], v[24:27], v[56:59]
  v_mfma_f32_16x16x32_bf16 v[60:63], a[52:55], v[28:31], v[60:63]
  ds_read_b128 v[20:23], v5 offset:36864
  v_mfma_f32_16x16x32_bf16 v[64:67], a[132:135], v[28:31], v[64:67]
  v_mfma_f32_16x16x32_bf16 v[68:71], a[212:215], v[28:31], v[68:71]
  s_waitcnt lgkmcnt(4)
  v_mfma_f32_16x16x32_bf16 v[48:51], a[56:59], v[32:35], v[48:51]
  ds_read_b128 v[24:27], v5 offset:17408
  v_mfma_f32_16x16x32_bf16 v[52:55], a[136:139], v[32:35], v[52:55]
  v_mfma_f32_16x16x32_bf16 v[56:59], a[216:219], v[32:35], v[56:59]
  v_mfma_f32_16x16x32_bf16 v[60:63], a[56:59], v[36:39], v[60:63]
  ds_read_b128 v[28:31], v5 offset:37888
  v_mfma_f32_16x16x32_bf16 v[64:67], a[136:139], v[36:39], v[64:67]
  v_mfma_f32_16x16x32_bf16 v[68:71], a[216:219], v[36:39], v[68:71]
  s_waitcnt lgkmcnt(4)
  v_mfma_f32_16x16x32_bf16 v[48:51], a[60:63], v[40:43], v[48:51]
  ds_read_b128 v[32:35], v5 offset:18432
  v_mfma_f32_16x16x32_bf16 v[52:55], a[140:143], v[40:43], v[52:55]
  v_mfma_f32_16x16x32_bf16 v[56:59], a[220:223], v[40:43], v[56:59]
  v_mfma_f32_16x16x32_bf16 v[60:63], a[60:63], v[44:47], v[60:63]
  ds_read_b128 v[36:39], v5 offset:38912
  v_mfma_f32_16x16x32_bf16 v[64:67], a[140:143], v[44:47], v[64:67]
  v_mfma_f32_16x16x32_bf16 v[68:71], a[220:223], v[44:47], v[68:71]
  s_waitcnt lgkmcnt(4)
  v_mfma_f32_16x16x32_bf16 v[48:51], a[64:67], v[16:19], v[48:51]
  ds_read_b128 v[40:43], v5 offset:19456
  v_mfma_f32_16x16x32_bf16 v[52:55], a[144:147], v[16:19], v[52:55]
  v_mfma_f32_16x16x32_bf16 v[56:59], a[224:227], v[16:19], v[56:59]
  v_mfma_f32_16x16x32_bf16 v[60:63], a[64:67], v[20:23], v[60:63]
  ds_read_b128 v[44:47], v5 offset:39936
  v_mfma_f32_16x16x32_bf16 v[64:67], a[144:147], v[20:23], v[64:67]
  v_mfma_f32_16x16x32_bf16 v[68:71], a[224:227], v[20:23], v[68:71]
  s_waitcnt lgkmcnt(4)
  v_mfma_f32_16x16x32_bf16 v[48:51], a[68:71], v[24:27], v[48:51]
  v_mfma_f32_16x16x32_bf16 v[52:55], a[148:151], v[24:27], v[52:55]
  v_mfma_f32_16x16x32_bf16 v[56:59], a[228:231], v[24:27], v[56:59]
  v_mfma_f32_16x16x32_bf16 v[60:63], a[68:71], v[28:31], v[60:63]
  v_mfma_f32_16x16x32_bf16 v[64:67], a[148:151], v[28:31], v[64:67]
  v_mfma_f32_16x16x32_bf16 v[68:71], a[228:231], v[28:31], v[68:71]
  s_waitcnt lgkmcnt(2)
  v_mfma_f32_16x16x32_bf16 v[48:51], a[72:75], v[32:35], v[48:51]
  v_mfma_f32_16x16x32_bf16 v[52:55], a[152:155], v[32:35], v[52:55]
  v_mfma_f32_16x16x32_bf16 v[56:59], a[232:235], v[32:35], v[56:59]
  v_mfma_f32_16x16x32_bf16 v[60:63], a[72:75], v[36:39], v[60:63]
  v_mfma_f32_16x16x32_bf16 v[64:67], a[152:155], v[36:39], v[64:67]
  v_mfma_f32_16x16x32_bf16 v[68:71], a[232:235], v[36:39], v[68:71]
  s_waitcnt lgkmcnt(0)
  v_mfma_f32_16x16x32_bf16 v[48:51], a[76:79], v[40:43], v[48:51]
  v_mfma_f32_16x16x32_bf16 v[52:55], a[156:159], v[40:43], v[52:55]
  v_mfma_f32_16x16x32_bf16 v[56:59], a[236:239], v[40:43], v[56:59]
  v_mfma_f32_16x16x32_bf16 v[60:63], a[76:79], v[44:47], v[60:63]
  v_mfma_f32_16x16x32_bf16 v[64:67], a[156:159], v[44:47], v[64:67]
  v_mfma_f32_16x16x32_bf16 v[68:71], a[236:239], v[44:47], v[68:71]
  v_add_u32 v5, s19, v5
  s_sub_u32 s13, s13, s19
  s_sub_u32 s19, 0, s19
  s_add_u32 s12, s12, 40960
  s_add_u32 s24, s24, 1
  v_cvt_pk_bf16_f32 v96, v48, v49
  v_cvt_pk_bf16_f32 v97, v50, v51
  v_cvt_pk_bf16_f32 v98, v52, v53
  v_cvt_pk_bf16_f32 v99, v54, v55
  v_cvt_pk_bf16_f32 v100, v56, v57
  v_cvt_pk_bf16_f32 v101, v58, v59
  ds_write_b128 v3, v[96:99] offset:0
  ds_write_b64 v4, v[100:101] offset:0
  v_cvt_pk_bf16_f32 v104, v60, v61
  v_cvt_pk_bf16_f32 v105, v62, v63
  v_cvt_pk_bf16_f32 v106, v64, v65
  v_cvt_pk_bf16_f32 v107, v66, v67
  v_cvt_pk_bf16_f32 v108, v68, v69
  v_cvt_pk_bf16_f32 v109, v70, v71
  ds_write_b128 v3, v[104:107] offset:6144
  ds_write_b64 v4, v[108:109] offset:6144
  s_waitcnt vmcnt(0)
  s_barrier
  ds_read_b128 v[16:19], v5 offset:0
  ds_read_b128 v[20:23], v5 offset:20480
  ds_read_b128 v[24:27], v5 offset:1024
  ds_read_b128 v[28:31], v5 offset:21504
  ds_read_b128 v[32:35], v5 offset:2048
  ds_read_b128 v[36:39], v5 offset:22528
  s_waitcnt lgkmcnt(4)
  v_mfma_f32_16x16x32_bf16 v[48:51], a[0:3], v[16:19], 0
  ds_read_b128 v[40:43], v5 offset:3072
  v_mfma_f32_16x16x32_bf16 v[52:55], a[80:83], v[16:19], 0
  s_add_u32 m0, s13, 0
  s_add_u32 s18, s12, 0
  buffer_load_dwordx4 v2, s[4:7], s18 offen offset:0 lds
  v_mfma_f32_16x16x32_bf16 v[56:59], a[160:163], v[16:19], 0
  v_mfma_f32_16x16x32_bf16 v[60:63], a[0:3], v[20:23], 0
  ds_read_b128 v[44:47], v5 offset:23552
  v_mfma_f32_16x16x32_bf16 v[64:67], a[80:83], v[20:23], 0
  v_mfma_f32_16x16x32_bf16 v[68:71], a[160:163], v[20:23], 0
  s_waitcnt lgkmcnt(4)
  v_mfma_f32_16x16x32_bf16 v[48:51], a[4:7], v[24:27], v[48:51]
  ds_read_b128 v[16:19], v5 offset:4096
  v_mfma_f32_16x16x32_bf16 v[52:55], a[84:87], v[24:27], v[52:55]
  v_mfma_f32_16x16x32_bf16 v[56:59], a[164:167], v[24:27], v[56:59]
  v_mfma_f32_16x16x32_bf16 v[60:63], a[4:7], v[28:31], v[60:63]
  ds_read_b128 v[20:23], v5 offset:24576
  v_mfma_f32_16x16x32_bf16 v[64:67], a[84:87], v[28:31], v[64:67]
  buffer_load_dwordx4 v2, s[4:7], s18 offen offset:1024 lds
  v_mfma_f32_16x16x32_bf16 v[68:71], a[164:167], v[28:31], v[68:71]
  s_waitcnt lgkmcnt(4)
  v_mfma_f32_16x16x32_bf16 v[48:51], a[8:11], v[32:35], v[48:51]
  ds_read_b128 v[24:27], v5 offset:5120
  v_mfma_f32_16x16x32_bf16 v[52:55], a[88:91], v[32:35], v[52:55]
  v_mfma_f32_16x16x32_bf16 v[56:59], a[168:171], v[32:35], v[56:59]
  v_mfma_f32_16x16x32_bf16 v[60:63], a[8:11], v[36:39], v[60:63]
  ds_read_b128 v[28:31], v5 offset:25600
  v_mfma_f32_16x16x32_bf16 v[64:67], a[88:91], v[36:39], v[64:67]
  v_mfma_f32_16x16x32_bf16 v[68:71], a[168:171], v[36:39], v[68:71]
  s_waitcnt lgkmcnt(4)
  v_mfma_f32_16x16x32_bf16 v[48:51], a[12:15], v[40:43], v[48:51]
  ds_read_b128 v[32:35], v5 offset:6144
  v_mfma_f32_16x16x32_bf16 v[52:55], a[92:95], v[40:43], v[52:55]
  v_mfma_f32_16x16x32_bf16 v[56:59], a[172:175], v[40:43], v[56:59]
  buffer_load_dwordx4 v2, s[4:7], s18 offen offset:2048 lds
  v_mfma_f32_16x16x32_bf16 v[60:63], a[12:15], v[44:47], v[60:63]
  ds_read_b128 v[36:39], v5 offset:26624
  v_mfma_f32_16x16x32_bf16 v[64:67], a[92:95], v[44:47], v[64:67]
  v_mfma_f32_16x16x32_bf16 v[68:71], a[172:175], v[44:47], v[68:71]
  s_waitcnt lgkmcnt(4)
  v_mfma_f32_16x16x32_bf16 v[48:51], a[16:19], v[16:19], v[48:51]
  ds_read_b128 v[40:43], v5 offset:7168
  v_mfma_f32_16x16x32_bf16 v[52:55], a[96:99], v[16:19], v[52:55]
  v_mfma_f32_16x16x32_bf16 v[56:59], a[176:179], v[16:19], v[56:59]
  v_mfma_f32_16x16x32_bf16 v[60:63], a[16:19], v[20:23], v[60:63]
  ds_read_b128 v[44:47], v5 offset:27648
  v_mfma_f32_16x16x32_bf16 v[64:67], a[96:99], v[20:23], v[64:67]
  v_mfma_f32_16x16x32_bf16 v[68:71], a[176:179], v[20:23], v[68:71]
  s_waitcnt lgkmcnt(4)
  v_mfma_f32_16x16x32_bf16 v[48:51], a[20:23], v[24:27], v[48:51]
  ds_read_b128 v[16:19], v5 offset:8192
  v_mfma_f32_16x16x32_bf16 v[52:55], a[100:103], v[24:27], v[52:55]
  buffer_load_dwordx4 v2, s[4:7], s18 offen offset:3072 lds
  v_mfma_f32_16x16x32_bf16 v[56:59], a[180:183], v[24:27], v[56:59]
  v_mfma_f32_16x16x32_bf16 v[60:63], a[20:23], v[28:31], v[60:63]
  ds_read_b128 v[20:23], v5 offset:28672
  v_mfma_f32_16x16x32_bf16 v[64:67], a[100:103], v[28:31], v[64:67]
  v_mfma_f32_16x16x32_bf16 v[68:71], a[180:183], v[28:31], v[68:71]
  s_waitcnt lgkmcnt(4)
  v_mfma_f32_16x16x32_bf16 v[48:51], a[24:27], v[32:35], v[48:51]
  ds_read_b128 v[24:27], v5 offset:9216
  v_mfma_f32_16x16x32_bf16 v[52:55], a[104:107], v[32:35], v[52:55]
  v_mfma_f32_16x16x32_bf16 v[56:59], a[184:187], v[32:35], v[56:59]
  v_mfma_f32_16x16x32_bf16 v[60:63], a[24:27], v[36:39], v[60:63]
  ds_read_b128 v[28:31], v5 offset:29696
  v_mfma_f32_16x16x32_bf16 v[64:67], a[104:107], v[36:39], v[64:67]
  v_mfma_f32_16x16x32_bf16 v[68:71], a[184:187], v[36:39], v[68:71]
  s_add_u32 m0, s13, 4096
  s_add_u32 s18, s12, 4096
  buffer_load_dwordx4 v2, s[4:7], s18 offen offset:0 lds
  s_waitcnt lgkmcnt(4)
  v_mfma_f32_16x16x32_bf16 v[48:51], a[28:31], v[40:43], v[48:51]
  ds_read_b128 v[32:35], v5 offset:10240
  v_mfma_f32_16x16x32_bf16 v[52:55], a[108:111], v[40:43], v[52:55]
  v_mfma_f32_16x16x32_bf16 v[56:59], a[188:191], v[40:43], v[56:59]
  v_mfma_f32_16x16x32_bf16 v[60:63], a[28:31], v[44:47], v[60:63]
  ds_read_b128 v[36:39], v5 offset:30720
  v_mfma_f32_16x16x32_bf16 v[64:67], a[108:111], v[44:47], v[64:67]
  v_mfma_f32_16x16x32_bf16 v[68:71], a[188:191], v[44:47], v[68:71]
  s_waitcnt lgkmcnt(4)
  v_mfma_f32_16x16x32_bf16 v[48:51], a[32:35], v[16:19], v[48:51]
  ds_read_b128 v[40:43], v5 offset:11264
  v_mfma_f32_16x16x32_bf16 v[52:55], a[112:115], v[16:19], v[52:55]
  v_mfma_f32_16x16x32_bf16 v[56:59], a[192:195], v[16:19], v[56:59]
  v_mfma_f32_16x16x32_bf16 v[60:63], a[32:35], v[20:23], v[60:63]
  ds_read_b128 v[44:47], v5 offset:31744
  v_mfma_f32_16x16x32_bf16 v[64:67], a[112:115], v[20:23], v[64:67]
  buffer_load_dwordx4 v2, s[4:7], s18 offen offset:1024 lds
  v_mfma_f32_16x16x32_bf16 v[68:71], a[192:195], v[20:23], v[68:71]
  s_waitcnt lgkmcnt(4)
  v_mfma_f32_16x16x32_bf16 v[48:51], a[36:39], v[24:27], v[48:51]
  ds_read_b128 v[16:19], v5 offset:12288
  v_mfma_f32_16x16x32_bf16 v[52:55], a[116:119], v[24:27], v[52:55]
  v_mfma_f32_16x16x32_bf16 v[56:59], a[196:199], v[24:27], v[56:59]
  v_mfma_f32_16x16x32_bf16 v[60:63], a[36:39], v[28:31], v[60:63]
  ds_read_b128 v[20:23], v5 offset:32768
  v_mfma_f32_16x16x32_bf16 v[64:67], a[116:119], v[28:31], v[64:67]
  v_mfma_f32_16x16x32_bf16 v[68:71], a[196:199], v[28:31], v[68:71]
  s_waitcnt lgkmcnt(4)
  v_mfma_f32_16x16x32_bf16 v[48:51], a[40:43], v[32:35], v[48:51]
  ds_read_b128 v[24:27], v5 offset:13312
  v_mfma_f32_16x16x32_bf16 v[52:55], a[120:123], v[32:35], v[52:55]
  buffer_load_dwordx4 v2, s[4:7], s18 offen offset:2048 lds
  v_mfma_f32_16x16x32_bf16 v[56:59], a[200:203], v[32:35], v[56:59]
  v_mfma_f32_16x16x32_bf16 v[60:63], a[40:43], v[36:39], v[60:63]
  ds_read_b128 v[28:31], v5 offset:33792
  v_mfma_f32_16x16x32_bf16 v[64:67], a[120:123], v[36:39], v[64:67]
  v_mfma_f32_16x16x32_bf16 v[68:71], a[200:203], v[36:39], v[68:71]
  s_waitcnt lgkmcnt(4)
  v_mfma_f32_16x16x32_bf16 v[48:51], a[44:47], v[40:43], v[48:51]
  ds_read_b128 v[32:35], v5 offset:14336
  v_mfma_f32_16x16x32_bf16 v[52:55], a[124:127], v[40:43], v[52:55]
  v_mfma_f32_16x16x32_bf16 v[56:59], a[204:207], v[40:43], v[56:59]
  v_mfma_f32_16x16x32_bf16 v[60:63], a[44:47], v[44:47], v[60:63]
  ds_read_b128 v[36:39], v5 offset:34816
  v_mfma_f32_16x16x32_bf16 v[64:67], a[124:127], v[44:47], v[64:67]
  v_mfma_f32_16x16x32_bf16 v[68:71], a[204:207], v[44:47], v[68:71]
  buffer_load_dwordx4 v2, s[4:7], s18 offen offset:3072 lds
  s_waitcnt lgkmcnt(4)
  v_mfma_f32_16x16x32_bf16 v[48:51], a[48:51], v[16:19], v[48:51]
  ds_read_b128 v[40:43], v5 offset:15360
  v_mfma_f32_16x16x32_bf16 v[52:55], a[128:131], v[16:19], v[52:55]
  v_mfma_f32_16x16x32_bf16 v[56:59], a[208:211], v[16:19], v[56:59]
  v_mfma_f32_16x16x32_bf16 v[60:63], a[48:51], v[20:23], v[60:63]
  ds_read_b128 v[44:47], v5 offset:35840
  v_mfma_f32_16x16x32_bf16 v[64:67], a[128:131], v[20:23], v[64:67]
  v_mfma_f32_16x16x32_bf16 v[68:71], a[208:211], v[20:23], v[68:71]
  s_waitcnt lgkmcnt(4)
  v_mfma_f32_16x16x32_bf16 v[48:51], a[52:55], v[24:27], v[48:51]
  ds_read_b128 v[16:19], v5 offset:16384
  v_mfma_f32_16x16x32_bf16 v[52:55], a[132:135], v[24:27], v[52:55]
  v_mfma_f32_16x16x32_bf16 v[56:59], a[212:215], v[24:27], v[56:59]
  v_mfma_f32_16x16x32_bf16 v[60:63], a[52:55], v[28:31], v[60:63]
  ds_read_b128 v[20:23], v5 offset:36864
  v_mfma_f32_16x16x32_bf16 v[64:67], a[132:135], v[28:31], v[64:67]
  s_add_u32 m0, s13, 8192
  s_add_u32 s18, s12, 8192
  buffer_load_dwordx4 v2, s[4:7], s18 offen offset:0 lds
  v_mfma_f32_16x16x32_bf16 v[68:71], a[212:215], v[28:31], v[68:71]
  s_waitcnt lgkmcnt(4)
  v_mfma_f32_16x16x32_bf16 v[48:51], a[56:59], v[32:35], v[48:51]
  ds_read_b128 v[24:27], v5 offset:17408
  v_mfma_f32_16x16x32_bf16 v[52:55], a[136:139], v[32:35], v[52:55]
  v_mfma_f32_16x16x32_bf16 v[56:59], a[216:219], v[32:35], v[56:59]
  v_mfma_f32_16x16x32_bf16 v[60:63], a[56:59], v[36:39], v[60:63]
  ds_read_b128 v[28:31], v5 offset:37888
  v_mfma_f32_16x16x32_bf16 v[64:67], a[136:139], v[36:39], v[64:67]
  v_mfma_f32_16x16x32_bf16 v[68:71], a[216:219], v[36:39], v[68:71]
  s_waitcnt lgkmcnt(4)
  v_mfma_f32_16x16x32_bf16 v[48:51], a[60:63], v[40:43], v[48:51]
  ds_read_b128 v[32:35], v5 offset:18432
  v_mfma_f32_16x16x32_bf16 v[52:55], a[140:143], v[40:43], v[52:55]
  v_mfma_f32_16x16x32_bf16 v[56:59], a[220:223], v[40:43], v[56:59]
  buffer_load_dwordx4 v2, s[4:7], s18 offen offset:1024 lds
  v_mfma_f32_16x16x32_bf16 v[60:63], a[60:63], v[44:47], v[60:63]
  ds_read_b128 v[36:39], v5 offset:38912
  v_mfma_f32_16x16x32_bf16 v[64:67], a[140:143], v[44:47], v[64:67]
  v_mfma_f32_16x16x32_bf16 v[68:71], a[220:223], v[44:47], v[68:71]
  s_waitcnt lgkmcnt(4)
  v_mfma_f32_16x16x32_bf16 v[48:51], a[64:67], v[16:19], v[48:51]
  ds_read_b128 v[40:43], v5 offset:19456
  v_mfma_f32_16x16x32_bf16 v[52:55], a[144:147], v[16:19], v[52:55]
  v_mfma_f32_16x16x32_bf16 v[56:59], a[224:227], v[16:19], v[56:59]
  v_mfma_f32_16x16x32_bf16 v[60:63], a[64:67], v[20:23], v[60:63]
  ds_read_b128 v[44:47], v5 offset:39936
  v_mfma_f32_16x16x32_bf16 v[64:67], a[144:147], v[20:23], v[64:67]
  v_mfma_f32_16x16x32_bf16 v[68:71], a[224:227], v[20:23], v[68:71]
  s_waitcnt lgkmcnt(4)
  v_mfma_f32_16x16x32_bf16 v[48:51], a[68:71], v[24:27], v[48:51]
  v_mfma_f32_16x16x32_bf16 v[52:55], a[148:151], v[24:27], v[52:55]
  v_mfma_f32_16x16x32_bf16 v[56:59], a[228:231], v[24:27], v[56:59]
  v_mfma_f32_16x16x32_bf16 v[60:63], a[68:71], v[28:31], v[60:63]
  v_mfma_f32_16x16x32_bf16 v[64:67], a[148:151], v[28:31], v[64:67]
  v_mfma_f32_16x16x32_bf16 v[68:71], a[228:231], v[28:31], v[68:71]
  s_waitcnt lgkmcnt(2)
  v_mfma_f32_16x16x32_bf16 v[48:51], a[72:75], v[32:35], v[48:51]
  v_mfma_f32_16x16x32_bf16 v[52:55], a[152:155], v[32:35], v[52:55]
  v_mfma_f32_16x16x32_bf16 v[56:59], a[232:235], v[32:35], v[56:59]
  v_mfma_f32_16x16x32_bf16 v[60:63], a[72:75], v[36:39], v[60:63]
  v_mfma_f32_16x16x32_bf16 v[64:67], a[152:155], v[36:39], v[64:67]
  v_mfma_f32_16x16x32_bf16 v[68:71], a[232:235], v[36:39], v[68:71]
  s_waitcnt lgkmcnt(0)
  v_mfma_f32_16x16x32_bf16 v[48:51], a[76:79], v[40:43], v[48:51]
  v_mfma_f32_16x16x32_bf16 v[52:55], a[156:159], v[40:43], v[52:55]
  v_mfma_f32_16x16x32_bf16 v[56:59], a[236:239], v[40:43], v[56:59]
  v_mfma_f32_16x16x32_bf16 v[60:63], a[76:79], v[44:47], v[60:63]
  v_mfma_f32_16x16x32_bf16 v[64:67], a[156:159], v[44:47], v[64:67]
  v_mfma_f32_16x16x32_bf16 v[68:71], a[236:239], v[44:47], v[68:71]
  v_add_u32 v5, s19, v5
  s_sub_u32 s13, s13, s19
  s_sub_u32 s19, 0, s19
  s_add_u32 s12, s12, 40960
  s_add_u32 s24, s24, 1
  v_cvt_pk_bf16_f32 v96, v48, v49
  v_cvt_pk_bf16_f32 v97, v50, v51
  v_cvt_pk_bf16_f32 v98, v52, v53
  v_cvt_pk_bf16_f32 v99, v54, v55
  v_cvt_pk_bf16_f32 v100, v56, v57
  v_cvt_pk_bf16_f32 v101, v58, v59
  ds_write_b128 v3, v[96:99] offset:12288
  ds_write_b64 v4, v[100:101] offset:12288
  v_cvt_pk_bf16_f32 v104, v60, v61
  v_cvt_pk_bf16_f32 v105, v62, v63
  v_cvt_pk_bf16_f32 v106, v64, v65
  v_cvt_pk_bf16_f32 v107, v66, v67
  v_cvt_pk_bf16_f32 v108, v68, v69
  v_cvt_pk_bf16_f32 v109, v70, v71
  ds_write_b128 v3, v[104:107] offset:18432
  ds_write_b64 v4, v[108:109] offset:18432
  s_waitcnt lgkmcnt(0)
  s_barrier
  ds_read_b128 v[232:235], v12 offset:0
  ds_read_b128 v[236:239], v12 offset:1024
  ds_read_b128 v[240:243], v12 offset:2048
  ds_read_b128 v[244:247], v12 offset:3072
  ds_read_b128 v[248:251], v12 offset:4096
  ds_read_b128 v[252:255], v12 offset:5120
  s_waitcnt vmcnt(0)
mega_q_loop:
  s_waitcnt lgkmcnt(0)
  v_mov_b32 v112, v232
  v_mov_b32 v113, v233
  v_mov_b32 v114, v234
  v_mov_b32 v115, v235
  v_mov_b32 v116, v236
  v_mov_b32 v117, v237
  v_mov_b32 v118, v238
  v_mov_b32 v119, v239
  v_mov_b32 v120, v240
  v_mov_b32 v121, v241
  v_mov_b32 v122, v242
  v_mov_b32 v123, v243
  v_mov_b32 v124, v244
  v_mov_b32 v125, v245
  v_mov_b32 v126, v246
  v_mov_b32 v127, v247
  v_mov_b32 v128, v248
  v_mov_b32 v129, v249
  v_mov_b32 v130, v250
  v_mov_b32 v131, v251
  v_mov_b32 v132, v252
  v_mov_b32 v133, v253
  v_mov_b32 v134, v254
  v_mov_b32 v135, v255
  s_cmp_eq_u32 s62, 62
  s_cbranch_scc1 mega_q_last
  s_barrier
  ds_read_b128 v[16:19], v5 offset:0
  ds_read_b128 v[20:23], v5 offset:20480
  ds_read_b128 v[24:27], v5 offset:1024
  ds_read_b128 v[28:31], v5 offset:21504
  ds_read_b128 v[32:35], v5 offset:2048
  ds_read_b128 v[36:39], v5 offset:22528
  s_waitcnt lgkmcnt(4)
  v_mfma_f32_16x16x32_bf16 v[48:51], a[0:3], v[16:19], 0
  ds_read_b128 v[40:43], v5 offset:3072
  v_mfma_f32_16x16x32_bf16 v[52:55], a[80:83], v[16:19], 0
  s_add_u32 m0, s13, 0
  s_add_u32 s18, s12, 0
  buffer_load_dwordx4 v2, s[4:7], s18 offen offset:0 lds
  v_mfma_f32_16x16x32_bf16 v[56:59], a[160:163], v[16:19], 0
  v_mfma_f32_16x16x32_bf16 v[60:63], a[0:3], v[20:23], 0
  ds_read_b128 v[44:47], v5 offset:23552
  v_mfma_f32_16x16x32_bf16 v[64:67], a[80:83], v[20:23], 0
  v_mfma_f32_16x16x32_bf16 v[68:71], a[160:163], v[20:23], 0
  s_waitcnt lgkmcnt(4)
  v_mfma_f32_16x16x32_bf16 v[48:51], a[4:7], v[24:27], v[48:51]
  ds_read_b128 v[16:19], v5 offset:4096
  v_mfma_f32_16x16x32_bf16 v[52:55], a[84:87], v[24:27], v[52:55]
  v_mfma_f32_16x16x32_bf16 v[56:59], a[164:167], v[24:27], v[56:59]
  buffer_load_dwordx4 v2, s[4:7], s18 offen offset:1024 lds
  v_mfma_f32_16x16x32_bf16 v[60:63], a[4:7], v[28:31], v[60:63]
  ds_read_b128 v[20:23], v5 offset:24576
  v_mfma_f32_16x16x32_bf16 v[64:67], a[84:87], v[28:31], v[64:67]
  v_mfma_f32_16x16x32_bf16 v[68:71], a[164:167], v[28:31], v[68:71]
  s_waitcnt lgkmcnt(4)
  v_mfma_f32_16x16x32_bf16 v[48:51], a[8:11], v[32:35], v[48:51]
  ds_read_b128 v[24:27], v5 offset:5120
  v_mfma_f32_16x16x32_bf16 v[52:55], a[88:91], v[32:35], v[52:55]
  v_mfma_f32_16x16x32_bf16 v[56:59], a[168:171], v[32:35], v[56:59]
  v_mfma_f32_16x16x32_bf16 v[60:63], a[8:11], v[36:39], v[60:63]
  ds_read_b128 v[28:31], v5 offset:25600
  v_mfma_f32_16x16x32_bf16 v[64:67], a[88:91], v[36:39], v[64:67]
  v_mfma_f32_16x16x32_bf16 v[68:71], a[168:171], v[36:39], v[68:71]
  buffer_load_dwordx4 v2, s[4:7], s18 offen offset:2048 lds
  s_waitcnt lgkmcnt(4)
  v_mfma_f32_16x16x32_bf16 v[48:51], a[12:15], v[40:43], v[48:51]
  ds_read_b128 v[32:35], v5 offset:6144
  v_mfma_f32_16x16x32_bf16 v[52:55], a[92:95], v[40:43], v[52:55]
  v_mfma_f32_16x16x32_bf16 v[56:59], a[172:175], v[40:43], v[56:59]
  v_mfma_f32_16x16x32_bf16 v[60:63], a[12:15], v[44:47], v[60:63]
  ds_read_b128 v[36:39], v5 offset:26624
  v_mfma_f32_16x16x32_bf16 v[64:67], a[92:95], v[44:47], v[64:67]
  v_mfma_f32_16x16x32_bf16 v[68:71], a[172:175], v[44:47], v[68:71]
  s_waitcnt lgkmcnt(4)
  v_mfma_f32_16x16x32_bf16 v[48:51], a[16:19], v[16:19], v[48:51]
  ds_read_b128 v[40:43], v5 offset:7168
  v_mfma_f32_16x16x32_bf16 v[52:55], a[96:99], v[16:19], v[52:55]
  buffer_load_dwordx4 v2, s[4:7], s18 offen offset:3072 lds
  v_mfma_f32_16x16x32_bf16 v[56:59], a[176:179], v[16:19], v[56:59]
  v_mfma_f32_16x16x32_bf16 v[60:63], a[16:19], v[20:23], v[60:63]
  ds_read_b128 v[44:47], v5 offset:27648
  v_mfma_f32_16x16x32_bf16 v[64:67], a[96:99], v[20:23], v[64:67]
  v_mfma_f32_16x16x32_bf16 v[68:71], a[176:179], v[20:23], v[68:71]
  s_waitcnt lgkmcnt(4)
  v_mfma_f32_16x16x32_bf16 v[48:51], a[20:23], v[24:27], v[48:51]
  ds_read_b128 v[16:19], v5 offset:8192
  v_mfma_f32_16x16x32_bf16 v[52:55], a[100:103], v[24:27], v[52:55]
  v_mfma_f32_16x16x32_bf16 v[56:59], a[180:183], v[24:27], v[56:59]
  v_mfma_f32_16x16x32_bf16 v[60:63], a[20:23], v[28:31], v[60:63]
  ds_read_b128 v[20:23], v5 offset:28672
  v_mfma_f32_16x16x32_bf16 v[64:67], a[100:103], v[28:31], v[64:67]
  s_add_u32 m0, s13, 4096
  s_add_u32 s18, s12, 4096
  buffer_load_dwordx4 v2, s[4:7], s18 offen offset:0 lds
  v_mfma_f32_16x16x32_bf16 v[68:71], a[180:183], v[28:31], v[68:71]
  s_waitcnt lgkmcnt(4)
  v_mfma_f32_16x16x32_bf16 v[48:51], a[24:27], v[32:35], v[48:51]
  ds_read_b128 v[24:27], v5 offset:9216
  v_mfma_f32_16x16x32_bf16 v[52:55], a[104:107], v[32:35], v[52:55]
  v_mfma_f32_16x16x32_bf16 v[56:59], a[184:187], v[32:35], v[56:59]
  v_mfma_f32_16x16x32_bf16 v[60:63], a[24:27], v[36:39], v[60:63]
  ds_read_b128 v[28:31], v5 offset:29696
  v_mfma_f32_16x16x32_bf16 v[64:67], a[104:107], v[36:39], v[64:67]
  v_mfma_f32_16x16x32_bf16 v[68:71], a[184:187], v[36:39], v[68:71]
  s_waitcnt lgkmcnt(4)
  v_mfma_f32_16x16x32_bf16 v[48:51], a[28:31], v[40:43], v[48:51]
  ds_read_b128 v[32:35], v5 offset:10240
  v_mfma_f32_16x16x32_bf16 v[52:55], a[108:111], v[40:43], v[52:55]
  buffer_load_dwordx4 v2, s[4:7], s18 offen offset:1024 lds
  v_mfma_f32_16x16x32_bf16 v[56:59], a[188:191], v[40:43], v[56:59]
  v_mfma_f32_16x16x32_bf16 v[60:63], a[28:31], v[44:47], v[60:63]
  ds_read_b128 v[36:39], v5 offset:30720
  v_mfma_f32_16x16x32_bf16 v[64:67], a[108:111], v[44:47], v[64:67]
  v_mfma_f32_16x16x32_bf16 v[68:71], a[188:191], v[44:47], v[68:71]
  s_waitcnt lgkmcnt(4)
  v_mfma_f32_16x16x32_bf16 v[48:51], a[32:35], v[16:19], v[48:51]
  ds_read_b128 v[40:43], v5 offset:11264
  v_mfma_f32_16x16x32_bf16 v[52:55], a[112:115], v[16:19], v[52:55]
  v_mfma_f32_16x16x32_bf16 v[56:59], a[192:195], v[16:19], v[56:59]
  buffer_load_dwordx4 v2, s[4:7], s18 offen offset:2048 lds
  v_mfma_f32_16x16x32_bf16 v[60:63], a[32:35], v[20:23], v[60:63]
  ds_read_b128 v[44:47], v5 offset:31744
  v_mfma_f32_16x16x32_bf16 v[64:67], a[112:115], v[20:23], v[64:67]
  v_mfma_f32_16x16x32_bf16 v[68:71], a[192:195], v[20:23], v[68:71]
  s_waitcnt lgkmcnt(4)
  v_mfma_f32_16x16x32_bf16 v[48:51], a[36:39], v[24:27], v[48:51]
  ds_read_b128 v[16:19], v5 offset:12288
  v_mfma_f32_16x16x32_bf16 v[52:55], a[116:119], v[24:27], v[52:55]
  v_mfma_f32_16x16x32_bf16 v[56:59], a[196:199], v[24:27], v[56:59]
  v_mfma_f32_16x16x32_bf16 v[60:63], a[36:39], v[28:31], v[60:63]
  ds_read_b128 v[20:23], v5 offset:32768
  v_mfma_f32_16x16x32_bf16 v[64:67], a[116:119], v[28:31], v[64:67]
  v_mfma_f32_16x16x32_bf16 v[68:71], a[196:199], v[28:31], v[68:71]
  buffer_load_dwordx4 v2, s[4:7], s18 offen offset:3072 lds
  s_waitcnt lgkmcnt(4)
  v_mfma_f32_16x16x32_bf16 v[48:51], a[40:43], v[32:35], v[48:51]
  ds_read_b128 v[24:27], v5 offset:13312
  v_mfma_f32_16x16x32_bf16 v[52:55], a[120:123], v[32:35], v[52:55]
  v_mfma_f32_16x16x32_bf16 v[56:59], a[200:203], v[32:35], v[56:59]
  v_mfma_f32_16x16x32_bf16 v[60:63], a[40:43], v[36:39], v[60:63]
  ds_read_b128 v[28:31], v5 offset:33792
  v_mfma_f32_16x16x32_bf16 v[64:67], a[120:123], v[36:39], v[64:67]
  v_mfma_f32_16x16x32_bf16 v[68:71], a[200:203], v[36:39], v[68:71]
  s_waitcnt lgkmcnt(4)
  v_mfma_f32_16x16x32_bf16 v[48:51], a[44:47], v[40:43], v[48:51]
  ds_read_b128 v[32:35], v5 offset:14336
  v_mfma_f32_16x16x32_bf16 v[52:55], a[124:127], v[40:43], v[52:55]
  s_add_u32 m0, s13, 8192
  s_add_u32 s18, s12, 8192
  buffer_load_dwordx4 v2, s[4:7], s18 offen offset:0 lds
  v_mfma_f32_16x16x32_bf16 v[56:59], a[204:207], v[40:43], v[56:59]
  v_mfma_f32_16x16x32_bf16 v[60:63], a[44:47], v[44:47], v[60:63]
  ds_read_b128 v[36:39], v5 offset:34816
  v_mfma_f32_16x16x32_bf16 v[64:67], a[124:127], v[44:47], v[64:67]
  v_mfma_f32_16x16x32_bf16 v[68:71], a[204:207], v[44:47], v[68:71]
  s_waitcnt lgkmcnt(4)
  v_mfma_f32_16x16x32_bf16 v[48:51], a[48:51], v[16:19], v[48:51]
  ds_read_b128 v[40:43], v5 offset:15360
  v_mfma_f32_16x16x32_bf16 v[52:55], a[128:131], v[16:19], v[52:55]
  v_mfma_f32_16x16x32_bf16 v[56:59], a[208:211], v[16:19], v[56:59]
  v_mfma_f32_16x16x32_bf16 v[60:63], a[48:51], v[20:23], v[60:63]
  ds_read_b128 v[44:47], v5 offset:35840
  v_mfma_f32_16x16x32_bf16 v[64:67], a[128:131], v[20:23], v[64:67]
  buffer_load_dwordx4 v2, s[4:7], s18 offen offset:1024 lds
  v_mfma_f32_16x16x32_bf16 v[68:71], a[208:211], v[20:23], v[68:71]
  s_waitcnt lgkmcnt(4)
  v_mfma_f32_16x16x32_bf16 v[48:51], a[52:55], v[24:27], v[48:51]
  ds_read_b128 v[16:19], v5 offset:16384
  v_mfma_f32_16x16x32_bf16 v[52:55], a[132:135], v[24:27], v[52:55]
  v_mfma_f32_16x16x32_bf16 v[56:59], a[212:215], v[24:27], v[56:59]
  v_mfma_f32_16x16x32_bf16 v[60:63], a[52:55], v[28:31], v[60:63]
  ds_read_b128 v[20:23], v5 offset:36864
  v_mfma_f32_16x16x32_bf16 v[64:67], a[132:135], v[28:31], v[64:67]
  v_mfma_f32_16x16x32_bf16 v[68:71], a[212:215], v[28:31], v[68:71]
  s_waitcnt lgkmcnt(4)
  v_mfma_f32_16x16x32_bf16 v[48:51], a[56:59], v[32:35], v[48:51]
  ds_read_b128 v[24:27], v5 offset:17408
  v_mfma_f32_16x16x32_bf16 v[52:55], a[136:139], v[32:35], v[52:55]
  buffer_load_dword v86, v84, s[4:7], s71 offen sc1
  v_mfma_f32_16x16x32_bf16 v[56:59], a[216:219], v[32:35], v[56:59]
  v_mfma_f32_16x16x32_bf16 v[60:63], a[56:59], v[36:39], v[60:63]
  ds_read_b128 v[28:31], v5 offset:37888
  v_mfma_f32_16x16x32_bf16 v[64:67], a[136:139], v[36:39], v[64:67]
  v_mfma_f32_16x16x32_bf16 v[68:71], a[216:219], v[36:39], v[68:71]
  s_waitcnt lgkmcnt(4)
  v_mfma_f32_16x16x32_bf16 v[48:51], a[60:63], v[40:43], v[48:51]
  ds_read_b128 v[32:35], v5 offset:18432
  v_mfma_f32_16x16x32_bf16 v[52:55], a[140:143], v[40:43], v[52:55]
  v_mfma_f32_16x16x32_bf16 v[56:59], a[220:223], v[40:43], v[56:59]
  v_mfma_f32_16x16x32_bf16 v[60:63], a[60:63], v[44:47], v[60:63]
  ds_read_b128 v[36:39], v5 offset:38912
  v_mfma_f32_16x16x32_bf16 v[64:67], a[140:143], v[44:47], v[64:67]
  v_mfma_f32_16x16x32_bf16 v[68:71], a[220:223], v[44:47], v[68:71]
  s_waitcnt lgkmcnt(4)
  v_mfma_f32_16x16x32_bf16 v[48:51], a[64:67], v[16:19], v[48:51]
  ds_read_b128 v[40:43], v5 offset:19456
  v_mfma_f32_16x16x32_bf16 v[52:55], a[144:147], v[16:19], v[52:55]
  v_mfma_f32_16x16x32_bf16 v[56:59], a[224:227], v[16:19], v[56:59]
  v_mfma_f32_16x16x32_bf16 v[60:63], a[64:67], v[20:23], v[60:63]
  ds_read_b128 v[44:47], v5 offset:39936
  v_mfma_f32_16x16x32_bf16 v[64:67], a[144:147], v[20:23], v[64:67]
  v_mfma_f32_16x16x32_bf16 v[68:71], a[224:227], v[20:23], v[68:71]
  s_waitcnt lgkmcnt(4)
  v_mfma_f32_16x16x32_bf16 v[48:51], a[68:71], v[24:27], v[48:51]
  v_mfma_f32_16x16x32_bf16 v[52:55], a[148:151], v[24:27], v[52:55]
  v_mfma_f32_16x16x32_bf16 v[56:59], a[228:231], v[24:27], v[56:59]
  v_mfma_f32_16x16x32_bf16 v[60:63], a[68:71], v[28:31], v[60:63]
  v_mfma_f32_16x16x32_bf16 v[64:67], a[148:151], v[28:31], v[64:67]
  v_mfma_f32_16x16x32_bf16 v[68:71], a[228:231], v[28:31], v[68:71]
  s_waitcnt lgkmcnt(2)
  v_mfma_f32_16x16x32_bf16 v[48:51], a[72:75], v[32:35], v[48:51]
  v_mfma_f32_16x16x32_bf16 v[52:55], a[152:155], v[32:35], v[52:55]
  v_mfma_f32_16x16x32_bf16 v[56:59], a[232:235], v[32:35], v[56:59]
  v_mfma_f32_16x16x32_bf16 v[60:63], a[72:75], v[36:39], v[60:63]
  v_mfma_f32_16x16x32_bf16 v[64:67], a[152:155], v[36:39], v[64:67]
  v_mfma_f32_16x16x32_bf16 v[68:71], a[232:235], v[36:39], v[68:71]
  s_waitcnt lgkmcnt(0)
  v_mfma_f32_16x16x32_bf16 v[48:51], a[76:79], v[40:43], v[48:51]
  v_mfma_f32_16x16x32_bf16 v[52:55], a[156:159], v[40:43], v[52:55]
  v_mfma_f32_16x16x32_bf16 v[56:59], a[236:239], v[40:43], v[56:59]
  v_mfma_f32_16x16x32_bf16 v[60:63], a[76:79], v[44:47], v[60:63]
  v_mfma_f32_16x16x32_bf16 v[64:67], a[156:159], v[44:47], v[64:67]
  v_mfma_f32_16x16x32_bf16 v[68:71], a[236:239], v[44:47], v[68:71]
  v_add_u32 v5, s19, v5
  s_sub_u32 s13, s13, s19
  s_sub_u32 s19, 0, s19
  s_add_u32 s12, s12, 40960
  s_add_u32 s24, s24, 1
  v_cvt_pk_bf16_f32 v96, v48, v49
  v_cvt_pk_bf16_f32 v97, v50, v51
  v_cvt_pk_bf16_f32 v98, v52, v53
  v_cvt_pk_bf16_f32 v99, v54, v55
  v_cvt_pk_bf16_f32 v100, v56, v57
  v_cvt_pk_bf16_f32 v101, v58, v59
  ds_write_b128 v3, v[96:99] offset:0
  ds_write_b64 v4, v[100:101] offset:0
  v_cvt_pk_bf16_f32 v104, v60, v61
  v_cvt_pk_bf16_f32 v105, v62, v63
  v_cvt_pk_bf16_f32 v106, v64, v65
  v_cvt_pk_bf16_f32 v107, v66, v67
  v_cvt_pk_bf16_f32 v108, v68, v69
  v_cvt_pk_bf16_f32 v109, v70, v71
  ds_write_b128 v3, v[104:107] offset:6144
  ds_write_b64 v4, v[108:109] offset:6144
  s_waitcnt vmcnt(0)
  s_add_u32 s52, s26, s20
  s_add_u32 s53, s52, 4096
  s_add_u32 s54, s52, 8192
  s_mov_b32 s30, 0
  s_branch mega0_kernel_pv16_t
mega0_kernel_pv16:
  buffer_load_dword v86, v84, s[4:7], s71 offen sc1
  s_waitcnt vmcnt(0)
mega0_kernel_pv16_t:
  v_cmp_gt_u32 vcc, s60, v86
  s_nop 0
  s_cbranch_vccz mega0_kernel_pv16_ok
  s_sleep 2
  s_add_u32 s30, s30, 1
  s_cmp_lt_u32 s30, 262144
  s_cbranch_scc1 mega0_kernel_pv16
  s_branch mega_fail
mega0_kernel_pv16_ok:
  s_barrier
  ds_read_b128 v[16:19], v5 offset:0
  ds_read_b128 v[20:23], v5 offset:20480
  ds_read_b128 v[24:27], v5 offset:1024
  ds_read_b128 v[28:31], v5 offset:21504
  ds_read_b128 v[32:35], v5 offset:2048
  ds_read_b128 v[36:39], v5 offset:22528
  s_waitcnt lgkmcnt(4)
  v_mfma_f32_16x16x32_bf16 v[48:51], a[0:3], v[16:19], 0
  ds_read_b128 v[40:43], v5 offset:3072
  v_mfma_f32_16x16x32_bf16 v[52:55], a[80:83], v[16:19], 0
  s_add_u32 m0, s13, 0
  s_add_u32 s18, s12, 0
  buffer_load_dwordx4 v2, s[4:7], s18 offen offset:0 lds
  v_mfma_f32_16x16x32_bf16 v[56:59], a[160:163], v[16:19], 0
  v_mfma_f32_16x16x32_bf16 v[60:63], a[0:3], v[20:23], 0
  ds_read_b128 v[44:47], v5 offset:23552
  v_mfma_f32_16x16x32_bf16 v[64:67], a[80:83], v[20:23], 0
  buffer_load_dwordx4 v[136:139], v2, s[4:7], s52 offen offset:0 sc1
  v_mfma_f32_16x16x32_bf16 v[68:71], a[160:163], v[20:23], 0
  s_waitcnt lgkmcnt(4)
  v_mfma_f32_16x16x32_bf16 v[48:51], a[4:7], v[24:27], v[48:51]
  ds_read_b128 v[16:19], v5 offset:4096
  v_mfma_f32_16x16x32_bf16 v[52:55], a[84:87], v[24:27], v[52:55]
  v_mfma_f32_16x16x32_bf16 v[56:59], a[164:167], v[24:27], v[56:59]
  buffer_load_dwordx4 v2, s[4:7], s18 offen offset:1024 lds
  v_mfma_f32_16x16x32_bf16 v[60:63], a[4:7], v[28:31], v[60:63]
  ds_read_b128 v[20:23], v5 offset:24576
  v_mfma_f32_16x16x32_bf16 v[64:67], a[84:87], v[28:31], v[64:67]
  v_mfma_f32_16x16x32_bf16 v[68:71], a[164:167], v[28:31], v[68:71]
  buffer_load_dwordx4 v[140:143], v2, s[4:7], s52 offen offset:1024 sc1
  s_waitcnt lgkmcnt(4)
  v_mfma_f32_16x16x32_bf16 v[48:51], a[8:11], v[32:35], v[48:51]
  ds_read_b128 v[24:27], v5 offset:5120
  v_mfma_f32_16x16x32_bf16 v[52:55], a[88:91], v[32:35], v[52:55]
  v_mfma_f32_16x16x32_bf16 v[56:59], a[168:171], v[32:35], v[56:59]
  v_mfma_f32_16x16x32_bf16 v[60:63], a[8:11], v[36:39], v[60:63]
  ds_read_b128 v[28:31], v5 offset:25600
  v_mfma_f32_16x16x32_bf16 v[64:67], a[88:91], v[36:39], v[64:67]
  buffer_load_dwordx4 v[144:147], v2, s[4:7], s52 offen offset:2048 sc1
  v_mfma_f32_16x16x32_bf16 v[68:71], a[168:171], v[36:39], v[68:71]
  s_waitcnt lgkmcnt(4)
  v_mfma_f32_16x16x32_bf16 v[48:51], a[12:15], v[40:43], v[48:51]
  ds_read_b128 v[32:35], v5 offset:6144
  v_mfma_f32_16x16x32_bf16 v[52:55], a[92:95], v[40:43], v[52:55]
  v_mfma_f32_16x16x32_bf16 v[56:59], a[172:175], v[40:43], v[56:59]
  buffer_load_dwordx4 v2, s[4:7], s18 offen offset:2048 lds
  v_mfma_f32_16x16x32_bf16 v[60:63], a[12:15], v[44:47], v[60:63]
  ds_read_b128 v[36:39], v5 offset:26624
  v_mfma_f32_16x16x32_bf16 v[64:67], a[92:95], v[44:47], v[64:67]
  v_mfma_f32_16x16x32_bf16 v[68:71], a[172:175], v[44:47], v[68:71]
  buffer_load_dwordx4 v[148:151], v2, s[4:7], s52 offen offset:3072 sc1
  s_waitcnt lgkmcnt(4)
  v_mfma_f32_16x16x32_bf16 v[48:51], a[16:19], v[16:19], v[48:51]
  ds_read_b128 v[40:43], v5 offset:7168
  v_mfma_f32_16x16x32_bf16 v[52:55], a[96:99], v[16:19], v[52:55]
  v_mfma_f32_16x16x32_bf16 v[56:59], a[176:179], v[16:19], v[56:59]
  v_mfma_f32_16x16x32_bf16 v[60:63], a[16:19], v[20:23], v[60:63]
  ds_read_b128 v[44:47], v5 offset:27648
  v_mfma_f32_16x16x32_bf16 v[64:67], a[96:99], v[20:23], v[64:67]
  buffer_load_dwordx2 v[152:153], v2, s[4:7], s54 offen offset:0 sc1
  v_mfma_f32_16x16x32_bf16 v[68:71], a[176:179], v[20:23], v[68:71]
  s_waitcnt lgkmcnt(4)
  v_mfma_f32_16x16x32_bf16 v[48:51], a[20:23], v[24:27], v[48:51]
  ds_read_b128 v[16:19], v5 offset:8192
  v_mfma_f32_16x16x32_bf16 v[52:55], a[100:103], v[24:27], v[52:55]
  buffer_load_dwordx4 v2, s[4:7], s18 offen offset:3072 lds
  v_mfma_f32_16x16x32_bf16 v[56:59], a[180:183], v[24:27], v[56:59]
  v_mfma_f32_16x16x32_bf16 v[60:63], a[20:23], v[28:31], v[60:63]
  ds_read_b128 v[20:23], v5 offset:28672
  v_mfma_f32_16x16x32_bf16 v[64:67], a[100:103], v[28:31], v[64:67]
  v_mfma_f32_16x16x32_bf16 v[68:71], a[180:183], v[28:31], v[68:71]
  buffer_load_dwordx2 v[154:155], v2, s[4:7], s54 offen offset:1024 sc1
  s_waitcnt lgkmcnt(4)
  v_mfma_f32_16x16x32_bf16 v[48:51], a[24:27], v[32:35], v[48:51]
  ds_read_b128 v[24:27], v5 offset:9216
  v_mfma_f32_16x16x32_bf16 v[52:55], a[104:107], v[32:35], v[52:55]
  v_mfma_f32_16x16x32_bf16 v[56:59], a[184:187], v[32:35], v[56:59]
  v_mfma_f32_16x16x32_bf16 v[60:63], a[24:27], v[36:39], v[60:63]
  ds_read_b128 v[28:31], v5 offset:29696
  v_mfma_f32_16x16x32_bf16 v[64:67], a[104:107], v[36:39], v[64:67]
  s_add_u32 m0, s13, 4096
  s_add_u32 s18, s12, 4096
  buffer_load_dwordx4 v2, s[4:7], s18 offen offset:0 lds
  v_mfma_f32_16x16x32_bf16 v[68:71], a[184:187], v[36:39], v[68:71]
  s_waitcnt lgkmcnt(4)
  v_mfma_f32_16x16x32_bf16 v[48:51], a[28:31], v[40:43], v[48:51]
  ds_read_b128 v[32:35], v5 offset:10240
  v_mfma_f32_16x16x32_bf16 v[52:55], a[108:111], v[40:43], v[52:55]
  buffer_load_dwordx2 v[156:157], v2, s[4:7], s54 offen offset:2048 sc1
  v_mfma_f32_16x16x32_bf16 v[56:59], a[188:191], v[40:43], v[56:59]
  v_mfma_f32_16x16x32_bf16 v[60:63], a[28:31], v[44:47], v[60:63]
  ds_read_b128 v[36:39], v5 offset:30720
  v_mfma_f32_16x16x32_bf16 v[64:67], a[108:111], v[44:47], v[64:67]
  v_mfma_f32_16x16x32_bf16 v[68:71], a[188:191], v[44:47], v[68:71]
  buffer_load_dwordx2 v[158:159], v2, s[4:7], s54 offen offset:3072 sc1
  s_waitcnt lgkmcnt(4)
  v_mfma_f32_16x16x32_bf16 v[48:51], a[32:35], v[16:19], v[48:51]
  ds_read_b128 v[40:43], v5 offset:11264
  v_mfma_f32_16x16x32_bf16 v[52:55], a[112:115], v[16:19], v[52:55]
  v_mfma_f32_16x16x32_bf16 v[56:59], a[192:195], v[16:19], v[56:59]
  v_mfma_f32_16x16x32_bf16 v[60:63], a[32:35], v[20:23], v[60:63]
  ds_read_b128 v[44:47], v5 offset:31744
  v_mfma_f32_16x16x32_bf16 v[64:67], a[112:115], v[20:23], v[64:67]
  buffer_load_dwordx4 v2, s[4:7], s18 offen offset:1024 lds
  v_mfma_f32_16x16x32_bf16 v[68:71], a[192:195], v[20:23], v[68:71]
  s_waitcnt lgkmcnt(4)
  v_mfma_f32_16x16x32_bf16 v[48:51], a[36:39], v[24:27], v[48:51]
  ds_read_b128 v[16:19], v5 offset:12288
  v_mfma_f32_16x16x32_bf16 v[52:55], a[116:119], v[24:27], v[52:55]
  buffer_load_dwordx4 v[160:163], v2, s[4:7], s53 offen offset:0 sc1
  v_mfma_f32_16x16x32_bf16 v[56:59], a[196:199], v[24:27], v[56:59]
  v_mfma_f32_16x16x32_bf16 v[60:63], a[36:39], v[28:31], v[60:63]
  ds_read_b128 v[20:23], v5 offset:32768
  v_mfma_f32_16x16x32_bf16 v[64:67], a[116:119], v[28:31], v[64:67]
  v_mfma_f32_16x16x32_bf16 v[68:71], a[196:199], v[28:31], v[68:71]
  buffer_load_dwordx4 v[164:167], v2, s[4:7], s53 offen offset:1024 sc1
  s_waitcnt lgkmcnt(4)
  v_mfma_f32_16x16x32_bf16 v[48:51], a[40:43], v[32:35], v[48:51]
  ds_read_b128 v[24:27], v5 offset:13312
  v_mfma_f32_16x16x32_bf16 v[52:55], a[120:123], v[32:35], v[52:55]
  v_mfma_f32_16x16x32_bf16 v[56:59], a[200:203], v[32:35], v[56:59]
  buffer_load_dwordx4 v2, s[4:7], s18 offen offset:2048 lds
  v_mfma_f32_16x16x32_bf16 v[60:63], a[40:43], v[36:39], v[60:63]
  ds_read_b128 v[28:31], v5 offset:33792
  v_mfma_f32_16x16x32_bf16 v[64:67], a[120:123], v[36:39], v[64:67]
  v_mfma_f32_16x16x32_bf16 v[68:71], a[200:203], v[36:39], v[68:71]
  s_waitcnt lgkmcnt(4)
  v_mfma_f32_16x16x32_bf16 v[48:51], a[44:47], v[40:43], v[48:51]
  ds_read_b128 v[32:35], v5 offset:14336
  v_mfma_f32_16x16x32_bf16 v[52:55], a[124:127], v[40:43], v[52:55]
  buffer_load_dwordx4 v[168:171], v2, s[4:7], s53 offen offset:2048 sc1
  v_mfma_f32_16x16x32_bf16 v[56:59], a[204:207], v[40:43], v[56:59]
  v_mfma_f32_16x16x32_bf16 v[60:63], a[44:47], v[44:47], v[60:63]
  ds_read_b128 v[36:39], v5 offset:34816
  v_mfma_f32_16x16x32_bf16 v[64:67], a[124:127], v[44:47], v[64:67]
  v_mfma_f32_16x16x32_bf16 v[68:71], a[204:207], v[44:47], v[68:71]
  buffer_load_dwordx4 v2, s[4:7], s18 offen offset:3072 lds
  s_waitcnt lgkmcnt(4)
  v_mfma_f32_16x16x32_bf16 v[48:51], a[48:51], v[16:19], v[48:51]
  ds_read_b128 v[40:43], v5 offset:15360
  v_mfma_f32_16x16x32_bf16 v[52:55], a[128:131], v[16:19], v[52:55]
  v_mfma_f32_16x16x32_bf16 v[56:59], a[208:211], v[16:19], v[56:59]
  buffer_load_dwordx4 v[172:175], v2, s[4:7], s53 offen offset:3072 sc1
  v_mfma_f32_16x16x32_bf16 v[60:63], a[48:51], v[20:23], v[60:63]
  ds_read_b128 v[44:47], v5 offset:35840
  v_mfma_f32_16x16x32_bf16 v[64:67], a[128:131], v[20:23], v[64:67]
  v_mfma_f32_16x16x32_bf16 v[68:71], a[208:211], v[20:23], v[68:71]
  s_waitcnt lgkmcnt(4)
  v_mfma_f32_16x16x32_bf16 v[48:51], a[52:55], v[24:27], v[48:51]
  ds_read_b128 v[16:19], v5 offset:16384
  v_mfma_f32_16x16x32_bf16 v[52:55], a[132:135], v[24:27], v[52:55]
  buffer_load_dwordx2 v[176:177], v2, s[4:7], s54 offen offset:8 sc1
  v_mfma_f32_16x16x32_bf16 v[56:59], a[212:215], v[24:27], v[56:59]
  v_mfma_f32_16x16x32_bf16 v[60:63], a[52:55], v[28:31], v[60:63]
  ds_read_b128 v[20:23], v5 offset:36864
  v_mfma_f32_16x16x32_bf16 v[64:67], a[132:135], v[28:31], v[64:67]
  s_add_u32 m0, s13, 8192
  s_add_u32 s18, s12, 8192
  buffer_load_dwordx4 v2, s[4:7], s18 offen offset:0 lds
  v_mfma_f32_16x16x32_bf16 v[68:71], a[212:215], v[28:31], v[68:71]
  s_waitcnt lgkmcnt(4)
  v_mfma_f32_16x16x32_bf16 v[48:51], a[56:59], v[32:35], v[48:51]
  ds_read_b128 v[24:27], v5 offset:17408
  v_mfma_f32_16x16x32_bf16 v[52:55], a[136:139], v[32:35], v[52:55]
  v_mfma_f32_16x16x32_bf16 v[56:59], a[216:219], v[32:35], v[56:59]
  buffer_load_dwordx2 v[178:179], v2, s[4:7], s54 offen offset:1032 sc1
  v_mfma_f32_16x16x32_bf16 v[60:63], a[56:59], v[36:39], v[60:63]
  ds_read_b128 v[28:31], v5 offset:37888
  v_mfma_f32_16x16x32_bf16 v[64:67], a[136:139], v[36:39], v[64:67]
  v_mfma_f32_16x16x32_bf16 v[68:71], a[216:219], v[36:39], v[68:71]
  s_waitcnt lgkmcnt(4)
  v_mfma_f32_16x16x32_bf16 v[48:51], a[60:63], v[40:43], v[48:51]
  ds_read_b128 v[32:35], v5 offset:18432
  v_mfma_f32_16x16x32_bf16 v[52:55], a[140:143], v[40:43], v[52:55]
  buffer_load_dwordx2 v[180:181], v2, s[4:7], s54 offen offset:2056 sc1
  v_mfma_f32_16x16x32_bf16 v[56:59], a[220:223], v[40:43], v[56:59]
  v_mfma_f32_16x16x32_bf16 v[60:63], a[60:63], v[44:47], v[60:63]
  ds_read_b128 v[36:39], v5 offset:38912
  v_mfma_f32_16x16x32_bf16 v[64:67], a[140:143], v[44:47], v[64:67]
  buffer_load_dwordx4 v2, s[4:7], s18 offen offset:1024 lds
  v_mfma_f32_16x16x32_bf16 v[68:71], a[220:223], v[44:47], v[68:71]
  s_waitcnt lgkmcnt(4)
  v_mfma_f32_16x16x32_bf16 v[48:51], a[64:67], v[16:19], v[48:51]
  ds_read_b128 v[40:43], v5 offset:19456
  v_mfma_f32_16x16x32_bf16 v[52:55], a[144:147], v[16:19], v[52:55]
  v_mfma_f32_16x16x32_bf16 v[56:59], a[224:227], v[16:19], v[56:59]
  buffer_load_dwordx2 v[182:183], v2, s[4:7], s54 offen offset:3080 sc1
  v_mfma_f32_16x16x32_bf16 v[60:63], a[64:67], v[20:23], v[60:63]
  ds_read_b128 v[44:47], v5 offset:39936
  v_mfma_f32_16x16x32_bf16 v[64:67], a[144:147], v[20:23], v[64:67]
  v_mfma_f32_16x16x32_bf16 v[68:71], a[224:227], v[20:23], v[68:71]
  s_waitcnt lgkmcnt(4)
  v_mfma_f32_16x16x32_bf16 v[48:51], a[68:71], v[24:27], v[48:51]
  v_mfma_f32_16x16x32_bf16 v[52:55], a[148:151], v[24:27], v[52:55]
  v_mfma_f32_16x16x32_bf16 v[56:59], a[228:231], v[24:27], v[56:59]
  v_mfma_f32_16x16x32_bf16 v[60:63], a[68:71], v[28:31], v[60:63]
  v_mfma_f32_16x16x32_bf16 v[64:67], a[148:151], v[28:31], v[64:67]
  v_mfma_f32_16x16x32_bf16 v[68:71], a[228:231], v[28:31], v[68:71]
  s_waitcnt lgkmcnt(2)
  v_mfma_f32_16x16x32_bf16 v[48:51], a[72:75], v[32:35], v[48:51]
  v_mfma_f32_16x16x32_bf16 v[52:55], a[152:155], v[32:35], v[52:55]
  v_mfma_f32_16x16x32_bf16 v[56:59], a[232:235], v[32:35], v[56:59]
  v_mfma_f32_16x16x32_bf16 v[60:63], a[72:75], v[36:39], v[60:63]
  v_mfma_f32_16x16x32_bf16 v[64:67], a[152:155], v[36:39], v[64:67]
  v_mfma_f32_16x16x32_bf16 v[68:71], a[232:235], v[36:39], v[68:71]
  s_waitcnt lgkmcnt(0)
  v_mfma_f32_16x16x32_bf16 v[48:51], a[76:79], v[40:43], v[48:51]
  v_mfma_f32_16x16x32_bf16 v[52:55], a[156:159], v[40:43], v[52:55]
  v_mfma_f32_16x16x32_bf16 v[56:59], a[236:239], v[40:43], v[56:59]
  v_mfma_f32_16x16x32_bf16 v[60:63], a[76:79], v[44:47], v[60:63]
  v_mfma_f32_16x16x32_bf16 v[64:67], a[156:159], v[44:47], v[64:67]
  v_mfma_f32_16x16x32_bf16 v[68:71], a[236:239], v[44:47], v[68:71]
  v_add_u32 v5, s19, v5
  s_sub_u32 s13, s13, s19
  s_sub_u32 s19, 0, s19
  s_add_u32 s12, s12, 40960
  s_add_u32 s24, s24, 1
  v_cvt_pk_bf16_f32 v96, v48, v49
  v_cvt_pk_bf16_f32 v97, v50, v51
  v_cvt_pk_bf16_f32 v98, v52, v53
  v_cvt_pk_bf16_f32 v99, v54, v55
  v_cvt_pk_bf16_f32 v100, v56, v57
  v_cvt_pk_bf16_f32 v101, v58, v59
  ds_write_b128 v3, v[96:99] offset:12288
  ds_write_b64 v4, v[100:101] offset:12288
  v_cvt_pk_bf16_f32 v104, v60, v61
  v_cvt_pk_bf16_f32 v105, v62, v63
  v_cvt_pk_bf16_f32 v106, v64, v65
  v_cvt_pk_bf16_f32 v107, v66, v67
  v_cvt_pk_bf16_f32 v108, v68, v69
  v_cvt_pk_bf16_f32 v109, v70, v71
  ds_write_b128 v3, v[104:107] offset:18432
  ds_write_b64 v4, v[108:109] offset:18432
  s_waitcnt lgkmcnt(0)
  s_barrier
  ds_read_b128 v[232:235], v12 offset:0
  ds_read_b128 v[236:239], v12 offset:1024
  ds_read_b128 v[240:243], v12 offset:2048
  ds_read_b128 v[244:247], v12 offset:3072
  ds_read_b128 v[248:251], v12 offset:4096
  ds_read_b128 v[252:255], v12 offset:5120
  s_branch mega_q_sc
mega_q_last:
  s_add_u32 s52, s26, s20
  s_add_u32 s53, s52, 4096
  s_add_u32 s54, s52, 8192
  s_mov_b32 s30, 0
mega0_kernel_pv17:
  buffer_load_dword v86, v84, s[4:7], s71 offen sc1
  s_waitcnt vmcnt(0)
mega0_kernel_pv17_t:
  v_cmp_gt_u32 vcc, s60, v86
  s_nop 0
  s_cbranch_vccz mega0_kernel_pv17_ok
  s_sleep 2
  s_add_u32 s30, s30, 1
  s_cmp_lt_u32 s30, 262144
  s_cbranch_scc1 mega0_kernel_pv17
  s_branch mega_fail
mega0_kernel_pv17_ok:
  buffer_load_dwordx4 v[136:139], v2, s[4:7], s52 offen offset:0 sc1
  buffer_load_dwordx4 v[140:143], v2, s[4:7], s52 offen offset:1024 sc1
  buffer_load_dwordx4 v[144:147], v2, s[4:7], s52 offen offset:2048 sc1
  buffer_load_dwordx4 v[148:151], v2, s[4:7], s52 offen offset:3072 sc1
  buffer_load_dwordx2 v[152:153], v2, s[4:7], s54 offen offset:0 sc1
  buffer_load_dwordx2 v[154:155], v2, s[4:7], s54 offen offset:1024 sc1
  buffer_load_dwordx2 v[156:157], v2, s[4:7], s54 offen offset:2048 sc1
  buffer_load_dwordx2 v[158:159], v2, s[4:7], s54 offen offset:3072 sc1
  buffer_load_dwordx4 v[160:163], v2, s[4:7], s53 offen offset:0 sc1
  buffer_load_dwordx4 v[164:167], v2, s[4:7], s53 offen offset:1024 sc1
  buffer_load_dwordx4 v[168:171], v2, s[4:7], s53 offen offset:2048 sc1
  buffer_load_dwordx4 v[172:175], v2, s[4:7], s53 offen offset:3072 sc1
  buffer_load_dwordx2 v[176:177], v2, s[4:7], s54 offen offset:8 sc1
  buffer_load_dwordx2 v[178:179], v2, s[4:7], s54 offen offset:1032 sc1
  buffer_load_dwordx2 v[180:181], v2, s[4:7], s54 offen offset:2056 sc1
  buffer_load_dwordx2 v[182:183], v2, s[4:7], s54 offen offset:3080 sc1
mega_q_sc:
  s_waitcnt vmcnt(0)
  v_mfma_f32_16x16x32_bf16 v[208:211], v[136:139], v[112:115], 0
  v_mfma_f32_16x16x32_bf16 v[212:215], v[160:163], v[112:115], 0
  v_mfma_f32_16x16x32_bf16 v[208:211], v[140:143], v[116:119], v[208:211]
  v_mfma_f32_16x16x32_bf16 v[212:215], v[164:167], v[116:119], v[212:215]
  v_mfma_f32_16x16x32_bf16 v[208:211], v[144:147], v[120:123], v[208:211]
  v_mfma_f32_16x16x32_bf16 v[212:215], v[168:171], v[120:123], v[212:215]
  v_mfma_f32_16x16x32_bf16 v[208:211], v[148:151], v[124:127], v[208:211]
  v_mfma_f32_16x16x32_bf16 v[212:215], v[172:175], v[124:127], v[212:215]
  v_mfma_f32_16x16x32_bf16 v[208:211], v[152:155], v[128:131], v[208:211]
  v_mfma_f32_16x16x32_bf16 v[212:215], v[176:179], v[128:131], v[212:215]
  v_mfma_f32_16x16x32_bf16 v[208:211], v[156:159], v[132:135], v[208:211]
  v_mfma_f32_16x16x32_bf16 v[212:215], v[180:183], v[132:135], v[212:215]
  s_add_u32 s52, s27, s20
  s_add_u32 s53, s28, s20
  s_mov_b32 s30, 0
mega0_kernel_pv18:
  buffer_load_dword v86, v85, s[4:7], s71 offen sc1
  s_waitcnt vmcnt(0)
mega0_kernel_pv18_t:
  v_cmp_gt_u32 vcc, s60, v86
  s_nop 0
  s_cbranch_vccz mega0_kernel_pv18_ok
  s_sleep 1
  s_add_u32 s30, s30, 1
  s_cmp_lt_u32 s30, 262144
  s_cbranch_scc1 mega0_kernel_pv18
  s_branch mega_fail
mega0_kernel_pv18_ok:
  buffer_load_dwordx4 v[184:187], v11, s[4:7], s52 offen offset:0 sc1
  buffer_load_dwordx4 v[188:191], v11, s[4:7], s52 offen offset:512 sc1
  buffer_load_dwordx4 v[192:195], v11, s[4:7], s52 offen offset:1024 sc1
  buffer_load_dwordx4 v[196:199], v11, s[4:7], s52 offen offset:1536 sc1
  buffer_load_dwordx2 v[200:201], v8, s[4:7], s52 offen offset:2048 sc1
  buffer_load_dwordx2 v[202:203], v8, s[4:7], s52 offen offset:2304 sc1
  buffer_load_dwordx2 v[204:205], v8, s[4:7], s52 offen offset:2560 sc1
  buffer_load_dwordx2 v[206:207], v8, s[4:7], s52 offen offset:2816 sc1
  s_bitcmp0_b32 s3, 0
  s_cselect_b64 s[56:57], s[32:33], -1
  s_cselect_b64 s[58:59], 0, s[32:33]
  v_cndmask_b32 v208, v13, v208, s[56:57]
  v_cndmask_b32 v212, v13, v212, s[58:59]
  s_cselect_b64 s[56:57], s[34:35], -1
  s_cselect_b64 s[58:59], 0, s[34:35]
  v_cndmask_b32 v209, v13, v209, s[56:57]
  v_cndmask_b32 v213, v13, v213, s[58:59]
  s_cselect_b64 s[56:57], s[36:37], -1
  s_cselect_b64 s[58:59], 0, s[36:37]
  v_cndmask_b32 v210, v13, v210, s[56:57]
  v_cndmask_b32 v214, v13, v214, s[58:59]
  s_cselect_b64 s[56:57], s[38:39], -1
  s_cselect_b64 s[58:59], 0, s[38:39]
  v_cndmask_b32 v211, v13, v211, s[56:57]
  v_cndmask_b32 v215, v13, v215, s[58:59]
  v_max3_f32 v220, v208, v209, v210
  v_max3_f32 v220, v220, v211, v212
  v_max3_f32 v220, v220, v213, v214
  v_max_f32 v220, v220, v215
  s_waitcnt vmcnt(7)
  v_mfma_f32_16x16x32_bf16 v[216:219], v[184:187], v[112:115], 0
  s_waitcnt vmcnt(6)
  v_mfma_f32_16x16x32_bf16 v[216:219], v[188:191], v[116:119], v[216:219]
  s_waitcnt vmcnt(5)
  v_mfma_f32_16x16x32_bf16 v[216:219], v[192:195], v[120:123], v[216:219]
  s_waitcnt vmcnt(4)
  v_mfma_f32_16x16x32_bf16 v[216:219], v[196:199], v[124:127], v[216:219]
  s_waitcnt vmcnt(2)
  v_mfma_f32_16x16x32_bf16 v[216:219], v[200:203], v[128:131], v[216:219]
  s_waitcnt vmcnt(0)
  v_mfma_f32_16x16x32_bf16 v[216:219], v[204:207], v[132:135], v[216:219]
  s_nop 7
  v_cndmask_b32 v216, v13, v216, s[40:41]
  v_cndmask_b32 v217, v13, v217, s[40:41]
  v_cndmask_b32 v218, v13, v218, s[40:41]
  v_cndmask_b32 v219, v13, v219, s[40:41]
  v_max3_f32 v220, v220, v216, v217
  v_max3_f32 v220, v220, v218, v219
  v_mov_b32 v221, v220
  s_nop 1
  v_permlane16_swap_b32 v220, v221
  v_max_f32 v220, v220, v221
  v_mov_b32 v221, v220
  s_nop 1
  v_permlane32_swap_b32 v220, v221
  v_max_f32 v220, v220, v221
  v_mul_f32 v220, s42, v220
  v_fma_f32 v208, v208, s42, -v220
  v_fma_f32 v209, v209, s42, -v220
  v_fma_f32 v210, v210, s42, -v220
  v_fma_f32 v211, v211, s42, -v220
  v_fma_f32 v212, v212, s42, -v220
  v_fma_f32 v213, v213, s42, -v220
  v_fma_f32 v214, v214, s42, -v220
  v_fma_f32 v215, v215, s42, -v220
  v_fma_f32 v216, v216, s42, -v220
  v_fma_f32 v217, v217, s42, -v220
  v_fma_f32 v218, v218, s42, -v220
  v_fma_f32 v219, v219, s42, -v220
  v_exp_f32 v208, v208
  v_exp_f32 v209, v209
  v_exp_f32 v210, v210
  v_exp_f32 v211, v211
  v_exp_f32 v212, v212
  v_exp_f32 v213, v213
  v_exp_f32 v214, v214
  v_exp_f32 v215, v215
  v_exp_f32 v216, v216
  v_exp_f32 v217, v217
  v_exp_f32 v218, v218
  v_exp_f32 v219, v219
  v_cndmask_b32 v216, 0, v216, s[40:41]
  v_cndmask_b32 v217, 0, v217, s[40:41]
  v_cndmask_b32 v218, 0, v218, s[40:41]
  v_cndmask_b32 v219, 0, v219, s[40:41]
  v_add_f32 v220, v208, v209
  v_add_f32 v220, v220, v210
  v_add_f32 v220, v220, v211
  v_add_f32 v220, v220, v212
  v_add_f32 v220, v220, v213
  v_add_f32 v220, v220, v214
  v_add_f32 v220, v220, v215
  v_add_f32 v220, v220, v216
  v_add_f32 v220, v220, v217
  v_add_f32 v220, v220, v218
  v_add_f32 v220, v220, v219
  v_mov_b32 v221, v220
  s_nop 1
  v_permlane16_swap_b32 v220, v221
  v_add_f32 v220, v220, v221
  v_mov_b32 v221, v220
  s_nop 1
  v_permlane32_swap_b32 v220, v221
  v_add_f32 v220, v220, v221
  v_rcp_f32 v220, v220
  s_nop 0
  v_mul_f32 v208, v208, v220
  v_mul_f32 v209, v209, v220
  v_mul_f32 v210, v210, v220
  v_mul_f32 v211, v211, v220
  v_mul_f32 v212, v212, v220
  v_mul_f32 v213, v213, v220
  v_mul_f32 v214, v214, v220
  v_mul_f32 v215, v215, v220
  v_mul_f32 v216, v216, v220
  v_mul_f32 v217, v217, v220
  v_mul_f32 v218, v218, v220
  v_mul_f32 v219, v219, v220
  v_cvt_pk_bf16_f32 v224, v208, v209
  v_cvt_pk_bf16_f32 v225, v210, v211
  v_cvt_pk_bf16_f32 v226, v212, v213
  v_cvt_pk_bf16_f32 v227, v214, v215
  v_cvt_pk_bf16_f32 v228, v216, v217
  v_cvt_pk_bf16_f32 v229, v218, v219
  buffer_store_dwordx4 v[224:227], v14, s[4:7], s53 offen
  s_mov_b64 exec, s[40:41]
  buffer_store_dwordx2 v[228:229], v15, s[4:7], s53 offen
  s_mov_b64 exec, -1
  s_add_u32 s20, s20, 651264
  s_cmp_ge_u32 s20, 1302528
  s_cselect_b32 s30, 1302528, 0
  s_sub_u32 s20, s20, s30
  s_add_u32 s61, s60, 1
  s_add_u32 s60, s60, 2
  s_add_u32 s62, s62, 2
  s_waitcnt vmcnt(0)
  v_mov_b32 v220, s61
  s_mov_b64 exec, 1
  s_cmp_lg_u32 s69, 0
  s_cbranch_scc1 mega0_kernel_pf19
  buffer_store_dword v220, v7, s[4:7], s50 offen
mega0_kernel_pf19_b:
  s_mov_b64 exec, -1
  s_cmp_lt_u32 s62, 64
  s_cbranch_scc1 mega_q_loop
  s_endpgm
mega0_kernel_pf2:
  buffer_wbl2 sc1
  s_waitcnt vmcnt(0)
  buffer_store_dword v8, v7, s[4:7], s25 offen sc1
  s_branch mega0_kernel_pf2_b
mega0_kernel_pf4:
  buffer_store_dword v8, v7, s[4:7], s51 offen sc1
  s_branch mega0_kernel_pf4_b
mega0_kernel_pf5:
  buffer_wbl2 sc1
  s_waitcnt vmcnt(0)
  buffer_store_dword v8, v7, s[4:7], s25 offen sc1
  s_branch mega0_kernel_pf5_b
mega0_kernel_pf7:
  buffer_store_dword v8, v7, s[4:7], s51 offen sc1
  s_branch mega0_kernel_pf7_b
mega0_kernel_pf9:
  buffer_wbl2 sc1
  s_waitcnt vmcnt(0)
  buffer_store_dword v8, v7, s[4:7], s25 offen sc1
  s_branch mega0_kernel_pf9_b
mega0_kernel_pf14:
  buffer_wbl2 sc1
  s_waitcnt vmcnt(0)
  buffer_store_dword v8, v7, s[4:7], s21 offen sc1
  s_branch mega0_kernel_pf14_b
mega0_kernel_pf19:
  buffer_wbl2 sc1
  s_waitcnt vmcnt(0)
  buffer_store_dword v220, v7, s[4:7], s50 offen sc1
  s_branch mega0_kernel_pf19_b
mega_rec:
  s_lshr_b32 s9, s2, 3
  s_lshr_b32 s10, s9, 2
  s_lshl_b32 s27, s68, 2
  s_add_u32 s10, s10, s27
  s_and_b32 s11, s9, 3
  s_mul_i32 s48, s10, 384
  s_mul_i32 s28, s11, 96
  s_add_u32 s48, s48, s28
  s_mul_i32 s28, s3, 1966080
  s_add_u32 s48, s48, s28
  s_mov_b32 s49, s48
  s_mul_i32 s50, s3, 15360
  s_add_u32 s50, s50, 40960
  s_add_u32 s51, s50, 61440
  v_mul_u32_u24 v22, 10923, v1
  v_lshrrev_b32 v22, 16, v22
  v_mul_u32_u24 v20, 6, v22
  v_sub_u32 v20, v1, v20
  v_lshlrev_b32 v20, 4, v20
  v_mul_u32_u24 v22, 12288, v22
  v_add_u32 v20, v20, v22
  v_lshrrev_b32 v22, 4, v1
  v_mul_u32_u24 v22, 8, v22
  v_bfe_u32 v21, v1, 2, 2
  v_add_u32 v22, v22, v21
  v_mul_u32_u24 v22, 96, v22
  v_and_b32 v21, 3, v1
  v_lshl_add_u32 v21, v21, 3, v22
  s_mov_b64 exec, s[82:83]
  s_add_u32 m0, s50, 0
  s_nop 0
  buffer_load_dwordx4 v20, s[92:95], s48 offen lds
  s_add_u32 s48, s48, 122880
  s_add_u32 m0, s50, 960
  s_nop 0
  buffer_load_dwordx4 v20, s[92:95], s48 offen lds
  s_add_u32 s48, s48, 122880
  s_add_u32 m0, s50, 1920
  s_nop 0
  buffer_load_dwordx4 v20, s[92:95], s48 offen lds
  s_add_u32 s48, s48, 122880
  s_add_u32 m0, s50, 2880
  s_nop 0
  buffer_load_dwordx4 v20, s[92:95], s48 offen lds
  s_add_u32 s48, s48, 122880
  s_add_u32 m0, s50, 3840
  s_nop 0
  buffer_load_dwordx4 v20, s[92:95], s48 offen lds
  s_add_u32 s48, s48, 122880
  s_add_u32 m0, s50, 4800
  s_nop 0
  buffer_load_dwordx4 v20, s[92:95], s48 offen lds
  s_add_u32 s48, s48, 122880
  s_add_u32 m0, s50, 5760
  s_nop 0
  buffer_load_dwordx4 v20, s[92:95], s48 offen lds
  s_add_u32 s48, s48, 122880
  s_add_u32 m0, s50, 6720
  s_nop 0
  buffer_load_dwordx4 v20, s[92:95], s48 offen lds
  s_add_u32 s48, s48, 122880
  s_add_u32 m0, s50, 7680
  s_nop 0
  buffer_load_dwordx4 v20, s[92:95], s48 offen lds
  s_add_u32 s48, s48, 122880
  s_add_u32 m0, s50, 8640
  s_nop 0
  buffer_load_dwordx4 v20, s[92:95], s48 offen lds
  s_add_u32 s48, s48, 122880
  s_add_u32 m0, s50, 9600
  s_nop 0
  buffer_load_dwordx4 v20, s[92:95], s48 offen lds
  s_add_u32 s48, s48, 122880
  s_add_u32 m0, s50, 10560
  s_nop 0
  buffer_load_dwordx4 v20, s[92:95], s48 offen lds
  s_add_u32 s48, s48, 122880
  s_add_u32 m0, s50, 11520
  s_nop 0
  buffer_load_dwordx4 v20, s[92:95], s48 offen lds
  s_add_u32 s48, s48, 122880
  s_add_u32 m0, s50, 12480
  s_nop 0
  buffer_load_dwordx4 v20, s[92:95], s48 offen lds
  s_add_u32 s48, s48, 122880
  s_add_u32 m0, s50, 13440
  s_nop 0
  buffer_load_dwordx4 v20, s[92:95], s48 offen lds
  s_add_u32 s48, s48, 122880
  s_add_u32 m0, s50, 14400
  s_nop 0
  buffer_load_dwordx4 v20, s[92:95], s48 offen lds
  s_add_u32 s48, s48, 122880
  s_mov_b64 exec, -1
  s_mov_b64 exec, s[82:83]
  s_add_u32 m0, s51, 0
  s_nop 0
  buffer_load_dwordx4 v20, s[96:99], s49 offen lds
  s_add_u32 s49, s49, 122880
  s_add_u32 m0, s51, 960
  s_nop 0
  buffer_load_dwordx4 v20, s[96:99], s49 offen lds
  s_add_u32 s49, s49, 122880
  s_add_u32 m0, s51, 1920
  s_nop 0
  buffer_load_dwordx4 v20, s[96:99], s49 offen lds
  s_add_u32 s49, s49, 122880
  s_add_u32 m0, s51, 2880
  s_nop 0
  buffer_load_dwordx4 v20, s[96:99], s49 offen lds
  s_add_u32 s49, s49, 122880
  s_add_u32 m0, s51, 3840
  s_nop 0
  buffer_load_dwordx4 v20, s[96:99], s49 offen lds
  s_add_u32 s49, s49, 122880
  s_add_u32 m0, s51, 4800
  s_nop 0
  buffer_load_dwordx4 v20, s[96:99], s49 offen lds
  s_add_u32 s49, s49, 122880
  s_add_u32 m0, s51, 5760
  s_nop 0
  buffer_load_dwordx4 v20, s[96:99], s49 offen lds
  s_add_u32 s49, s49, 122880
  s_add_u32 m0, s51, 6720
  s_nop 0
  buffer_load_dwordx4 v20, s[96:99], s49 offen lds
  s_add_u32 s49, s49, 122880
  s_add_u32 m0, s51, 7680
  s_nop 0
  buffer_load_dwordx4 v20, s[96:99], s49 offen lds
  s_add_u32 s49, s49, 122880
  s_add_u32 m0, s51, 8640
  s_nop 0
  buffer_load_dwordx4 v20, s[96:99], s49 offen lds
  s_add_u32 s49, s49, 122880
  s_add_u32 m0, s51, 9600
  s_nop 0
  buffer_load_dwordx4 v20, s[96:99], s49 offen lds
  s_add_u32 s49, s49, 122880
  s_add_u32 m0, s51, 10560
  s_nop 0
  buffer_load_dwordx4 v20, s[96:99], s49 offen lds
  s_add_u32 s49, s49, 122880
  s_add_u32 m0, s51, 11520
  s_nop 0
  buffer_load_dwordx4 v20, s[96:99], s49 offen lds
  s_add_u32 s49, s49, 122880
  s_add_u32 m0, s51, 12480
  s_nop 0
  buffer_load_dwordx4 v20, s[96:99], s49 offen lds
  s_add_u32 s49, s49, 122880
  s_add_u32 m0, s51, 13440
  s_nop 0
  buffer_load_dwordx4 v20, s[96:99], s49 offen lds
  s_add_u32 s49, s49, 122880
  s_add_u32 m0, s51, 14400
  s_nop 0
  buffer_load_dwordx4 v20, s[96:99], s49 offen lds
  s_add_u32 s49, s49, 122880
  s_mov_b64 exec, -1
  v_and_b32 v16, 15, v1
  v_lshrrev_b32 v17, 4, v1
  v_and_b32 v18, 7, v1
  v_lshrrev_b32 v19, 3, v16
  v_lshlrev_b32 v2, 4, v1
  s_mul_i32 s27, s9, 40
  v_add_u32 v20, s27, v16
  v_lshrrev_b32 v22, 4, v20
  v_mul_u32_u24 v22, 20480, v22
  v_and_b32 v20, 15, v20
  v_lshl_add_u32 v22, v20, 4, v22
  v_lshl_add_u32 v22, v17, 8, v22
  s_lshl_b32 s28, s68, 2
  s_mul_i32 s53, s28, 819200
  s_add_u32 s53, s53, 0
  s_mul_i32 s28, s3, 819200
  s_add_u32 s52, s53, s28
  buffer_load_dwordx4 a[0:3], v22, s[4:7], s52 offen offset:0
  buffer_load_dwordx4 a[4:7], v22, s[4:7], s52 offen offset:1024
  buffer_load_dwordx4 a[8:11], v22, s[4:7], s52 offen offset:2048
  buffer_load_dwordx4 a[12:15], v22, s[4:7], s52 offen offset:3072
  s_add_u32 s52, s52, 4096
  buffer_load_dwordx4 a[16:19], v22, s[4:7], s52 offen offset:0
  buffer_load_dwordx4 a[20:23], v22, s[4:7], s52 offen offset:1024
  buffer_load_dwordx4 a[24:27], v22, s[4:7], s52 offen offset:2048
  buffer_load_dwordx4 a[28:31], v22, s[4:7], s52 offen offset:3072
  s_add_u32 s52, s52, 4096
  buffer_load_dwordx4 a[32:35], v22, s[4:7], s52 offen offset:0
  buffer_load_dwordx4 a[36:39], v22, s[4:7], s52 offen offset:1024
  buffer_load_dwordx4 a[40:43], v22, s[4:7], s52 offen offset:2048
  buffer_load_dwordx4 a[44:47], v22, s[4:7], s52 offen offset:3072
  s_add_u32 s52, s52, 4096
  buffer_load_dwordx4 a[48:51], v22, s[4:7], s52 offen offset:0
  buffer_load_dwordx4 a[52:55], v22, s[4:7], s52 offen offset:1024
  buffer_load_dwordx4 a[56:59], v22, s[4:7], s52 offen offset:2048
  buffer_load_dwordx4 a[60:63], v22, s[4:7], s52 offen offset:3072
  s_add_u32 s52, s52, 4096
  buffer_load_dwordx4 a[64:67], v22, s[4:7], s52 offen offset:0
  buffer_load_dwordx4 a[68:71], v22, s[4:7], s52 offen offset:1024
  buffer_load_dwordx4 a[72:75], v22, s[4:7], s52 offen offset:2048
  buffer_load_dwordx4 a[76:79], v22, s[4:7], s52 offen offset:3072
  s_add_u32 s52, s52, 4096
  s_add_u32 s27, s27, 32
  v_add_u32 v20, s27, v18
  v_lshrrev_b32 v23, 4, v20
  v_mul_u32_u24 v23, 20480, v23
  v_and_b32 v20, 15, v20
  v_lshl_add_u32 v23, v20, 4, v23
  v_lshl_add_u32 v23, v17, 8, v23
  v_mul_u32_u24 v20, 819200, v19
  v_add_u32 v23, v23, v20
  s_mov_b32 s26, 0x3dd53b95
  s_mov_b32 s42, 0xff00ff00
  s_mov_b32 s43, 0xff00ff00
  v_bfe_u32 v20, v1, 1, 1
  v_mul_u32_u24 v20, 0xaaaa, v20
  v_add_u32 v9, 0x4444, v20
  s_lshr_b32 s27, s3, 1
  s_lshl_b32 s27, s27, 10
  s_and_b32 s28, s3, 1
  s_lshl_b32 s28, s28, 3
  s_add_u32 s27, s27, s28
  v_add_u32 v3, s27, v2
  v_mul_u32_u24 v20, 640, v17
  v_lshl_add_u32 v4, v16, 4, v20
  v_lshrrev_b32 v21, 2, v16
  v_lshl_add_u32 v5, v21, 5, v20
  v_and_b32 v21, 1, v16
  v_lshl_add_u32 v5, v21, 4, v5
  v_lshl_add_u32 v20, v19, 2, v17
  v_and_b32 v6, 3, v1
  v_lshlrev_b32 v6, 8, v6
  v_lshl_add_u32 v6, v20, 4, v6
  v_and_b32 v21, 4, v1
  v_lshl_add_u32 v6, v21, 1, v6
  s_lshl_b32 s27, s3, 10
  v_add_u32 v6, s27, v6
  v_lshlrev_b32 v7, 1, v18
  v_lshl_add_u32 v7, v20, 4, v7
  s_lshl_b32 s28, s3, 8
  v_add_u32 v7, s28, v7
  v_lshlrev_b32 v8, 2, v17
  v_lshl_add_u32 v8, v16, 4, v8
  v_add_u32 v8, s28, v8
  v_bfe_u32 v20, v1, 2, 1
  v_and_b32 v21, 1, v17
  v_lshl_add_u32 v20, v21, 2, v20
  v_lshrrev_b32 v21, 1, v17
  v_lshl_add_u32 v21, v21, 1, v19
  v_lshl_add_u32 v24, v21, 3, v20
  v_mul_u32_u24 v21, 40, v21
  v_add_u32 v26, v21, v20
  v_and_b32 v20, 3, v1
  v_lshlrev_b32 v20, 3, v20
  v_mul_u32_u24 v24, 96, v24
  v_add_u32 v24, v24, v20
  v_add_u32 v24, 40960, v24
  v_add_u32 v25, 61440, v24
  v_mul_u32_u24 v26, 96, v26
  v_add_u32 v26, v26, v20
  v_add_u32 v26, 40960, v26
  v_add_u32 v27, 61440, v26
  v_and_b32 v20, 1, v1
  v_lshlrev_b32 v20, 4, v20
  v_mov_b32 v21, 0x3f80
  v_lshlrev_b32 v20, v20, v21
  v_lshrrev_b32 v21, 1, v16
  v_cmp_eq_u32 vcc, 0, v21
  s_nop 1
  v_cndmask_b32 v28, 0, v20, vcc
  v_cmp_eq_u32 vcc, 4, v21
  s_nop 1
  v_cndmask_b32 v32, 0, v20, vcc
  v_or_b32 v36, v28, v32
  v_cmp_eq_u32 vcc, 1, v21
  s_nop 1
  v_cndmask_b32 v29, 0, v20, vcc
  v_cmp_eq_u32 vcc, 5, v21
  s_nop 1
  v_cndmask_b32 v33, 0, v20, vcc
  v_or_b32 v37, v29, v33
  v_cmp_eq_u32 vcc, 2, v21
  s_nop 1
  v_cndmask_b32 v30, 0, v20, vcc
  v_cmp_eq_u32 vcc, 6, v21
  s_nop 1
  v_cndmask_b32 v34, 0, v20, vcc
  v_or_b32 v38, v30, v34
  v_cmp_eq_u32 vcc, 3, v21
  s_nop 1
  v_cndmask_b32 v31, 0, v20, vcc
  v_cmp_eq_u32 vcc, 7, v21
  s_nop 1
  v_cndmask_b32 v35, 0, v20, vcc
  v_or_b32 v39, v31, v35
  v_cmp_eq_u32 vcc, v17, v21
  s_nop 1
  v_cndmask_b32 v40, 0, v20, vcc
  v_add_u32 v41, 4, v17
  v_cmp_eq_u32 vcc, v41, v21
  s_nop 1
  v_cndmask_b32 v41, 0, v20, vcc
  v_mov_b32 v42, v40
  v_mov_b32 v43, v41
  s_mul_i32 s27, s68, 20480
  s_mul_i32 s28, s70, 163840
  s_add_u32 s27, s27, s28
  s_add_u32 s17, s27, 56033280
  s_add_u32 s16, s17, 10240
  s_add_u32 s27, s27, 56360960
  s_mul_i32 s28, s9, 640
  s_add_u32 s18, s27, s28
  s_add_u32 s19, s18, 10240
  s_mul_i32 s28, s3, 2560
  s_add_u32 s20, s27, s28
  s_add_u32 s21, s20, 10240
  s_mul_i32 s29, s68, 1302528
  s_add_u32 s29, s29, 28835840
  s_lshr_b32 s28, s9, 2
  s_mul_i32 s22, s28, 12288
  s_lshl_b32 s27, s11, 10
  s_add_u32 s22, s22, s27
  s_add_u32 s22, s22, s29
  s_add_u32 s22, s22, 204800
  s_mul_i32 s23, s28, 3072
  s_add_u32 s23, s23, s29
  s_add_u32 s23, s23, 303104
  s_mov_b32 s24, s29
  s_add_u32 s25, s24, 163840
  s_mov_b32 s72, 0
  s_mov_b32 s12, 0
  s_mov_b32 s76, 0
  s_lshl_b32 s27, s10, 7
  s_lshl_b32 s28, s11, 2
  s_add_u32 s54, s27, s28
  s_add_u32 s77, s54, s71
  s_add_u32 s77, s77, 16384
  s_mov_b32 s33, s52
  s_mov_b32 s34, s53
  s_mov_b32 s35, s54
  s_add_u32 s64, s4, 93487104
  s_addc_u32 s65, s5, 0
  s_mov_b32 s31, 0
  s_load_dwordx16 s[48:63], s[64:65], 0
  s_waitcnt lgkmcnt(0)
  s_add_u32 s48, s48, s49
  s_add_u32 s48, s48, s50
  s_add_u32 s48, s48, s51
  s_add_u32 s48, s48, s52
  s_add_u32 s48, s48, s53
  s_add_u32 s48, s48, s54
  s_add_u32 s48, s48, s55
  s_cmp_ge_u32 s48, 4
  s_cselect_b32 s48, 0, 1
  s_or_b32 s31, s31, s48
  s_add_u32 s56, s56, s57
  s_add_u32 s56, s56, s58
  s_add_u32 s56, s56, s59
  s_add_u32 s56, s56, s60
  s_add_u32 s56, s56, s61
  s_add_u32 s56, s56, s62
  s_add_u32 s56, s56, s63
  s_cmp_ge_u32 s56, 4
  s_cselect_b32 s56, 0, 2
  s_or_b32 s31, s31, s56
  s_load_dwordx16 s[48:63], s[64:65], 64
  s_waitcnt lgkmcnt(0)
  s_add_u32 s48, s48, s49
  s_add_u32 s48, s48, s50
  s_add_u32 s48, s48, s51
  s_add_u32 s48, s48, s52
  s_add_u32 s48, s48, s53
  s_add_u32 s48, s48, s54
  s_add_u32 s48, s48, s55
  s_cmp_ge_u32 s48, 4
  s_cselect_b32 s48, 0, 4
  s_or_b32 s31, s31, s48
  s_add_u32 s56, s56, s57
  s_add_u32 s56, s56, s58
  s_add_u32 s56, s56, s59
  s_add_u32 s56, s56, s60
  s_add_u32 s56, s56, s61
  s_add_u32 s56, s56, s62
  s_add_u32 s56, s56, s63
  s_cmp_ge_u32 s56, 4
  s_cselect_b32 s56, 0, 8
  s_or_b32 s31, s31, s56
  s_mov_b32 s52, s33
  s_mov_b32 s53, s34
  s_mov_b32 s54, s35
  s_cmp_ge_u32 s68, 4
  s_cselect_b32 s27, 15, 0
  s_xor_b32 s31, s31, s27
  s_add_u32 s30, s4, 58785791
  s_and_b32 s30, s30, 0xffe00000
  s_sub_u32 s30, s30, s4
  s_lshl_b32 s27, s9, 1
  s_add_u32 s27, s27, s3
  s_lshr_b32 s28, s27, 2
  s_lshl_b32 s28, s28, 14
  s_and_b32 s27, s27, 3
  s_lshl_b32 s27, s27, 11
  s_add_u32 s27, s27, s28
  s_lshr_b32 s28, s9, 3
  s_add_u32 s28, s28, 8
  s_lshl_b32 s28, s28, 14
  s_and_b32 s29, s9, 7
  s_lshl_b32 s29, s29, 10
  s_add_u32 s28, s28, s29
  s_cmp_lt_u32 s3, 2
  s_cselect_b32 s27, s27, s28
  s_cselect_b32 s28, 8, 7
  s_lshl_b32 s29, s68, s28
  s_add_u32 s30, s30, s27
  s_and_b32 s27, s68, 3
  s_lshr_b32 s28, s31, s27
  s_and_b32 s28, s28, 1
  s_lshl_b32 s28, s28, 13
  s_mul_i32 s27, s27, 2260992
  s_add_u32 s32, s30, s27
  s_add_u32 s32, s32, s28
  s_add_u32 s30, s30, s29
  s_mul_i32 s39, s70, 63
  s_sub_u32 s39, s39, 1
  s_mov_b32 s15, 0
  s_mov_b32 s78, 0
  s_mov_b32 s75, 0
  s_mov_b32 s80, 0
  s_waitcnt vmcnt(40)
  buffer_load_dwordx4 a[80:83], v22, s[4:7], s52 offen offset:0
  buffer_load_dwordx4 a[84:87], v22, s[4:7], s52 offen offset:1024
  buffer_load_dwordx4 a[88:91], v22, s[4:7], s52 offen offset:2048
  buffer_load_dwordx4 a[92:95], v22, s[4:7], s52 offen offset:3072
  s_add_u32 s52, s52, 4096
  buffer_load_dwordx4 a[96:99], v22, s[4:7], s52 offen offset:0
  buffer_load_dwordx4 a[100:103], v22, s[4:7], s52 offen offset:1024
  buffer_load_dwordx4 a[104:107], v22, s[4:7], s52 offen offset:2048
  buffer_load_dwordx4 a[108:111], v22, s[4:7], s52 offen offset:3072
  s_add_u32 s52, s52, 4096
  buffer_load_dwordx4 a[112:115], v22, s[4:7], s52 offen offset:0
  buffer_load_dwordx4 a[116:119], v22, s[4:7], s52 offen offset:1024
  buffer_load_dwordx4 a[120:123], v22, s[4:7], s52 offen offset:2048
  buffer_load_dwordx4 a[124:127], v22, s[4:7], s52 offen offset:3072
  s_add_u32 s52, s52, 4096
  buffer_load_dwordx4 a[128:131], v22, s[4:7], s52 offen offset:0
  buffer_load_dwordx4 a[132:135], v22, s[4:7], s52 offen offset:1024
  buffer_load_dwordx4 a[136:139], v22, s[4:7], s52 offen offset:2048
  buffer_load_dwordx4 a[140:143], v22, s[4:7], s52 offen offset:3072
  s_add_u32 s52, s52, 4096
  buffer_load_dwordx4 a[144:147], v22, s[4:7], s52 offen offset:0
  buffer_load_dwordx4 a[148:151], v22, s[4:7], s52 offen offset:1024
  buffer_load_dwordx4 a[152:155], v22, s[4:7], s52 offen offset:2048
  buffer_load_dwordx4 a[156:159], v22, s[4:7], s52 offen offset:3072
  s_add_u32 s52, s52, 4096
  s_waitcnt vmcnt(40)
  s_barrier
  s_cmp_eq_u32 s3, 1
  s_cbranch_scc1 mega_pro1
  s_cmp_eq_u32 s3, 2
  s_cbranch_scc1 mega_pro2
  s_cmp_eq_u32 s3, 3
  s_cbranch_scc1 mega_pro3
  ds_read_b64_tr_b16 v[136:137], v24 offset:0
  ds_read_b64_tr_b16 v[138:139], v24 offset:192
  ds_read_b64_tr_b16 v[140:141], v24 offset:3840
  ds_read_b64_tr_b16 v[142:143], v24 offset:4032
  ds_read_b64_tr_b16 v[144:145], v25 offset:0
  ds_read_b64_tr_b16 v[146:147], v25 offset:192
  ds_read_b64_tr_b16 v[148:149], v25 offset:3840
  ds_read_b64_tr_b16 v[150:151], v25 offset:4032
  ds_read_b64_tr_b16 v[152:153], v24 offset:7680
  ds_read_b64_tr_b16 v[154:155], v24 offset:7872
  ds_read_b64_tr_b16 v[156:157], v24 offset:11520
  ds_read_b64_tr_b16 v[158:159], v24 offset:11712
  ds_read_b64_tr_b16 v[160:161], v25 offset:7680
  ds_read_b64_tr_b16 v[162:163], v25 offset:7872
  ds_read_b64_tr_b16 v[164:165], v25 offset:11520
  ds_read_b64_tr_b16 v[166:167], v25 offset:11712
  ds_read_b64_tr_b16 v[168:169], v24 offset:15360
  ds_read_b64_tr_b16 v[170:171], v24 offset:15552
  ds_read_b64_tr_b16 v[172:173], v24 offset:19200
  ds_read_b64_tr_b16 v[174:175], v24 offset:19392
  ds_read_b64_tr_b16 v[176:177], v25 offset:15360
  ds_read_b64_tr_b16 v[178:179], v25 offset:15552
  ds_read_b64_tr_b16 v[180:181], v25 offset:19200
  ds_read_b64_tr_b16 v[182:183], v25 offset:19392
  ds_read_b64_tr_b16 v[184:185], v24 offset:32
  ds_read_b64_tr_b16 v[186:187], v24 offset:224
  ds_read_b64_tr_b16 v[188:189], v24 offset:3872
  ds_read_b64_tr_b16 v[190:191], v24 offset:4064
  ds_read_b64_tr_b16 v[192:193], v25 offset:32
  ds_read_b64_tr_b16 v[194:195], v25 offset:224
  ds_read_b64_tr_b16 v[196:197], v25 offset:3872
  ds_read_b64_tr_b16 v[198:199], v25 offset:4064
  ds_read_b64_tr_b16 v[200:201], v24 offset:7712
  ds_read_b64_tr_b16 v[202:203], v24 offset:7904
  ds_read_b64_tr_b16 v[204:205], v24 offset:11552
  ds_read_b64_tr_b16 v[206:207], v24 offset:11744
  ds_read_b64_tr_b16 v[208:209], v25 offset:7712
  ds_read_b64_tr_b16 v[210:211], v25 offset:7904
  ds_read_b64_tr_b16 v[212:213], v25 offset:11552
  ds_read_b64_tr_b16 v[214:215], v25 offset:11744
  ds_read_b64_tr_b16 v[216:217], v24 offset:15392
  ds_read_b64_tr_b16 v[218:219], v24 offset:15584
  ds_read_b64_tr_b16 v[220:221], v24 offset:19232
  ds_read_b64_tr_b16 v[222:223], v24 offset:19424
  ds_read_b64_tr_b16 v[224:225], v24 offset:64
  ds_read_b64_tr_b16 v[226:227], v24 offset:256
  ds_read_b64_tr_b16 v[228:229], v24 offset:3904
  ds_read_b64_tr_b16 v[230:231], v24 offset:4096
  ds_read_b64_tr_b16 v[232:233], v25 offset:64
  ds_read_b64_tr_b16 v[234:235], v25 offset:256
  ds_read_b64_tr_b16 v[236:237], v25 offset:3904
  ds_read_b64_tr_b16 v[238:239], v25 offset:4096
  ds_read_b64_tr_b16 v[240:241], v24 offset:7744
  ds_read_b64_tr_b16 v[242:243], v24 offset:7936
  ds_read_b64_tr_b16 v[244:245], v24 offset:11584
  ds_read_b64_tr_b16 v[246:247], v24 offset:11776
  ds_read_b64_tr_b16 v[248:249], v25 offset:7744
  ds_read_b64_tr_b16 v[250:251], v25 offset:7936
  ds_read_b64_tr_b16 v[252:253], v25 offset:11584
  ds_read_b64_tr_b16 v[254:255], v25 offset:11776
  v_accvgpr_write_b32 a160, v28
  v_accvgpr_write_b32 a161, v29
  v_accvgpr_write_b32 a162, v30
  v_accvgpr_write_b32 a163, v31
  v_accvgpr_write_b32 a164, v32
  v_accvgpr_write_b32 a165, v33
  v_accvgpr_write_b32 a166, v34
  v_accvgpr_write_b32 a167, v35
  v_accvgpr_write_b32 a168, v36
  v_accvgpr_write_b32 a169, v37
  v_accvgpr_write_b32 a170, v38
  v_accvgpr_write_b32 a171, v39
  v_accvgpr_write_b32 a172, v40
  v_accvgpr_write_b32 a173, v41
  v_accvgpr_write_b32 a174, v42
  v_accvgpr_write_b32 a175, v43
  v_lshrrev_b32 v20, 1, v18
  v_lshlrev_b32 v44, 6, v20
  v_and_b32 v20, 1, v18
  v_lshl_add_u32 v44, v20, 4, v44
  v_lshlrev_b32 v12, 8, v17
  v_lshl_add_u32 v12, v18, 4, v12
  v_add_u32 v13, 0, v2
  s_mul_i32 s27, s9, 40
  s_add_u32 s27, s27, 0
  v_add_u32 v20, s27, v16
  v_lshrrev_b32 v66, 4, v20
  v_lshlrev_b32 v66, 10, v66
  v_and_b32 v20, 15, v20
  v_lshl_add_u32 v66, v20, 4, v66
  v_lshl_add_u32 v66, v17, 8, v66
  v_lshlrev_b32 v10, 6, v18
  v_lshl_add_u32 v10, v17, 4, v10
  v_add_u32 v10, 0, v10
  v_cmp_gt_u32 vcc, 8, v16
  v_mov_b32 v0, 0x40000000
  s_nop 0
  v_cndmask_b32 v10, v0, v10, vcc
  v_and_b32 v20, 3, v16
  v_lshlrev_b32 v11, 6, v20
  v_lshrrev_b32 v20, 2, v16
  v_lshl_add_u32 v11, v20, 4, v11
  v_lshl_add_u32 v11, v17, 8, v11
  v_lshrrev_b32 v20, 1, v17
  v_lshl_add_u32 v61, v20, 5, v44
  v_and_b32 v20, 1, v17
  v_lshl_add_u32 v20, v20, 1, v19
  v_mul_u32_u24 v134, 2260992, v20
  v_add_u32 v61, v134, v61
  v_lshrrev_b32 v20, v20, s31
  v_and_b32 v20, 1, v20
  v_lshl_add_u32 v134, v20, 13, v61
  v_xor_b32 v61, 8192, v134
  v_mov_b32 v62, v2
  v_lshlrev_b32 v63, 4, v16
  v_lshl_add_u32 v63, v17, 3, v63
  s_lshl_b32 s27, s9, 9
  s_add_u32 s27, s27, 0
  v_add_u32 v63, s27, v63
  v_cmp_gt_u32 vcc, 32, v1
  v_mov_b32 v0, 0x40000000
  s_nop 0
  v_cndmask_b32 v63, v0, v63, vcc
  v_mov_b32 v118, 0
  v_mov_b32 v119, 0
  v_mov_b32 v126, 0
  v_mov_b32 v127, 0
  v_mov_b32 v132, -1
  v_mov_b32 v133, -1
  s_waitcnt lgkmcnt(0)
  v_mov_b32 v0, 0xbdd53b95
  v_mov_b32 v28, 0
  v_mov_b32 v29, 0
  v_mov_b32 v30, 0
  v_mov_b32 v31, 0
  v_mov_b32 v32, 0
  v_mov_b32 v33, 0
  v_mov_b32 v34, 0
  v_mov_b32 v35, 0
  v_mov_b32 v36, 0
  v_mov_b32 v37, 0
  v_mov_b32 v38, 0
  v_mov_b32 v39, 0
  v_mov_b32 v40, 0
  v_mov_b32 v41, 0
  v_mov_b32 v42, 0
  v_mov_b32 v43, 0
  v_mov_b32 v44, 0
  v_mov_b32 v45, 0
  v_mov_b32 v46, 0
  v_mov_b32 v47, 0
  v_mov_b32 v48, 0
  v_mov_b32 v49, 0
  v_mov_b32 v50, 0
  v_mov_b32 v51, 0
  v_mov_b32 v52, 0
  v_mov_b32 v53, 0
  v_mov_b32 v54, 0
  v_mov_b32 v55, 0
  v_mov_b32 v56, 0
  v_mov_b32 v57, 0
  v_mov_b32 v58, 0
  v_mov_b32 v59, 0
  s_add_u32 s13, s17, 0
  s_add_u32 s14, s17, 2048
  s_lshl_b32 s29, s68, 2
  v_mov_b32 v15, s29
  s_mov_b32 s29, 0
mega0_kernel_cen20:
  buffer_load_dword v14, v15, s[44:47], 0 offen sc1
  s_waitcnt vmcnt(0)
  v_readfirstlane_b32 s27, v14
  s_nop 0
  s_and_b32 s28, s27, 63
  s_cmp_eq_u32 s28, 32
  s_cbranch_scc1 mega0_kernel_cen20_done
  s_sleep 4
  s_add_u32 s29, s29, 1
  s_cmp_lt_u32 s29, 262144
  s_cbranch_scc1 mega0_kernel_cen20
  s_branch mega_fail
mega0_kernel_cen20_done:
  s_cmp_eq_u32 s27, s69
  s_cselect_b32 s69, 0, 1
  s_cmp_eq_u32 s69, 0
  s_cbranch_scc1 mega_loop0
  s_branch mega_loop4
mega_pro1:
  ds_read_b64_tr_b16 v[136:137], v24 offset:23104
  ds_read_b64_tr_b16 v[138:139], v24 offset:23296
  ds_read_b64_tr_b16 v[140:141], v24 offset:26944
  ds_read_b64_tr_b16 v[142:143], v24 offset:27136
  ds_read_b64_tr_b16 v[144:145], v25 offset:23104
  ds_read_b64_tr_b16 v[146:147], v25 offset:23296
  ds_read_b64_tr_b16 v[148:149], v25 offset:26944
  ds_read_b64_tr_b16 v[150:151], v25 offset:27136
  ds_read_b64_tr_b16 v[152:153], v24 offset:30784
  ds_read_b64_tr_b16 v[154:155], v24 offset:30976
  ds_read_b64_tr_b16 v[156:157], v24 offset:34624
  ds_read_b64_tr_b16 v[158:159], v24 offset:34816
  ds_read_b64_tr_b16 v[160:161], v25 offset:30784
  ds_read_b64_tr_b16 v[162:163], v25 offset:30976
  ds_read_b64_tr_b16 v[164:165], v25 offset:34624
  ds_read_b64_tr_b16 v[166:167], v25 offset:34816
  ds_read_b64_tr_b16 v[168:169], v24 offset:15424
  ds_read_b64_tr_b16 v[170:171], v24 offset:15616
  ds_read_b64_tr_b16 v[172:173], v24 offset:19264
  ds_read_b64_tr_b16 v[174:175], v24 offset:19456
  ds_read_b64_tr_b16 v[176:177], v25 offset:15424
  ds_read_b64_tr_b16 v[178:179], v25 offset:15616
  ds_read_b64_tr_b16 v[180:181], v25 offset:19264
  ds_read_b64_tr_b16 v[182:183], v25 offset:19456
  ds_read_b64_tr_b16 v[184:185], v24 offset:23072
  ds_read_b64_tr_b16 v[186:187], v24 offset:23264
  ds_read_b64_tr_b16 v[188:189], v24 offset:26912
  ds_read_b64_tr_b16 v[190:191], v24 offset:27104
  ds_read_b64_tr_b16 v[192:193], v25 offset:23072
  ds_read_b64_tr_b16 v[194:195], v25 offset:23264
  ds_read_b64_tr_b16 v[196:197], v25 offset:26912
  ds_read_b64_tr_b16 v[198:199], v25 offset:27104
  ds_read_b64_tr_b16 v[200:201], v24 offset:30752
  ds_read_b64_tr_b16 v[202:203], v24 offset:30944
  ds_read_b64_tr_b16 v[204:205], v24 offset:34592
  ds_read_b64_tr_b16 v[206:207], v24 offset:34784
  ds_read_b64_tr_b16 v[208:209], v25 offset:30752
  ds_read_b64_tr_b16 v[210:211], v25 offset:30944
  ds_read_b64_tr_b16 v[212:213], v25 offset:34592
  ds_read_b64_tr_b16 v[214:215], v25 offset:34784
  ds_read_b64_tr_b16 v[216:217], v25 offset:15392
  ds_read_b64_tr_b16 v[218:219], v25 offset:15584
  ds_read_b64_tr_b16 v[220:221], v25 offset:19232
  ds_read_b64_tr_b16 v[222:223], v25 offset:19424
  ds_read_b64_tr_b16 v[224:225], v24 offset:23040
  ds_read_b64_tr_b16 v[226:227], v24 offset:23232
  ds_read_b64_tr_b16 v[228:229], v24 offset:26880
  ds_read_b64_tr_b16 v[230:231], v24 offset:27072
  ds_read_b64_tr_b16 v[232:233], v25 offset:23040
  ds_read_b64_tr_b16 v[234:235], v25 offset:23232
  ds_read_b64_tr_b16 v[236:237], v25 offset:26880
  ds_read_b64_tr_b16 v[238:239], v25 offset:27072
  ds_read_b64_tr_b16 v[240:241], v24 offset:30720
  ds_read_b64_tr_b16 v[242:243], v24 offset:30912
  ds_read_b64_tr_b16 v[244:245], v24 offset:34560
  ds_read_b64_tr_b16 v[246:247], v24 offset:34752
  ds_read_b64_tr_b16 v[248:249], v25 offset:30720
  ds_read_b64_tr_b16 v[250:251], v25 offset:30912
  ds_read_b64_tr_b16 v[252:253], v25 offset:34560
  ds_read_b64_tr_b16 v[254:255], v25 offset:34752
  v_accvgpr_write_b32 a160, v28
  v_accvgpr_write_b32 a161, v29
  v_accvgpr_write_b32 a162, v30
  v_accvgpr_write_b32 a163, v31
  v_accvgpr_write_b32 a164, v32
  v_accvgpr_write_b32 a165, v33
  v_accvgpr_write_b32 a166, v34
  v_accvgpr_write_b32 a167, v35
  v_accvgpr_write_b32 a168, v36
  v_accvgpr_write_b32 a169, v37
  v_accvgpr_write_b32 a170, v38
  v_accvgpr_write_b32 a171, v39
  v_accvgpr_write_b32 a172, v40
  v_accvgpr_write_b32 a173, v41
  v_accvgpr_write_b32 a174, v42
  v_accvgpr_write_b32 a175, v43
  v_lshrrev_b32 v20, 1, v18
  v_lshlrev_b32 v44, 6, v20
  v_and_b32 v20, 1, v18
  v_lshl_add_u32 v44, v20, 4, v44
  v_lshlrev_b32 v12, 8, v17
  v_lshl_add_u32 v12, v18, 4, v12
  v_add_u32 v13, 1024, v2
  s_mul_i32 s27, s9, 40
  s_add_u32 s27, s27, 16
  v_add_u32 v20, s27, v16
  v_lshrrev_b32 v66, 4, v20
  v_lshlrev_b32 v66, 10, v66
  v_and_b32 v20, 15, v20
  v_lshl_add_u32 v66, v20, 4, v66
  v_lshl_add_u32 v66, v17, 8, v66
  v_lshlrev_b32 v10, 6, v18
  v_lshl_add_u32 v10, v17, 4, v10
  v_add_u32 v10, 8, v10
  v_cmp_gt_u32 vcc, 8, v16
  v_mov_b32 v0, 0x40000000
  s_nop 0
  v_cndmask_b32 v10, v0, v10, vcc
  v_and_b32 v20, 3, v16
  v_lshlrev_b32 v11, 6, v20
  v_lshrrev_b32 v20, 2, v16
  v_lshl_add_u32 v11, v20, 4, v11
  v_lshl_add_u32 v11, v17, 8, v11
  v_lshrrev_b32 v20, 1, v17
  v_lshl_add_u32 v61, v20, 5, v44
  v_and_b32 v20, 1, v17
  v_lshl_add_u32 v20, v20, 1, v19
  v_mul_u32_u24 v134, 2260992, v20
  v_add_u32 v61, v134, v61
  v_lshrrev_b32 v20, v20, s31
  v_and_b32 v20, 1, v20
  v_lshl_add_u32 v134, v20, 13, v61
  v_xor_b32 v61, 8192, v134
  v_mov_b32 v62, v2
  v_lshlrev_b32 v63, 4, v16
  v_lshl_add_u32 v63, v17, 3, v63
  s_lshl_b32 s27, s9, 9
  s_add_u32 s27, s27, 256
  v_add_u32 v63, s27, v63
  v_cmp_gt_u32 vcc, 32, v1
  v_mov_b32 v0, 0x40000000
  s_nop 0
  v_cndmask_b32 v63, v0, v63, vcc
  v_mov_b32 v118, 0
  v_mov_b32 v119, 0
  v_mov_b32 v126, 0
  v_mov_b32 v127, 0
  v_mov_b32 v132, -1
  v_mov_b32 v133, -1
  s_waitcnt lgkmcnt(0)
  v_mov_b32 v0, 0xbdd53b95
  v_mov_b32 v28, 0
  v_mov_b32 v29, 0
  v_mov_b32 v30, 0
  v_mov_b32 v31, 0
  v_mov_b32 v32, 0
  v_mov_b32 v33, 0
  v_mov_b32 v34, 0
  v_mov_b32 v35, 0
  v_mov_b32 v36, 0
  v_mov_b32 v37, 0
  v_mov_b32 v38, 0
  v_mov_b32 v39, 0
  v_mov_b32 v40, 0
  v_mov_b32 v41, 0
  v_mov_b32 v42, 0
  v_mov_b32 v43, 0
  v_mov_b32 v44, 0
  v_mov_b32 v45, 0
  v_mov_b32 v46, 0
  v_mov_b32 v47, 0
  v_mov_b32 v48, 0
  v_mov_b32 v49, 0
  v_mov_b32 v50, 0
  v_mov_b32 v51, 0
  v_mov_b32 v52, 0
  v_mov_b32 v53, 0
  v_mov_b32 v54, 0
  v_mov_b32 v55, 0
  v_mov_b32 v56, 0
  v_mov_b32 v57, 0
  v_mov_b32 v58, 0
  v_mov_b32 v59, 0
  s_add_u32 s13, s17, 3072
  s_add_u32 s14, s17, 2048
  s_lshl_b32 s29, s68, 2
  v_mov_b32 v15, s29
  s_mov_b32 s29, 0
mega0_kernel_cen21:
  buffer_load_dword v14, v15, s[44:47], 0 offen sc1
  s_waitcnt vmcnt(0)
  v_readfirstlane_b32 s27, v14
  s_nop 0
  s_and_b32 s28, s27, 63
  s_cmp_eq_u32 s28, 32
  s_cbranch_scc1 mega0_kernel_cen21_done
  s_sleep 4
  s_add_u32 s29, s29, 1
  s_cmp_lt_u32 s29, 262144
  s_cbranch_scc1 mega0_kernel_cen21
  s_branch mega_fail
mega0_kernel_cen21_done:
  s_cmp_eq_u32 s27, s69
  s_cselect_b32 s69, 0, 1
  s_cmp_eq_u32 s69, 0
  s_cbranch_scc1 mega_loop1
  s_branch mega_loop5
mega_pro2:
  ds_read_b64_tr_b16 v[136:137], v24 offset:38400
  ds_read_b64_tr_b16 v[138:139], v24 offset:38592
  ds_read_b64_tr_b16 v[140:141], v24 offset:42240
  ds_read_b64_tr_b16 v[142:143], v24 offset:42432
  ds_read_b64_tr_b16 v[144:145], v25 offset:38400
  ds_read_b64_tr_b16 v[146:147], v25 offset:38592
  ds_read_b64_tr_b16 v[148:149], v25 offset:42240
  ds_read_b64_tr_b16 v[150:151], v25 offset:42432
  ds_read_b64_tr_b16 v[152:153], v24 offset:46080
  ds_read_b64_tr_b16 v[154:155], v24 offset:46272
  ds_read_b64_tr_b16 v[156:157], v24 offset:49920
  ds_read_b64_tr_b16 v[158:159], v24 offset:50112
  ds_read_b64_tr_b16 v[160:161], v25 offset:46080
  ds_read_b64_tr_b16 v[162:163], v25 offset:46272
  ds_read_b64_tr_b16 v[164:165], v25 offset:49920
  ds_read_b64_tr_b16 v[166:167], v25 offset:50112
  ds_read_b64_tr_b16 v[168:169], v24 offset:53760
  ds_read_b64_tr_b16 v[170:171], v24 offset:53952
  ds_read_b64_tr_b16 v[172:173], v24 offset:57600
  ds_read_b64_tr_b16 v[174:175], v24 offset:57792
  ds_read_b64_tr_b16 v[176:177], v25 offset:53760
  ds_read_b64_tr_b16 v[178:179], v25 offset:53952
  ds_read_b64_tr_b16 v[180:181], v25 offset:57600
  ds_read_b64_tr_b16 v[182:183], v25 offset:57792
  ds_read_b64_tr_b16 v[184:185], v24 offset:38432
  ds_read_b64_tr_b16 v[186:187], v24 offset:38624
  ds_read_b64_tr_b16 v[188:189], v24 offset:42272
  ds_read_b64_tr_b16 v[190:191], v24 offset:42464
  ds_read_b64_tr_b16 v[192:193], v25 offset:38432
  ds_read_b64_tr_b16 v[194:195], v25 offset:38624
  ds_read_b64_tr_b16 v[196:197], v25 offset:42272
  ds_read_b64_tr_b16 v[198:199], v25 offset:42464
  ds_read_b64_tr_b16 v[200:201], v24 offset:46112
  ds_read_b64_tr_b16 v[202:203], v24 offset:46304
  ds_read_b64_tr_b16 v[204:205], v24 offset:49952
  ds_read_b64_tr_b16 v[206:207], v24 offset:50144
  ds_read_b64_tr_b16 v[208:209], v25 offset:46112
  ds_read_b64_tr_b16 v[210:211], v25 offset:46304
  ds_read_b64_tr_b16 v[212:213], v25 offset:49952
  ds_read_b64_tr_b16 v[214:215], v25 offset:50144
  ds_read_b64_tr_b16 v[216:217], v24 offset:53792
  ds_read_b64_tr_b16 v[218:219], v24 offset:53984
  ds_read_b64_tr_b16 v[220:221], v24 offset:57632
  ds_read_b64_tr_b16 v[222:223], v24 offset:57824
  ds_read_b64_tr_b16 v[224:225], v24 offset:38464
  ds_read_b64_tr_b16 v[226:227], v24 offset:38656
  ds_read_b64_tr_b16 v[228:229], v24 offset:42304
  ds_read_b64_tr_b16 v[230:231], v24 offset:42496
  ds_read_b64_tr_b16 v[232:233], v25 offset:38464
  ds_read_b64_tr_b16 v[234:235], v25 offset:38656
  ds_read_b64_tr_b16 v[236:237], v25 offset:42304
  ds_read_b64_tr_b16 v[238:239], v25 offset:42496
  ds_read_b64_tr_b16 v[240:241], v24 offset:46144
  ds_read_b64_tr_b16 v[242:243], v24 offset:46336
  ds_read_b64_tr_b16 v[244:245], v24 offset:49984
  ds_read_b64_tr_b16 v[246:247], v24 offset:50176
  ds_read_b64_tr_b16 v[248:249], v25 offset:46144
  ds_read_b64_tr_b16 v[250:251], v25 offset:46336
  ds_read_b64_tr_b16 v[252:253], v25 offset:49984
  ds_read_b64_tr_b16 v[254:255], v25 offset:50176
  v_accvgpr_write_b32 a160, v28
  v_accvgpr_write_b32 a161, v29
  v_accvgpr_write_b32 a162, v30
  v_accvgpr_write_b32 a163, v31
  v_accvgpr_write_b32 a164, v32
  v_accvgpr_write_b32 a165, v33
  v_accvgpr_write_b32 a166, v34
  v_accvgpr_write_b32 a167, v35
  v_accvgpr_write_b32 a168, v36
  v_accvgpr_write_b32 a169, v37
  v_accvgpr_write_b32 a170, v38
  v_accvgpr_write_b32 a171, v39
  v_accvgpr_write_b32 a172, v40
  v_accvgpr_write_b32 a173, v41
  v_accvgpr_write_b32 a174, v42
  v_accvgpr_write_b32 a175, v43
  v_lshrrev_b32 v20, 1, v18
  v_lshlrev_b32 v44, 6, v20
  v_and_b32 v20, 1, v18
  v_lshl_add_u32 v44, v20, 4, v44
  v_lshlrev_b32 v12, 8, v17
  v_lshl_add_u32 v12, v18, 4, v12
  v_add_u32 v13, 2048, v2
  s_mul_i32 s27, s9, 40
  s_add_u32 s27, s27, 32
  v_add_u32 v20, s27, v16
  v_lshrrev_b32 v66, 4, v20
  v_lshlrev_b32 v66, 10, v66
  v_and_b32 v20, 15, v20
  v_lshl_add_u32 v66, v20, 4, v66
  v_lshl_add_u32 v66, v17, 8, v66
  v_and_b32 v20, 3, v18
  v_lshlrev_b32 v10, 5, v20
  v_lshrrev_b32 v20, 2, v18
  v_lshl_add_u32 v10, v20, 4, v10
  v_lshl_add_u32 v10, v17, 3, v10
  v_add_u32 v10, 496, v10
  v_and_b32 v21, 40, v1
  v_cmp_eq_u32 vcc, 32, v21
  v_mov_b32 v0, 0x40000000
  s_nop 0
  v_cndmask_b32 v10, v0, v10, vcc
  v_lshlrev_b32 v61, 4, v18
  v_lshl_add_u32 v62, v17, 7, v61
  v_and_b32 v20, 1, v17
  v_lshl_add_u32 v61, v20, 3, v61
  v_and_b32 v20, 2, v17
  v_add_u32 v20, v20, v19
  v_mul_u32_u24 v134, 2260992, v20
  v_add_u32 v61, v134, v61
  v_lshrrev_b32 v20, v20, s31
  v_and_b32 v20, 1, v20
  v_lshl_add_u32 v134, v20, 13, v61
  v_xor_b32 v61, 8192, v134
  v_lshlrev_b32 v20, 7, v19
  v_sub_u32 v13, v13, v20
  v_lshl_add_u32 v63, v17, 3, v44
  s_lshr_b32 s27, s9, 1
  s_lshl_b32 s27, s27, 8
  s_and_b32 s28, s9, 1
  s_lshl_b32 s28, s28, 5
  s_add_u32 s27, s27, s28
  s_add_u32 s27, s27, 8192
  v_add_u32 v63, s27, v63
  v_cmp_eq_u32 vcc, 0, v21
  v_mov_b32 v0, 0x40000000
  s_nop 0
  v_cndmask_b32 v63, v0, v63, vcc
  v_cmp_gt_u32 vcc, 8, v16
  v_mov_b32 v0, 0x40000000
  s_nop 0
  v_cndmask_b32 v66, v0, v66, vcc
  s_lshl_b32 s27, s11, 9
  v_add_u32 v64, s27, v62
  v_lshrrev_b32 v65, 1, v64
  v_add_u32 v65, 2048, v65
  v_cmp_le_u32 vcc, 8, v16
  v_mov_b32 v0, 0x40000000
  s_nop 0
  v_cndmask_b32 v64, v0, v64, vcc
  v_cmp_le_u32 vcc, 8, v16
  v_mov_b32 v0, 0x40000000
  s_nop 0
  v_cndmask_b32 v65, v0, v65, vcc
  v_mov_b32 v67, 0
  v_cmp_eq_u32 vcc, 0, v1
  v_mov_b32 v0, 0x40000000
  s_nop 0
  v_cndmask_b32 v67, v0, v67, vcc
  v_mov_b32 v118, 0
  v_mov_b32 v119, 0
  v_mov_b32 v126, 0
  v_mov_b32 v127, 0
  v_mov_b32 v132, -1
  v_mov_b32 v133, -1
  s_waitcnt lgkmcnt(0)
  v_mov_b32 v0, 0xbdd53b95
  v_mov_b32 v28, 0
  v_mov_b32 v29, 0
  v_mov_b32 v30, 0
  v_mov_b32 v31, 0
  v_mov_b32 v32, 0
  v_mov_b32 v33, 0
  v_mov_b32 v34, 0
  v_mov_b32 v35, 0
  v_mov_b32 v36, 0
  v_mov_b32 v37, 0
  v_mov_b32 v38, 0
  v_mov_b32 v39, 0
  v_mov_b32 v40, 0
  v_mov_b32 v41, 0
  v_mov_b32 v42, 0
  v_mov_b32 v43, 0
  v_mov_b32 v44, 0
  v_mov_b32 v45, 0
  v_mov_b32 v46, 0
  v_mov_b32 v47, 0
  v_mov_b32 v48, 0
  v_mov_b32 v49, 0
  v_mov_b32 v50, 0
  v_mov_b32 v51, 0
  v_mov_b32 v52, 0
  v_mov_b32 v53, 0
  v_mov_b32 v54, 0
  v_mov_b32 v55, 0
  v_mov_b32 v56, 0
  v_mov_b32 v57, 0
  v_mov_b32 v58, 0
  v_mov_b32 v59, 0
  s_add_u32 s13, s17, 5120
  s_add_u32 s14, s17, 7168
  s_lshl_b32 s29, s68, 2
  v_mov_b32 v15, s29
  s_mov_b32 s29, 0
mega0_kernel_cen22:
  buffer_load_dword v14, v15, s[44:47], 0 offen sc1
  s_waitcnt vmcnt(0)
  v_readfirstlane_b32 s27, v14
  s_nop 0
  s_and_b32 s28, s27, 63
  s_cmp_eq_u32 s28, 32
  s_cbranch_scc1 mega0_kernel_cen22_done
  s_sleep 4
  s_add_u32 s29, s29, 1
  s_cmp_lt_u32 s29, 262144
  s_cbranch_scc1 mega0_kernel_cen22
  s_branch mega_fail
mega0_kernel_cen22_done:
  s_cmp_eq_u32 s27, s69
  s_cselect_b32 s69, 0, 1
  s_cmp_eq_u32 s69, 0
  s_cbranch_scc1 mega_loop2
  s_branch mega_loop6
mega_pro3:
  ds_read_b64_tr_b16 v[136:137], v26 offset:3136
  ds_read_b64_tr_b16 v[138:139], v26 offset:3328
  ds_read_b64_tr_b16 v[140:141], v26 offset:18496
  ds_read_b64_tr_b16 v[142:143], v26 offset:18688
  ds_read_b64_tr_b16 v[144:145], v27 offset:3136
  ds_read_b64_tr_b16 v[146:147], v27 offset:3328
  ds_read_b64_tr_b16 v[148:149], v27 offset:18496
  ds_read_b64_tr_b16 v[150:151], v27 offset:18688
  ds_read_b64_tr_b16 v[152:153], v26 offset:33856
  ds_read_b64_tr_b16 v[154:155], v26 offset:34048
  ds_read_b64_tr_b16 v[156:157], v26 offset:49216
  ds_read_b64_tr_b16 v[158:159], v26 offset:49408
  ds_read_b64_tr_b16 v[160:161], v27 offset:33856
  ds_read_b64_tr_b16 v[162:163], v27 offset:34048
  ds_read_b64_tr_b16 v[164:165], v27 offset:49216
  ds_read_b64_tr_b16 v[166:167], v27 offset:49408
  ds_read_b64_tr_b16 v[168:169], v24 offset:53824
  ds_read_b64_tr_b16 v[170:171], v24 offset:54016
  ds_read_b64_tr_b16 v[172:173], v24 offset:57664
  ds_read_b64_tr_b16 v[174:175], v24 offset:57856
  ds_read_b64_tr_b16 v[176:177], v25 offset:53824
  ds_read_b64_tr_b16 v[178:179], v25 offset:54016
  ds_read_b64_tr_b16 v[180:181], v25 offset:57664
  ds_read_b64_tr_b16 v[182:183], v25 offset:57856
  ds_read_b64_tr_b16 v[184:185], v26 offset:3104
  ds_read_b64_tr_b16 v[186:187], v26 offset:3296
  ds_read_b64_tr_b16 v[188:189], v26 offset:18464
  ds_read_b64_tr_b16 v[190:191], v26 offset:18656
  ds_read_b64_tr_b16 v[192:193], v27 offset:3104
  ds_read_b64_tr_b16 v[194:195], v27 offset:3296
  ds_read_b64_tr_b16 v[196:197], v27 offset:18464
  ds_read_b64_tr_b16 v[198:199], v27 offset:18656
  ds_read_b64_tr_b16 v[200:201], v26 offset:33824
  ds_read_b64_tr_b16 v[202:203], v26 offset:34016
  ds_read_b64_tr_b16 v[204:205], v26 offset:49184
  ds_read_b64_tr_b16 v[206:207], v26 offset:49376
  ds_read_b64_tr_b16 v[208:209], v27 offset:33824
  ds_read_b64_tr_b16 v[210:211], v27 offset:34016
  ds_read_b64_tr_b16 v[212:213], v27 offset:49184
  ds_read_b64_tr_b16 v[214:215], v27 offset:49376
  ds_read_b64_tr_b16 v[216:217], v25 offset:53792
  ds_read_b64_tr_b16 v[218:219], v25 offset:53984
  ds_read_b64_tr_b16 v[220:221], v25 offset:57632
  ds_read_b64_tr_b16 v[222:223], v25 offset:57824
  ds_read_b64_tr_b16 v[224:225], v26 offset:3072
  ds_read_b64_tr_b16 v[226:227], v26 offset:3264
  ds_read_b64_tr_b16 v[228:229], v26 offset:18432
  ds_read_b64_tr_b16 v[230:231], v26 offset:18624
  ds_read_b64_tr_b16 v[232:233], v27 offset:3072
  ds_read_b64_tr_b16 v[234:235], v27 offset:3264
  ds_read_b64_tr_b16 v[236:237], v27 offset:18432
  ds_read_b64_tr_b16 v[238:239], v27 offset:18624
  ds_read_b64_tr_b16 v[240:241], v26 offset:33792
  ds_read_b64_tr_b16 v[242:243], v26 offset:33984
  ds_read_b64_tr_b16 v[244:245], v26 offset:49152
  ds_read_b64_tr_b16 v[246:247], v26 offset:49344
  ds_read_b64_tr_b16 v[248:249], v27 offset:33792
  ds_read_b64_tr_b16 v[250:251], v27 offset:33984
  ds_read_b64_tr_b16 v[252:253], v27 offset:49152
  ds_read_b64_tr_b16 v[254:255], v27 offset:49344
  buffer_load_dwordx4 a[160:163], v23, s[4:7], s53 offen offset:0
  buffer_load_dwordx4 a[164:167], v23, s[4:7], s53 offen offset:1024
  buffer_load_dwordx4 a[168:171], v23, s[4:7], s53 offen offset:2048
  buffer_load_dwordx4 a[172:175], v23, s[4:7], s53 offen offset:3072
  s_add_u32 s53, s53, 4096
  buffer_load_dwordx4 a[176:179], v23, s[4:7], s53 offen offset:0
  buffer_load_dwordx4 a[180:183], v23, s[4:7], s53 offen offset:1024
  buffer_load_dwordx4 a[184:187], v23, s[4:7], s53 offen offset:2048
  buffer_load_dwordx4 a[188:191], v23, s[4:7], s53 offen offset:3072
  s_add_u32 s53, s53, 4096
  buffer_load_dwordx4 a[192:195], v23, s[4:7], s53 offen offset:0
  buffer_load_dwordx4 a[196:199], v23, s[4:7], s53 offen offset:1024
  buffer_load_dwordx4 a[200:203], v23, s[4:7], s53 offen offset:2048
  buffer_load_dwordx4 a[204:207], v23, s[4:7], s53 offen offset:3072
  s_add_u32 s53, s53, 4096
  buffer_load_dwordx4 a[208:211], v23, s[4:7], s53 offen offset:0
  buffer_load_dwordx4 a[212:215], v23, s[4:7], s53 offen offset:1024
  buffer_load_dwordx4 a[216:219], v23, s[4:7], s53 offen offset:2048
  buffer_load_dwordx4 a[220:223], v23, s[4:7], s53 offen offset:3072
  s_add_u32 s53, s53, 4096
  buffer_load_dwordx4 a[224:227], v23, s[4:7], s53 offen offset:0
  buffer_load_dwordx4 a[228:231], v23, s[4:7], s53 offen offset:1024
  buffer_load_dwordx4 a[232:235], v23, s[4:7], s53 offen offset:2048
  buffer_load_dwordx4 a[236:239], v23, s[4:7], s53 offen offset:3072
  s_add_u32 s53, s53, 4096
  s_add_u32 s53, s53, 1617920
  ds_write_b128 v2, v[28:31] offset:37888
  ds_write_b128 v2, v[32:35] offset:38912
  ds_write_b128 v2, v[36:39] offset:39936
  v_lshlrev_b32 v10, 2, v17
  v_lshl_add_u32 v10, v18, 4, v10
  v_lshl_add_u32 v10, v19, 8, v10
  s_mul_i32 s27, s9, 40
  s_add_u32 s27, s27, 0
  v_add_u32 v20, s27, v16
  v_lshrrev_b32 v11, 4, v20
  v_lshlrev_b32 v11, 10, v11
  v_and_b32 v20, 15, v20
  v_lshl_add_u32 v11, v20, 4, v11
  v_lshl_add_u32 v11, v17, 8, v11
  s_mul_i32 s27, s9, 40
  s_add_u32 s27, s27, 32
  v_add_u32 v20, s27, v18
  v_lshrrev_b32 v68, 4, v20
  v_lshlrev_b32 v68, 10, v68
  v_and_b32 v20, 15, v20
  v_lshl_add_u32 v68, v20, 4, v68
  v_lshl_add_u32 v68, v17, 8, v68
  v_mul_u32_u24 v20, 40960, v19
  v_add_u32 v68, v68, v20
  v_and_b32 v20, 3, v1
  v_lshlrev_b32 v20, 7, v20
  s_lshl_b32 s27, s68, 9
  s_and_b32 s28, s9, 12
  s_add_u32 s27, s27, s28
  s_add_u32 s27, s27, 12288
  v_add_u32 v20, s27, v20
  s_add_u32 s27, s54, 0
  v_mov_b32 v21, s27
  v_and_b32 v12, 4, v1
  v_cmp_eq_u32 vcc, 0, v12
  s_nop 1
  v_cndmask_b32 v12, v21, v20, vcc
  v_cmp_gt_u32 vcc, 8, v1
  v_mov_b32 v0, 0x40000000
  s_nop 0
  v_cndmask_b32 v12, v0, v12, vcc
  s_waitcnt vmcnt(40)
  buffer_load_dwordx4 a[240:243], v23, s[4:7], s53 offen offset:0
  buffer_load_dwordx4 a[244:247], v23, s[4:7], s53 offen offset:1024
  buffer_load_dwordx4 a[248:251], v23, s[4:7], s53 offen offset:2048
  buffer_load_dwordx4 a[252:255], v23, s[4:7], s53 offen offset:3072
  s_add_u32 s53, s53, 4096
  buffer_load_dwordx4 v[72:75], v23, s[4:7], s53 offen offset:0
  buffer_load_dwordx4 v[76:79], v23, s[4:7], s53 offen offset:1024
  buffer_load_dwordx4 v[80:83], v23, s[4:7], s53 offen offset:2048
  buffer_load_dwordx4 v[84:87], v23, s[4:7], s53 offen offset:3072
  s_add_u32 s53, s53, 4096
  buffer_load_dwordx4 v[88:91], v23, s[4:7], s53 offen offset:0
  buffer_load_dwordx4 v[92:95], v23, s[4:7], s53 offen offset:1024
  buffer_load_dwordx4 v[96:99], v23, s[4:7], s53 offen offset:2048
  buffer_load_dwordx4 v[100:103], v23, s[4:7], s53 offen offset:3072
  s_add_u32 s53, s53, 4096
  buffer_load_dwordx4 v[104:107], v23, s[4:7], s53 offen offset:0
  buffer_load_dwordx4 v[108:111], v23, s[4:7], s53 offen offset:1024
  buffer_load_dwordx4 v[112:115], v23, s[4:7], s53 offen offset:2048
  buffer_load_dwordx4 v[116:119], v23, s[4:7], s53 offen offset:3072
  s_add_u32 s53, s53, 4096
  buffer_load_dwordx4 v[120:123], v23, s[4:7], s53 offen offset:0
  buffer_load_dwordx4 v[124:127], v23, s[4:7], s53 offen offset:1024
  buffer_load_dwordx4 v[128:131], v23, s[4:7], s53 offen offset:2048
  buffer_load_dwordx4 v[132:135], v23, s[4:7], s53 offen offset:3072
  s_add_u32 s53, s53, 4096
  s_waitcnt lgkmcnt(0)
  v_mov_b32 v0, 0xbdd53b95
  v_mov_b32 v28, 0
  v_mov_b32 v29, 0
  v_mov_b32 v30, 0
  v_mov_b32 v31, 0
  v_mov_b32 v32, 0
  v_mov_b32 v33, 0
  v_mov_b32 v34, 0
  v_mov_b32 v35, 0
  v_mov_b32 v36, 0
  v_mov_b32 v37, 0
  v_mov_b32 v38, 0
  v_mov_b32 v39, 0
  v_mov_b32 v40, 0
  v_mov_b32 v41, 0
  v_mov_b32 v42, 0
  v_mov_b32 v43, 0
  v_mov_b32 v44, 0
  v_mov_b32 v45, 0
  v_mov_b32 v46, 0
  v_mov_b32 v47, 0
  v_mov_b32 v48, 0
  v_mov_b32 v49, 0
  v_mov_b32 v50, 0
  v_mov_b32 v51, 0
  v_mov_b32 v52, 0
  v_mov_b32 v53, 0
  v_mov_b32 v54, 0
  v_mov_b32 v55, 0
  v_mov_b32 v56, 0
  v_mov_b32 v57, 0
  v_mov_b32 v58, 0
  v_mov_b32 v59, 0
  v_mov_b32 v60, 0
  v_mov_b32 v61, 0
  v_mov_b32 v62, 0
  v_mov_b32 v63, 0
  v_mov_b32 v64, 0
  v_mov_b32 v65, 0
  v_mov_b32 v66, 0
  v_mov_b32 v67, 0
  s_add_u32 s13, s17, 8192
  s_add_u32 s14, s17, 7168
  s_lshl_b32 s29, s68, 2
  v_mov_b32 v15, s29
  s_mov_b32 s29, 0
mega0_kernel_cen23:
  buffer_load_dword v14, v15, s[44:47], 0 offen sc1
  s_waitcnt vmcnt(0)
  v_readfirstlane_b32 s27, v14
  s_nop 0
  s_and_b32 s28, s27, 63
  s_cmp_eq_u32 s28, 32
  s_cbranch_scc1 mega0_kernel_cen23_done
  s_sleep 4
  s_add_u32 s29, s29, 1
  s_cmp_lt_u32 s29, 262144
  s_cbranch_scc1 mega0_kernel_cen23
  s_branch mega_fail
mega0_kernel_cen23_done:
  s_cmp_eq_u32 s27, s69
  s_cselect_b32 s69, 0, 1
  s_add_u32 s29, s12, 1
  s_cmp_lt_u32 s76, s29
  s_cbranch_scc1 mega0_kernel_sd24_wait
mega0_kernel_sd24_go:
  s_mov_b32 m0, 24576
  s_add_u32 s27, s24, 0
  buffer_load_dwordx4 v11, s[4:7], s27 offen offset:0 sc1 lds
  buffer_load_dwordx4 v11, s[4:7], s27 offen offset:1024 sc1 lds
  s_mov_b32 m0, 32768
  s_nop 0
  buffer_load_dwordx4 v68, s[4:7], s27 offen sc1 lds
  s_mov_b32 m0, 26624
  s_add_u32 s27, s24, 40960
  buffer_load_dwordx4 v11, s[4:7], s27 offen offset:0 sc1 lds
  buffer_load_dwordx4 v11, s[4:7], s27 offen offset:1024 sc1 lds
  s_mov_b32 m0, 28672
  s_add_u32 s27, s24, 81920
  buffer_load_dwordx4 v11, s[4:7], s27 offen offset:0 sc1 lds
  buffer_load_dwordx4 v11, s[4:7], s27 offen offset:1024 sc1 lds
  s_mov_b32 m0, 33792
  s_nop 0
  buffer_load_dwordx4 v68, s[4:7], s27 offen sc1 lds
  s_mov_b32 m0, 30720
  s_add_u32 s27, s24, 122880
  buffer_load_dwordx4 v11, s[4:7], s27 offen offset:0 sc1 lds
  buffer_load_dwordx4 v11, s[4:7], s27 offen offset:1024 sc1 lds
  s_mov_b32 m0, 34816
  s_add_u32 s27, s22, 0
  buffer_load_dwordx4 v2, s[4:7], s27 offen offset:0 sc1 lds
  s_add_u32 s27, s22, 3072
  buffer_load_dwordx4 v2, s[4:7], s27 offen offset:1024 sc1 lds
  s_add_u32 s27, s22, 6144
  buffer_load_dwordx4 v2, s[4:7], s27 offen offset:2048 sc1 lds
  s_add_u32 s72, s72, 1
  s_cmp_eq_u32 s72, 4
  s_cselect_b32 s72, 0, s72
  s_mov_b32 s73, 325632
  s_cselect_b32 s73, 0xfff11800, s73
  s_add_u32 s22, s22, s73
  s_add_u32 s24, s24, s73
  s_cmp_eq_u32 s69, 0
  s_cbranch_scc1 mega_loop3
  s_branch mega_loop7
mega_loop0:
  buffer_load_dwordx4 v[16:19], v2, s[4:7], s13 offen offset:0 sc1
  buffer_load_dwordx4 v[20:23], v2, s[4:7], s13 offen offset:1024 sc1
  buffer_load_dwordx4 v[24:27], v2, s[4:7], s14 offen offset:0 sc1
  s_xor_b32 s16, s16, s17
  s_xor_b32 s17, s17, s16
  s_xor_b32 s16, s16, s17
  s_mov_b32 m0, 0
  s_add_u32 s39, s39, 1
  s_and_b32 s27, s39, 7
  s_mul_i32 s27, s27, 163840
  s_add_u32 s37, s32, s27
  s_add_u32 s33, s30, s27
  s_nop 15
  s_nop 14
  buffer_load_dwordx4 v[16:19], v2, s[4:7], s13 offen offset:0 sc1
  buffer_load_dwordx4 v[20:23], v2, s[4:7], s13 offen offset:1024 sc1
  buffer_load_dwordx4 v[24:27], v2, s[4:7], s14 offen offset:0 sc1
mega_loop0_pc2:
  s_waitcnt vmcnt(3)
  v_max3_u32 v14, v16, v17, v18
  v_max3_u32 v14, v14, v19, v20
  v_smfmac_f32_16x16x64_bf16 v[28:31], v[16:19], v[136:143], v9
  v_max3_u32 v14, v14, v21, v22
  v_max3_u32 v14, v14, v23, v24
  v_smfmac_f32_16x16x64_bf16 v[32:35], v[16:19], v[144:151], v9
  v_max3_u32 v14, v14, v25, v26
  v_max_u32 v14, v14, v27
  v_smfmac_f32_16x16x64_bf16 v[28:31], v[20:23], v[152:159], v9
  v_cmp_eq_u32 vcc, -1, v14
  v_smfmac_f32_16x16x64_bf16 v[32:35], v[20:23], v[160:167], v9
  s_cbranch_vccnz mega_loop0_pcf
  v_smfmac_f32_16x16x64_bf16 v[28:31], v[24:27], v[168:175], v9
  ds_write_b128 v2, v[16:19] offset:0
  v_smfmac_f32_16x16x64_bf16 v[32:35], v[24:27], v[176:183], v9
  ds_write_b128 v2, v[20:23] offset:1024
  v_smfmac_f32_16x16x64_bf16 v[36:39], v[16:19], v[184:191], v9
  ds_write_b128 v2, v[24:27] offset:2048
  v_smfmac_f32_16x16x64_bf16 v[40:43], v[16:19], v[192:199], v9
  v_add_f32 v28, v28, v30
  v_smfmac_f32_16x16x64_bf16 v[36:39], v[20:23], v[200:207], v9
  v_add_f32 v29, v29, v31
  v_cvt_pk_bf16_f32 v30, v28, v29
  v_smfmac_f32_16x16x64_bf16 v[40:43], v[20:23], v[208:215], v9
  v_add_f32 v32, v32, v34
  v_smfmac_f32_16x16x64_bf16 v[36:39], v[24:27], v[216:223], v9
  v_add_f32 v33, v33, v35
  v_cvt_pk_bf16_f32 v31, v32, v33
  v_smfmac_f32_16x16x64_bf16 v[44:47], v[16:19], v[224:231], v9
  ds_write_b64 v3, v[30:31] offset:10240
  v_smfmac_f32_16x16x64_bf16 v[48:51], v[16:19], v[232:239], v9
  s_nop 0
  v_add_f32 v36, v36, v38
  v_smfmac_f32_16x16x64_bf16 v[44:47], v[20:23], v[240:247], v9
  v_add_f32 v37, v37, v39
  v_cvt_pk_bf16_f32 v38, v36, v37
  v_smfmac_f32_16x16x64_bf16 v[48:51], v[20:23], v[248:255], v9
  v_add_f32 v40, v40, v42
  v_add_f32 v41, v41, v43
  v_cvt_pk_bf16_f32 v39, v40, v41
  ds_write_b64 v3, v[38:39] offset:12288
  s_nop 0
  v_add_f32 v44, v44, v46
  v_add_f32 v45, v45, v47
  v_cvt_pk_bf16_f32 v46, v44, v45
  v_add_f32 v48, v48, v50
  v_add_f32 v49, v49, v51
  v_cvt_pk_bf16_f32 v47, v48, v49
  ds_write_b64 v3, v[46:47] offset:14336
  v_smfmac_f32_16x16x64_bf16 v[52:55], v[16:19], a[0:7], v9
  v_smfmac_f32_16x16x64_bf16 v[56:59], v[16:19], a[80:87], v9
  v_smfmac_f32_16x16x64_bf16 v[52:55], v[20:23], a[8:15], v9
  s_waitcnt lgkmcnt(0)
  s_barrier
  ds_read_b128 v[28:31], v2 offset:10240
  ds_read_b128 v[32:35], v2 offset:11264
  ds_read_b128 v[36:39], v2 offset:12288
  ds_read_b128 v[40:43], v2 offset:13312
  ds_read_b128 v[44:47], v2 offset:14336
  ds_read_b128 v[48:51], v2 offset:15360
  ds_read_b128 v[120:123], v11 offset:34816
  ds_read_b64 v[124:125], v11 offset:36864
  v_smfmac_f32_16x16x64_bf16 v[56:59], v[20:23], a[88:95], v9
  s_waitcnt lgkmcnt(7)
  v_mfma_f32_16x16x32_bf16 v[100:103], v[28:31], a[172:175], 0
  ds_read_b128 v[72:75], v2 offset:3072
  s_waitcnt lgkmcnt(7)
  v_mfma_f32_16x16x32_bf16 v[100:103], v[32:35], a[172:175], v[100:103]
  ds_read_b128 v[76:79], v2 offset:4096
  s_waitcnt lgkmcnt(7)
  v_mfma_f32_16x16x32_bf16 v[104:107], v[36:39], a[172:175], 0
  ds_read_b128 v[80:83], v2 offset:5120
  s_waitcnt lgkmcnt(7)
  v_mfma_f32_16x16x32_bf16 v[104:107], v[40:43], a[172:175], v[104:107]
  ds_read_b128 v[84:87], v2 offset:6144
  s_waitcnt lgkmcnt(7)
  v_mfma_f32_16x16x32_bf16 v[108:111], v[44:47], a[172:175], 0
  v_cvt_pk_bf16_f32 v112, v100, v101
  v_cvt_pk_bf16_f32 v113, v102, v103
  s_waitcnt lgkmcnt(6)
  v_mfma_f32_16x16x32_bf16 v[108:111], v[48:51], a[172:175], v[108:111]
  s_nop 0
  v_cvt_pk_bf16_f32 v114, v104, v105
  v_cvt_pk_bf16_f32 v115, v106, v107
  s_waitcnt lgkmcnt(4)
  ds_read_b128 v[88:91], v2 offset:7168
  v_mfma_f32_16x16x32_bf16 v[128:131], v[120:123], v[112:115], 0
  ds_read_b128 v[92:95], v2 offset:8192
  ds_read_b128 v[96:99], v2 offset:9216
  v_cvt_pk_bf16_f32 v116, v108, v109
  v_cvt_pk_bf16_f32 v117, v110, v111
  s_nop 1
  v_mfma_f32_16x16x32_bf16 v[128:131], v[124:127], v[116:119], v[128:131]
  v_smfmac_f32_16x16x64_bf16 v[52:55], v[24:27], a[16:23], v9
  ds_read_b128 a[176:179], v2 offset:24576
  ds_read_b128 a[180:183], v2 offset:26624
  ds_read_b128 a[184:187], v2 offset:28672
  s_nop 1
  v_cvt_pk_bf16_f32 v68, v128, v129
  v_cvt_pk_bf16_f32 v69, v130, v131
  buffer_store_dwordx2 v[68:69], v10, s[4:7], s18 offen
  s_cmp_eq_u32 s12, 63
  s_cbranch_scc1 mega_loop0_last
  v_smfmac_f32_16x16x64_bf16 v[56:59], v[24:27], a[96:103], v9
  ds_read_b128 a[188:191], v2 offset:30720
  s_waitcnt lgkmcnt(4)
  buffer_store_dwordx2 v[132:133], v10, s[4:7], s19 offen
  v_smfmac_f32_16x16x64_bf16 v[52:55], v[72:75], a[24:31], v9
  v_smfmac_f32_16x16x64_bf16 v[56:59], v[72:75], a[104:111], v9
  v_smfmac_f32_16x16x64_bf16 v[52:55], v[76:79], a[32:39], v9
  v_smfmac_f32_16x16x64_bf16 v[56:59], v[76:79], a[112:119], v9
  v_smfmac_f32_16x16x64_bf16 v[52:55], v[80:83], a[40:47], v9
  v_smfmac_f32_16x16x64_bf16 v[56:59], v[80:83], a[120:127], v9
  v_smfmac_f32_16x16x64_bf16 v[52:55], v[84:87], a[48:55], v9
  v_smfmac_f32_16x16x64_bf16 v[56:59], v[84:87], a[128:135], v9
  v_smfmac_f32_16x16x64_bf16 v[52:55], v[88:91], a[56:63], v9
  v_smfmac_f32_16x16x64_bf16 v[56:59], v[88:91], a[136:143], v9
  buffer_load_dwordx4 v[16:19], v4, s[4:7], s20 offen sc1
  v_smfmac_f32_16x16x64_bf16 v[52:55], v[92:95], a[64:71], v9
  buffer_load_dwordx4 v[20:23], v4, s[4:7], s20 offen offset:256 sc1
  v_smfmac_f32_16x16x64_bf16 v[56:59], v[92:95], a[144:151], v9
  buffer_load_dwordx4 v[24:27], v5, s[4:7], s20 offen offset:512 sc1
  v_smfmac_f32_16x16x64_bf16 v[52:55], v[96:99], a[72:79], v9
  v_smfmac_f32_16x16x64_bf16 v[56:59], v[96:99], a[152:159], v9
  s_nop 4
  v_add_f32 v52, v52, v54
  v_add_f32 v53, v53, v55
  v_cvt_pk_bf16_f32 v52, v52, v53
  ds_write_b32 v8, v52 offset:21504
  v_add_f32 v56, v56, v58
  v_add_f32 v57, v57, v59
  v_cvt_pk_bf16_f32 v56, v56, v57
  ds_write_b32 v8, v56 offset:22528
mega_loop0_pa:
  buffer_load_dwordx4 v[16:19], v4, s[4:7], s20 offen sc1
  buffer_load_dwordx4 v[20:23], v4, s[4:7], s20 offen offset:256 sc1
  buffer_load_dwordx4 v[24:27], v5, s[4:7], s20 offen offset:512 sc1
  s_add_u32 s15, s15, 16384
  s_cbranch_scc1 mega_fail
  s_waitcnt vmcnt(3)
  v_max3_u32 v14, v16, v17, v18
  v_max3_u32 v14, v14, v19, v20
  v_mfma_f32_16x16x32_bf16 v[40:43], v[16:19], a[160:163], 0
  v_max3_u32 v14, v14, v21, v22
  v_max3_u32 v14, v14, v23, v24
  v_mfma_f32_16x16x32_bf16 v[40:43], v[20:23], a[164:167], v[40:43]
  v_max3_u32 v14, v14, v25, v26
  v_max_u32 v14, v14, v27
  v_mfma_f32_16x16x32_bf16 v[44:47], v[24:27], a[168:171], 0
  v_cmp_eq_u32 vcc, -1, v14
  s_nop 3
  v_max3_f32 v48, v40, v41, v42
  s_cbranch_vccnz mega_loop0_pa
  s_nop 0
  v_cndmask_b32 v44, v44, v45, s[42:43]
  v_max3_f32 v48, v48, v43, v44
  s_nop 1
  v_max_f32_dpp v48, v48, v48 quad_perm:[1,0,3,2] row_mask:0xf bank_mask:0xf
  s_nop 1
  v_max_f32_dpp v48, v48, v48 quad_perm:[2,3,0,1] row_mask:0xf bank_mask:0xf
  s_nop 1
  v_max_f32_dpp v48, v48, v48 row_half_mirror row_mask:0xf bank_mask:0xf
  v_mul_f32 v48, v0, v48
  v_pk_fma_f32 v[40:41], v[40:41], v[0:1], v[48:49] op_sel_hi:[1,0,0] neg_lo:[0,1,0] neg_hi:[0,1,0]
  v_pk_fma_f32 v[42:43], v[42:43], v[0:1], v[48:49] op_sel_hi:[1,0,0] neg_lo:[0,1,0] neg_hi:[0,1,0]
  v_fma_f32 v44, v44, -v0, v48
  v_exp_f32 v40, v40
  v_exp_f32 v41, v41
  v_exp_f32 v42, v42
  v_exp_f32 v43, v43
  v_exp_f32 v44, v44
  v_pk_add_f32 v[48:49], v[40:41], v[42:43]
  v_add_f32 v48, v48, v49
  v_add_f32 v48, v48, v44
  s_nop 1
  v_add_f32_dpp v48, v48, v48 quad_perm:[1,0,3,2] row_mask:0xf bank_mask:0xf
  s_nop 1
  v_add_f32_dpp v48, v48, v48 quad_perm:[2,3,0,1] row_mask:0xf bank_mask:0xf
  s_nop 1
  v_add_f32_dpp v48, v48, v48 row_half_mirror row_mask:0xf bank_mask:0xf
  v_rcp_f32 v48, v48
  s_nop 0
  v_pk_mul_f32 v[40:41], v[40:41], v[48:49] op_sel_hi:[1,0]
  v_pk_mul_f32 v[42:43], v[42:43], v[48:49] op_sel_hi:[1,0]
  v_mul_f32 v44, v44, v48
  v_cvt_pk_bf16_f32 v40, v40, v41
  v_cvt_pk_bf16_f32 v41, v42, v43
  ds_write_b64 v6, v[40:41] offset:16384
  v_cvt_pk_bf16_f32 v44, v44, v44
  ds_write_b16 v7, v44 offset:20480
  s_waitcnt lgkmcnt(0)
  s_barrier
  ds_read_b128 v[72:75], v12 offset:16384
  ds_read_b128 v[76:79], v12 offset:17408
  ds_read_b128 v[80:83], v12 offset:18432
  ds_read_b128 v[84:87], v12 offset:19456
  ds_read_b128 v[88:91], v12 offset:20480
  ds_read_b128 v[92:95], v13 offset:21504
  s_waitcnt lgkmcnt(5)
  v_mfma_f32_16x16x32_bf16 v[128:131], a[176:179], v[72:75], 0
  s_waitcnt lgkmcnt(4)
  v_mfma_f32_16x16x32_bf16 v[128:131], a[180:183], v[76:79], v[128:131]
  s_waitcnt lgkmcnt(3)
  v_mfma_f32_16x16x32_bf16 v[128:131], a[184:187], v[80:83], v[128:131]
  s_waitcnt lgkmcnt(2)
  v_mfma_f32_16x16x32_bf16 v[128:131], a[188:191], v[84:87], v[128:131]
  s_waitcnt lgkmcnt(0)
  v_mfma_f32_16x16x32_bf16 v[128:131], v[92:95], v[88:91], v[128:131]
  v_mov_b32 v28, 0
  v_mov_b32 v29, 0
  v_mov_b32 v30, 0
  v_mov_b32 v31, 0
  v_mov_b32 v32, 0
  v_mov_b32 v33, 0
  v_mov_b32 v34, 0
  s_nop 0
  v_cvt_pk_bf16_f32 v68, v128, v129
  v_cvt_pk_bf16_f32 v70, v128, v129
  v_cvt_pk_bf16_f32 v69, v130, v131
  v_cvt_pk_bf16_f32 v71, v130, v131
  v_permlane16_swap_b32 v68, v70
  s_nop 0
  v_permlane16_swap_b32 v69, v71
  buffer_store_dwordx4 v[68:71], v61, s[4:7], s33 offen sc1
  buffer_store_dwordx4 v[68:71], v134, s[4:7], s33 offen sc1
  v_mov_b32 v35, 0
  v_mov_b32 v36, 0
  v_mov_b32 v37, 0
  v_mov_b32 v38, 0
  v_mov_b32 v39, 0
  v_mov_b32 v40, 0
  v_mov_b32 v41, 0
  v_mov_b32 v42, 0
  v_mov_b32 v43, 0
  v_mov_b32 v44, 0
  v_mov_b32 v45, 0
  v_mov_b32 v46, 0
  v_mov_b32 v47, 0
  v_mov_b32 v48, 0
  v_mov_b32 v49, 0
  v_mov_b32 v50, 0
  v_mov_b32 v51, 0
  v_mov_b32 v52, 0
  v_mov_b32 v53, 0
  v_mov_b32 v54, 0
  v_mov_b32 v55, 0
  v_mov_b32 v56, 0
  v_mov_b32 v57, 0
  v_mov_b32 v58, 0
  v_mov_b32 v59, 0
  s_xor_b32 s18, s18, s19
  s_xor_b32 s19, s19, s18
  s_xor_b32 s18, s18, s19
  s_xor_b32 s20, s20, s21
  s_xor_b32 s21, s21, s20
  s_xor_b32 s20, s20, s21
  s_add_u32 s72, s72, 1
  s_cmp_eq_u32 s72, 4
  s_cselect_b32 s72, 0, s72
  s_mov_b32 s73, 325632
  s_cselect_b32 s73, 0xfff11800, s73
  s_add_u32 s23, s23, s73
  s_mov_b32 s15, 0
  s_add_u32 s13, s17, 0
  s_add_u32 s14, s17, 2048
  s_nop 15
  s_nop 15
  s_nop 15
  s_nop 15
  s_nop 15
  s_nop 15
  buffer_load_dwordx4 v[96:99], v62, s[4:7], s37 offen offset:0 sc1
  buffer_load_dwordx4 v[100:103], v62, s[4:7], s37 offen offset:1024 sc1
  s_barrier
  buffer_store_dwordx4 v[92:95], v66, s[4:7], s25 offen
  s_add_u32 s25, s25, s73
  s_add_u32 s12, s12, 1
  s_waitcnt vmcnt(1)
  v_mfma_f32_16x16x32_bf16 v[128:131], a[160:163], v[96:99], 0
  v_max3_u32 v14, v96, v97, v98
  v_max3_u32 v14, v14, v99, v100
  v_mfma_f32_16x16x32_bf16 v[128:131], a[160:163], v[100:103], v[128:131]
  v_max3_u32 v14, v14, v101, v102
  v_max_u32 v14, v14, v103
  v_cmp_eq_u32 vcc, -1, v14
  s_nop 4
  v_cvt_pk_bf16_f32 v68, v128, v129
  v_cvt_pk_bf16_f32 v69, v130, v131
  s_cbranch_vccnz mega_loop0_pbf
mega_loop0_pbok:
  buffer_store_dwordx2 v[68:69], v63, s[4:7], s17 offen
  buffer_store_dwordx2 v[132:133], v63, s[4:7], s16 offen
  s_barrier
  s_nop 15
  s_nop 15
  s_branch mega_loop0
mega0_kernel_sd24_wait:
  s_mov_b32 s15, 0
mega0_kernel_sd24_w2:
  buffer_load_dword v13, v12, s[4:7], s71 offen sc1
  s_waitcnt vmcnt(0)
  v_min_u32_dpp v13, v13, v13 quad_perm:[1,0,3,2] row_mask:0xf bank_mask:0xf
  s_nop 1
  v_min_u32_dpp v13, v13, v13 quad_perm:[2,3,0,1] row_mask:0xf bank_mask:0xf
  s_nop 1
  v_min_u32_dpp v13, v13, v13 row_half_mirror row_mask:0xf bank_mask:0xf
  s_nop 0
  v_readfirstlane_b32 s76, v13
  s_nop 0
  s_cmp_ge_u32 s76, s29
  s_cbranch_scc1 mega0_kernel_sd24_go
  s_sleep 1
  s_add_u32 s15, s15, 1
  s_cmp_lt_u32 s15, 262144
  s_cbranch_scc1 mega0_kernel_sd24_w2
  s_branch mega_fail
mega_loop0_pcf:
  buffer_load_dwordx4 v[16:19], v2, s[4:7], s13 offen offset:0 sc1
  buffer_load_dwordx4 v[20:23], v2, s[4:7], s13 offen offset:1024 sc1
  buffer_load_dwordx4 v[24:27], v2, s[4:7], s14 offen offset:0 sc1
  s_nop 0
  v_mov_b32 v28, 0
  v_mov_b32 v29, 0
  v_mov_b32 v30, 0
  v_mov_b32 v31, 0
  v_mov_b32 v32, 0
  v_mov_b32 v33, 0
  v_mov_b32 v34, 0
  v_mov_b32 v35, 0
  s_add_u32 s15, s15, 16384
  s_cbranch_scc1 mega_fail
  s_branch mega_loop0_pc2
mega_loop0_last:
  v_smfmac_f32_16x16x64_bf16 v[56:59], v[24:27], a[96:103], v9
  ds_read_b128 a[188:191], v2 offset:30720
  s_waitcnt lgkmcnt(4)
  buffer_store_dwordx2 v[132:133], v10, s[4:7], s19 offen
  v_smfmac_f32_16x16x64_bf16 v[52:55], v[72:75], a[24:31], v9
  v_smfmac_f32_16x16x64_bf16 v[56:59], v[72:75], a[104:111], v9
  v_smfmac_f32_16x16x64_bf16 v[52:55], v[76:79], a[32:39], v9
  v_smfmac_f32_16x16x64_bf16 v[56:59], v[76:79], a[112:119], v9
  v_smfmac_f32_16x16x64_bf16 v[52:55], v[80:83], a[40:47], v9
  v_smfmac_f32_16x16x64_bf16 v[56:59], v[80:83], a[120:127], v9
  v_smfmac_f32_16x16x64_bf16 v[52:55], v[84:87], a[48:55], v9
  v_smfmac_f32_16x16x64_bf16 v[56:59], v[84:87], a[128:135], v9
  v_smfmac_f32_16x16x64_bf16 v[52:55], v[88:91], a[56:63], v9
  v_smfmac_f32_16x16x64_bf16 v[56:59], v[88:91], a[136:143], v9
  v_smfmac_f32_16x16x64_bf16 v[52:55], v[92:95], a[64:71], v9
  v_smfmac_f32_16x16x64_bf16 v[56:59], v[92:95], a[144:151], v9
  v_smfmac_f32_16x16x64_bf16 v[52:55], v[96:99], a[72:79], v9
  v_smfmac_f32_16x16x64_bf16 v[56:59], v[96:99], a[152:159], v9
  s_nop 4
  v_add_f32 v52, v52, v54
  v_add_f32 v53, v53, v55
  v_cvt_pk_bf16_f32 v52, v52, v53
  ds_write_b32 v8, v52 offset:21504
  v_add_f32 v56, v56, v58
  v_add_f32 v57, v57, v59
  v_cvt_pk_bf16_f32 v56, v56, v57
  ds_write_b32 v8, v56 offset:22528
  s_waitcnt lgkmcnt(0)
  s_barrier
  ds_read_b128 v[92:95], v13 offset:21504
  s_waitcnt lgkmcnt(0)
  buffer_store_dwordx4 v[92:95], v66, s[4:7], s25 offen
  s_waitcnt vmcnt(0)
  s_barrier
  s_cmp_lg_u32 s70, 0
  s_cbranch_scc1 mega_end
  s_lshl_b32 s73, s2, 2
  s_add_u32 s73, s73, s3
  s_branch mega_bjobs
mega_loop0_pbf:
  buffer_load_dwordx4 v[96:99], v62, s[4:7], s37 offen offset:0 sc1
  buffer_load_dwordx4 v[100:103], v62, s[4:7], s37 offen offset:1024 sc1
mega_loop0_pbl:
  buffer_load_dwordx4 v[96:99], v62, s[4:7], s37 offen offset:0 sc1
  buffer_load_dwordx4 v[100:103], v62, s[4:7], s37 offen offset:1024 sc1
  s_add_u32 s15, s15, 16384
  s_cbranch_scc1 mega_fail
  s_waitcnt vmcnt(2)
  v_max3_u32 v14, v96, v97, v98
  v_max3_u32 v14, v14, v99, v100
  v_mfma_f32_16x16x32_bf16 v[128:131], a[160:163], v[96:99], 0
  v_max3_u32 v14, v14, v101, v102
  v_max_u32 v14, v14, v103
  v_mfma_f32_16x16x32_bf16 v[128:131], a[160:163], v[100:103], v[128:131]
  v_cmp_eq_u32 vcc, -1, v14
  s_nop 6
  v_cvt_pk_bf16_f32 v68, v128, v129
  v_cvt_pk_bf16_f32 v69, v130, v131
  s_cbranch_vccnz mega_loop0_pbl
  s_branch mega_loop0_pbok
mega_loop1:
  buffer_load_dwordx4 v[16:19], v2, s[4:7], s13 offen offset:0 sc1
  buffer_load_dwordx4 v[20:23], v2, s[4:7], s13 offen offset:1024 sc1
  buffer_load_dwordx4 v[24:27], v2, s[4:7], s14 offen offset:0 sc1
  s_xor_b32 s16, s16, s17
  s_xor_b32 s17, s17, s16
  s_xor_b32 s16, s16, s17
  s_mov_b32 m0, 3072
  s_add_u32 s39, s39, 1
  s_and_b32 s27, s39, 7
  s_mul_i32 s27, s27, 163840
  s_add_u32 s37, s32, s27
  s_add_u32 s33, s30, s27
  s_nop 15
  s_nop 14
  buffer_load_dwordx4 v[16:19], v2, s[4:7], s13 offen offset:0 sc1
  buffer_load_dwordx4 v[20:23], v2, s[4:7], s13 offen offset:1024 sc1
  buffer_load_dwordx4 v[24:27], v2, s[4:7], s14 offen offset:0 sc1
mega_loop1_pc2:
  s_waitcnt vmcnt(3)
  v_max3_u32 v14, v16, v17, v18
  v_max3_u32 v14, v14, v19, v20
  v_smfmac_f32_16x16x64_bf16 v[44:47], v[16:19], v[136:143], v9
  v_max3_u32 v14, v14, v21, v22
  v_max3_u32 v14, v14, v23, v24
  v_smfmac_f32_16x16x64_bf16 v[48:51], v[16:19], v[144:151], v9
  v_max3_u32 v14, v14, v25, v26
  v_max_u32 v14, v14, v27
  v_smfmac_f32_16x16x64_bf16 v[44:47], v[20:23], v[152:159], v9
  v_cmp_eq_u32 vcc, -1, v14
  v_smfmac_f32_16x16x64_bf16 v[48:51], v[20:23], v[160:167], v9
  s_cbranch_vccnz mega_loop1_pcf
  v_smfmac_f32_16x16x64_bf16 v[44:47], v[24:27], v[168:175], v9
  ds_write_b128 v2, v[16:19] offset:3072
  v_smfmac_f32_16x16x64_bf16 v[48:51], v[24:27], v[176:183], v9
  ds_write_b128 v2, v[20:23] offset:4096
  v_smfmac_f32_16x16x64_bf16 v[36:39], v[16:19], v[184:191], v9
  v_smfmac_f32_16x16x64_bf16 v[40:43], v[16:19], v[192:199], v9
  v_add_f32 v44, v44, v46
  v_smfmac_f32_16x16x64_bf16 v[36:39], v[20:23], v[200:207], v9
  v_add_f32 v45, v45, v47
  v_cvt_pk_bf16_f32 v46, v44, v45
  v_smfmac_f32_16x16x64_bf16 v[40:43], v[20:23], v[208:215], v9
  v_add_f32 v48, v48, v50
  v_smfmac_f32_16x16x64_bf16 v[40:43], v[24:27], v[216:223], v9
  v_add_f32 v49, v49, v51
  v_cvt_pk_bf16_f32 v47, v48, v49
  v_smfmac_f32_16x16x64_bf16 v[28:31], v[16:19], v[224:231], v9
  ds_write_b64 v3, v[46:47] offset:14336
  v_smfmac_f32_16x16x64_bf16 v[32:35], v[16:19], v[232:239], v9
  v_add_f32 v36, v36, v38
  v_smfmac_f32_16x16x64_bf16 v[28:31], v[20:23], v[240:247], v9
  v_add_f32 v37, v37, v39
  v_cvt_pk_bf16_f32 v38, v36, v37
  v_smfmac_f32_16x16x64_bf16 v[32:35], v[20:23], v[248:255], v9
  v_add_f32 v40, v40, v42
  v_add_f32 v41, v41, v43
  v_cvt_pk_bf16_f32 v39, v40, v41
  ds_write_b64 v3, v[38:39] offset:12288
  s_nop 0
  v_add_f32 v28, v28, v30
  v_add_f32 v29, v29, v31
  v_cvt_pk_bf16_f32 v30, v28, v29
  v_add_f32 v32, v32, v34
  v_add_f32 v33, v33, v35
  v_cvt_pk_bf16_f32 v31, v32, v33
  ds_write_b64 v3, v[30:31] offset:10240
  v_smfmac_f32_16x16x64_bf16 v[52:55], v[16:19], a[24:31], v9
  v_smfmac_f32_16x16x64_bf16 v[56:59], v[16:19], a[104:111], v9
  v_smfmac_f32_16x16x64_bf16 v[52:55], v[20:23], a[32:39], v9
  s_waitcnt lgkmcnt(0)
  s_barrier
  ds_read_b128 v[28:31], v2 offset:10240
  ds_read_b128 v[32:35], v2 offset:11264
  ds_read_b128 v[36:39], v2 offset:12288
  ds_read_b128 v[40:43], v2 offset:13312
  ds_read_b128 v[44:47], v2 offset:14336
  ds_read_b128 v[48:51], v2 offset:15360
  ds_read_b128 v[120:123], v11 offset:35840
  ds_read_b64 v[124:125], v11 offset:36872
  v_smfmac_f32_16x16x64_bf16 v[56:59], v[20:23], a[112:119], v9
  s_waitcnt lgkmcnt(7)
  v_mfma_f32_16x16x32_bf16 v[100:103], v[28:31], a[172:175], 0
  ds_read_b128 v[72:75], v2 offset:0
  s_waitcnt lgkmcnt(7)
  v_mfma_f32_16x16x32_bf16 v[100:103], v[32:35], a[172:175], v[100:103]
  ds_read_b128 v[76:79], v2 offset:1024
  s_waitcnt lgkmcnt(7)
  v_mfma_f32_16x16x32_bf16 v[104:107], v[36:39], a[172:175], 0
  ds_read_b128 v[80:83], v2 offset:5120
  s_waitcnt lgkmcnt(7)
  v_mfma_f32_16x16x32_bf16 v[104:107], v[40:43], a[172:175], v[104:107]
  ds_read_b128 v[84:87], v2 offset:6144
  s_waitcnt lgkmcnt(7)
  v_mfma_f32_16x16x32_bf16 v[108:111], v[44:47], a[172:175], 0
  v_cvt_pk_bf16_f32 v112, v100, v101
  v_cvt_pk_bf16_f32 v113, v102, v103
  s_waitcnt lgkmcnt(6)
  v_mfma_f32_16x16x32_bf16 v[108:111], v[48:51], a[172:175], v[108:111]
  s_nop 0
  v_cvt_pk_bf16_f32 v114, v104, v105
  v_cvt_pk_bf16_f32 v115, v106, v107
  s_waitcnt lgkmcnt(4)
  ds_read_b128 v[88:91], v2 offset:7168
  v_mfma_f32_16x16x32_bf16 v[128:131], v[120:123], v[112:115], 0
  ds_read_b128 v[92:95], v2 offset:8192
  ds_read_b128 v[96:99], v2 offset:9216
  v_cvt_pk_bf16_f32 v116, v108, v109
  v_cvt_pk_bf16_f32 v117, v110, v111
  s_nop 1
  v_mfma_f32_16x16x32_bf16 v[128:131], v[124:127], v[116:119], v[128:131]
  v_smfmac_f32_16x16x64_bf16 v[52:55], v[24:27], a[16:23], v9
  ds_read_b128 a[176:179], v2 offset:25600
  ds_read_b128 a[180:183], v2 offset:27648
  ds_read_b128 a[184:187], v2 offset:29696
  s_nop 1
  v_cvt_pk_bf16_f32 v68, v128, v129
  v_cvt_pk_bf16_f32 v69, v130, v131
  buffer_store_dwordx2 v[68:69], v10, s[4:7], s18 offen
  s_cmp_eq_u32 s12, 63
  s_cbranch_scc1 mega_loop1_last
  v_smfmac_f32_16x16x64_bf16 v[56:59], v[24:27], a[96:103], v9
  ds_read_b128 a[188:191], v2 offset:31744
  s_waitcnt lgkmcnt(4)
  buffer_store_dwordx2 v[132:133], v10, s[4:7], s19 offen
  v_smfmac_f32_16x16x64_bf16 v[52:55], v[72:75], a[0:7], v9
  v_smfmac_f32_16x16x64_bf16 v[56:59], v[72:75], a[80:87], v9
  v_smfmac_f32_16x16x64_bf16 v[52:55], v[76:79], a[8:15], v9
  v_smfmac_f32_16x16x64_bf16 v[56:59], v[76:79], a[88:95], v9
  v_smfmac_f32_16x16x64_bf16 v[52:55], v[80:83], a[40:47], v9
  v_smfmac_f32_16x16x64_bf16 v[56:59], v[80:83], a[120:127], v9
  v_smfmac_f32_16x16x64_bf16 v[52:55], v[84:87], a[48:55], v9
  v_smfmac_f32_16x16x64_bf16 v[56:59], v[84:87], a[128:135], v9
  v_smfmac_f32_16x16x64_bf16 v[52:55], v[88:91], a[56:63], v9
  v_smfmac_f32_16x16x64_bf16 v[56:59], v[88:91], a[136:143], v9
  buffer_load_dwordx4 v[16:19], v4, s[4:7], s20 offen sc1
  v_smfmac_f32_16x16x64_bf16 v[52:55], v[92:95], a[64:71], v9
  buffer_load_dwordx4 v[20:23], v4, s[4:7], s20 offen offset:256 sc1
  v_smfmac_f32_16x16x64_bf16 v[56:59], v[92:95], a[144:151], v9
  buffer_load_dwordx4 v[24:27], v5, s[4:7], s20 offen offset:512 sc1
  v_smfmac_f32_16x16x64_bf16 v[52:55], v[96:99], a[72:79], v9
  v_smfmac_f32_16x16x64_bf16 v[56:59], v[96:99], a[152:159], v9
  s_nop 4
  v_add_f32 v52, v52, v54
  v_add_f32 v53, v53, v55
  v_cvt_pk_bf16_f32 v52, v52, v53
  ds_write_b32 v8, v52 offset:21504
  v_add_f32 v56, v56, v58
  v_add_f32 v57, v57, v59
  v_cvt_pk_bf16_f32 v56, v56, v57
  ds_write_b32 v8, v56 offset:22528
mega_loop1_pa:
  buffer_load_dwordx4 v[16:19], v4, s[4:7], s20 offen sc1
  buffer_load_dwordx4 v[20:23], v4, s[4:7], s20 offen offset:256 sc1
  buffer_load_dwordx4 v[24:27], v5, s[4:7], s20 offen offset:512 sc1
  s_add_u32 s15, s15, 16384
  s_cbranch_scc1 mega_fail
  s_waitcnt vmcnt(3)
  v_max3_u32 v14, v16, v17, v18
  v_max3_u32 v14, v14, v19, v20
  v_mfma_f32_16x16x32_bf16 v[40:43], v[16:19], a[160:163], 0
  v_max3_u32 v14, v14, v21, v22
  v_max3_u32 v14, v14, v23, v24
  v_mfma_f32_16x16x32_bf16 v[40:43], v[20:23], a[164:167], v[40:43]
  v_max3_u32 v14, v14, v25, v26
  v_max_u32 v14, v14, v27
  v_mfma_f32_16x16x32_bf16 v[44:47], v[24:27], a[168:171], 0
  v_cmp_eq_u32 vcc, -1, v14
  s_nop 3
  v_max3_f32 v48, v40, v41, v42
  s_cbranch_vccnz mega_loop1_pa
  s_nop 0
  v_cndmask_b32 v44, v44, v45, s[42:43]
  v_max3_f32 v48, v48, v43, v44
  s_nop 1
  v_max_f32_dpp v48, v48, v48 quad_perm:[1,0,3,2] row_mask:0xf bank_mask:0xf
  s_nop 1
  v_max_f32_dpp v48, v48, v48 quad_perm:[2,3,0,1] row_mask:0xf bank_mask:0xf
  s_nop 1
  v_max_f32_dpp v48, v48, v48 row_half_mirror row_mask:0xf bank_mask:0xf
  v_mul_f32 v48, v0, v48
  v_pk_fma_f32 v[40:41], v[40:41], v[0:1], v[48:49] op_sel_hi:[1,0,0] neg_lo:[0,1,0] neg_hi:[0,1,0]
  v_pk_fma_f32 v[42:43], v[42:43], v[0:1], v[48:49] op_sel_hi:[1,0,0] neg_lo:[0,1,0] neg_hi:[0,1,0]
  v_fma_f32 v44, v44, -v0, v48
  v_exp_f32 v40, v40
  v_exp_f32 v41, v41
  v_exp_f32 v42, v42
  v_exp_f32 v43, v43
  v_exp_f32 v44, v44
  v_pk_add_f32 v[48:49], v[40:41], v[42:43]
  v_add_f32 v48, v48, v49
  v_add_f32 v48, v48, v44
  s_nop 1
  v_add_f32_dpp v48, v48, v48 quad_perm:[1,0,3,2] row_mask:0xf bank_mask:0xf
  s_nop 1
  v_add_f32_dpp v48, v48, v48 quad_perm:[2,3,0,1] row_mask:0xf bank_mask:0xf
  s_nop 1
  v_add_f32_dpp v48, v48, v48 row_half_mirror row_mask:0xf bank_mask:0xf
  v_rcp_f32 v48, v48
  s_nop 0
  v_pk_mul_f32 v[40:41], v[40:41], v[48:49] op_sel_hi:[1,0]
  v_pk_mul_f32 v[42:43], v[42:43], v[48:49] op_sel_hi:[1,0]
  v_mul_f32 v44, v44, v48
  v_cvt_pk_bf16_f32 v40, v40, v41
  v_cvt_pk_bf16_f32 v41, v42, v43
  ds_write_b64 v6, v[40:41] offset:16384
  v_cvt_pk_bf16_f32 v44, v44, v44
  ds_write_b16 v7, v44 offset:20480
  s_waitcnt lgkmcnt(0)
  s_barrier
  ds_read_b128 v[72:75], v12 offset:16384
  ds_read_b128 v[76:79], v12 offset:17408
  ds_read_b128 v[80:83], v12 offset:18432
  ds_read_b128 v[84:87], v12 offset:19456
  ds_read_b128 v[88:91], v12 offset:20480
  ds_read_b128 v[92:95], v13 offset:21504
  s_waitcnt lgkmcnt(5)
  v_mfma_f32_16x16x32_bf16 v[128:131], a[176:179], v[72:75], 0
  s_waitcnt lgkmcnt(4)
  v_mfma_f32_16x16x32_bf16 v[128:131], a[180:183], v[76:79], v[128:131]
  s_waitcnt lgkmcnt(3)
  v_mfma_f32_16x16x32_bf16 v[128:131], a[184:187], v[80:83], v[128:131]
  s_waitcnt lgkmcnt(2)
  v_mfma_f32_16x16x32_bf16 v[128:131], a[188:191], v[84:87], v[128:131]
  s_waitcnt lgkmcnt(0)
  v_mfma_f32_16x16x32_bf16 v[128:131], v[92:95], v[88:91], v[128:131]
  v_mov_b32 v28, 0
  v_mov_b32 v29, 0
  v_mov_b32 v30, 0
  v_mov_b32 v31, 0
  v_mov_b32 v32, 0
  v_mov_b32 v33, 0
  v_mov_b32 v34, 0
  s_nop 0
  v_cvt_pk_bf16_f32 v68, v128, v129
  v_cvt_pk_bf16_f32 v70, v128, v129
  v_cvt_pk_bf16_f32 v69, v130, v131
  v_cvt_pk_bf16_f32 v71, v130, v131
  v_permlane16_swap_b32 v68, v70
  s_nop 0
  v_permlane16_swap_b32 v69, v71
  buffer_store_dwordx4 v[68:71], v61, s[4:7], s33 offen sc1
  buffer_store_dwordx4 v[68:71], v134, s[4:7], s33 offen sc1
  v_mov_b32 v35, 0
  v_mov_b32 v36, 0
  v_mov_b32 v37, 0
  v_mov_b32 v38, 0
  v_mov_b32 v39, 0
  v_mov_b32 v40, 0
  v_mov_b32 v41, 0
  v_mov_b32 v42, 0
  v_mov_b32 v43, 0
  v_mov_b32 v44, 0
  v_mov_b32 v45, 0
  v_mov_b32 v46, 0
  v_mov_b32 v47, 0
  v_mov_b32 v48, 0
  v_mov_b32 v49, 0
  v_mov_b32 v50, 0
  v_mov_b32 v51, 0
  v_mov_b32 v52, 0
  v_mov_b32 v53, 0
  v_mov_b32 v54, 0
  v_mov_b32 v55, 0
  v_mov_b32 v56, 0
  v_mov_b32 v57, 0
  v_mov_b32 v58, 0
  v_mov_b32 v59, 0
  s_xor_b32 s18, s18, s19
  s_xor_b32 s19, s19, s18
  s_xor_b32 s18, s18, s19
  s_xor_b32 s20, s20, s21
  s_xor_b32 s21, s21, s20
  s_xor_b32 s20, s20, s21
  s_add_u32 s72, s72, 1
  s_cmp_eq_u32 s72, 4
  s_cselect_b32 s72, 0, s72
  s_mov_b32 s73, 325632
  s_cselect_b32 s73, 0xfff11800, s73
  s_add_u32 s23, s23, s73
  s_mov_b32 s15, 0
  s_add_u32 s13, s17, 3072
  s_add_u32 s14, s17, 2048
  s_nop 15
  s_nop 15
  s_nop 15
  s_nop 15
  s_nop 15
  s_nop 15
  buffer_load_dwordx4 v[96:99], v62, s[4:7], s37 offen offset:0 sc1
  buffer_load_dwordx4 v[100:103], v62, s[4:7], s37 offen offset:1024 sc1
  s_barrier
  buffer_store_dwordx4 v[92:95], v66, s[4:7], s25 offen
  s_add_u32 s25, s25, s73
  s_add_u32 s12, s12, 1
  s_waitcnt vmcnt(1)
  v_mfma_f32_16x16x32_bf16 v[128:131], a[160:163], v[96:99], 0
  v_max3_u32 v14, v96, v97, v98
  v_max3_u32 v14, v14, v99, v100
  v_mfma_f32_16x16x32_bf16 v[128:131], a[160:163], v[100:103], v[128:131]
  v_max3_u32 v14, v14, v101, v102
  v_max_u32 v14, v14, v103
  v_cmp_eq_u32 vcc, -1, v14
  s_nop 4
  v_cvt_pk_bf16_f32 v68, v128, v129
  v_cvt_pk_bf16_f32 v69, v130, v131
  s_cbranch_vccnz mega_loop1_pbf
mega_loop1_pbok:
  buffer_store_dwordx2 v[68:69], v63, s[4:7], s17 offen
  buffer_store_dwordx2 v[132:133], v63, s[4:7], s16 offen
  s_barrier
  s_nop 15
  s_nop 15
  s_branch mega_loop1
mega_loop1_pcf:
  buffer_load_dwordx4 v[16:19], v2, s[4:7], s13 offen offset:0 sc1
  buffer_load_dwordx4 v[20:23], v2, s[4:7], s13 offen offset:1024 sc1
  buffer_load_dwordx4 v[24:27], v2, s[4:7], s14 offen offset:0 sc1
  s_nop 0
  v_mov_b32 v44, 0
  v_mov_b32 v45, 0
  v_mov_b32 v46, 0
  v_mov_b32 v47, 0
  v_mov_b32 v48, 0
  v_mov_b32 v49, 0
  v_mov_b32 v50, 0
  v_mov_b32 v51, 0
  s_add_u32 s15, s15, 16384
  s_cbranch_scc1 mega_fail
  s_branch mega_loop1_pc2
mega_loop1_last:
  v_smfmac_f32_16x16x64_bf16 v[56:59], v[24:27], a[96:103], v9
  ds_read_b128 a[188:191], v2 offset:31744
  s_waitcnt lgkmcnt(4)
  buffer_store_dwordx2 v[132:133], v10, s[4:7], s19 offen
  v_smfmac_f32_16x16x64_bf16 v[52:55], v[72:75], a[0:7], v9
  v_smfmac_f32_16x16x64_bf16 v[56:59], v[72:75], a[80:87], v9
  v_smfmac_f32_16x16x64_bf16 v[52:55], v[76:79], a[8:15], v9
  v_smfmac_f32_16x16x64_bf16 v[56:59], v[76:79], a[88:95], v9
  v_smfmac_f32_16x16x64_bf16 v[52:55], v[80:83], a[40:47], v9
  v_smfmac_f32_16x16x64_bf16 v[56:59], v[80:83], a[120:127], v9
  v_smfmac_f32_16x16x64_bf16 v[52:55], v[84:87], a[48:55], v9
  v_smfmac_f32_16x16x64_bf16 v[56:59], v[84:87], a[128:135], v9
  v_smfmac_f32_16x16x64_bf16 v[52:55], v[88:91], a[56:63], v9
  v_smfmac_f32_16x16x64_bf16 v[56:59], v[88:91], a[136:143], v9
  v_smfmac_f32_16x16x64_bf16 v[52:55], v[92:95], a[64:71], v9
  v_smfmac_f32_16x16x64_bf16 v[56:59], v[92:95], a[144:151], v9
  v_smfmac_f32_16x16x64_bf16 v[52:55], v[96:99], a[72:79], v9
  v_smfmac_f32_16x16x64_bf16 v[56:59], v[96:99], a[152:159], v9
  s_nop 4
  v_add_f32 v52, v52, v54
  v_add_f32 v53, v53, v55
  v_cvt_pk_bf16_f32 v52, v52, v53
  ds_write_b32 v8, v52 offset:21504
  v_add_f32 v56, v56, v58
  v_add_f32 v57, v57, v59
  v_cvt_pk_bf16_f32 v56, v56, v57
  ds_write_b32 v8, v56 offset:22528
  s_waitcnt lgkmcnt(0)
  s_barrier
  ds_read_b128 v[92:95], v13 offset:21504
  s_waitcnt lgkmcnt(0)
  buffer_store_dwordx4 v[92:95], v66, s[4:7], s25 offen
  s_waitcnt vmcnt(0)
  s_barrier
  s_cmp_lg_u32 s70, 0
  s_cbranch_scc1 mega_end
  s_lshl_b32 s73, s2, 2
  s_add_u32 s73, s73, s3
  s_branch mega_bjobs
mega_loop1_pbf:
  buffer_load_dwordx4 v[96:99], v62, s[4:7], s37 offen offset:0 sc1
  buffer_load_dwordx4 v[100:103], v62, s[4:7], s37 offen offset:1024 sc1
mega_loop1_pbl:
  buffer_load_dwordx4 v[96:99], v62, s[4:7], s37 offen offset:0 sc1
  buffer_load_dwordx4 v[100:103], v62, s[4:7], s37 offen offset:1024 sc1
  s_add_u32 s15, s15, 16384
  s_cbranch_scc1 mega_fail
  s_waitcnt vmcnt(2)
  v_max3_u32 v14, v96, v97, v98
  v_max3_u32 v14, v14, v99, v100
  v_mfma_f32_16x16x32_bf16 v[128:131], a[160:163], v[96:99], 0
  v_max3_u32 v14, v14, v101, v102
  v_max_u32 v14, v14, v103
  v_mfma_f32_16x16x32_bf16 v[128:131], a[160:163], v[100:103], v[128:131]
  v_cmp_eq_u32 vcc, -1, v14
  s_nop 6
  v_cvt_pk_bf16_f32 v68, v128, v129
  v_cvt_pk_bf16_f32 v69, v130, v131
  s_cbranch_vccnz mega_loop1_pbl
  s_branch mega_loop1_pbok
mega_loop2:
  buffer_load_dwordx4 v[16:19], v2, s[4:7], s13 offen offset:0 sc1
  buffer_load_dwordx4 v[20:23], v2, s[4:7], s13 offen offset:1024 sc1
  buffer_load_dwordx4 v[24:27], v2, s[4:7], s14 offen offset:0 sc1
  s_xor_b32 s16, s16, s17
  s_xor_b32 s17, s17, s16
  s_xor_b32 s16, s16, s17
  s_mov_b32 m0, 5120
  s_add_u32 s39, s39, 1
  s_and_b32 s27, s39, 7
  s_mul_i32 s27, s27, 163840
  s_add_u32 s37, s32, s27
  s_add_u32 s33, s30, s27
  s_nop 15
  s_nop 14
  buffer_load_dwordx4 v[16:19], v2, s[4:7], s13 offen offset:0 sc1
  buffer_load_dwordx4 v[20:23], v2, s[4:7], s13 offen offset:1024 sc1
  buffer_load_dwordx4 v[24:27], v2, s[4:7], s14 offen offset:0 sc1
mega_loop2_pc2:
  s_waitcnt vmcnt(3)
  v_max3_u32 v14, v16, v17, v18
  v_max3_u32 v14, v14, v19, v20
  v_smfmac_f32_16x16x64_bf16 v[28:31], v[16:19], v[136:143], v9
  v_max3_u32 v14, v14, v21, v22
  v_max3_u32 v14, v14, v23, v24
  v_smfmac_f32_16x16x64_bf16 v[32:35], v[16:19], v[144:151], v9
  v_max3_u32 v14, v14, v25, v26
  v_max_u32 v14, v14, v27
  v_smfmac_f32_16x16x64_bf16 v[28:31], v[20:23], v[152:159], v9
  v_cmp_eq_u32 vcc, -1, v14
  v_smfmac_f32_16x16x64_bf16 v[32:35], v[20:23], v[160:167], v9
  s_cbranch_vccnz mega_loop2_pcf
  v_smfmac_f32_16x16x64_bf16 v[28:31], v[24:27], v[168:175], v9
  ds_write_b128 v2, v[16:19] offset:5120
  v_smfmac_f32_16x16x64_bf16 v[32:35], v[24:27], v[176:183], v9
  ds_write_b128 v2, v[20:23] offset:6144
  v_smfmac_f32_16x16x64_bf16 v[36:39], v[16:19], v[184:191], v9
  ds_write_b128 v2, v[24:27] offset:7168
  v_smfmac_f32_16x16x64_bf16 v[40:43], v[16:19], v[192:199], v9
  v_add_f32 v28, v28, v30
  v_smfmac_f32_16x16x64_bf16 v[36:39], v[20:23], v[200:207], v9
  v_add_f32 v29, v29, v31
  v_cvt_pk_bf16_f32 v30, v28, v29
  v_smfmac_f32_16x16x64_bf16 v[40:43], v[20:23], v[208:215], v9
  v_add_f32 v32, v32, v34
  v_smfmac_f32_16x16x64_bf16 v[36:39], v[24:27], v[216:223], v9
  v_add_f32 v33, v33, v35
  v_cvt_pk_bf16_f32 v31, v32, v33
  v_smfmac_f32_16x16x64_bf16 v[44:47], v[16:19], v[224:231], v9
  ds_write_b64 v3, v[30:31] offset:10240
  v_smfmac_f32_16x16x64_bf16 v[48:51], v[16:19], v[232:239], v9
  s_nop 0
  v_add_f32 v36, v36, v38
  v_smfmac_f32_16x16x64_bf16 v[44:47], v[20:23], v[240:247], v9
  v_add_f32 v37, v37, v39
  v_cvt_pk_bf16_f32 v38, v36, v37
  v_smfmac_f32_16x16x64_bf16 v[48:51], v[20:23], v[248:255], v9
  v_add_f32 v40, v40, v42
  v_add_f32 v41, v41, v43
  v_cvt_pk_bf16_f32 v39, v40, v41
  ds_write_b64 v3, v[38:39] offset:12288
  s_nop 0
  v_add_f32 v44, v44, v46
  v_add_f32 v45, v45, v47
  v_cvt_pk_bf16_f32 v46, v44, v45
  v_add_f32 v48, v48, v50
  v_add_f32 v49, v49, v51
  v_cvt_pk_bf16_f32 v47, v48, v49
  ds_write_b64 v3, v[46:47] offset:14336
  v_smfmac_f32_16x16x64_bf16 v[52:55], v[16:19], a[40:47], v9
  v_smfmac_f32_16x16x64_bf16 v[56:59], v[16:19], a[120:127], v9
  v_smfmac_f32_16x16x64_bf16 v[52:55], v[20:23], a[48:55], v9
  s_waitcnt lgkmcnt(0)
  s_barrier
  ds_read_b128 v[28:31], v2 offset:10240
  ds_read_b128 v[32:35], v2 offset:11264
  ds_read_b128 v[36:39], v2 offset:12288
  ds_read_b128 v[40:43], v2 offset:13312
  ds_read_b128 v[44:47], v2 offset:14336
  ds_read_b128 v[48:51], v2 offset:15360
  v_smfmac_f32_16x16x64_bf16 v[56:59], v[20:23], a[128:135], v9
  s_waitcnt lgkmcnt(5)
  v_mfma_f32_16x16x32_bf16 v[100:103], v[28:31], a[172:175], 0
  ds_read_b128 v[72:75], v2 offset:0
  s_waitcnt lgkmcnt(5)
  v_mfma_f32_16x16x32_bf16 v[100:103], v[32:35], a[172:175], v[100:103]
  ds_read_b128 v[76:79], v2 offset:1024
  s_waitcnt lgkmcnt(5)
  v_mfma_f32_16x16x32_bf16 v[104:107], v[36:39], a[172:175], 0
  ds_read_b128 v[80:83], v2 offset:2048
  s_waitcnt lgkmcnt(5)
  v_mfma_f32_16x16x32_bf16 v[104:107], v[40:43], a[172:175], v[104:107]
  ds_read_b128 v[84:87], v2 offset:3072
  s_waitcnt lgkmcnt(5)
  v_mfma_f32_16x16x32_bf16 v[108:111], v[44:47], a[172:175], 0
  v_cvt_pk_bf16_f32 v112, v100, v101
  v_cvt_pk_bf16_f32 v113, v102, v103
  s_waitcnt lgkmcnt(4)
  v_mfma_f32_16x16x32_bf16 v[108:111], v[48:51], a[172:175], v[108:111]
  s_nop 0
  v_cvt_pk_bf16_f32 v114, v104, v105
  v_cvt_pk_bf16_f32 v115, v106, v107
  s_waitcnt lgkmcnt(4)
  ds_read_b128 v[88:91], v2 offset:4096
  v_mfma_f32_16x16x32_bf16 v[128:131], v[112:115], v[112:115], 0
  ds_read_b128 v[92:95], v2 offset:8192
  ds_read_b128 v[96:99], v2 offset:9216
  v_cvt_pk_bf16_f32 v116, v108, v109
  v_cvt_pk_bf16_f32 v117, v110, v111
  s_nop 1
  v_mfma_f32_16x16x32_bf16 v[128:131], v[116:119], v[116:119], v[128:131]
  v_smfmac_f32_16x16x64_bf16 v[52:55], v[24:27], a[56:63], v9
  ds_read_b128 a[176:179], v12 offset:32768
  ds_read_b128 a[180:183], v12 offset:32896
  ds_read_b128 a[184:187], v12 offset:33792
  s_nop 1
  v_cvt_pk_bf16_f32 v68, v128, v129
  v_cvt_pk_bf16_f32 v69, v130, v131
  buffer_store_dwordx2 v[68:69], v10, s[4:7], s18 offen
  s_cmp_eq_u32 s12, 63
  s_cbranch_scc1 mega_loop2_last
  v_smfmac_f32_16x16x64_bf16 v[56:59], v[24:27], a[136:143], v9
  ds_read_b128 a[188:191], v12 offset:33920
  s_waitcnt lgkmcnt(4)
  buffer_store_dwordx4 v[112:115], v64, s[4:7], s23 offen
  v_smfmac_f32_16x16x64_bf16 v[52:55], v[72:75], a[0:7], v9
  buffer_store_dwordx2 v[116:117], v65, s[4:7], s23 offen
  v_smfmac_f32_16x16x64_bf16 v[56:59], v[72:75], a[80:87], v9
  buffer_store_dwordx2 v[132:133], v10, s[4:7], s19 offen
  v_smfmac_f32_16x16x64_bf16 v[52:55], v[76:79], a[8:15], v9
  v_smfmac_f32_16x16x64_bf16 v[56:59], v[76:79], a[88:95], v9
  v_smfmac_f32_16x16x64_bf16 v[52:55], v[80:83], a[16:23], v9
  v_smfmac_f32_16x16x64_bf16 v[56:59], v[80:83], a[96:103], v9
  v_smfmac_f32_16x16x64_bf16 v[52:55], v[84:87], a[24:31], v9
  v_smfmac_f32_16x16x64_bf16 v[56:59], v[84:87], a[104:111], v9
  v_smfmac_f32_16x16x64_bf16 v[52:55], v[88:91], a[32:39], v9
  v_smfmac_f32_16x16x64_bf16 v[56:59], v[88:91], a[112:119], v9
  buffer_load_dwordx4 v[16:19], v4, s[4:7], s20 offen sc1
  v_smfmac_f32_16x16x64_bf16 v[52:55], v[92:95], a[64:71], v9
  buffer_load_dwordx4 v[20:23], v4, s[4:7], s20 offen offset:256 sc1
  v_smfmac_f32_16x16x64_bf16 v[56:59], v[92:95], a[144:151], v9
  buffer_load_dwordx4 v[24:27], v5, s[4:7], s20 offen offset:512 sc1
  v_smfmac_f32_16x16x64_bf16 v[52:55], v[96:99], a[72:79], v9
  v_smfmac_f32_16x16x64_bf16 v[56:59], v[96:99], a[152:159], v9
  s_nop 4
  v_add_f32 v52, v52, v54
  v_add_f32 v53, v53, v55
  v_cvt_pk_bf16_f32 v52, v52, v53
  ds_write_b32 v8, v52 offset:21504
  v_add_f32 v56, v56, v58
  v_add_f32 v57, v57, v59
  v_cvt_pk_bf16_f32 v56, v56, v57
  ds_write_b32 v8, v56 offset:22528
mega_loop2_pa:
  buffer_load_dwordx4 v[16:19], v4, s[4:7], s20 offen sc1
  buffer_load_dwordx4 v[20:23], v4, s[4:7], s20 offen offset:256 sc1
  buffer_load_dwordx4 v[24:27], v5, s[4:7], s20 offen offset:512 sc1
  s_add_u32 s15, s15, 16384
  s_cbranch_scc1 mega_fail
  s_waitcnt vmcnt(3)
  v_max3_u32 v14, v16, v17, v18
  v_max3_u32 v14, v14, v19, v20
  v_mfma_f32_16x16x32_bf16 v[40:43], v[16:19], a[160:163], 0
  v_max3_u32 v14, v14, v21, v22
  v_max3_u32 v14, v14, v23, v24
  v_mfma_f32_16x16x32_bf16 v[40:43], v[20:23], a[164:167], v[40:43]
  v_max3_u32 v14, v14, v25, v26
  v_max_u32 v14, v14, v27
  v_mfma_f32_16x16x32_bf16 v[44:47], v[24:27], a[168:171], 0
  v_cmp_eq_u32 vcc, -1, v14
  s_nop 3
  v_max3_f32 v48, v40, v41, v42
  s_cbranch_vccnz mega_loop2_pa
  s_nop 0
  v_cndmask_b32 v44, v44, v45, s[42:43]
  v_max3_f32 v48, v48, v43, v44
  s_nop 1
  v_max_f32_dpp v48, v48, v48 quad_perm:[1,0,3,2] row_mask:0xf bank_mask:0xf
  s_nop 1
  v_max_f32_dpp v48, v48, v48 quad_perm:[2,3,0,1] row_mask:0xf bank_mask:0xf
  s_nop 1
  v_max_f32_dpp v48, v48, v48 row_half_mirror row_mask:0xf bank_mask:0xf
  v_mul_f32 v48, v0, v48
  v_pk_fma_f32 v[40:41], v[40:41], v[0:1], v[48:49] op_sel_hi:[1,0,0] neg_lo:[0,1,0] neg_hi:[0,1,0]
  v_pk_fma_f32 v[42:43], v[42:43], v[0:1], v[48:49] op_sel_hi:[1,0,0] neg_lo:[0,1,0] neg_hi:[0,1,0]
  v_fma_f32 v44, v44, -v0, v48
  v_exp_f32 v40, v40
  v_exp_f32 v41, v41
  v_exp_f32 v42, v42
  v_exp_f32 v43, v43
  v_exp_f32 v44, v44
  v_pk_add_f32 v[48:49], v[40:41], v[42:43]
  v_add_f32 v48, v48, v49
  v_add_f32 v48, v48, v44
  s_nop 1
  v_add_f32_dpp v48, v48, v48 quad_perm:[1,0,3,2] row_mask:0xf bank_mask:0xf
  s_nop 1
  v_add_f32_dpp v48, v48, v48 quad_perm:[2,3,0,1] row_mask:0xf bank_mask:0xf
  s_nop 1
  v_add_f32_dpp v48, v48, v48 row_half_mirror row_mask:0xf bank_mask:0xf
  v_rcp_f32 v48, v48
  s_nop 0
  v_pk_mul_f32 v[40:41], v[40:41], v[48:49] op_sel_hi:[1,0]
  v_pk_mul_f32 v[42:43], v[42:43], v[48:49] op_sel_hi:[1,0]
  v_mul_f32 v44, v44, v48
  v_cvt_pk_bf16_f32 v40, v40, v41
  v_cvt_pk_bf16_f32 v41, v42, v43
  ds_write_b64 v6, v[40:41] offset:16384
  v_cvt_pk_bf16_f32 v44, v44, v44
  ds_write_b16 v7, v44 offset:20480
  s_add_u32 s27, s12, 1
  v_mov_b32 v14, s27
  buffer_store_dword v14, v67, s[4:7], s77 offen offset:0
  s_waitcnt lgkmcnt(0)
  s_barrier
  ds_read_b128 v[72:75], v12 offset:16384
  ds_read_b128 v[76:79], v12 offset:17408
  ds_read_b128 v[80:83], v12 offset:18432
  ds_read_b128 v[84:87], v12 offset:19456
  ds_read_b128 v[88:91], v12 offset:20480
  ds_read_b128 v[92:95], v13 offset:21504
  s_waitcnt lgkmcnt(5)
  v_mfma_f32_16x16x32_bf16 v[128:131], a[176:179], v[72:75], 0
  s_waitcnt lgkmcnt(4)
  v_mfma_f32_16x16x32_bf16 v[128:131], a[180:183], v[76:79], v[128:131]
  s_waitcnt lgkmcnt(3)
  v_mfma_f32_16x16x32_bf16 v[128:131], a[184:187], v[80:83], v[128:131]
  s_waitcnt lgkmcnt(2)
  v_mfma_f32_16x16x32_bf16 v[128:131], a[188:191], v[84:87], v[128:131]
  s_waitcnt lgkmcnt(0)
  v_mfma_f32_16x16x32_bf16 v[128:131], v[92:95], v[88:91], v[128:131]
  v_mov_b32 v28, 0
  v_mov_b32 v29, 0
  v_mov_b32 v30, 0
  v_mov_b32 v31, 0
  v_mov_b32 v32, 0
  v_mov_b32 v33, 0
  v_mov_b32 v34, 0
  s_nop 0
  v_cvt_pk_bf16_f32 v68, v128, v129
  v_cvt_pk_bf16_f32 v69, v130, v131
  buffer_store_dwordx2 v[68:69], v61, s[4:7], s33 offen sc1
  buffer_store_dwordx2 v[68:69], v134, s[4:7], s33 offen sc1
  v_mov_b32 v35, 0
  v_mov_b32 v36, 0
  v_mov_b32 v37, 0
  v_mov_b32 v38, 0
  v_mov_b32 v39, 0
  v_mov_b32 v40, 0
  v_mov_b32 v41, 0
  v_mov_b32 v42, 0
  v_mov_b32 v43, 0
  v_mov_b32 v44, 0
  v_mov_b32 v45, 0
  v_mov_b32 v46, 0
  v_mov_b32 v47, 0
  v_mov_b32 v48, 0
  v_mov_b32 v49, 0
  v_mov_b32 v50, 0
  v_mov_b32 v51, 0
  v_mov_b32 v52, 0
  v_mov_b32 v53, 0
  v_mov_b32 v54, 0
  v_mov_b32 v55, 0
  v_mov_b32 v56, 0
  v_mov_b32 v57, 0
  v_mov_b32 v58, 0
  v_mov_b32 v59, 0
  s_xor_b32 s18, s18, s19
  s_xor_b32 s19, s19, s18
  s_xor_b32 s18, s18, s19
  s_xor_b32 s20, s20, s21
  s_xor_b32 s21, s21, s20
  s_xor_b32 s20, s20, s21
  s_add_u32 s72, s72, 1
  s_cmp_eq_u32 s72, 4
  s_cselect_b32 s72, 0, s72
  s_mov_b32 s73, 325632
  s_cselect_b32 s73, 0xfff11800, s73
  s_add_u32 s23, s23, s73
  s_mov_b32 s15, 0
  s_add_u32 s13, s17, 5120
  s_add_u32 s14, s17, 7168
  s_nop 15
  s_nop 15
  s_nop 15
  s_nop 15
  s_nop 15
  s_nop 15
  buffer_load_dwordx4 v[96:99], v62, s[4:7], s37 offen offset:0 sc1
  buffer_load_dwordx4 v[100:103], v62, s[4:7], s37 offen offset:512 sc1
  s_barrier
  buffer_store_dwordx4 v[92:95], v66, s[4:7], s25 offen
  s_add_u32 s25, s25, s73
  s_add_u32 s12, s12, 1
  s_waitcnt vmcnt(1)
  v_mfma_f32_16x16x32_bf16 v[128:131], a[160:163], v[96:99], 0
  v_max3_u32 v14, v96, v97, v98
  v_max3_u32 v14, v14, v99, v100
  v_mfma_f32_16x16x32_bf16 v[128:131], a[160:163], v[100:103], v[128:131]
  v_max3_u32 v14, v14, v101, v102
  v_max_u32 v14, v14, v103
  v_cmp_eq_u32 vcc, -1, v14
  s_nop 4
  v_cvt_pk_bf16_f32 v68, v128, v129
  v_cvt_pk_bf16_f32 v69, v130, v131
  s_cbranch_vccnz mega_loop2_pbf
mega_loop2_pbok:
  buffer_store_dwordx2 v[68:69], v63, s[4:7], s17 offen
  buffer_store_dwordx2 v[132:133], v63, s[4:7], s16 offen
  s_barrier
  s_nop 15
  s_nop 15
  s_branch mega_loop2
mega_loop2_pcf:
  buffer_load_dwordx4 v[16:19], v2, s[4:7], s13 offen offset:0 sc1
  buffer_load_dwordx4 v[20:23], v2, s[4:7], s13 offen offset:1024 sc1
  buffer_load_dwordx4 v[24:27], v2, s[4:7], s14 offen offset:0 sc1
  s_nop 0
  v_mov_b32 v28, 0
  v_mov_b32 v29, 0
  v_mov_b32 v30, 0
  v_mov_b32 v31, 0
  v_mov_b32 v32, 0
  v_mov_b32 v33, 0
  v_mov_b32 v34, 0
  v_mov_b32 v35, 0
  s_add_u32 s15, s15, 16384
  s_cbranch_scc1 mega_fail
  s_branch mega_loop2_pc2
mega_loop2_last:
  v_smfmac_f32_16x16x64_bf16 v[56:59], v[24:27], a[136:143], v9
  ds_read_b128 a[188:191], v12 offset:33920
  s_waitcnt lgkmcnt(4)
  buffer_store_dwordx4 v[112:115], v64, s[4:7], s23 offen
  v_smfmac_f32_16x16x64_bf16 v[52:55], v[72:75], a[0:7], v9
  buffer_store_dwordx2 v[116:117], v65, s[4:7], s23 offen
  v_smfmac_f32_16x16x64_bf16 v[56:59], v[72:75], a[80:87], v9
  buffer_store_dwordx2 v[132:133], v10, s[4:7], s19 offen
  v_smfmac_f32_16x16x64_bf16 v[52:55], v[76:79], a[8:15], v9
  v_smfmac_f32_16x16x64_bf16 v[56:59], v[76:79], a[88:95], v9
  v_smfmac_f32_16x16x64_bf16 v[52:55], v[80:83], a[16:23], v9
  v_smfmac_f32_16x16x64_bf16 v[56:59], v[80:83], a[96:103], v9
  v_smfmac_f32_16x16x64_bf16 v[52:55], v[84:87], a[24:31], v9
  v_smfmac_f32_16x16x64_bf16 v[56:59], v[84:87], a[104:111], v9
  v_smfmac_f32_16x16x64_bf16 v[52:55], v[88:91], a[32:39], v9
  v_smfmac_f32_16x16x64_bf16 v[56:59], v[88:91], a[112:119], v9
  v_smfmac_f32_16x16x64_bf16 v[52:55], v[92:95], a[64:71], v9
  v_smfmac_f32_16x16x64_bf16 v[56:59], v[92:95], a[144:151], v9
  v_smfmac_f32_16x16x64_bf16 v[52:55], v[96:99], a[72:79], v9
  v_smfmac_f32_16x16x64_bf16 v[56:59], v[96:99], a[152:159], v9
  s_nop 4
  v_add_f32 v52, v52, v54
  v_add_f32 v53, v53, v55
  v_cvt_pk_bf16_f32 v52, v52, v53
  ds_write_b32 v8, v52 offset:21504
  v_add_f32 v56, v56, v58
  v_add_f32 v57, v57, v59
  v_cvt_pk_bf16_f32 v56, v56, v57
  ds_write_b32 v8, v56 offset:22528
  s_waitcnt vmcnt(0)
  s_add_u32 s27, s12, 1
  v_mov_b32 v14, s27
  buffer_store_dword v14, v67, s[4:7], s77 offen offset:0
  s_waitcnt lgkmcnt(0)
  s_barrier
  ds_read_b128 v[92:95], v13 offset:21504
  s_waitcnt lgkmcnt(0)
  buffer_store_dwordx4 v[92:95], v66, s[4:7], s25 offen
  s_waitcnt vmcnt(0)
  s_barrier
  s_add_u32 s27, s12, 1
  v_mov_b32 v14, s27
  buffer_store_dword v14, v67, s[4:7], s77 offen offset:16
  s_cmp_lg_u32 s70, 0
  s_cbranch_scc1 mega_end
  s_lshl_b32 s73, s2, 2
  s_add_u32 s73, s73, s3
  s_branch mega_bjobs
mega_loop2_pbf:
  buffer_load_dwordx4 v[96:99], v62, s[4:7], s37 offen offset:0 sc1
  buffer_load_dwordx4 v[100:103], v62, s[4:7], s37 offen offset:512 sc1
mega_loop2_pbl:
  buffer_load_dwordx4 v[96:99], v62, s[4:7], s37 offen offset:0 sc1
  buffer_load_dwordx4 v[100:103], v62, s[4:7], s37 offen offset:512 sc1
  s_add_u32 s15, s15, 16384
  s_cbranch_scc1 mega_fail
  s_waitcnt vmcnt(2)
  v_max3_u32 v14, v96, v97, v98
  v_max3_u32 v14, v14, v99, v100
  v_mfma_f32_16x16x32_bf16 v[128:131], a[160:163], v[96:99], 0
  v_max3_u32 v14, v14, v101, v102
  v_max_u32 v14, v14, v103
  v_mfma_f32_16x16x32_bf16 v[128:131], a[160:163], v[100:103], v[128:131]
  v_cmp_eq_u32 vcc, -1, v14
  s_nop 6
  v_cvt_pk_bf16_f32 v68, v128, v129
  v_cvt_pk_bf16_f32 v69, v130, v131
  s_cbranch_vccnz mega_loop2_pbl
  s_branch mega_loop2_pbok
mega_loop3:
  buffer_load_dwordx4 v[16:19], v2, s[4:7], s13 offen offset:0 sc1
  buffer_load_dwordx4 v[20:23], v2, s[4:7], s13 offen offset:1024 sc1
  buffer_load_dwordx4 v[24:27], v2, s[4:7], s14 offen offset:0 sc1
  s_xor_b32 s16, s16, s17
  s_xor_b32 s17, s17, s16
  s_xor_b32 s16, s16, s17
  s_mov_b32 m0, 8192
  s_nop 15
  s_nop 15
  s_nop 3
  buffer_load_dwordx4 v[16:19], v2, s[4:7], s13 offen offset:0 sc1
  buffer_load_dwordx4 v[20:23], v2, s[4:7], s13 offen offset:1024 sc1
  buffer_load_dwordx4 v[24:27], v2, s[4:7], s14 offen offset:0 sc1
mega_loop3_pc2:
  s_waitcnt vmcnt(3)
  v_max3_u32 v14, v16, v17, v18
  v_max3_u32 v14, v14, v19, v20
  v_smfmac_f32_16x16x64_bf16 v[44:47], v[16:19], v[136:143], v9
  v_max3_u32 v14, v14, v21, v22
  v_max3_u32 v14, v14, v23, v24
  v_smfmac_f32_16x16x64_bf16 v[48:51], v[16:19], v[144:151], v9
  v_max3_u32 v14, v14, v25, v26
  v_max_u32 v14, v14, v27
  v_smfmac_f32_16x16x64_bf16 v[44:47], v[20:23], v[152:159], v9
  v_cmp_eq_u32 vcc, -1, v14
  v_smfmac_f32_16x16x64_bf16 v[48:51], v[20:23], v[160:167], v9
  s_cbranch_vccnz mega_loop3_pcf
  v_smfmac_f32_16x16x64_bf16 v[44:47], v[24:27], v[168:175], v9
  ds_write_b128 v2, v[16:19] offset:8192
  v_smfmac_f32_16x16x64_bf16 v[48:51], v[24:27], v[176:183], v9
  ds_write_b128 v2, v[20:23] offset:9216
  v_smfmac_f32_16x16x64_bf16 v[36:39], v[16:19], v[184:191], v9
  v_smfmac_f32_16x16x64_bf16 v[40:43], v[16:19], v[192:199], v9
  v_add_f32 v44, v44, v46
  v_smfmac_f32_16x16x64_bf16 v[36:39], v[20:23], v[200:207], v9
  v_add_f32 v45, v45, v47
  v_cvt_pk_bf16_f32 v46, v44, v45
  v_smfmac_f32_16x16x64_bf16 v[40:43], v[20:23], v[208:215], v9
  v_add_f32 v48, v48, v50
  v_smfmac_f32_16x16x64_bf16 v[40:43], v[24:27], v[216:223], v9
  v_add_f32 v49, v49, v51
  v_cvt_pk_bf16_f32 v47, v48, v49
  v_smfmac_f32_16x16x64_bf16 v[28:31], v[16:19], v[224:231], v9
  ds_write_b64 v3, v[46:47] offset:14336
  v_smfmac_f32_16x16x64_bf16 v[32:35], v[16:19], v[232:239], v9
  v_add_f32 v36, v36, v38
  v_smfmac_f32_16x16x64_bf16 v[28:31], v[20:23], v[240:247], v9
  v_add_f32 v37, v37, v39
  v_cvt_pk_bf16_f32 v38, v36, v37
  v_smfmac_f32_16x16x64_bf16 v[32:35], v[20:23], v[248:255], v9
  v_add_f32 v40, v40, v42
  v_add_f32 v41, v41, v43
  v_cvt_pk_bf16_f32 v39, v40, v41
  ds_write_b64 v3, v[38:39] offset:12288
  s_nop 0
  v_add_f32 v28, v28, v30
  v_add_f32 v29, v29, v31
  v_cvt_pk_bf16_f32 v30, v28, v29
  v_add_f32 v32, v32, v34
  v_add_f32 v33, v33, v35
  v_cvt_pk_bf16_f32 v31, v32, v33
  ds_write_b64 v3, v[30:31] offset:10240
  v_smfmac_f32_16x16x64_bf16 v[52:55], v[16:19], a[64:71], v9
  v_smfmac_f32_16x16x64_bf16 v[56:59], v[16:19], a[144:151], v9
  v_smfmac_f32_16x16x64_bf16 v[60:63], v[16:19], a[224:231], v9
  s_waitcnt lgkmcnt(0)
  s_barrier
  v_smfmac_f32_16x16x64_bf16 v[64:67], v[16:19], v[120:127], v9
  v_smfmac_f32_16x16x64_bf16 v[52:55], v[20:23], a[72:79], v9
  v_smfmac_f32_16x16x64_bf16 v[56:59], v[20:23], a[152:159], v9
  ds_read_b128 v[40:43], v2 offset:0
  v_smfmac_f32_16x16x64_bf16 v[60:63], v[20:23], a[232:239], v9
  ds_read_b128 v[28:31], v2 offset:1024
  v_smfmac_f32_16x16x64_bf16 v[64:67], v[20:23], v[128:135], v9
  ds_read_b128 v[32:35], v2 offset:2048
  v_smfmac_f32_16x16x64_bf16 v[52:55], v[24:27], a[56:63], v9
  ds_read_b128 v[36:39], v2 offset:3072
  v_smfmac_f32_16x16x64_bf16 v[56:59], v[24:27], a[136:143], v9
  ds_read_b128 v[44:47], v2 offset:4096
  v_smfmac_f32_16x16x64_bf16 v[60:63], v[24:27], a[216:223], v9
  ds_read_b128 v[48:51], v2 offset:5120
  v_smfmac_f32_16x16x64_bf16 v[64:67], v[24:27], v[112:119], v9
  s_cmp_eq_u32 s12, 63
  s_cbranch_scc1 mega_loop3_last
  s_waitcnt lgkmcnt(0)
  v_smfmac_f32_16x16x64_bf16 v[52:55], v[40:43], a[0:7], v9
  v_smfmac_f32_16x16x64_bf16 v[56:59], v[40:43], a[80:87], v9
  v_smfmac_f32_16x16x64_bf16 v[60:63], v[40:43], a[160:167], v9
  v_smfmac_f32_16x16x64_bf16 v[64:67], v[40:43], a[240:247], v9
  ds_read_b128 v[40:43], v2 offset:6144
  v_smfmac_f32_16x16x64_bf16 v[52:55], v[28:31], a[8:15], v9
  v_smfmac_f32_16x16x64_bf16 v[56:59], v[28:31], a[88:95], v9
  v_smfmac_f32_16x16x64_bf16 v[60:63], v[28:31], a[168:175], v9
  v_smfmac_f32_16x16x64_bf16 v[64:67], v[28:31], a[248:255], v9
  ds_read_b128 v[28:31], v2 offset:37888
  v_smfmac_f32_16x16x64_bf16 v[52:55], v[32:35], a[16:23], v9
  v_smfmac_f32_16x16x64_bf16 v[56:59], v[32:35], a[96:103], v9
  v_smfmac_f32_16x16x64_bf16 v[60:63], v[32:35], a[176:183], v9
  v_smfmac_f32_16x16x64_bf16 v[64:67], v[32:35], v[72:79], v9
  ds_read_b128 v[32:35], v2 offset:38912
  v_smfmac_f32_16x16x64_bf16 v[52:55], v[36:39], a[24:31], v9
  v_smfmac_f32_16x16x64_bf16 v[56:59], v[36:39], a[104:111], v9
  v_smfmac_f32_16x16x64_bf16 v[60:63], v[36:39], a[184:191], v9
  v_smfmac_f32_16x16x64_bf16 v[64:67], v[36:39], v[80:87], v9
  ds_read_b128 v[36:39], v2 offset:39936
  v_smfmac_f32_16x16x64_bf16 v[52:55], v[44:47], a[32:39], v9
  v_smfmac_f32_16x16x64_bf16 v[56:59], v[44:47], a[112:119], v9
  v_smfmac_f32_16x16x64_bf16 v[60:63], v[44:47], a[192:199], v9
  v_smfmac_f32_16x16x64_bf16 v[64:67], v[44:47], v[88:95], v9
  v_smfmac_f32_16x16x64_bf16 v[52:55], v[48:51], a[40:47], v9
  v_smfmac_f32_16x16x64_bf16 v[56:59], v[48:51], a[120:127], v9
  v_smfmac_f32_16x16x64_bf16 v[60:63], v[48:51], a[200:207], v9
  v_smfmac_f32_16x16x64_bf16 v[64:67], v[48:51], v[96:103], v9
  buffer_load_dword v13, v12, s[4:7], s71 offen sc1
  s_waitcnt lgkmcnt(3)
  v_smfmac_f32_16x16x64_bf16 v[52:55], v[40:43], a[48:55], v9
  buffer_load_dwordx4 v[16:19], v4, s[4:7], s20 offen sc1
  v_smfmac_f32_16x16x64_bf16 v[56:59], v[40:43], a[128:135], v9
  buffer_load_dwordx4 v[20:23], v4, s[4:7], s20 offen offset:256 sc1
  v_smfmac_f32_16x16x64_bf16 v[60:63], v[40:43], a[208:215], v9
  buffer_load_dwordx4 v[24:27], v5, s[4:7], s20 offen offset:512 sc1
  v_smfmac_f32_16x16x64_bf16 v[64:67], v[40:43], v[104:111], v9
  v_add_f32 v52, v52, v54
  v_add_f32 v53, v53, v55
  v_cvt_pk_bf16_f32 v52, v52, v53
  ds_write_b32 v8, v52 offset:21504
  v_add_f32 v56, v56, v58
  v_add_f32 v57, v57, v59
  v_cvt_pk_bf16_f32 v56, v56, v57
  ds_write_b32 v8, v56 offset:22528
  v_add_f32 v60, v60, v62
  v_add_f32 v61, v61, v63
  v_cvt_pk_bf16_f32 v60, v60, v61
  ds_write_b32 v10, v60 offset:23552
  v_add_f32 v64, v64, v66
  v_add_f32 v65, v65, v67
  v_cvt_pk_bf16_f32 v64, v64, v65
  ds_write_b32 v10, v64 offset:24064
mega_loop3_pa:
  buffer_load_dwordx4 v[16:19], v4, s[4:7], s20 offen sc1
  buffer_load_dwordx4 v[20:23], v4, s[4:7], s20 offen offset:256 sc1
  buffer_load_dwordx4 v[24:27], v5, s[4:7], s20 offen offset:512 sc1
  s_add_u32 s15, s15, 16384
  s_cbranch_scc1 mega_fail
  s_waitcnt vmcnt(3) lgkmcnt(0)
  v_max3_u32 v14, v16, v17, v18
  v_max3_u32 v14, v14, v19, v20
  v_mfma_f32_16x16x32_bf16 v[40:43], v[16:19], v[28:31], 0
  v_max3_u32 v14, v14, v21, v22
  v_max3_u32 v14, v14, v23, v24
  v_mfma_f32_16x16x32_bf16 v[40:43], v[20:23], v[32:35], v[40:43]
  v_max3_u32 v14, v14, v25, v26
  v_max_u32 v14, v14, v27
  v_mfma_f32_16x16x32_bf16 v[44:47], v[24:27], v[36:39], 0
  v_cmp_eq_u32 vcc, -1, v14
  s_nop 3
  v_max3_f32 v48, v40, v41, v42
  s_cbranch_vccnz mega_loop3_pa
  s_nop 0
  v_cndmask_b32 v44, v44, v45, s[42:43]
  v_max3_f32 v48, v48, v43, v44
  s_nop 1
  v_max_f32_dpp v48, v48, v48 quad_perm:[1,0,3,2] row_mask:0xf bank_mask:0xf
  s_nop 1
  v_max_f32_dpp v48, v48, v48 quad_perm:[2,3,0,1] row_mask:0xf bank_mask:0xf
  s_nop 1
  v_max_f32_dpp v48, v48, v48 row_half_mirror row_mask:0xf bank_mask:0xf
  v_mul_f32 v48, v0, v48
  v_pk_fma_f32 v[40:41], v[40:41], v[0:1], v[48:49] op_sel_hi:[1,0,0] neg_lo:[0,1,0] neg_hi:[0,1,0]
  v_pk_fma_f32 v[42:43], v[42:43], v[0:1], v[48:49] op_sel_hi:[1,0,0] neg_lo:[0,1,0] neg_hi:[0,1,0]
  v_fma_f32 v44, v44, -v0, v48
  v_exp_f32 v40, v40
  v_exp_f32 v41, v41
  v_exp_f32 v42, v42
  v_exp_f32 v43, v43
  v_exp_f32 v44, v44
  v_pk_add_f32 v[48:49], v[40:41], v[42:43]
  v_add_f32 v48, v48, v49
  v_add_f32 v48, v48, v44
  s_nop 1
  v_add_f32_dpp v48, v48, v48 quad_perm:[1,0,3,2] row_mask:0xf bank_mask:0xf
  s_nop 1
  v_add_f32_dpp v48, v48, v48 quad_perm:[2,3,0,1] row_mask:0xf bank_mask:0xf
  s_nop 1
  v_add_f32_dpp v48, v48, v48 row_half_mirror row_mask:0xf bank_mask:0xf
  v_rcp_f32 v48, v48
  s_nop 0
  v_pk_mul_f32 v[40:41], v[40:41], v[48:49] op_sel_hi:[1,0]
  v_pk_mul_f32 v[42:43], v[42:43], v[48:49] op_sel_hi:[1,0]
  v_mul_f32 v44, v44, v48
  v_cvt_pk_bf16_f32 v40, v40, v41
  v_cvt_pk_bf16_f32 v41, v42, v43
  ds_write_b64 v6, v[40:41] offset:16384
  v_cvt_pk_bf16_f32 v44, v44, v44
  ds_write_b16 v7, v44 offset:20480
  v_min_u32_dpp v13, v13, v13 quad_perm:[1,0,3,2] row_mask:0xf bank_mask:0xf
  s_nop 1
  v_min_u32_dpp v13, v13, v13 quad_perm:[2,3,0,1] row_mask:0xf bank_mask:0xf
  s_nop 1
  v_min_u32_dpp v13, v13, v13 row_half_mirror row_mask:0xf bank_mask:0xf
  s_nop 0
  v_readfirstlane_b32 s76, v13
  s_waitcnt lgkmcnt(0)
  s_barrier
  v_mov_b32 v28, 0
  v_mov_b32 v29, 0
  v_mov_b32 v30, 0
  v_mov_b32 v31, 0
  v_mov_b32 v32, 0
  v_mov_b32 v33, 0
  v_mov_b32 v34, 0
  v_mov_b32 v35, 0
  v_mov_b32 v36, 0
  v_mov_b32 v37, 0
  v_mov_b32 v38, 0
  v_mov_b32 v39, 0
  v_mov_b32 v40, 0
  v_mov_b32 v41, 0
  v_mov_b32 v42, 0
  v_mov_b32 v43, 0
  v_mov_b32 v44, 0
  v_mov_b32 v45, 0
  v_mov_b32 v46, 0
  v_mov_b32 v47, 0
  v_mov_b32 v48, 0
  v_mov_b32 v49, 0
  v_mov_b32 v50, 0
  v_mov_b32 v51, 0
  v_mov_b32 v52, 0
  v_mov_b32 v53, 0
  v_mov_b32 v54, 0
  v_mov_b32 v55, 0
  v_mov_b32 v56, 0
  v_mov_b32 v57, 0
  v_mov_b32 v58, 0
  v_mov_b32 v59, 0
  v_mov_b32 v60, 0
  v_mov_b32 v61, 0
  v_mov_b32 v62, 0
  v_mov_b32 v63, 0
  v_mov_b32 v64, 0
  v_mov_b32 v65, 0
  v_mov_b32 v66, 0
  v_mov_b32 v67, 0
  s_xor_b32 s18, s18, s19
  s_xor_b32 s19, s19, s18
  s_xor_b32 s18, s18, s19
  s_xor_b32 s20, s20, s21
  s_xor_b32 s21, s21, s20
  s_xor_b32 s20, s20, s21
  s_mov_b32 s15, 0
  s_add_u32 s13, s17, 8192
  s_add_u32 s14, s17, 7168
  s_barrier
  s_add_u32 s29, s12, 2
  s_cmp_lt_u32 s76, s29
  s_cbranch_scc1 mega0_kernel_sd25_wait
mega0_kernel_sd25_go:
  s_mov_b32 m0, 24576
  s_add_u32 s27, s24, 0
  buffer_load_dwordx4 v11, s[4:7], s27 offen offset:0 sc1 lds
  buffer_load_dwordx4 v11, s[4:7], s27 offen offset:1024 sc1 lds
  s_mov_b32 m0, 32768
  s_nop 0
  buffer_load_dwordx4 v68, s[4:7], s27 offen sc1 lds
  s_mov_b32 m0, 26624
  s_add_u32 s27, s24, 40960
  buffer_load_dwordx4 v11, s[4:7], s27 offen offset:0 sc1 lds
  buffer_load_dwordx4 v11, s[4:7], s27 offen offset:1024 sc1 lds
  s_mov_b32 m0, 28672
  s_add_u32 s27, s24, 81920
  buffer_load_dwordx4 v11, s[4:7], s27 offen offset:0 sc1 lds
  buffer_load_dwordx4 v11, s[4:7], s27 offen offset:1024 sc1 lds
  s_mov_b32 m0, 33792
  s_nop 0
  buffer_load_dwordx4 v68, s[4:7], s27 offen sc1 lds
  s_mov_b32 m0, 30720
  s_add_u32 s27, s24, 122880
  buffer_load_dwordx4 v11, s[4:7], s27 offen offset:0 sc1 lds
  buffer_load_dwordx4 v11, s[4:7], s27 offen offset:1024 sc1 lds
  s_mov_b32 m0, 34816
  s_add_u32 s27, s22, 0
  buffer_load_dwordx4 v2, s[4:7], s27 offen offset:0 sc1 lds
  s_add_u32 s27, s22, 3072
  buffer_load_dwordx4 v2, s[4:7], s27 offen offset:1024 sc1 lds
  s_add_u32 s27, s22, 6144
  buffer_load_dwordx4 v2, s[4:7], s27 offen offset:2048 sc1 lds
  s_add_u32 s72, s72, 1
  s_cmp_eq_u32 s72, 4
  s_cselect_b32 s72, 0, s72
  s_mov_b32 s73, 325632
  s_cselect_b32 s73, 0xfff11800, s73
  s_add_u32 s22, s22, s73
  s_add_u32 s24, s24, s73
  s_add_u32 s12, s12, 1
  s_barrier
  s_nop 15
  s_nop 15
  s_branch mega_loop3
mega_loop3_pcf:
  buffer_load_dwordx4 v[16:19], v2, s[4:7], s13 offen offset:0 sc1
  buffer_load_dwordx4 v[20:23], v2, s[4:7], s13 offen offset:1024 sc1
  buffer_load_dwordx4 v[24:27], v2, s[4:7], s14 offen offset:0 sc1
  s_nop 0
  v_mov_b32 v44, 0
  v_mov_b32 v45, 0
  v_mov_b32 v46, 0
  v_mov_b32 v47, 0
  v_mov_b32 v48, 0
  v_mov_b32 v49, 0
  v_mov_b32 v50, 0
  v_mov_b32 v51, 0
  s_add_u32 s15, s15, 16384
  s_cbranch_scc1 mega_fail
  s_branch mega_loop3_pc2
mega_loop3_last:
  s_waitcnt lgkmcnt(0)
  v_smfmac_f32_16x16x64_bf16 v[52:55], v[40:43], a[0:7], v9
  v_smfmac_f32_16x16x64_bf16 v[56:59], v[40:43], a[80:87], v9
  v_smfmac_f32_16x16x64_bf16 v[60:63], v[40:43], a[160:167], v9
  v_smfmac_f32_16x16x64_bf16 v[64:67], v[40:43], a[240:247], v9
  ds_read_b128 v[40:43], v2 offset:6144
  v_smfmac_f32_16x16x64_bf16 v[52:55], v[28:31], a[8:15], v9
  v_smfmac_f32_16x16x64_bf16 v[56:59], v[28:31], a[88:95], v9
  v_smfmac_f32_16x16x64_bf16 v[60:63], v[28:31], a[168:175], v9
  v_smfmac_f32_16x16x64_bf16 v[64:67], v[28:31], a[248:255], v9
  ds_read_b128 v[28:31], v2 offset:37888
  v_smfmac_f32_16x16x64_bf16 v[52:55], v[32:35], a[16:23], v9
  v_smfmac_f32_16x16x64_bf16 v[56:59], v[32:35], a[96:103], v9
  v_smfmac_f32_16x16x64_bf16 v[60:63], v[32:35], a[176:183], v9
  v_smfmac_f32_16x16x64_bf16 v[64:67], v[32:35], v[72:79], v9
  ds_read_b128 v[32:35], v2 offset:38912
  v_smfmac_f32_16x16x64_bf16 v[52:55], v[36:39], a[24:31], v9
  v_smfmac_f32_16x16x64_bf16 v[56:59], v[36:39], a[104:111], v9
  v_smfmac_f32_16x16x64_bf16 v[60:63], v[36:39], a[184:191], v9
  v_smfmac_f32_16x16x64_bf16 v[64:67], v[36:39], v[80:87], v9
  ds_read_b128 v[36:39], v2 offset:39936
  v_smfmac_f32_16x16x64_bf16 v[52:55], v[44:47], a[32:39], v9
  v_smfmac_f32_16x16x64_bf16 v[56:59], v[44:47], a[112:119], v9
  v_smfmac_f32_16x16x64_bf16 v[60:63], v[44:47], a[192:199], v9
  v_smfmac_f32_16x16x64_bf16 v[64:67], v[44:47], v[88:95], v9
  v_smfmac_f32_16x16x64_bf16 v[52:55], v[48:51], a[40:47], v9
  v_smfmac_f32_16x16x64_bf16 v[56:59], v[48:51], a[120:127], v9
  v_smfmac_f32_16x16x64_bf16 v[60:63], v[48:51], a[200:207], v9
  v_smfmac_f32_16x16x64_bf16 v[64:67], v[48:51], v[96:103], v9
  s_waitcnt lgkmcnt(3)
  v_smfmac_f32_16x16x64_bf16 v[52:55], v[40:43], a[48:55], v9
  v_smfmac_f32_16x16x64_bf16 v[56:59], v[40:43], a[128:135], v9
  v_smfmac_f32_16x16x64_bf16 v[60:63], v[40:43], a[208:215], v9
  v_smfmac_f32_16x16x64_bf16 v[64:67], v[40:43], v[104:111], v9
  v_add_f32 v52, v52, v54
  v_add_f32 v53, v53, v55
  v_cvt_pk_bf16_f32 v52, v52, v53
  ds_write_b32 v8, v52 offset:21504
  v_add_f32 v56, v56, v58
  v_add_f32 v57, v57, v59
  v_cvt_pk_bf16_f32 v56, v56, v57
  ds_write_b32 v8, v56 offset:22528
  v_add_f32 v60, v60, v62
  v_add_f32 v61, v61, v63
  v_cvt_pk_bf16_f32 v60, v60, v61
  ds_write_b32 v10, v60 offset:23552
  v_add_f32 v64, v64, v66
  v_add_f32 v65, v65, v67
  v_cvt_pk_bf16_f32 v64, v64, v65
  ds_write_b32 v10, v64 offset:24064
  s_waitcnt lgkmcnt(0)
  s_barrier
  s_barrier
  s_cmp_lg_u32 s70, 0
  s_cbranch_scc1 mega_end
  s_lshl_b32 s73, s2, 2
  s_add_u32 s73, s73, s3
  s_branch mega_bjobs
mega0_kernel_sd25_wait:
  s_mov_b32 s15, 0
mega0_kernel_sd25_w2:
  buffer_load_dword v13, v12, s[4:7], s71 offen sc1
  s_waitcnt vmcnt(0)
  v_min_u32_dpp v13, v13, v13 quad_perm:[1,0,3,2] row_mask:0xf bank_mask:0xf
  s_nop 1
  v_min_u32_dpp v13, v13, v13 quad_perm:[2,3,0,1] row_mask:0xf bank_mask:0xf
  s_nop 1
  v_min_u32_dpp v13, v13, v13 row_half_mirror row_mask:0xf bank_mask:0xf
  s_nop 0
  v_readfirstlane_b32 s76, v13
  s_nop 0
  s_cmp_ge_u32 s76, s29
  s_cbranch_scc1 mega0_kernel_sd25_go
  s_sleep 1
  s_add_u32 s15, s15, 1
  s_cmp_lt_u32 s15, 262144
  s_cbranch_scc1 mega0_kernel_sd25_w2
  s_branch mega_fail
mega_loop4:
  buffer_load_dwordx4 v[16:19], v2, s[4:7], s13 offen offset:0 sc1
  buffer_load_dwordx4 v[20:23], v2, s[4:7], s13 offen offset:1024 sc1
  buffer_load_dwordx4 v[24:27], v2, s[4:7], s14 offen offset:0 sc1
  s_xor_b32 s16, s16, s17
  s_xor_b32 s17, s17, s16
  s_xor_b32 s16, s16, s17
  s_mov_b32 m0, 0
  s_add_u32 s39, s39, 1
  s_and_b32 s27, s39, 7
  s_mul_i32 s27, s27, 163840
  s_add_u32 s37, s32, s27
  s_add_u32 s33, s30, s27
  s_nop 15
  s_nop 14
  buffer_load_dwordx4 v[16:19], v2, s[4:7], s13 offen offset:0 sc1
  buffer_load_dwordx4 v[20:23], v2, s[4:7], s13 offen offset:1024 sc1
  buffer_load_dwordx4 v[24:27], v2, s[4:7], s14 offen offset:0 sc1
mega_loop4_pc2:
  s_waitcnt vmcnt(3)
  v_max3_u32 v14, v16, v17, v18
  v_max3_u32 v14, v14, v19, v20
  v_smfmac_f32_16x16x64_bf16 v[28:31], v[16:19], v[136:143], v9
  v_max3_u32 v14, v14, v21, v22
  v_max3_u32 v14, v14, v23, v24
  v_smfmac_f32_16x16x64_bf16 v[32:35], v[16:19], v[144:151], v9
  v_max3_u32 v14, v14, v25, v26
  v_max_u32 v14, v14, v27
  v_smfmac_f32_16x16x64_bf16 v[28:31], v[20:23], v[152:159], v9
  v_cmp_eq_u32 vcc, -1, v14
  v_smfmac_f32_16x16x64_bf16 v[32:35], v[20:23], v[160:167], v9
  s_cbranch_vccnz mega_loop4_pcf
  v_smfmac_f32_16x16x64_bf16 v[28:31], v[24:27], v[168:175], v9
  ds_write_b128 v2, v[16:19] offset:0
  v_smfmac_f32_16x16x64_bf16 v[32:35], v[24:27], v[176:183], v9
  ds_write_b128 v2, v[20:23] offset:1024
  v_smfmac_f32_16x16x64_bf16 v[36:39], v[16:19], v[184:191], v9
  ds_write_b128 v2, v[24:27] offset:2048
  v_smfmac_f32_16x16x64_bf16 v[40:43], v[16:19], v[192:199], v9
  v_add_f32 v28, v28, v30
  v_smfmac_f32_16x16x64_bf16 v[36:39], v[20:23], v[200:207], v9
  v_add_f32 v29, v29, v31
  v_cvt_pk_bf16_f32 v30, v28, v29
  v_smfmac_f32_16x16x64_bf16 v[40:43], v[20:23], v[208:215], v9
  v_add_f32 v32, v32, v34
  v_smfmac_f32_16x16x64_bf16 v[36:39], v[24:27], v[216:223], v9
  v_add_f32 v33, v33, v35
  v_cvt_pk_bf16_f32 v31, v32, v33
  v_smfmac_f32_16x16x64_bf16 v[44:47], v[16:19], v[224:231], v9
  ds_write_b64 v3, v[30:31] offset:10240
  v_smfmac_f32_16x16x64_bf16 v[48:51], v[16:19], v[232:239], v9
  s_nop 0
  v_add_f32 v36, v36, v38
  v_smfmac_f32_16x16x64_bf16 v[44:47], v[20:23], v[240:247], v9
  v_add_f32 v37, v37, v39
  v_cvt_pk_bf16_f32 v38, v36, v37
  v_smfmac_f32_16x16x64_bf16 v[48:51], v[20:23], v[248:255], v9
  v_add_f32 v40, v40, v42
  v_add_f32 v41, v41, v43
  v_cvt_pk_bf16_f32 v39, v40, v41
  ds_write_b64 v3, v[38:39] offset:12288
  s_nop 0
  v_add_f32 v44, v44, v46
  v_add_f32 v45, v45, v47
  v_cvt_pk_bf16_f32 v46, v44, v45
  v_add_f32 v48, v48, v50
  v_add_f32 v49, v49, v51
  v_cvt_pk_bf16_f32 v47, v48, v49
  ds_write_b64 v3, v[46:47] offset:14336
  v_smfmac_f32_16x16x64_bf16 v[52:55], v[16:19], a[0:7], v9
  v_smfmac_f32_16x16x64_bf16 v[56:59], v[16:19], a[80:87], v9
  v_smfmac_f32_16x16x64_bf16 v[52:55], v[20:23], a[8:15], v9
  s_waitcnt lgkmcnt(0)
  s_barrier
  ds_read_b128 v[28:31], v2 offset:10240
  ds_read_b128 v[32:35], v2 offset:11264
  ds_read_b128 v[36:39], v2 offset:12288
  ds_read_b128 v[40:43], v2 offset:13312
  ds_read_b128 v[44:47], v2 offset:14336
  ds_read_b128 v[48:51], v2 offset:15360
  ds_read_b128 v[120:123], v11 offset:34816
  ds_read_b64 v[124:125], v11 offset:36864
  v_smfmac_f32_16x16x64_bf16 v[56:59], v[20:23], a[88:95], v9
  s_waitcnt lgkmcnt(7)
  v_mfma_f32_16x16x32_bf16 v[100:103], v[28:31], a[172:175], 0
  ds_read_b128 v[72:75], v2 offset:3072
  s_waitcnt lgkmcnt(7)
  v_mfma_f32_16x16x32_bf16 v[100:103], v[32:35], a[172:175], v[100:103]
  ds_read_b128 v[76:79], v2 offset:4096
  s_waitcnt lgkmcnt(7)
  v_mfma_f32_16x16x32_bf16 v[104:107], v[36:39], a[172:175], 0
  ds_read_b128 v[80:83], v2 offset:5120
  s_waitcnt lgkmcnt(7)
  v_mfma_f32_16x16x32_bf16 v[104:107], v[40:43], a[172:175], v[104:107]
  ds_read_b128 v[84:87], v2 offset:6144
  s_waitcnt lgkmcnt(7)
  v_mfma_f32_16x16x32_bf16 v[108:111], v[44:47], a[172:175], 0
  v_cvt_pk_bf16_f32 v112, v100, v101
  v_cvt_pk_bf16_f32 v113, v102, v103
  s_waitcnt lgkmcnt(6)
  v_mfma_f32_16x16x32_bf16 v[108:111], v[48:51], a[172:175], v[108:111]
  s_nop 0
  v_cvt_pk_bf16_f32 v114, v104, v105
  v_cvt_pk_bf16_f32 v115, v106, v107
  s_waitcnt lgkmcnt(4)
  ds_read_b128 v[88:91], v2 offset:7168
  v_mfma_f32_16x16x32_bf16 v[128:131], v[120:123], v[112:115], 0
  ds_read_b128 v[92:95], v2 offset:8192
  ds_read_b128 v[96:99], v2 offset:9216
  v_cvt_pk_bf16_f32 v116, v108, v109
  v_cvt_pk_bf16_f32 v117, v110, v111
  s_nop 1
  v_mfma_f32_16x16x32_bf16 v[128:131], v[124:127], v[116:119], v[128:131]
  v_smfmac_f32_16x16x64_bf16 v[52:55], v[24:27], a[16:23], v9
  ds_read_b128 a[176:179], v2 offset:24576
  ds_read_b128 a[180:183], v2 offset:26624
  ds_read_b128 a[184:187], v2 offset:28672
  s_nop 1
  v_cvt_pk_bf16_f32 v68, v128, v129
  v_cvt_pk_bf16_f32 v69, v130, v131
  buffer_store_dwordx2 v[68:69], v10, s[4:7], s18 offen sc1
  s_cmp_eq_u32 s12, 63
  s_cbranch_scc1 mega_loop4_last
  v_smfmac_f32_16x16x64_bf16 v[56:59], v[24:27], a[96:103], v9
  ds_read_b128 a[188:191], v2 offset:30720
  s_waitcnt lgkmcnt(4)
  buffer_store_dwordx2 v[132:133], v10, s[4:7], s19 offen sc1
  v_smfmac_f32_16x16x64_bf16 v[52:55], v[72:75], a[24:31], v9
  v_smfmac_f32_16x16x64_bf16 v[56:59], v[72:75], a[104:111], v9
  v_smfmac_f32_16x16x64_bf16 v[52:55], v[76:79], a[32:39], v9
  v_smfmac_f32_16x16x64_bf16 v[56:59], v[76:79], a[112:119], v9
  v_smfmac_f32_16x16x64_bf16 v[52:55], v[80:83], a[40:47], v9
  v_smfmac_f32_16x16x64_bf16 v[56:59], v[80:83], a[120:127], v9
  v_smfmac_f32_16x16x64_bf16 v[52:55], v[84:87], a[48:55], v9
  v_smfmac_f32_16x16x64_bf16 v[56:59], v[84:87], a[128:135], v9
  v_smfmac_f32_16x16x64_bf16 v[52:55], v[88:91], a[56:63], v9
  v_smfmac_f32_16x16x64_bf16 v[56:59], v[88:91], a[136:143], v9
  buffer_load_dwordx4 v[16:19], v4, s[4:7], s20 offen sc1
  v_smfmac_f32_16x16x64_bf16 v[52:55], v[92:95], a[64:71], v9
  buffer_load_dwordx4 v[20:23], v4, s[4:7], s20 offen offset:256 sc1
  v_smfmac_f32_16x16x64_bf16 v[56:59], v[92:95], a[144:151], v9
  buffer_load_dwordx4 v[24:27], v5, s[4:7], s20 offen offset:512 sc1
  v_smfmac_f32_16x16x64_bf16 v[52:55], v[96:99], a[72:79], v9
  v_smfmac_f32_16x16x64_bf16 v[56:59], v[96:99], a[152:159], v9
  s_nop 4
  v_add_f32 v52, v52, v54
  v_add_f32 v53, v53, v55
  v_cvt_pk_bf16_f32 v52, v52, v53
  ds_write_b32 v8, v52 offset:21504
  v_add_f32 v56, v56, v58
  v_add_f32 v57, v57, v59
  v_cvt_pk_bf16_f32 v56, v56, v57
  ds_write_b32 v8, v56 offset:22528
mega_loop4_pa:
  buffer_load_dwordx4 v[16:19], v4, s[4:7], s20 offen sc1
  buffer_load_dwordx4 v[20:23], v4, s[4:7], s20 offen offset:256 sc1
  buffer_load_dwordx4 v[24:27], v5, s[4:7], s20 offen offset:512 sc1
  s_add_u32 s15, s15, 16384
  s_cbranch_scc1 mega_fail
  s_waitcnt vmcnt(3)
  v_max3_u32 v14, v16, v17, v18
  v_max3_u32 v14, v14, v19, v20
  v_mfma_f32_16x16x32_bf16 v[40:43], v[16:19], a[160:163], 0
  v_max3_u32 v14, v14, v21, v22
  v_max3_u32 v14, v14, v23, v24
  v_mfma_f32_16x16x32_bf16 v[40:43], v[20:23], a[164:167], v[40:43]
  v_max3_u32 v14, v14, v25, v26
  v_max_u32 v14, v14, v27
  v_mfma_f32_16x16x32_bf16 v[44:47], v[24:27], a[168:171], 0
  v_cmp_eq_u32 vcc, -1, v14
  s_nop 3
  v_max3_f32 v48, v40, v41, v42
  s_cbranch_vccnz mega_loop4_pa
  s_nop 0
  v_cndmask_b32 v44, v44, v45, s[42:43]
  v_max3_f32 v48, v48, v43, v44
  s_nop 1
  v_max_f32_dpp v48, v48, v48 quad_perm:[1,0,3,2] row_mask:0xf bank_mask:0xf
  s_nop 1
  v_max_f32_dpp v48, v48, v48 quad_perm:[2,3,0,1] row_mask:0xf bank_mask:0xf
  s_nop 1
  v_max_f32_dpp v48, v48, v48 row_half_mirror row_mask:0xf bank_mask:0xf
  v_mul_f32 v48, v0, v48
  v_pk_fma_f32 v[40:41], v[40:41], v[0:1], v[48:49] op_sel_hi:[1,0,0] neg_lo:[0,1,0] neg_hi:[0,1,0]
  v_pk_fma_f32 v[42:43], v[42:43], v[0:1], v[48:49] op_sel_hi:[1,0,0] neg_lo:[0,1,0] neg_hi:[0,1,0]
  v_fma_f32 v44, v44, -v0, v48
  v_exp_f32 v40, v40
  v_exp_f32 v41, v41
  v_exp_f32 v42, v42
  v_exp_f32 v43, v43
  v_exp_f32 v44, v44
  v_pk_add_f32 v[48:49], v[40:41], v[42:43]
  v_add_f32 v48, v48, v49
  v_add_f32 v48, v48, v44
  s_nop 1
  v_add_f32_dpp v48, v48, v48 quad_perm:[1,0,3,2] row_mask:0xf bank_mask:0xf
  s_nop 1
  v_add_f32_dpp v48, v48, v48 quad_perm:[2,3,0,1] row_mask:0xf bank_mask:0xf
  s_nop 1
  v_add_f32_dpp v48, v48, v48 row_half_mirror row_mask:0xf bank_mask:0xf
  v_rcp_f32 v48, v48
  s_nop 0
  v_pk_mul_f32 v[40:41], v[40:41], v[48:49] op_sel_hi:[1,0]
  v_pk_mul_f32 v[42:43], v[42:43], v[48:49] op_sel_hi:[1,0]
  v_mul_f32 v44, v44, v48
  v_cvt_pk_bf16_f32 v40, v40, v41
  v_cvt_pk_bf16_f32 v41, v42, v43
  ds_write_b64 v6, v[40:41] offset:16384
  v_cvt_pk_bf16_f32 v44, v44, v44
  ds_write_b16 v7, v44 offset:20480
  s_waitcnt lgkmcnt(0)
  s_barrier
  ds_read_b128 v[72:75], v12 offset:16384
  ds_read_b128 v[76:79], v12 offset:17408
  ds_read_b128 v[80:83], v12 offset:18432
  ds_read_b128 v[84:87], v12 offset:19456
  ds_read_b128 v[88:91], v12 offset:20480
  ds_read_b128 v[92:95], v13 offset:21504
  s_waitcnt lgkmcnt(5)
  v_mfma_f32_16x16x32_bf16 v[128:131], a[176:179], v[72:75], 0
  s_waitcnt lgkmcnt(4)
  v_mfma_f32_16x16x32_bf16 v[128:131], a[180:183], v[76:79], v[128:131]
  s_waitcnt lgkmcnt(3)
  v_mfma_f32_16x16x32_bf16 v[128:131], a[184:187], v[80:83], v[128:131]
  s_waitcnt lgkmcnt(2)
  v_mfma_f32_16x16x32_bf16 v[128:131], a[188:191], v[84:87], v[128:131]
  s_waitcnt lgkmcnt(0)
  v_mfma_f32_16x16x32_bf16 v[128:131], v[92:95], v[88:91], v[128:131]
  v_mov_b32 v28, 0
  v_mov_b32 v29, 0
  v_mov_b32 v30, 0
  v_mov_b32 v31, 0
  v_mov_b32 v32, 0
  v_mov_b32 v33, 0
  v_mov_b32 v34, 0
  s_nop 0
  v_cvt_pk_bf16_f32 v68, v128, v129
  v_cvt_pk_bf16_f32 v70, v128, v129
  v_cvt_pk_bf16_f32 v69, v130, v131
  v_cvt_pk_bf16_f32 v71, v130, v131
  v_permlane16_swap_b32 v68, v70
  s_nop 0
  v_permlane16_swap_b32 v69, v71
  buffer_store_dwordx4 v[68:71], v61, s[4:7], s33 offen sc1
  buffer_store_dwordx4 v[68:71], v134, s[4:7], s33 offen sc1
  v_mov_b32 v35, 0
  v_mov_b32 v36, 0
  v_mov_b32 v37, 0
  v_mov_b32 v38, 0
  v_mov_b32 v39, 0
  v_mov_b32 v40, 0
  v_mov_b32 v41, 0
  v_mov_b32 v42, 0
  v_mov_b32 v43, 0
  v_mov_b32 v44, 0
  v_mov_b32 v45, 0
  v_mov_b32 v46, 0
  v_mov_b32 v47, 0
  v_mov_b32 v48, 0
  v_mov_b32 v49, 0
  v_mov_b32 v50, 0
  v_mov_b32 v51, 0
  v_mov_b32 v52, 0
  v_mov_b32 v53, 0
  v_mov_b32 v54, 0
  v_mov_b32 v55, 0
  v_mov_b32 v56, 0
  v_mov_b32 v57, 0
  v_mov_b32 v58, 0
  v_mov_b32 v59, 0
  s_xor_b32 s18, s18, s19
  s_xor_b32 s19, s19, s18
  s_xor_b32 s18, s18, s19
  s_xor_b32 s20, s20, s21
  s_xor_b32 s21, s21, s20
  s_xor_b32 s20, s20, s21
  s_add_u32 s72, s72, 1
  s_cmp_eq_u32 s72, 4
  s_cselect_b32 s72, 0, s72
  s_mov_b32 s73, 325632
  s_cselect_b32 s73, 0xfff11800, s73
  s_add_u32 s23, s23, s73
  s_mov_b32 s15, 0
  s_add_u32 s13, s17, 0
  s_add_u32 s14, s17, 2048
  s_nop 15
  s_nop 15
  s_nop 15
  s_nop 15
  s_nop 15
  s_nop 15
  buffer_load_dwordx4 v[96:99], v62, s[4:7], s37 offen offset:0 sc1
  buffer_load_dwordx4 v[100:103], v62, s[4:7], s37 offen offset:1024 sc1
  s_barrier
  buffer_store_dwordx4 v[92:95], v66, s[4:7], s25 offen sc1
  s_add_u32 s25, s25, s73
  s_add_u32 s12, s12, 1
  s_waitcnt vmcnt(1)
  v_mfma_f32_16x16x32_bf16 v[128:131], a[160:163], v[96:99], 0
  v_max3_u32 v14, v96, v97, v98
  v_max3_u32 v14, v14, v99, v100
  v_mfma_f32_16x16x32_bf16 v[128:131], a[160:163], v[100:103], v[128:131]
  v_max3_u32 v14, v14, v101, v102
  v_max_u32 v14, v14, v103
  v_cmp_eq_u32 vcc, -1, v14
  s_nop 4
  v_cvt_pk_bf16_f32 v68, v128, v129
  v_cvt_pk_bf16_f32 v69, v130, v131
  s_cbranch_vccnz mega_loop4_pbf
mega_loop4_pbok:
  buffer_store_dwordx2 v[68:69], v63, s[4:7], s17 offen sc1
  buffer_store_dwordx2 v[132:133], v63, s[4:7], s16 offen sc1
  s_barrier
  s_nop 15
  s_nop 15
  s_branch mega_loop4
mega_loop4_pcf:
  buffer_load_dwordx4 v[16:19], v2, s[4:7], s13 offen offset:0 sc1
  buffer_load_dwordx4 v[20:23], v2, s[4:7], s13 offen offset:1024 sc1
  buffer_load_dwordx4 v[24:27], v2, s[4:7], s14 offen offset:0 sc1
  s_nop 0
  v_mov_b32 v28, 0
  v_mov_b32 v29, 0
  v_mov_b32 v30, 0
  v_mov_b32 v31, 0
  v_mov_b32 v32, 0
  v_mov_b32 v33, 0
  v_mov_b32 v34, 0
  v_mov_b32 v35, 0
  s_add_u32 s15, s15, 16384
  s_cbranch_scc1 mega_fail
  s_branch mega_loop4_pc2
mega_loop4_last:
  v_smfmac_f32_16x16x64_bf16 v[56:59], v[24:27], a[96:103], v9
  ds_read_b128 a[188:191], v2 offset:30720
  s_waitcnt lgkmcnt(4)
  buffer_store_dwordx2 v[132:133], v10, s[4:7], s19 offen sc1
  v_smfmac_f32_16x16x64_bf16 v[52:55], v[72:75], a[24:31], v9
  v_smfmac_f32_16x16x64_bf16 v[56:59], v[72:75], a[104:111], v9
  v_smfmac_f32_16x16x64_bf16 v[52:55], v[76:79], a[32:39], v9
  v_smfmac_f32_16x16x64_bf16 v[56:59], v[76:79], a[112:119], v9
  v_smfmac_f32_16x16x64_bf16 v[52:55], v[80:83], a[40:47], v9
  v_smfmac_f32_16x16x64_bf16 v[56:59], v[80:83], a[120:127], v9
  v_smfmac_f32_16x16x64_bf16 v[52:55], v[84:87], a[48:55], v9
  v_smfmac_f32_16x16x64_bf16 v[56:59], v[84:87], a[128:135], v9
  v_smfmac_f32_16x16x64_bf16 v[52:55], v[88:91], a[56:63], v9
  v_smfmac_f32_16x16x64_bf16 v[56:59], v[88:91], a[136:143], v9
  v_smfmac_f32_16x16x64_bf16 v[52:55], v[92:95], a[64:71], v9
  v_smfmac_f32_16x16x64_bf16 v[56:59], v[92:95], a[144:151], v9
  v_smfmac_f32_16x16x64_bf16 v[52:55], v[96:99], a[72:79], v9
  v_smfmac_f32_16x16x64_bf16 v[56:59], v[96:99], a[152:159], v9
  s_nop 4
  v_add_f32 v52, v52, v54
  v_add_f32 v53, v53, v55
  v_cvt_pk_bf16_f32 v52, v52, v53
  ds_write_b32 v8, v52 offset:21504
  v_add_f32 v56, v56, v58
  v_add_f32 v57, v57, v59
  v_cvt_pk_bf16_f32 v56, v56, v57
  ds_write_b32 v8, v56 offset:22528
  s_waitcnt lgkmcnt(0)
  s_barrier
  ds_read_b128 v[92:95], v13 offset:21504
  s_waitcnt lgkmcnt(0)
  buffer_store_dwordx4 v[92:95], v66, s[4:7], s25 offen sc1
  s_waitcnt vmcnt(0)
  s_barrier
  s_cmp_lg_u32 s70, 0
  s_cbranch_scc1 mega_end
  s_lshl_b32 s73, s2, 2
  s_add_u32 s73, s73, s3
  s_branch mega_bjobs
mega_loop4_pbf:
  buffer_load_dwordx4 v[96:99], v62, s[4:7], s37 offen offset:0 sc1
  buffer_load_dwordx4 v[100:103], v62, s[4:7], s37 offen offset:1024 sc1
mega_loop4_pbl:
  buffer_load_dwordx4 v[96:99], v62, s[4:7], s37 offen offset:0 sc1
  buffer_load_dwordx4 v[100:103], v62, s[4:7], s37 offen offset:1024 sc1
  s_add_u32 s15, s15, 16384
  s_cbranch_scc1 mega_fail
  s_waitcnt vmcnt(2)
  v_max3_u32 v14, v96, v97, v98
  v_max3_u32 v14, v14, v99, v100
  v_mfma_f32_16x16x32_bf16 v[128:131], a[160:163], v[96:99], 0
  v_max3_u32 v14, v14, v101, v102
  v_max_u32 v14, v14, v103
  v_mfma_f32_16x16x32_bf16 v[128:131], a[160:163], v[100:103], v[128:131]
  v_cmp_eq_u32 vcc, -1, v14
  s_nop 6
  v_cvt_pk_bf16_f32 v68, v128, v129
  v_cvt_pk_bf16_f32 v69, v130, v131
  s_cbranch_vccnz mega_loop4_pbl
  s_branch mega_loop4_pbok
mega_loop5:
  buffer_load_dwordx4 v[16:19], v2, s[4:7], s13 offen offset:0 sc1
  buffer_load_dwordx4 v[20:23], v2, s[4:7], s13 offen offset:1024 sc1
  buffer_load_dwordx4 v[24:27], v2, s[4:7], s14 offen offset:0 sc1
  s_xor_b32 s16, s16, s17
  s_xor_b32 s17, s17, s16
  s_xor_b32 s16, s16, s17
  s_mov_b32 m0, 3072
  s_add_u32 s39, s39, 1
  s_and_b32 s27, s39, 7
  s_mul_i32 s27, s27, 163840
  s_add_u32 s37, s32, s27
  s_add_u32 s33, s30, s27
  s_nop 15
  s_nop 14
  buffer_load_dwordx4 v[16:19], v2, s[4:7], s13 offen offset:0 sc1
  buffer_load_dwordx4 v[20:23], v2, s[4:7], s13 offen offset:1024 sc1
  buffer_load_dwordx4 v[24:27], v2, s[4:7], s14 offen offset:0 sc1
mega_loop5_pc2:
  s_waitcnt vmcnt(3)
  v_max3_u32 v14, v16, v17, v18
  v_max3_u32 v14, v14, v19, v20
  v_smfmac_f32_16x16x64_bf16 v[44:47], v[16:19], v[136:143], v9
  v_max3_u32 v14, v14, v21, v22
  v_max3_u32 v14, v14, v23, v24
  v_smfmac_f32_16x16x64_bf16 v[48:51], v[16:19], v[144:151], v9
  v_max3_u32 v14, v14, v25, v26
  v_max_u32 v14, v14, v27
  v_smfmac_f32_16x16x64_bf16 v[44:47], v[20:23], v[152:159], v9
  v_cmp_eq_u32 vcc, -1, v14
  v_smfmac_f32_16x16x64_bf16 v[48:51], v[20:23], v[160:167], v9
  s_cbranch_vccnz mega_loop5_pcf
  v_smfmac_f32_16x16x64_bf16 v[44:47], v[24:27], v[168:175], v9
  ds_write_b128 v2, v[16:19] offset:3072
  v_smfmac_f32_16x16x64_bf16 v[48:51], v[24:27], v[176:183], v9
  ds_write_b128 v2, v[20:23] offset:4096
  v_smfmac_f32_16x16x64_bf16 v[36:39], v[16:19], v[184:191], v9
  v_smfmac_f32_16x16x64_bf16 v[40:43], v[16:19], v[192:199], v9
  v_add_f32 v44, v44, v46
  v_smfmac_f32_16x16x64_bf16 v[36:39], v[20:23], v[200:207], v9
  v_add_f32 v45, v45, v47
  v_cvt_pk_bf16_f32 v46, v44, v45
  v_smfmac_f32_16x16x64_bf16 v[40:43], v[20:23], v[208:215], v9
  v_add_f32 v48, v48, v50
  v_smfmac_f32_16x16x64_bf16 v[40:43], v[24:27], v[216:223], v9
  v_add_f32 v49, v49, v51
  v_cvt_pk_bf16_f32 v47, v48, v49
  v_smfmac_f32_16x16x64_bf16 v[28:31], v[16:19], v[224:231], v9
  ds_write_b64 v3, v[46:47] offset:14336
  v_smfmac_f32_16x16x64_bf16 v[32:35], v[16:19], v[232:239], v9
  v_add_f32 v36, v36, v38
  v_smfmac_f32_16x16x64_bf16 v[28:31], v[20:23], v[240:247], v9
  v_add_f32 v37, v37, v39
  v_cvt_pk_bf16_f32 v38, v36, v37
  v_smfmac_f32_16x16x64_bf16 v[32:35], v[20:23], v[248:255], v9
  v_add_f32 v40, v40, v42
  v_add_f32 v41, v41, v43
  v_cvt_pk_bf16_f32 v39, v40, v41
  ds_write_b64 v3, v[38:39] offset:12288
  s_nop 0
  v_add_f32 v28, v28, v30
  v_add_f32 v29, v29, v31
  v_cvt_pk_bf16_f32 v30, v28, v29
  v_add_f32 v32, v32, v34
  v_add_f32 v33, v33, v35
  v_cvt_pk_bf16_f32 v31, v32, v33
  ds_write_b64 v3, v[30:31] offset:10240
  v_smfmac_f32_16x16x64_bf16 v[52:55], v[16:19], a[24:31], v9
  v_smfmac_f32_16x16x64_bf16 v[56:59], v[16:19], a[104:111], v9
  v_smfmac_f32_16x16x64_bf16 v[52:55], v[20:23], a[32:39], v9
  s_waitcnt lgkmcnt(0)
  s_barrier
  ds_read_b128 v[28:31], v2 offset:10240
  ds_read_b128 v[32:35], v2 offset:11264
  ds_read_b128 v[36:39], v2 offset:12288
  ds_read_b128 v[40:43], v2 offset:13312
  ds_read_b128 v[44:47], v2 offset:14336
  ds_read_b128 v[48:51], v2 offset:15360
  ds_read_b128 v[120:123], v11 offset:35840
  ds_read_b64 v[124:125], v11 offset:36872
  v_smfmac_f32_16x16x64_bf16 v[56:59], v[20:23], a[112:119], v9
  s_waitcnt lgkmcnt(7)
  v_mfma_f32_16x16x32_bf16 v[100:103], v[28:31], a[172:175], 0
  ds_read_b128 v[72:75], v2 offset:0
  s_waitcnt lgkmcnt(7)
  v_mfma_f32_16x16x32_bf16 v[100:103], v[32:35], a[172:175], v[100:103]
  ds_read_b128 v[76:79], v2 offset:1024
  s_waitcnt lgkmcnt(7)
  v_mfma_f32_16x16x32_bf16 v[104:107], v[36:39], a[172:175], 0
  ds_read_b128 v[80:83], v2 offset:5120
  s_waitcnt lgkmcnt(7)
  v_mfma_f32_16x16x32_bf16 v[104:107], v[40:43], a[172:175], v[104:107]
  ds_read_b128 v[84:87], v2 offset:6144
  s_waitcnt lgkmcnt(7)
  v_mfma_f32_16x16x32_bf16 v[108:111], v[44:47], a[172:175], 0
  v_cvt_pk_bf16_f32 v112, v100, v101
  v_cvt_pk_bf16_f32 v113, v102, v103
  s_waitcnt lgkmcnt(6)
  v_mfma_f32_16x16x32_bf16 v[108:111], v[48:51], a[172:175], v[108:111]
  s_nop 0
  v_cvt_pk_bf16_f32 v114, v104, v105
  v_cvt_pk_bf16_f32 v115, v106, v107
  s_waitcnt lgkmcnt(4)
  ds_read_b128 v[88:91], v2 offset:7168
  v_mfma_f32_16x16x32_bf16 v[128:131], v[120:123], v[112:115], 0
  ds_read_b128 v[92:95], v2 offset:8192
  ds_read_b128 v[96:99], v2 offset:9216
  v_cvt_pk_bf16_f32 v116, v108, v109
  v_cvt_pk_bf16_f32 v117, v110, v111
  s_nop 1
  v_mfma_f32_16x16x32_bf16 v[128:131], v[124:127], v[116:119], v[128:131]
  v_smfmac_f32_16x16x64_bf16 v[52:55], v[24:27], a[16:23], v9
  ds_read_b128 a[176:179], v2 offset:25600
  ds_read_b128 a[180:183], v2 offset:27648
  ds_read_b128 a[184:187], v2 offset:29696
  s_nop 1
  v_cvt_pk_bf16_f32 v68, v128, v129
  v_cvt_pk_bf16_f32 v69, v130, v131
  buffer_store_dwordx2 v[68:69], v10, s[4:7], s18 offen sc1
  s_cmp_eq_u32 s12, 63
  s_cbranch_scc1 mega_loop5_last
  v_smfmac_f32_16x16x64_bf16 v[56:59], v[24:27], a[96:103], v9
  ds_read_b128 a[188:191], v2 offset:31744
  s_waitcnt lgkmcnt(4)
  buffer_store_dwordx2 v[132:133], v10, s[4:7], s19 offen sc1
  v_smfmac_f32_16x16x64_bf16 v[52:55], v[72:75], a[0:7], v9
  v_smfmac_f32_16x16x64_bf16 v[56:59], v[72:75], a[80:87], v9
  v_smfmac_f32_16x16x64_bf16 v[52:55], v[76:79], a[8:15], v9
  v_smfmac_f32_16x16x64_bf16 v[56:59], v[76:79], a[88:95], v9
  v_smfmac_f32_16x16x64_bf16 v[52:55], v[80:83], a[40:47], v9
  v_smfmac_f32_16x16x64_bf16 v[56:59], v[80:83], a[120:127], v9
  v_smfmac_f32_16x16x64_bf16 v[52:55], v[84:87], a[48:55], v9
  v_smfmac_f32_16x16x64_bf16 v[56:59], v[84:87], a[128:135], v9
  v_smfmac_f32_16x16x64_bf16 v[52:55], v[88:91], a[56:63], v9
  v_smfmac_f32_16x16x64_bf16 v[56:59], v[88:91], a[136:143], v9
  buffer_load_dwordx4 v[16:19], v4, s[4:7], s20 offen sc1
  v_smfmac_f32_16x16x64_bf16 v[52:55], v[92:95], a[64:71], v9
  buffer_load_dwordx4 v[20:23], v4, s[4:7], s20 offen offset:256 sc1
  v_smfmac_f32_16x16x64_bf16 v[56:59], v[92:95], a[144:151], v9
  buffer_load_dwordx4 v[24:27], v5, s[4:7], s20 offen offset:512 sc1
  v_smfmac_f32_16x16x64_bf16 v[52:55], v[96:99], a[72:79], v9
  v_smfmac_f32_16x16x64_bf16 v[56:59], v[96:99], a[152:159], v9
  s_nop 4
  v_add_f32 v52, v52, v54
  v_add_f32 v53, v53, v55
  v_cvt_pk_bf16_f32 v52, v52, v53
  ds_write_b32 v8, v52 offset:21504
  v_add_f32 v56, v56, v58
  v_add_f32 v57, v57, v59
  v_cvt_pk_bf16_f32 v56, v56, v57
  ds_write_b32 v8, v56 offset:22528
mega_loop5_pa:
  buffer_load_dwordx4 v[16:19], v4, s[4:7], s20 offen sc1
  buffer_load_dwordx4 v[20:23], v4, s[4:7], s20 offen offset:256 sc1
  buffer_load_dwordx4 v[24:27], v5, s[4:7], s20 offen offset:512 sc1
  s_add_u32 s15, s15, 16384
  s_cbranch_scc1 mega_fail
  s_waitcnt vmcnt(3)
  v_max3_u32 v14, v16, v17, v18
  v_max3_u32 v14, v14, v19, v20
  v_mfma_f32_16x16x32_bf16 v[40:43], v[16:19], a[160:163], 0
  v_max3_u32 v14, v14, v21, v22
  v_max3_u32 v14, v14, v23, v24
  v_mfma_f32_16x16x32_bf16 v[40:43], v[20:23], a[164:167], v[40:43]
  v_max3_u32 v14, v14, v25, v26
  v_max_u32 v14, v14, v27
  v_mfma_f32_16x16x32_bf16 v[44:47], v[24:27], a[168:171], 0
  v_cmp_eq_u32 vcc, -1, v14
  s_nop 3
  v_max3_f32 v48, v40, v41, v42
  s_cbranch_vccnz mega_loop5_pa
  s_nop 0
  v_cndmask_b32 v44, v44, v45, s[42:43]
  v_max3_f32 v48, v48, v43, v44
  s_nop 1
  v_max_f32_dpp v48, v48, v48 quad_perm:[1,0,3,2] row_mask:0xf bank_mask:0xf
  s_nop 1
  v_max_f32_dpp v48, v48, v48 quad_perm:[2,3,0,1] row_mask:0xf bank_mask:0xf
  s_nop 1
  v_max_f32_dpp v48, v48, v48 row_half_mirror row_mask:0xf bank_mask:0xf
  v_mul_f32 v48, v0, v48
  v_pk_fma_f32 v[40:41], v[40:41], v[0:1], v[48:49] op_sel_hi:[1,0,0] neg_lo:[0,1,0] neg_hi:[0,1,0]
  v_pk_fma_f32 v[42:43], v[42:43], v[0:1], v[48:49] op_sel_hi:[1,0,0] neg_lo:[0,1,0] neg_hi:[0,1,0]
  v_fma_f32 v44, v44, -v0, v48
  v_exp_f32 v40, v40
  v_exp_f32 v41, v41
  v_exp_f32 v42, v42
  v_exp_f32 v43, v43
  v_exp_f32 v44, v44
  v_pk_add_f32 v[48:49], v[40:41], v[42:43]
  v_add_f32 v48, v48, v49
  v_add_f32 v48, v48, v44
  s_nop 1
  v_add_f32_dpp v48, v48, v48 quad_perm:[1,0,3,2] row_mask:0xf bank_mask:0xf
  s_nop 1
  v_add_f32_dpp v48, v48, v48 quad_perm:[2,3,0,1] row_mask:0xf bank_mask:0xf
  s_nop 1
  v_add_f32_dpp v48, v48, v48 row_half_mirror row_mask:0xf bank_mask:0xf
  v_rcp_f32 v48, v48
  s_nop 0
  v_pk_mul_f32 v[40:41], v[40:41], v[48:49] op_sel_hi:[1,0]
  v_pk_mul_f32 v[42:43], v[42:43], v[48:49] op_sel_hi:[1,0]
  v_mul_f32 v44, v44, v48
  v_cvt_pk_bf16_f32 v40, v40, v41
  v_cvt_pk_bf16_f32 v41, v42, v43
  ds_write_b64 v6, v[40:41] offset:16384
  v_cvt_pk_bf16_f32 v44, v44, v44
  ds_write_b16 v7, v44 offset:20480
  s_waitcnt lgkmcnt(0)
  s_barrier
  ds_read_b128 v[72:75], v12 offset:16384
  ds_read_b128 v[76:79], v12 offset:17408
  ds_read_b128 v[80:83], v12 offset:18432
  ds_read_b128 v[84:87], v12 offset:19456
  ds_read_b128 v[88:91], v12 offset:20480
  ds_read_b128 v[92:95], v13 offset:21504
  s_waitcnt lgkmcnt(5)
  v_mfma_f32_16x16x32_bf16 v[128:131], a[176:179], v[72:75], 0
  s_waitcnt lgkmcnt(4)
  v_mfma_f32_16x16x32_bf16 v[128:131], a[180:183], v[76:79], v[128:131]
  s_waitcnt lgkmcnt(3)
  v_mfma_f32_16x16x32_bf16 v[128:131], a[184:187], v[80:83], v[128:131]
  s_waitcnt lgkmcnt(2)
  v_mfma_f32_16x16x32_bf16 v[128:131], a[188:191], v[84:87], v[128:131]
  s_waitcnt lgkmcnt(0)
  v_mfma_f32_16x16x32_bf16 v[128:131], v[92:95], v[88:91], v[128:131]
  v_mov_b32 v28, 0
  v_mov_b32 v29, 0
  v_mov_b32 v30, 0
  v_mov_b32 v31, 0
  v_mov_b32 v32, 0
  v_mov_b32 v33, 0
  v_mov_b32 v34, 0
  s_nop 0
  v_cvt_pk_bf16_f32 v68, v128, v129
  v_cvt_pk_bf16_f32 v70, v128, v129
  v_cvt_pk_bf16_f32 v69, v130, v131
  v_cvt_pk_bf16_f32 v71, v130, v131
  v_permlane16_swap_b32 v68, v70
  s_nop 0
  v_permlane16_swap_b32 v69, v71
  buffer_store_dwordx4 v[68:71], v61, s[4:7], s33 offen sc1
  buffer_store_dwordx4 v[68:71], v134, s[4:7], s33 offen sc1
  v_mov_b32 v35, 0
  v_mov_b32 v36, 0
  v_mov_b32 v37, 0
  v_mov_b32 v38, 0
  v_mov_b32 v39, 0
  v_mov_b32 v40, 0
  v_mov_b32 v41, 0
  v_mov_b32 v42, 0
  v_mov_b32 v43, 0
  v_mov_b32 v44, 0
  v_mov_b32 v45, 0
  v_mov_b32 v46, 0
  v_mov_b32 v47, 0
  v_mov_b32 v48, 0
  v_mov_b32 v49, 0
  v_mov_b32 v50, 0
  v_mov_b32 v51, 0
  v_mov_b32 v52, 0
  v_mov_b32 v53, 0
  v_mov_b32 v54, 0
  v_mov_b32 v55, 0
  v_mov_b32 v56, 0
  v_mov_b32 v57, 0
  v_mov_b32 v58, 0
  v_mov_b32 v59, 0
  s_xor_b32 s18, s18, s19
  s_xor_b32 s19, s19, s18
  s_xor_b32 s18, s18, s19
  s_xor_b32 s20, s20, s21
  s_xor_b32 s21, s21, s20
  s_xor_b32 s20, s20, s21
  s_add_u32 s72, s72, 1
  s_cmp_eq_u32 s72, 4
  s_cselect_b32 s72, 0, s72
  s_mov_b32 s73, 325632
  s_cselect_b32 s73, 0xfff11800, s73
  s_add_u32 s23, s23, s73
  s_mov_b32 s15, 0
  s_add_u32 s13, s17, 3072
  s_add_u32 s14, s17, 2048
  s_nop 15
  s_nop 15
  s_nop 15
  s_nop 15
  s_nop 15
  s_nop 15
  buffer_load_dwordx4 v[96:99], v62, s[4:7], s37 offen offset:0 sc1
  buffer_load_dwordx4 v[100:103], v62, s[4:7], s37 offen offset:1024 sc1
  s_barrier
  buffer_store_dwordx4 v[92:95], v66, s[4:7], s25 offen sc1
  s_add_u32 s25, s25, s73
  s_add_u32 s12, s12, 1
  s_waitcnt vmcnt(1)
  v_mfma_f32_16x16x32_bf16 v[128:131], a[160:163], v[96:99], 0
  v_max3_u32 v14, v96, v97, v98
  v_max3_u32 v14, v14, v99, v100
  v_mfma_f32_16x16x32_bf16 v[128:131], a[160:163], v[100:103], v[128:131]
  v_max3_u32 v14, v14, v101, v102
  v_max_u32 v14, v14, v103
  v_cmp_eq_u32 vcc, -1, v14
  s_nop 4
  v_cvt_pk_bf16_f32 v68, v128, v129
  v_cvt_pk_bf16_f32 v69, v130, v131
  s_cbranch_vccnz mega_loop5_pbf
mega_loop5_pbok:
  buffer_store_dwordx2 v[68:69], v63, s[4:7], s17 offen sc1
  buffer_store_dwordx2 v[132:133], v63, s[4:7], s16 offen sc1
  s_barrier
  s_nop 15
  s_nop 15
  s_branch mega_loop5
mega_loop5_pcf:
  buffer_load_dwordx4 v[16:19], v2, s[4:7], s13 offen offset:0 sc1
  buffer_load_dwordx4 v[20:23], v2, s[4:7], s13 offen offset:1024 sc1
  buffer_load_dwordx4 v[24:27], v2, s[4:7], s14 offen offset:0 sc1
  s_nop 0
  v_mov_b32 v44, 0
  v_mov_b32 v45, 0
  v_mov_b32 v46, 0
  v_mov_b32 v47, 0
  v_mov_b32 v48, 0
  v_mov_b32 v49, 0
  v_mov_b32 v50, 0
  v_mov_b32 v51, 0
  s_add_u32 s15, s15, 16384
  s_cbranch_scc1 mega_fail
  s_branch mega_loop5_pc2
mega_loop5_last:
  v_smfmac_f32_16x16x64_bf16 v[56:59], v[24:27], a[96:103], v9
  ds_read_b128 a[188:191], v2 offset:31744
  s_waitcnt lgkmcnt(4)
  buffer_store_dwordx2 v[132:133], v10, s[4:7], s19 offen sc1
  v_smfmac_f32_16x16x64_bf16 v[52:55], v[72:75], a[0:7], v9
  v_smfmac_f32_16x16x64_bf16 v[56:59], v[72:75], a[80:87], v9
  v_smfmac_f32_16x16x64_bf16 v[52:55], v[76:79], a[8:15], v9
  v_smfmac_f32_16x16x64_bf16 v[56:59], v[76:79], a[88:95], v9
  v_smfmac_f32_16x16x64_bf16 v[52:55], v[80:83], a[40:47], v9
  v_smfmac_f32_16x16x64_bf16 v[56:59], v[80:83], a[120:127], v9
  v_smfmac_f32_16x16x64_bf16 v[52:55], v[84:87], a[48:55], v9
  v_smfmac_f32_16x16x64_bf16 v[56:59], v[84:87], a[128:135], v9
  v_smfmac_f32_16x16x64_bf16 v[52:55], v[88:91], a[56:63], v9
  v_smfmac_f32_16x16x64_bf16 v[56:59], v[88:91], a[136:143], v9
  v_smfmac_f32_16x16x64_bf16 v[52:55], v[92:95], a[64:71], v9
  v_smfmac_f32_16x16x64_bf16 v[56:59], v[92:95], a[144:151], v9
  v_smfmac_f32_16x16x64_bf16 v[52:55], v[96:99], a[72:79], v9
  v_smfmac_f32_16x16x64_bf16 v[56:59], v[96:99], a[152:159], v9
  s_nop 4
  v_add_f32 v52, v52, v54
  v_add_f32 v53, v53, v55
  v_cvt_pk_bf16_f32 v52, v52, v53
  ds_write_b32 v8, v52 offset:21504
  v_add_f32 v56, v56, v58
  v_add_f32 v57, v57, v59
  v_cvt_pk_bf16_f32 v56, v56, v57
  ds_write_b32 v8, v56 offset:22528
  s_waitcnt lgkmcnt(0)
  s_barrier
  ds_read_b128 v[92:95], v13 offset:21504
  s_waitcnt lgkmcnt(0)
  buffer_store_dwordx4 v[92:95], v66, s[4:7], s25 offen sc1
  s_waitcnt vmcnt(0)
  s_barrier
  s_cmp_lg_u32 s70, 0
  s_cbranch_scc1 mega_end
  s_lshl_b32 s73, s2, 2
  s_add_u32 s73, s73, s3
  s_branch mega_bjobs
mega_loop5_pbf:
  buffer_load_dwordx4 v[96:99], v62, s[4:7], s37 offen offset:0 sc1
  buffer_load_dwordx4 v[100:103], v62, s[4:7], s37 offen offset:1024 sc1
mega_loop5_pbl:
  buffer_load_dwordx4 v[96:99], v62, s[4:7], s37 offen offset:0 sc1
  buffer_load_dwordx4 v[100:103], v62, s[4:7], s37 offen offset:1024 sc1
  s_add_u32 s15, s15, 16384
  s_cbranch_scc1 mega_fail
  s_waitcnt vmcnt(2)
  v_max3_u32 v14, v96, v97, v98
  v_max3_u32 v14, v14, v99, v100
  v_mfma_f32_16x16x32_bf16 v[128:131], a[160:163], v[96:99], 0
  v_max3_u32 v14, v14, v101, v102
  v_max_u32 v14, v14, v103
  v_mfma_f32_16x16x32_bf16 v[128:131], a[160:163], v[100:103], v[128:131]
  v_cmp_eq_u32 vcc, -1, v14
  s_nop 6
  v_cvt_pk_bf16_f32 v68, v128, v129
  v_cvt_pk_bf16_f32 v69, v130, v131
  s_cbranch_vccnz mega_loop5_pbl
  s_branch mega_loop5_pbok
mega_loop6:
  buffer_load_dwordx4 v[16:19], v2, s[4:7], s13 offen offset:0 sc1
  buffer_load_dwordx4 v[20:23], v2, s[4:7], s13 offen offset:1024 sc1
  buffer_load_dwordx4 v[24:27], v2, s[4:7], s14 offen offset:0 sc1
  s_xor_b32 s16, s16, s17
  s_xor_b32 s17, s17, s16
  s_xor_b32 s16, s16, s17
  s_mov_b32 m0, 5120
  s_add_u32 s39, s39, 1
  s_and_b32 s27, s39, 7
  s_mul_i32 s27, s27, 163840
  s_add_u32 s37, s32, s27
  s_add_u32 s33, s30, s27
  s_nop 15
  s_nop 14
  buffer_load_dwordx4 v[16:19], v2, s[4:7], s13 offen offset:0 sc1
  buffer_load_dwordx4 v[20:23], v2, s[4:7], s13 offen offset:1024 sc1
  buffer_load_dwordx4 v[24:27], v2, s[4:7], s14 offen offset:0 sc1
mega_loop6_pc2:
  s_waitcnt vmcnt(3)
  v_max3_u32 v14, v16, v17, v18
  v_max3_u32 v14, v14, v19, v20
  v_smfmac_f32_16x16x64_bf16 v[28:31], v[16:19], v[136:143], v9
  v_max3_u32 v14, v14, v21, v22
  v_max3_u32 v14, v14, v23, v24
  v_smfmac_f32_16x16x64_bf16 v[32:35], v[16:19], v[144:151], v9
  v_max3_u32 v14, v14, v25, v26
  v_max_u32 v14, v14, v27
  v_smfmac_f32_16x16x64_bf16 v[28:31], v[20:23], v[152:159], v9
  v_cmp_eq_u32 vcc, -1, v14
  v_smfmac_f32_16x16x64_bf16 v[32:35], v[20:23], v[160:167], v9
  s_cbranch_vccnz mega_loop6_pcf
  v_smfmac_f32_16x16x64_bf16 v[28:31], v[24:27], v[168:175], v9
  ds_write_b128 v2, v[16:19] offset:5120
  v_smfmac_f32_16x16x64_bf16 v[32:35], v[24:27], v[176:183], v9
  ds_write_b128 v2, v[20:23] offset:6144
  v_smfmac_f32_16x16x64_bf16 v[36:39], v[16:19], v[184:191], v9
  ds_write_b128 v2, v[24:27] offset:7168
  v_smfmac_f32_16x16x64_bf16 v[40:43], v[16:19], v[192:199], v9
  v_add_f32 v28, v28, v30
  v_smfmac_f32_16x16x64_bf16 v[36:39], v[20:23], v[200:207], v9
  v_add_f32 v29, v29, v31
  v_cvt_pk_bf16_f32 v30, v28, v29
  v_smfmac_f32_16x16x64_bf16 v[40:43], v[20:23], v[208:215], v9
  v_add_f32 v32, v32, v34
  v_smfmac_f32_16x16x64_bf16 v[36:39], v[24:27], v[216:223], v9
  v_add_f32 v33, v33, v35
  v_cvt_pk_bf16_f32 v31, v32, v33
  v_smfmac_f32_16x16x64_bf16 v[44:47], v[16:19], v[224:231], v9
  ds_write_b64 v3, v[30:31] offset:10240
  v_smfmac_f32_16x16x64_bf16 v[48:51], v[16:19], v[232:239], v9
  s_nop 0
  v_add_f32 v36, v36, v38
  v_smfmac_f32_16x16x64_bf16 v[44:47], v[20:23], v[240:247], v9
  v_add_f32 v37, v37, v39
  v_cvt_pk_bf16_f32 v38, v36, v37
  v_smfmac_f32_16x16x64_bf16 v[48:51], v[20:23], v[248:255], v9
  v_add_f32 v40, v40, v42
  v_add_f32 v41, v41, v43
  v_cvt_pk_bf16_f32 v39, v40, v41
  ds_write_b64 v3, v[38:39] offset:12288
  s_nop 0
  v_add_f32 v44, v44, v46
  v_add_f32 v45, v45, v47
  v_cvt_pk_bf16_f32 v46, v44, v45
  v_add_f32 v48, v48, v50
  v_add_f32 v49, v49, v51
  v_cvt_pk_bf16_f32 v47, v48, v49
  ds_write_b64 v3, v[46:47] offset:14336
  v_smfmac_f32_16x16x64_bf16 v[52:55], v[16:19], a[40:47], v9
  v_smfmac_f32_16x16x64_bf16 v[56:59], v[16:19], a[120:127], v9
  v_smfmac_f32_16x16x64_bf16 v[52:55], v[20:23], a[48:55], v9
  s_waitcnt lgkmcnt(0)
  s_barrier
  ds_read_b128 v[28:31], v2 offset:10240
  ds_read_b128 v[32:35], v2 offset:11264
  ds_read_b128 v[36:39], v2 offset:12288
  ds_read_b128 v[40:43], v2 offset:13312
  ds_read_b128 v[44:47], v2 offset:14336
  ds_read_b128 v[48:51], v2 offset:15360
  v_smfmac_f32_16x16x64_bf16 v[56:59], v[20:23], a[128:135], v9
  s_waitcnt lgkmcnt(5)
  v_mfma_f32_16x16x32_bf16 v[100:103], v[28:31], a[172:175], 0
  ds_read_b128 v[72:75], v2 offset:0
  s_waitcnt lgkmcnt(5)
  v_mfma_f32_16x16x32_bf16 v[100:103], v[32:35], a[172:175], v[100:103]
  ds_read_b128 v[76:79], v2 offset:1024
  s_waitcnt lgkmcnt(5)
  v_mfma_f32_16x16x32_bf16 v[104:107], v[36:39], a[172:175], 0
  ds_read_b128 v[80:83], v2 offset:2048
  s_waitcnt lgkmcnt(5)
  v_mfma_f32_16x16x32_bf16 v[104:107], v[40:43], a[172:175], v[104:107]
  ds_read_b128 v[84:87], v2 offset:3072
  s_waitcnt lgkmcnt(5)
  v_mfma_f32_16x16x32_bf16 v[108:111], v[44:47], a[172:175], 0
  v_cvt_pk_bf16_f32 v112, v100, v101
  v_cvt_pk_bf16_f32 v113, v102, v103
  s_waitcnt lgkmcnt(4)
  v_mfma_f32_16x16x32_bf16 v[108:111], v[48:51], a[172:175], v[108:111]
  s_nop 0
  v_cvt_pk_bf16_f32 v114, v104, v105
  v_cvt_pk_bf16_f32 v115, v106, v107
  s_waitcnt lgkmcnt(4)
  ds_read_b128 v[88:91], v2 offset:4096
  v_mfma_f32_16x16x32_bf16 v[128:131], v[112:115], v[112:115], 0
  ds_read_b128 v[92:95], v2 offset:8192
  ds_read_b128 v[96:99], v2 offset:9216
  v_cvt_pk_bf16_f32 v116, v108, v109
  v_cvt_pk_bf16_f32 v117, v110, v111
  s_nop 1
  v_mfma_f32_16x16x32_bf16 v[128:131], v[116:119], v[116:119], v[128:131]
  v_smfmac_f32_16x16x64_bf16 v[52:55], v[24:27], a[56:63], v9
  ds_read_b128 a[176:179], v12 offset:32768
  ds_read_b128 a[180:183], v12 offset:32896
  ds_read_b128 a[184:187], v12 offset:33792
  s_nop 1
  v_cvt_pk_bf16_f32 v68, v128, v129
  v_cvt_pk_bf16_f32 v69, v130, v131
  buffer_store_dwordx2 v[68:69], v10, s[4:7], s18 offen sc1
  s_cmp_eq_u32 s12, 63
  s_cbranch_scc1 mega_loop6_last
  v_smfmac_f32_16x16x64_bf16 v[56:59], v[24:27], a[136:143], v9
  ds_read_b128 a[188:191], v12 offset:33920
  s_waitcnt lgkmcnt(4)
  buffer_store_dwordx4 v[112:115], v64, s[4:7], s23 offen sc1
  v_smfmac_f32_16x16x64_bf16 v[52:55], v[72:75], a[0:7], v9
  buffer_store_dwordx2 v[116:117], v65, s[4:7], s23 offen sc1
  v_smfmac_f32_16x16x64_bf16 v[56:59], v[72:75], a[80:87], v9
  buffer_store_dwordx2 v[132:133], v10, s[4:7], s19 offen sc1
  v_smfmac_f32_16x16x64_bf16 v[52:55], v[76:79], a[8:15], v9
  v_smfmac_f32_16x16x64_bf16 v[56:59], v[76:79], a[88:95], v9
  v_smfmac_f32_16x16x64_bf16 v[52:55], v[80:83], a[16:23], v9
  v_smfmac_f32_16x16x64_bf16 v[56:59], v[80:83], a[96:103], v9
  v_smfmac_f32_16x16x64_bf16 v[52:55], v[84:87], a[24:31], v9
  v_smfmac_f32_16x16x64_bf16 v[56:59], v[84:87], a[104:111], v9
  v_smfmac_f32_16x16x64_bf16 v[52:55], v[88:91], a[32:39], v9
  v_smfmac_f32_16x16x64_bf16 v[56:59], v[88:91], a[112:119], v9
  buffer_load_dwordx4 v[16:19], v4, s[4:7], s20 offen sc1
  v_smfmac_f32_16x16x64_bf16 v[52:55], v[92:95], a[64:71], v9
  buffer_load_dwordx4 v[20:23], v4, s[4:7], s20 offen offset:256 sc1
  v_smfmac_f32_16x16x64_bf16 v[56:59], v[92:95], a[144:151], v9
  buffer_load_dwordx4 v[24:27], v5, s[4:7], s20 offen offset:512 sc1
  v_smfmac_f32_16x16x64_bf16 v[52:55], v[96:99], a[72:79], v9
  v_smfmac_f32_16x16x64_bf16 v[56:59], v[96:99], a[152:159], v9
  s_nop 4
  v_add_f32 v52, v52, v54
  v_add_f32 v53, v53, v55
  v_cvt_pk_bf16_f32 v52, v52, v53
  ds_write_b32 v8, v52 offset:21504
  v_add_f32 v56, v56, v58
  v_add_f32 v57, v57, v59
  v_cvt_pk_bf16_f32 v56, v56, v57
  ds_write_b32 v8, v56 offset:22528
mega_loop6_pa:
  buffer_load_dwordx4 v[16:19], v4, s[4:7], s20 offen sc1
  buffer_load_dwordx4 v[20:23], v4, s[4:7], s20 offen offset:256 sc1
  buffer_load_dwordx4 v[24:27], v5, s[4:7], s20 offen offset:512 sc1
  s_add_u32 s15, s15, 16384
  s_cbranch_scc1 mega_fail
  s_waitcnt vmcnt(3)
  v_max3_u32 v14, v16, v17, v18
  v_max3_u32 v14, v14, v19, v20
  v_mfma_f32_16x16x32_bf16 v[40:43], v[16:19], a[160:163], 0
  v_max3_u32 v14, v14, v21, v22
  v_max3_u32 v14, v14, v23, v24
  v_mfma_f32_16x16x32_bf16 v[40:43], v[20:23], a[164:167], v[40:43]
  v_max3_u32 v14, v14, v25, v26
  v_max_u32 v14, v14, v27
  v_mfma_f32_16x16x32_bf16 v[44:47], v[24:27], a[168:171], 0
  v_cmp_eq_u32 vcc, -1, v14
  s_nop 3
  v_max3_f32 v48, v40, v41, v42
  s_cbranch_vccnz mega_loop6_pa
  s_nop 0
  v_cndmask_b32 v44, v44, v45, s[42:43]
  v_max3_f32 v48, v48, v43, v44
  s_nop 1
  v_max_f32_dpp v48, v48, v48 quad_perm:[1,0,3,2] row_mask:0xf bank_mask:0xf
  s_nop 1
  v_max_f32_dpp v48, v48, v48 quad_perm:[2,3,0,1] row_mask:0xf bank_mask:0xf
  s_nop 1
  v_max_f32_dpp v48, v48, v48 row_half_mirror row_mask:0xf bank_mask:0xf
  v_mul_f32 v48, v0, v48
  v_pk_fma_f32 v[40:41], v[40:41], v[0:1], v[48:49] op_sel_hi:[1,0,0] neg_lo:[0,1,0] neg_hi:[0,1,0]
  v_pk_fma_f32 v[42:43], v[42:43], v[0:1], v[48:49] op_sel_hi:[1,0,0] neg_lo:[0,1,0] neg_hi:[0,1,0]
  v_fma_f32 v44, v44, -v0, v48
  v_exp_f32 v40, v40
  v_exp_f32 v41, v41
  v_exp_f32 v42, v42
  v_exp_f32 v43, v43
  v_exp_f32 v44, v44
  v_pk_add_f32 v[48:49], v[40:41], v[42:43]
  v_add_f32 v48, v48, v49
  v_add_f32 v48, v48, v44
  s_nop 1
  v_add_f32_dpp v48, v48, v48 quad_perm:[1,0,3,2] row_mask:0xf bank_mask:0xf
  s_nop 1
  v_add_f32_dpp v48, v48, v48 quad_perm:[2,3,0,1] row_mask:0xf bank_mask:0xf
  s_nop 1
  v_add_f32_dpp v48, v48, v48 row_half_mirror row_mask:0xf bank_mask:0xf
  v_rcp_f32 v48, v48
  s_nop 0
  v_pk_mul_f32 v[40:41], v[40:41], v[48:49] op_sel_hi:[1,0]
  v_pk_mul_f32 v[42:43], v[42:43], v[48:49] op_sel_hi:[1,0]
  v_mul_f32 v44, v44, v48
  v_cvt_pk_bf16_f32 v40, v40, v41
  v_cvt_pk_bf16_f32 v41, v42, v43
  ds_write_b64 v6, v[40:41] offset:16384
  v_cvt_pk_bf16_f32 v44, v44, v44
  ds_write_b16 v7, v44 offset:20480
  s_add_u32 s27, s12, 1
  v_mov_b32 v14, s27
  buffer_store_dword v14, v67, s[4:7], s77 offen offset:0 sc1
  s_waitcnt lgkmcnt(0)
  s_barrier
  ds_read_b128 v[72:75], v12 offset:16384
  ds_read_b128 v[76:79], v12 offset:17408
  ds_read_b128 v[80:83], v12 offset:18432
  ds_read_b128 v[84:87], v12 offset:19456
  ds_read_b128 v[88:91], v12 offset:20480
  ds_read_b128 v[92:95], v13 offset:21504
  s_waitcnt lgkmcnt(5)
  v_mfma_f32_16x16x32_bf16 v[128:131], a[176:179], v[72:75], 0
  s_waitcnt lgkmcnt(4)
  v_mfma_f32_16x16x32_bf16 v[128:131], a[180:183], v[76:79], v[128:131]
  s_waitcnt lgkmcnt(3)
  v_mfma_f32_16x16x32_bf16 v[128:131], a[184:187], v[80:83], v[128:131]
  s_waitcnt lgkmcnt(2)
  v_mfma_f32_16x16x32_bf16 v[128:131], a[188:191], v[84:87], v[128:131]
  s_waitcnt lgkmcnt(0)
  v_mfma_f32_16x16x32_bf16 v[128:131], v[92:95], v[88:91], v[128:131]
  v_mov_b32 v28, 0
  v_mov_b32 v29, 0
  v_mov_b32 v30, 0
  v_mov_b32 v31, 0
  v_mov_b32 v32, 0
  v_mov_b32 v33, 0
  v_mov_b32 v34, 0
  s_nop 0
  v_cvt_pk_bf16_f32 v68, v128, v129
  v_cvt_pk_bf16_f32 v69, v130, v131
  buffer_store_dwordx2 v[68:69], v61, s[4:7], s33 offen sc1
  buffer_store_dwordx2 v[68:69], v134, s[4:7], s33 offen sc1
  v_mov_b32 v35, 0
  v_mov_b32 v36, 0
  v_mov_b32 v37, 0
  v_mov_b32 v38, 0
  v_mov_b32 v39, 0
  v_mov_b32 v40, 0
  v_mov_b32 v41, 0
  v_mov_b32 v42, 0
  v_mov_b32 v43, 0
  v_mov_b32 v44, 0
  v_mov_b32 v45, 0
  v_mov_b32 v46, 0
  v_mov_b32 v47, 0
  v_mov_b32 v48, 0
  v_mov_b32 v49, 0
  v_mov_b32 v50, 0
  v_mov_b32 v51, 0
  v_mov_b32 v52, 0
  v_mov_b32 v53, 0
  v_mov_b32 v54, 0
  v_mov_b32 v55, 0
  v_mov_b32 v56, 0
  v_mov_b32 v57, 0
  v_mov_b32 v58, 0
  v_mov_b32 v59, 0
  s_xor_b32 s18, s18, s19
  s_xor_b32 s19, s19, s18
  s_xor_b32 s18, s18, s19
  s_xor_b32 s20, s20, s21
  s_xor_b32 s21, s21, s20
  s_xor_b32 s20, s20, s21
  s_add_u32 s72, s72, 1
  s_cmp_eq_u32 s72, 4
  s_cselect_b32 s72, 0, s72
  s_mov_b32 s73, 325632
  s_cselect_b32 s73, 0xfff11800, s73
  s_add_u32 s23, s23, s73
  s_mov_b32 s15, 0
  s_add_u32 s13, s17, 5120
  s_add_u32 s14, s17, 7168
  s_nop 15
  s_nop 15
  s_nop 15
  s_nop 15
  s_nop 15
  s_nop 15
  buffer_load_dwordx4 v[96:99], v62, s[4:7], s37 offen offset:0 sc1
  buffer_load_dwordx4 v[100:103], v62, s[4:7], s37 offen offset:512 sc1
  s_barrier
  buffer_store_dwordx4 v[92:95], v66, s[4:7], s25 offen sc1
  s_add_u32 s25, s25, s73
  s_add_u32 s12, s12, 1
  s_waitcnt vmcnt(1)
  v_mfma_f32_16x16x32_bf16 v[128:131], a[160:163], v[96:99], 0
  v_max3_u32 v14, v96, v97, v98
  v_max3_u32 v14, v14, v99, v100
  v_mfma_f32_16x16x32_bf16 v[128:131], a[160:163], v[100:103], v[128:131]
  v_max3_u32 v14, v14, v101, v102
  v_max_u32 v14, v14, v103
  v_cmp_eq_u32 vcc, -1, v14
  s_nop 4
  v_cvt_pk_bf16_f32 v68, v128, v129
  v_cvt_pk_bf16_f32 v69, v130, v131
  s_cbranch_vccnz mega_loop6_pbf
mega_loop6_pbok:
  buffer_store_dwordx2 v[68:69], v63, s[4:7], s17 offen sc1
  buffer_store_dwordx2 v[132:133], v63, s[4:7], s16 offen sc1
  s_barrier
  s_nop 15
  s_nop 15
  s_branch mega_loop6
mega_loop6_pcf:
  buffer_load_dwordx4 v[16:19], v2, s[4:7], s13 offen offset:0 sc1
  buffer_load_dwordx4 v[20:23], v2, s[4:7], s13 offen offset:1024 sc1
  buffer_load_dwordx4 v[24:27], v2, s[4:7], s14 offen offset:0 sc1
  s_nop 0
  v_mov_b32 v28, 0
  v_mov_b32 v29, 0
  v_mov_b32 v30, 0
  v_mov_b32 v31, 0
  v_mov_b32 v32, 0
  v_mov_b32 v33, 0
  v_mov_b32 v34, 0
  v_mov_b32 v35, 0
  s_add_u32 s15, s15, 16384
  s_cbranch_scc1 mega_fail
  s_branch mega_loop6_pc2
mega_loop6_last:
  v_smfmac_f32_16x16x64_bf16 v[56:59], v[24:27], a[136:143], v9
  ds_read_b128 a[188:191], v12 offset:33920
  s_waitcnt lgkmcnt(4)
  buffer_store_dwordx4 v[112:115], v64, s[4:7], s23 offen sc1
  v_smfmac_f32_16x16x64_bf16 v[52:55], v[72:75], a[0:7], v9
  buffer_store_dwordx2 v[116:117], v65, s[4:7], s23 offen sc1
  v_smfmac_f32_16x16x64_bf16 v[56:59], v[72:75], a[80:87], v9
  buffer_store_dwordx2 v[132:133], v10, s[4:7], s19 offen sc1
  v_smfmac_f32_16x16x64_bf16 v[52:55], v[76:79], a[8:15], v9
  v_smfmac_f32_16x16x64_bf16 v[56:59], v[76:79], a[88:95], v9
  v_smfmac_f32_16x16x64_bf16 v[52:55], v[80:83], a[16:23], v9
  v_smfmac_f32_16x16x64_bf16 v[56:59], v[80:83], a[96:103], v9
  v_smfmac_f32_16x16x64_bf16 v[52:55], v[84:87], a[24:31], v9
  v_smfmac_f32_16x16x64_bf16 v[56:59], v[84:87], a[104:111], v9
  v_smfmac_f32_16x16x64_bf16 v[52:55], v[88:91], a[32:39], v9
  v_smfmac_f32_16x16x64_bf16 v[56:59], v[88:91], a[112:119], v9
  v_smfmac_f32_16x16x64_bf16 v[52:55], v[92:95], a[64:71], v9
  v_smfmac_f32_16x16x64_bf16 v[56:59], v[92:95], a[144:151], v9
  v_smfmac_f32_16x16x64_bf16 v[52:55], v[96:99], a[72:79], v9
  v_smfmac_f32_16x16x64_bf16 v[56:59], v[96:99], a[152:159], v9
  s_nop 4
  v_add_f32 v52, v52, v54
  v_add_f32 v53, v53, v55
  v_cvt_pk_bf16_f32 v52, v52, v53
  ds_write_b32 v8, v52 offset:21504
  v_add_f32 v56, v56, v58
  v_add_f32 v57, v57, v59
  v_cvt_pk_bf16_f32 v56, v56, v57
  ds_write_b32 v8, v56 offset:22528
  s_waitcnt vmcnt(0)
  s_add_u32 s27, s12, 1
  v_mov_b32 v14, s27
  buffer_store_dword v14, v67, s[4:7], s77 offen offset:0 sc1
  s_waitcnt lgkmcnt(0)
  s_barrier
  ds_read_b128 v[92:95], v13 offset:21504
  s_waitcnt lgkmcnt(0)
  buffer_store_dwordx4 v[92:95], v66, s[4:7], s25 offen sc1
  s_waitcnt vmcnt(0)
  s_barrier
  s_add_u32 s27, s12, 1
  v_mov_b32 v14, s27
  buffer_store_dword v14, v67, s[4:7], s77 offen offset:16 sc1
  s_cmp_lg_u32 s70, 0
  s_cbranch_scc1 mega_end
  s_lshl_b32 s73, s2, 2
  s_add_u32 s73, s73, s3
  s_branch mega_bjobs
mega_loop6_pbf:
  buffer_load_dwordx4 v[96:99], v62, s[4:7], s37 offen offset:0 sc1
  buffer_load_dwordx4 v[100:103], v62, s[4:7], s37 offen offset:512 sc1
mega_loop6_pbl:
  buffer_load_dwordx4 v[96:99], v62, s[4:7], s37 offen offset:0 sc1
  buffer_load_dwordx4 v[100:103], v62, s[4:7], s37 offen offset:512 sc1
  s_add_u32 s15, s15, 16384
  s_cbranch_scc1 mega_fail
  s_waitcnt vmcnt(2)
  v_max3_u32 v14, v96, v97, v98
  v_max3_u32 v14, v14, v99, v100
  v_mfma_f32_16x16x32_bf16 v[128:131], a[160:163], v[96:99], 0
  v_max3_u32 v14, v14, v101, v102
  v_max_u32 v14, v14, v103
  v_mfma_f32_16x16x32_bf16 v[128:131], a[160:163], v[100:103], v[128:131]
  v_cmp_eq_u32 vcc, -1, v14
  s_nop 6
  v_cvt_pk_bf16_f32 v68, v128, v129
  v_cvt_pk_bf16_f32 v69, v130, v131
  s_cbranch_vccnz mega_loop6_pbl
  s_branch mega_loop6_pbok
mega_loop7:
  buffer_load_dwordx4 v[16:19], v2, s[4:7], s13 offen offset:0 sc1
  buffer_load_dwordx4 v[20:23], v2, s[4:7], s13 offen offset:1024 sc1
  buffer_load_dwordx4 v[24:27], v2, s[4:7], s14 offen offset:0 sc1
  s_xor_b32 s16, s16, s17
  s_xor_b32 s17, s17, s16
  s_xor_b32 s16, s16, s17
  s_mov_b32 m0, 8192
  s_nop 15
  s_nop 15
  s_nop 3
  buffer_load_dwordx4 v[16:19], v2, s[4:7], s13 offen offset:0 sc1
  buffer_load_dwordx4 v[20:23], v2, s[4:7], s13 offen offset:1024 sc1
  buffer_load_dwordx4 v[24:27], v2, s[4:7], s14 offen offset:0 sc1
mega_loop7_pc2:
  s_waitcnt vmcnt(3)
  v_max3_u32 v14, v16, v17, v18
  v_max3_u32 v14, v14, v19, v20
  v_smfmac_f32_16x16x64_bf16 v[44:47], v[16:19], v[136:143], v9
  v_max3_u32 v14, v14, v21, v22
  v_max3_u32 v14, v14, v23, v24
  v_smfmac_f32_16x16x64_bf16 v[48:51], v[16:19], v[144:151], v9
  v_max3_u32 v14, v14, v25, v26
  v_max_u32 v14, v14, v27
  v_smfmac_f32_16x16x64_bf16 v[44:47], v[20:23], v[152:159], v9
  v_cmp_eq_u32 vcc, -1, v14
  v_smfmac_f32_16x16x64_bf16 v[48:51], v[20:23], v[160:167], v9
  s_cbranch_vccnz mega_loop7_pcf
  v_smfmac_f32_16x16x64_bf16 v[44:47], v[24:27], v[168:175], v9
  ds_write_b128 v2, v[16:19] offset:8192
  v_smfmac_f32_16x16x64_bf16 v[48:51], v[24:27], v[176:183], v9
  ds_write_b128 v2, v[20:23] offset:9216
  v_smfmac_f32_16x16x64_bf16 v[36:39], v[16:19], v[184:191], v9
  v_smfmac_f32_16x16x64_bf16 v[40:43], v[16:19], v[192:199], v9
  v_add_f32 v44, v44, v46
  v_smfmac_f32_16x16x64_bf16 v[36:39], v[20:23], v[200:207], v9
  v_add_f32 v45, v45, v47
  v_cvt_pk_bf16_f32 v46, v44, v45
  v_smfmac_f32_16x16x64_bf16 v[40:43], v[20:23], v[208:215], v9
  v_add_f32 v48, v48, v50
  v_smfmac_f32_16x16x64_bf16 v[40:43], v[24:27], v[216:223], v9
  v_add_f32 v49, v49, v51
  v_cvt_pk_bf16_f32 v47, v48, v49
  v_smfmac_f32_16x16x64_bf16 v[28:31], v[16:19], v[224:231], v9
  ds_write_b64 v3, v[46:47] offset:14336
  v_smfmac_f32_16x16x64_bf16 v[32:35], v[16:19], v[232:239], v9
  v_add_f32 v36, v36, v38
  v_smfmac_f32_16x16x64_bf16 v[28:31], v[20:23], v[240:247], v9
  v_add_f32 v37, v37, v39
  v_cvt_pk_bf16_f32 v38, v36, v37
  v_smfmac_f32_16x16x64_bf16 v[32:35], v[20:23], v[248:255], v9
  v_add_f32 v40, v40, v42
  v_add_f32 v41, v41, v43
  v_cvt_pk_bf16_f32 v39, v40, v41
  ds_write_b64 v3, v[38:39] offset:12288
  s_nop 0
  v_add_f32 v28, v28, v30
  v_add_f32 v29, v29, v31
  v_cvt_pk_bf16_f32 v30, v28, v29
  v_add_f32 v32, v32, v34
  v_add_f32 v33, v33, v35
  v_cvt_pk_bf16_f32 v31, v32, v33
  ds_write_b64 v3, v[30:31] offset:10240
  v_smfmac_f32_16x16x64_bf16 v[52:55], v[16:19], a[64:71], v9
  v_smfmac_f32_16x16x64_bf16 v[56:59], v[16:19], a[144:151], v9
  v_smfmac_f32_16x16x64_bf16 v[60:63], v[16:19], a[224:231], v9
  s_waitcnt lgkmcnt(0)
  s_barrier
  v_smfmac_f32_16x16x64_bf16 v[64:67], v[16:19], v[120:127], v9
  v_smfmac_f32_16x16x64_bf16 v[52:55], v[20:23], a[72:79], v9
  v_smfmac_f32_16x16x64_bf16 v[56:59], v[20:23], a[152:159], v9
  ds_read_b128 v[40:43], v2 offset:0
  v_smfmac_f32_16x16x64_bf16 v[60:63], v[20:23], a[232:239], v9
  ds_read_b128 v[28:31], v2 offset:1024
  v_smfmac_f32_16x16x64_bf16 v[64:67], v[20:23], v[128:135], v9
  ds_read_b128 v[32:35], v2 offset:2048
  v_smfmac_f32_16x16x64_bf16 v[52:55], v[24:27], a[56:63], v9
  ds_read_b128 v[36:39], v2 offset:3072
  v_smfmac_f32_16x16x64_bf16 v[56:59], v[24:27], a[136:143], v9
  ds_read_b128 v[44:47], v2 offset:4096
  v_smfmac_f32_16x16x64_bf16 v[60:63], v[24:27], a[216:223], v9
  ds_read_b128 v[48:51], v2 offset:5120
  v_smfmac_f32_16x16x64_bf16 v[64:67], v[24:27], v[112:119], v9
  s_cmp_eq_u32 s12, 63
  s_cbranch_scc1 mega_loop7_last
  s_waitcnt lgkmcnt(0)
  v_smfmac_f32_16x16x64_bf16 v[52:55], v[40:43], a[0:7], v9
  v_smfmac_f32_16x16x64_bf16 v[56:59], v[40:43], a[80:87], v9
  v_smfmac_f32_16x16x64_bf16 v[60:63], v[40:43], a[160:167], v9
  v_smfmac_f32_16x16x64_bf16 v[64:67], v[40:43], a[240:247], v9
  ds_read_b128 v[40:43], v2 offset:6144
  v_smfmac_f32_16x16x64_bf16 v[52:55], v[28:31], a[8:15], v9
  v_smfmac_f32_16x16x64_bf16 v[56:59], v[28:31], a[88:95], v9
  v_smfmac_f32_16x16x64_bf16 v[60:63], v[28:31], a[168:175], v9
  v_smfmac_f32_16x16x64_bf16 v[64:67], v[28:31], a[248:255], v9
  ds_read_b128 v[28:31], v2 offset:37888
  v_smfmac_f32_16x16x64_bf16 v[52:55], v[32:35], a[16:23], v9
  v_smfmac_f32_16x16x64_bf16 v[56:59], v[32:35], a[96:103], v9
  v_smfmac_f32_16x16x64_bf16 v[60:63], v[32:35], a[176:183], v9
  v_smfmac_f32_16x16x64_bf16 v[64:67], v[32:35], v[72:79], v9
  ds_read_b128 v[32:35], v2 offset:38912
  v_smfmac_f32_16x16x64_bf16 v[52:55], v[36:39], a[24:31], v9
  v_smfmac_f32_16x16x64_bf16 v[56:59], v[36:39], a[104:111], v9
  v_smfmac_f32_16x16x64_bf16 v[60:63], v[36:39], a[184:191], v9
  v_smfmac_f32_16x16x64_bf16 v[64:67], v[36:39], v[80:87], v9
  ds_read_b128 v[36:39], v2 offset:39936
  v_smfmac_f32_16x16x64_bf16 v[52:55], v[44:47], a[32:39], v9
  v_smfmac_f32_16x16x64_bf16 v[56:59], v[44:47], a[112:119], v9
  v_smfmac_f32_16x16x64_bf16 v[60:63], v[44:47], a[192:199], v9
  v_smfmac_f32_16x16x64_bf16 v[64:67], v[44:47], v[88:95], v9
  v_smfmac_f32_16x16x64_bf16 v[52:55], v[48:51], a[40:47], v9
  v_smfmac_f32_16x16x64_bf16 v[56:59], v[48:51], a[120:127], v9
  v_smfmac_f32_16x16x64_bf16 v[60:63], v[48:51], a[200:207], v9
  v_smfmac_f32_16x16x64_bf16 v[64:67], v[48:51], v[96:103], v9
  buffer_load_dword v13, v12, s[4:7], s71 offen sc1
  s_waitcnt lgkmcnt(3)
  v_smfmac_f32_16x16x64_bf16 v[52:55], v[40:43], a[48:55], v9
  buffer_load_dwordx4 v[16:19], v4, s[4:7], s20 offen sc1
  v_smfmac_f32_16x16x64_bf16 v[56:59], v[40:43], a[128:135], v9
  buffer_load_dwordx4 v[20:23], v4, s[4:7], s20 offen offset:256 sc1
  v_smfmac_f32_16x16x64_bf16 v[60:63], v[40:43], a[208:215], v9
  buffer_load_dwordx4 v[24:27], v5, s[4:7], s20 offen offset:512 sc1
  v_smfmac_f32_16x16x64_bf16 v[64:67], v[40:43], v[104:111], v9
  v_add_f32 v52, v52, v54
  v_add_f32 v53, v53, v55
  v_cvt_pk_bf16_f32 v52, v52, v53
  ds_write_b32 v8, v52 offset:21504
  v_add_f32 v56, v56, v58
  v_add_f32 v57, v57, v59
  v_cvt_pk_bf16_f32 v56, v56, v57
  ds_write_b32 v8, v56 offset:22528
  v_add_f32 v60, v60, v62
  v_add_f32 v61, v61, v63
  v_cvt_pk_bf16_f32 v60, v60, v61
  ds_write_b32 v10, v60 offset:23552
  v_add_f32 v64, v64, v66
  v_add_f32 v65, v65, v67
  v_cvt_pk_bf16_f32 v64, v64, v65
  ds_write_b32 v10, v64 offset:24064
mega_loop7_pa:
  buffer_load_dwordx4 v[16:19], v4, s[4:7], s20 offen sc1
  buffer_load_dwordx4 v[20:23], v4, s[4:7], s20 offen offset:256 sc1
  buffer_load_dwordx4 v[24:27], v5, s[4:7], s20 offen offset:512 sc1
  s_add_u32 s15, s15, 16384
  s_cbranch_scc1 mega_fail
  s_waitcnt vmcnt(3) lgkmcnt(0)
  v_max3_u32 v14, v16, v17, v18
  v_max3_u32 v14, v14, v19, v20
  v_mfma_f32_16x16x32_bf16 v[40:43], v[16:19], v[28:31], 0
  v_max3_u32 v14, v14, v21, v22
  v_max3_u32 v14, v14, v23, v24
  v_mfma_f32_16x16x32_bf16 v[40:43], v[20:23], v[32:35], v[40:43]
  v_max3_u32 v14, v14, v25, v26
  v_max_u32 v14, v14, v27
  v_mfma_f32_16x16x32_bf16 v[44:47], v[24:27], v[36:39], 0
  v_cmp_eq_u32 vcc, -1, v14
  s_nop 3
  v_max3_f32 v48, v40, v41, v42
  s_cbranch_vccnz mega_loop7_pa
  s_nop 0
  v_cndmask_b32 v44, v44, v45, s[42:43]
  v_max3_f32 v48, v48, v43, v44
  s_nop 1
  v_max_f32_dpp v48, v48, v48 quad_perm:[1,0,3,2] row_mask:0xf bank_mask:0xf
  s_nop 1
  v_max_f32_dpp v48, v48, v48 quad_perm:[2,3,0,1] row_mask:0xf bank_mask:0xf
  s_nop 1
  v_max_f32_dpp v48, v48, v48 row_half_mirror row_mask:0xf bank_mask:0xf
  v_mul_f32 v48, v0, v48
  v_pk_fma_f32 v[40:41], v[40:41], v[0:1], v[48:49] op_sel_hi:[1,0,0] neg_lo:[0,1,0] neg_hi:[0,1,0]
  v_pk_fma_f32 v[42:43], v[42:43], v[0:1], v[48:49] op_sel_hi:[1,0,0] neg_lo:[0,1,0] neg_hi:[0,1,0]
  v_fma_f32 v44, v44, -v0, v48
  v_exp_f32 v40, v40
  v_exp_f32 v41, v41
  v_exp_f32 v42, v42
  v_exp_f32 v43, v43
  v_exp_f32 v44, v44
  v_pk_add_f32 v[48:49], v[40:41], v[42:43]
  v_add_f32 v48, v48, v49
  v_add_f32 v48, v48, v44
  s_nop 1
  v_add_f32_dpp v48, v48, v48 quad_perm:[1,0,3,2] row_mask:0xf bank_mask:0xf
  s_nop 1
  v_add_f32_dpp v48, v48, v48 quad_perm:[2,3,0,1] row_mask:0xf bank_mask:0xf
  s_nop 1
  v_add_f32_dpp v48, v48, v48 row_half_mirror row_mask:0xf bank_mask:0xf
  v_rcp_f32 v48, v48
  s_nop 0
  v_pk_mul_f32 v[40:41], v[40:41], v[48:49] op_sel_hi:[1,0]
  v_pk_mul_f32 v[42:43], v[42:43], v[48:49] op_sel_hi:[1,0]
  v_mul_f32 v44, v44, v48
  v_cvt_pk_bf16_f32 v40, v40, v41
  v_cvt_pk_bf16_f32 v41, v42, v43
  ds_write_b64 v6, v[40:41] offset:16384
  v_cvt_pk_bf16_f32 v44, v44, v44
  ds_write_b16 v7, v44 offset:20480
  v_min_u32_dpp v13, v13, v13 quad_perm:[1,0,3,2] row_mask:0xf bank_mask:0xf
  s_nop 1
  v_min_u32_dpp v13, v13, v13 quad_perm:[2,3,0,1] row_mask:0xf bank_mask:0xf
  s_nop 1
  v_min_u32_dpp v13, v13, v13 row_half_mirror row_mask:0xf bank_mask:0xf
  s_nop 0
  v_readfirstlane_b32 s76, v13
  s_waitcnt lgkmcnt(0)
  s_barrier
  v_mov_b32 v28, 0
  v_mov_b32 v29, 0
  v_mov_b32 v30, 0
  v_mov_b32 v31, 0
  v_mov_b32 v32, 0
  v_mov_b32 v33, 0
  v_mov_b32 v34, 0
  v_mov_b32 v35, 0
  v_mov_b32 v36, 0
  v_mov_b32 v37, 0
  v_mov_b32 v38, 0
  v_mov_b32 v39, 0
  v_mov_b32 v40, 0
  v_mov_b32 v41, 0
  v_mov_b32 v42, 0
  v_mov_b32 v43, 0
  v_mov_b32 v44, 0
  v_mov_b32 v45, 0
  v_mov_b32 v46, 0
  v_mov_b32 v47, 0
  v_mov_b32 v48, 0
  v_mov_b32 v49, 0
  v_mov_b32 v50, 0
  v_mov_b32 v51, 0
  v_mov_b32 v52, 0
  v_mov_b32 v53, 0
  v_mov_b32 v54, 0
  v_mov_b32 v55, 0
  v_mov_b32 v56, 0
  v_mov_b32 v57, 0
  v_mov_b32 v58, 0
  v_mov_b32 v59, 0
  v_mov_b32 v60, 0
  v_mov_b32 v61, 0
  v_mov_b32 v62, 0
  v_mov_b32 v63, 0
  v_mov_b32 v64, 0
  v_mov_b32 v65, 0
  v_mov_b32 v66, 0
  v_mov_b32 v67, 0
  s_xor_b32 s18, s18, s19
  s_xor_b32 s19, s19, s18
  s_xor_b32 s18, s18, s19
  s_xor_b32 s20, s20, s21
  s_xor_b32 s21, s21, s20
  s_xor_b32 s20, s20, s21
  s_mov_b32 s15, 0
  s_add_u32 s13, s17, 8192
  s_add_u32 s14, s17, 7168
  s_barrier
  s_add_u32 s29, s12, 2
  s_cmp_lt_u32 s76, s29
  s_cbranch_scc1 mega0_kernel_sd26_wait
mega0_kernel_sd26_go:
  s_mov_b32 m0, 24576
  s_add_u32 s27, s24, 0
  buffer_load_dwordx4 v11, s[4:7], s27 offen offset:0 sc1 lds
  buffer_load_dwordx4 v11, s[4:7], s27 offen offset:1024 sc1 lds
  s_mov_b32 m0, 32768
  s_nop 0
  buffer_load_dwordx4 v68, s[4:7], s27 offen sc1 lds
  s_mov_b32 m0, 26624
  s_add_u32 s27, s24, 40960
  buffer_load_dwordx4 v11, s[4:7], s27 offen offset:0 sc1 lds
  buffer_load_dwordx4 v11, s[4:7], s27 offen offset:1024 sc1 lds
  s_mov_b32 m0, 28672
  s_add_u32 s27, s24, 81920
  buffer_load_dwordx4 v11, s[4:7], s27 offen offset:0 sc1 lds
  buffer_load_dwordx4 v11, s[4:7], s27 offen offset:1024 sc1 lds
  s_mov_b32 m0, 33792
  s_nop 0
  buffer_load_dwordx4 v68, s[4:7], s27 offen sc1 lds
  s_mov_b32 m0, 30720
  s_add_u32 s27, s24, 122880
  buffer_load_dwordx4 v11, s[4:7], s27 offen offset:0 sc1 lds
  buffer_load_dwordx4 v11, s[4:7], s27 offen offset:1024 sc1 lds
  s_mov_b32 m0, 34816
  s_add_u32 s27, s22, 0
  buffer_load_dwordx4 v2, s[4:7], s27 offen offset:0 sc1 lds
  s_add_u32 s27, s22, 3072
  buffer_load_dwordx4 v2, s[4:7], s27 offen offset:1024 sc1 lds
  s_add_u32 s27, s22, 6144
  buffer_load_dwordx4 v2, s[4:7], s27 offen offset:2048 sc1 lds
  s_add_u32 s72, s72, 1
  s_cmp_eq_u32 s72, 4
  s_cselect_b32 s72, 0, s72
  s_mov_b32 s73, 325632
  s_cselect_b32 s73, 0xfff11800, s73
  s_add_u32 s22, s22, s73
  s_add_u32 s24, s24, s73
  s_add_u32 s12, s12, 1
  s_barrier
  s_nop 15
  s_nop 15
  s_branch mega_loop7
mega_loop7_pcf:
  buffer_load_dwordx4 v[16:19], v2, s[4:7], s13 offen offset:0 sc1
  buffer_load_dwordx4 v[20:23], v2, s[4:7], s13 offen offset:1024 sc1
  buffer_load_dwordx4 v[24:27], v2, s[4:7], s14 offen offset:0 sc1
  s_nop 0
  v_mov_b32 v44, 0
  v_mov_b32 v45, 0
  v_mov_b32 v46, 0
  v_mov_b32 v47, 0
  v_mov_b32 v48, 0
  v_mov_b32 v49, 0
  v_mov_b32 v50, 0
  v_mov_b32 v51, 0
  s_add_u32 s15, s15, 16384
  s_cbranch_scc1 mega_fail
  s_branch mega_loop7_pc2
mega_loop7_last:
  s_waitcnt lgkmcnt(0)
  v_smfmac_f32_16x16x64_bf16 v[52:55], v[40:43], a[0:7], v9
  v_smfmac_f32_16x16x64_bf16 v[56:59], v[40:43], a[80:87], v9
  v_smfmac_f32_16x16x64_bf16 v[60:63], v[40:43], a[160:167], v9
  v_smfmac_f32_16x16x64_bf16 v[64:67], v[40:43], a[240:247], v9
  ds_read_b128 v[40:43], v2 offset:6144
  v_smfmac_f32_16x16x64_bf16 v[52:55], v[28:31], a[8:15], v9
  v_smfmac_f32_16x16x64_bf16 v[56:59], v[28:31], a[88:95], v9
  v_smfmac_f32_16x16x64_bf16 v[60:63], v[28:31], a[168:175], v9
  v_smfmac_f32_16x16x64_bf16 v[64:67], v[28:31], a[248:255], v9
  ds_read_b128 v[28:31], v2 offset:37888
  v_smfmac_f32_16x16x64_bf16 v[52:55], v[32:35], a[16:23], v9
  v_smfmac_f32_16x16x64_bf16 v[56:59], v[32:35], a[96:103], v9
  v_smfmac_f32_16x16x64_bf16 v[60:63], v[32:35], a[176:183], v9
  v_smfmac_f32_16x16x64_bf16 v[64:67], v[32:35], v[72:79], v9
  ds_read_b128 v[32:35], v2 offset:38912
  v_smfmac_f32_16x16x64_bf16 v[52:55], v[36:39], a[24:31], v9
  v_smfmac_f32_16x16x64_bf16 v[56:59], v[36:39], a[104:111], v9
  v_smfmac_f32_16x16x64_bf16 v[60:63], v[36:39], a[184:191], v9
  v_smfmac_f32_16x16x64_bf16 v[64:67], v[36:39], v[80:87], v9
  ds_read_b128 v[36:39], v2 offset:39936
  v_smfmac_f32_16x16x64_bf16 v[52:55], v[44:47], a[32:39], v9
  v_smfmac_f32_16x16x64_bf16 v[56:59], v[44:47], a[112:119], v9
  v_smfmac_f32_16x16x64_bf16 v[60:63], v[44:47], a[192:199], v9
  v_smfmac_f32_16x16x64_bf16 v[64:67], v[44:47], v[88:95], v9
  v_smfmac_f32_16x16x64_bf16 v[52:55], v[48:51], a[40:47], v9
  v_smfmac_f32_16x16x64_bf16 v[56:59], v[48:51], a[120:127], v9
  v_smfmac_f32_16x16x64_bf16 v[60:63], v[48:51], a[200:207], v9
  v_smfmac_f32_16x16x64_bf16 v[64:67], v[48:51], v[96:103], v9
  s_waitcnt lgkmcnt(3)
  v_smfmac_f32_16x16x64_bf16 v[52:55], v[40:43], a[48:55], v9
  v_smfmac_f32_16x16x64_bf16 v[56:59], v[40:43], a[128:135], v9
  v_smfmac_f32_16x16x64_bf16 v[60:63], v[40:43], a[208:215], v9
  v_smfmac_f32_16x16x64_bf16 v[64:67], v[40:43], v[104:111], v9
  v_add_f32 v52, v52, v54
  v_add_f32 v53, v53, v55
  v_cvt_pk_bf16_f32 v52, v52, v53
  ds_write_b32 v8, v52 offset:21504
  v_add_f32 v56, v56, v58
  v_add_f32 v57, v57, v59
  v_cvt_pk_bf16_f32 v56, v56, v57
  ds_write_b32 v8, v56 offset:22528
  v_add_f32 v60, v60, v62
  v_add_f32 v61, v61, v63
  v_cvt_pk_bf16_f32 v60, v60, v61
  ds_write_b32 v10, v60 offset:23552
  v_add_f32 v64, v64, v66
  v_add_f32 v65, v65, v67
  v_cvt_pk_bf16_f32 v64, v64, v65
  ds_write_b32 v10, v64 offset:24064
  s_waitcnt lgkmcnt(0)
  s_barrier
  s_barrier
  s_cmp_lg_u32 s70, 0
  s_cbranch_scc1 mega_end
  s_lshl_b32 s73, s2, 2
  s_add_u32 s73, s73, s3
  s_branch mega_bjobs
mega0_kernel_sd26_wait:
  s_mov_b32 s15, 0
mega0_kernel_sd26_w2:
  buffer_load_dword v13, v12, s[4:7], s71 offen sc1
  s_waitcnt vmcnt(0)
  v_min_u32_dpp v13, v13, v13 quad_perm:[1,0,3,2] row_mask:0xf bank_mask:0xf
  s_nop 1
  v_min_u32_dpp v13, v13, v13 quad_perm:[2,3,0,1] row_mask:0xf bank_mask:0xf
  s_nop 1
  v_min_u32_dpp v13, v13, v13 row_half_mirror row_mask:0xf bank_mask:0xf
  s_nop 0
  v_readfirstlane_b32 s76, v13
  s_nop 0
  s_cmp_ge_u32 s76, s29
  s_cbranch_scc1 mega0_kernel_sd26_go
  s_sleep 1
  s_add_u32 s15, s15, 1
  s_cmp_lt_u32 s15, 262144
  s_cbranch_scc1 mega0_kernel_sd26_w2
  s_branch mega_fail
mega_fail:
  s_mov_b64 exec, 1
  v_mov_b32 v24, s79
  v_add_u32 v24, 0x1000, v24
  v_mov_b32 v25, 64
  buffer_store_dword v24, v25, s[44:47], 0 offen
mega_end:
  s_endpgm

.globl mega1_kernel
.p2align 8
.type mega1_kernel,@function
mega1_kernel:
  s_mov_b32 s70, 1
  s_mov_b32 s99, 0
  s_branch mega_common

.globl b1_kernel
.p2align 8
.type b1_kernel,@function
b1_kernel:
  s_load_dwordx2 s[4:5], s[0:1], 104
  s_mov_b32 s6, 0x10000000
  s_mov_b32 s7, 0x20000
  v_lshrrev_b32 v1, 6, v0
  s_nop 0
  v_readfirstlane_b32 s3, v1
  v_and_b32 v1, 63, v0
  s_cmp_ge_u32 s2, 256
  s_cbranch_scc1 b1_end
  s_bfe_u32 s8, s2, 0x20001
  s_lshl_b32 s8, s8, 3
  s_lshr_b32 s9, s2, 5
  s_add_u32 s8, s8, s9
  s_and_b32 s9, s2, 1
  s_lshl_b32 s9, s9, 2
  s_bfe_u32 s10, s2, 0x20003
  s_add_u32 s9, s9, s10
  s_lshl_b32 s10, s8, 2
  s_add_u32 s10, s10, s3
  v_lshlrev_b32 v2, 4, v1
  v_add_u32 v3, 61440, v2
  v_add_u32 v6, 122880, v2
  v_and_b32 v4, 15, v1
  v_lshrrev_b32 v5, 4, v1
  s_mul_i32 s11, s10, 20480
  s_add_u32 s11, s11, 50790400
  s_mov_b32 s31, 0x3fb8aa3b
  s_waitcnt lgkmcnt(0)
  s_cmp_eq_u32 s3, 4
  s_cbranch_scc0 b1_comp
  s_mul_i32 s12, s9, 307200
  s_add_u32 s12, s12, 93491200
  s_sleep 2
  s_mov_b32 m0, 0
  s_nop 0
  buffer_load_dwordx4 v2, s[4:7], s12 offen offset:0 lds
  buffer_load_dwordx4 v2, s[4:7], s12 offen offset:1024 lds
  buffer_load_dwordx4 v2, s[4:7], s12 offen offset:2048 lds
  buffer_load_dwordx4 v2, s[4:7], s12 offen offset:3072 lds
  s_mov_b32 m0, 4096
  s_add_u32 s12, s12, 4096
  buffer_load_dwordx4 v2, s[4:7], s12 offen offset:0 lds
  buffer_load_dwordx4 v2, s[4:7], s12 offen offset:1024 lds
  buffer_load_dwordx4 v2, s[4:7], s12 offen offset:2048 lds
  buffer_load_dwordx4 v2, s[4:7], s12 offen offset:3072 lds
  s_mov_b32 m0, 8192
  s_add_u32 s12, s12, 4096
  buffer_load_dwordx4 v2, s[4:7], s12 offen offset:0 lds
  buffer_load_dwordx4 v2, s[4:7], s12 offen offset:1024 lds
  buffer_load_dwordx4 v2, s[4:7], s12 offen offset:2048 lds
  buffer_load_dwordx4 v2, s[4:7], s12 offen offset:3072 lds
  s_mov_b32 m0, 12288
  s_add_u32 s12, s12, 4096
  buffer_load_dwordx4 v2, s[4:7], s12 offen offset:0 lds
  buffer_load_dwordx4 v2, s[4:7], s12 offen offset:1024 lds
  buffer_load_dwordx4 v2, s[4:7], s12 offen offset:2048 lds
  s_add_u32 s12, s12, 3072
  s_mov_b32 m0, 15360
  s_nop 0
  buffer_load_dwordx4 v2, s[4:7], s12 offen offset:0 lds
  buffer_load_dwordx4 v2, s[4:7], s12 offen offset:1024 lds
  buffer_load_dwordx4 v2, s[4:7], s12 offen offset:2048 lds
  buffer_load_dwordx4 v2, s[4:7], s12 offen offset:3072 lds
  s_mov_b32 m0, 19456
  s_add_u32 s12, s12, 4096
  buffer_load_dwordx4 v2, s[4:7], s12 offen offset:0 lds
  buffer_load_dwordx4 v2, s[4:7], s12 offen offset:1024 lds
  buffer_load_dwordx4 v2, s[4:7], s12 offen offset:2048 lds
  buffer_load_dwordx4 v2, s[4:7], s12 offen offset:3072 lds
  s_mov_b32 m0, 23552
  s_add_u32 s12, s12, 4096
  buffer_load_dwordx4 v2, s[4:7], s12 offen offset:0 lds
  buffer_load_dwordx4 v2, s[4:7], s12 offen offset:1024 lds
  buffer_load_dwordx4 v2, s[4:7], s12 offen offset:2048 lds
  buffer_load_dwordx4 v2, s[4:7], s12 offen offset:3072 lds
  s_mov_b32 m0, 27648
  s_add_u32 s12, s12, 4096
  buffer_load_dwordx4 v2, s[4:7], s12 offen offset:0 lds
  buffer_load_dwordx4 v2, s[4:7], s12 offen offset:1024 lds
  buffer_load_dwordx4 v2, s[4:7], s12 offen offset:2048 lds
  s_add_u32 s12, s12, 3072
  s_mov_b32 m0, 30720
  s_nop 0
  buffer_load_dwordx4 v2, s[4:7], s12 offen offset:0 lds
  buffer_load_dwordx4 v2, s[4:7], s12 offen offset:1024 lds
  buffer_load_dwordx4 v2, s[4:7], s12 offen offset:2048 lds
  buffer_load_dwordx4 v2, s[4:7], s12 offen offset:3072 lds
  s_mov_b32 m0, 34816
  s_add_u32 s12, s12, 4096
  buffer_load_dwordx4 v2, s[4:7], s12 offen offset:0 lds
  buffer_load_dwordx4 v2, s[4:7], s12 offen offset:1024 lds
  buffer_load_dwordx4 v2, s[4:7], s12 offen offset:2048 lds
  buffer_load_dwordx4 v2, s[4:7], s12 offen offset:3072 lds
  s_mov_b32 m0, 38912
  s_add_u32 s12, s12, 4096
  buffer_load_dwordx4 v2, s[4:7], s12 offen offset:0 lds
  buffer_load_dwordx4 v2, s[4:7], s12 offen offset:1024 lds
  buffer_load_dwordx4 v2, s[4:7], s12 offen offset:2048 lds
  buffer_load_dwordx4 v2, s[4:7], s12 offen offset:3072 lds
  s_mov_b32 m0, 43008
  s_add_u32 s12, s12, 4096
  buffer_load_dwordx4 v2, s[4:7], s12 offen offset:0 lds
  buffer_load_dwordx4 v2, s[4:7], s12 offen offset:1024 lds
  buffer_load_dwordx4 v2, s[4:7], s12 offen offset:2048 lds
  s_add_u32 s12, s12, 3072
  s_mov_b32 m0, 46080
  s_nop 0
  buffer_load_dwordx4 v2, s[4:7], s12 offen offset:0 lds
  buffer_load_dwordx4 v2, s[4:7], s12 offen offset:1024 lds
  buffer_load_dwordx4 v2, s[4:7], s12 offen offset:2048 lds
  buffer_load_dwordx4 v2, s[4:7], s12 offen offset:3072 lds
  s_mov_b32 m0, 50176
  s_add_u32 s12, s12, 4096
  buffer_load_dwordx4 v2, s[4:7], s12 offen offset:0 lds
  buffer_load_dwordx4 v2, s[4:7], s12 offen offset:1024 lds
  buffer_load_dwordx4 v2, s[4:7], s12 offen offset:2048 lds
  buffer_load_dwordx4 v2, s[4:7], s12 offen offset:3072 lds
  s_mov_b32 m0, 54272
  s_add_u32 s12, s12, 4096
  buffer_load_dwordx4 v2, s[4:7], s12 offen offset:0 lds
  buffer_load_dwordx4 v2, s[4:7], s12 offen offset:1024 lds
  buffer_load_dwordx4 v2, s[4:7], s12 offen offset:2048 lds
  buffer_load_dwordx4 v2, s[4:7], s12 offen offset:3072 lds
  s_mov_b32 m0, 58368
  s_add_u32 s12, s12, 4096
  buffer_load_dwordx4 v2, s[4:7], s12 offen offset:0 lds
  buffer_load_dwordx4 v2, s[4:7], s12 offen offset:1024 lds
  buffer_load_dwordx4 v2, s[4:7], s12 offen offset:2048 lds
  s_add_u32 s12, s12, 3072
  s_waitcnt vmcnt(45)
  s_mov_b32 m0, 61440
  s_nop 0
  buffer_load_dwordx4 v2, s[4:7], s12 offen offset:0 lds
  buffer_load_dwordx4 v2, s[4:7], s12 offen offset:1024 lds
  buffer_load_dwordx4 v2, s[4:7], s12 offen offset:2048 lds
  buffer_load_dwordx4 v2, s[4:7], s12 offen offset:3072 lds
  s_mov_b32 m0, 65536
  s_add_u32 s12, s12, 4096
  buffer_load_dwordx4 v2, s[4:7], s12 offen offset:0 lds
  buffer_load_dwordx4 v2, s[4:7], s12 offen offset:1024 lds
  buffer_load_dwordx4 v2, s[4:7], s12 offen offset:2048 lds
  buffer_load_dwordx4 v2, s[4:7], s12 offen offset:3072 lds
  s_mov_b32 m0, 69632
  s_add_u32 s12, s12, 4096
  buffer_load_dwordx4 v2, s[4:7], s12 offen offset:0 lds
  buffer_load_dwordx4 v2, s[4:7], s12 offen offset:1024 lds
  buffer_load_dwordx4 v2, s[4:7], s12 offen offset:2048 lds
  buffer_load_dwordx4 v2, s[4:7], s12 offen offset:3072 lds
  s_mov_b32 m0, 73728
  s_add_u32 s12, s12, 4096
  buffer_load_dwordx4 v2, s[4:7], s12 offen offset:0 lds
  buffer_load_dwordx4 v2, s[4:7], s12 offen offset:1024 lds
  buffer_load_dwordx4 v2, s[4:7], s12 offen offset:2048 lds
  s_add_u32 s12, s12, 3072
  s_waitcnt vmcnt(45)
  s_mov_b32 m0, 76800
  s_nop 0
  buffer_load_dwordx4 v2, s[4:7], s12 offen offset:0 lds
  buffer_load_dwordx4 v2, s[4:7], s12 offen offset:1024 lds
  buffer_load_dwordx4 v2, s[4:7], s12 offen offset:2048 lds
  buffer_load_dwordx4 v2, s[4:7], s12 offen offset:3072 lds
  s_mov_b32 m0, 80896
  s_add_u32 s12, s12, 4096
  buffer_load_dwordx4 v2, s[4:7], s12 offen offset:0 lds
  buffer_load_dwordx4 v2, s[4:7], s12 offen offset:1024 lds
  buffer_load_dwordx4 v2, s[4:7], s12 offen offset:2048 lds
  buffer_load_dwordx4 v2, s[4:7], s12 offen offset:3072 lds
  s_mov_b32 m0, 84992
  s_add_u32 s12, s12, 4096
  buffer_load_dwordx4 v2, s[4:7], s12 offen offset:0 lds
  buffer_load_dwordx4 v2, s[4:7], s12 offen offset:1024 lds
  buffer_load_dwordx4 v2, s[4:7], s12 offen offset:2048 lds
  buffer_load_dwordx4 v2, s[4:7], s12 offen offset:3072 lds
  s_mov_b32 m0, 89088
  s_add_u32 s12, s12, 4096
  buffer_load_dwordx4 v2, s[4:7], s12 offen offset:0 lds
  buffer_load_dwordx4 v2, s[4:7], s12 offen offset:1024 lds
  buffer_load_dwordx4 v2, s[4:7], s12 offen offset:2048 lds
  s_add_u32 s12, s12, 3072
  s_waitcnt vmcnt(45)
  s_mov_b32 m0, 92160
  s_nop 0
  buffer_load_dwordx4 v2, s[4:7], s12 offen offset:0 lds
  buffer_load_dwordx4 v2, s[4:7], s12 offen offset:1024 lds
  buffer_load_dwordx4 v2, s[4:7], s12 offen offset:2048 lds
  buffer_load_dwordx4 v2, s[4:7], s12 offen offset:3072 lds
  s_mov_b32 m0, 96256
  s_add_u32 s12, s12, 4096
  buffer_load_dwordx4 v2, s[4:7], s12 offen offset:0 lds
  buffer_load_dwordx4 v2, s[4:7], s12 offen offset:1024 lds
  buffer_load_dwordx4 v2, s[4:7], s12 offen offset:2048 lds
  buffer_load_dwordx4 v2, s[4:7], s12 offen offset:3072 lds
  s_mov_b32 m0, 100352
  s_add_u32 s12, s12, 4096
  buffer_load_dwordx4 v2, s[4:7], s12 offen offset:0 lds
  buffer_load_dwordx4 v2, s[4:7], s12 offen offset:1024 lds
  buffer_load_dwordx4 v2, s[4:7], s12 offen offset:2048 lds
  buffer_load_dwordx4 v2, s[4:7], s12 offen offset:3072 lds
  s_mov_b32 m0, 104448
  s_add_u32 s12, s12, 4096
  buffer_load_dwordx4 v2, s[4:7], s12 offen offset:0 lds
  buffer_load_dwordx4 v2, s[4:7], s12 offen offset:1024 lds
  buffer_load_dwordx4 v2, s[4:7], s12 offen offset:2048 lds
  s_add_u32 s12, s12, 3072
  s_waitcnt vmcnt(45)
  s_mov_b32 m0, 107520
  s_nop 0
  buffer_load_dwordx4 v2, s[4:7], s12 offen offset:0 lds
  buffer_load_dwordx4 v2, s[4:7], s12 offen offset:1024 lds
  buffer_load_dwordx4 v2, s[4:7], s12 offen offset:2048 lds
  buffer_load_dwordx4 v2, s[4:7], s12 offen offset:3072 lds
  s_mov_b32 m0, 111616
  s_add_u32 s12, s12, 4096
  buffer_load_dwordx4 v2, s[4:7], s12 offen offset:0 lds
  buffer_load_dwordx4 v2, s[4:7], s12 offen offset:1024 lds
  buffer_load_dwordx4 v2, s[4:7], s12 offen offset:2048 lds
  buffer_load_dwordx4 v2, s[4:7], s12 offen offset:3072 lds
  s_mov_b32 m0, 115712
  s_add_u32 s12, s12, 4096
  buffer_load_dwordx4 v2, s[4:7], s12 offen offset:0 lds
  buffer_load_dwordx4 v2, s[4:7], s12 offen offset:1024 lds
  buffer_load_dwordx4 v2, s[4:7], s12 offen offset:2048 lds
  buffer_load_dwordx4 v2, s[4:7], s12 offen offset:3072 lds
  s_mov_b32 m0, 119808
  s_add_u32 s12, s12, 4096
  buffer_load_dwordx4 v2, s[4:7], s12 offen offset:0 lds
  buffer_load_dwordx4 v2, s[4:7], s12 offen offset:1024 lds
  buffer_load_dwordx4 v2, s[4:7], s12 offen offset:2048 lds
  s_add_u32 s12, s12, 3072
  s_waitcnt vmcnt(45)
  s_mov_b32 m0, 122880
  s_nop 0
  buffer_load_dwordx4 v2, s[4:7], s12 offen offset:0 lds
  buffer_load_dwordx4 v2, s[4:7], s12 offen offset:1024 lds
  buffer_load_dwordx4 v2, s[4:7], s12 offen offset:2048 lds
  buffer_load_dwordx4 v2, s[4:7], s12 offen offset:3072 lds
  s_mov_b32 m0, 126976
  s_add_u32 s12, s12, 4096
  buffer_load_dwordx4 v2, s[4:7], s12 offen offset:0 lds
  buffer_load_dwordx4 v2, s[4:7], s12 offen offset:1024 lds
  buffer_load_dwordx4 v2, s[4:7], s12 offen offset:2048 lds
  buffer_load_dwordx4 v2, s[4:7], s12 offen offset:3072 lds
  s_mov_b32 m0, 131072
  s_add_u32 s12, s12, 4096
  buffer_load_dwordx4 v2, s[4:7], s12 offen offset:0 lds
  buffer_load_dwordx4 v2, s[4:7], s12 offen offset:1024 lds
  buffer_load_dwordx4 v2, s[4:7], s12 offen offset:2048 lds
  buffer_load_dwordx4 v2, s[4:7], s12 offen offset:3072 lds
  s_mov_b32 m0, 135168
  s_add_u32 s12, s12, 4096
  buffer_load_dwordx4 v2, s[4:7], s12 offen offset:0 lds
  buffer_load_dwordx4 v2, s[4:7], s12 offen offset:1024 lds
  buffer_load_dwordx4 v2, s[4:7], s12 offen offset:2048 lds
  s_add_u32 s12, s12, 3072
  s_waitcnt vmcnt(45)
  s_mov_b32 m0, 138240
  s_nop 0
  buffer_load_dwordx4 v2, s[4:7], s12 offen offset:0 lds
  buffer_load_dwordx4 v2, s[4:7], s12 offen offset:1024 lds
  buffer_load_dwordx4 v2, s[4:7], s12 offen offset:2048 lds
  buffer_load_dwordx4 v2, s[4:7], s12 offen offset:3072 lds
  s_mov_b32 m0, 142336
  s_add_u32 s12, s12, 4096
  buffer_load_dwordx4 v2, s[4:7], s12 offen offset:0 lds
  buffer_load_dwordx4 v2, s[4:7], s12 offen offset:1024 lds
  buffer_load_dwordx4 v2, s[4:7], s12 offen offset:2048 lds
  buffer_load_dwordx4 v2, s[4:7], s12 offen offset:3072 lds
  s_mov_b32 m0, 146432
  s_add_u32 s12, s12, 4096
  buffer_load_dwordx4 v2, s[4:7], s12 offen offset:0 lds
  buffer_load_dwordx4 v2, s[4:7], s12 offen offset:1024 lds
  buffer_load_dwordx4 v2, s[4:7], s12 offen offset:2048 lds
  buffer_load_dwordx4 v2, s[4:7], s12 offen offset:3072 lds
  s_mov_b32 m0, 150528
  s_add_u32 s12, s12, 4096
  buffer_load_dwordx4 v2, s[4:7], s12 offen offset:0 lds
  buffer_load_dwordx4 v2, s[4:7], s12 offen offset:1024 lds
  buffer_load_dwordx4 v2, s[4:7], s12 offen offset:2048 lds
  s_add_u32 s12, s12, 3072
  s_waitcnt vmcnt(60)
  s_barrier
  s_waitcnt vmcnt(60)
  s_barrier
  s_mov_b32 m0, 0
  s_nop 0
  buffer_load_dwordx4 v2, s[4:7], s12 offen offset:0 lds
  buffer_load_dwordx4 v2, s[4:7], s12 offen offset:1024 lds
  buffer_load_dwordx4 v2, s[4:7], s12 offen offset:2048 lds
  buffer_load_dwordx4 v2, s[4:7], s12 offen offset:3072 lds
  s_mov_b32 m0, 4096
  s_add_u32 s12, s12, 4096
  buffer_load_dwordx4 v2, s[4:7], s12 offen offset:0 lds
  buffer_load_dwordx4 v2, s[4:7], s12 offen offset:1024 lds
  buffer_load_dwordx4 v2, s[4:7], s12 offen offset:2048 lds
  buffer_load_dwordx4 v2, s[4:7], s12 offen offset:3072 lds
  s_mov_b32 m0, 8192
  s_add_u32 s12, s12, 4096
  buffer_load_dwordx4 v2, s[4:7], s12 offen offset:0 lds
  buffer_load_dwordx4 v2, s[4:7], s12 offen offset:1024 lds
  buffer_load_dwordx4 v2, s[4:7], s12 offen offset:2048 lds
  buffer_load_dwordx4 v2, s[4:7], s12 offen offset:3072 lds
  s_mov_b32 m0, 12288
  s_add_u32 s12, s12, 4096
  buffer_load_dwordx4 v2, s[4:7], s12 offen offset:0 lds
  buffer_load_dwordx4 v2, s[4:7], s12 offen offset:1024 lds
  buffer_load_dwordx4 v2, s[4:7], s12 offen offset:2048 lds
  s_add_u32 s12, s12, 3072
  s_mov_b32 m0, 15360
  s_nop 0
  buffer_load_dwordx4 v2, s[4:7], s12 offen offset:0 lds
  buffer_load_dwordx4 v2, s[4:7], s12 offen offset:1024 lds
  buffer_load_dwordx4 v2, s[4:7], s12 offen offset:2048 lds
  buffer_load_dwordx4 v2, s[4:7], s12 offen offset:3072 lds
  s_mov_b32 m0, 19456
  s_add_u32 s12, s12, 4096
  buffer_load_dwordx4 v2, s[4:7], s12 offen offset:0 lds
  buffer_load_dwordx4 v2, s[4:7], s12 offen offset:1024 lds
  buffer_load_dwordx4 v2, s[4:7], s12 offen offset:2048 lds
  buffer_load_dwordx4 v2, s[4:7], s12 offen offset:3072 lds
  s_mov_b32 m0, 23552
  s_add_u32 s12, s12, 4096
  buffer_load_dwordx4 v2, s[4:7], s12 offen offset:0 lds
  buffer_load_dwordx4 v2, s[4:7], s12 offen offset:1024 lds
  buffer_load_dwordx4 v2, s[4:7], s12 offen offset:2048 lds
  buffer_load_dwordx4 v2, s[4:7], s12 offen offset:3072 lds
  s_mov_b32 m0, 27648
  s_add_u32 s12, s12, 4096
  buffer_load_dwordx4 v2, s[4:7], s12 offen offset:0 lds
  buffer_load_dwordx4 v2, s[4:7], s12 offen offset:1024 lds
  buffer_load_dwordx4 v2, s[4:7], s12 offen offset:2048 lds
  s_add_u32 s12, s12, 3072
  s_waitcnt vmcnt(60)
  s_barrier
  s_mov_b32 m0, 30720
  s_nop 0
  buffer_load_dwordx4 v2, s[4:7], s12 offen offset:0 lds
  buffer_load_dwordx4 v2, s[4:7], s12 offen offset:1024 lds
  buffer_load_dwordx4 v2, s[4:7], s12 offen offset:2048 lds
  buffer_load_dwordx4 v2, s[4:7], s12 offen offset:3072 lds
  s_mov_b32 m0, 34816
  s_add_u32 s12, s12, 4096
  buffer_load_dwordx4 v2, s[4:7], s12 offen offset:0 lds
  buffer_load_dwordx4 v2, s[4:7], s12 offen offset:1024 lds
  buffer_load_dwordx4 v2, s[4:7], s12 offen offset:2048 lds
  buffer_load_dwordx4 v2, s[4:7], s12 offen offset:3072 lds
  s_mov_b32 m0, 38912
  s_add_u32 s12, s12, 4096
  buffer_load_dwordx4 v2, s[4:7], s12 offen offset:0 lds
  buffer_load_dwordx4 v2, s[4:7], s12 offen offset:1024 lds
  buffer_load_dwordx4 v2, s[4:7], s12 offen offset:2048 lds
  buffer_load_dwordx4 v2, s[4:7], s12 offen offset:3072 lds
  s_mov_b32 m0, 43008
  s_add_u32 s12, s12, 4096
  buffer_load_dwordx4 v2, s[4:7], s12 offen offset:0 lds
  buffer_load_dwordx4 v2, s[4:7], s12 offen offset:1024 lds
  buffer_load_dwordx4 v2, s[4:7], s12 offen offset:2048 lds
  s_add_u32 s12, s12, 3072
  s_mov_b32 m0, 46080
  s_nop 0
  buffer_load_dwordx4 v2, s[4:7], s12 offen offset:0 lds
  buffer_load_dwordx4 v2, s[4:7], s12 offen offset:1024 lds
  buffer_load_dwordx4 v2, s[4:7], s12 offen offset:2048 lds
  buffer_load_dwordx4 v2, s[4:7], s12 offen offset:3072 lds
  s_mov_b32 m0, 50176
  s_add_u32 s12, s12, 4096
  buffer_load_dwordx4 v2, s[4:7], s12 offen offset:0 lds
  buffer_load_dwordx4 v2, s[4:7], s12 offen offset:1024 lds
  buffer_load_dwordx4 v2, s[4:7], s12 offen offset:2048 lds
  buffer_load_dwordx4 v2, s[4:7], s12 offen offset:3072 lds
  s_mov_b32 m0, 54272
  s_add_u32 s12, s12, 4096
  buffer_load_dwordx4 v2, s[4:7], s12 offen offset:0 lds
  buffer_load_dwordx4 v2, s[4:7], s12 offen offset:1024 lds
  buffer_load_dwordx4 v2, s[4:7], s12 offen offset:2048 lds
  buffer_load_dwordx4 v2, s[4:7], s12 offen offset:3072 lds
  s_mov_b32 m0, 58368
  s_add_u32 s12, s12, 4096
  buffer_load_dwordx4 v2, s[4:7], s12 offen offset:0 lds
  buffer_load_dwordx4 v2, s[4:7], s12 offen offset:1024 lds
  buffer_load_dwordx4 v2, s[4:7], s12 offen offset:2048 lds
  s_add_u32 s12, s12, 3072
  s_waitcnt vmcnt(60)
  s_barrier
  s_mov_b32 m0, 61440
  s_nop 0
  buffer_load_dwordx4 v2, s[4:7], s12 offen offset:0 lds
  buffer_load_dwordx4 v2, s[4:7], s12 offen offset:1024 lds
  buffer_load_dwordx4 v2, s[4:7], s12 offen offset:2048 lds
  buffer_load_dwordx4 v2, s[4:7], s12 offen offset:3072 lds
  s_mov_b32 m0, 65536
  s_add_u32 s12, s12, 4096
  buffer_load_dwordx4 v2, s[4:7], s12 offen offset:0 lds
  buffer_load_dwordx4 v2, s[4:7], s12 offen offset:1024 lds
  buffer_load_dwordx4 v2, s[4:7], s12 offen offset:2048 lds
  buffer_load_dwordx4 v2, s[4:7], s12 offen offset:3072 lds
  s_mov_b32 m0, 69632
  s_add_u32 s12, s12, 4096
  buffer_load_dwordx4 v2, s[4:7], s12 offen offset:0 lds
  buffer_load_dwordx4 v2, s[4:7], s12 offen offset:1024 lds
  buffer_load_dwordx4 v2, s[4:7], s12 offen offset:2048 lds
  buffer_load_dwordx4 v2, s[4:7], s12 offen offset:3072 lds
  s_mov_b32 m0, 73728
  s_add_u32 s12, s12, 4096
  buffer_load_dwordx4 v2, s[4:7], s12 offen offset:0 lds
  buffer_load_dwordx4 v2, s[4:7], s12 offen offset:1024 lds
  buffer_load_dwordx4 v2, s[4:7], s12 offen offset:2048 lds
  s_add_u32 s12, s12, 3072
  s_mov_b32 m0, 76800
  s_nop 0
  buffer_load_dwordx4 v2, s[4:7], s12 offen offset:0 lds
  buffer_load_dwordx4 v2, s[4:7], s12 offen offset:1024 lds
  buffer_load_dwordx4 v2, s[4:7], s12 offen offset:2048 lds
  buffer_load_dwordx4 v2, s[4:7], s12 offen offset:3072 lds
  s_mov_b32 m0, 80896
  s_add_u32 s12, s12, 4096
  buffer_load_dwordx4 v2, s[4:7], s12 offen offset:0 lds
  buffer_load_dwordx4 v2, s[4:7], s12 offen offset:1024 lds
  buffer_load_dwordx4 v2, s[4:7], s12 offen offset:2048 lds
  buffer_load_dwordx4 v2, s[4:7], s12 offen offset:3072 lds
  s_mov_b32 m0, 84992
  s_add_u32 s12, s12, 4096
  buffer_load_dwordx4 v2, s[4:7], s12 offen offset:0 lds
  buffer_load_dwordx4 v2, s[4:7], s12 offen offset:1024 lds
  buffer_load_dwordx4 v2, s[4:7], s12 offen offset:2048 lds
  buffer_load_dwordx4 v2, s[4:7], s12 offen offset:3072 lds
  s_mov_b32 m0, 89088
  s_add_u32 s12, s12, 4096
  buffer_load_dwordx4 v2, s[4:7], s12 offen offset:0 lds
  buffer_load_dwordx4 v2, s[4:7], s12 offen offset:1024 lds
  buffer_load_dwordx4 v2, s[4:7], s12 offen offset:2048 lds
  s_add_u32 s12, s12, 3072
  s_waitcnt vmcnt(60)
  s_barrier
  s_mov_b32 m0, 92160
  s_nop 0
  buffer_load_dwordx4 v2, s[4:7], s12 offen offset:0 lds
  buffer_load_dwordx4 v2, s[4:7], s12 offen offset:1024 lds
  buffer_load_dwordx4 v2, s[4:7], s12 offen offset:2048 lds
  buffer_load_dwordx4 v2, s[4:7], s12 offen offset:3072 lds
  s_mov_b32 m0, 96256
  s_add_u32 s12, s12, 4096
  buffer_load_dwordx4 v2, s[4:7], s12 offen offset:0 lds
  buffer_load_dwordx4 v2, s[4:7], s12 offen offset:1024 lds
  buffer_load_dwordx4 v2, s[4:7], s12 offen offset:2048 lds
  buffer_load_dwordx4 v2, s[4:7], s12 offen offset:3072 lds
  s_mov_b32 m0, 100352
  s_add_u32 s12, s12, 4096
  buffer_load_dwordx4 v2, s[4:7], s12 offen offset:0 lds
  buffer_load_dwordx4 v2, s[4:7], s12 offen offset:1024 lds
  buffer_load_dwordx4 v2, s[4:7], s12 offen offset:2048 lds
  buffer_load_dwordx4 v2, s[4:7], s12 offen offset:3072 lds
  s_mov_b32 m0, 104448
  s_add_u32 s12, s12, 4096
  buffer_load_dwordx4 v2, s[4:7], s12 offen offset:0 lds
  buffer_load_dwordx4 v2, s[4:7], s12 offen offset:1024 lds
  buffer_load_dwordx4 v2, s[4:7], s12 offen offset:2048 lds
  s_add_u32 s12, s12, 3072
  s_mov_b32 m0, 107520
  s_nop 0
  buffer_load_dwordx4 v2, s[4:7], s12 offen offset:0 lds
  buffer_load_dwordx4 v2, s[4:7], s12 offen offset:1024 lds
  buffer_load_dwordx4 v2, s[4:7], s12 offen offset:2048 lds
  buffer_load_dwordx4 v2, s[4:7], s12 offen offset:3072 lds
  s_mov_b32 m0, 111616
  s_add_u32 s12, s12, 4096
  buffer_load_dwordx4 v2, s[4:7], s12 offen offset:0 lds
  buffer_load_dwordx4 v2, s[4:7], s12 offen offset:1024 lds
  buffer_load_dwordx4 v2, s[4:7], s12 offen offset:2048 lds
  buffer_load_dwordx4 v2, s[4:7], s12 offen offset:3072 lds
  s_mov_b32 m0, 115712
  s_add_u32 s12, s12, 4096
  buffer_load_dwordx4 v2, s[4:7], s12 offen offset:0 lds
  buffer_load_dwordx4 v2, s[4:7], s12 offen offset:1024 lds
  buffer_load_dwordx4 v2, s[4:7], s12 offen offset:2048 lds
  buffer_load_dwordx4 v2, s[4:7], s12 offen offset:3072 lds
  s_mov_b32 m0, 119808
  s_add_u32 s12, s12, 4096
  buffer_load_dwordx4 v2, s[4:7], s12 offen offset:0 lds
  buffer_load_dwordx4 v2, s[4:7], s12 offen offset:1024 lds
  buffer_load_dwordx4 v2, s[4:7], s12 offen offset:2048 lds
  s_add_u32 s12, s12, 3072
  s_waitcnt vmcnt(60)
  s_barrier
  s_mov_b32 m0, 122880
  s_nop 0
  buffer_load_dwordx4 v2, s[4:7], s12 offen offset:0 lds
  buffer_load_dwordx4 v2, s[4:7], s12 offen offset:1024 lds
  buffer_load_dwordx4 v2, s[4:7], s12 offen offset:2048 lds
  buffer_load_dwordx4 v2, s[4:7], s12 offen offset:3072 lds
  s_mov_b32 m0, 126976
  s_add_u32 s12, s12, 4096
  buffer_load_dwordx4 v2, s[4:7], s12 offen offset:0 lds
  buffer_load_dwordx4 v2, s[4:7], s12 offen offset:1024 lds
  buffer_load_dwordx4 v2, s[4:7], s12 offen offset:2048 lds
  buffer_load_dwordx4 v2, s[4:7], s12 offen offset:3072 lds
  s_mov_b32 m0, 131072
  s_add_u32 s12, s12, 4096
  buffer_load_dwordx4 v2, s[4:7], s12 offen offset:0 lds
  buffer_load_dwordx4 v2, s[4:7], s12 offen offset:1024 lds
  buffer_load_dwordx4 v2, s[4:7], s12 offen offset:2048 lds
  buffer_load_dwordx4 v2, s[4:7], s12 offen offset:3072 lds
  s_mov_b32 m0, 135168
  s_add_u32 s12, s12, 4096
  buffer_load_dwordx4 v2, s[4:7], s12 offen offset:0 lds
  buffer_load_dwordx4 v2, s[4:7], s12 offen offset:1024 lds
  buffer_load_dwordx4 v2, s[4:7], s12 offen offset:2048 lds
  s_add_u32 s12, s12, 3072
  s_mov_b32 m0, 138240
  s_nop 0
  buffer_load_dwordx4 v2, s[4:7], s12 offen offset:0 lds
  buffer_load_dwordx4 v2, s[4:7], s12 offen offset:1024 lds
  buffer_load_dwordx4 v2, s[4:7], s12 offen offset:2048 lds
  buffer_load_dwordx4 v2, s[4:7], s12 offen offset:3072 lds
  s_mov_b32 m0, 142336
  s_add_u32 s12, s12, 4096
  buffer_load_dwordx4 v2, s[4:7], s12 offen offset:0 lds
  buffer_load_dwordx4 v2, s[4:7], s12 offen offset:1024 lds
  buffer_load_dwordx4 v2, s[4:7], s12 offen offset:2048 lds
  buffer_load_dwordx4 v2, s[4:7], s12 offen offset:3072 lds
  s_mov_b32 m0, 146432
  s_add_u32 s12, s12, 4096
  buffer_load_dwordx4 v2, s[4:7], s12 offen offset:0 lds
  buffer_load_dwordx4 v2, s[4:7], s12 offen offset:1024 lds
  buffer_load_dwordx4 v2, s[4:7], s12 offen offset:2048 lds
  buffer_load_dwordx4 v2, s[4:7], s12 offen offset:3072 lds
  s_mov_b32 m0, 150528
  s_add_u32 s12, s12, 4096
  buffer_load_dwordx4 v2, s[4:7], s12 offen offset:0 lds
  buffer_load_dwordx4 v2, s[4:7], s12 offen offset:1024 lds
  buffer_load_dwordx4 v2, s[4:7], s12 offen offset:2048 lds
  s_add_u32 s12, s12, 3072
  s_waitcnt vmcnt(60)
  s_barrier
  s_waitcnt vmcnt(60)
  s_barrier
  s_waitcnt vmcnt(30)
  s_barrier
  s_waitcnt vmcnt(0)
  s_barrier
  s_barrier
  s_endpgm
b1_comp:
  s_mov_b32 s14, s11
  buffer_load_dwordx4 v[16:19], v2, s[4:7], s14 offen offset:0
  buffer_load_dwordx4 v[20:23], v2, s[4:7], s14 offen offset:1024
  buffer_load_dwordx4 v[24:27], v2, s[4:7], s14 offen offset:2048
  buffer_load_dwordx4 v[28:31], v2, s[4:7], s14 offen offset:3072
  s_add_u32 s14, s14, 4096
  buffer_load_dwordx4 v[32:35], v2, s[4:7], s14 offen offset:0
  buffer_load_dwordx4 v[36:39], v2, s[4:7], s14 offen offset:1024
  buffer_load_dwordx4 v[40:43], v2, s[4:7], s14 offen offset:2048
  buffer_load_dwordx4 v[44:47], v2, s[4:7], s14 offen offset:3072
  s_add_u32 s14, s14, 4096
  buffer_load_dwordx4 v[48:51], v2, s[4:7], s14 offen offset:0
  buffer_load_dwordx4 v[52:55], v2, s[4:7], s14 offen offset:1024
  buffer_load_dwordx4 v[56:59], v2, s[4:7], s14 offen offset:2048
  buffer_load_dwordx4 v[60:63], v2, s[4:7], s14 offen offset:3072
  s_add_u32 s14, s14, 4096
  buffer_load_dwordx4 v[64:67], v2, s[4:7], s14 offen offset:0
  buffer_load_dwordx4 v[68:71], v2, s[4:7], s14 offen offset:1024
  buffer_load_dwordx4 v[72:75], v2, s[4:7], s14 offen offset:2048
  buffer_load_dwordx4 v[76:79], v2, s[4:7], s14 offen offset:3072
  s_add_u32 s14, s14, 4096
  buffer_load_dwordx4 v[80:83], v2, s[4:7], s14 offen offset:0
  buffer_load_dwordx4 v[84:87], v2, s[4:7], s14 offen offset:1024
  buffer_load_dwordx4 v[88:91], v2, s[4:7], s14 offen offset:2048
  buffer_load_dwordx4 v[92:95], v2, s[4:7], s14 offen offset:3072
  s_waitcnt vmcnt(0)
  s_mov_b32 s30, 0xffff0000
  v_lshlrev_b32 v96, 16, v16
  v_and_b32 v97, s30, v16
  v_lshlrev_b32 v98, 16, v17
  v_and_b32 v99, s30, v17
  v_pk_add_f32 v[8:9], v[96:97], v[98:99]
  v_lshlrev_b32 v100, 16, v18
  v_and_b32 v101, s30, v18
  v_pk_add_f32 v[8:9], v[8:9], v[100:101]
  v_lshlrev_b32 v102, 16, v19
  v_and_b32 v103, s30, v19
  v_pk_add_f32 v[8:9], v[8:9], v[102:103]
  v_lshlrev_b32 v104, 16, v20
  v_and_b32 v105, s30, v20
  v_pk_add_f32 v[8:9], v[8:9], v[104:105]
  v_lshlrev_b32 v106, 16, v21
  v_and_b32 v107, s30, v21
  v_pk_add_f32 v[8:9], v[8:9], v[106:107]
  v_lshlrev_b32 v108, 16, v22
  v_and_b32 v109, s30, v22
  v_pk_add_f32 v[8:9], v[8:9], v[108:109]
  v_lshlrev_b32 v110, 16, v23
  v_and_b32 v111, s30, v23
  v_pk_add_f32 v[8:9], v[8:9], v[110:111]
  v_lshlrev_b32 v112, 16, v24
  v_and_b32 v113, s30, v24
  v_pk_add_f32 v[8:9], v[8:9], v[112:113]
  v_lshlrev_b32 v114, 16, v25
  v_and_b32 v115, s30, v25
  v_pk_add_f32 v[8:9], v[8:9], v[114:115]
  v_lshlrev_b32 v116, 16, v26
  v_and_b32 v117, s30, v26
  v_pk_add_f32 v[8:9], v[8:9], v[116:117]
  v_lshlrev_b32 v118, 16, v27
  v_and_b32 v119, s30, v27
  v_pk_add_f32 v[8:9], v[8:9], v[118:119]
  v_lshlrev_b32 v120, 16, v28
  v_and_b32 v121, s30, v28
  v_pk_add_f32 v[8:9], v[8:9], v[120:121]
  v_lshlrev_b32 v122, 16, v29
  v_and_b32 v123, s30, v29
  v_pk_add_f32 v[8:9], v[8:9], v[122:123]
  v_lshlrev_b32 v124, 16, v30
  v_and_b32 v125, s30, v30
  v_pk_add_f32 v[8:9], v[8:9], v[124:125]
  v_lshlrev_b32 v126, 16, v31
  v_and_b32 v127, s30, v31
  v_pk_add_f32 v[8:9], v[8:9], v[126:127]
  v_lshlrev_b32 v128, 16, v32
  v_and_b32 v129, s30, v32
  v_pk_add_f32 v[8:9], v[8:9], v[128:129]
  v_lshlrev_b32 v130, 16, v33
  v_and_b32 v131, s30, v33
  v_pk_add_f32 v[8:9], v[8:9], v[130:131]
  v_lshlrev_b32 v132, 16, v34
  v_and_b32 v133, s30, v34
  v_pk_add_f32 v[8:9], v[8:9], v[132:133]
  v_lshlrev_b32 v134, 16, v35
  v_and_b32 v135, s30, v35
  v_pk_add_f32 v[8:9], v[8:9], v[134:135]
  v_lshlrev_b32 v136, 16, v36
  v_and_b32 v137, s30, v36
  v_pk_add_f32 v[8:9], v[8:9], v[136:137]
  v_lshlrev_b32 v138, 16, v37
  v_and_b32 v139, s30, v37
  v_pk_add_f32 v[8:9], v[8:9], v[138:139]
  v_lshlrev_b32 v140, 16, v38
  v_and_b32 v141, s30, v38
  v_pk_add_f32 v[8:9], v[8:9], v[140:141]
  v_lshlrev_b32 v142, 16, v39
  v_and_b32 v143, s30, v39
  v_pk_add_f32 v[8:9], v[8:9], v[142:143]
  v_lshlrev_b32 v144, 16, v40
  v_and_b32 v145, s30, v40
  v_pk_add_f32 v[8:9], v[8:9], v[144:145]
  v_lshlrev_b32 v146, 16, v41
  v_and_b32 v147, s30, v41
  v_pk_add_f32 v[8:9], v[8:9], v[146:147]
  v_lshlrev_b32 v148, 16, v42
  v_and_b32 v149, s30, v42
  v_pk_add_f32 v[8:9], v[8:9], v[148:149]
  v_lshlrev_b32 v150, 16, v43
  v_and_b32 v151, s30, v43
  v_pk_add_f32 v[8:9], v[8:9], v[150:151]
  v_lshlrev_b32 v152, 16, v44
  v_and_b32 v153, s30, v44
  v_pk_add_f32 v[8:9], v[8:9], v[152:153]
  v_lshlrev_b32 v154, 16, v45
  v_and_b32 v155, s30, v45
  v_pk_add_f32 v[8:9], v[8:9], v[154:155]
  v_lshlrev_b32 v156, 16, v46
  v_and_b32 v157, s30, v46
  v_pk_add_f32 v[8:9], v[8:9], v[156:157]
  v_lshlrev_b32 v158, 16, v47
  v_and_b32 v159, s30, v47
  v_pk_add_f32 v[8:9], v[8:9], v[158:159]
  v_lshlrev_b32 v160, 16, v48
  v_and_b32 v161, s30, v48
  v_pk_add_f32 v[8:9], v[8:9], v[160:161]
  v_lshlrev_b32 v162, 16, v49
  v_and_b32 v163, s30, v49
  v_pk_add_f32 v[8:9], v[8:9], v[162:163]
  v_lshlrev_b32 v164, 16, v50
  v_and_b32 v165, s30, v50
  v_pk_add_f32 v[8:9], v[8:9], v[164:165]
  v_lshlrev_b32 v166, 16, v51
  v_and_b32 v167, s30, v51
  v_pk_add_f32 v[8:9], v[8:9], v[166:167]
  v_lshlrev_b32 v168, 16, v52
  v_and_b32 v169, s30, v52
  v_pk_add_f32 v[8:9], v[8:9], v[168:169]
  v_lshlrev_b32 v170, 16, v53
  v_and_b32 v171, s30, v53
  v_pk_add_f32 v[8:9], v[8:9], v[170:171]
  v_lshlrev_b32 v172, 16, v54
  v_and_b32 v173, s30, v54
  v_pk_add_f32 v[8:9], v[8:9], v[172:173]
  v_lshlrev_b32 v174, 16, v55
  v_and_b32 v175, s30, v55
  v_pk_add_f32 v[8:9], v[8:9], v[174:175]
  v_lshlrev_b32 v176, 16, v56
  v_and_b32 v177, s30, v56
  v_pk_add_f32 v[8:9], v[8:9], v[176:177]
  v_lshlrev_b32 v178, 16, v57
  v_and_b32 v179, s30, v57
  v_pk_add_f32 v[8:9], v[8:9], v[178:179]
  v_lshlrev_b32 v180, 16, v58
  v_and_b32 v181, s30, v58
  v_pk_add_f32 v[8:9], v[8:9], v[180:181]
  v_lshlrev_b32 v182, 16, v59
  v_and_b32 v183, s30, v59
  v_pk_add_f32 v[8:9], v[8:9], v[182:183]
  v_lshlrev_b32 v184, 16, v60
  v_and_b32 v185, s30, v60
  v_pk_add_f32 v[8:9], v[8:9], v[184:185]
  v_lshlrev_b32 v186, 16, v61
  v_and_b32 v187, s30, v61
  v_pk_add_f32 v[8:9], v[8:9], v[186:187]
  v_lshlrev_b32 v188, 16, v62
  v_and_b32 v189, s30, v62
  v_pk_add_f32 v[8:9], v[8:9], v[188:189]
  v_lshlrev_b32 v190, 16, v63
  v_and_b32 v191, s30, v63
  v_pk_add_f32 v[8:9], v[8:9], v[190:191]
  v_lshlrev_b32 v192, 16, v64
  v_and_b32 v193, s30, v64
  v_pk_add_f32 v[8:9], v[8:9], v[192:193]
  v_lshlrev_b32 v194, 16, v65
  v_and_b32 v195, s30, v65
  v_pk_add_f32 v[8:9], v[8:9], v[194:195]
  v_lshlrev_b32 v196, 16, v66
  v_and_b32 v197, s30, v66
  v_pk_add_f32 v[8:9], v[8:9], v[196:197]
  v_lshlrev_b32 v198, 16, v67
  v_and_b32 v199, s30, v67
  v_pk_add_f32 v[8:9], v[8:9], v[198:199]
  v_lshlrev_b32 v200, 16, v68
  v_and_b32 v201, s30, v68
  v_pk_add_f32 v[8:9], v[8:9], v[200:201]
  v_lshlrev_b32 v202, 16, v69
  v_and_b32 v203, s30, v69
  v_pk_add_f32 v[8:9], v[8:9], v[202:203]
  v_lshlrev_b32 v204, 16, v70
  v_and_b32 v205, s30, v70
  v_pk_add_f32 v[8:9], v[8:9], v[204:205]
  v_lshlrev_b32 v206, 16, v71
  v_and_b32 v207, s30, v71
  v_pk_add_f32 v[8:9], v[8:9], v[206:207]
  v_lshlrev_b32 v208, 16, v72
  v_and_b32 v209, s30, v72
  v_pk_add_f32 v[8:9], v[8:9], v[208:209]
  v_lshlrev_b32 v210, 16, v73
  v_and_b32 v211, s30, v73
  v_pk_add_f32 v[8:9], v[8:9], v[210:211]
  v_lshlrev_b32 v212, 16, v74
  v_and_b32 v213, s30, v74
  v_pk_add_f32 v[8:9], v[8:9], v[212:213]
  v_lshlrev_b32 v214, 16, v75
  v_and_b32 v215, s30, v75
  v_pk_add_f32 v[8:9], v[8:9], v[214:215]
  v_lshlrev_b32 v216, 16, v76
  v_and_b32 v217, s30, v76
  v_pk_add_f32 v[8:9], v[8:9], v[216:217]
  v_lshlrev_b32 v218, 16, v77
  v_and_b32 v219, s30, v77
  v_pk_add_f32 v[8:9], v[8:9], v[218:219]
  v_lshlrev_b32 v220, 16, v78
  v_and_b32 v221, s30, v78
  v_pk_add_f32 v[8:9], v[8:9], v[220:221]
  v_lshlrev_b32 v222, 16, v79
  v_and_b32 v223, s30, v79
  v_pk_add_f32 v[8:9], v[8:9], v[222:223]
  v_lshlrev_b32 v224, 16, v80
  v_and_b32 v225, s30, v80
  v_pk_add_f32 v[8:9], v[8:9], v[224:225]
  v_lshlrev_b32 v226, 16, v81
  v_and_b32 v227, s30, v81
  v_pk_add_f32 v[8:9], v[8:9], v[226:227]
  v_lshlrev_b32 v228, 16, v82
  v_and_b32 v229, s30, v82
  v_pk_add_f32 v[8:9], v[8:9], v[228:229]
  v_lshlrev_b32 v230, 16, v83
  v_and_b32 v231, s30, v83
  v_pk_add_f32 v[8:9], v[8:9], v[230:231]
  v_lshlrev_b32 v232, 16, v84
  v_and_b32 v233, s30, v84
  v_pk_add_f32 v[8:9], v[8:9], v[232:233]
  v_lshlrev_b32 v234, 16, v85
  v_and_b32 v235, s30, v85
  v_pk_add_f32 v[8:9], v[8:9], v[234:235]
  v_lshlrev_b32 v236, 16, v86
  v_and_b32 v237, s30, v86
  v_pk_add_f32 v[8:9], v[8:9], v[236:237]
  v_lshlrev_b32 v238, 16, v87
  v_and_b32 v239, s30, v87
  v_pk_add_f32 v[8:9], v[8:9], v[238:239]
  v_lshlrev_b32 v240, 16, v88
  v_and_b32 v241, s30, v88
  v_pk_add_f32 v[8:9], v[8:9], v[240:241]
  v_lshlrev_b32 v242, 16, v89
  v_and_b32 v243, s30, v89
  v_pk_add_f32 v[8:9], v[8:9], v[242:243]
  v_lshlrev_b32 v244, 16, v90
  v_and_b32 v245, s30, v90
  v_pk_add_f32 v[8:9], v[8:9], v[244:245]
  v_lshlrev_b32 v246, 16, v91
  v_and_b32 v247, s30, v91
  v_pk_add_f32 v[8:9], v[8:9], v[246:247]
  v_lshlrev_b32 v248, 16, v92
  v_and_b32 v249, s30, v92
  v_pk_add_f32 v[8:9], v[8:9], v[248:249]
  v_lshlrev_b32 v250, 16, v93
  v_and_b32 v251, s30, v93
  v_pk_add_f32 v[8:9], v[8:9], v[250:251]
  v_lshlrev_b32 v252, 16, v94
  v_and_b32 v253, s30, v94
  v_pk_add_f32 v[8:9], v[8:9], v[252:253]
  v_lshlrev_b32 v254, 16, v95
  v_and_b32 v255, s30, v95
  v_pk_add_f32 v[8:9], v[8:9], v[254:255]
  v_add_f32 v8, v8, v9
  v_mov_b32 v9, v8
  s_nop 1
  v_permlane16_swap_b32 v8, v9
  v_add_f32 v8, v8, v9
  v_mov_b32 v9, v8
  s_nop 1
  v_permlane32_swap_b32 v8, v9
  v_add_f32 v8, v8, v9
  v_mul_f32 v8, 0xbacccccd, v8
  v_mov_b32 v9, v8
  v_pk_add_f32 v[96:97], v[96:97], v[8:9]
  v_pk_mul_f32 v[10:11], v[96:97], v[96:97]
  v_pk_add_f32 v[98:99], v[98:99], v[8:9]
  v_pk_fma_f32 v[10:11], v[98:99], v[98:99], v[10:11]
  v_pk_add_f32 v[100:101], v[100:101], v[8:9]
  v_pk_fma_f32 v[10:11], v[100:101], v[100:101], v[10:11]
  v_pk_add_f32 v[102:103], v[102:103], v[8:9]
  v_pk_fma_f32 v[10:11], v[102:103], v[102:103], v[10:11]
  v_pk_add_f32 v[104:105], v[104:105], v[8:9]
  v_pk_fma_f32 v[10:11], v[104:105], v[104:105], v[10:11]
  v_pk_add_f32 v[106:107], v[106:107], v[8:9]
  v_pk_fma_f32 v[10:11], v[106:107], v[106:107], v[10:11]
  v_pk_add_f32 v[108:109], v[108:109], v[8:9]
  v_pk_fma_f32 v[10:11], v[108:109], v[108:109], v[10:11]
  v_pk_add_f32 v[110:111], v[110:111], v[8:9]
  v_pk_fma_f32 v[10:11], v[110:111], v[110:111], v[10:11]
  v_pk_add_f32 v[112:113], v[112:113], v[8:9]
  v_pk_fma_f32 v[10:11], v[112:113], v[112:113], v[10:11]
  v_pk_add_f32 v[114:115], v[114:115], v[8:9]
  v_pk_fma_f32 v[10:11], v[114:115], v[114:115], v[10:11]
  v_pk_add_f32 v[116:117], v[116:117], v[8:9]
  v_pk_fma_f32 v[10:11], v[116:117], v[116:117], v[10:11]
  v_pk_add_f32 v[118:119], v[118:119], v[8:9]
  v_pk_fma_f32 v[10:11], v[118:119], v[118:119], v[10:11]
  v_pk_add_f32 v[120:121], v[120:121], v[8:9]
  v_pk_fma_f32 v[10:11], v[120:121], v[120:121], v[10:11]
  v_pk_add_f32 v[122:123], v[122:123], v[8:9]
  v_pk_fma_f32 v[10:11], v[122:123], v[122:123], v[10:11]
  v_pk_add_f32 v[124:125], v[124:125], v[8:9]
  v_pk_fma_f32 v[10:11], v[124:125], v[124:125], v[10:11]
  v_pk_add_f32 v[126:127], v[126:127], v[8:9]
  v_pk_fma_f32 v[10:11], v[126:127], v[126:127], v[10:11]
  v_pk_add_f32 v[128:129], v[128:129], v[8:9]
  v_pk_fma_f32 v[10:11], v[128:129], v[128:129], v[10:11]
  v_pk_add_f32 v[130:131], v[130:131], v[8:9]
  v_pk_fma_f32 v[10:11], v[130:131], v[130:131], v[10:11]
  v_pk_add_f32 v[132:133], v[132:133], v[8:9]
  v_pk_fma_f32 v[10:11], v[132:133], v[132:133], v[10:11]
  v_pk_add_f32 v[134:135], v[134:135], v[8:9]
  v_pk_fma_f32 v[10:11], v[134:135], v[134:135], v[10:11]
  v_pk_add_f32 v[136:137], v[136:137], v[8:9]
  v_pk_fma_f32 v[10:11], v[136:137], v[136:137], v[10:11]
  v_pk_add_f32 v[138:139], v[138:139], v[8:9]
  v_pk_fma_f32 v[10:11], v[138:139], v[138:139], v[10:11]
  v_pk_add_f32 v[140:141], v[140:141], v[8:9]
  v_pk_fma_f32 v[10:11], v[140:141], v[140:141], v[10:11]
  v_pk_add_f32 v[142:143], v[142:143], v[8:9]
  v_pk_fma_f32 v[10:11], v[142:143], v[142:143], v[10:11]
  v_pk_add_f32 v[144:145], v[144:145], v[8:9]
  v_pk_fma_f32 v[10:11], v[144:145], v[144:145], v[10:11]
  v_pk_add_f32 v[146:147], v[146:147], v[8:9]
  v_pk_fma_f32 v[10:11], v[146:147], v[146:147], v[10:11]
  v_pk_add_f32 v[148:149], v[148:149], v[8:9]
  v_pk_fma_f32 v[10:11], v[148:149], v[148:149], v[10:11]
  v_pk_add_f32 v[150:151], v[150:151], v[8:9]
  v_pk_fma_f32 v[10:11], v[150:151], v[150:151], v[10:11]
  v_pk_add_f32 v[152:153], v[152:153], v[8:9]
  v_pk_fma_f32 v[10:11], v[152:153], v[152:153], v[10:11]
  v_pk_add_f32 v[154:155], v[154:155], v[8:9]
  v_pk_fma_f32 v[10:11], v[154:155], v[154:155], v[10:11]
  v_pk_add_f32 v[156:157], v[156:157], v[8:9]
  v_pk_fma_f32 v[10:11], v[156:157], v[156:157], v[10:11]
  v_pk_add_f32 v[158:159], v[158:159], v[8:9]
  v_pk_fma_f32 v[10:11], v[158:159], v[158:159], v[10:11]
  v_pk_add_f32 v[160:161], v[160:161], v[8:9]
  v_pk_fma_f32 v[10:11], v[160:161], v[160:161], v[10:11]
  v_pk_add_f32 v[162:163], v[162:163], v[8:9]
  v_pk_fma_f32 v[10:11], v[162:163], v[162:163], v[10:11]
  v_pk_add_f32 v[164:165], v[164:165], v[8:9]
  v_pk_fma_f32 v[10:11], v[164:165], v[164:165], v[10:11]
  v_pk_add_f32 v[166:167], v[166:167], v[8:9]
  v_pk_fma_f32 v[10:11], v[166:167], v[166:167], v[10:11]
  v_pk_add_f32 v[168:169], v[168:169], v[8:9]
  v_pk_fma_f32 v[10:11], v[168:169], v[168:169], v[10:11]
  v_pk_add_f32 v[170:171], v[170:171], v[8:9]
  v_pk_fma_f32 v[10:11], v[170:171], v[170:171], v[10:11]
  v_pk_add_f32 v[172:173], v[172:173], v[8:9]
  v_pk_fma_f32 v[10:11], v[172:173], v[172:173], v[10:11]
  v_pk_add_f32 v[174:175], v[174:175], v[8:9]
  v_pk_fma_f32 v[10:11], v[174:175], v[174:175], v[10:11]
  v_pk_add_f32 v[176:177], v[176:177], v[8:9]
  v_pk_fma_f32 v[10:11], v[176:177], v[176:177], v[10:11]
  v_pk_add_f32 v[178:179], v[178:179], v[8:9]
  v_pk_fma_f32 v[10:11], v[178:179], v[178:179], v[10:11]
  v_pk_add_f32 v[180:181], v[180:181], v[8:9]
  v_pk_fma_f32 v[10:11], v[180:181], v[180:181], v[10:11]
  v_pk_add_f32 v[182:183], v[182:183], v[8:9]
  v_pk_fma_f32 v[10:11], v[182:183], v[182:183], v[10:11]
  v_pk_add_f32 v[184:185], v[184:185], v[8:9]
  v_pk_fma_f32 v[10:11], v[184:185], v[184:185], v[10:11]
  v_pk_add_f32 v[186:187], v[186:187], v[8:9]
  v_pk_fma_f32 v[10:11], v[186:187], v[186:187], v[10:11]
  v_pk_add_f32 v[188:189], v[188:189], v[8:9]
  v_pk_fma_f32 v[10:11], v[188:189], v[188:189], v[10:11]
  v_pk_add_f32 v[190:191], v[190:191], v[8:9]
  v_pk_fma_f32 v[10:11], v[190:191], v[190:191], v[10:11]
  v_pk_add_f32 v[192:193], v[192:193], v[8:9]
  v_pk_fma_f32 v[10:11], v[192:193], v[192:193], v[10:11]
  v_pk_add_f32 v[194:195], v[194:195], v[8:9]
  v_pk_fma_f32 v[10:11], v[194:195], v[194:195], v[10:11]
  v_pk_add_f32 v[196:197], v[196:197], v[8:9]
  v_pk_fma_f32 v[10:11], v[196:197], v[196:197], v[10:11]
  v_pk_add_f32 v[198:199], v[198:199], v[8:9]
  v_pk_fma_f32 v[10:11], v[198:199], v[198:199], v[10:11]
  v_pk_add_f32 v[200:201], v[200:201], v[8:9]
  v_pk_fma_f32 v[10:11], v[200:201], v[200:201], v[10:11]
  v_pk_add_f32 v[202:203], v[202:203], v[8:9]
  v_pk_fma_f32 v[10:11], v[202:203], v[202:203], v[10:11]
  v_pk_add_f32 v[204:205], v[204:205], v[8:9]
  v_pk_fma_f32 v[10:11], v[204:205], v[204:205], v[10:11]
  v_pk_add_f32 v[206:207], v[206:207], v[8:9]
  v_pk_fma_f32 v[10:11], v[206:207], v[206:207], v[10:11]
  v_pk_add_f32 v[208:209], v[208:209], v[8:9]
  v_pk_fma_f32 v[10:11], v[208:209], v[208:209], v[10:11]
  v_pk_add_f32 v[210:211], v[210:211], v[8:9]
  v_pk_fma_f32 v[10:11], v[210:211], v[210:211], v[10:11]
  v_pk_add_f32 v[212:213], v[212:213], v[8:9]
  v_pk_fma_f32 v[10:11], v[212:213], v[212:213], v[10:11]
  v_pk_add_f32 v[214:215], v[214:215], v[8:9]
  v_pk_fma_f32 v[10:11], v[214:215], v[214:215], v[10:11]
  v_pk_add_f32 v[216:217], v[216:217], v[8:9]
  v_pk_fma_f32 v[10:11], v[216:217], v[216:217], v[10:11]
  v_pk_add_f32 v[218:219], v[218:219], v[8:9]
  v_pk_fma_f32 v[10:11], v[218:219], v[218:219], v[10:11]
  v_pk_add_f32 v[220:221], v[220:221], v[8:9]
  v_pk_fma_f32 v[10:11], v[220:221], v[220:221], v[10:11]
  v_pk_add_f32 v[222:223], v[222:223], v[8:9]
  v_pk_fma_f32 v[10:11], v[222:223], v[222:223], v[10:11]
  v_pk_add_f32 v[224:225], v[224:225], v[8:9]
  v_pk_fma_f32 v[10:11], v[224:225], v[224:225], v[10:11]
  v_pk_add_f32 v[226:227], v[226:227], v[8:9]
  v_pk_fma_f32 v[10:11], v[226:227], v[226:227], v[10:11]
  v_pk_add_f32 v[228:229], v[228:229], v[8:9]
  v_pk_fma_f32 v[10:11], v[228:229], v[228:229], v[10:11]
  v_pk_add_f32 v[230:231], v[230:231], v[8:9]
  v_pk_fma_f32 v[10:11], v[230:231], v[230:231], v[10:11]
  v_pk_add_f32 v[232:233], v[232:233], v[8:9]
  v_pk_fma_f32 v[10:11], v[232:233], v[232:233], v[10:11]
  v_pk_add_f32 v[234:235], v[234:235], v[8:9]
  v_pk_fma_f32 v[10:11], v[234:235], v[234:235], v[10:11]
  v_pk_add_f32 v[236:237], v[236:237], v[8:9]
  v_pk_fma_f32 v[10:11], v[236:237], v[236:237], v[10:11]
  v_pk_add_f32 v[238:239], v[238:239], v[8:9]
  v_pk_fma_f32 v[10:11], v[238:239], v[238:239], v[10:11]
  v_pk_add_f32 v[240:241], v[240:241], v[8:9]
  v_pk_fma_f32 v[10:11], v[240:241], v[240:241], v[10:11]
  v_pk_add_f32 v[242:243], v[242:243], v[8:9]
  v_pk_fma_f32 v[10:11], v[242:243], v[242:243], v[10:11]
  v_pk_add_f32 v[244:245], v[244:245], v[8:9]
  v_pk_fma_f32 v[10:11], v[244:245], v[244:245], v[10:11]
  v_pk_add_f32 v[246:247], v[246:247], v[8:9]
  v_pk_fma_f32 v[10:11], v[246:247], v[246:247], v[10:11]
  v_pk_add_f32 v[248:249], v[248:249], v[8:9]
  v_pk_fma_f32 v[10:11], v[248:249], v[248:249], v[10:11]
  v_pk_add_f32 v[250:251], v[250:251], v[8:9]
  v_pk_fma_f32 v[10:11], v[250:251], v[250:251], v[10:11]
  v_pk_add_f32 v[252:253], v[252:253], v[8:9]
  v_pk_fma_f32 v[10:11], v[252:253], v[252:253], v[10:11]
  v_pk_add_f32 v[254:255], v[254:255], v[8:9]
  v_pk_fma_f32 v[10:11], v[254:255], v[254:255], v[10:11]
  v_add_f32 v10, v10, v11
  v_mov_b32 v11, v10
  s_nop 1
  v_permlane16_swap_b32 v10, v11
  v_add_f32 v10, v10, v11
  v_mov_b32 v11, v10
  s_nop 1
  v_permlane32_swap_b32 v10, v11
  v_add_f32 v10, v10, v11
  v_mov_b32 v8, 0x3727c5ac
  v_fmac_f32 v8, 0x3acccccd, v10
  v_rsq_f32 v8, v8
  s_nop 0
  v_mov_b32 v9, v8
  v_pk_mul_f32 v[96:97], v[96:97], v[8:9]
  v_cvt_pk_bf16_f32 v16, v96, v97
  v_pk_mul_f32 v[98:99], v[98:99], v[8:9]
  v_cvt_pk_bf16_f32 v17, v98, v99
  v_pk_mul_f32 v[100:101], v[100:101], v[8:9]
  v_cvt_pk_bf16_f32 v18, v100, v101
  v_pk_mul_f32 v[102:103], v[102:103], v[8:9]
  v_cvt_pk_bf16_f32 v19, v102, v103
  v_pk_mul_f32 v[104:105], v[104:105], v[8:9]
  v_cvt_pk_bf16_f32 v20, v104, v105
  v_pk_mul_f32 v[106:107], v[106:107], v[8:9]
  v_cvt_pk_bf16_f32 v21, v106, v107
  v_pk_mul_f32 v[108:109], v[108:109], v[8:9]
  v_cvt_pk_bf16_f32 v22, v108, v109
  v_pk_mul_f32 v[110:111], v[110:111], v[8:9]
  v_cvt_pk_bf16_f32 v23, v110, v111
  v_pk_mul_f32 v[112:113], v[112:113], v[8:9]
  v_cvt_pk_bf16_f32 v24, v112, v113
  v_pk_mul_f32 v[114:115], v[114:115], v[8:9]
  v_cvt_pk_bf16_f32 v25, v114, v115
  v_pk_mul_f32 v[116:117], v[116:117], v[8:9]
  v_cvt_pk_bf16_f32 v26, v116, v117
  v_pk_mul_f32 v[118:119], v[118:119], v[8:9]
  v_cvt_pk_bf16_f32 v27, v118, v119
  v_pk_mul_f32 v[120:121], v[120:121], v[8:9]
  v_cvt_pk_bf16_f32 v28, v120, v121
  v_pk_mul_f32 v[122:123], v[122:123], v[8:9]
  v_cvt_pk_bf16_f32 v29, v122, v123
  v_pk_mul_f32 v[124:125], v[124:125], v[8:9]
  v_cvt_pk_bf16_f32 v30, v124, v125
  v_pk_mul_f32 v[126:127], v[126:127], v[8:9]
  v_cvt_pk_bf16_f32 v31, v126, v127
  v_pk_mul_f32 v[128:129], v[128:129], v[8:9]
  v_cvt_pk_bf16_f32 v32, v128, v129
  v_pk_mul_f32 v[130:131], v[130:131], v[8:9]
  v_cvt_pk_bf16_f32 v33, v130, v131
  v_pk_mul_f32 v[132:133], v[132:133], v[8:9]
  v_cvt_pk_bf16_f32 v34, v132, v133
  v_pk_mul_f32 v[134:135], v[134:135], v[8:9]
  v_cvt_pk_bf16_f32 v35, v134, v135
  v_pk_mul_f32 v[136:137], v[136:137], v[8:9]
  v_cvt_pk_bf16_f32 v36, v136, v137
  v_pk_mul_f32 v[138:139], v[138:139], v[8:9]
  v_cvt_pk_bf16_f32 v37, v138, v139
  v_pk_mul_f32 v[140:141], v[140:141], v[8:9]
  v_cvt_pk_bf16_f32 v38, v140, v141
  v_pk_mul_f32 v[142:143], v[142:143], v[8:9]
  v_cvt_pk_bf16_f32 v39, v142, v143
  v_pk_mul_f32 v[144:145], v[144:145], v[8:9]
  v_cvt_pk_bf16_f32 v40, v144, v145
  v_pk_mul_f32 v[146:147], v[146:147], v[8:9]
  v_cvt_pk_bf16_f32 v41, v146, v147
  v_pk_mul_f32 v[148:149], v[148:149], v[8:9]
  v_cvt_pk_bf16_f32 v42, v148, v149
  v_pk_mul_f32 v[150:151], v[150:151], v[8:9]
  v_cvt_pk_bf16_f32 v43, v150, v151
  v_pk_mul_f32 v[152:153], v[152:153], v[8:9]
  v_cvt_pk_bf16_f32 v44, v152, v153
  v_pk_mul_f32 v[154:155], v[154:155], v[8:9]
  v_cvt_pk_bf16_f32 v45, v154, v155
  v_pk_mul_f32 v[156:157], v[156:157], v[8:9]
  v_cvt_pk_bf16_f32 v46, v156, v157
  v_pk_mul_f32 v[158:159], v[158:159], v[8:9]
  v_cvt_pk_bf16_f32 v47, v158, v159
  v_pk_mul_f32 v[160:161], v[160:161], v[8:9]
  v_cvt_pk_bf16_f32 v48, v160, v161
  v_pk_mul_f32 v[162:163], v[162:163], v[8:9]
  v_cvt_pk_bf16_f32 v49, v162, v163
  v_pk_mul_f32 v[164:165], v[164:165], v[8:9]
  v_cvt_pk_bf16_f32 v50, v164, v165
  v_pk_mul_f32 v[166:167], v[166:167], v[8:9]
  v_cvt_pk_bf16_f32 v51, v166, v167
  v_pk_mul_f32 v[168:169], v[168:169], v[8:9]
  v_cvt_pk_bf16_f32 v52, v168, v169
  v_pk_mul_f32 v[170:171], v[170:171], v[8:9]
  v_cvt_pk_bf16_f32 v53, v170, v171
  v_pk_mul_f32 v[172:173], v[172:173], v[8:9]
  v_cvt_pk_bf16_f32 v54, v172, v173
  v_pk_mul_f32 v[174:175], v[174:175], v[8:9]
  v_cvt_pk_bf16_f32 v55, v174, v175
  v_pk_mul_f32 v[176:177], v[176:177], v[8:9]
  v_cvt_pk_bf16_f32 v56, v176, v177
  v_pk_mul_f32 v[178:179], v[178:179], v[8:9]
  v_cvt_pk_bf16_f32 v57, v178, v179
  v_pk_mul_f32 v[180:181], v[180:181], v[8:9]
  v_cvt_pk_bf16_f32 v58, v180, v181
  v_pk_mul_f32 v[182:183], v[182:183], v[8:9]
  v_cvt_pk_bf16_f32 v59, v182, v183
  v_pk_mul_f32 v[184:185], v[184:185], v[8:9]
  v_cvt_pk_bf16_f32 v60, v184, v185
  v_pk_mul_f32 v[186:187], v[186:187], v[8:9]
  v_cvt_pk_bf16_f32 v61, v186, v187
  v_pk_mul_f32 v[188:189], v[188:189], v[8:9]
  v_cvt_pk_bf16_f32 v62, v188, v189
  v_pk_mul_f32 v[190:191], v[190:191], v[8:9]
  v_cvt_pk_bf16_f32 v63, v190, v191
  v_pk_mul_f32 v[192:193], v[192:193], v[8:9]
  v_cvt_pk_bf16_f32 v64, v192, v193
  v_pk_mul_f32 v[194:195], v[194:195], v[8:9]
  v_cvt_pk_bf16_f32 v65, v194, v195
  v_pk_mul_f32 v[196:197], v[196:197], v[8:9]
  v_cvt_pk_bf16_f32 v66, v196, v197
  v_pk_mul_f32 v[198:199], v[198:199], v[8:9]
  v_cvt_pk_bf16_f32 v67, v198, v199
  v_pk_mul_f32 v[200:201], v[200:201], v[8:9]
  v_cvt_pk_bf16_f32 v68, v200, v201
  v_pk_mul_f32 v[202:203], v[202:203], v[8:9]
  v_cvt_pk_bf16_f32 v69, v202, v203
  v_pk_mul_f32 v[204:205], v[204:205], v[8:9]
  v_cvt_pk_bf16_f32 v70, v204, v205
  v_pk_mul_f32 v[206:207], v[206:207], v[8:9]
  v_cvt_pk_bf16_f32 v71, v206, v207
  v_pk_mul_f32 v[208:209], v[208:209], v[8:9]
  v_cvt_pk_bf16_f32 v72, v208, v209
  v_pk_mul_f32 v[210:211], v[210:211], v[8:9]
  v_cvt_pk_bf16_f32 v73, v210, v211
  v_pk_mul_f32 v[212:213], v[212:213], v[8:9]
  v_cvt_pk_bf16_f32 v74, v212, v213
  v_pk_mul_f32 v[214:215], v[214:215], v[8:9]
  v_cvt_pk_bf16_f32 v75, v214, v215
  v_pk_mul_f32 v[216:217], v[216:217], v[8:9]
  v_cvt_pk_bf16_f32 v76, v216, v217
  v_pk_mul_f32 v[218:219], v[218:219], v[8:9]
  v_cvt_pk_bf16_f32 v77, v218, v219
  v_pk_mul_f32 v[220:221], v[220:221], v[8:9]
  v_cvt_pk_bf16_f32 v78, v220, v221
  v_pk_mul_f32 v[222:223], v[222:223], v[8:9]
  v_cvt_pk_bf16_f32 v79, v222, v223
  v_pk_mul_f32 v[224:225], v[224:225], v[8:9]
  v_cvt_pk_bf16_f32 v80, v224, v225
  v_pk_mul_f32 v[226:227], v[226:227], v[8:9]
  v_cvt_pk_bf16_f32 v81, v226, v227
  v_pk_mul_f32 v[228:229], v[228:229], v[8:9]
  v_cvt_pk_bf16_f32 v82, v228, v229
  v_pk_mul_f32 v[230:231], v[230:231], v[8:9]
  v_cvt_pk_bf16_f32 v83, v230, v231
  v_pk_mul_f32 v[232:233], v[232:233], v[8:9]
  v_cvt_pk_bf16_f32 v84, v232, v233
  v_pk_mul_f32 v[234:235], v[234:235], v[8:9]
  v_cvt_pk_bf16_f32 v85, v234, v235
  v_pk_mul_f32 v[236:237], v[236:237], v[8:9]
  v_cvt_pk_bf16_f32 v86, v236, v237
  v_pk_mul_f32 v[238:239], v[238:239], v[8:9]
  v_cvt_pk_bf16_f32 v87, v238, v239
  v_pk_mul_f32 v[240:241], v[240:241], v[8:9]
  v_cvt_pk_bf16_f32 v88, v240, v241
  v_pk_mul_f32 v[242:243], v[242:243], v[8:9]
  v_cvt_pk_bf16_f32 v89, v242, v243
  v_pk_mul_f32 v[244:245], v[244:245], v[8:9]
  v_cvt_pk_bf16_f32 v90, v244, v245
  v_pk_mul_f32 v[246:247], v[246:247], v[8:9]
  v_cvt_pk_bf16_f32 v91, v246, v247
  v_pk_mul_f32 v[248:249], v[248:249], v[8:9]
  v_cvt_pk_bf16_f32 v92, v248, v249
  v_pk_mul_f32 v[250:251], v[250:251], v[8:9]
  v_cvt_pk_bf16_f32 v93, v250, v251
  v_pk_mul_f32 v[252:253], v[252:253], v[8:9]
  v_cvt_pk_bf16_f32 v94, v252, v253
  v_pk_mul_f32 v[254:255], v[254:255], v[8:9]
  v_cvt_pk_bf16_f32 v95, v254, v255
  s_barrier
  ds_read_b128 v[96:99], v2 offset:0
  ds_read_b128 v[100:103], v2 offset:1024
  ds_read_b128 v[104:107], v2 offset:2048
  ds_read_b128 v[108:111], v2 offset:3072
  ds_read_b128 v[112:115], v2 offset:4096
  ds_read_b128 v[116:119], v2 offset:5120
  ds_read_b128 v[120:123], v2 offset:6144
  ds_read_b128 v[124:127], v2 offset:7168
  s_waitcnt lgkmcnt(6)
  v_mfma_f32_16x16x32_bf16 v[136:139], v[96:99], v[16:19], 0
  ds_read_b128 v[128:131], v2 offset:8192
  v_mfma_f32_16x16x32_bf16 v[140:143], v[100:103], v[16:19], 0
  ds_read_b128 v[132:135], v2 offset:9216
  s_waitcnt lgkmcnt(6)
  v_mfma_f32_16x16x32_bf16 v[144:147], v[104:107], v[16:19], 0
  ds_read_b128 v[96:99], v2 offset:10240
  v_mfma_f32_16x16x32_bf16 v[148:151], v[108:111], v[16:19], 0
  ds_read_b128 v[100:103], v2 offset:11264
  s_waitcnt lgkmcnt(6)
  v_mfma_f32_16x16x32_bf16 v[152:155], v[112:115], v[16:19], 0
  ds_read_b128 v[104:107], v2 offset:12288
  v_mfma_f32_16x16x32_bf16 v[156:159], v[116:119], v[16:19], 0
  ds_read_b128 v[108:111], v2 offset:13312
  s_waitcnt lgkmcnt(6)
  v_mfma_f32_16x16x32_bf16 v[160:163], v[120:123], v[16:19], 0
  ds_read_b128 v[112:115], v2 offset:14336
  v_mfma_f32_16x16x32_bf16 v[164:167], v[124:127], v[16:19], 0
  ds_read_b128 v[116:119], v2 offset:15360
  s_waitcnt lgkmcnt(6)
  v_mfma_f32_16x16x32_bf16 v[168:171], v[128:131], v[16:19], 0
  ds_read_b128 v[120:123], v2 offset:16384
  v_mfma_f32_16x16x32_bf16 v[172:175], v[132:135], v[16:19], 0
  ds_read_b128 v[124:127], v2 offset:17408
  s_waitcnt lgkmcnt(6)
  v_mfma_f32_16x16x32_bf16 v[176:179], v[16:19], v[96:99], 0
  ds_read_b128 v[128:131], v2 offset:18432
  v_mfma_f32_16x16x32_bf16 v[180:183], v[16:19], v[100:103], 0
  ds_read_b128 v[132:135], v2 offset:19456
  s_waitcnt lgkmcnt(6)
  v_mfma_f32_16x16x32_bf16 v[184:187], v[16:19], v[104:107], 0
  ds_read_b128 v[96:99], v2 offset:20480
  v_mfma_f32_16x16x32_bf16 v[188:191], v[16:19], v[108:111], 0
  ds_read_b128 v[100:103], v2 offset:21504
  s_waitcnt lgkmcnt(6)
  v_mfma_f32_16x16x32_bf16 v[192:195], v[16:19], v[112:115], 0
  ds_read_b128 v[104:107], v2 offset:22528
  v_mfma_f32_16x16x32_bf16 v[136:139], v[116:119], v[20:23], v[136:139]
  ds_read_b128 v[108:111], v2 offset:23552
  s_waitcnt lgkmcnt(6)
  v_mfma_f32_16x16x32_bf16 v[140:143], v[120:123], v[20:23], v[140:143]
  ds_read_b128 v[112:115], v2 offset:24576
  v_mfma_f32_16x16x32_bf16 v[144:147], v[124:127], v[20:23], v[144:147]
  ds_read_b128 v[116:119], v2 offset:25600
  s_waitcnt lgkmcnt(6)
  v_mfma_f32_16x16x32_bf16 v[148:151], v[128:131], v[20:23], v[148:151]
  ds_read_b128 v[120:123], v2 offset:26624
  v_mfma_f32_16x16x32_bf16 v[152:155], v[132:135], v[20:23], v[152:155]
  ds_read_b128 v[124:127], v2 offset:27648
  s_waitcnt lgkmcnt(6)
  v_mfma_f32_16x16x32_bf16 v[156:159], v[96:99], v[20:23], v[156:159]
  ds_read_b128 v[128:131], v2 offset:28672
  v_mfma_f32_16x16x32_bf16 v[160:163], v[100:103], v[20:23], v[160:163]
  ds_read_b128 v[132:135], v2 offset:29696
  s_waitcnt lgkmcnt(6)
  v_mfma_f32_16x16x32_bf16 v[164:167], v[104:107], v[20:23], v[164:167]
  v_mfma_f32_16x16x32_bf16 v[168:171], v[108:111], v[20:23], v[168:171]
  s_waitcnt lgkmcnt(4)
  v_mfma_f32_16x16x32_bf16 v[172:175], v[112:115], v[20:23], v[172:175]
  v_mfma_f32_16x16x32_bf16 v[176:179], v[20:23], v[116:119], v[176:179]
  s_waitcnt lgkmcnt(2)
  v_mfma_f32_16x16x32_bf16 v[180:183], v[20:23], v[120:123], v[180:183]
  v_mfma_f32_16x16x32_bf16 v[184:187], v[20:23], v[124:127], v[184:187]
  s_waitcnt lgkmcnt(0)
  v_mfma_f32_16x16x32_bf16 v[188:191], v[20:23], v[128:131], v[188:191]
  v_mfma_f32_16x16x32_bf16 v[192:195], v[20:23], v[132:135], v[192:195]
  s_barrier
  ds_read_b128 v[96:99], v2 offset:30720
  ds_read_b128 v[100:103], v2 offset:31744
  ds_read_b128 v[104:107], v2 offset:32768
  ds_read_b128 v[108:111], v2 offset:33792
  ds_read_b128 v[112:115], v2 offset:34816
  ds_read_b128 v[116:119], v2 offset:35840
  ds_read_b128 v[120:123], v2 offset:36864
  ds_read_b128 v[124:127], v2 offset:37888
  s_waitcnt lgkmcnt(6)
  v_mfma_f32_16x16x32_bf16 v[136:139], v[96:99], v[24:27], v[136:139]
  ds_read_b128 v[128:131], v2 offset:38912
  v_mfma_f32_16x16x32_bf16 v[140:143], v[100:103], v[24:27], v[140:143]
  ds_read_b128 v[132:135], v2 offset:39936
  s_waitcnt lgkmcnt(6)
  v_mfma_f32_16x16x32_bf16 v[144:147], v[104:107], v[24:27], v[144:147]
  ds_read_b128 v[96:99], v2 offset:40960
  v_mfma_f32_16x16x32_bf16 v[148:151], v[108:111], v[24:27], v[148:151]
  ds_read_b128 v[100:103], v2 offset:41984
  s_waitcnt lgkmcnt(6)
  v_mfma_f32_16x16x32_bf16 v[152:155], v[112:115], v[24:27], v[152:155]
  ds_read_b128 v[104:107], v2 offset:43008
  v_mfma_f32_16x16x32_bf16 v[156:159], v[116:119], v[24:27], v[156:159]
  ds_read_b128 v[108:111], v2 offset:44032
  s_waitcnt lgkmcnt(6)
  v_mfma_f32_16x16x32_bf16 v[160:163], v[120:123], v[24:27], v[160:163]
  ds_read_b128 v[112:115], v2 offset:45056
  v_mfma_f32_16x16x32_bf16 v[164:167], v[124:127], v[24:27], v[164:167]
  ds_read_b128 v[116:119], v2 offset:46080
  s_waitcnt lgkmcnt(6)
  v_mfma_f32_16x16x32_bf16 v[168:171], v[128:131], v[24:27], v[168:171]
  ds_read_b128 v[120:123], v2 offset:47104
  v_mfma_f32_16x16x32_bf16 v[172:175], v[132:135], v[24:27], v[172:175]
  ds_read_b128 v[124:127], v2 offset:48128
  s_waitcnt lgkmcnt(6)
  v_mfma_f32_16x16x32_bf16 v[176:179], v[24:27], v[96:99], v[176:179]
  ds_read_b128 v[128:131], v2 offset:49152
  v_mfma_f32_16x16x32_bf16 v[180:183], v[24:27], v[100:103], v[180:183]
  ds_read_b128 v[132:135], v2 offset:50176
  s_waitcnt lgkmcnt(6)
  v_mfma_f32_16x16x32_bf16 v[184:187], v[24:27], v[104:107], v[184:187]
  ds_read_b128 v[96:99], v2 offset:51200
  v_mfma_f32_16x16x32_bf16 v[188:191], v[24:27], v[108:111], v[188:191]
  ds_read_b128 v[100:103], v2 offset:52224
  s_waitcnt lgkmcnt(6)
  v_mfma_f32_16x16x32_bf16 v[192:195], v[24:27], v[112:115], v[192:195]
  ds_read_b128 v[104:107], v2 offset:53248
  v_mfma_f32_16x16x32_bf16 v[136:139], v[116:119], v[28:31], v[136:139]
  ds_read_b128 v[108:111], v2 offset:54272
  s_waitcnt lgkmcnt(6)
  v_mfma_f32_16x16x32_bf16 v[140:143], v[120:123], v[28:31], v[140:143]
  ds_read_b128 v[112:115], v2 offset:55296
  v_mfma_f32_16x16x32_bf16 v[144:147], v[124:127], v[28:31], v[144:147]
  ds_read_b128 v[116:119], v2 offset:56320
  s_waitcnt lgkmcnt(6)
  v_mfma_f32_16x16x32_bf16 v[148:151], v[128:131], v[28:31], v[148:151]
  ds_read_b128 v[120:123], v2 offset:57344
  v_mfma_f32_16x16x32_bf16 v[152:155], v[132:135], v[28:31], v[152:155]
  ds_read_b128 v[124:127], v2 offset:58368
  s_waitcnt lgkmcnt(6)
  v_mfma_f32_16x16x32_bf16 v[156:159], v[96:99], v[28:31], v[156:159]
  ds_read_b128 v[128:131], v2 offset:59392
  v_mfma_f32_16x16x32_bf16 v[160:163], v[100:103], v[28:31], v[160:163]
  ds_read_b128 v[132:135], v2 offset:60416
  s_waitcnt lgkmcnt(6)
  v_mfma_f32_16x16x32_bf16 v[164:167], v[104:107], v[28:31], v[164:167]
  v_mfma_f32_16x16x32_bf16 v[168:171], v[108:111], v[28:31], v[168:171]
  s_waitcnt lgkmcnt(4)
  v_mfma_f32_16x16x32_bf16 v[172:175], v[112:115], v[28:31], v[172:175]
  v_mfma_f32_16x16x32_bf16 v[176:179], v[28:31], v[116:119], v[176:179]
  s_waitcnt lgkmcnt(2)
  v_mfma_f32_16x16x32_bf16 v[180:183], v[28:31], v[120:123], v[180:183]
  v_mfma_f32_16x16x32_bf16 v[184:187], v[28:31], v[124:127], v[184:187]
  s_waitcnt lgkmcnt(0)
  v_mfma_f32_16x16x32_bf16 v[188:191], v[28:31], v[128:131], v[188:191]
  v_mfma_f32_16x16x32_bf16 v[192:195], v[28:31], v[132:135], v[192:195]
  s_barrier
  ds_read_b128 v[96:99], v3 offset:0
  ds_read_b128 v[100:103], v3 offset:1024
  ds_read_b128 v[104:107], v3 offset:2048
  ds_read_b128 v[108:111], v3 offset:3072
  ds_read_b128 v[112:115], v3 offset:4096
  ds_read_b128 v[116:119], v3 offset:5120
  ds_read_b128 v[120:123], v3 offset:6144
  ds_read_b128 v[124:127], v3 offset:7168
  s_waitcnt lgkmcnt(6)
  v_mfma_f32_16x16x32_bf16 v[136:139], v[96:99], v[32:35], v[136:139]
  ds_read_b128 v[128:131], v3 offset:8192
  v_mfma_f32_16x16x32_bf16 v[140:143], v[100:103], v[32:35], v[140:143]
  ds_read_b128 v[132:135], v3 offset:9216
  s_waitcnt lgkmcnt(6)
  v_mfma_f32_16x16x32_bf16 v[144:147], v[104:107], v[32:35], v[144:147]
  ds_read_b128 v[96:99], v3 offset:10240
  v_mfma_f32_16x16x32_bf16 v[148:151], v[108:111], v[32:35], v[148:151]
  ds_read_b128 v[100:103], v3 offset:11264
  s_waitcnt lgkmcnt(6)
  v_mfma_f32_16x16x32_bf16 v[152:155], v[112:115], v[32:35], v[152:155]
  ds_read_b128 v[104:107], v3 offset:12288
  v_mfma_f32_16x16x32_bf16 v[156:159], v[116:119], v[32:35], v[156:159]
  ds_read_b128 v[108:111], v3 offset:13312
  s_waitcnt lgkmcnt(6)
  v_mfma_f32_16x16x32_bf16 v[160:163], v[120:123], v[32:35], v[160:163]
  ds_read_b128 v[112:115], v3 offset:14336
  v_mfma_f32_16x16x32_bf16 v[164:167], v[124:127], v[32:35], v[164:167]
  ds_read_b128 v[116:119], v3 offset:15360
  s_waitcnt lgkmcnt(6)
  v_mfma_f32_16x16x32_bf16 v[168:171], v[128:131], v[32:35], v[168:171]
  ds_read_b128 v[120:123], v3 offset:16384
  v_mfma_f32_16x16x32_bf16 v[172:175], v[132:135], v[32:35], v[172:175]
  ds_read_b128 v[124:127], v3 offset:17408
  s_waitcnt lgkmcnt(6)
  v_mfma_f32_16x16x32_bf16 v[176:179], v[32:35], v[96:99], v[176:179]
  ds_read_b128 v[128:131], v3 offset:18432
  v_mfma_f32_16x16x32_bf16 v[180:183], v[32:35], v[100:103], v[180:183]
  ds_read_b128 v[132:135], v3 offset:19456
  s_waitcnt lgkmcnt(6)
  v_mfma_f32_16x16x32_bf16 v[184:187], v[32:35], v[104:107], v[184:187]
  ds_read_b128 v[96:99], v3 offset:20480
  v_mfma_f32_16x16x32_bf16 v[188:191], v[32:35], v[108:111], v[188:191]
  ds_read_b128 v[100:103], v3 offset:21504
  s_waitcnt lgkmcnt(6)
  v_mfma_f32_16x16x32_bf16 v[192:195], v[32:35], v[112:115], v[192:195]
  ds_read_b128 v[104:107], v3 offset:22528
  v_mfma_f32_16x16x32_bf16 v[136:139], v[116:119], v[36:39], v[136:139]
  ds_read_b128 v[108:111], v3 offset:23552
  s_waitcnt lgkmcnt(6)
  v_mfma_f32_16x16x32_bf16 v[140:143], v[120:123], v[36:39], v[140:143]
  ds_read_b128 v[112:115], v3 offset:24576
  v_mfma_f32_16x16x32_bf16 v[144:147], v[124:127], v[36:39], v[144:147]
  ds_read_b128 v[116:119], v3 offset:25600
  s_waitcnt lgkmcnt(6)
  v_mfma_f32_16x16x32_bf16 v[148:151], v[128:131], v[36:39], v[148:151]
  ds_read_b128 v[120:123], v3 offset:26624
  v_mfma_f32_16x16x32_bf16 v[152:155], v[132:135], v[36:39], v[152:155]
  ds_read_b128 v[124:127], v3 offset:27648
  s_waitcnt lgkmcnt(6)
  v_mfma_f32_16x16x32_bf16 v[156:159], v[96:99], v[36:39], v[156:159]
  ds_read_b128 v[128:131], v3 offset:28672
  v_mfma_f32_16x16x32_bf16 v[160:163], v[100:103], v[36:39], v[160:163]
  ds_read_b128 v[132:135], v3 offset:29696
  s_waitcnt lgkmcnt(6)
  v_mfma_f32_16x16x32_bf16 v[164:167], v[104:107], v[36:39], v[164:167]
  v_mfma_f32_16x16x32_bf16 v[168:171], v[108:111], v[36:39], v[168:171]
  s_waitcnt lgkmcnt(4)
  v_mfma_f32_16x16x32_bf16 v[172:175], v[112:115], v[36:39], v[172:175]
  v_mfma_f32_16x16x32_bf16 v[176:179], v[36:39], v[116:119], v[176:179]
  s_waitcnt lgkmcnt(2)
  v_mfma_f32_16x16x32_bf16 v[180:183], v[36:39], v[120:123], v[180:183]
  v_mfma_f32_16x16x32_bf16 v[184:187], v[36:39], v[124:127], v[184:187]
  s_waitcnt lgkmcnt(0)
  v_mfma_f32_16x16x32_bf16 v[188:191], v[36:39], v[128:131], v[188:191]
  v_mfma_f32_16x16x32_bf16 v[192:195], v[36:39], v[132:135], v[192:195]
  s_barrier
  ds_read_b128 v[96:99], v3 offset:30720
  ds_read_b128 v[100:103], v3 offset:31744
  ds_read_b128 v[104:107], v3 offset:32768
  ds_read_b128 v[108:111], v3 offset:33792
  ds_read_b128 v[112:115], v3 offset:34816
  ds_read_b128 v[116:119], v3 offset:35840
  ds_read_b128 v[120:123], v3 offset:36864
  ds_read_b128 v[124:127], v3 offset:37888
  s_waitcnt lgkmcnt(6)
  v_mfma_f32_16x16x32_bf16 v[136:139], v[96:99], v[40:43], v[136:139]
  ds_read_b128 v[128:131], v3 offset:38912
  v_mfma_f32_16x16x32_bf16 v[140:143], v[100:103], v[40:43], v[140:143]
  ds_read_b128 v[132:135], v3 offset:39936
  s_waitcnt lgkmcnt(6)
  v_mfma_f32_16x16x32_bf16 v[144:147], v[104:107], v[40:43], v[144:147]
  ds_read_b128 v[96:99], v3 offset:40960
  v_mfma_f32_16x16x32_bf16 v[148:151], v[108:111], v[40:43], v[148:151]
  ds_read_b128 v[100:103], v3 offset:41984
  s_waitcnt lgkmcnt(6)
  v_mfma_f32_16x16x32_bf16 v[152:155], v[112:115], v[40:43], v[152:155]
  ds_read_b128 v[104:107], v3 offset:43008
  v_mfma_f32_16x16x32_bf16 v[156:159], v[116:119], v[40:43], v[156:159]
  ds_read_b128 v[108:111], v3 offset:44032
  s_waitcnt lgkmcnt(6)
  v_mfma_f32_16x16x32_bf16 v[160:163], v[120:123], v[40:43], v[160:163]
  ds_read_b128 v[112:115], v3 offset:45056
  v_mfma_f32_16x16x32_bf16 v[164:167], v[124:127], v[40:43], v[164:167]
  ds_read_b128 v[116:119], v3 offset:46080
  s_waitcnt lgkmcnt(6)
  v_mfma_f32_16x16x32_bf16 v[168:171], v[128:131], v[40:43], v[168:171]
  ds_read_b128 v[120:123], v3 offset:47104
  v_mfma_f32_16x16x32_bf16 v[172:175], v[132:135], v[40:43], v[172:175]
  ds_read_b128 v[124:127], v3 offset:48128
  s_waitcnt lgkmcnt(6)
  v_mfma_f32_16x16x32_bf16 v[176:179], v[40:43], v[96:99], v[176:179]
  ds_read_b128 v[128:131], v3 offset:49152
  v_mfma_f32_16x16x32_bf16 v[180:183], v[40:43], v[100:103], v[180:183]
  ds_read_b128 v[132:135], v3 offset:50176
  s_waitcnt lgkmcnt(6)
  v_mfma_f32_16x16x32_bf16 v[184:187], v[40:43], v[104:107], v[184:187]
  ds_read_b128 v[96:99], v3 offset:51200
  v_mfma_f32_16x16x32_bf16 v[188:191], v[40:43], v[108:111], v[188:191]
  ds_read_b128 v[100:103], v3 offset:52224
  s_waitcnt lgkmcnt(6)
  v_mfma_f32_16x16x32_bf16 v[192:195], v[40:43], v[112:115], v[192:195]
  ds_read_b128 v[104:107], v3 offset:53248
  v_mfma_f32_16x16x32_bf16 v[136:139], v[116:119], v[44:47], v[136:139]
  ds_read_b128 v[108:111], v3 offset:54272
  s_waitcnt lgkmcnt(6)
  v_mfma_f32_16x16x32_bf16 v[140:143], v[120:123], v[44:47], v[140:143]
  ds_read_b128 v[112:115], v3 offset:55296
  v_mfma_f32_16x16x32_bf16 v[144:147], v[124:127], v[44:47], v[144:147]
  ds_read_b128 v[116:119], v3 offset:56320
  s_waitcnt lgkmcnt(6)
  v_mfma_f32_16x16x32_bf16 v[148:151], v[128:131], v[44:47], v[148:151]
  ds_read_b128 v[120:123], v3 offset:57344
  v_mfma_f32_16x16x32_bf16 v[152:155], v[132:135], v[44:47], v[152:155]
  ds_read_b128 v[124:127], v3 offset:58368
  s_waitcnt lgkmcnt(6)
  v_mfma_f32_16x16x32_bf16 v[156:159], v[96:99], v[44:47], v[156:159]
  ds_read_b128 v[128:131], v3 offset:59392
  v_mfma_f32_16x16x32_bf16 v[160:163], v[100:103], v[44:47], v[160:163]
  ds_read_b128 v[132:135], v3 offset:60416
  s_waitcnt lgkmcnt(6)
  v_mfma_f32_16x16x32_bf16 v[164:167], v[104:107], v[44:47], v[164:167]
  v_mfma_f32_16x16x32_bf16 v[168:171], v[108:111], v[44:47], v[168:171]
  s_waitcnt lgkmcnt(4)
  v_mfma_f32_16x16x32_bf16 v[172:175], v[112:115], v[44:47], v[172:175]
  v_mfma_f32_16x16x32_bf16 v[176:179], v[44:47], v[116:119], v[176:179]
  s_waitcnt lgkmcnt(2)
  v_mfma_f32_16x16x32_bf16 v[180:183], v[44:47], v[120:123], v[180:183]
  v_mfma_f32_16x16x32_bf16 v[184:187], v[44:47], v[124:127], v[184:187]
  s_waitcnt lgkmcnt(0)
  v_mfma_f32_16x16x32_bf16 v[188:191], v[44:47], v[128:131], v[188:191]
  v_mfma_f32_16x16x32_bf16 v[192:195], v[44:47], v[132:135], v[192:195]
  s_barrier
  ds_read_b128 v[96:99], v6 offset:0
  ds_read_b128 v[100:103], v6 offset:1024
  ds_read_b128 v[104:107], v6 offset:2048
  ds_read_b128 v[108:111], v6 offset:3072
  ds_read_b128 v[112:115], v6 offset:4096
  ds_read_b128 v[116:119], v6 offset:5120
  ds_read_b128 v[120:123], v6 offset:6144
  ds_read_b128 v[124:127], v6 offset:7168
  s_waitcnt lgkmcnt(6)
  v_mfma_f32_16x16x32_bf16 v[136:139], v[96:99], v[48:51], v[136:139]
  ds_read_b128 v[128:131], v6 offset:8192
  v_mfma_f32_16x16x32_bf16 v[140:143], v[100:103], v[48:51], v[140:143]
  ds_read_b128 v[132:135], v6 offset:9216
  s_waitcnt lgkmcnt(6)
  v_mfma_f32_16x16x32_bf16 v[144:147], v[104:107], v[48:51], v[144:147]
  ds_read_b128 v[96:99], v6 offset:10240
  v_mfma_f32_16x16x32_bf16 v[148:151], v[108:111], v[48:51], v[148:151]
  ds_read_b128 v[100:103], v6 offset:11264
  s_waitcnt lgkmcnt(6)
  v_mfma_f32_16x16x32_bf16 v[152:155], v[112:115], v[48:51], v[152:155]
  ds_read_b128 v[104:107], v6 offset:12288
  v_mfma_f32_16x16x32_bf16 v[156:159], v[116:119], v[48:51], v[156:159]
  ds_read_b128 v[108:111], v6 offset:13312
  s_waitcnt lgkmcnt(6)
  v_mfma_f32_16x16x32_bf16 v[160:163], v[120:123], v[48:51], v[160:163]
  ds_read_b128 v[112:115], v6 offset:14336
  v_mfma_f32_16x16x32_bf16 v[164:167], v[124:127], v[48:51], v[164:167]
  ds_read_b128 v[116:119], v6 offset:15360
  s_waitcnt lgkmcnt(6)
  v_mfma_f32_16x16x32_bf16 v[168:171], v[128:131], v[48:51], v[168:171]
  ds_read_b128 v[120:123], v6 offset:16384
  v_mfma_f32_16x16x32_bf16 v[172:175], v[132:135], v[48:51], v[172:175]
  ds_read_b128 v[124:127], v6 offset:17408
  s_waitcnt lgkmcnt(6)
  v_mfma_f32_16x16x32_bf16 v[176:179], v[48:51], v[96:99], v[176:179]
  ds_read_b128 v[128:131], v6 offset:18432
  v_mfma_f32_16x16x32_bf16 v[180:183], v[48:51], v[100:103], v[180:183]
  ds_read_b128 v[132:135], v6 offset:19456
  s_waitcnt lgkmcnt(6)
  v_mfma_f32_16x16x32_bf16 v[184:187], v[48:51], v[104:107], v[184:187]
  ds_read_b128 v[96:99], v6 offset:20480
  v_mfma_f32_16x16x32_bf16 v[188:191], v[48:51], v[108:111], v[188:191]
  ds_read_b128 v[100:103], v6 offset:21504
  s_waitcnt lgkmcnt(6)
  v_mfma_f32_16x16x32_bf16 v[192:195], v[48:51], v[112:115], v[192:195]
  ds_read_b128 v[104:107], v6 offset:22528
  v_mfma_f32_16x16x32_bf16 v[136:139], v[116:119], v[52:55], v[136:139]
  ds_read_b128 v[108:111], v6 offset:23552
  s_waitcnt lgkmcnt(6)
  v_mfma_f32_16x16x32_bf16 v[140:143], v[120:123], v[52:55], v[140:143]
  ds_read_b128 v[112:115], v6 offset:24576
  v_mfma_f32_16x16x32_bf16 v[144:147], v[124:127], v[52:55], v[144:147]
  ds_read_b128 v[116:119], v6 offset:25600
  s_waitcnt lgkmcnt(6)
  v_mfma_f32_16x16x32_bf16 v[148:151], v[128:131], v[52:55], v[148:151]
  ds_read_b128 v[120:123], v6 offset:26624
  v_mfma_f32_16x16x32_bf16 v[152:155], v[132:135], v[52:55], v[152:155]
  ds_read_b128 v[124:127], v6 offset:27648
  s_waitcnt lgkmcnt(6)
  v_mfma_f32_16x16x32_bf16 v[156:159], v[96:99], v[52:55], v[156:159]
  ds_read_b128 v[128:131], v6 offset:28672
  v_mfma_f32_16x16x32_bf16 v[160:163], v[100:103], v[52:55], v[160:163]
  ds_read_b128 v[132:135], v6 offset:29696
  s_waitcnt lgkmcnt(6)
  v_mfma_f32_16x16x32_bf16 v[164:167], v[104:107], v[52:55], v[164:167]
  v_mfma_f32_16x16x32_bf16 v[168:171], v[108:111], v[52:55], v[168:171]
  s_waitcnt lgkmcnt(4)
  v_mfma_f32_16x16x32_bf16 v[172:175], v[112:115], v[52:55], v[172:175]
  v_mfma_f32_16x16x32_bf16 v[176:179], v[52:55], v[116:119], v[176:179]
  s_waitcnt lgkmcnt(2)
  v_mfma_f32_16x16x32_bf16 v[180:183], v[52:55], v[120:123], v[180:183]
  v_mfma_f32_16x16x32_bf16 v[184:187], v[52:55], v[124:127], v[184:187]
  s_waitcnt lgkmcnt(0)
  v_mfma_f32_16x16x32_bf16 v[188:191], v[52:55], v[128:131], v[188:191]
  v_mfma_f32_16x16x32_bf16 v[192:195], v[52:55], v[132:135], v[192:195]
  s_barrier
  ds_read_b128 v[96:99], v2 offset:0
  ds_read_b128 v[100:103], v2 offset:1024
  ds_read_b128 v[104:107], v2 offset:2048
  ds_read_b128 v[108:111], v2 offset:3072
  ds_read_b128 v[112:115], v2 offset:4096
  ds_read_b128 v[116:119], v2 offset:5120
  ds_read_b128 v[120:123], v2 offset:6144
  ds_read_b128 v[124:127], v2 offset:7168
  s_waitcnt lgkmcnt(6)
  v_mfma_f32_16x16x32_bf16 v[136:139], v[96:99], v[56:59], v[136:139]
  ds_read_b128 v[128:131], v2 offset:8192
  v_mfma_f32_16x16x32_bf16 v[140:143], v[100:103], v[56:59], v[140:143]
  ds_read_b128 v[132:135], v2 offset:9216
  s_waitcnt lgkmcnt(6)
  v_mfma_f32_16x16x32_bf16 v[144:147], v[104:107], v[56:59], v[144:147]
  ds_read_b128 v[96:99], v2 offset:10240
  v_mfma_f32_16x16x32_bf16 v[148:151], v[108:111], v[56:59], v[148:151]
  ds_read_b128 v[100:103], v2 offset:11264
  s_waitcnt lgkmcnt(6)
  v_mfma_f32_16x16x32_bf16 v[152:155], v[112:115], v[56:59], v[152:155]
  ds_read_b128 v[104:107], v2 offset:12288
  v_mfma_f32_16x16x32_bf16 v[156:159], v[116:119], v[56:59], v[156:159]
  ds_read_b128 v[108:111], v2 offset:13312
  s_waitcnt lgkmcnt(6)
  v_mfma_f32_16x16x32_bf16 v[160:163], v[120:123], v[56:59], v[160:163]
  ds_read_b128 v[112:115], v2 offset:14336
  v_mfma_f32_16x16x32_bf16 v[164:167], v[124:127], v[56:59], v[164:167]
  ds_read_b128 v[116:119], v2 offset:15360
  s_waitcnt lgkmcnt(6)
  v_mfma_f32_16x16x32_bf16 v[168:171], v[128:131], v[56:59], v[168:171]
  ds_read_b128 v[120:123], v2 offset:16384
  v_mfma_f32_16x16x32_bf16 v[172:175], v[132:135], v[56:59], v[172:175]
  ds_read_b128 v[124:127], v2 offset:17408
  s_waitcnt lgkmcnt(6)
  v_mfma_f32_16x16x32_bf16 v[176:179], v[56:59], v[96:99], v[176:179]
  ds_read_b128 v[128:131], v2 offset:18432
  v_mfma_f32_16x16x32_bf16 v[180:183], v[56:59], v[100:103], v[180:183]
  ds_read_b128 v[132:135], v2 offset:19456
  s_waitcnt lgkmcnt(6)
  v_mfma_f32_16x16x32_bf16 v[184:187], v[56:59], v[104:107], v[184:187]
  ds_read_b128 v[96:99], v2 offset:20480
  v_mfma_f32_16x16x32_bf16 v[188:191], v[56:59], v[108:111], v[188:191]
  ds_read_b128 v[100:103], v2 offset:21504
  s_waitcnt lgkmcnt(6)
  v_mfma_f32_16x16x32_bf16 v[192:195], v[56:59], v[112:115], v[192:195]
  ds_read_b128 v[104:107], v2 offset:22528
  v_mfma_f32_16x16x32_bf16 v[136:139], v[116:119], v[60:63], v[136:139]
  ds_read_b128 v[108:111], v2 offset:23552
  s_waitcnt lgkmcnt(6)
  v_mfma_f32_16x16x32_bf16 v[140:143], v[120:123], v[60:63], v[140:143]
  ds_read_b128 v[112:115], v2 offset:24576
  v_mfma_f32_16x16x32_bf16 v[144:147], v[124:127], v[60:63], v[144:147]
  ds_read_b128 v[116:119], v2 offset:25600
  s_waitcnt lgkmcnt(6)
  v_mfma_f32_16x16x32_bf16 v[148:151], v[128:131], v[60:63], v[148:151]
  ds_read_b128 v[120:123], v2 offset:26624
  v_mfma_f32_16x16x32_bf16 v[152:155], v[132:135], v[60:63], v[152:155]
  ds_read_b128 v[124:127], v2 offset:27648
  s_waitcnt lgkmcnt(6)
  v_mfma_f32_16x16x32_bf16 v[156:159], v[96:99], v[60:63], v[156:159]
  ds_read_b128 v[128:131], v2 offset:28672
  v_mfma_f32_16x16x32_bf16 v[160:163], v[100:103], v[60:63], v[160:163]
  ds_read_b128 v[132:135], v2 offset:29696
  s_waitcnt lgkmcnt(6)
  v_mfma_f32_16x16x32_bf16 v[164:167], v[104:107], v[60:63], v[164:167]
  v_mfma_f32_16x16x32_bf16 v[168:171], v[108:111], v[60:63], v[168:171]
  s_waitcnt lgkmcnt(4)
  v_mfma_f32_16x16x32_bf16 v[172:175], v[112:115], v[60:63], v[172:175]
  v_mfma_f32_16x16x32_bf16 v[176:179], v[60:63], v[116:119], v[176:179]
  s_waitcnt lgkmcnt(2)
  v_mfma_f32_16x16x32_bf16 v[180:183], v[60:63], v[120:123], v[180:183]
  v_mfma_f32_16x16x32_bf16 v[184:187], v[60:63], v[124:127], v[184:187]
  s_waitcnt lgkmcnt(0)
  v_mfma_f32_16x16x32_bf16 v[188:191], v[60:63], v[128:131], v[188:191]
  v_mfma_f32_16x16x32_bf16 v[192:195], v[60:63], v[132:135], v[192:195]
  s_barrier
  ds_read_b128 v[96:99], v2 offset:30720
  ds_read_b128 v[100:103], v2 offset:31744
  ds_read_b128 v[104:107], v2 offset:32768
  ds_read_b128 v[108:111], v2 offset:33792
  ds_read_b128 v[112:115], v2 offset:34816
  ds_read_b128 v[116:119], v2 offset:35840
  ds_read_b128 v[120:123], v2 offset:36864
  ds_read_b128 v[124:127], v2 offset:37888
  s_waitcnt lgkmcnt(6)
  v_mfma_f32_16x16x32_bf16 v[136:139], v[96:99], v[64:67], v[136:139]
  ds_read_b128 v[128:131], v2 offset:38912
  v_mfma_f32_16x16x32_bf16 v[140:143], v[100:103], v[64:67], v[140:143]
  ds_read_b128 v[132:135], v2 offset:39936
  s_waitcnt lgkmcnt(6)
  v_mfma_f32_16x16x32_bf16 v[144:147], v[104:107], v[64:67], v[144:147]
  ds_read_b128 v[96:99], v2 offset:40960
  v_mfma_f32_16x16x32_bf16 v[148:151], v[108:111], v[64:67], v[148:151]
  ds_read_b128 v[100:103], v2 offset:41984
  s_waitcnt lgkmcnt(6)
  v_mfma_f32_16x16x32_bf16 v[152:155], v[112:115], v[64:67], v[152:155]
  ds_read_b128 v[104:107], v2 offset:43008
  v_mfma_f32_16x16x32_bf16 v[156:159], v[116:119], v[64:67], v[156:159]
  ds_read_b128 v[108:111], v2 offset:44032
  s_waitcnt lgkmcnt(6)
  v_mfma_f32_16x16x32_bf16 v[160:163], v[120:123], v[64:67], v[160:163]
  ds_read_b128 v[112:115], v2 offset:45056
  v_mfma_f32_16x16x32_bf16 v[164:167], v[124:127], v[64:67], v[164:167]
  ds_read_b128 v[116:119], v2 offset:46080
  s_waitcnt lgkmcnt(6)
  v_mfma_f32_16x16x32_bf16 v[168:171], v[128:131], v[64:67], v[168:171]
  ds_read_b128 v[120:123], v2 offset:47104
  v_mfma_f32_16x16x32_bf16 v[172:175], v[132:135], v[64:67], v[172:175]
  ds_read_b128 v[124:127], v2 offset:48128
  s_waitcnt lgkmcnt(6)
  v_mfma_f32_16x16x32_bf16 v[176:179], v[64:67], v[96:99], v[176:179]
  ds_read_b128 v[128:131], v2 offset:49152
  v_mfma_f32_16x16x32_bf16 v[180:183], v[64:67], v[100:103], v[180:183]
  ds_read_b128 v[132:135], v2 offset:50176
  s_waitcnt lgkmcnt(6)
  v_mfma_f32_16x16x32_bf16 v[184:187], v[64:67], v[104:107], v[184:187]
  ds_read_b128 v[96:99], v2 offset:51200
  v_mfma_f32_16x16x32_bf16 v[188:191], v[64:67], v[108:111], v[188:191]
  ds_read_b128 v[100:103], v2 offset:52224
  s_waitcnt lgkmcnt(6)
  v_mfma_f32_16x16x32_bf16 v[192:195], v[64:67], v[112:115], v[192:195]
  ds_read_b128 v[104:107], v2 offset:53248
  v_mfma_f32_16x16x32_bf16 v[136:139], v[116:119], v[68:71], v[136:139]
  ds_read_b128 v[108:111], v2 offset:54272
  s_waitcnt lgkmcnt(6)
  v_mfma_f32_16x16x32_bf16 v[140:143], v[120:123], v[68:71], v[140:143]
  ds_read_b128 v[112:115], v2 offset:55296
  v_mfma_f32_16x16x32_bf16 v[144:147], v[124:127], v[68:71], v[144:147]
  ds_read_b128 v[116:119], v2 offset:56320
  s_waitcnt lgkmcnt(6)
  v_mfma_f32_16x16x32_bf16 v[148:151], v[128:131], v[68:71], v[148:151]
  ds_read_b128 v[120:123], v2 offset:57344
  v_mfma_f32_16x16x32_bf16 v[152:155], v[132:135], v[68:71], v[152:155]
  ds_read_b128 v[124:127], v2 offset:58368
  s_waitcnt lgkmcnt(6)
  v_mfma_f32_16x16x32_bf16 v[156:159], v[96:99], v[68:71], v[156:159]
  ds_read_b128 v[128:131], v2 offset:59392
  v_mfma_f32_16x16x32_bf16 v[160:163], v[100:103], v[68:71], v[160:163]
  ds_read_b128 v[132:135], v2 offset:60416
  s_waitcnt lgkmcnt(6)
  v_mfma_f32_16x16x32_bf16 v[164:167], v[104:107], v[68:71], v[164:167]
  v_mfma_f32_16x16x32_bf16 v[168:171], v[108:111], v[68:71], v[168:171]
  s_waitcnt lgkmcnt(4)
  v_mfma_f32_16x16x32_bf16 v[172:175], v[112:115], v[68:71], v[172:175]
  v_mfma_f32_16x16x32_bf16 v[176:179], v[68:71], v[116:119], v[176:179]
  s_waitcnt lgkmcnt(2)
  v_mfma_f32_16x16x32_bf16 v[180:183], v[68:71], v[120:123], v[180:183]
  v_mfma_f32_16x16x32_bf16 v[184:187], v[68:71], v[124:127], v[184:187]
  s_waitcnt lgkmcnt(0)
  v_mfma_f32_16x16x32_bf16 v[188:191], v[68:71], v[128:131], v[188:191]
  v_mfma_f32_16x16x32_bf16 v[192:195], v[68:71], v[132:135], v[192:195]
  s_barrier
  ds_read_b128 v[96:99], v3 offset:0
  ds_read_b128 v[100:103], v3 offset:1024
  ds_read_b128 v[104:107], v3 offset:2048
  ds_read_b128 v[108:111], v3 offset:3072
  ds_read_b128 v[112:115], v3 offset:4096
  ds_read_b128 v[116:119], v3 offset:5120
  ds_read_b128 v[120:123], v3 offset:6144
  ds_read_b128 v[124:127], v3 offset:7168
  s_waitcnt lgkmcnt(6)
  v_mfma_f32_16x16x32_bf16 v[136:139], v[96:99], v[72:75], v[136:139]
  ds_read_b128 v[128:131], v3 offset:8192
  v_mfma_f32_16x16x32_bf16 v[140:143], v[100:103], v[72:75], v[140:143]
  ds_read_b128 v[132:135], v3 offset:9216
  s_waitcnt lgkmcnt(6)
  v_mfma_f32_16x16x32_bf16 v[144:147], v[104:107], v[72:75], v[144:147]
  ds_read_b128 v[96:99], v3 offset:10240
  v_mfma_f32_16x16x32_bf16 v[148:151], v[108:111], v[72:75], v[148:151]
  ds_read_b128 v[100:103], v3 offset:11264
  s_waitcnt lgkmcnt(6)
  v_mfma_f32_16x16x32_bf16 v[152:155], v[112:115], v[72:75], v[152:155]
  ds_read_b128 v[104:107], v3 offset:12288
  v_mfma_f32_16x16x32_bf16 v[156:159], v[116:119], v[72:75], v[156:159]
  ds_read_b128 v[108:111], v3 offset:13312
  s_waitcnt lgkmcnt(6)
  v_mfma_f32_16x16x32_bf16 v[160:163], v[120:123], v[72:75], v[160:163]
  ds_read_b128 v[112:115], v3 offset:14336
  v_mfma_f32_16x16x32_bf16 v[164:167], v[124:127], v[72:75], v[164:167]
  ds_read_b128 v[116:119], v3 offset:15360
  s_waitcnt lgkmcnt(6)
  v_mfma_f32_16x16x32_bf16 v[168:171], v[128:131], v[72:75], v[168:171]
  ds_read_b128 v[120:123], v3 offset:16384
  v_mfma_f32_16x16x32_bf16 v[172:175], v[132:135], v[72:75], v[172:175]
  ds_read_b128 v[124:127], v3 offset:17408
  s_waitcnt lgkmcnt(6)
  v_mfma_f32_16x16x32_bf16 v[176:179], v[72:75], v[96:99], v[176:179]
  ds_read_b128 v[128:131], v3 offset:18432
  v_mfma_f32_16x16x32_bf16 v[180:183], v[72:75], v[100:103], v[180:183]
  ds_read_b128 v[132:135], v3 offset:19456
  s_waitcnt lgkmcnt(6)
  v_mfma_f32_16x16x32_bf16 v[184:187], v[72:75], v[104:107], v[184:187]
  ds_read_b128 v[96:99], v3 offset:20480
  v_mfma_f32_16x16x32_bf16 v[188:191], v[72:75], v[108:111], v[188:191]
  ds_read_b128 v[100:103], v3 offset:21504
  s_waitcnt lgkmcnt(6)
  v_mfma_f32_16x16x32_bf16 v[192:195], v[72:75], v[112:115], v[192:195]
  ds_read_b128 v[104:107], v3 offset:22528
  v_mfma_f32_16x16x32_bf16 v[136:139], v[116:119], v[76:79], v[136:139]
  ds_read_b128 v[108:111], v3 offset:23552
  s_waitcnt lgkmcnt(6)
  v_mfma_f32_16x16x32_bf16 v[140:143], v[120:123], v[76:79], v[140:143]
  ds_read_b128 v[112:115], v3 offset:24576
  v_mfma_f32_16x16x32_bf16 v[144:147], v[124:127], v[76:79], v[144:147]
  ds_read_b128 v[116:119], v3 offset:25600
  s_waitcnt lgkmcnt(6)
  v_mfma_f32_16x16x32_bf16 v[148:151], v[128:131], v[76:79], v[148:151]
  ds_read_b128 v[120:123], v3 offset:26624
  v_mfma_f32_16x16x32_bf16 v[152:155], v[132:135], v[76:79], v[152:155]
  ds_read_b128 v[124:127], v3 offset:27648
  s_waitcnt lgkmcnt(6)
  v_mfma_f32_16x16x32_bf16 v[156:159], v[96:99], v[76:79], v[156:159]
  ds_read_b128 v[128:131], v3 offset:28672
  v_mfma_f32_16x16x32_bf16 v[160:163], v[100:103], v[76:79], v[160:163]
  ds_read_b128 v[132:135], v3 offset:29696
  s_waitcnt lgkmcnt(6)
  v_mfma_f32_16x16x32_bf16 v[164:167], v[104:107], v[76:79], v[164:167]
  v_mfma_f32_16x16x32_bf16 v[168:171], v[108:111], v[76:79], v[168:171]
  s_waitcnt lgkmcnt(4)
  v_mfma_f32_16x16x32_bf16 v[172:175], v[112:115], v[76:79], v[172:175]
  v_mfma_f32_16x16x32_bf16 v[176:179], v[76:79], v[116:119], v[176:179]
  s_waitcnt lgkmcnt(2)
  v_mfma_f32_16x16x32_bf16 v[180:183], v[76:79], v[120:123], v[180:183]
  v_mfma_f32_16x16x32_bf16 v[184:187], v[76:79], v[124:127], v[184:187]
  s_waitcnt lgkmcnt(0)
  v_mfma_f32_16x16x32_bf16 v[188:191], v[76:79], v[128:131], v[188:191]
  v_mfma_f32_16x16x32_bf16 v[192:195], v[76:79], v[132:135], v[192:195]
  s_barrier
  ds_read_b128 v[96:99], v3 offset:30720
  ds_read_b128 v[100:103], v3 offset:31744
  ds_read_b128 v[104:107], v3 offset:32768
  ds_read_b128 v[108:111], v3 offset:33792
  ds_read_b128 v[112:115], v3 offset:34816
  ds_read_b128 v[116:119], v3 offset:35840
  ds_read_b128 v[120:123], v3 offset:36864
  ds_read_b128 v[124:127], v3 offset:37888
  s_waitcnt lgkmcnt(6)
  v_mfma_f32_16x16x32_bf16 v[136:139], v[96:99], v[80:83], v[136:139]
  ds_read_b128 v[128:131], v3 offset:38912
  v_mfma_f32_16x16x32_bf16 v[140:143], v[100:103], v[80:83], v[140:143]
  ds_read_b128 v[132:135], v3 offset:39936
  s_waitcnt lgkmcnt(6)
  v_mfma_f32_16x16x32_bf16 v[144:147], v[104:107], v[80:83], v[144:147]
  ds_read_b128 v[96:99], v3 offset:40960
  v_mfma_f32_16x16x32_bf16 v[148:151], v[108:111], v[80:83], v[148:151]
  ds_read_b128 v[100:103], v3 offset:41984
  s_waitcnt lgkmcnt(6)
  v_mfma_f32_16x16x32_bf16 v[152:155], v[112:115], v[80:83], v[152:155]
  ds_read_b128 v[104:107], v3 offset:43008
  v_mfma_f32_16x16x32_bf16 v[156:159], v[116:119], v[80:83], v[156:159]
  ds_read_b128 v[108:111], v3 offset:44032
  s_waitcnt lgkmcnt(6)
  v_mfma_f32_16x16x32_bf16 v[160:163], v[120:123], v[80:83], v[160:163]
  ds_read_b128 v[112:115], v3 offset:45056
  v_mfma_f32_16x16x32_bf16 v[164:167], v[124:127], v[80:83], v[164:167]
  ds_read_b128 v[116:119], v3 offset:46080
  s_waitcnt lgkmcnt(6)
  v_mfma_f32_16x16x32_bf16 v[168:171], v[128:131], v[80:83], v[168:171]
  ds_read_b128 v[120:123], v3 offset:47104
  v_mfma_f32_16x16x32_bf16 v[172:175], v[132:135], v[80:83], v[172:175]
  ds_read_b128 v[124:127], v3 offset:48128
  s_waitcnt lgkmcnt(6)
  v_mfma_f32_16x16x32_bf16 v[176:179], v[80:83], v[96:99], v[176:179]
  ds_read_b128 v[128:131], v3 offset:49152
  v_mfma_f32_16x16x32_bf16 v[180:183], v[80:83], v[100:103], v[180:183]
  ds_read_b128 v[132:135], v3 offset:50176
  s_waitcnt lgkmcnt(6)
  v_mfma_f32_16x16x32_bf16 v[184:187], v[80:83], v[104:107], v[184:187]
  ds_read_b128 v[96:99], v3 offset:51200
  v_mfma_f32_16x16x32_bf16 v[188:191], v[80:83], v[108:111], v[188:191]
  ds_read_b128 v[100:103], v3 offset:52224
  s_waitcnt lgkmcnt(6)
  v_mfma_f32_16x16x32_bf16 v[192:195], v[80:83], v[112:115], v[192:195]
  ds_read_b128 v[104:107], v3 offset:53248
  v_mfma_f32_16x16x32_bf16 v[136:139], v[116:119], v[84:87], v[136:139]
  ds_read_b128 v[108:111], v3 offset:54272
  s_waitcnt lgkmcnt(6)
  v_mfma_f32_16x16x32_bf16 v[140:143], v[120:123], v[84:87], v[140:143]
  ds_read_b128 v[112:115], v3 offset:55296
  v_mfma_f32_16x16x32_bf16 v[144:147], v[124:127], v[84:87], v[144:147]
  ds_read_b128 v[116:119], v3 offset:56320
  s_waitcnt lgkmcnt(6)
  v_mfma_f32_16x16x32_bf16 v[148:151], v[128:131], v[84:87], v[148:151]
  ds_read_b128 v[120:123], v3 offset:57344
  v_mfma_f32_16x16x32_bf16 v[152:155], v[132:135], v[84:87], v[152:155]
  ds_read_b128 v[124:127], v3 offset:58368
  s_waitcnt lgkmcnt(6)
  v_mfma_f32_16x16x32_bf16 v[156:159], v[96:99], v[84:87], v[156:159]
  ds_read_b128 v[128:131], v3 offset:59392
  v_mfma_f32_16x16x32_bf16 v[160:163], v[100:103], v[84:87], v[160:163]
  ds_read_b128 v[132:135], v3 offset:60416
  s_waitcnt lgkmcnt(6)
  v_mfma_f32_16x16x32_bf16 v[164:167], v[104:107], v[84:87], v[164:167]
  v_mfma_f32_16x16x32_bf16 v[168:171], v[108:111], v[84:87], v[168:171]
  s_waitcnt lgkmcnt(4)
  v_mfma_f32_16x16x32_bf16 v[172:175], v[112:115], v[84:87], v[172:175]
  v_mfma_f32_16x16x32_bf16 v[176:179], v[84:87], v[116:119], v[176:179]
  s_waitcnt lgkmcnt(2)
  v_mfma_f32_16x16x32_bf16 v[180:183], v[84:87], v[120:123], v[180:183]
  v_mfma_f32_16x16x32_bf16 v[184:187], v[84:87], v[124:127], v[184:187]
  s_waitcnt lgkmcnt(0)
  v_mfma_f32_16x16x32_bf16 v[188:191], v[84:87], v[128:131], v[188:191]
  v_mfma_f32_16x16x32_bf16 v[192:195], v[84:87], v[132:135], v[192:195]
  s_barrier
  ds_read_b128 v[96:99], v6 offset:0
  ds_read_b128 v[100:103], v6 offset:1024
  ds_read_b128 v[104:107], v6 offset:2048
  ds_read_b128 v[108:111], v6 offset:3072
  ds_read_b128 v[112:115], v6 offset:4096
  ds_read_b128 v[116:119], v6 offset:5120
  ds_read_b128 v[120:123], v6 offset:6144
  ds_read_b128 v[124:127], v6 offset:7168
  s_waitcnt lgkmcnt(6)
  v_mfma_f32_16x16x32_bf16 v[136:139], v[96:99], v[88:91], v[136:139]
  ds_read_b128 v[128:131], v6 offset:8192
  v_mfma_f32_16x16x32_bf16 v[140:143], v[100:103], v[88:91], v[140:143]
  ds_read_b128 v[132:135], v6 offset:9216
  s_waitcnt lgkmcnt(6)
  v_mfma_f32_16x16x32_bf16 v[144:147], v[104:107], v[88:91], v[144:147]
  ds_read_b128 v[96:99], v6 offset:10240
  v_mfma_f32_16x16x32_bf16 v[148:151], v[108:111], v[88:91], v[148:151]
  ds_read_b128 v[100:103], v6 offset:11264
  s_waitcnt lgkmcnt(6)
  v_mfma_f32_16x16x32_bf16 v[152:155], v[112:115], v[88:91], v[152:155]
  ds_read_b128 v[104:107], v6 offset:12288
  v_mfma_f32_16x16x32_bf16 v[156:159], v[116:119], v[88:91], v[156:159]
  ds_read_b128 v[108:111], v6 offset:13312
  s_waitcnt lgkmcnt(6)
  v_mfma_f32_16x16x32_bf16 v[160:163], v[120:123], v[88:91], v[160:163]
  ds_read_b128 v[112:115], v6 offset:14336
  v_mfma_f32_16x16x32_bf16 v[164:167], v[124:127], v[88:91], v[164:167]
  ds_read_b128 v[116:119], v6 offset:15360
  s_waitcnt lgkmcnt(6)
  v_mfma_f32_16x16x32_bf16 v[168:171], v[128:131], v[88:91], v[168:171]
  ds_read_b128 v[120:123], v6 offset:16384
  v_mfma_f32_16x16x32_bf16 v[172:175], v[132:135], v[88:91], v[172:175]
  ds_read_b128 v[124:127], v6 offset:17408
  s_waitcnt lgkmcnt(6)
  v_mfma_f32_16x16x32_bf16 v[176:179], v[88:91], v[96:99], v[176:179]
  ds_read_b128 v[128:131], v6 offset:18432
  v_mfma_f32_16x16x32_bf16 v[180:183], v[88:91], v[100:103], v[180:183]
  ds_read_b128 v[132:135], v6 offset:19456
  s_waitcnt lgkmcnt(6)
  v_mfma_f32_16x16x32_bf16 v[184:187], v[88:91], v[104:107], v[184:187]
  ds_read_b128 v[96:99], v6 offset:20480
  v_mfma_f32_16x16x32_bf16 v[188:191], v[88:91], v[108:111], v[188:191]
  ds_read_b128 v[100:103], v6 offset:21504
  s_waitcnt lgkmcnt(6)
  v_mfma_f32_16x16x32_bf16 v[192:195], v[88:91], v[112:115], v[192:195]
  ds_read_b128 v[104:107], v6 offset:22528
  v_mfma_f32_16x16x32_bf16 v[136:139], v[116:119], v[92:95], v[136:139]
  ds_read_b128 v[108:111], v6 offset:23552
  s_waitcnt lgkmcnt(6)
  v_mfma_f32_16x16x32_bf16 v[140:143], v[120:123], v[92:95], v[140:143]
  ds_read_b128 v[112:115], v6 offset:24576
  v_mfma_f32_16x16x32_bf16 v[144:147], v[124:127], v[92:95], v[144:147]
  ds_read_b128 v[116:119], v6 offset:25600
  s_waitcnt lgkmcnt(6)
  v_mfma_f32_16x16x32_bf16 v[148:151], v[128:131], v[92:95], v[148:151]
  ds_read_b128 v[120:123], v6 offset:26624
  v_mfma_f32_16x16x32_bf16 v[152:155], v[132:135], v[92:95], v[152:155]
  ds_read_b128 v[124:127], v6 offset:27648
  s_waitcnt lgkmcnt(6)
  v_mfma_f32_16x16x32_bf16 v[156:159], v[96:99], v[92:95], v[156:159]
  ds_read_b128 v[128:131], v6 offset:28672
  v_mfma_f32_16x16x32_bf16 v[160:163], v[100:103], v[92:95], v[160:163]
  ds_read_b128 v[132:135], v6 offset:29696
  s_waitcnt lgkmcnt(6)
  v_mfma_f32_16x16x32_bf16 v[164:167], v[104:107], v[92:95], v[164:167]
  v_mfma_f32_16x16x32_bf16 v[168:171], v[108:111], v[92:95], v[168:171]
  s_waitcnt lgkmcnt(4)
  v_mfma_f32_16x16x32_bf16 v[172:175], v[112:115], v[92:95], v[172:175]
  v_mfma_f32_16x16x32_bf16 v[176:179], v[92:95], v[116:119], v[176:179]
  s_waitcnt lgkmcnt(2)
  v_mfma_f32_16x16x32_bf16 v[180:183], v[92:95], v[120:123], v[180:183]
  v_mfma_f32_16x16x32_bf16 v[184:187], v[92:95], v[124:127], v[184:187]
  s_waitcnt lgkmcnt(0)
  v_mfma_f32_16x16x32_bf16 v[188:191], v[92:95], v[128:131], v[188:191]
  v_mfma_f32_16x16x32_bf16 v[192:195], v[92:95], v[132:135], v[192:195]
  v_max3_f32 v8, v156, v157, v158
  v_max3_f32 v8, v8, v159, v160
  v_max3_f32 v8, v8, v161, v162
  v_max3_f32 v8, v8, v163, v164
  v_max3_f32 v8, v8, v165, v166
  v_max3_f32 v8, v8, v167, v168
  v_max3_f32 v8, v8, v169, v170
  v_max3_f32 v8, v8, v171, v172
  v_max3_f32 v8, v8, v173, v174
  v_max_f32 v8, v8, v175
  v_min3_f32 v9, v156, v157, v158
  v_min3_f32 v9, v9, v159, v160
  v_min3_f32 v9, v9, v161, v162
  v_min3_f32 v9, v9, v163, v164
  v_min3_f32 v9, v9, v165, v166
  v_min3_f32 v9, v9, v167, v168
  v_min3_f32 v9, v9, v169, v170
  v_min3_f32 v9, v9, v171, v172
  v_min3_f32 v9, v9, v173, v174
  v_min_f32 v9, v9, v175
  v_mul_f32 v8, s31, v8
  v_mul_f32 v9, s31, v9
  v_fma_f32 v16, v156, s31, -v8
  v_fma_f32 v36, -v156, s31, v9
  v_fma_f32 v17, v157, s31, -v8
  v_fma_f32 v37, -v157, s31, v9
  v_fma_f32 v18, v158, s31, -v8
  v_fma_f32 v38, -v158, s31, v9
  v_fma_f32 v19, v159, s31, -v8
  v_fma_f32 v39, -v159, s31, v9
  v_fma_f32 v20, v160, s31, -v8
  v_fma_f32 v40, -v160, s31, v9
  v_fma_f32 v21, v161, s31, -v8
  v_fma_f32 v41, -v161, s31, v9
  v_fma_f32 v22, v162, s31, -v8
  v_fma_f32 v42, -v162, s31, v9
  v_fma_f32 v23, v163, s31, -v8
  v_fma_f32 v43, -v163, s31, v9
  v_fma_f32 v24, v164, s31, -v8
  v_fma_f32 v44, -v164, s31, v9
  v_fma_f32 v25, v165, s31, -v8
  v_fma_f32 v45, -v165, s31, v9
  v_fma_f32 v26, v166, s31, -v8
  v_fma_f32 v46, -v166, s31, v9
  v_fma_f32 v27, v167, s31, -v8
  v_fma_f32 v47, -v167, s31, v9
  v_fma_f32 v28, v168, s31, -v8
  v_fma_f32 v48, -v168, s31, v9
  v_fma_f32 v29, v169, s31, -v8
  v_fma_f32 v49, -v169, s31, v9
  v_fma_f32 v30, v170, s31, -v8
  v_fma_f32 v50, -v170, s31, v9
  v_fma_f32 v31, v171, s31, -v8
  v_fma_f32 v51, -v171, s31, v9
  v_fma_f32 v32, v172, s31, -v8
  v_fma_f32 v52, -v172, s31, v9
  v_fma_f32 v33, v173, s31, -v8
  v_fma_f32 v53, -v173, s31, v9
  v_fma_f32 v34, v174, s31, -v8
  v_fma_f32 v54, -v174, s31, v9
  v_fma_f32 v35, v175, s31, -v8
  v_fma_f32 v55, -v175, s31, v9
  v_exp_f32 v16, v16
  v_exp_f32 v17, v17
  v_exp_f32 v18, v18
  v_exp_f32 v19, v19
  v_exp_f32 v20, v20
  v_exp_f32 v21, v21
  v_exp_f32 v22, v22
  v_exp_f32 v23, v23
  v_exp_f32 v24, v24
  v_exp_f32 v25, v25
  v_exp_f32 v26, v26
  v_exp_f32 v27, v27
  v_exp_f32 v28, v28
  v_exp_f32 v29, v29
  v_exp_f32 v30, v30
  v_exp_f32 v31, v31
  v_exp_f32 v32, v32
  v_exp_f32 v33, v33
  v_exp_f32 v34, v34
  v_exp_f32 v35, v35
  v_exp_f32 v36, v36
  v_exp_f32 v37, v37
  v_exp_f32 v38, v38
  v_exp_f32 v39, v39
  v_exp_f32 v40, v40
  v_exp_f32 v41, v41
  v_exp_f32 v42, v42
  v_exp_f32 v43, v43
  v_exp_f32 v44, v44
  v_exp_f32 v45, v45
  v_exp_f32 v46, v46
  v_exp_f32 v47, v47
  v_exp_f32 v48, v48
  v_exp_f32 v49, v49
  v_exp_f32 v50, v50
  v_exp_f32 v51, v51
  v_exp_f32 v52, v52
  v_exp_f32 v53, v53
  v_exp_f32 v54, v54
  v_exp_f32 v55, v55
  v_pk_add_f32 v[8:9], v[16:17], v[18:19]
  v_pk_add_f32 v[8:9], v[8:9], v[20:21]
  v_pk_add_f32 v[8:9], v[8:9], v[22:23]
  v_pk_add_f32 v[8:9], v[8:9], v[24:25]
  v_pk_add_f32 v[8:9], v[8:9], v[26:27]
  v_pk_add_f32 v[8:9], v[8:9], v[28:29]
  v_pk_add_f32 v[8:9], v[8:9], v[30:31]
  v_pk_add_f32 v[8:9], v[8:9], v[32:33]
  v_pk_add_f32 v[8:9], v[8:9], v[34:35]
  v_add_f32 v8, v8, v9
  v_rcp_f32 v8, v8
  s_nop 0
  v_mov_b32 v9, v8
  v_pk_mul_f32 v[16:17], v[16:17], v[8:9]
  v_cvt_pk_bf16_f32 v56, v16, v17
  v_pk_mul_f32 v[18:19], v[18:19], v[8:9]
  v_cvt_pk_bf16_f32 v57, v18, v19
  v_pk_mul_f32 v[20:21], v[20:21], v[8:9]
  v_cvt_pk_bf16_f32 v58, v20, v21
  v_pk_mul_f32 v[22:23], v[22:23], v[8:9]
  v_cvt_pk_bf16_f32 v59, v22, v23
  v_pk_mul_f32 v[24:25], v[24:25], v[8:9]
  v_cvt_pk_bf16_f32 v60, v24, v25
  v_pk_mul_f32 v[26:27], v[26:27], v[8:9]
  v_cvt_pk_bf16_f32 v61, v26, v27
  v_pk_mul_f32 v[28:29], v[28:29], v[8:9]
  v_cvt_pk_bf16_f32 v62, v28, v29
  v_pk_mul_f32 v[30:31], v[30:31], v[8:9]
  v_cvt_pk_bf16_f32 v63, v30, v31
  v_pk_mul_f32 v[32:33], v[32:33], v[8:9]
  v_cvt_pk_bf16_f32 v64, v32, v33
  v_pk_mul_f32 v[34:35], v[34:35], v[8:9]
  v_cvt_pk_bf16_f32 v65, v34, v35
  v_pk_add_f32 v[10:11], v[36:37], v[38:39]
  v_pk_add_f32 v[10:11], v[10:11], v[40:41]
  v_pk_add_f32 v[10:11], v[10:11], v[42:43]
  v_pk_add_f32 v[10:11], v[10:11], v[44:45]
  v_pk_add_f32 v[10:11], v[10:11], v[46:47]
  v_pk_add_f32 v[10:11], v[10:11], v[48:49]
  v_pk_add_f32 v[10:11], v[10:11], v[50:51]
  v_pk_add_f32 v[10:11], v[10:11], v[52:53]
  v_pk_add_f32 v[10:11], v[10:11], v[54:55]
  v_add_f32 v10, v10, v11
  v_rcp_f32 v10, v10
  s_nop 0
  v_mov_b32 v11, v10
  v_pk_mul_f32 v[36:37], v[36:37], v[10:11]
  v_cvt_pk_bf16_f32 v66, v36, v37
  v_pk_mul_f32 v[38:39], v[38:39], v[10:11]
  v_cvt_pk_bf16_f32 v67, v38, v39
  v_pk_mul_f32 v[40:41], v[40:41], v[10:11]
  v_cvt_pk_bf16_f32 v68, v40, v41
  v_pk_mul_f32 v[42:43], v[42:43], v[10:11]
  v_cvt_pk_bf16_f32 v69, v42, v43
  v_pk_mul_f32 v[44:45], v[44:45], v[10:11]
  v_cvt_pk_bf16_f32 v70, v44, v45
  v_pk_mul_f32 v[46:47], v[46:47], v[10:11]
  v_cvt_pk_bf16_f32 v71, v46, v47
  v_pk_mul_f32 v[48:49], v[48:49], v[10:11]
  v_cvt_pk_bf16_f32 v72, v48, v49
  v_pk_mul_f32 v[50:51], v[50:51], v[10:11]
  v_cvt_pk_bf16_f32 v73, v50, v51
  v_pk_mul_f32 v[52:53], v[52:53], v[10:11]
  v_cvt_pk_bf16_f32 v74, v52, v53
  v_pk_mul_f32 v[54:55], v[54:55], v[10:11]
  v_cvt_pk_bf16_f32 v75, v54, v55
  s_lshl_b32 s14, s3, 2
  v_add_u32 v7, s14, v5
  v_mul_u32_u24 v7, 1536, v7
  v_mul_u32_u24 v12, 96, v4
  v_add3_u32 v7, v7, v12, v3
  v_sub_u32 v7, v7, v2
  ds_write_b128 v7, v[56:59] offset:0
  ds_write_b128 v7, v[60:63] offset:16
  ds_write_b128 v7, v[64:67] offset:32
  ds_write_b128 v7, v[68:71] offset:48
  ds_write_b128 v7, v[72:75] offset:64
  v_lshlrev_b32 v12, 3, v1
  s_mul_i32 s14, s3, 2560
  s_add_u32 s14, s14, 86016
  v_add_u32 v13, s14, v12
  v_cvt_pk_bf16_f32 v176, v176, v177
  v_cvt_pk_bf16_f32 v177, v178, v179
  ds_write_b64 v13, v[176:177] offset:0
  v_cvt_pk_bf16_f32 v180, v180, v181
  v_cvt_pk_bf16_f32 v181, v182, v183
  ds_write_b64 v13, v[180:181] offset:512
  v_cvt_pk_bf16_f32 v184, v184, v185
  v_cvt_pk_bf16_f32 v185, v186, v187
  ds_write_b64 v13, v[184:185] offset:1024
  v_cvt_pk_bf16_f32 v188, v188, v189
  v_cvt_pk_bf16_f32 v189, v190, v191
  ds_write_b64 v13, v[188:189] offset:1536
  v_cvt_pk_bf16_f32 v192, v192, v193
  v_cvt_pk_bf16_f32 v193, v194, v195
  ds_write_b64 v13, v[192:193] offset:2048
  v_max3_f32 v8, v136, v137, v138
  v_max3_f32 v8, v8, v139, v140
  v_max3_f32 v8, v8, v141, v142
  v_max3_f32 v8, v8, v143, v144
  v_max3_f32 v8, v8, v145, v146
  v_max3_f32 v8, v8, v147, v148
  v_max3_f32 v8, v8, v149, v150
  v_max3_f32 v8, v8, v151, v152
  v_max3_f32 v8, v8, v153, v154
  v_max_f32 v8, v8, v155
  v_min3_f32 v9, v136, v137, v138
  v_min3_f32 v9, v9, v139, v140
  v_min3_f32 v9, v9, v141, v142
  v_min3_f32 v9, v9, v143, v144
  v_min3_f32 v9, v9, v145, v146
  v_min3_f32 v9, v9, v147, v148
  v_min3_f32 v9, v9, v149, v150
  v_min3_f32 v9, v9, v151, v152
  v_min3_f32 v9, v9, v153, v154
  v_min_f32 v9, v9, v155
  v_mul_f32 v8, s31, v8
  v_mul_f32 v9, s31, v9
  v_fma_f32 v16, v136, s31, -v8
  v_fma_f32 v36, -v136, s31, v9
  v_fma_f32 v17, v137, s31, -v8
  v_fma_f32 v37, -v137, s31, v9
  v_fma_f32 v18, v138, s31, -v8
  v_fma_f32 v38, -v138, s31, v9
  v_fma_f32 v19, v139, s31, -v8
  v_fma_f32 v39, -v139, s31, v9
  v_fma_f32 v20, v140, s31, -v8
  v_fma_f32 v40, -v140, s31, v9
  v_fma_f32 v21, v141, s31, -v8
  v_fma_f32 v41, -v141, s31, v9
  v_fma_f32 v22, v142, s31, -v8
  v_fma_f32 v42, -v142, s31, v9
  v_fma_f32 v23, v143, s31, -v8
  v_fma_f32 v43, -v143, s31, v9
  v_fma_f32 v24, v144, s31, -v8
  v_fma_f32 v44, -v144, s31, v9
  v_fma_f32 v25, v145, s31, -v8
  v_fma_f32 v45, -v145, s31, v9
  v_fma_f32 v26, v146, s31, -v8
  v_fma_f32 v46, -v146, s31, v9
  v_fma_f32 v27, v147, s31, -v8
  v_fma_f32 v47, -v147, s31, v9
  v_fma_f32 v28, v148, s31, -v8
  v_fma_f32 v48, -v148, s31, v9
  v_fma_f32 v29, v149, s31, -v8
  v_fma_f32 v49, -v149, s31, v9
  v_fma_f32 v30, v150, s31, -v8
  v_fma_f32 v50, -v150, s31, v9
  v_fma_f32 v31, v151, s31, -v8
  v_fma_f32 v51, -v151, s31, v9
  v_fma_f32 v32, v152, s31, -v8
  v_fma_f32 v52, -v152, s31, v9
  v_fma_f32 v33, v153, s31, -v8
  v_fma_f32 v53, -v153, s31, v9
  v_fma_f32 v34, v154, s31, -v8
  v_fma_f32 v54, -v154, s31, v9
  v_fma_f32 v35, v155, s31, -v8
  v_fma_f32 v55, -v155, s31, v9
  v_exp_f32 v16, v16
  v_exp_f32 v17, v17
  v_exp_f32 v18, v18
  v_exp_f32 v19, v19
  v_exp_f32 v20, v20
  v_exp_f32 v21, v21
  v_exp_f32 v22, v22
  v_exp_f32 v23, v23
  v_exp_f32 v24, v24
  v_exp_f32 v25, v25
  v_exp_f32 v26, v26
  v_exp_f32 v27, v27
  v_exp_f32 v28, v28
  v_exp_f32 v29, v29
  v_exp_f32 v30, v30
  v_exp_f32 v31, v31
  v_exp_f32 v32, v32
  v_exp_f32 v33, v33
  v_exp_f32 v34, v34
  v_exp_f32 v35, v35
  v_exp_f32 v36, v36
  v_exp_f32 v37, v37
  v_exp_f32 v38, v38
  v_exp_f32 v39, v39
  v_exp_f32 v40, v40
  v_exp_f32 v41, v41
  v_exp_f32 v42, v42
  v_exp_f32 v43, v43
  v_exp_f32 v44, v44
  v_exp_f32 v45, v45
  v_exp_f32 v46, v46
  v_exp_f32 v47, v47
  v_exp_f32 v48, v48
  v_exp_f32 v49, v49
  v_exp_f32 v50, v50
  v_exp_f32 v51, v51
  v_exp_f32 v52, v52
  v_exp_f32 v53, v53
  v_exp_f32 v54, v54
  v_exp_f32 v55, v55
  v_pk_add_f32 v[8:9], v[16:17], v[18:19]
  v_pk_add_f32 v[8:9], v[8:9], v[20:21]
  v_pk_add_f32 v[8:9], v[8:9], v[22:23]
  v_pk_add_f32 v[8:9], v[8:9], v[24:25]
  v_pk_add_f32 v[8:9], v[8:9], v[26:27]
  v_pk_add_f32 v[8:9], v[8:9], v[28:29]
  v_pk_add_f32 v[8:9], v[8:9], v[30:31]
  v_pk_add_f32 v[8:9], v[8:9], v[32:33]
  v_pk_add_f32 v[8:9], v[8:9], v[34:35]
  v_add_f32 v8, v8, v9
  v_rcp_f32 v8, v8
  s_nop 0
  v_mov_b32 v9, v8
  v_pk_mul_f32 v[16:17], v[16:17], v[8:9]
  v_cvt_pk_bf16_f32 v76, v16, v17
  v_pk_mul_f32 v[18:19], v[18:19], v[8:9]
  v_cvt_pk_bf16_f32 v77, v18, v19
  v_pk_mul_f32 v[20:21], v[20:21], v[8:9]
  v_cvt_pk_bf16_f32 v78, v20, v21
  v_pk_mul_f32 v[22:23], v[22:23], v[8:9]
  v_cvt_pk_bf16_f32 v79, v22, v23
  v_pk_mul_f32 v[24:25], v[24:25], v[8:9]
  v_cvt_pk_bf16_f32 v80, v24, v25
  v_pk_mul_f32 v[26:27], v[26:27], v[8:9]
  v_cvt_pk_bf16_f32 v81, v26, v27
  v_pk_mul_f32 v[28:29], v[28:29], v[8:9]
  v_cvt_pk_bf16_f32 v82, v28, v29
  v_pk_mul_f32 v[30:31], v[30:31], v[8:9]
  v_cvt_pk_bf16_f32 v83, v30, v31
  v_pk_mul_f32 v[32:33], v[32:33], v[8:9]
  v_cvt_pk_bf16_f32 v84, v32, v33
  v_pk_mul_f32 v[34:35], v[34:35], v[8:9]
  v_cvt_pk_bf16_f32 v85, v34, v35
  v_pk_add_f32 v[10:11], v[36:37], v[38:39]
  v_pk_add_f32 v[10:11], v[10:11], v[40:41]
  v_pk_add_f32 v[10:11], v[10:11], v[42:43]
  v_pk_add_f32 v[10:11], v[10:11], v[44:45]
  v_pk_add_f32 v[10:11], v[10:11], v[46:47]
  v_pk_add_f32 v[10:11], v[10:11], v[48:49]
  v_pk_add_f32 v[10:11], v[10:11], v[50:51]
  v_pk_add_f32 v[10:11], v[10:11], v[52:53]
  v_pk_add_f32 v[10:11], v[10:11], v[54:55]
  v_add_f32 v10, v10, v11
  v_rcp_f32 v10, v10
  s_nop 0
  v_mov_b32 v11, v10
  v_pk_mul_f32 v[36:37], v[36:37], v[10:11]
  v_cvt_pk_bf16_f32 v86, v36, v37
  v_pk_mul_f32 v[38:39], v[38:39], v[10:11]
  v_cvt_pk_bf16_f32 v87, v38, v39
  v_pk_mul_f32 v[40:41], v[40:41], v[10:11]
  v_cvt_pk_bf16_f32 v88, v40, v41
  v_pk_mul_f32 v[42:43], v[42:43], v[10:11]
  v_cvt_pk_bf16_f32 v89, v42, v43
  v_pk_mul_f32 v[44:45], v[44:45], v[10:11]
  v_cvt_pk_bf16_f32 v90, v44, v45
  v_pk_mul_f32 v[46:47], v[46:47], v[10:11]
  v_cvt_pk_bf16_f32 v91, v46, v47
  v_pk_mul_f32 v[48:49], v[48:49], v[10:11]
  v_cvt_pk_bf16_f32 v92, v48, v49
  v_pk_mul_f32 v[50:51], v[50:51], v[10:11]
  v_cvt_pk_bf16_f32 v93, v50, v51
  v_pk_mul_f32 v[52:53], v[52:53], v[10:11]
  v_cvt_pk_bf16_f32 v94, v52, v53
  v_pk_mul_f32 v[54:55], v[54:55], v[10:11]
  v_cvt_pk_bf16_f32 v95, v54, v55
  s_lshl_b32 s14, s10, 3
  s_add_u32 s14, s14, s9
  s_mul_i32 s14, s14, 5120
  s_add_u32 s14, s14, 39256064
  s_add_u32 s15, s14, 4096
  buffer_store_dwordx4 v[76:79], v2, s[4:7], s14 offen offset:0
  buffer_store_dwordx4 v[80:83], v2, s[4:7], s14 offen offset:1024
  buffer_store_dwordx4 v[84:87], v2, s[4:7], s14 offen offset:2048
  buffer_store_dwordx4 v[88:91], v2, s[4:7], s14 offen offset:3072
  buffer_store_dwordx4 v[92:95], v2, s[4:7], s15 offen offset:0
  s_waitcnt lgkmcnt(0)
  s_barrier
  v_lshrrev_b32 v7, 2, v1
  v_mul_u32_u24 v7, 96, v7
  v_and_b32 v13, 3, v1
  v_lshl_add_u32 v7, v13, 3, v7
  s_mul_i32 s14, s3, 1536
  s_add_u32 s14, s14, 61440
  v_add_u32 v7, s14, v7
  s_lshl_b32 s14, s3, 9
  s_add_u32 s14, s14, 86016
  v_add_u32 v13, s14, v12
  ds_read_b64_tr_b16 v[96:97], v7 offset:0
  ds_read_b64_tr_b16 v[98:99], v7 offset:6144
  ds_read_b64_tr_b16 v[100:101], v7 offset:32
  ds_read_b64_tr_b16 v[102:103], v7 offset:6176
  ds_read_b64_tr_b16 v[104:105], v7 offset:64
  ds_read_b64_tr_b16 v[106:107], v7 offset:6208
  ds_read_b64 v[120:121], v13 offset:0
  ds_read_b64 v[122:123], v13 offset:2560
  ds_read_b64 v[124:125], v13 offset:512
  ds_read_b64 v[126:127], v13 offset:3072
  ds_read_b64_tr_b16 v[108:109], v7 offset:12288
  ds_read_b64_tr_b16 v[110:111], v7 offset:18432
  ds_read_b64_tr_b16 v[112:113], v7 offset:12320
  ds_read_b64_tr_b16 v[114:115], v7 offset:18464
  ds_read_b64_tr_b16 v[116:117], v7 offset:12352
  ds_read_b64_tr_b16 v[118:119], v7 offset:18496
  ds_read_b64 v[128:129], v13 offset:5120
  ds_read_b64 v[130:131], v13 offset:7680
  ds_read_b64 v[132:133], v13 offset:5632
  ds_read_b64 v[134:135], v13 offset:8192
  s_mov_b32 s16, 0x80008000
  s_mov_b32 s17, 0x00010001
  s_cmp_lt_u32 s3, 3
  s_cselect_b32 s18, 0, s17
  s_cselect_b32 s19, 0, s17
  s_cselect_b32 s20, s16, 0
  s_cselect_b32 s21, s16, 0
  v_mov_b32 v14, 0x3f803f80
  s_waitcnt lgkmcnt(0)
  v_cndmask_b32 v120, v120, v14, s[18:19]
  v_cndmask_b32 v121, v121, v14, s[18:19]
  v_cndmask_b32 v122, v122, v14, s[18:19]
  v_cndmask_b32 v123, v123, v14, s[18:19]
  v_cndmask_b32 v124, v124, v14, s[20:21]
  v_cndmask_b32 v125, v125, v14, s[20:21]
  v_cndmask_b32 v126, v126, v14, s[20:21]
  v_cndmask_b32 v127, v127, v14, s[20:21]
  v_cndmask_b32 v128, v128, v14, s[18:19]
  v_cndmask_b32 v129, v129, v14, s[18:19]
  v_cndmask_b32 v130, v130, v14, s[18:19]
  v_cndmask_b32 v131, v131, v14, s[18:19]
  v_cndmask_b32 v132, v132, v14, s[20:21]
  v_cndmask_b32 v133, v133, v14, s[20:21]
  v_cndmask_b32 v134, v134, v14, s[20:21]
  v_cndmask_b32 v135, v135, v14, s[20:21]
  v_mfma_f32_16x16x32_bf16 v[136:139], v[96:99], v[120:123], 0
  v_mfma_f32_16x16x32_bf16 v[140:143], v[96:99], v[124:127], 0
  v_mfma_f32_16x16x32_bf16 v[144:147], v[100:103], v[120:123], 0
  v_mfma_f32_16x16x32_bf16 v[148:151], v[100:103], v[124:127], 0
  v_mfma_f32_16x16x32_bf16 v[152:155], v[104:107], v[120:123], 0
  v_mfma_f32_16x16x32_bf16 v[156:159], v[104:107], v[124:127], 0
  v_mfma_f32_16x16x32_bf16 v[136:139], v[108:111], v[128:131], v[136:139]
  v_mfma_f32_16x16x32_bf16 v[140:143], v[108:111], v[132:135], v[140:143]
  v_mfma_f32_16x16x32_bf16 v[144:147], v[112:115], v[128:131], v[144:147]
  v_mfma_f32_16x16x32_bf16 v[148:151], v[112:115], v[132:135], v[148:151]
  v_mfma_f32_16x16x32_bf16 v[152:155], v[116:119], v[128:131], v[152:155]
  v_mfma_f32_16x16x32_bf16 v[156:159], v[116:119], v[132:135], v[156:159]
  s_lshl_b32 s14, s8, 3
  s_add_u32 s14, s14, s9
  s_lshl_b32 s14, s14, 2
  s_add_u32 s14, s14, s3
  s_mul_i32 s14, s14, 6144
  s_add_u32 s14, s14, 44498944
  s_add_u32 s15, s14, 4096
  buffer_store_dwordx4 v[136:139], v2, s[4:7], s14 offen offset:0
  buffer_store_dwordx4 v[140:143], v2, s[4:7], s14 offen offset:1024
  buffer_store_dwordx4 v[144:147], v2, s[4:7], s14 offen offset:2048
  buffer_store_dwordx4 v[148:151], v2, s[4:7], s14 offen offset:3072
  buffer_store_dwordx4 v[152:155], v2, s[4:7], s15 offen offset:0
  buffer_store_dwordx4 v[156:159], v2, s[4:7], s15 offen offset:1024
b1_end:
  s_endpgm

.globl bred_kernel
.p2align 8
.type bred_kernel,@function
bred_kernel:
  s_load_dwordx2 s[4:5], s[0:1], 104
  s_mov_b32 s6, 0x10000000
  s_mov_b32 s7, 0x20000
  s_cmp_ge_u32 s2, 105
  s_cbranch_scc1 bred_end
  s_lshl_b32 s8, s2, 8
  v_add_u32 v1, s8, v0
  v_lshrrev_b32 v2, 2, v1
  v_and_b32 v3, 3, v1
  s_mov_b32 s9, 0x1381382
  v_mul_hi_u32 v4, v2, s9
  v_mul_u32_u24 v5, 210, v4
  v_sub_u32 v5, v2, v5
  v_mul_u32_u24 v6, 205, v5
  v_lshrrev_b32 v6, 11, v6
  v_mul_u32_u24 v7, 10, v6
  v_sub_u32 v7, v5, v7
  v_and_b32 v8, 3, v4
  v_lshl_add_u32 v9, v8, 2, v6
  v_cmp_gt_u32 vcc, 3, v8
  s_nop 1
  v_cndmask_b32 v10, 0, 31, vcc
  v_cmp_eq_u32 vcc, 20, v6
  s_nop 1
  v_cndmask_b32 v9, v9, v10, vcc
  v_lshrrev_b32 v10, 4, v9
  v_and_b32 v9, 15, v9
  v_lshrrev_b32 v11, 2, v7
  v_lshl_add_u32 v10, v11, 1, v10
  v_lshlrev_b32 v10, 10, v10
  v_lshl_add_u32 v10, v9, 4, v10
  v_and_b32 v11, 3, v7
  v_lshl_add_u32 v10, v11, 8, v10
  v_mul_u32_u24 v11, 6144, v4
  v_add_u32 v10, v10, v11
  v_mul_u32_u24 v11, 1572864, v3
  v_add_u32 v10, v10, v11
  s_mov_b32 s10, 44498944
  s_waitcnt lgkmcnt(0)
  buffer_load_dwordx4 v[16:19], v10, s[4:7], s10 offen
  s_add_u32 s10, s10, 196608
  buffer_load_dwordx4 v[20:23], v10, s[4:7], s10 offen
  s_add_u32 s10, s10, 196608
  buffer_load_dwordx4 v[24:27], v10, s[4:7], s10 offen
  s_add_u32 s10, s10, 196608
  buffer_load_dwordx4 v[28:31], v10, s[4:7], s10 offen
  s_add_u32 s10, s10, 196608
  buffer_load_dwordx4 v[32:35], v10, s[4:7], s10 offen
  s_add_u32 s10, s10, 196608
  buffer_load_dwordx4 v[36:39], v10, s[4:7], s10 offen
  s_add_u32 s10, s10, 196608
  buffer_load_dwordx4 v[40:43], v10, s[4:7], s10 offen
  s_add_u32 s10, s10, 196608
  buffer_load_dwordx4 v[44:47], v10, s[4:7], s10 offen
  v_lshrrev_b32 v11, 2, v4
  v_mul_u32_u24 v11, 6, v11
  v_lshrrev_b32 v12, 2, v6
  v_add_u32 v11, v11, v12
  v_mul_u32_u24 v11, 5, v11
  v_lshrrev_b32 v12, 1, v7
  v_add_u32 v11, v11, v12
  v_lshlrev_b32 v11, 8, v11
  v_lshl_add_u32 v11, v8, 6, v11
  v_and_b32 v12, 3, v6
  v_lshl_add_u32 v11, v12, 4, v11
  v_and_b32 v12, 1, v7
  v_lshl_add_u32 v11, v12, 3, v11
  s_mov_b32 s10, 96768000
  s_mov_b32 s12, 0x11111111
  s_mov_b32 s13, 0x11111111
  s_waitcnt vmcnt(0)
  v_pk_add_f32 v[16:17], v[16:17], v[32:33]
  v_pk_add_f32 v[18:19], v[18:19], v[34:35]
  v_pk_add_f32 v[20:21], v[20:21], v[36:37]
  v_pk_add_f32 v[22:23], v[22:23], v[38:39]
  v_pk_add_f32 v[24:25], v[24:25], v[40:41]
  v_pk_add_f32 v[26:27], v[26:27], v[42:43]
  v_pk_add_f32 v[28:29], v[28:29], v[44:45]
  v_pk_add_f32 v[30:31], v[30:31], v[46:47]
  v_pk_add_f32 v[16:17], v[16:17], v[24:25]
  v_pk_add_f32 v[18:19], v[18:19], v[26:27]
  v_pk_add_f32 v[20:21], v[20:21], v[28:29]
  v_pk_add_f32 v[22:23], v[22:23], v[30:31]
  v_pk_add_f32 v[16:17], v[16:17], v[20:21]
  v_pk_add_f32 v[18:19], v[18:19], v[22:23]
  s_nop 0
  v_add_f32_dpp v16, v16, v16 quad_perm:[1,0,3,2] row_mask:0xf bank_mask:0xf
  v_add_f32_dpp v17, v17, v17 quad_perm:[1,0,3,2] row_mask:0xf bank_mask:0xf
  v_add_f32_dpp v18, v18, v18 quad_perm:[1,0,3,2] row_mask:0xf bank_mask:0xf
  v_add_f32_dpp v19, v19, v19 quad_perm:[1,0,3,2] row_mask:0xf bank_mask:0xf
  v_add_f32_dpp v16, v16, v16 quad_perm:[2,3,0,1] row_mask:0xf bank_mask:0xf
  v_add_f32_dpp v17, v17, v17 quad_perm:[2,3,0,1] row_mask:0xf bank_mask:0xf
  v_add_f32_dpp v18, v18, v18 quad_perm:[2,3,0,1] row_mask:0xf bank_mask:0xf
  v_add_f32_dpp v19, v19, v19 quad_perm:[2,3,0,1] row_mask:0xf bank_mask:0xf
  v_cvt_pk_bf16_f32 v16, v16, v17
  v_cvt_pk_bf16_f32 v17, v18, v19
  s_mov_b64 exec, s[12:13]
  buffer_store_dwordx2 v[16:17], v11, s[4:7], s10 offen
bred_end:
  s_endpgm

.globl b2_kernel
.p2align 8
.type b2_kernel,@function
b2_kernel:
  s_load_dwordx2 s[4:5], s[0:1], 104
  s_mov_b32 s6, 0x10000000
  s_mov_b32 s7, 0x20000
  s_load_dwordx2 s[24:25], s[0:1], 96
  s_mov_b32 s26, 0x100
  s_mov_b32 s27, 0x20000
  v_lshrrev_b32 v1, 6, v0
  s_nop 0
  v_readfirstlane_b32 s3, v1
  v_and_b32 v1, 63, v0
  s_cmp_ge_u32 s2, 256
  s_cbranch_scc1 b2_kernel_end
  s_and_b32 s8, s2, 7
  s_lshl_b32 s8, s8, 3
  s_lshr_b32 s9, s2, 5
  s_add_u32 s8, s8, s9
  s_bfe_u32 s9, s2, 0x20003
  v_lshlrev_b32 v2, 4, v1
  v_and_b32 v4, 15, v1
  v_lshrrev_b32 v5, 4, v1
  v_mul_u32_u24 v6, 1280, v4
  v_lshl_add_u32 v6, v5, 4, v6
  s_mul_i32 s10, s9, 5
  s_add_u32 s10, s10, s3
  s_mul_i32 s11, s8, 40960
  s_lshl_b32 s12, s10, 6
  s_add_u32 s11, s11, s12
  s_mul_i32 s12, s8, 40
  s_add_u32 s12, s12, s10
  s_lshl_b32 s12, s12, 10
  s_add_u32 s22, s12, 26214400
  s_add_u32 s12, s12, 50790400
  s_mul_i32 s14, s10, 40960
  s_add_u32 s14, s14, 95948800
  v_add_u32 v3, 20480, v2
  v_lshrrev_b32 v7, 2, v4
  v_cmp_eq_u32 vcc, v7, v5
  v_lshlrev_b32 v7, 4, v4
  s_mov_b64 s[20:21], vcc
  s_mul_i32 s15, s3, 15360
  s_add_u32 s15, s15, 40960
  v_add_u32 v7, s15, v7
  s_waitcnt lgkmcnt(0)
  s_cmp_eq_u32 s3, 4
  s_cbranch_scc1 b2_kernel_ph2
  s_mul_i32 s16, s3, 15360
  s_add_u32 s16, s16, 96768000
  s_mov_b32 m0, s15
  s_nop 0
  buffer_load_dwordx4 v2, s[4:7], s16 offen offset:0 lds
  buffer_load_dwordx4 v2, s[4:7], s16 offen offset:1024 lds
  buffer_load_dwordx4 v2, s[4:7], s16 offen offset:2048 lds
  buffer_load_dwordx4 v2, s[4:7], s16 offen offset:3072 lds
  s_add_u32 s15, s15, 4096
  s_add_u32 s16, s16, 4096
  s_mov_b32 m0, s15
  s_nop 0
  buffer_load_dwordx4 v2, s[4:7], s16 offen offset:0 lds
  buffer_load_dwordx4 v2, s[4:7], s16 offen offset:1024 lds
  buffer_load_dwordx4 v2, s[4:7], s16 offen offset:2048 lds
  buffer_load_dwordx4 v2, s[4:7], s16 offen offset:3072 lds
  s_add_u32 s15, s15, 4096
  s_add_u32 s16, s16, 4096
  s_mov_b32 m0, s15
  s_nop 0
  buffer_load_dwordx4 v2, s[4:7], s16 offen offset:0 lds
  buffer_load_dwordx4 v2, s[4:7], s16 offen offset:1024 lds
  buffer_load_dwordx4 v2, s[4:7], s16 offen offset:2048 lds
  buffer_load_dwordx4 v2, s[4:7], s16 offen offset:3072 lds
  s_add_u32 s15, s15, 4096
  s_add_u32 s16, s16, 4096
  s_mov_b32 m0, s15
  s_nop 0
  buffer_load_dwordx4 v2, s[4:7], s16 offen offset:0 lds
  buffer_load_dwordx4 v2, s[4:7], s16 offen offset:1024 lds
  buffer_load_dwordx4 v2, s[4:7], s16 offen offset:2048 lds
  s_lshl_b32 s15, s8, 4
  s_lshl_b32 s16, s3, 1
  s_add_u32 s15, s15, s16
  s_mul_i32 s15, s15, 5120
  s_add_u32 s15, s15, 39256064
  s_add_u32 s17, s15, 0
  s_add_u32 s18, s17, 4096
  buffer_load_dwordx4 v[56:59], v2, s[4:7], s17 offen offset:0
  buffer_load_dwordx4 v[60:63], v2, s[4:7], s17 offen offset:1024
  buffer_load_dwordx4 v[64:67], v2, s[4:7], s17 offen offset:2048
  buffer_load_dwordx4 v[68:71], v2, s[4:7], s17 offen offset:3072
  buffer_load_dwordx4 v[72:75], v2, s[4:7], s18 offen offset:0
  s_add_u32 s17, s15, 40960
  s_add_u32 s18, s17, 4096
  buffer_load_dwordx4 v[96:99], v2, s[4:7], s17 offen offset:0
  buffer_load_dwordx4 v[100:103], v2, s[4:7], s17 offen offset:1024
  buffer_load_dwordx4 v[104:107], v2, s[4:7], s17 offen offset:2048
  buffer_load_dwordx4 v[108:111], v2, s[4:7], s17 offen offset:3072
  buffer_load_dwordx4 v[112:115], v2, s[4:7], s18 offen offset:0
  s_add_u32 s17, s15, 5120
  s_add_u32 s18, s17, 4096
  buffer_load_dwordx4 v[76:79], v2, s[4:7], s17 offen offset:0
  buffer_load_dwordx4 v[80:83], v2, s[4:7], s17 offen offset:1024
  buffer_load_dwordx4 v[84:87], v2, s[4:7], s17 offen offset:2048
  buffer_load_dwordx4 v[88:91], v2, s[4:7], s17 offen offset:3072
  buffer_load_dwordx4 v[92:95], v2, s[4:7], s18 offen offset:0
  s_add_u32 s17, s15, 46080
  s_add_u32 s18, s17, 4096
  buffer_load_dwordx4 v[116:119], v2, s[4:7], s17 offen offset:0
  buffer_load_dwordx4 v[120:123], v2, s[4:7], s17 offen offset:1024
  buffer_load_dwordx4 v[124:127], v2, s[4:7], s17 offen offset:2048
  buffer_load_dwordx4 v[128:131], v2, s[4:7], s17 offen offset:3072
  buffer_load_dwordx4 v[132:135], v2, s[4:7], s18 offen offset:0
  buffer_load_dwordx4 v[24:27], v2, s[4:7], s14 offen
  buffer_load_dwordx4 v[28:31], v3, s[4:7], s14 offen
  s_add_u32 s14, s14, 1024
  buffer_load_dwordx4 v[32:35], v2, s[4:7], s14 offen
  buffer_load_dwordx4 v[36:39], v3, s[4:7], s14 offen
  s_add_u32 s14, s14, 1024
  buffer_load_dwordx4 v[40:43], v2, s[4:7], s14 offen
  buffer_load_dwordx4 v[44:47], v3, s[4:7], s14 offen
  s_add_u32 s14, s14, 1024
  buffer_load_dwordx4 v[48:51], v2, s[4:7], s14 offen
  buffer_load_dwordx4 v[52:55], v3, s[4:7], s14 offen
  s_add_u32 s14, s14, 1024
  v_mov_b32 v136, 0
  v_mov_b32 v137, 0
  v_mov_b32 v138, 0
  v_mov_b32 v139, 0
  v_mov_b32 v140, 0
  v_mov_b32 v141, 0
  v_mov_b32 v142, 0
  v_mov_b32 v143, 0
  v_mov_b32 v144, 0
  v_mov_b32 v145, 0
  v_mov_b32 v146, 0
  v_mov_b32 v147, 0
  v_mov_b32 v148, 0
  v_mov_b32 v149, 0
  v_mov_b32 v150, 0
  v_mov_b32 v151, 0
  v_mov_b32 v152, 0
  v_mov_b32 v153, 0
  v_mov_b32 v154, 0
  v_mov_b32 v155, 0
  v_mov_b32 v156, 0
  v_mov_b32 v157, 0
  v_mov_b32 v158, 0
  v_mov_b32 v159, 0
  v_mov_b32 v160, 0
  v_mov_b32 v161, 0
  v_mov_b32 v162, 0
  v_mov_b32 v163, 0
  v_mov_b32 v164, 0
  v_mov_b32 v165, 0
  v_mov_b32 v166, 0
  v_mov_b32 v167, 0
  v_mov_b32 v168, 0
  v_mov_b32 v169, 0
  v_mov_b32 v170, 0
  v_mov_b32 v171, 0
  v_mov_b32 v172, 0
  v_mov_b32 v173, 0
  v_mov_b32 v174, 0
  v_mov_b32 v175, 0
  v_mov_b32 v176, 0
  v_mov_b32 v177, 0
  v_mov_b32 v178, 0
  v_mov_b32 v179, 0
  v_mov_b32 v180, 0
  v_mov_b32 v181, 0
  v_mov_b32 v182, 0
  v_mov_b32 v183, 0
  v_mov_b32 v184, 0
  v_mov_b32 v185, 0
  v_mov_b32 v186, 0
  v_mov_b32 v187, 0
  v_mov_b32 v188, 0
  v_mov_b32 v189, 0
  v_mov_b32 v190, 0
  v_mov_b32 v191, 0
  v_mov_b32 v192, 0
  v_mov_b32 v193, 0
  v_mov_b32 v194, 0
  v_mov_b32 v195, 0
  s_waitcnt vmcnt(28)
  s_mov_b64 exec, s[20:21]
  ds_read_b128 v[136:139], v7 offset:0
  ds_read_b128 v[140:143], v7 offset:256
  ds_read_b128 v[144:147], v7 offset:512
  ds_read_b128 v[148:151], v7 offset:768
  ds_read_b128 v[152:155], v7 offset:1024
  s_mov_b64 exec, -1
  s_mov_b64 exec, s[20:21]
  ds_read_b128 v[156:159], v7 offset:1280
  ds_read_b128 v[160:163], v7 offset:1536
  ds_read_b128 v[164:167], v7 offset:1792
  ds_read_b128 v[168:171], v7 offset:2048
  ds_read_b128 v[172:175], v7 offset:2304
  s_mov_b64 exec, -1
  s_mov_b64 exec, s[20:21]
  ds_read_b128 v[176:179], v7 offset:2560
  ds_read_b128 v[180:183], v7 offset:2816
  ds_read_b128 v[184:187], v7 offset:3072
  ds_read_b128 v[188:191], v7 offset:3328
  ds_read_b128 v[192:195], v7 offset:3584
  s_mov_b64 exec, -1
  s_mul_i32 s17, s3, 5120
  v_add_u32 v9, s17, v2
  v_mov_b32 v10, 0x358637bd
  s_waitcnt vmcnt(18)
  s_waitcnt lgkmcnt(10)
  v_mfma_f32_16x16x32_bf16 v[196:199], v[136:139], v[56:59], 0
  v_mfma_f32_16x16x32_bf16 v[200:203], v[136:139], v[96:99], 0
  v_mfma_f32_16x16x32_bf16 v[196:199], v[140:143], v[60:63], v[196:199]
  v_mfma_f32_16x16x32_bf16 v[200:203], v[140:143], v[100:103], v[200:203]
  v_mfma_f32_16x16x32_bf16 v[196:199], v[144:147], v[64:67], v[196:199]
  v_mfma_f32_16x16x32_bf16 v[200:203], v[144:147], v[104:107], v[200:203]
  v_mfma_f32_16x16x32_bf16 v[196:199], v[148:151], v[68:71], v[196:199]
  v_mfma_f32_16x16x32_bf16 v[200:203], v[148:151], v[108:111], v[200:203]
  v_mfma_f32_16x16x32_bf16 v[196:199], v[152:155], v[72:75], v[196:199]
  v_mfma_f32_16x16x32_bf16 v[200:203], v[152:155], v[112:115], v[200:203]
  s_mov_b64 exec, s[20:21]
  ds_read_b128 v[136:139], v7 offset:3840
  ds_read_b128 v[140:143], v7 offset:4096
  ds_read_b128 v[144:147], v7 offset:4352
  ds_read_b128 v[148:151], v7 offset:4608
  ds_read_b128 v[152:155], v7 offset:4864
  s_mov_b64 exec, -1
  s_waitcnt lgkmcnt(10)
  v_mfma_f32_16x16x32_bf16 v[204:207], v[156:159], v[56:59], 0
  v_mfma_f32_16x16x32_bf16 v[208:211], v[156:159], v[96:99], 0
  v_mfma_f32_16x16x32_bf16 v[204:207], v[160:163], v[60:63], v[204:207]
  v_mfma_f32_16x16x32_bf16 v[208:211], v[160:163], v[100:103], v[208:211]
  v_mfma_f32_16x16x32_bf16 v[204:207], v[164:167], v[64:67], v[204:207]
  v_mfma_f32_16x16x32_bf16 v[208:211], v[164:167], v[104:107], v[208:211]
  v_mfma_f32_16x16x32_bf16 v[204:207], v[168:171], v[68:71], v[204:207]
  v_mfma_f32_16x16x32_bf16 v[208:211], v[168:171], v[108:111], v[208:211]
  v_mfma_f32_16x16x32_bf16 v[204:207], v[172:175], v[72:75], v[204:207]
  v_mfma_f32_16x16x32_bf16 v[208:211], v[172:175], v[112:115], v[208:211]
  s_mov_b64 exec, s[20:21]
  ds_read_b128 v[156:159], v7 offset:5120
  ds_read_b128 v[160:163], v7 offset:5376
  ds_read_b128 v[164:167], v7 offset:5632
  ds_read_b128 v[168:171], v7 offset:5888
  ds_read_b128 v[172:175], v7 offset:6144
  s_mov_b64 exec, -1
  s_waitcnt lgkmcnt(10)
  v_mfma_f32_16x16x32_bf16 v[212:215], v[176:179], v[56:59], 0
  v_mfma_f32_16x16x32_bf16 v[216:219], v[176:179], v[96:99], 0
  v_mfma_f32_16x16x32_bf16 v[212:215], v[180:183], v[60:63], v[212:215]
  v_mfma_f32_16x16x32_bf16 v[216:219], v[180:183], v[100:103], v[216:219]
  v_mfma_f32_16x16x32_bf16 v[212:215], v[184:187], v[64:67], v[212:215]
  v_mfma_f32_16x16x32_bf16 v[216:219], v[184:187], v[104:107], v[216:219]
  v_mfma_f32_16x16x32_bf16 v[212:215], v[188:191], v[68:71], v[212:215]
  v_mfma_f32_16x16x32_bf16 v[216:219], v[188:191], v[108:111], v[216:219]
  v_mfma_f32_16x16x32_bf16 v[212:215], v[192:195], v[72:75], v[212:215]
  v_mfma_f32_16x16x32_bf16 v[216:219], v[192:195], v[112:115], v[216:219]
  s_mov_b64 exec, s[20:21]
  ds_read_b128 v[176:179], v7 offset:6400
  ds_read_b128 v[180:183], v7 offset:6656
  ds_read_b128 v[184:187], v7 offset:6912
  ds_read_b128 v[188:191], v7 offset:7168
  ds_read_b128 v[192:195], v7 offset:7424
  s_mov_b64 exec, -1
  s_waitcnt lgkmcnt(10)
  v_mfma_f32_16x16x32_bf16 v[220:223], v[136:139], v[56:59], 0
  v_mfma_f32_16x16x32_bf16 v[224:227], v[136:139], v[96:99], 0
  v_mfma_f32_16x16x32_bf16 v[220:223], v[140:143], v[60:63], v[220:223]
  v_mfma_f32_16x16x32_bf16 v[224:227], v[140:143], v[100:103], v[224:227]
  v_mfma_f32_16x16x32_bf16 v[220:223], v[144:147], v[64:67], v[220:223]
  v_mfma_f32_16x16x32_bf16 v[224:227], v[144:147], v[104:107], v[224:227]
  v_mfma_f32_16x16x32_bf16 v[220:223], v[148:151], v[68:71], v[220:223]
  v_mfma_f32_16x16x32_bf16 v[224:227], v[148:151], v[108:111], v[224:227]
  v_mfma_f32_16x16x32_bf16 v[220:223], v[152:155], v[72:75], v[220:223]
  v_mfma_f32_16x16x32_bf16 v[224:227], v[152:155], v[112:115], v[224:227]
  s_mov_b64 exec, s[20:21]
  ds_read_b128 v[136:139], v7 offset:7680
  ds_read_b128 v[140:143], v7 offset:7936
  ds_read_b128 v[144:147], v7 offset:8192
  ds_read_b128 v[148:151], v7 offset:8448
  ds_read_b128 v[152:155], v7 offset:8704
  s_mov_b64 exec, -1
  s_waitcnt lgkmcnt(10)
  v_mfma_f32_16x16x32_bf16 v[228:231], v[156:159], v[56:59], 0
  v_mfma_f32_16x16x32_bf16 v[232:235], v[156:159], v[96:99], 0
  v_mfma_f32_16x16x32_bf16 v[228:231], v[160:163], v[60:63], v[228:231]
  v_mfma_f32_16x16x32_bf16 v[232:235], v[160:163], v[100:103], v[232:235]
  v_mfma_f32_16x16x32_bf16 v[228:231], v[164:167], v[64:67], v[228:231]
  v_mfma_f32_16x16x32_bf16 v[232:235], v[164:167], v[104:107], v[232:235]
  v_mfma_f32_16x16x32_bf16 v[228:231], v[168:171], v[68:71], v[228:231]
  v_mfma_f32_16x16x32_bf16 v[232:235], v[168:171], v[108:111], v[232:235]
  v_mfma_f32_16x16x32_bf16 v[228:231], v[172:175], v[72:75], v[228:231]
  v_mfma_f32_16x16x32_bf16 v[232:235], v[172:175], v[112:115], v[232:235]
  s_mov_b64 exec, s[20:21]
  ds_read_b128 v[156:159], v7 offset:8960
  ds_read_b128 v[160:163], v7 offset:9216
  ds_read_b128 v[164:167], v7 offset:9472
  ds_read_b128 v[168:171], v7 offset:9728
  ds_read_b128 v[172:175], v7 offset:9984
  s_mov_b64 exec, -1
  s_waitcnt lgkmcnt(10)
  v_mfma_f32_16x16x32_bf16 v[236:239], v[176:179], v[56:59], 0
  v_mfma_f32_16x16x32_bf16 v[240:243], v[176:179], v[96:99], 0
  v_mfma_f32_16x16x32_bf16 v[236:239], v[180:183], v[60:63], v[236:239]
  v_mfma_f32_16x16x32_bf16 v[240:243], v[180:183], v[100:103], v[240:243]
  v_mfma_f32_16x16x32_bf16 v[236:239], v[184:187], v[64:67], v[236:239]
  v_mfma_f32_16x16x32_bf16 v[240:243], v[184:187], v[104:107], v[240:243]
  v_mfma_f32_16x16x32_bf16 v[236:239], v[188:191], v[68:71], v[236:239]
  v_mfma_f32_16x16x32_bf16 v[240:243], v[188:191], v[108:111], v[240:243]
  v_mfma_f32_16x16x32_bf16 v[236:239], v[192:195], v[72:75], v[236:239]
  v_mfma_f32_16x16x32_bf16 v[240:243], v[192:195], v[112:115], v[240:243]
  s_mov_b64 exec, s[20:21]
  ds_read_b128 v[176:179], v7 offset:10240
  ds_read_b128 v[180:183], v7 offset:10496
  ds_read_b128 v[184:187], v7 offset:10752
  ds_read_b128 v[188:191], v7 offset:11008
  ds_read_b128 v[192:195], v7 offset:11264
  s_mov_b64 exec, -1
  v_add_f32 v236, v236, v10
  v_rcp_f32 v236, v236
  s_nop 0
  v_mov_b32 v237, v236
  v_pk_mul_f32 v[196:197], v[196:197], v[236:237]
  v_cvt_pk_bf16_f32 v244, v196, v197
  v_pk_mul_f32 v[198:199], v[198:199], v[236:237]
  v_cvt_pk_bf16_f32 v245, v198, v199
  v_pk_mul_f32 v[204:205], v[204:205], v[236:237]
  v_cvt_pk_bf16_f32 v246, v204, v205
  v_pk_mul_f32 v[206:207], v[206:207], v[236:237]
  v_cvt_pk_bf16_f32 v247, v206, v207
  v_pk_mul_f32 v[212:213], v[212:213], v[236:237]
  v_cvt_pk_bf16_f32 v248, v212, v213
  v_pk_mul_f32 v[214:215], v[214:215], v[236:237]
  v_cvt_pk_bf16_f32 v249, v214, v215
  v_pk_mul_f32 v[220:221], v[220:221], v[236:237]
  v_cvt_pk_bf16_f32 v250, v220, v221
  v_pk_mul_f32 v[222:223], v[222:223], v[236:237]
  v_cvt_pk_bf16_f32 v251, v222, v223
  v_pk_mul_f32 v[228:229], v[228:229], v[236:237]
  v_cvt_pk_bf16_f32 v252, v228, v229
  v_pk_mul_f32 v[230:231], v[230:231], v[236:237]
  v_cvt_pk_bf16_f32 v253, v230, v231
  ds_write_b128 v9, v[244:247] offset:0
  ds_write_b128 v9, v[248:251] offset:1024
  ds_write_b64 v9, v[252:253] offset:2048
  s_waitcnt lgkmcnt(0)
  v_add_f32 v240, v240, v10
  v_rcp_f32 v240, v240
  s_nop 0
  v_mov_b32 v241, v240
  v_pk_mul_f32 v[200:201], v[200:201], v[240:241]
  v_cvt_pk_bf16_f32 v244, v200, v201
  v_pk_mul_f32 v[202:203], v[202:203], v[240:241]
  v_cvt_pk_bf16_f32 v245, v202, v203
  v_pk_mul_f32 v[208:209], v[208:209], v[240:241]
  v_cvt_pk_bf16_f32 v246, v208, v209
  v_pk_mul_f32 v[210:211], v[210:211], v[240:241]
  v_cvt_pk_bf16_f32 v247, v210, v211
  v_pk_mul_f32 v[216:217], v[216:217], v[240:241]
  v_cvt_pk_bf16_f32 v248, v216, v217
  v_pk_mul_f32 v[218:219], v[218:219], v[240:241]
  v_cvt_pk_bf16_f32 v249, v218, v219
  v_pk_mul_f32 v[224:225], v[224:225], v[240:241]
  v_cvt_pk_bf16_f32 v250, v224, v225
  v_pk_mul_f32 v[226:227], v[226:227], v[240:241]
  v_cvt_pk_bf16_f32 v251, v226, v227
  v_pk_mul_f32 v[232:233], v[232:233], v[240:241]
  v_cvt_pk_bf16_f32 v252, v232, v233
  v_pk_mul_f32 v[234:235], v[234:235], v[240:241]
  v_cvt_pk_bf16_f32 v253, v234, v235
  ds_write_b128 v9, v[244:247] offset:20480
  ds_write_b128 v9, v[248:251] offset:21504
  ds_write_b64 v9, v[252:253] offset:22528
  s_waitcnt lgkmcnt(0)
  s_waitcnt vmcnt(8)
  s_waitcnt lgkmcnt(5)
  v_mfma_f32_16x16x32_bf16 v[196:199], v[136:139], v[76:79], 0
  v_mfma_f32_16x16x32_bf16 v[200:203], v[136:139], v[116:119], 0
  v_mfma_f32_16x16x32_bf16 v[196:199], v[140:143], v[80:83], v[196:199]
  v_mfma_f32_16x16x32_bf16 v[200:203], v[140:143], v[120:123], v[200:203]
  v_mfma_f32_16x16x32_bf16 v[196:199], v[144:147], v[84:87], v[196:199]
  v_mfma_f32_16x16x32_bf16 v[200:203], v[144:147], v[124:127], v[200:203]
  v_mfma_f32_16x16x32_bf16 v[196:199], v[148:151], v[88:91], v[196:199]
  v_mfma_f32_16x16x32_bf16 v[200:203], v[148:151], v[128:131], v[200:203]
  v_mfma_f32_16x16x32_bf16 v[196:199], v[152:155], v[92:95], v[196:199]
  v_mfma_f32_16x16x32_bf16 v[200:203], v[152:155], v[132:135], v[200:203]
  s_mov_b64 exec, s[20:21]
  ds_read_b128 v[136:139], v7 offset:11520
  ds_read_b128 v[140:143], v7 offset:11776
  ds_read_b128 v[144:147], v7 offset:12032
  ds_read_b128 v[148:151], v7 offset:12288
  ds_read_b128 v[152:155], v7 offset:12544
  s_mov_b64 exec, -1
  s_waitcnt lgkmcnt(10)
  v_mfma_f32_16x16x32_bf16 v[204:207], v[156:159], v[76:79], 0
  v_mfma_f32_16x16x32_bf16 v[208:211], v[156:159], v[116:119], 0
  v_mfma_f32_16x16x32_bf16 v[204:207], v[160:163], v[80:83], v[204:207]
  v_mfma_f32_16x16x32_bf16 v[208:211], v[160:163], v[120:123], v[208:211]
  v_mfma_f32_16x16x32_bf16 v[204:207], v[164:167], v[84:87], v[204:207]
  v_mfma_f32_16x16x32_bf16 v[208:211], v[164:167], v[124:127], v[208:211]
  v_mfma_f32_16x16x32_bf16 v[204:207], v[168:171], v[88:91], v[204:207]
  v_mfma_f32_16x16x32_bf16 v[208:211], v[168:171], v[128:131], v[208:211]
  v_mfma_f32_16x16x32_bf16 v[204:207], v[172:175], v[92:95], v[204:207]
  v_mfma_f32_16x16x32_bf16 v[208:211], v[172:175], v[132:135], v[208:211]
  s_mov_b64 exec, s[20:21]
  ds_read_b128 v[156:159], v7 offset:12800
  ds_read_b128 v[160:163], v7 offset:13056
  ds_read_b128 v[164:167], v7 offset:13312
  ds_read_b128 v[168:171], v7 offset:13568
  ds_read_b128 v[172:175], v7 offset:13824
  s_mov_b64 exec, -1
  s_waitcnt lgkmcnt(10)
  v_mfma_f32_16x16x32_bf16 v[212:215], v[176:179], v[76:79], 0
  v_mfma_f32_16x16x32_bf16 v[216:219], v[176:179], v[116:119], 0
  v_mfma_f32_16x16x32_bf16 v[212:215], v[180:183], v[80:83], v[212:215]
  v_mfma_f32_16x16x32_bf16 v[216:219], v[180:183], v[120:123], v[216:219]
  v_mfma_f32_16x16x32_bf16 v[212:215], v[184:187], v[84:87], v[212:215]
  v_mfma_f32_16x16x32_bf16 v[216:219], v[184:187], v[124:127], v[216:219]
  v_mfma_f32_16x16x32_bf16 v[212:215], v[188:191], v[88:91], v[212:215]
  v_mfma_f32_16x16x32_bf16 v[216:219], v[188:191], v[128:131], v[216:219]
  v_mfma_f32_16x16x32_bf16 v[212:215], v[192:195], v[92:95], v[212:215]
  v_mfma_f32_16x16x32_bf16 v[216:219], v[192:195], v[132:135], v[216:219]
  s_mov_b64 exec, s[20:21]
  ds_read_b128 v[176:179], v7 offset:14080
  ds_read_b128 v[180:183], v7 offset:14336
  ds_read_b128 v[184:187], v7 offset:14592
  ds_read_b128 v[188:191], v7 offset:14848
  ds_read_b128 v[192:195], v7 offset:15104
  s_mov_b64 exec, -1
  s_waitcnt lgkmcnt(10)
  v_mfma_f32_16x16x32_bf16 v[220:223], v[136:139], v[76:79], 0
  v_mfma_f32_16x16x32_bf16 v[224:227], v[136:139], v[116:119], 0
  v_mfma_f32_16x16x32_bf16 v[220:223], v[140:143], v[80:83], v[220:223]
  v_mfma_f32_16x16x32_bf16 v[224:227], v[140:143], v[120:123], v[224:227]
  v_mfma_f32_16x16x32_bf16 v[220:223], v[144:147], v[84:87], v[220:223]
  v_mfma_f32_16x16x32_bf16 v[224:227], v[144:147], v[124:127], v[224:227]
  v_mfma_f32_16x16x32_bf16 v[220:223], v[148:151], v[88:91], v[220:223]
  v_mfma_f32_16x16x32_bf16 v[224:227], v[148:151], v[128:131], v[224:227]
  v_mfma_f32_16x16x32_bf16 v[220:223], v[152:155], v[92:95], v[220:223]
  v_mfma_f32_16x16x32_bf16 v[224:227], v[152:155], v[132:135], v[224:227]
  s_waitcnt lgkmcnt(5)
  v_mfma_f32_16x16x32_bf16 v[228:231], v[156:159], v[76:79], 0
  v_mfma_f32_16x16x32_bf16 v[232:235], v[156:159], v[116:119], 0
  v_mfma_f32_16x16x32_bf16 v[228:231], v[160:163], v[80:83], v[228:231]
  v_mfma_f32_16x16x32_bf16 v[232:235], v[160:163], v[120:123], v[232:235]
  v_mfma_f32_16x16x32_bf16 v[228:231], v[164:167], v[84:87], v[228:231]
  v_mfma_f32_16x16x32_bf16 v[232:235], v[164:167], v[124:127], v[232:235]
  v_mfma_f32_16x16x32_bf16 v[228:231], v[168:171], v[88:91], v[228:231]
  v_mfma_f32_16x16x32_bf16 v[232:235], v[168:171], v[128:131], v[232:235]
  v_mfma_f32_16x16x32_bf16 v[228:231], v[172:175], v[92:95], v[228:231]
  v_mfma_f32_16x16x32_bf16 v[232:235], v[172:175], v[132:135], v[232:235]
  s_waitcnt lgkmcnt(0)
  v_mfma_f32_16x16x32_bf16 v[236:239], v[176:179], v[76:79], 0
  v_mfma_f32_16x16x32_bf16 v[240:243], v[176:179], v[116:119], 0
  v_mfma_f32_16x16x32_bf16 v[236:239], v[180:183], v[80:83], v[236:239]
  v_mfma_f32_16x16x32_bf16 v[240:243], v[180:183], v[120:123], v[240:243]
  v_mfma_f32_16x16x32_bf16 v[236:239], v[184:187], v[84:87], v[236:239]
  v_mfma_f32_16x16x32_bf16 v[240:243], v[184:187], v[124:127], v[240:243]
  v_mfma_f32_16x16x32_bf16 v[236:239], v[188:191], v[88:91], v[236:239]
  v_mfma_f32_16x16x32_bf16 v[240:243], v[188:191], v[128:131], v[240:243]
  v_mfma_f32_16x16x32_bf16 v[236:239], v[192:195], v[92:95], v[236:239]
  v_mfma_f32_16x16x32_bf16 v[240:243], v[192:195], v[132:135], v[240:243]
  s_nop 4
  v_add_f32 v236, v236, v10
  v_rcp_f32 v236, v236
  s_nop 0
  v_mov_b32 v237, v236
  v_pk_mul_f32 v[196:197], v[196:197], v[236:237]
  v_cvt_pk_bf16_f32 v246, v196, v197
  v_pk_mul_f32 v[198:199], v[198:199], v[236:237]
  v_cvt_pk_bf16_f32 v247, v198, v199
  v_pk_mul_f32 v[204:205], v[204:205], v[236:237]
  v_cvt_pk_bf16_f32 v248, v204, v205
  v_pk_mul_f32 v[206:207], v[206:207], v[236:237]
  v_cvt_pk_bf16_f32 v249, v206, v207
  v_pk_mul_f32 v[212:213], v[212:213], v[236:237]
  v_cvt_pk_bf16_f32 v250, v212, v213
  v_pk_mul_f32 v[214:215], v[214:215], v[236:237]
  v_cvt_pk_bf16_f32 v251, v214, v215
  v_pk_mul_f32 v[220:221], v[220:221], v[236:237]
  v_cvt_pk_bf16_f32 v252, v220, v221
  v_pk_mul_f32 v[222:223], v[222:223], v[236:237]
  v_cvt_pk_bf16_f32 v253, v222, v223
  v_pk_mul_f32 v[228:229], v[228:229], v[236:237]
  v_cvt_pk_bf16_f32 v254, v228, v229
  v_pk_mul_f32 v[230:231], v[230:231], v[236:237]
  v_cvt_pk_bf16_f32 v255, v230, v231
  ds_write_b64 v9, v[246:247] offset:2056
  ds_write_b128 v9, v[248:251] offset:3072
  ds_write_b128 v9, v[252:255] offset:4096
  s_waitcnt lgkmcnt(0)
  v_add_f32 v240, v240, v10
  v_rcp_f32 v240, v240
  s_nop 0
  v_mov_b32 v241, v240
  v_pk_mul_f32 v[200:201], v[200:201], v[240:241]
  v_cvt_pk_bf16_f32 v246, v200, v201
  v_pk_mul_f32 v[202:203], v[202:203], v[240:241]
  v_cvt_pk_bf16_f32 v247, v202, v203
  v_pk_mul_f32 v[208:209], v[208:209], v[240:241]
  v_cvt_pk_bf16_f32 v248, v208, v209
  v_pk_mul_f32 v[210:211], v[210:211], v[240:241]
  v_cvt_pk_bf16_f32 v249, v210, v211
  v_pk_mul_f32 v[216:217], v[216:217], v[240:241]
  v_cvt_pk_bf16_f32 v250, v216, v217
  v_pk_mul_f32 v[218:219], v[218:219], v[240:241]
  v_cvt_pk_bf16_f32 v251, v218, v219
  v_pk_mul_f32 v[224:225], v[224:225], v[240:241]
  v_cvt_pk_bf16_f32 v252, v224, v225
  v_pk_mul_f32 v[226:227], v[226:227], v[240:241]
  v_cvt_pk_bf16_f32 v253, v226, v227
  v_pk_mul_f32 v[232:233], v[232:233], v[240:241]
  v_cvt_pk_bf16_f32 v254, v232, v233
  v_pk_mul_f32 v[234:235], v[234:235], v[240:241]
  v_cvt_pk_bf16_f32 v255, v234, v235
  ds_write_b64 v9, v[246:247] offset:22536
  ds_write_b128 v9, v[248:251] offset:23552
  ds_write_b128 v9, v[252:255] offset:24576
  s_waitcnt lgkmcnt(0)
  s_branch b2_kernel_ph2b
b2_kernel_ph2:
  buffer_load_dwordx4 v[24:27], v2, s[4:7], s14 offen
  buffer_load_dwordx4 v[28:31], v3, s[4:7], s14 offen
  s_add_u32 s14, s14, 1024
  buffer_load_dwordx4 v[32:35], v2, s[4:7], s14 offen
  buffer_load_dwordx4 v[36:39], v3, s[4:7], s14 offen
  s_add_u32 s14, s14, 1024
  buffer_load_dwordx4 v[40:43], v2, s[4:7], s14 offen
  buffer_load_dwordx4 v[44:47], v3, s[4:7], s14 offen
  s_add_u32 s14, s14, 1024
  buffer_load_dwordx4 v[48:51], v2, s[4:7], s14 offen
  buffer_load_dwordx4 v[52:55], v3, s[4:7], s14 offen
  s_add_u32 s14, s14, 1024
b2_kernel_ph2b:
  buffer_load_dwordx4 v[56:59], v2, s[4:7], s14 offen
  buffer_load_dwordx4 v[60:63], v3, s[4:7], s14 offen
  s_add_u32 s14, s14, 1024
  buffer_load_dwordx4 v[64:67], v2, s[4:7], s14 offen
  buffer_load_dwordx4 v[68:71], v3, s[4:7], s14 offen
  s_add_u32 s14, s14, 1024
  buffer_load_dwordx4 v[72:75], v2, s[4:7], s14 offen
  buffer_load_dwordx4 v[76:79], v3, s[4:7], s14 offen
  s_add_u32 s14, s14, 1024
  buffer_load_dwordx4 v[80:83], v2, s[4:7], s14 offen
  buffer_load_dwordx4 v[84:87], v3, s[4:7], s14 offen
  s_add_u32 s14, s14, 1024
  buffer_load_dwordx4 v[88:91], v2, s[4:7], s14 offen
  buffer_load_dwordx4 v[92:95], v3, s[4:7], s14 offen
  s_add_u32 s14, s14, 1024
  buffer_load_dwordx4 v[96:99], v2, s[4:7], s14 offen
  buffer_load_dwordx4 v[100:103], v3, s[4:7], s14 offen
  s_add_u32 s14, s14, 1024
  buffer_load_dwordx4 v[16:19], v2, s[4:7], s12 offen
  buffer_load_dwordx4 v[20:23], v3, s[4:7], s12 offen
  s_barrier
  ds_read_b128 v[136:139], v2 offset:0
  ds_read_b128 v[140:143], v3 offset:0
  ds_read_b128 v[144:147], v2 offset:1024
  ds_read_b128 v[148:151], v3 offset:1024
  ds_read_b128 v[152:155], v2 offset:2048
  ds_read_b128 v[156:159], v3 offset:2048
  s_waitcnt vmcnt(20) lgkmcnt(4)
  v_mfma_f32_16x16x32_bf16 v[168:171], v[24:27], v[136:139], 0
  v_mfma_f32_16x16x32_bf16 v[176:179], v[24:27], v[140:143], 0
  v_mfma_f32_16x16x32_bf16 v[172:175], v[28:31], v[136:139], 0
  v_mfma_f32_16x16x32_bf16 v[180:183], v[28:31], v[140:143], 0
  buffer_load_dwordx4 v[24:27], v2, s[4:7], s14 offen
  buffer_load_dwordx4 v[28:31], v3, s[4:7], s14 offen
  s_add_u32 s14, s14, 1024
  ds_read_b128 v[160:163], v2 offset:3072
  ds_read_b128 v[164:167], v3 offset:3072
  s_waitcnt vmcnt(20) lgkmcnt(4)
  v_mfma_f32_16x16x32_bf16 v[168:171], v[32:35], v[144:147], v[168:171]
  v_mfma_f32_16x16x32_bf16 v[176:179], v[32:35], v[148:151], v[176:179]
  v_mfma_f32_16x16x32_bf16 v[172:175], v[36:39], v[144:147], v[172:175]
  v_mfma_f32_16x16x32_bf16 v[180:183], v[36:39], v[148:151], v[180:183]
  buffer_load_dwordx4 v[32:35], v2, s[4:7], s14 offen
  buffer_load_dwordx4 v[36:39], v3, s[4:7], s14 offen
  s_add_u32 s14, s14, 1024
  ds_read_b128 v[136:139], v2 offset:4096
  ds_read_b128 v[140:143], v3 offset:4096
  s_waitcnt vmcnt(20) lgkmcnt(4)
  v_mfma_f32_16x16x32_bf16 v[168:171], v[40:43], v[152:155], v[168:171]
  v_mfma_f32_16x16x32_bf16 v[176:179], v[40:43], v[156:159], v[176:179]
  v_mfma_f32_16x16x32_bf16 v[172:175], v[44:47], v[152:155], v[172:175]
  v_mfma_f32_16x16x32_bf16 v[180:183], v[44:47], v[156:159], v[180:183]
  buffer_load_dwordx4 v[40:43], v2, s[4:7], s14 offen
  buffer_load_dwordx4 v[44:47], v3, s[4:7], s14 offen
  s_add_u32 s14, s14, 1024
  ds_read_b128 v[144:147], v2 offset:5120
  ds_read_b128 v[148:151], v3 offset:5120
  s_waitcnt vmcnt(20) lgkmcnt(4)
  v_mfma_f32_16x16x32_bf16 v[168:171], v[48:51], v[160:163], v[168:171]
  v_mfma_f32_16x16x32_bf16 v[176:179], v[48:51], v[164:167], v[176:179]
  v_mfma_f32_16x16x32_bf16 v[172:175], v[52:55], v[160:163], v[172:175]
  v_mfma_f32_16x16x32_bf16 v[180:183], v[52:55], v[164:167], v[180:183]
  buffer_load_dwordx4 v[48:51], v2, s[4:7], s14 offen
  buffer_load_dwordx4 v[52:55], v3, s[4:7], s14 offen
  s_add_u32 s14, s14, 1024
  ds_read_b128 v[152:155], v2 offset:6144
  ds_read_b128 v[156:159], v3 offset:6144
  s_waitcnt vmcnt(20) lgkmcnt(4)
  v_mfma_f32_16x16x32_bf16 v[168:171], v[56:59], v[136:139], v[168:171]
  v_mfma_f32_16x16x32_bf16 v[176:179], v[56:59], v[140:143], v[176:179]
  v_mfma_f32_16x16x32_bf16 v[172:175], v[60:63], v[136:139], v[172:175]
  v_mfma_f32_16x16x32_bf16 v[180:183], v[60:63], v[140:143], v[180:183]
  buffer_load_dwordx4 v[56:59], v2, s[4:7], s14 offen
  buffer_load_dwordx4 v[60:63], v3, s[4:7], s14 offen
  s_add_u32 s14, s14, 1024
  ds_read_b128 v[160:163], v2 offset:7168
  ds_read_b128 v[164:167], v3 offset:7168
  s_waitcnt vmcnt(20) lgkmcnt(4)
  v_mfma_f32_16x16x32_bf16 v[168:171], v[64:67], v[144:147], v[168:171]
  v_mfma_f32_16x16x32_bf16 v[176:179], v[64:67], v[148:151], v[176:179]
  v_mfma_f32_16x16x32_bf16 v[172:175], v[68:71], v[144:147], v[172:175]
  v_mfma_f32_16x16x32_bf16 v[180:183], v[68:71], v[148:151], v[180:183]
  buffer_load_dwordx4 v[64:67], v2, s[4:7], s14 offen
  buffer_load_dwordx4 v[68:71], v3, s[4:7], s14 offen
  s_add_u32 s14, s14, 1024
  ds_read_b128 v[136:139], v2 offset:8192
  ds_read_b128 v[140:143], v3 offset:8192
  s_waitcnt vmcnt(20) lgkmcnt(4)
  v_mfma_f32_16x16x32_bf16 v[168:171], v[72:75], v[152:155], v[168:171]
  v_mfma_f32_16x16x32_bf16 v[176:179], v[72:75], v[156:159], v[176:179]
  v_mfma_f32_16x16x32_bf16 v[172:175], v[76:79], v[152:155], v[172:175]
  v_mfma_f32_16x16x32_bf16 v[180:183], v[76:79], v[156:159], v[180:183]
  buffer_load_dwordx4 v[72:75], v2, s[4:7], s14 offen
  buffer_load_dwordx4 v[76:79], v3, s[4:7], s14 offen
  s_add_u32 s14, s14, 1024
  ds_read_b128 v[144:147], v2 offset:9216
  ds_read_b128 v[148:151], v3 offset:9216
  s_waitcnt vmcnt(20) lgkmcnt(4)
  v_mfma_f32_16x16x32_bf16 v[168:171], v[80:83], v[160:163], v[168:171]
  v_mfma_f32_16x16x32_bf16 v[176:179], v[80:83], v[164:167], v[176:179]
  v_mfma_f32_16x16x32_bf16 v[172:175], v[84:87], v[160:163], v[172:175]
  v_mfma_f32_16x16x32_bf16 v[180:183], v[84:87], v[164:167], v[180:183]
  buffer_load_dwordx4 v[80:83], v2, s[4:7], s14 offen
  buffer_load_dwordx4 v[84:87], v3, s[4:7], s14 offen
  s_add_u32 s14, s14, 1024
  ds_read_b128 v[152:155], v2 offset:10240
  ds_read_b128 v[156:159], v3 offset:10240
  s_waitcnt vmcnt(20) lgkmcnt(4)
  v_mfma_f32_16x16x32_bf16 v[168:171], v[88:91], v[136:139], v[168:171]
  v_mfma_f32_16x16x32_bf16 v[176:179], v[88:91], v[140:143], v[176:179]
  v_mfma_f32_16x16x32_bf16 v[172:175], v[92:95], v[136:139], v[172:175]
  v_mfma_f32_16x16x32_bf16 v[180:183], v[92:95], v[140:143], v[180:183]
  buffer_load_dwordx4 v[88:91], v2, s[4:7], s14 offen
  buffer_load_dwordx4 v[92:95], v3, s[4:7], s14 offen
  s_add_u32 s14, s14, 1024
  ds_read_b128 v[160:163], v2 offset:11264
  ds_read_b128 v[164:167], v3 offset:11264
  s_waitcnt vmcnt(20) lgkmcnt(4)
  v_mfma_f32_16x16x32_bf16 v[168:171], v[96:99], v[144:147], v[168:171]
  v_mfma_f32_16x16x32_bf16 v[176:179], v[96:99], v[148:151], v[176:179]
  v_mfma_f32_16x16x32_bf16 v[172:175], v[100:103], v[144:147], v[172:175]
  v_mfma_f32_16x16x32_bf16 v[180:183], v[100:103], v[148:151], v[180:183]
  buffer_load_dwordx4 v[96:99], v2, s[4:7], s14 offen
  buffer_load_dwordx4 v[100:103], v3, s[4:7], s14 offen
  s_add_u32 s14, s14, 1024
  ds_read_b128 v[136:139], v2 offset:12288
  ds_read_b128 v[140:143], v3 offset:12288
  s_waitcnt vmcnt(18) lgkmcnt(4)
  v_mfma_f32_16x16x32_bf16 v[168:171], v[24:27], v[152:155], v[168:171]
  v_mfma_f32_16x16x32_bf16 v[176:179], v[24:27], v[156:159], v[176:179]
  v_mfma_f32_16x16x32_bf16 v[172:175], v[28:31], v[152:155], v[172:175]
  v_mfma_f32_16x16x32_bf16 v[180:183], v[28:31], v[156:159], v[180:183]
  ds_read_b128 v[144:147], v2 offset:13312
  ds_read_b128 v[148:151], v3 offset:13312
  s_waitcnt vmcnt(16) lgkmcnt(4)
  v_mfma_f32_16x16x32_bf16 v[168:171], v[32:35], v[160:163], v[168:171]
  v_mfma_f32_16x16x32_bf16 v[176:179], v[32:35], v[164:167], v[176:179]
  v_mfma_f32_16x16x32_bf16 v[172:175], v[36:39], v[160:163], v[172:175]
  v_mfma_f32_16x16x32_bf16 v[180:183], v[36:39], v[164:167], v[180:183]
  ds_read_b128 v[152:155], v2 offset:14336
  ds_read_b128 v[156:159], v3 offset:14336
  s_waitcnt vmcnt(14) lgkmcnt(4)
  v_mfma_f32_16x16x32_bf16 v[168:171], v[40:43], v[136:139], v[168:171]
  v_mfma_f32_16x16x32_bf16 v[176:179], v[40:43], v[140:143], v[176:179]
  v_mfma_f32_16x16x32_bf16 v[172:175], v[44:47], v[136:139], v[172:175]
  v_mfma_f32_16x16x32_bf16 v[180:183], v[44:47], v[140:143], v[180:183]
  ds_read_b128 v[160:163], v2 offset:15360
  ds_read_b128 v[164:167], v3 offset:15360
  s_waitcnt vmcnt(12) lgkmcnt(4)
  v_mfma_f32_16x16x32_bf16 v[168:171], v[48:51], v[144:147], v[168:171]
  v_mfma_f32_16x16x32_bf16 v[176:179], v[48:51], v[148:151], v[176:179]
  v_mfma_f32_16x16x32_bf16 v[172:175], v[52:55], v[144:147], v[172:175]
  v_mfma_f32_16x16x32_bf16 v[180:183], v[52:55], v[148:151], v[180:183]
  ds_read_b128 v[136:139], v2 offset:16384
  ds_read_b128 v[140:143], v3 offset:16384
  s_waitcnt vmcnt(10) lgkmcnt(4)
  v_mfma_f32_16x16x32_bf16 v[168:171], v[56:59], v[152:155], v[168:171]
  v_mfma_f32_16x16x32_bf16 v[176:179], v[56:59], v[156:159], v[176:179]
  v_mfma_f32_16x16x32_bf16 v[172:175], v[60:63], v[152:155], v[172:175]
  v_mfma_f32_16x16x32_bf16 v[180:183], v[60:63], v[156:159], v[180:183]
  ds_read_b128 v[144:147], v2 offset:17408
  ds_read_b128 v[148:151], v3 offset:17408
  s_waitcnt vmcnt(8) lgkmcnt(4)
  v_mfma_f32_16x16x32_bf16 v[168:171], v[64:67], v[160:163], v[168:171]
  v_mfma_f32_16x16x32_bf16 v[176:179], v[64:67], v[164:167], v[176:179]
  v_mfma_f32_16x16x32_bf16 v[172:175], v[68:71], v[160:163], v[172:175]
  v_mfma_f32_16x16x32_bf16 v[180:183], v[68:71], v[164:167], v[180:183]
  ds_read_b128 v[152:155], v2 offset:18432
  ds_read_b128 v[156:159], v3 offset:18432
  s_waitcnt vmcnt(6) lgkmcnt(4)
  v_mfma_f32_16x16x32_bf16 v[168:171], v[72:75], v[136:139], v[168:171]
  v_mfma_f32_16x16x32_bf16 v[176:179], v[72:75], v[140:143], v[176:179]
  v_mfma_f32_16x16x32_bf16 v[172:175], v[76:79], v[136:139], v[172:175]
  v_mfma_f32_16x16x32_bf16 v[180:183], v[76:79], v[140:143], v[180:183]
  ds_read_b128 v[160:163], v2 offset:19456
  ds_read_b128 v[164:167], v3 offset:19456
  s_waitcnt vmcnt(4) lgkmcnt(4)
  v_mfma_f32_16x16x32_bf16 v[168:171], v[80:83], v[144:147], v[168:171]
  v_mfma_f32_16x16x32_bf16 v[176:179], v[80:83], v[148:151], v[176:179]
  v_mfma_f32_16x16x32_bf16 v[172:175], v[84:87], v[144:147], v[172:175]
  v_mfma_f32_16x16x32_bf16 v[180:183], v[84:87], v[148:151], v[180:183]
  s_waitcnt vmcnt(2) lgkmcnt(2)
  v_mfma_f32_16x16x32_bf16 v[168:171], v[88:91], v[152:155], v[168:171]
  v_mfma_f32_16x16x32_bf16 v[176:179], v[88:91], v[156:159], v[176:179]
  v_mfma_f32_16x16x32_bf16 v[172:175], v[92:95], v[152:155], v[172:175]
  v_mfma_f32_16x16x32_bf16 v[180:183], v[92:95], v[156:159], v[180:183]
  s_waitcnt vmcnt(0) lgkmcnt(0)
  v_mfma_f32_16x16x32_bf16 v[168:171], v[96:99], v[160:163], v[168:171]
  v_mfma_f32_16x16x32_bf16 v[176:179], v[96:99], v[164:167], v[176:179]
  v_mfma_f32_16x16x32_bf16 v[172:175], v[100:103], v[160:163], v[172:175]
  v_mfma_f32_16x16x32_bf16 v[180:183], v[100:103], v[164:167], v[180:183]
  s_mov_b32 s23, 0xffff0000
  v_lshlrev_b32 v10, 16, v16
  v_and_b32 v11, s23, v16
  v_pk_add_f32 v[168:169], v[168:169], v[10:11]
  v_cvt_pk_bf16_f32 v16, v168, v169
  v_lshlrev_b32 v10, 16, v17
  v_and_b32 v11, s23, v17
  v_pk_add_f32 v[170:171], v[170:171], v[10:11]
  v_cvt_pk_bf16_f32 v17, v170, v171
  v_lshlrev_b32 v10, 16, v18
  v_and_b32 v11, s23, v18
  v_pk_add_f32 v[172:173], v[172:173], v[10:11]
  v_cvt_pk_bf16_f32 v18, v172, v173
  v_lshlrev_b32 v10, 16, v19
  v_and_b32 v11, s23, v19
  v_pk_add_f32 v[174:175], v[174:175], v[10:11]
  v_cvt_pk_bf16_f32 v19, v174, v175
  v_lshlrev_b32 v10, 16, v20
  v_and_b32 v11, s23, v20
  v_pk_add_f32 v[176:177], v[176:177], v[10:11]
  v_cvt_pk_bf16_f32 v20, v176, v177
  v_lshlrev_b32 v10, 16, v21
  v_and_b32 v11, s23, v21
  v_pk_add_f32 v[178:179], v[178:179], v[10:11]
  v_cvt_pk_bf16_f32 v21, v178, v179
  v_lshlrev_b32 v10, 16, v22
  v_and_b32 v11, s23, v22
  v_pk_add_f32 v[180:181], v[180:181], v[10:11]
  v_cvt_pk_bf16_f32 v22, v180, v181
  v_lshlrev_b32 v10, 16, v23
  v_and_b32 v11, s23, v23
  v_pk_add_f32 v[182:183], v[182:183], v[10:11]
  v_cvt_pk_bf16_f32 v23, v182, v183
  v_pk_add_f32 v[10:11], v[168:169], v[170:171]
  v_pk_add_f32 v[12:13], v[172:173], v[174:175]
  v_pk_add_f32 v[10:11], v[10:11], v[12:13]
  v_add_f32 v24, v10, v11
  v_mov_b32 v10, v24
  s_nop 1
  v_permlane16_swap_b32 v24, v10
  v_add_f32 v24, v24, v10
  v_mov_b32 v10, v24
  s_nop 1
  v_permlane32_swap_b32 v24, v10
  v_add_f32 v24, v24, v10
  v_mul_f32 v24, 0x3d000000, v24
  v_sub_f32 v10, v168, v24
  v_mul_f32 v25, v10, v10
  v_sub_f32 v10, v169, v24
  v_fmac_f32 v25, v10, v10
  v_sub_f32 v10, v170, v24
  v_fmac_f32 v25, v10, v10
  v_sub_f32 v10, v171, v24
  v_fmac_f32 v25, v10, v10
  v_sub_f32 v10, v172, v24
  v_fmac_f32 v25, v10, v10
  v_sub_f32 v10, v173, v24
  v_fmac_f32 v25, v10, v10
  v_sub_f32 v10, v174, v24
  v_fmac_f32 v25, v10, v10
  v_sub_f32 v10, v175, v24
  v_fmac_f32 v25, v10, v10
  v_mov_b32 v10, v25
  s_nop 1
  v_permlane16_swap_b32 v25, v10
  v_add_f32 v25, v25, v10
  v_mov_b32 v10, v25
  s_nop 1
  v_permlane32_swap_b32 v25, v10
  v_add_f32 v25, v25, v10
  v_and_b32 v24, -2, v24
  v_and_b32 v25, -2, v25
  v_pk_add_f32 v[10:11], v[176:177], v[178:179]
  v_pk_add_f32 v[12:13], v[180:181], v[182:183]
  v_pk_add_f32 v[10:11], v[10:11], v[12:13]
  v_add_f32 v26, v10, v11
  v_mov_b32 v10, v26
  s_nop 1
  v_permlane16_swap_b32 v26, v10
  v_add_f32 v26, v26, v10
  v_mov_b32 v10, v26
  s_nop 1
  v_permlane32_swap_b32 v26, v10
  v_add_f32 v26, v26, v10
  v_mul_f32 v26, 0x3d000000, v26
  v_sub_f32 v10, v176, v26
  v_mul_f32 v27, v10, v10
  v_sub_f32 v10, v177, v26
  v_fmac_f32 v27, v10, v10
  v_sub_f32 v10, v178, v26
  v_fmac_f32 v27, v10, v10
  v_sub_f32 v10, v179, v26
  v_fmac_f32 v27, v10, v10
  v_sub_f32 v10, v180, v26
  v_fmac_f32 v27, v10, v10
  v_sub_f32 v10, v181, v26
  v_fmac_f32 v27, v10, v10
  v_sub_f32 v10, v182, v26
  v_fmac_f32 v27, v10, v10
  v_sub_f32 v10, v183, v26
  v_fmac_f32 v27, v10, v10
  v_mov_b32 v10, v27
  s_nop 1
  v_permlane16_swap_b32 v27, v10
  v_add_f32 v27, v27, v10
  v_mov_b32 v10, v27
  s_nop 1
  v_permlane32_swap_b32 v27, v10
  v_add_f32 v27, v27, v10
  v_and_b32 v26, -2, v26
  v_and_b32 v27, -2, v27
  s_mul_i32 s15, s8, 5120
  s_add_u32 s15, s15, 96829440
  s_lshl_b32 s16, s10, 7
  s_add_u32 s16, s16, s15
  v_lshlrev_b32 v8, 3, v4
  s_mov_b64 exec, 0xffff
  buffer_store_dwordx2 v[24:25], v8, s[4:7], s16 offen sc1
  buffer_store_dwordx2 v[26:27], v8, s[4:7], s16 offen offset:2560 sc1
  s_mov_b64 exec, -1
  buffer_store_dwordx4 v[16:19], v2, s[4:7], s12 offen
  buffer_store_dwordx4 v[20:23], v3, s[4:7], s12 offen
  v_mul_u32_u24 v9, 640, v5
  v_add_u32 v8, v8, v9
  s_mov_b32 s17, 0
b2_kernel_poll:
  buffer_load_dwordx2 v[32:33], v8, s[4:7], s15 offen offset:0 sc1
  buffer_load_dwordx2 v[34:35], v8, s[4:7], s15 offen offset:128 sc1
  buffer_load_dwordx2 v[36:37], v8, s[4:7], s15 offen offset:256 sc1
  buffer_load_dwordx2 v[38:39], v8, s[4:7], s15 offen offset:384 sc1
  buffer_load_dwordx2 v[40:41], v8, s[4:7], s15 offen offset:512 sc1
  buffer_load_dwordx2 v[42:43], v8, s[4:7], s15 offen offset:2560 sc1
  buffer_load_dwordx2 v[44:45], v8, s[4:7], s15 offen offset:2688 sc1
  buffer_load_dwordx2 v[46:47], v8, s[4:7], s15 offen offset:2816 sc1
  buffer_load_dwordx2 v[48:49], v8, s[4:7], s15 offen offset:2944 sc1
  buffer_load_dwordx2 v[50:51], v8, s[4:7], s15 offen offset:3072 sc1
  s_waitcnt vmcnt(0)
  v_or3_b32 v10, v32, v33, v34
  v_or3_b32 v10, v10, v35, v36
  v_or3_b32 v10, v10, v37, v38
  v_or3_b32 v10, v10, v39, v40
  v_or3_b32 v10, v10, v41, v42
  v_or3_b32 v10, v10, v43, v44
  v_or3_b32 v10, v10, v45, v46
  v_or3_b32 v10, v10, v47, v48
  v_or3_b32 v10, v10, v49, v50
  v_or_b32 v10, v10, v51
  v_and_b32 v10, 1, v10
  v_cmp_ne_u32 vcc, 0, v10
  s_nop 0
  s_cbranch_vccz b2_kernel_ok
  s_add_u32 s17, s17, 1
  s_cmp_lt_u32 s17, 262144
  s_cbranch_scc1 b2_kernel_poll
  v_mov_b32 v10, 0x2000
  v_mov_b32 v11, 68
  buffer_store_dword v10, v11, s[24:27], 0 offen
  s_endpgm
b2_kernel_ok:
  v_add_f32 v10, v32, v34
  v_add_f32 v11, v36, v38
  v_add_f32 v10, v10, v40
  v_add_f32 v10, v10, v11
  v_mov_b32 v11, v10
  s_nop 1
  v_permlane16_swap_b32 v10, v11
  v_add_f32 v10, v10, v11
  v_mov_b32 v11, v10
  s_nop 1
  v_permlane32_swap_b32 v10, v11
  v_add_f32 v10, v10, v11
  v_mul_f32 v10, 0x3d4ccccd, v10
  v_mov_b32 v12, 0
  v_sub_f32 v11, v32, v10
  v_fmac_f32 v12, v11, v11
  v_sub_f32 v11, v34, v10
  v_fmac_f32 v12, v11, v11
  v_sub_f32 v11, v36, v10
  v_fmac_f32 v12, v11, v11
  v_sub_f32 v11, v38, v10
  v_fmac_f32 v12, v11, v11
  v_sub_f32 v11, v40, v10
  v_fmac_f32 v12, v11, v11
  v_mul_f32 v12, 0x42000000, v12
  v_add_f32 v12, v12, v33
  v_add_f32 v12, v12, v35
  v_add_f32 v12, v12, v37
  v_add_f32 v12, v12, v39
  v_add_f32 v12, v12, v41
  v_mov_b32 v11, v12
  s_nop 1
  v_permlane16_swap_b32 v12, v11
  v_add_f32 v12, v12, v11
  v_mov_b32 v11, v12
  s_nop 1
  v_permlane32_swap_b32 v12, v11
  v_add_f32 v12, v12, v11
  v_mov_b32 v11, 0x3727c5ac
  v_fmac_f32 v11, 0x3acccccd, v12
  v_rsq_f32 v11, v11
  s_nop 0
  v_mul_f32 v10, v10, v11
  v_fma_f32 v168, v168, v11, -v10
  v_fma_f32 v169, v169, v11, -v10
  v_fma_f32 v170, v170, v11, -v10
  v_fma_f32 v171, v171, v11, -v10
  v_fma_f32 v172, v172, v11, -v10
  v_fma_f32 v173, v173, v11, -v10
  v_fma_f32 v174, v174, v11, -v10
  v_fma_f32 v175, v175, v11, -v10
  v_cvt_pk_bf16_f32 v60, v168, v169
  v_cvt_pk_bf16_f32 v61, v170, v171
  v_cvt_pk_bf16_f32 v62, v172, v173
  v_cvt_pk_bf16_f32 v63, v174, v175
  buffer_store_dwordx4 v[60:63], v2, s[4:7], s22 offen
  v_add_f32 v10, v42, v44
  v_add_f32 v11, v46, v48
  v_add_f32 v10, v10, v50
  v_add_f32 v10, v10, v11
  v_mov_b32 v11, v10
  s_nop 1
  v_permlane16_swap_b32 v10, v11
  v_add_f32 v10, v10, v11
  v_mov_b32 v11, v10
  s_nop 1
  v_permlane32_swap_b32 v10, v11
  v_add_f32 v10, v10, v11
  v_mul_f32 v10, 0x3d4ccccd, v10
  v_mov_b32 v12, 0
  v_sub_f32 v11, v42, v10
  v_fmac_f32 v12, v11, v11
  v_sub_f32 v11, v44, v10
  v_fmac_f32 v12, v11, v11
  v_sub_f32 v11, v46, v10
  v_fmac_f32 v12, v11, v11
  v_sub_f32 v11, v48, v10
  v_fmac_f32 v12, v11, v11
  v_sub_f32 v11, v50, v10
  v_fmac_f32 v12, v11, v11
  v_mul_f32 v12, 0x42000000, v12
  v_add_f32 v12, v12, v43
  v_add_f32 v12, v12, v45
  v_add_f32 v12, v12, v47
  v_add_f32 v12, v12, v49
  v_add_f32 v12, v12, v51
  v_mov_b32 v11, v12
  s_nop 1
  v_permlane16_swap_b32 v12, v11
  v_add_f32 v12, v12, v11
  v_mov_b32 v11, v12
  s_nop 1
  v_permlane32_swap_b32 v12, v11
  v_add_f32 v12, v12, v11
  v_mov_b32 v11, 0x3727c5ac
  v_fmac_f32 v11, 0x3acccccd, v12
  v_rsq_f32 v11, v11
  s_nop 0
  v_mul_f32 v10, v10, v11
  v_fma_f32 v176, v176, v11, -v10
  v_fma_f32 v177, v177, v11, -v10
  v_fma_f32 v178, v178, v11, -v10
  v_fma_f32 v179, v179, v11, -v10
  v_fma_f32 v180, v180, v11, -v10
  v_fma_f32 v181, v181, v11, -v10
  v_fma_f32 v182, v182, v11, -v10
  v_fma_f32 v183, v183, v11, -v10
  v_cvt_pk_bf16_f32 v64, v176, v177
  v_cvt_pk_bf16_f32 v65, v178, v179
  v_cvt_pk_bf16_f32 v66, v180, v181
  v_cvt_pk_bf16_f32 v67, v182, v183
  buffer_store_dwordx4 v[64:67], v3, s[4:7], s22 offen
b2_kernel_end:
  s_endpgm

.globl b2f_kernel
.p2align 8
.type b2f_kernel,@function
b2f_kernel:
  s_load_dwordx2 s[4:5], s[0:1], 104
  s_mov_b32 s6, 0x10000000
  s_mov_b32 s7, 0x20000
  s_load_dwordx2 s[24:25], s[0:1], 88
  s_mov_b32 s26, 0x280000
  s_mov_b32 s27, 0x20000
  v_lshrrev_b32 v1, 6, v0
  s_nop 0
  v_readfirstlane_b32 s3, v1
  v_and_b32 v1, 63, v0
  s_cmp_ge_u32 s2, 256
  s_cbranch_scc1 b2f_kernel_end
  s_and_b32 s8, s2, 7
  s_lshl_b32 s8, s8, 3
  s_lshr_b32 s9, s2, 5
  s_add_u32 s8, s8, s9
  s_bfe_u32 s9, s2, 0x20003
  v_lshlrev_b32 v2, 4, v1
  v_and_b32 v4, 15, v1
  v_lshrrev_b32 v5, 4, v1
  v_mul_u32_u24 v6, 1280, v4
  v_lshl_add_u32 v6, v5, 4, v6
  s_mul_i32 s10, s9, 5
  s_add_u32 s10, s10, s3
  s_mul_i32 s11, s8, 40960
  s_lshl_b32 s12, s10, 6
  s_add_u32 s11, s11, s12
  s_mul_i32 s12, s8, 40
  s_add_u32 s12, s12, s10
  s_lshl_b32 s12, s12, 10
  s_add_u32 s22, s12, 26214400
  s_add_u32 s12, s12, 50790400
  s_mul_i32 s14, s10, 40960
  s_add_u32 s14, s14, 95948800
  v_add_u32 v3, 20480, v2
  v_lshrrev_b32 v7, 2, v4
  v_cmp_eq_u32 vcc, v7, v5
  v_lshlrev_b32 v7, 4, v4
  s_mov_b64 s[20:21], vcc
  s_mul_i32 s15, s3, 15360
  s_add_u32 s15, s15, 40960
  v_add_u32 v7, s15, v7
  s_waitcnt lgkmcnt(0)
  s_cmp_eq_u32 s3, 4
  s_cbranch_scc1 b2f_kernel_ph2
  s_mul_i32 s16, s3, 15360
  s_add_u32 s16, s16, 96768000
  s_mov_b32 m0, s15
  s_nop 0
  buffer_load_dwordx4 v2, s[4:7], s16 offen offset:0 lds
  buffer_load_dwordx4 v2, s[4:7], s16 offen offset:1024 lds
  buffer_load_dwordx4 v2, s[4:7], s16 offen offset:2048 lds
  buffer_load_dwordx4 v2, s[4:7], s16 offen offset:3072 lds
  s_add_u32 s15, s15, 4096
  s_add_u32 s16, s16, 4096
  s_mov_b32 m0, s15
  s_nop 0
  buffer_load_dwordx4 v2, s[4:7], s16 offen offset:0 lds
  buffer_load_dwordx4 v2, s[4:7], s16 offen offset:1024 lds
  buffer_load_dwordx4 v2, s[4:7], s16 offen offset:2048 lds
  buffer_load_dwordx4 v2, s[4:7], s16 offen offset:3072 lds
  s_add_u32 s15, s15, 4096
  s_add_u32 s16, s16, 4096
  s_mov_b32 m0, s15
  s_nop 0
  buffer_load_dwordx4 v2, s[4:7], s16 offen offset:0 lds
  buffer_load_dwordx4 v2, s[4:7], s16 offen offset:1024 lds
  buffer_load_dwordx4 v2, s[4:7], s16 offen offset:2048 lds
  buffer_load_dwordx4 v2, s[4:7], s16 offen offset:3072 lds
  s_add_u32 s15, s15, 4096
  s_add_u32 s16, s16, 4096
  s_mov_b32 m0, s15
  s_nop 0
  buffer_load_dwordx4 v2, s[4:7], s16 offen offset:0 lds
  buffer_load_dwordx4 v2, s[4:7], s16 offen offset:1024 lds
  buffer_load_dwordx4 v2, s[4:7], s16 offen offset:2048 lds
  s_lshl_b32 s15, s8, 4
  s_lshl_b32 s16, s3, 1
  s_add_u32 s15, s15, s16
  s_mul_i32 s15, s15, 5120
  s_add_u32 s15, s15, 39256064
  s_add_u32 s17, s15, 0
  s_add_u32 s18, s17, 4096
  buffer_load_dwordx4 v[56:59], v2, s[4:7], s17 offen offset:0
  buffer_load_dwordx4 v[60:63], v2, s[4:7], s17 offen offset:1024
  buffer_load_dwordx4 v[64:67], v2, s[4:7], s17 offen offset:2048
  buffer_load_dwordx4 v[68:71], v2, s[4:7], s17 offen offset:3072
  buffer_load_dwordx4 v[72:75], v2, s[4:7], s18 offen offset:0
  s_add_u32 s17, s15, 40960
  s_add_u32 s18, s17, 4096
  buffer_load_dwordx4 v[96:99], v2, s[4:7], s17 offen offset:0
  buffer_load_dwordx4 v[100:103], v2, s[4:7], s17 offen offset:1024
  buffer_load_dwordx4 v[104:107], v2, s[4:7], s17 offen offset:2048
  buffer_load_dwordx4 v[108:111], v2, s[4:7], s17 offen offset:3072
  buffer_load_dwordx4 v[112:115], v2, s[4:7], s18 offen offset:0
  s_add_u32 s17, s15, 5120
  s_add_u32 s18, s17, 4096
  buffer_load_dwordx4 v[76:79], v2, s[4:7], s17 offen offset:0
  buffer_load_dwordx4 v[80:83], v2, s[4:7], s17 offen offset:1024
  buffer_load_dwordx4 v[84:87], v2, s[4:7], s17 offen offset:2048
  buffer_load_dwordx4 v[88:91], v2, s[4:7], s17 offen offset:3072
  buffer_load_dwordx4 v[92:95], v2, s[4:7], s18 offen offset:0
  s_add_u32 s17, s15, 46080
  s_add_u32 s18, s17, 4096
  buffer_load_dwordx4 v[116:119], v2, s[4:7], s17 offen offset:0
  buffer_load_dwordx4 v[120:123], v2, s[4:7], s17 offen offset:1024
  buffer_load_dwordx4 v[124:127], v2, s[4:7], s17 offen offset:2048
  buffer_load_dwordx4 v[128:131], v2, s[4:7], s17 offen offset:3072
  buffer_load_dwordx4 v[132:135], v2, s[4:7], s18 offen offset:0
  buffer_load_dwordx4 v[24:27], v2, s[4:7], s14 offen
  buffer_load_dwordx4 v[28:31], v3, s[4:7], s14 offen
  s_add_u32 s14, s14, 1024
  buffer_load_dwordx4 v[32:35], v2, s[4:7], s14 offen
  buffer_load_dwordx4 v[36:39], v3, s[4:7], s14 offen
  s_add_u32 s14, s14, 1024
  buffer_load_dwordx4 v[40:43], v2, s[4:7], s14 offen
  buffer_load_dwordx4 v[44:47], v3, s[4:7], s14 offen
  s_add_u32 s14, s14, 1024
  buffer_load_dwordx4 v[48:51], v2, s[4:7], s14 offen
  buffer_load_dwordx4 v[52:55], v3, s[4:7], s14 offen
  s_add_u32 s14, s14, 1024
  v_mov_b32 v136, 0
  v_mov_b32 v137, 0
  v_mov_b32 v138, 0
  v_mov_b32 v139, 0
  v_mov_b32 v140, 0
  v_mov_b32 v141, 0
  v_mov_b32 v142, 0
  v_mov_b32 v143, 0
  v_mov_b32 v144, 0
  v_mov_b32 v145, 0
  v_mov_b32 v146, 0
  v_mov_b32 v147, 0
  v_mov_b32 v148, 0
  v_mov_b32 v149, 0
  v_mov_b32 v150, 0
  v_mov_b32 v151, 0
  v_mov_b32 v152, 0
  v_mov_b32 v153, 0
  v_mov_b32 v154, 0
  v_mov_b32 v155, 0
  v_mov_b32 v156, 0
  v_mov_b32 v157, 0
  v_mov_b32 v158, 0
  v_mov_b32 v159, 0
  v_mov_b32 v160, 0
  v_mov_b32 v161, 0
  v_mov_b32 v162, 0
  v_mov_b32 v163, 0
  v_mov_b32 v164, 0
  v_mov_b32 v165, 0
  v_mov_b32 v166, 0
  v_mov_b32 v167, 0
  v_mov_b32 v168, 0
  v_mov_b32 v169, 0
  v_mov_b32 v170, 0
  v_mov_b32 v171, 0
  v_mov_b32 v172, 0
  v_mov_b32 v173, 0
  v_mov_b32 v174, 0
  v_mov_b32 v175, 0
  v_mov_b32 v176, 0
  v_mov_b32 v177, 0
  v_mov_b32 v178, 0
  v_mov_b32 v179, 0
  v_mov_b32 v180, 0
  v_mov_b32 v181, 0
  v_mov_b32 v182, 0
  v_mov_b32 v183, 0
  v_mov_b32 v184, 0
  v_mov_b32 v185, 0
  v_mov_b32 v186, 0
  v_mov_b32 v187, 0
  v_mov_b32 v188, 0
  v_mov_b32 v189, 0
  v_mov_b32 v190, 0
  v_mov_b32 v191, 0
  v_mov_b32 v192, 0
  v_mov_b32 v193, 0
  v_mov_b32 v194, 0
  v_mov_b32 v195, 0
  s_waitcnt vmcnt(28)
  s_mov_b64 exec, s[20:21]
  ds_read_b128 v[136:139], v7 offset:0
  ds_read_b128 v[140:143], v7 offset:256
  ds_read_b128 v[144:147], v7 offset:512
  ds_read_b128 v[148:151], v7 offset:768
  ds_read_b128 v[152:155], v7 offset:1024
  s_mov_b64 exec, -1
  s_mov_b64 exec, s[20:21]
  ds_read_b128 v[156:159], v7 offset:1280
  ds_read_b128 v[160:163], v7 offset:1536
  ds_read_b128 v[164:167], v7 offset:1792
  ds_read_b128 v[168:171], v7 offset:2048
  ds_read_b128 v[172:175], v7 offset:2304
  s_mov_b64 exec, -1
  s_mov_b64 exec, s[20:21]
  ds_read_b128 v[176:179], v7 offset:2560
  ds_read_b128 v[180:183], v7 offset:2816
  ds_read_b128 v[184:187], v7 offset:3072
  ds_read_b128 v[188:191], v7 offset:3328
  ds_read_b128 v[192:195], v7 offset:3584
  s_mov_b64 exec, -1
  s_mul_i32 s17, s3, 5120
  v_add_u32 v9, s17, v2
  v_mov_b32 v10, 0x358637bd
  s_waitcnt vmcnt(18)
  s_waitcnt lgkmcnt(10)
  v_mfma_f32_16x16x32_bf16 v[196:199], v[136:139], v[56:59], 0
  v_mfma_f32_16x16x32_bf16 v[200:203], v[136:139], v[96:99], 0
  v_mfma_f32_16x16x32_bf16 v[196:199], v[140:143], v[60:63], v[196:199]
  v_mfma_f32_16x16x32_bf16 v[200:203], v[140:143], v[100:103], v[200:203]
  v_mfma_f32_16x16x32_bf16 v[196:199], v[144:147], v[64:67], v[196:199]
  v_mfma_f32_16x16x32_bf16 v[200:203], v[144:147], v[104:107], v[200:203]
  v_mfma_f32_16x16x32_bf16 v[196:199], v[148:151], v[68:71], v[196:199]
  v_mfma_f32_16x16x32_bf16 v[200:203], v[148:151], v[108:111], v[200:203]
  v_mfma_f32_16x16x32_bf16 v[196:199], v[152:155], v[72:75], v[196:199]
  v_mfma_f32_16x16x32_bf16 v[200:203], v[152:155], v[112:115], v[200:203]
  s_mov_b64 exec, s[20:21]
  ds_read_b128 v[136:139], v7 offset:3840
  ds_read_b128 v[140:143], v7 offset:4096
  ds_read_b128 v[144:147], v7 offset:4352
  ds_read_b128 v[148:151], v7 offset:4608
  ds_read_b128 v[152:155], v7 offset:4864
  s_mov_b64 exec, -1
  s_waitcnt lgkmcnt(10)
  v_mfma_f32_16x16x32_bf16 v[204:207], v[156:159], v[56:59], 0
  v_mfma_f32_16x16x32_bf16 v[208:211], v[156:159], v[96:99], 0
  v_mfma_f32_16x16x32_bf16 v[204:207], v[160:163], v[60:63], v[204:207]
  v_mfma_f32_16x16x32_bf16 v[208:211], v[160:163], v[100:103], v[208:211]
  v_mfma_f32_16x16x32_bf16 v[204:207], v[164:167], v[64:67], v[204:207]
  v_mfma_f32_16x16x32_bf16 v[208:211], v[164:167], v[104:107], v[208:211]
  v_mfma_f32_16x16x32_bf16 v[204:207], v[168:171], v[68:71], v[204:207]
  v_mfma_f32_16x16x32_bf16 v[208:211], v[168:171], v[108:111], v[208:211]
  v_mfma_f32_16x16x32_bf16 v[204:207], v[172:175], v[72:75], v[204:207]
  v_mfma_f32_16x16x32_bf16 v[208:211], v[172:175], v[112:115], v[208:211]
  s_mov_b64 exec, s[20:21]
  ds_read_b128 v[156:159], v7 offset:5120
  ds_read_b128 v[160:163], v7 offset:5376
  ds_read_b128 v[164:167], v7 offset:5632
  ds_read_b128 v[168:171], v7 offset:5888
  ds_read_b128 v[172:175], v7 offset:6144
  s_mov_b64 exec, -1
  s_waitcnt lgkmcnt(10)
  v_mfma_f32_16x16x32_bf16 v[212:215], v[176:179], v[56:59], 0
  v_mfma_f32_16x16x32_bf16 v[216:219], v[176:179], v[96:99], 0
  v_mfma_f32_16x16x32_bf16 v[212:215], v[180:183], v[60:63], v[212:215]
  v_mfma_f32_16x16x32_bf16 v[216:219], v[180:183], v[100:103], v[216:219]
  v_mfma_f32_16x16x32_bf16 v[212:215], v[184:187], v[64:67], v[212:215]
  v_mfma_f32_16x16x32_bf16 v[216:219], v[184:187], v[104:107], v[216:219]
  v_mfma_f32_16x16x32_bf16 v[212:215], v[188:191], v[68:71], v[212:215]
  v_mfma_f32_16x16x32_bf16 v[216:219], v[188:191], v[108:111], v[216:219]
  v_mfma_f32_16x16x32_bf16 v[212:215], v[192:195], v[72:75], v[212:215]
  v_mfma_f32_16x16x32_bf16 v[216:219], v[192:195], v[112:115], v[216:219]
  s_mov_b64 exec, s[20:21]
  ds_read_b128 v[176:179], v7 offset:6400
  ds_read_b128 v[180:183], v7 offset:6656
  ds_read_b128 v[184:187], v7 offset:6912
  ds_read_b128 v[188:191], v7 offset:7168
  ds_read_b128 v[192:195], v7 offset:7424
  s_mov_b64 exec, -1
  s_waitcnt lgkmcnt(10)
  v_mfma_f32_16x16x32_bf16 v[220:223], v[136:139], v[56:59], 0
  v_mfma_f32_16x16x32_bf16 v[224:227], v[136:139], v[96:99], 0
  v_mfma_f32_16x16x32_bf16 v[220:223], v[140:143], v[60:63], v[220:223]
  v_mfma_f32_16x16x32_bf16 v[224:227], v[140:143], v[100:103], v[224:227]
  v_mfma_f32_16x16x32_bf16 v[220:223], v[144:147], v[64:67], v[220:223]
  v_mfma_f32_16x16x32_bf16 v[224:227], v[144:147], v[104:107], v[224:227]
  v_mfma_f32_16x16x32_bf16 v[220:223], v[148:151], v[68:71], v[220:223]
  v_mfma_f32_16x16x32_bf16 v[224:227], v[148:151], v[108:111], v[224:227]
  v_mfma_f32_16x16x32_bf16 v[220:223], v[152:155], v[72:75], v[220:223]
  v_mfma_f32_16x16x32_bf16 v[224:227], v[152:155], v[112:115], v[224:227]
  s_mov_b64 exec, s[20:21]
  ds_read_b128 v[136:139], v7 offset:7680
  ds_read_b128 v[140:143], v7 offset:7936
  ds_read_b128 v[144:147], v7 offset:8192
  ds_read_b128 v[148:151], v7 offset:8448
  ds_read_b128 v[152:155], v7 offset:8704
  s_mov_b64 exec, -1
  s_waitcnt lgkmcnt(10)
  v_mfma_f32_16x16x32_bf16 v[228:231], v[156:159], v[56:59], 0
  v_mfma_f32_16x16x32_bf16 v[232:235], v[156:159], v[96:99], 0
  v_mfma_f32_16x16x32_bf16 v[228:231], v[160:163], v[60:63], v[228:231]
  v_mfma_f32_16x16x32_bf16 v[232:235], v[160:163], v[100:103], v[232:235]
  v_mfma_f32_16x16x32_bf16 v[228:231], v[164:167], v[64:67], v[228:231]
  v_mfma_f32_16x16x32_bf16 v[232:235], v[164:167], v[104:107], v[232:235]
  v_mfma_f32_16x16x32_bf16 v[228:231], v[168:171], v[68:71], v[228:231]
  v_mfma_f32_16x16x32_bf16 v[232:235], v[168:171], v[108:111], v[232:235]
  v_mfma_f32_16x16x32_bf16 v[228:231], v[172:175], v[72:75], v[228:231]
  v_mfma_f32_16x16x32_bf16 v[232:235], v[172:175], v[112:115], v[232:235]
  s_mov_b64 exec, s[20:21]
  ds_read_b128 v[156:159], v7 offset:8960
  ds_read_b128 v[160:163], v7 offset:9216
  ds_read_b128 v[164:167], v7 offset:9472
  ds_read_b128 v[168:171], v7 offset:9728
  ds_read_b128 v[172:175], v7 offset:9984
  s_mov_b64 exec, -1
  s_waitcnt lgkmcnt(10)
  v_mfma_f32_16x16x32_bf16 v[236:239], v[176:179], v[56:59], 0
  v_mfma_f32_16x16x32_bf16 v[240:243], v[176:179], v[96:99], 0
  v_mfma_f32_16x16x32_bf16 v[236:239], v[180:183], v[60:63], v[236:239]
  v_mfma_f32_16x16x32_bf16 v[240:243], v[180:183], v[100:103], v[240:243]
  v_mfma_f32_16x16x32_bf16 v[236:239], v[184:187], v[64:67], v[236:239]
  v_mfma_f32_16x16x32_bf16 v[240:243], v[184:187], v[104:107], v[240:243]
  v_mfma_f32_16x16x32_bf16 v[236:239], v[188:191], v[68:71], v[236:239]
  v_mfma_f32_16x16x32_bf16 v[240:243], v[188:191], v[108:111], v[240:243]
  v_mfma_f32_16x16x32_bf16 v[236:239], v[192:195], v[72:75], v[236:239]
  v_mfma_f32_16x16x32_bf16 v[240:243], v[192:195], v[112:115], v[240:243]
  s_mov_b64 exec, s[20:21]
  ds_read_b128 v[176:179], v7 offset:10240
  ds_read_b128 v[180:183], v7 offset:10496
  ds_read_b128 v[184:187], v7 offset:10752
  ds_read_b128 v[188:191], v7 offset:11008
  ds_read_b128 v[192:195], v7 offset:11264
  s_mov_b64 exec, -1
  v_add_f32 v236, v236, v10
  v_rcp_f32 v236, v236
  s_nop 0
  v_mov_b32 v237, v236
  v_pk_mul_f32 v[196:197], v[196:197], v[236:237]
  v_cvt_pk_bf16_f32 v244, v196, v197
  v_pk_mul_f32 v[198:199], v[198:199], v[236:237]
  v_cvt_pk_bf16_f32 v245, v198, v199
  v_pk_mul_f32 v[204:205], v[204:205], v[236:237]
  v_cvt_pk_bf16_f32 v246, v204, v205
  v_pk_mul_f32 v[206:207], v[206:207], v[236:237]
  v_cvt_pk_bf16_f32 v247, v206, v207
  v_pk_mul_f32 v[212:213], v[212:213], v[236:237]
  v_cvt_pk_bf16_f32 v248, v212, v213
  v_pk_mul_f32 v[214:215], v[214:215], v[236:237]
  v_cvt_pk_bf16_f32 v249, v214, v215
  v_pk_mul_f32 v[220:221], v[220:221], v[236:237]
  v_cvt_pk_bf16_f32 v250, v220, v221
  v_pk_mul_f32 v[222:223], v[222:223], v[236:237]
  v_cvt_pk_bf16_f32 v251, v222, v223
  v_pk_mul_f32 v[228:229], v[228:229], v[236:237]
  v_cvt_pk_bf16_f32 v252, v228, v229
  v_pk_mul_f32 v[230:231], v[230:231], v[236:237]
  v_cvt_pk_bf16_f32 v253, v230, v231
  ds_write_b128 v9, v[244:247] offset:0
  ds_write_b128 v9, v[248:251] offset:1024
  ds_write_b64 v9, v[252:253] offset:2048
  s_waitcnt lgkmcnt(0)
  v_add_f32 v240, v240, v10
  v_rcp_f32 v240, v240
  s_nop 0
  v_mov_b32 v241, v240
  v_pk_mul_f32 v[200:201], v[200:201], v[240:241]
  v_cvt_pk_bf16_f32 v244, v200, v201
  v_pk_mul_f32 v[202:203], v[202:203], v[240:241]
  v_cvt_pk_bf16_f32 v245, v202, v203
  v_pk_mul_f32 v[208:209], v[208:209], v[240:241]
  v_cvt_pk_bf16_f32 v246, v208, v209
  v_pk_mul_f32 v[210:211], v[210:211], v[240:241]
  v_cvt_pk_bf16_f32 v247, v210, v211
  v_pk_mul_f32 v[216:217], v[216:217], v[240:241]
  v_cvt_pk_bf16_f32 v248, v216, v217
  v_pk_mul_f32 v[218:219], v[218:219], v[240:241]
  v_cvt_pk_bf16_f32 v249, v218, v219
  v_pk_mul_f32 v[224:225], v[224:225], v[240:241]
  v_cvt_pk_bf16_f32 v250, v224, v225
  v_pk_mul_f32 v[226:227], v[226:227], v[240:241]
  v_cvt_pk_bf16_f32 v251, v226, v227
  v_pk_mul_f32 v[232:233], v[232:233], v[240:241]
  v_cvt_pk_bf16_f32 v252, v232, v233
  v_pk_mul_f32 v[234:235], v[234:235], v[240:241]
  v_cvt_pk_bf16_f32 v253, v234, v235
  ds_write_b128 v9, v[244:247] offset:20480
  ds_write_b128 v9, v[248:251] offset:21504
  ds_write_b64 v9, v[252:253] offset:22528
  s_waitcnt lgkmcnt(0)
  s_waitcnt vmcnt(8)
  s_waitcnt lgkmcnt(5)
  v_mfma_f32_16x16x32_bf16 v[196:199], v[136:139], v[76:79], 0
  v_mfma_f32_16x16x32_bf16 v[200:203], v[136:139], v[116:119], 0
  v_mfma_f32_16x16x32_bf16 v[196:199], v[140:143], v[80:83], v[196:199]
  v_mfma_f32_16x16x32_bf16 v[200:203], v[140:143], v[120:123], v[200:203]
  v_mfma_f32_16x16x32_bf16 v[196:199], v[144:147], v[84:87], v[196:199]
  v_mfma_f32_16x16x32_bf16 v[200:203], v[144:147], v[124:127], v[200:203]
  v_mfma_f32_16x16x32_bf16 v[196:199], v[148:151], v[88:91], v[196:199]
  v_mfma_f32_16x16x32_bf16 v[200:203], v[148:151], v[128:131], v[200:203]
  v_mfma_f32_16x16x32_bf16 v[196:199], v[152:155], v[92:95], v[196:199]
  v_mfma_f32_16x16x32_bf16 v[200:203], v[152:155], v[132:135], v[200:203]
  s_mov_b64 exec, s[20:21]
  ds_read_b128 v[136:139], v7 offset:11520
  ds_read_b128 v[140:143], v7 offset:11776
  ds_read_b128 v[144:147], v7 offset:12032
  ds_read_b128 v[148:151], v7 offset:12288
  ds_read_b128 v[152:155], v7 offset:12544
  s_mov_b64 exec, -1
  s_waitcnt lgkmcnt(10)
  v_mfma_f32_16x16x32_bf16 v[204:207], v[156:159], v[76:79], 0
  v_mfma_f32_16x16x32_bf16 v[208:211], v[156:159], v[116:119], 0
  v_mfma_f32_16x16x32_bf16 v[204:207], v[160:163], v[80:83], v[204:207]
  v_mfma_f32_16x16x32_bf16 v[208:211], v[160:163], v[120:123], v[208:211]
  v_mfma_f32_16x16x32_bf16 v[204:207], v[164:167], v[84:87], v[204:207]
  v_mfma_f32_16x16x32_bf16 v[208:211], v[164:167], v[124:127], v[208:211]
  v_mfma_f32_16x16x32_bf16 v[204:207], v[168:171], v[88:91], v[204:207]
  v_mfma_f32_16x16x32_bf16 v[208:211], v[168:171], v[128:131], v[208:211]
  v_mfma_f32_16x16x32_bf16 v[204:207], v[172:175], v[92:95], v[204:207]
  v_mfma_f32_16x16x32_bf16 v[208:211], v[172:175], v[132:135], v[208:211]
  s_mov_b64 exec, s[20:21]
  ds_read_b128 v[156:159], v7 offset:12800
  ds_read_b128 v[160:163], v7 offset:13056
  ds_read_b128 v[164:167], v7 offset:13312
  ds_read_b128 v[168:171], v7 offset:13568
  ds_read_b128 v[172:175], v7 offset:13824
  s_mov_b64 exec, -1
  s_waitcnt lgkmcnt(10)
  v_mfma_f32_16x16x32_bf16 v[212:215], v[176:179], v[76:79], 0
  v_mfma_f32_16x16x32_bf16 v[216:219], v[176:179], v[116:119], 0
  v_mfma_f32_16x16x32_bf16 v[212:215], v[180:183], v[80:83], v[212:215]
  v_mfma_f32_16x16x32_bf16 v[216:219], v[180:183], v[120:123], v[216:219]
  v_mfma_f32_16x16x32_bf16 v[212:215], v[184:187], v[84:87], v[212:215]
  v_mfma_f32_16x16x32_bf16 v[216:219], v[184:187], v[124:127], v[216:219]
  v_mfma_f32_16x16x32_bf16 v[212:215], v[188:191], v[88:91], v[212:215]
  v_mfma_f32_16x16x32_bf16 v[216:219], v[188:191], v[128:131], v[216:219]
  v_mfma_f32_16x16x32_bf16 v[212:215], v[192:195], v[92:95], v[212:215]
  v_mfma_f32_16x16x32_bf16 v[216:219], v[192:195], v[132:135], v[216:219]
  s_mov_b64 exec, s[20:21]
  ds_read_b128 v[176:179], v7 offset:14080
  ds_read_b128 v[180:183], v7 offset:14336
  ds_read_b128 v[184:187], v7 offset:14592
  ds_read_b128 v[188:191], v7 offset:14848
  ds_read_b128 v[192:195], v7 offset:15104
  s_mov_b64 exec, -1
  s_waitcnt lgkmcnt(10)
  v_mfma_f32_16x16x32_bf16 v[220:223], v[136:139], v[76:79], 0
  v_mfma_f32_16x16x32_bf16 v[224:227], v[136:139], v[116:119], 0
  v_mfma_f32_16x16x32_bf16 v[220:223], v[140:143], v[80:83], v[220:223]
  v_mfma_f32_16x16x32_bf16 v[224:227], v[140:143], v[120:123], v[224:227]
  v_mfma_f32_16x16x32_bf16 v[220:223], v[144:147], v[84:87], v[220:223]
  v_mfma_f32_16x16x32_bf16 v[224:227], v[144:147], v[124:127], v[224:227]
  v_mfma_f32_16x16x32_bf16 v[220:223], v[148:151], v[88:91], v[220:223]
  v_mfma_f32_16x16x32_bf16 v[224:227], v[148:151], v[128:131], v[224:227]
  v_mfma_f32_16x16x32_bf16 v[220:223], v[152:155], v[92:95], v[220:223]
  v_mfma_f32_16x16x32_bf16 v[224:227], v[152:155], v[132:135], v[224:227]
  s_waitcnt lgkmcnt(5)
  v_mfma_f32_16x16x32_bf16 v[228:231], v[156:159], v[76:79], 0
  v_mfma_f32_16x16x32_bf16 v[232:235], v[156:159], v[116:119], 0
  v_mfma_f32_16x16x32_bf16 v[228:231], v[160:163], v[80:83], v[228:231]
  v_mfma_f32_16x16x32_bf16 v[232:235], v[160:163], v[120:123], v[232:235]
  v_mfma_f32_16x16x32_bf16 v[228:231], v[164:167], v[84:87], v[228:231]
  v_mfma_f32_16x16x32_bf16 v[232:235], v[164:167], v[124:127], v[232:235]
  v_mfma_f32_16x16x32_bf16 v[228:231], v[168:171], v[88:91], v[228:231]
  v_mfma_f32_16x16x32_bf16 v[232:235], v[168:171], v[128:131], v[232:235]
  v_mfma_f32_16x16x32_bf16 v[228:231], v[172:175], v[92:95], v[228:231]
  v_mfma_f32_16x16x32_bf16 v[232:235], v[172:175], v[132:135], v[232:235]
  s_waitcnt lgkmcnt(0)
  v_mfma_f32_16x16x32_bf16 v[236:239], v[176:179], v[76:79], 0
  v_mfma_f32_16x16x32_bf16 v[240:243], v[176:179], v[116:119], 0
  v_mfma_f32_16x16x32_bf16 v[236:239], v[180:183], v[80:83], v[236:239]
  v_mfma_f32_16x16x32_bf16 v[240:243], v[180:183], v[120:123], v[240:243]
  v_mfma_f32_16x16x32_bf16 v[236:239], v[184:187], v[84:87], v[236:239]
  v_mfma_f32_16x16x32_bf16 v[240:243], v[184:187], v[124:127], v[240:243]
  v_mfma_f32_16x16x32_bf16 v[236:239], v[188:191], v[88:91], v[236:239]
  v_mfma_f32_16x16x32_bf16 v[240:243], v[188:191], v[128:131], v[240:243]
  v_mfma_f32_16x16x32_bf16 v[236:239], v[192:195], v[92:95], v[236:239]
  v_mfma_f32_16x16x32_bf16 v[240:243], v[192:195], v[132:135], v[240:243]
  s_nop 4
  v_add_f32 v236, v236, v10
  v_rcp_f32 v236, v236
  s_nop 0
  v_mov_b32 v237, v236
  v_pk_mul_f32 v[196:197], v[196:197], v[236:237]
  v_cvt_pk_bf16_f32 v246, v196, v197
  v_pk_mul_f32 v[198:199], v[198:199], v[236:237]
  v_cvt_pk_bf16_f32 v247, v198, v199
  v_pk_mul_f32 v[204:205], v[204:205], v[236:237]
  v_cvt_pk_bf16_f32 v248, v204, v205
  v_pk_mul_f32 v[206:207], v[206:207], v[236:237]
  v_cvt_pk_bf16_f32 v249, v206, v207
  v_pk_mul_f32 v[212:213], v[212:213], v[236:237]
  v_cvt_pk_bf16_f32 v250, v212, v213
  v_pk_mul_f32 v[214:215], v[214:215], v[236:237]
  v_cvt_pk_bf16_f32 v251, v214, v215
  v_pk_mul_f32 v[220:221], v[220:221], v[236:237]
  v_cvt_pk_bf16_f32 v252, v220, v221
  v_pk_mul_f32 v[222:223], v[222:223], v[236:237]
  v_cvt_pk_bf16_f32 v253, v222, v223
  v_pk_mul_f32 v[228:229], v[228:229], v[236:237]
  v_cvt_pk_bf16_f32 v254, v228, v229
  v_pk_mul_f32 v[230:231], v[230:231], v[236:237]
  v_cvt_pk_bf16_f32 v255, v230, v231
  ds_write_b64 v9, v[246:247] offset:2056
  ds_write_b128 v9, v[248:251] offset:3072
  ds_write_b128 v9, v[252:255] offset:4096
  s_waitcnt lgkmcnt(0)
  v_add_f32 v240, v240, v10
  v_rcp_f32 v240, v240
  s_nop 0
  v_mov_b32 v241, v240
  v_pk_mul_f32 v[200:201], v[200:201], v[240:241]
  v_cvt_pk_bf16_f32 v246, v200, v201
  v_pk_mul_f32 v[202:203], v[202:203], v[240:241]
  v_cvt_pk_bf16_f32 v247, v202, v203
  v_pk_mul_f32 v[208:209], v[208:209], v[240:241]
  v_cvt_pk_bf16_f32 v248, v208, v209
  v_pk_mul_f32 v[210:211], v[210:211], v[240:241]
  v_cvt_pk_bf16_f32 v249, v210, v211
  v_pk_mul_f32 v[216:217], v[216:217], v[240:241]
  v_cvt_pk_bf16_f32 v250, v216, v217
  v_pk_mul_f32 v[218:219], v[218:219], v[240:241]
  v_cvt_pk_bf16_f32 v251, v218, v219
  v_pk_mul_f32 v[224:225], v[224:225], v[240:241]
  v_cvt_pk_bf16_f32 v252, v224, v225
  v_pk_mul_f32 v[226:227], v[226:227], v[240:241]
  v_cvt_pk_bf16_f32 v253, v226, v227
  v_pk_mul_f32 v[232:233], v[232:233], v[240:241]
  v_cvt_pk_bf16_f32 v254, v232, v233
  v_pk_mul_f32 v[234:235], v[234:235], v[240:241]
  v_cvt_pk_bf16_f32 v255, v234, v235
  ds_write_b64 v9, v[246:247] offset:22536
  ds_write_b128 v9, v[248:251] offset:23552
  ds_write_b128 v9, v[252:255] offset:24576
  s_waitcnt lgkmcnt(0)
  s_branch b2f_kernel_ph2b
b2f_kernel_ph2:
  buffer_load_dwordx4 v[24:27], v2, s[4:7], s14 offen
  buffer_load_dwordx4 v[28:31], v3, s[4:7], s14 offen
  s_add_u32 s14, s14, 1024
  buffer_load_dwordx4 v[32:35], v2, s[4:7], s14 offen
  buffer_load_dwordx4 v[36:39], v3, s[4:7], s14 offen
  s_add_u32 s14, s14, 1024
  buffer_load_dwordx4 v[40:43], v2, s[4:7], s14 offen
  buffer_load_dwordx4 v[44:47], v3, s[4:7], s14 offen
  s_add_u32 s14, s14, 1024
  buffer_load_dwordx4 v[48:51], v2, s[4:7], s14 offen
  buffer_load_dwordx4 v[52:55], v3, s[4:7], s14 offen
  s_add_u32 s14, s14, 1024
b2f_kernel_ph2b:
  buffer_load_dwordx4 v[56:59], v2, s[4:7], s14 offen
  buffer_load_dwordx4 v[60:63], v3, s[4:7], s14 offen
  s_add_u32 s14, s14, 1024
  buffer_load_dwordx4 v[64:67], v2, s[4:7], s14 offen
  buffer_load_dwordx4 v[68:71], v3, s[4:7], s14 offen
  s_add_u32 s14, s14, 1024
  buffer_load_dwordx4 v[72:75], v2, s[4:7], s14 offen
  buffer_load_dwordx4 v[76:79], v3, s[4:7], s14 offen
  s_add_u32 s14, s14, 1024
  buffer_load_dwordx4 v[80:83], v2, s[4:7], s14 offen
  buffer_load_dwordx4 v[84:87], v3, s[4:7], s14 offen
  s_add_u32 s14, s14, 1024
  buffer_load_dwordx4 v[88:91], v2, s[4:7], s14 offen
  buffer_load_dwordx4 v[92:95], v3, s[4:7], s14 offen
  s_add_u32 s14, s14, 1024
  buffer_load_dwordx4 v[96:99], v2, s[4:7], s14 offen
  buffer_load_dwordx4 v[100:103], v3, s[4:7], s14 offen
  s_add_u32 s14, s14, 1024
  buffer_load_dwordx4 v[16:19], v2, s[4:7], s12 offen
  buffer_load_dwordx4 v[20:23], v3, s[4:7], s12 offen
  s_barrier
  ds_read_b128 v[136:139], v2 offset:0
  ds_read_b128 v[140:143], v3 offset:0
  ds_read_b128 v[144:147], v2 offset:1024
  ds_read_b128 v[148:151], v3 offset:1024
  ds_read_b128 v[152:155], v2 offset:2048
  ds_read_b128 v[156:159], v3 offset:2048
  s_waitcnt vmcnt(20) lgkmcnt(4)
  v_mfma_f32_16x16x32_bf16 v[168:171], v[24:27], v[136:139], 0
  v_mfma_f32_16x16x32_bf16 v[176:179], v[24:27], v[140:143], 0
  v_mfma_f32_16x16x32_bf16 v[172:175], v[28:31], v[136:139], 0
  v_mfma_f32_16x16x32_bf16 v[180:183], v[28:31], v[140:143], 0
  buffer_load_dwordx4 v[24:27], v2, s[4:7], s14 offen
  buffer_load_dwordx4 v[28:31], v3, s[4:7], s14 offen
  s_add_u32 s14, s14, 1024
  ds_read_b128 v[160:163], v2 offset:3072
  ds_read_b128 v[164:167], v3 offset:3072
  s_waitcnt vmcnt(20) lgkmcnt(4)
  v_mfma_f32_16x16x32_bf16 v[168:171], v[32:35], v[144:147], v[168:171]
  v_mfma_f32_16x16x32_bf16 v[176:179], v[32:35], v[148:151], v[176:179]
  v_mfma_f32_16x16x32_bf16 v[172:175], v[36:39], v[144:147], v[172:175]
  v_mfma_f32_16x16x32_bf16 v[180:183], v[36:39], v[148:151], v[180:183]
  buffer_load_dwordx4 v[32:35], v2, s[4:7], s14 offen
  buffer_load_dwordx4 v[36:39], v3, s[4:7], s14 offen
  s_add_u32 s14, s14, 1024
  ds_read_b128 v[136:139], v2 offset:4096
  ds_read_b128 v[140:143], v3 offset:4096
  s_waitcnt vmcnt(20) lgkmcnt(4)
  v_mfma_f32_16x16x32_bf16 v[168:171], v[40:43], v[152:155], v[168:171]
  v_mfma_f32_16x16x32_bf16 v[176:179], v[40:43], v[156:159], v[176:179]
  v_mfma_f32_16x16x32_bf16 v[172:175], v[44:47], v[152:155], v[172:175]
  v_mfma_f32_16x16x32_bf16 v[180:183], v[44:47], v[156:159], v[180:183]
  buffer_load_dwordx4 v[40:43], v2, s[4:7], s14 offen
  buffer_load_dwordx4 v[44:47], v3, s[4:7], s14 offen
  s_add_u32 s14, s14, 1024
  ds_read_b128 v[144:147], v2 offset:5120
  ds_read_b128 v[148:151], v3 offset:5120
  s_waitcnt vmcnt(20) lgkmcnt(4)
  v_mfma_f32_16x16x32_bf16 v[168:171], v[48:51], v[160:163], v[168:171]
  v_mfma_f32_16x16x32_bf16 v[176:179], v[48:51], v[164:167], v[176:179]
  v_mfma_f32_16x16x32_bf16 v[172:175], v[52:55], v[160:163], v[172:175]
  v_mfma_f32_16x16x32_bf16 v[180:183], v[52:55], v[164:167], v[180:183]
  buffer_load_dwordx4 v[48:51], v2, s[4:7], s14 offen
  buffer_load_dwordx4 v[52:55], v3, s[4:7], s14 offen
  s_add_u32 s14, s14, 1024
  ds_read_b128 v[152:155], v2 offset:6144
  ds_read_b128 v[156:159], v3 offset:6144
  s_waitcnt vmcnt(20) lgkmcnt(4)
  v_mfma_f32_16x16x32_bf16 v[168:171], v[56:59], v[136:139], v[168:171]
  v_mfma_f32_16x16x32_bf16 v[176:179], v[56:59], v[140:143], v[176:179]
  v_mfma_f32_16x16x32_bf16 v[172:175], v[60:63], v[136:139], v[172:175]
  v_mfma_f32_16x16x32_bf16 v[180:183], v[60:63], v[140:143], v[180:183]
  buffer_load_dwordx4 v[56:59], v2, s[4:7], s14 offen
  buffer_load_dwordx4 v[60:63], v3, s[4:7], s14 offen
  s_add_u32 s14, s14, 1024
  ds_read_b128 v[160:163], v2 offset:7168
  ds_read_b128 v[164:167], v3 offset:7168
  s_waitcnt vmcnt(20) lgkmcnt(4)
  v_mfma_f32_16x16x32_bf16 v[168:171], v[64:67], v[144:147], v[168:171]
  v_mfma_f32_16x16x32_bf16 v[176:179], v[64:67], v[148:151], v[176:179]
  v_mfma_f32_16x16x32_bf16 v[172:175], v[68:71], v[144:147], v[172:175]
  v_mfma_f32_16x16x32_bf16 v[180:183], v[68:71], v[148:151], v[180:183]
  buffer_load_dwordx4 v[64:67], v2, s[4:7], s14 offen
  buffer_load_dwordx4 v[68:71], v3, s[4:7], s14 offen
  s_add_u32 s14, s14, 1024
  ds_read_b128 v[136:139], v2 offset:8192
  ds_read_b128 v[140:143], v3 offset:8192
  s_waitcnt vmcnt(20) lgkmcnt(4)
  v_mfma_f32_16x16x32_bf16 v[168:171], v[72:75], v[152:155], v[168:171]
  v_mfma_f32_16x16x32_bf16 v[176:179], v[72:75], v[156:159], v[176:179]
  v_mfma_f32_16x16x32_bf16 v[172:175], v[76:79], v[152:155], v[172:175]
  v_mfma_f32_16x16x32_bf16 v[180:183], v[76:79], v[156:159], v[180:183]
  buffer_load_dwordx4 v[72:75], v2, s[4:7], s14 offen
  buffer_load_dwordx4 v[76:79], v3, s[4:7], s14 offen
  s_add_u32 s14, s14, 1024
  ds_read_b128 v[144:147], v2 offset:9216
  ds_read_b128 v[148:151], v3 offset:9216
  s_waitcnt vmcnt(20) lgkmcnt(4)
  v_mfma_f32_16x16x32_bf16 v[168:171], v[80:83], v[160:163], v[168:171]
  v_mfma_f32_16x16x32_bf16 v[176:179], v[80:83], v[164:167], v[176:179]
  v_mfma_f32_16x16x32_bf16 v[172:175], v[84:87], v[160:163], v[172:175]
  v_mfma_f32_16x16x32_bf16 v[180:183], v[84:87], v[164:167], v[180:183]
  buffer_load_dwordx4 v[80:83], v2, s[4:7], s14 offen
  buffer_load_dwordx4 v[84:87], v3, s[4:7], s14 offen
  s_add_u32 s14, s14, 1024
  ds_read_b128 v[152:155], v2 offset:10240
  ds_read_b128 v[156:159], v3 offset:10240
  s_waitcnt vmcnt(20) lgkmcnt(4)
  v_mfma_f32_16x16x32_bf16 v[168:171], v[88:91], v[136:139], v[168:171]
  v_mfma_f32_16x16x32_bf16 v[176:179], v[88:91], v[140:143], v[176:179]
  v_mfma_f32_16x16x32_bf16 v[172:175], v[92:95], v[136:139], v[172:175]
  v_mfma_f32_16x16x32_bf16 v[180:183], v[92:95], v[140:143], v[180:183]
  buffer_load_dwordx4 v[88:91], v2, s[4:7], s14 offen
  buffer_load_dwordx4 v[92:95], v3, s[4:7], s14 offen
  s_add_u32 s14, s14, 1024
  ds_read_b128 v[160:163], v2 offset:11264
  ds_read_b128 v[164:167], v3 offset:11264
  s_waitcnt vmcnt(20) lgkmcnt(4)
  v_mfma_f32_16x16x32_bf16 v[168:171], v[96:99], v[144:147], v[168:171]
  v_mfma_f32_16x16x32_bf16 v[176:179], v[96:99], v[148:151], v[176:179]
  v_mfma_f32_16x16x32_bf16 v[172:175], v[100:103], v[144:147], v[172:175]
  v_mfma_f32_16x16x32_bf16 v[180:183], v[100:103], v[148:151], v[180:183]
  buffer_load_dwordx4 v[96:99], v2, s[4:7], s14 offen
  buffer_load_dwordx4 v[100:103], v3, s[4:7], s14 offen
  s_add_u32 s14, s14, 1024
  ds_read_b128 v[136:139], v2 offset:12288
  ds_read_b128 v[140:143], v3 offset:12288
  s_waitcnt vmcnt(18) lgkmcnt(4)
  v_mfma_f32_16x16x32_bf16 v[168:171], v[24:27], v[152:155], v[168:171]
  v_mfma_f32_16x16x32_bf16 v[176:179], v[24:27], v[156:159], v[176:179]
  v_mfma_f32_16x16x32_bf16 v[172:175], v[28:31], v[152:155], v[172:175]
  v_mfma_f32_16x16x32_bf16 v[180:183], v[28:31], v[156:159], v[180:183]
  ds_read_b128 v[144:147], v2 offset:13312
  ds_read_b128 v[148:151], v3 offset:13312
  s_waitcnt vmcnt(16) lgkmcnt(4)
  v_mfma_f32_16x16x32_bf16 v[168:171], v[32:35], v[160:163], v[168:171]
  v_mfma_f32_16x16x32_bf16 v[176:179], v[32:35], v[164:167], v[176:179]
  v_mfma_f32_16x16x32_bf16 v[172:175], v[36:39], v[160:163], v[172:175]
  v_mfma_f32_16x16x32_bf16 v[180:183], v[36:39], v[164:167], v[180:183]
  ds_read_b128 v[152:155], v2 offset:14336
  ds_read_b128 v[156:159], v3 offset:14336
  s_waitcnt vmcnt(14) lgkmcnt(4)
  v_mfma_f32_16x16x32_bf16 v[168:171], v[40:43], v[136:139], v[168:171]
  v_mfma_f32_16x16x32_bf16 v[176:179], v[40:43], v[140:143], v[176:179]
  v_mfma_f32_16x16x32_bf16 v[172:175], v[44:47], v[136:139], v[172:175]
  v_mfma_f32_16x16x32_bf16 v[180:183], v[44:47], v[140:143], v[180:183]
  ds_read_b128 v[160:163], v2 offset:15360
  ds_read_b128 v[164:167], v3 offset:15360
  s_waitcnt vmcnt(12) lgkmcnt(4)
  v_mfma_f32_16x16x32_bf16 v[168:171], v[48:51], v[144:147], v[168:171]
  v_mfma_f32_16x16x32_bf16 v[176:179], v[48:51], v[148:151], v[176:179]
  v_mfma_f32_16x16x32_bf16 v[172:175], v[52:55], v[144:147], v[172:175]
  v_mfma_f32_16x16x32_bf16 v[180:183], v[52:55], v[148:151], v[180:183]
  ds_read_b128 v[136:139], v2 offset:16384
  ds_read_b128 v[140:143], v3 offset:16384
  s_waitcnt vmcnt(10) lgkmcnt(4)
  v_mfma_f32_16x16x32_bf16 v[168:171], v[56:59], v[152:155], v[168:171]
  v_mfma_f32_16x16x32_bf16 v[176:179], v[56:59], v[156:159], v[176:179]
  v_mfma_f32_16x16x32_bf16 v[172:175], v[60:63], v[152:155], v[172:175]
  v_mfma_f32_16x16x32_bf16 v[180:183], v[60:63], v[156:159], v[180:183]
  ds_read_b128 v[144:147], v2 offset:17408
  ds_read_b128 v[148:151], v3 offset:17408
  s_waitcnt vmcnt(8) lgkmcnt(4)
  v_mfma_f32_16x16x32_bf16 v[168:171], v[64:67], v[160:163], v[168:171]
  v_mfma_f32_16x16x32_bf16 v[176:179], v[64:67], v[164:167], v[176:179]
  v_mfma_f32_16x16x32_bf16 v[172:175], v[68:71], v[160:163], v[172:175]
  v_mfma_f32_16x16x32_bf16 v[180:183], v[68:71], v[164:167], v[180:183]
  ds_read_b128 v[152:155], v2 offset:18432
  ds_read_b128 v[156:159], v3 offset:18432
  s_waitcnt vmcnt(6) lgkmcnt(4)
  v_mfma_f32_16x16x32_bf16 v[168:171], v[72:75], v[136:139], v[168:171]
  v_mfma_f32_16x16x32_bf16 v[176:179], v[72:75], v[140:143], v[176:179]
  v_mfma_f32_16x16x32_bf16 v[172:175], v[76:79], v[136:139], v[172:175]
  v_mfma_f32_16x16x32_bf16 v[180:183], v[76:79], v[140:143], v[180:183]
  ds_read_b128 v[160:163], v2 offset:19456
  ds_read_b128 v[164:167], v3 offset:19456
  s_waitcnt vmcnt(4) lgkmcnt(4)
  v_mfma_f32_16x16x32_bf16 v[168:171], v[80:83], v[144:147], v[168:171]
  v_mfma_f32_16x16x32_bf16 v[176:179], v[80:83], v[148:151], v[176:179]
  v_mfma_f32_16x16x32_bf16 v[172:175], v[84:87], v[144:147], v[172:175]
  v_mfma_f32_16x16x32_bf16 v[180:183], v[84:87], v[148:151], v[180:183]
  s_waitcnt vmcnt(2) lgkmcnt(2)
  v_mfma_f32_16x16x32_bf16 v[168:171], v[88:91], v[152:155], v[168:171]
  v_mfma_f32_16x16x32_bf16 v[176:179], v[88:91], v[156:159], v[176:179]
  v_mfma_f32_16x16x32_bf16 v[172:175], v[92:95], v[152:155], v[172:175]
  v_mfma_f32_16x16x32_bf16 v[180:183], v[92:95], v[156:159], v[180:183]
  s_waitcnt vmcnt(0) lgkmcnt(0)
  v_mfma_f32_16x16x32_bf16 v[168:171], v[96:99], v[160:163], v[168:171]
  v_mfma_f32_16x16x32_bf16 v[176:179], v[96:99], v[164:167], v[176:179]
  v_mfma_f32_16x16x32_bf16 v[172:175], v[100:103], v[160:163], v[172:175]
  v_mfma_f32_16x16x32_bf16 v[180:183], v[100:103], v[164:167], v[180:183]
  s_mov_b32 s23, 0xffff0000
  v_lshlrev_b32 v10, 16, v16
  v_and_b32 v11, s23, v16
  v_pk_add_f32 v[168:169], v[168:169], v[10:11]
  v_cvt_pk_bf16_f32 v16, v168, v169
  v_lshlrev_b32 v10, 16, v17
  v_and_b32 v11, s23, v17
  v_pk_add_f32 v[170:171], v[170:171], v[10:11]
  v_cvt_pk_bf16_f32 v17, v170, v171
  v_lshlrev_b32 v10, 16, v18
  v_and_b32 v11, s23, v18
  v_pk_add_f32 v[172:173], v[172:173], v[10:11]
  v_cvt_pk_bf16_f32 v18, v172, v173
  v_lshlrev_b32 v10, 16, v19
  v_and_b32 v11, s23, v19
  v_pk_add_f32 v[174:175], v[174:175], v[10:11]
  v_cvt_pk_bf16_f32 v19, v174, v175
  v_lshlrev_b32 v10, 16, v20
  v_and_b32 v11, s23, v20
  v_pk_add_f32 v[176:177], v[176:177], v[10:11]
  v_cvt_pk_bf16_f32 v20, v176, v177
  v_lshlrev_b32 v10, 16, v21
  v_and_b32 v11, s23, v21
  v_pk_add_f32 v[178:179], v[178:179], v[10:11]
  v_cvt_pk_bf16_f32 v21, v178, v179
  v_lshlrev_b32 v10, 16, v22
  v_and_b32 v11, s23, v22
  v_pk_add_f32 v[180:181], v[180:181], v[10:11]
  v_cvt_pk_bf16_f32 v22, v180, v181
  v_lshlrev_b32 v10, 16, v23
  v_and_b32 v11, s23, v23
  v_pk_add_f32 v[182:183], v[182:183], v[10:11]
  v_cvt_pk_bf16_f32 v23, v182, v183
  s_add_u32 s12, s11, 20480
  buffer_store_dwordx4 v[16:19], v6, s[24:27], s11 offen
  buffer_store_dwordx4 v[20:23], v6, s[24:27], s12 offen
b2f_kernel_end:
  s_endpgm

.section .rodata,"a"
.p2align 6
.amdhsa_kernel prep_kernel
  .amdhsa_next_free_vgpr 248
  .amdhsa_next_free_sgpr 44
  .amdhsa_accum_offset 128
  .amdhsa_group_segment_fixed_size 0
  .amdhsa_kernarg_size 112
  .amdhsa_user_sgpr_count 2
  .amdhsa_user_sgpr_kernarg_segment_ptr 1
  .amdhsa_system_sgpr_workgroup_id_x 1
  .amdhsa_float_denorm_mode_32 3
.end_amdhsa_kernel
.text

.section .rodata,"a"
.p2align 6
.amdhsa_kernel mega0_kernel
  .amdhsa_next_free_vgpr 512
  .amdhsa_next_free_sgpr 100
  .amdhsa_accum_offset 256
  .amdhsa_group_segment_fixed_size 0
  .amdhsa_kernarg_size 112
  .amdhsa_user_sgpr_count 2
  .amdhsa_user_sgpr_kernarg_segment_ptr 1
  .amdhsa_system_sgpr_workgroup_id_x 1
  .amdhsa_float_denorm_mode_32 3
.end_amdhsa_kernel
.text

.section .rodata,"a"
.p2align 6
.amdhsa_kernel mega1_kernel
  .amdhsa_next_free_vgpr 512
  .amdhsa_next_free_sgpr 100
  .amdhsa_accum_offset 256
  .amdhsa_group_segment_fixed_size 0
  .amdhsa_kernarg_size 112
  .amdhsa_user_sgpr_count 2
  .amdhsa_user_sgpr_kernarg_segment_ptr 1
  .amdhsa_system_sgpr_workgroup_id_x 1
  .amdhsa_float_denorm_mode_32 3
.end_amdhsa_kernel
.text

.section .rodata,"a"
.p2align 6
.amdhsa_kernel b1_kernel
  .amdhsa_next_free_vgpr 256
  .amdhsa_next_free_sgpr 32
  .amdhsa_accum_offset 256
  .amdhsa_group_segment_fixed_size 0
  .amdhsa_kernarg_size 112
  .amdhsa_user_sgpr_count 2
  .amdhsa_user_sgpr_kernarg_segment_ptr 1
  .amdhsa_system_sgpr_workgroup_id_x 1
  .amdhsa_float_denorm_mode_32 3
.end_amdhsa_kernel
.text

.section .rodata,"a"
.p2align 6
.amdhsa_kernel bred_kernel
  .amdhsa_next_free_vgpr 48
  .amdhsa_next_free_sgpr 16
  .amdhsa_accum_offset 48
  .amdhsa_group_segment_fixed_size 0
  .amdhsa_kernarg_size 112
  .amdhsa_user_sgpr_count 2
  .amdhsa_user_sgpr_kernarg_segment_ptr 1
  .amdhsa_system_sgpr_workgroup_id_x 1
  .amdhsa_float_denorm_mode_32 3
.end_amdhsa_kernel
.text

.section .rodata,"a"
.p2align 6
.amdhsa_kernel b2_kernel
  .amdhsa_next_free_vgpr 256
  .amdhsa_next_free_sgpr 28
  .amdhsa_accum_offset 256
  .amdhsa_group_segment_fixed_size 0
  .amdhsa_kernarg_size 112
  .amdhsa_user_sgpr_count 2
  .amdhsa_user_sgpr_kernarg_segment_ptr 1
  .amdhsa_system_sgpr_workgroup_id_x 1
  .amdhsa_float_denorm_mode_32 3
.end_amdhsa_kernel
.text

.section .rodata,"a"
.p2align 6
.amdhsa_kernel b2f_kernel
  .amdhsa_next_free_vgpr 256
  .amdhsa_next_free_sgpr 28
  .amdhsa_accum_offset 256
  .amdhsa_group_segment_fixed_size 0
  .amdhsa_kernarg_size 112
  .amdhsa_user_sgpr_count 2
  .amdhsa_user_sgpr_kernarg_segment_ptr 1
  .amdhsa_system_sgpr_workgroup_id_x 1
  .amdhsa_float_denorm_mode_32 3
.end_amdhsa_kernel
.text
```

```asm
; @launch kernel=mega_kernel grid=(256,1,1) block=(256,1,1) lds=163840
.amdgcn_target "amdgcn-amd-amdhsa--gfx950"
.text
.globl mega_kernel
.p2align 8
.type mega_kernel,@function
mega_kernel:
  s_mov_b32 s70, 0
mega_common:
  s_load_dwordx2 s[4:5], s[0:1], 104
  s_mov_b32 s6, 0x10000000
  s_mov_b32 s7, 0x20000
  s_load_dwordx2 s[44:45], s[0:1], 96
  s_mov_b32 s46, 0x100
  s_mov_b32 s47, 0x20000
  s_load_dwordx2 s[84:85], s[0:1], 0
  s_mov_b32 s86, 0x280000
  s_mov_b32 s87, 0x20000
  s_load_dwordx8 s[8:15], s[0:1], 16
  s_mov_b32 s94, 0x780000
  s_mov_b32 s95, 0x20000
  s_mov_b32 s98, 0x780000
  s_mov_b32 s99, 0x20000
  s_mov_b32 s82, -1
  s_mov_b32 s83, 0x0fffffff
  v_lshrrev_b32 v1, 6, v0
  s_nop 0
  v_readfirstlane_b32 s3, v1
  v_and_b32 v1, 63, v0
  s_mov_b32 s79, s2
  s_cmp_ge_u32 s2, 256
  s_cbranch_scc1 mega_end
  s_mov_b32 s71, 53493760
  s_and_b32 s68, s2, 7
  s_waitcnt lgkmcnt(0)
  s_bfe_u32 s81, s2, 0x20005
  s_mov_b64 s[92:93], s[8:9]
  s_mov_b64 s[96:97], s[10:11]
  s_cmp_lt_u32 s2, 128
  s_cselect_b32 s16, 2, s81
  s_cmp_eq_u32 s16, 0
  s_cselect_b64 s[92:93], s[10:11], s[92:93]
  s_cmp_eq_u32 s16, 1
  s_cselect_b64 s[92:93], s[12:13], s[92:93]
  s_cmp_eq_u32 s16, 3
  s_cselect_b64 s[92:93], s[14:15], s[92:93]
  s_cmp_lt_u32 s2, 128
  s_cbranch_scc1 mega_rec
  s_lshl_b32 s8, s68, 2
  s_bfe_u32 s9, s2, 0x20003
  s_add_u32 s80, s8, s9
  s_mul_i32 s78, s68, 1302528
  s_add_u32 s78, s78, 5324800
  s_cmp_eq_u32 s81, 2
  s_cbranch_scc1 mega_qrole
  s_cmp_eq_u32 s81, 3
  s_cbranch_scc1 mega_urole
  s_lshl_b32 s9, s80, 2
  s_add_u32 s9, s9, s3
  s_cmp_lg_u32 s81, 0
  s_cbranch_scc1 mega_kv_go
  s_and_b32 s10, s9, 7
  s_cmp_lg_u32 s10, 0
  s_cbranch_scc1 mega_kv_noc
  s_lshr_b32 s10, s9, 3
  s_load_dwordx2 s[40:41], s[0:1], 8
  s_mov_b32 s42, 0x2800
  s_mov_b32 s43, 0x20000
  v_lshlrev_b32 v3, 4, v1
  v_mov_b32 v4, -1
  v_mov_b32 v5, -1
  v_mov_b32 v6, -1
  v_mov_b32 v7, -1
  v_bfe_u32 v2, v1, 2, 2
  v_and_b32 v48, 1, v1
  v_lshl_add_u32 v2, v2, 1, v48
  v_mul_u32_u24 v2, 1280, v2
  v_bfe_u32 v48, v1, 1, 1
  v_lshrrev_b32 v49, 4, v1
  v_lshl_add_u32 v50, v49, 1, v48
  v_mul_u32_u24 v50, 80, v50
  v_add_u32 v50, v50, v2
  v_lshl_add_u32 v2, v48, 4, v2
  v_and_b32 v48, 1, v49
  v_lshl_add_u32 v2, v48, 5, v2
  v_lshrrev_b32 v48, 1, v49
  v_mul_u32_u24 v48, 80, v48
  v_add_u32 v2, v2, v48
  s_waitcnt lgkmcnt(0)
  buffer_load_dwordx4 v[8:11], v2, s[40:43], 0 offen offset:0
  buffer_load_dwordx4 v[12:15], v2, s[40:43], 0 offen offset:160
  buffer_load_dwordx4 v[16:19], v2, s[40:43], 0 offen offset:320
  buffer_load_dwordx4 v[20:23], v2, s[40:43], 0 offen offset:480
  buffer_load_dwordx4 v[24:27], v2, s[40:43], 0 offen offset:640
  buffer_load_dwordx4 v[28:31], v2, s[40:43], 0 offen offset:800
  buffer_load_dwordx4 v[32:35], v2, s[40:43], 0 offen offset:960
  buffer_load_dwordx4 v[36:39], v2, s[40:43], 0 offen offset:1120
  buffer_load_dwordx4 v[40:43], v50, s[40:43], 0 offen offset:64
  buffer_load_dwordx4 v[44:47], v50, s[40:43], 0 offen offset:704
  s_mul_i32 s24, s10, 20480
  s_add_u32 s24, s24, 42090496
  s_add_u32 s25, s24, 10240
  s_waitcnt vmcnt(0)
  v_min_u32 v8, -2, v8
  v_min_u32 v9, -2, v9
  v_min_u32 v10, -2, v10
  v_min_u32 v11, -2, v11
  v_min_u32 v12, -2, v12
  v_min_u32 v13, -2, v13
  v_min_u32 v14, -2, v14
  v_min_u32 v15, -2, v15
  v_min_u32 v16, -2, v16
  v_min_u32 v17, -2, v17
  v_min_u32 v18, -2, v18
  v_min_u32 v19, -2, v19
  v_min_u32 v20, -2, v20
  v_min_u32 v21, -2, v21
  v_min_u32 v22, -2, v22
  v_min_u32 v23, -2, v23
  v_min_u32 v24, -2, v24
  v_min_u32 v25, -2, v25
  v_min_u32 v26, -2, v26
  v_min_u32 v27, -2, v27
  v_min_u32 v28, -2, v28
  v_min_u32 v29, -2, v29
  v_min_u32 v30, -2, v30
  v_min_u32 v31, -2, v31
  v_min_u32 v32, -2, v32
  v_min_u32 v33, -2, v33
  v_min_u32 v34, -2, v34
  v_min_u32 v35, -2, v35
  v_min_u32 v36, -2, v36
  v_min_u32 v37, -2, v37
  v_min_u32 v38, -2, v38
  v_min_u32 v39, -2, v39
  v_min_u32 v40, -2, v40
  v_min_u32 v41, -2, v41
  v_min_u32 v42, -2, v42
  v_min_u32 v43, -2, v43
  v_min_u32 v44, -2, v44
  v_min_u32 v45, -2, v45
  v_min_u32 v46, -2, v46
  v_min_u32 v47, -2, v47
  buffer_store_dwordx4 v[8:11], v3, s[4:7], s24 offen offset:0 sc1
  buffer_store_dwordx4 v[4:7], v3, s[4:7], s25 offen offset:0 sc1
  buffer_store_dwordx4 v[12:15], v3, s[4:7], s24 offen offset:1024 sc1
  buffer_store_dwordx4 v[4:7], v3, s[4:7], s25 offen offset:1024 sc1
  buffer_store_dwordx4 v[16:19], v3, s[4:7], s24 offen offset:2048 sc1
  buffer_store_dwordx4 v[4:7], v3, s[4:7], s25 offen offset:2048 sc1
  buffer_store_dwordx4 v[20:23], v3, s[4:7], s24 offen offset:3072 sc1
  buffer_store_dwordx4 v[4:7], v3, s[4:7], s25 offen offset:3072 sc1
  s_add_u32 s24, s24, 4096
  s_add_u32 s25, s25, 4096
  buffer_store_dwordx4 v[24:27], v3, s[4:7], s24 offen offset:0 sc1
  buffer_store_dwordx4 v[4:7], v3, s[4:7], s25 offen offset:0 sc1
  buffer_store_dwordx4 v[28:31], v3, s[4:7], s24 offen offset:1024 sc1
  buffer_store_dwordx4 v[4:7], v3, s[4:7], s25 offen offset:1024 sc1
  buffer_store_dwordx4 v[32:35], v3, s[4:7], s24 offen offset:2048 sc1
  buffer_store_dwordx4 v[4:7], v3, s[4:7], s25 offen offset:2048 sc1
  buffer_store_dwordx4 v[36:39], v3, s[4:7], s24 offen offset:3072 sc1
  buffer_store_dwordx4 v[4:7], v3, s[4:7], s25 offen offset:3072 sc1
  s_add_u32 s24, s24, 4096
  s_add_u32 s25, s25, 4096
  buffer_store_dwordx4 v[40:43], v3, s[4:7], s24 offen offset:0 sc1
  buffer_store_dwordx4 v[4:7], v3, s[4:7], s25 offen offset:0 sc1
  buffer_store_dwordx4 v[44:47], v3, s[4:7], s24 offen offset:1024 sc1
  buffer_store_dwordx4 v[4:7], v3, s[4:7], s25 offen offset:1024 sc1
mega_kv_noc:
  v_and_b32 v2, 15, v1
  v_lshrrev_b32 v3, 4, v1
  v_mul_u32_u24 v4, 1280, v3
  v_lshl_add_u32 v4, v2, 4, v4
  s_mul_i32 s20, s9, 10240
  s_add_u32 s21, s20, 5120
  buffer_load_dwordx4 v[100:103], v4, s[84:87], s20 offen offset:0
  buffer_load_dwordx4 v[104:107], v4, s[84:87], s20 offen offset:256
  buffer_load_dwordx4 v[108:111], v4, s[84:87], s20 offen offset:512
  buffer_load_dwordx4 v[112:115], v4, s[84:87], s20 offen offset:768
  buffer_load_dwordx4 v[116:119], v4, s[84:87], s20 offen offset:1024
  buffer_load_dwordx4 v[120:123], v4, s[84:87], s21 offen offset:0
  buffer_load_dwordx4 v[124:127], v4, s[84:87], s21 offen offset:256
  buffer_load_dwordx4 v[128:131], v4, s[84:87], s21 offen offset:512
  buffer_load_dwordx4 v[132:135], v4, s[84:87], s21 offen offset:768
  buffer_load_dwordx4 v[136:139], v4, s[84:87], s21 offen offset:1024
  v_lshrrev_b32 v5, 2, v2
  v_lshlrev_b32 v5, 10, v5
  v_and_b32 v6, 3, v2
  v_lshl_add_u32 v5, v6, 8, v5
  v_lshl_add_u32 v96, v3, 4, v5
  s_lshr_b32 s21, s9, 1
  s_mul_i32 s21, s21, 20480
  s_and_b32 s22, s9, 1
  s_lshl_b32 s22, s22, 7
  s_add_u32 s21, s21, s22
  s_add_u32 s21, s21, 0
  s_mov_b32 s30, 0xffff0000
  s_waitcnt vmcnt(0)
  s_mov_b32 s22, s21
  v_lshlrev_b32 v32, 16, v100
  v_and_b32 v33, s30, v100
  v_lshlrev_b32 v34, 16, v101
  v_and_b32 v35, s30, v101
  v_pk_add_f32 v[6:7], v[32:33], v[34:35]
  v_lshlrev_b32 v36, 16, v102
  v_and_b32 v37, s30, v102
  v_pk_add_f32 v[6:7], v[6:7], v[36:37]
  v_lshlrev_b32 v38, 16, v103
  v_and_b32 v39, s30, v103
  v_pk_add_f32 v[6:7], v[6:7], v[38:39]
  v_lshlrev_b32 v40, 16, v104
  v_and_b32 v41, s30, v104
  v_pk_add_f32 v[6:7], v[6:7], v[40:41]
  v_lshlrev_b32 v42, 16, v105
  v_and_b32 v43, s30, v105
  v_pk_add_f32 v[6:7], v[6:7], v[42:43]
  v_lshlrev_b32 v44, 16, v106
  v_and_b32 v45, s30, v106
  v_pk_add_f32 v[6:7], v[6:7], v[44:45]
  v_lshlrev_b32 v46, 16, v107
  v_and_b32 v47, s30, v107
  v_pk_add_f32 v[6:7], v[6:7], v[46:47]
  v_lshlrev_b32 v48, 16, v108
  v_and_b32 v49, s30, v108
  v_pk_add_f32 v[6:7], v[6:7], v[48:49]
  v_lshlrev_b32 v50, 16, v109
  v_and_b32 v51, s30, v109
  v_pk_add_f32 v[6:7], v[6:7], v[50:51]
  v_lshlrev_b32 v52, 16, v110
  v_and_b32 v53, s30, v110
  v_pk_add_f32 v[6:7], v[6:7], v[52:53]
  v_lshlrev_b32 v54, 16, v111
  v_and_b32 v55, s30, v111
  v_pk_add_f32 v[6:7], v[6:7], v[54:55]
  v_lshlrev_b32 v56, 16, v112
  v_and_b32 v57, s30, v112
  v_pk_add_f32 v[6:7], v[6:7], v[56:57]
  v_lshlrev_b32 v58, 16, v113
  v_and_b32 v59, s30, v113
  v_pk_add_f32 v[6:7], v[6:7], v[58:59]
  v_lshlrev_b32 v60, 16, v114
  v_and_b32 v61, s30, v114
  v_pk_add_f32 v[6:7], v[6:7], v[60:61]
  v_lshlrev_b32 v62, 16, v115
  v_and_b32 v63, s30, v115
  v_pk_add_f32 v[6:7], v[6:7], v[62:63]
  v_lshlrev_b32 v64, 16, v116
  v_and_b32 v65, s30, v116
  v_pk_add_f32 v[6:7], v[6:7], v[64:65]
  v_lshlrev_b32 v66, 16, v117
  v_and_b32 v67, s30, v117
  v_pk_add_f32 v[6:7], v[6:7], v[66:67]
  v_lshlrev_b32 v68, 16, v118
  v_and_b32 v69, s30, v118
  v_pk_add_f32 v[6:7], v[6:7], v[68:69]
  v_lshlrev_b32 v70, 16, v119
  v_and_b32 v71, s30, v119
  v_pk_add_f32 v[6:7], v[6:7], v[70:71]
  v_add_f32 v6, v6, v7
  s_nop 1
  v_add_f32_dpp v6, v6, v6 row_ror:8 row_mask:0xf bank_mask:0xf
  s_nop 1
  v_add_f32_dpp v6, v6, v6 row_ror:4 row_mask:0xf bank_mask:0xf
  s_nop 1
  v_add_f32_dpp v6, v6, v6 row_ror:2 row_mask:0xf bank_mask:0xf
  s_nop 1
  v_add_f32_dpp v6, v6, v6 row_ror:1 row_mask:0xf bank_mask:0xf
  v_mul_f32 v6, 0xbacccccd, v6
  v_mov_b32 v7, v6
  v_pk_add_f32 v[32:33], v[32:33], v[6:7]
  v_pk_mul_f32 v[28:29], v[32:33], v[32:33]
  v_pk_add_f32 v[34:35], v[34:35], v[6:7]
  v_pk_fma_f32 v[28:29], v[34:35], v[34:35], v[28:29]
  v_pk_add_f32 v[36:37], v[36:37], v[6:7]
  v_pk_fma_f32 v[28:29], v[36:37], v[36:37], v[28:29]
  v_pk_add_f32 v[38:39], v[38:39], v[6:7]
  v_pk_fma_f32 v[28:29], v[38:39], v[38:39], v[28:29]
  v_pk_add_f32 v[40:41], v[40:41], v[6:7]
  v_pk_fma_f32 v[28:29], v[40:41], v[40:41], v[28:29]
  v_pk_add_f32 v[42:43], v[42:43], v[6:7]
  v_pk_fma_f32 v[28:29], v[42:43], v[42:43], v[28:29]
  v_pk_add_f32 v[44:45], v[44:45], v[6:7]
  v_pk_fma_f32 v[28:29], v[44:45], v[44:45], v[28:29]
  v_pk_add_f32 v[46:47], v[46:47], v[6:7]
  v_pk_fma_f32 v[28:29], v[46:47], v[46:47], v[28:29]
  v_pk_add_f32 v[48:49], v[48:49], v[6:7]
  v_pk_fma_f32 v[28:29], v[48:49], v[48:49], v[28:29]
  v_pk_add_f32 v[50:51], v[50:51], v[6:7]
  v_pk_fma_f32 v[28:29], v[50:51], v[50:51], v[28:29]
  v_pk_add_f32 v[52:53], v[52:53], v[6:7]
  v_pk_fma_f32 v[28:29], v[52:53], v[52:53], v[28:29]
  v_pk_add_f32 v[54:55], v[54:55], v[6:7]
  v_pk_fma_f32 v[28:29], v[54:55], v[54:55], v[28:29]
  v_pk_add_f32 v[56:57], v[56:57], v[6:7]
  v_pk_fma_f32 v[28:29], v[56:57], v[56:57], v[28:29]
  v_pk_add_f32 v[58:59], v[58:59], v[6:7]
  v_pk_fma_f32 v[28:29], v[58:59], v[58:59], v[28:29]
  v_pk_add_f32 v[60:61], v[60:61], v[6:7]
  v_pk_fma_f32 v[28:29], v[60:61], v[60:61], v[28:29]
  v_pk_add_f32 v[62:63], v[62:63], v[6:7]
  v_pk_fma_f32 v[28:29], v[62:63], v[62:63], v[28:29]
  v_pk_add_f32 v[64:65], v[64:65], v[6:7]
  v_pk_fma_f32 v[28:29], v[64:65], v[64:65], v[28:29]
  v_pk_add_f32 v[66:67], v[66:67], v[6:7]
  v_pk_fma_f32 v[28:29], v[66:67], v[66:67], v[28:29]
  v_pk_add_f32 v[68:69], v[68:69], v[6:7]
  v_pk_fma_f32 v[28:29], v[68:69], v[68:69], v[28:29]
  v_pk_add_f32 v[70:71], v[70:71], v[6:7]
  v_pk_fma_f32 v[28:29], v[70:71], v[70:71], v[28:29]
  v_add_f32 v28, v28, v29
  s_nop 1
  v_add_f32_dpp v28, v28, v28 row_ror:8 row_mask:0xf bank_mask:0xf
  s_nop 1
  v_add_f32_dpp v28, v28, v28 row_ror:4 row_mask:0xf bank_mask:0xf
  s_nop 1
  v_add_f32_dpp v28, v28, v28 row_ror:2 row_mask:0xf bank_mask:0xf
  s_nop 1
  v_add_f32_dpp v28, v28, v28 row_ror:1 row_mask:0xf bank_mask:0xf
  v_mov_b32 v6, 0x3727c5ac
  v_fmac_f32 v6, 0x3acccccd, v28
  v_rsq_f32 v6, v6
  s_nop 0
  v_mov_b32 v7, v6
  v_pk_mul_f32 v[32:33], v[32:33], v[6:7]
  v_cvt_pk_bf16_f32 v100, v32, v33
  v_pk_mul_f32 v[34:35], v[34:35], v[6:7]
  v_cvt_pk_bf16_f32 v101, v34, v35
  v_pk_mul_f32 v[36:37], v[36:37], v[6:7]
  v_cvt_pk_bf16_f32 v102, v36, v37
  v_pk_mul_f32 v[38:39], v[38:39], v[6:7]
  v_cvt_pk_bf16_f32 v103, v38, v39
  buffer_store_dwordx4 v[100:103], v96, s[4:7], s22 offen offset:0 sc1
  s_add_u32 s22, s22, 4096
  v_pk_mul_f32 v[40:41], v[40:41], v[6:7]
  v_cvt_pk_bf16_f32 v104, v40, v41
  v_pk_mul_f32 v[42:43], v[42:43], v[6:7]
  v_cvt_pk_bf16_f32 v105, v42, v43
  v_pk_mul_f32 v[44:45], v[44:45], v[6:7]
  v_cvt_pk_bf16_f32 v106, v44, v45
  v_pk_mul_f32 v[46:47], v[46:47], v[6:7]
  v_cvt_pk_bf16_f32 v107, v46, v47
  buffer_store_dwordx4 v[104:107], v96, s[4:7], s22 offen offset:0 sc1
  s_add_u32 s22, s22, 4096
  v_pk_mul_f32 v[48:49], v[48:49], v[6:7]
  v_cvt_pk_bf16_f32 v108, v48, v49
  v_pk_mul_f32 v[50:51], v[50:51], v[6:7]
  v_cvt_pk_bf16_f32 v109, v50, v51
  v_pk_mul_f32 v[52:53], v[52:53], v[6:7]
  v_cvt_pk_bf16_f32 v110, v52, v53
  v_pk_mul_f32 v[54:55], v[54:55], v[6:7]
  v_cvt_pk_bf16_f32 v111, v54, v55
  buffer_store_dwordx4 v[108:111], v96, s[4:7], s22 offen offset:0 sc1
  s_add_u32 s22, s22, 4096
  v_pk_mul_f32 v[56:57], v[56:57], v[6:7]
  v_cvt_pk_bf16_f32 v112, v56, v57
  v_pk_mul_f32 v[58:59], v[58:59], v[6:7]
  v_cvt_pk_bf16_f32 v113, v58, v59
  v_pk_mul_f32 v[60:61], v[60:61], v[6:7]
  v_cvt_pk_bf16_f32 v114, v60, v61
  v_pk_mul_f32 v[62:63], v[62:63], v[6:7]
  v_cvt_pk_bf16_f32 v115, v62, v63
  buffer_store_dwordx4 v[112:115], v96, s[4:7], s22 offen offset:0 sc1
  s_add_u32 s22, s22, 4096
  v_pk_mul_f32 v[64:65], v[64:65], v[6:7]
  v_cvt_pk_bf16_f32 v116, v64, v65
  v_pk_mul_f32 v[66:67], v[66:67], v[6:7]
  v_cvt_pk_bf16_f32 v117, v66, v67
  v_pk_mul_f32 v[68:69], v[68:69], v[6:7]
  v_cvt_pk_bf16_f32 v118, v68, v69
  v_pk_mul_f32 v[70:71], v[70:71], v[6:7]
  v_cvt_pk_bf16_f32 v119, v70, v71
  buffer_store_dwordx4 v[116:119], v96, s[4:7], s22 offen offset:0 sc1
  s_add_u32 s22, s22, 4096
  s_mov_b32 s22, s21
  v_lshlrev_b32 v32, 16, v120
  v_and_b32 v33, s30, v120
  v_lshlrev_b32 v34, 16, v121
  v_and_b32 v35, s30, v121
  v_pk_add_f32 v[6:7], v[32:33], v[34:35]
  v_lshlrev_b32 v36, 16, v122
  v_and_b32 v37, s30, v122
  v_pk_add_f32 v[6:7], v[6:7], v[36:37]
  v_lshlrev_b32 v38, 16, v123
  v_and_b32 v39, s30, v123
  v_pk_add_f32 v[6:7], v[6:7], v[38:39]
  v_lshlrev_b32 v40, 16, v124
  v_and_b32 v41, s30, v124
  v_pk_add_f32 v[6:7], v[6:7], v[40:41]
  v_lshlrev_b32 v42, 16, v125
  v_and_b32 v43, s30, v125
  v_pk_add_f32 v[6:7], v[6:7], v[42:43]
  v_lshlrev_b32 v44, 16, v126
  v_and_b32 v45, s30, v126
  v_pk_add_f32 v[6:7], v[6:7], v[44:45]
  v_lshlrev_b32 v46, 16, v127
  v_and_b32 v47, s30, v127
  v_pk_add_f32 v[6:7], v[6:7], v[46:47]
  v_lshlrev_b32 v48, 16, v128
  v_and_b32 v49, s30, v128
  v_pk_add_f32 v[6:7], v[6:7], v[48:49]
  v_lshlrev_b32 v50, 16, v129
  v_and_b32 v51, s30, v129
  v_pk_add_f32 v[6:7], v[6:7], v[50:51]
  v_lshlrev_b32 v52, 16, v130
  v_and_b32 v53, s30, v130
  v_pk_add_f32 v[6:7], v[6:7], v[52:53]
  v_lshlrev_b32 v54, 16, v131
  v_and_b32 v55, s30, v131
  v_pk_add_f32 v[6:7], v[6:7], v[54:55]
  v_lshlrev_b32 v56, 16, v132
  v_and_b32 v57, s30, v132
  v_pk_add_f32 v[6:7], v[6:7], v[56:57]
  v_lshlrev_b32 v58, 16, v133
  v_and_b32 v59, s30, v133
  v_pk_add_f32 v[6:7], v[6:7], v[58:59]
  v_lshlrev_b32 v60, 16, v134
  v_and_b32 v61, s30, v134
  v_pk_add_f32 v[6:7], v[6:7], v[60:61]
  v_lshlrev_b32 v62, 16, v135
  v_and_b32 v63, s30, v135
  v_pk_add_f32 v[6:7], v[6:7], v[62:63]
  v_lshlrev_b32 v64, 16, v136
  v_and_b32 v65, s30, v136
  v_pk_add_f32 v[6:7], v[6:7], v[64:65]
  v_lshlrev_b32 v66, 16, v137
  v_and_b32 v67, s30, v137
  v_pk_add_f32 v[6:7], v[6:7], v[66:67]
  v_lshlrev_b32 v68, 16, v138
  v_and_b32 v69, s30, v138
  v_pk_add_f32 v[6:7], v[6:7], v[68:69]
  v_lshlrev_b32 v70, 16, v139
  v_and_b32 v71, s30, v139
  v_pk_add_f32 v[6:7], v[6:7], v[70:71]
  v_add_f32 v6, v6, v7
  s_nop 1
  v_add_f32_dpp v6, v6, v6 row_ror:8 row_mask:0xf bank_mask:0xf
  s_nop 1
  v_add_f32_dpp v6, v6, v6 row_ror:4 row_mask:0xf bank_mask:0xf
  s_nop 1
  v_add_f32_dpp v6, v6, v6 row_ror:2 row_mask:0xf bank_mask:0xf
  s_nop 1
  v_add_f32_dpp v6, v6, v6 row_ror:1 row_mask:0xf bank_mask:0xf
  v_mul_f32 v6, 0xbacccccd, v6
  v_mov_b32 v7, v6
  v_pk_add_f32 v[32:33], v[32:33], v[6:7]
  v_pk_mul_f32 v[28:29], v[32:33], v[32:33]
  v_pk_add_f32 v[34:35], v[34:35], v[6:7]
  v_pk_fma_f32 v[28:29], v[34:35], v[34:35], v[28:29]
  v_pk_add_f32 v[36:37], v[36:37], v[6:7]
  v_pk_fma_f32 v[28:29], v[36:37], v[36:37], v[28:29]
  v_pk_add_f32 v[38:39], v[38:39], v[6:7]
  v_pk_fma_f32 v[28:29], v[38:39], v[38:39], v[28:29]
  v_pk_add_f32 v[40:41], v[40:41], v[6:7]
  v_pk_fma_f32 v[28:29], v[40:41], v[40:41], v[28:29]
  v_pk_add_f32 v[42:43], v[42:43], v[6:7]
  v_pk_fma_f32 v[28:29], v[42:43], v[42:43], v[28:29]
  v_pk_add_f32 v[44:45], v[44:45], v[6:7]
  v_pk_fma_f32 v[28:29], v[44:45], v[44:45], v[28:29]
  v_pk_add_f32 v[46:47], v[46:47], v[6:7]
  v_pk_fma_f32 v[28:29], v[46:47], v[46:47], v[28:29]
  v_pk_add_f32 v[48:49], v[48:49], v[6:7]
  v_pk_fma_f32 v[28:29], v[48:49], v[48:49], v[28:29]
  v_pk_add_f32 v[50:51], v[50:51], v[6:7]
  v_pk_fma_f32 v[28:29], v[50:51], v[50:51], v[28:29]
  v_pk_add_f32 v[52:53], v[52:53], v[6:7]
  v_pk_fma_f32 v[28:29], v[52:53], v[52:53], v[28:29]
  v_pk_add_f32 v[54:55], v[54:55], v[6:7]
  v_pk_fma_f32 v[28:29], v[54:55], v[54:55], v[28:29]
  v_pk_add_f32 v[56:57], v[56:57], v[6:7]
  v_pk_fma_f32 v[28:29], v[56:57], v[56:57], v[28:29]
  v_pk_add_f32 v[58:59], v[58:59], v[6:7]
  v_pk_fma_f32 v[28:29], v[58:59], v[58:59], v[28:29]
  v_pk_add_f32 v[60:61], v[60:61], v[6:7]
  v_pk_fma_f32 v[28:29], v[60:61], v[60:61], v[28:29]
  v_pk_add_f32 v[62:63], v[62:63], v[6:7]
  v_pk_fma_f32 v[28:29], v[62:63], v[62:63], v[28:29]
  v_pk_add_f32 v[64:65], v[64:65], v[6:7]
  v_pk_fma_f32 v[28:29], v[64:65], v[64:65], v[28:29]
  v_pk_add_f32 v[66:67], v[66:67], v[6:7]
  v_pk_fma_f32 v[28:29], v[66:67], v[66:67], v[28:29]
  v_pk_add_f32 v[68:69], v[68:69], v[6:7]
  v_pk_fma_f32 v[28:29], v[68:69], v[68:69], v[28:29]
  v_pk_add_f32 v[70:71], v[70:71], v[6:7]
  v_pk_fma_f32 v[28:29], v[70:71], v[70:71], v[28:29]
  v_add_f32 v28, v28, v29
  s_nop 1
  v_add_f32_dpp v28, v28, v28 row_ror:8 row_mask:0xf bank_mask:0xf
  s_nop 1
  v_add_f32_dpp v28, v28, v28 row_ror:4 row_mask:0xf bank_mask:0xf
  s_nop 1
  v_add_f32_dpp v28, v28, v28 row_ror:2 row_mask:0xf bank_mask:0xf
  s_nop 1
  v_add_f32_dpp v28, v28, v28 row_ror:1 row_mask:0xf bank_mask:0xf
  v_mov_b32 v6, 0x3727c5ac
  v_fmac_f32 v6, 0x3acccccd, v28
  v_rsq_f32 v6, v6
  s_nop 0
  v_mov_b32 v7, v6
  v_pk_mul_f32 v[32:33], v[32:33], v[6:7]
  v_cvt_pk_bf16_f32 v120, v32, v33
  v_pk_mul_f32 v[34:35], v[34:35], v[6:7]
  v_cvt_pk_bf16_f32 v121, v34, v35
  v_pk_mul_f32 v[36:37], v[36:37], v[6:7]
  v_cvt_pk_bf16_f32 v122, v36, v37
  v_pk_mul_f32 v[38:39], v[38:39], v[6:7]
  v_cvt_pk_bf16_f32 v123, v38, v39
  buffer_store_dwordx4 v[120:123], v96, s[4:7], s22 offen offset:64 sc1
  s_add_u32 s22, s22, 4096
  v_pk_mul_f32 v[40:41], v[40:41], v[6:7]
  v_cvt_pk_bf16_f32 v124, v40, v41
  v_pk_mul_f32 v[42:43], v[42:43], v[6:7]
  v_cvt_pk_bf16_f32 v125, v42, v43
  v_pk_mul_f32 v[44:45], v[44:45], v[6:7]
  v_cvt_pk_bf16_f32 v126, v44, v45
  v_pk_mul_f32 v[46:47], v[46:47], v[6:7]
  v_cvt_pk_bf16_f32 v127, v46, v47
  buffer_store_dwordx4 v[124:127], v96, s[4:7], s22 offen offset:64 sc1
  s_add_u32 s22, s22, 4096
  v_pk_mul_f32 v[48:49], v[48:49], v[6:7]
  v_cvt_pk_bf16_f32 v128, v48, v49
  v_pk_mul_f32 v[50:51], v[50:51], v[6:7]
  v_cvt_pk_bf16_f32 v129, v50, v51
  v_pk_mul_f32 v[52:53], v[52:53], v[6:7]
  v_cvt_pk_bf16_f32 v130, v52, v53
  v_pk_mul_f32 v[54:55], v[54:55], v[6:7]
  v_cvt_pk_bf16_f32 v131, v54, v55
  buffer_store_dwordx4 v[128:131], v96, s[4:7], s22 offen offset:64 sc1
  s_add_u32 s22, s22, 4096
  v_pk_mul_f32 v[56:57], v[56:57], v[6:7]
  v_cvt_pk_bf16_f32 v132, v56, v57
  v_pk_mul_f32 v[58:59], v[58:59], v[6:7]
  v_cvt_pk_bf16_f32 v133, v58, v59
  v_pk_mul_f32 v[60:61], v[60:61], v[6:7]
  v_cvt_pk_bf16_f32 v134, v60, v61
  v_pk_mul_f32 v[62:63], v[62:63], v[6:7]
  v_cvt_pk_bf16_f32 v135, v62, v63
  buffer_store_dwordx4 v[132:135], v96, s[4:7], s22 offen offset:64 sc1
  s_add_u32 s22, s22, 4096
  v_pk_mul_f32 v[64:65], v[64:65], v[6:7]
  v_cvt_pk_bf16_f32 v136, v64, v65
  v_pk_mul_f32 v[66:67], v[66:67], v[6:7]
  v_cvt_pk_bf16_f32 v137, v66, v67
  v_pk_mul_f32 v[68:69], v[68:69], v[6:7]
  v_cvt_pk_bf16_f32 v138, v68, v69
  v_pk_mul_f32 v[70:71], v[70:71], v[6:7]
  v_cvt_pk_bf16_f32 v139, v70, v71
  buffer_store_dwordx4 v[136:139], v96, s[4:7], s22 offen offset:64 sc1
  s_add_u32 s22, s22, 4096
  s_waitcnt vmcnt(0)
  s_barrier
  s_getreg_b32 s27, hwreg(HW_REG_XCC_ID)
  s_and_b32 s27, s27, 7
  s_mul_i32 s28, s27, s27
  s_lshl_b32 s28, s28, 14
  s_lshl_b32 s27, s27, 6
  s_add_u32 s27, s27, s28
  s_add_u32 s69, s27, 1
  s_lshl_b32 s29, s68, 2
  s_cmp_eq_u32 s3, 0
  s_cselect_b32 s29, s29, 4096
  v_mov_b32 v13, s29
  v_mov_b32 v12, s69
  s_mov_b64 exec, 1
  buffer_atomic_add v12, v13, s[44:47], 0 offen sc0 sc1
  s_mov_b64 exec, -1
  s_waitcnt vmcnt(0)
  v_readfirstlane_b32 s27, v12
  s_nop 0
  s_and_b32 s28, s27, 63
  s_cmp_eq_u32 s28, 31
  s_cbranch_scc1 mega_kernel_cf1
mega_kernel_cf1_b:
  v_mov_b32 v12, 0
  s_branch mega_kv_go2
mega_kv_go:
  s_getreg_b32 s27, hwreg(HW_REG_XCC_ID)
  s_and_b32 s27, s27, 7
  s_mul_i32 s28, s27, s27
  s_lshl_b32 s28, s28, 14
  s_lshl_b32 s27, s27, 6
  s_add_u32 s27, s27, s28
  s_add_u32 s69, s27, 1
  s_lshl_b32 s29, s68, 2
  s_cmp_eq_u32 s3, 0
  s_cselect_b32 s29, s29, 4096
  v_mov_b32 v13, s29
  v_mov_b32 v12, s69
  s_mov_b64 exec, 1
  buffer_atomic_add v12, v13, s[44:47], 0 offen sc0 sc1
  s_mov_b64 exec, -1
mega_kv_go2:
  s_mul_i32 s10, s80, 384
  s_mul_i32 s11, s3, 96
  s_add_u32 s10, s10, s11
  s_mul_i32 s11, s3, 30720
  s_add_u32 s11, s11, 40960
  v_mul_u32_u24 v18, 10923, v1
  v_lshrrev_b32 v18, 16, v18
  v_mul_u32_u24 v16, 6, v18
  v_sub_u32 v16, v1, v16
  v_lshlrev_b32 v16, 4, v16
  v_mul_u32_u24 v18, 12288, v18
  v_add_u32 v16, v16, v18
  v_lshrrev_b32 v18, 4, v1
  v_mul_u32_u24 v18, 8, v18
  v_bfe_u32 v17, v1, 2, 2
  v_add_u32 v18, v18, v17
  v_mul_u32_u24 v18, 96, v18
  v_and_b32 v17, 3, v1
  v_lshl_add_u32 v17, v17, 3, v18
  v_add_u32 v17, s11, v17
  s_mov_b64 exec, s[82:83]
  s_add_u32 m0, s11, 0
  s_nop 0
  buffer_load_dwordx4 v16, s[92:95], s10 offen lds
  s_add_u32 s10, s10, 122880
  s_add_u32 m0, s11, 960
  s_nop 0
  buffer_load_dwordx4 v16, s[92:95], s10 offen lds
  s_add_u32 s10, s10, 122880
  s_add_u32 m0, s11, 1920
  s_nop 0
  buffer_load_dwordx4 v16, s[92:95], s10 offen lds
  s_add_u32 s10, s10, 122880
  s_add_u32 m0, s11, 2880
  s_nop 0
  buffer_load_dwordx4 v16, s[92:95], s10 offen lds
  s_add_u32 s10, s10, 122880
  s_add_u32 m0, s11, 3840
  s_nop 0
  buffer_load_dwordx4 v16, s[92:95], s10 offen lds
  s_add_u32 s10, s10, 122880
  s_add_u32 m0, s11, 4800
  s_nop 0
  buffer_load_dwordx4 v16, s[92:95], s10 offen lds
  s_add_u32 s10, s10, 122880
  s_add_u32 m0, s11, 5760
  s_nop 0
  buffer_load_dwordx4 v16, s[92:95], s10 offen lds
  s_add_u32 s10, s10, 122880
  s_add_u32 m0, s11, 6720
  s_nop 0
  buffer_load_dwordx4 v16, s[92:95], s10 offen lds
  s_add_u32 s10, s10, 122880
  s_add_u32 m0, s11, 7680
  s_nop 0
  buffer_load_dwordx4 v16, s[92:95], s10 offen lds
  s_add_u32 s10, s10, 122880
  s_add_u32 m0, s11, 8640
  s_nop 0
  buffer_load_dwordx4 v16, s[92:95], s10 offen lds
  s_add_u32 s10, s10, 122880
  s_add_u32 m0, s11, 9600
  s_nop 0
  buffer_load_dwordx4 v16, s[92:95], s10 offen lds
  s_add_u32 s10, s10, 122880
  s_add_u32 m0, s11, 10560
  s_nop 0
  buffer_load_dwordx4 v16, s[92:95], s10 offen lds
  s_add_u32 s10, s10, 122880
  s_add_u32 m0, s11, 11520
  s_nop 0
  buffer_load_dwordx4 v16, s[92:95], s10 offen lds
  s_add_u32 s10, s10, 122880
  s_add_u32 m0, s11, 12480
  s_nop 0
  buffer_load_dwordx4 v16, s[92:95], s10 offen lds
  s_add_u32 s10, s10, 122880
  s_add_u32 m0, s11, 13440
  s_nop 0
  buffer_load_dwordx4 v16, s[92:95], s10 offen lds
  s_add_u32 s10, s10, 122880
  s_add_u32 m0, s11, 14400
  s_nop 0
  buffer_load_dwordx4 v16, s[92:95], s10 offen lds
  s_add_u32 s10, s10, 122880
  s_add_u32 m0, s11, 15360
  s_nop 0
  buffer_load_dwordx4 v16, s[92:95], s10 offen lds
  s_add_u32 s10, s10, 122880
  s_add_u32 m0, s11, 16320
  s_nop 0
  buffer_load_dwordx4 v16, s[92:95], s10 offen lds
  s_add_u32 s10, s10, 122880
  s_add_u32 m0, s11, 17280
  s_nop 0
  buffer_load_dwordx4 v16, s[92:95], s10 offen lds
  s_add_u32 s10, s10, 122880
  s_add_u32 m0, s11, 18240
  s_nop 0
  buffer_load_dwordx4 v16, s[92:95], s10 offen lds
  s_add_u32 s10, s10, 122880
  s_add_u32 m0, s11, 19200
  s_nop 0
  buffer_load_dwordx4 v16, s[92:95], s10 offen lds
  s_add_u32 s10, s10, 122880
  s_add_u32 m0, s11, 20160
  s_nop 0
  buffer_load_dwordx4 v16, s[92:95], s10 offen lds
  s_add_u32 s10, s10, 122880
  s_add_u32 m0, s11, 21120
  s_nop 0
  buffer_load_dwordx4 v16, s[92:95], s10 offen lds
  s_add_u32 s10, s10, 122880
  s_add_u32 m0, s11, 22080
  s_nop 0
  buffer_load_dwordx4 v16, s[92:95], s10 offen lds
  s_add_u32 s10, s10, 122880
  s_add_u32 m0, s11, 23040
  s_nop 0
  buffer_load_dwordx4 v16, s[92:95], s10 offen lds
  s_add_u32 s10, s10, 122880
  s_add_u32 m0, s11, 24000
  s_nop 0
  buffer_load_dwordx4 v16, s[92:95], s10 offen lds
  s_add_u32 s10, s10, 122880
  s_add_u32 m0, s11, 24960
  s_nop 0
  buffer_load_dwordx4 v16, s[92:95], s10 offen lds
  s_add_u32 s10, s10, 122880
  s_add_u32 m0, s11, 25920
  s_nop 0
  buffer_load_dwordx4 v16, s[92:95], s10 offen lds
  s_add_u32 s10, s10, 122880
  s_add_u32 m0, s11, 26880
  s_nop 0
  buffer_load_dwordx4 v16, s[92:95], s10 offen lds
  s_add_u32 s10, s10, 122880
  s_add_u32 m0, s11, 27840
  s_nop 0
  buffer_load_dwordx4 v16, s[92:95], s10 offen lds
  s_add_u32 s10, s10, 122880
  s_add_u32 m0, s11, 28800
  s_nop 0
  buffer_load_dwordx4 v16, s[92:95], s10 offen lds
  s_add_u32 s10, s10, 122880
  s_add_u32 m0, s11, 29760
  s_nop 0
  buffer_load_dwordx4 v16, s[92:95], s10 offen lds
  s_add_u32 s10, s10, 122880
  s_mov_b64 exec, -1
  s_waitcnt vmcnt(28)
  v_readfirstlane_b32 s27, v12
  s_nop 0
  s_and_b32 s28, s27, 63
  s_cmp_eq_u32 s28, 31
  s_cbranch_scc1 mega_kernel_cf3
mega_kernel_cf3_b:
  ds_read_b64_tr_b16 a[0:1], v17 offset:0
  ds_read_b64_tr_b16 a[2:3], v17 offset:384
  ds_read_b64_tr_b16 a[80:81], v17 offset:32
  ds_read_b64_tr_b16 a[82:83], v17 offset:416
  ds_read_b64_tr_b16 a[160:161], v17 offset:64
  ds_read_b64_tr_b16 a[162:163], v17 offset:448
  s_waitcnt lgkmcnt(0)
  s_mov_b64 exec, s[82:83]
  s_add_u32 m0, s11, 0
  s_nop 0
  buffer_load_dwordx4 v16, s[92:95], s10 offen lds
  s_add_u32 s10, s10, 122880
  s_add_u32 m0, s11, 960
  s_nop 0
  buffer_load_dwordx4 v16, s[92:95], s10 offen lds
  s_add_u32 s10, s10, 122880
  s_add_u32 m0, s11, 1920
  s_nop 0
  buffer_load_dwordx4 v16, s[92:95], s10 offen lds
  s_add_u32 s10, s10, 122880
  s_mov_b64 exec, -1
  s_waitcnt vmcnt(28)
  ds_read_b64_tr_b16 a[4:5], v17 offset:3072
  ds_read_b64_tr_b16 a[6:7], v17 offset:3456
  ds_read_b64_tr_b16 a[84:85], v17 offset:3104
  ds_read_b64_tr_b16 a[86:87], v17 offset:3488
  ds_read_b64_tr_b16 a[164:165], v17 offset:3136
  ds_read_b64_tr_b16 a[166:167], v17 offset:3520
  s_waitcnt lgkmcnt(0)
  s_mov_b64 exec, s[82:83]
  s_add_u32 m0, s11, 2880
  s_nop 0
  buffer_load_dwordx4 v16, s[92:95], s10 offen lds
  s_add_u32 s10, s10, 122880
  s_add_u32 m0, s11, 3840
  s_nop 0
  buffer_load_dwordx4 v16, s[92:95], s10 offen lds
  s_add_u32 s10, s10, 122880
  s_add_u32 m0, s11, 4800
  s_nop 0
  buffer_load_dwordx4 v16, s[92:95], s10 offen lds
  s_add_u32 s10, s10, 122880
  s_mov_b64 exec, -1
  s_waitcnt vmcnt(28)
  ds_read_b64_tr_b16 a[8:9], v17 offset:6144
  ds_read_b64_tr_b16 a[10:11], v17 offset:6528
  ds_read_b64_tr_b16 a[88:89], v17 offset:6176
  ds_read_b64_tr_b16 a[90:91], v17 offset:6560
  ds_read_b64_tr_b16 a[168:169], v17 offset:6208
  ds_read_b64_tr_b16 a[170:171], v17 offset:6592
  s_waitcnt lgkmcnt(0)
  s_mov_b64 exec, s[82:83]
  s_add_u32 m0, s11, 5760
  s_nop 0
  buffer_load_dwordx4 v16, s[92:95], s10 offen lds
  s_add_u32 s10, s10, 122880
  s_add_u32 m0, s11, 6720
  s_nop 0
  buffer_load_dwordx4 v16, s[92:95], s10 offen lds
  s_add_u32 s10, s10, 122880
  s_add_u32 m0, s11, 7680
  s_nop 0
  buffer_load_dwordx4 v16, s[92:95], s10 offen lds
  s_add_u32 s10, s10, 122880
  s_mov_b64 exec, -1
  s_waitcnt vmcnt(28)
  ds_read_b64_tr_b16 a[12:13], v17 offset:9216
  ds_read_b64_tr_b16 a[14:15], v17 offset:9600
  ds_read_b64_tr_b16 a[92:93], v17 offset:9248
  ds_read_b64_tr_b16 a[94:95], v17 offset:9632
  ds_read_b64_tr_b16 a[172:173], v17 offset:9280
  ds_read_b64_tr_b16 a[174:175], v17 offset:9664
  s_waitcnt lgkmcnt(0)
  s_mov_b64 exec, s[82:83]
  s_add_u32 m0, s11, 8640
  s_nop 0
  buffer_load_dwordx4 v16, s[92:95], s10 offen lds
  s_add_u32 s10, s10, 122880
  s_add_u32 m0, s11, 9600
  s_nop 0
  buffer_load_dwordx4 v16, s[92:95], s10 offen lds
  s_add_u32 s10, s10, 122880
  s_add_u32 m0, s11, 10560
  s_nop 0
  buffer_load_dwordx4 v16, s[92:95], s10 offen lds
  s_add_u32 s10, s10, 122880
  s_mov_b64 exec, -1
  s_waitcnt vmcnt(28)
  ds_read_b64_tr_b16 a[16:17], v17 offset:12288
  ds_read_b64_tr_b16 a[18:19], v17 offset:12672
  ds_read_b64_tr_b16 a[96:97], v17 offset:12320
  ds_read_b64_tr_b16 a[98:99], v17 offset:12704
  ds_read_b64_tr_b16 a[176:177], v17 offset:12352
  ds_read_b64_tr_b16 a[178:179], v17 offset:12736
  s_waitcnt lgkmcnt(0)
  s_mov_b64 exec, s[82:83]
  s_add_u32 m0, s11, 11520
  s_nop 0
  buffer_load_dwordx4 v16, s[92:95], s10 offen lds
  s_add_u32 s10, s10, 122880
  s_add_u32 m0, s11, 12480
  s_nop 0
  buffer_load_dwordx4 v16, s[92:95], s10 offen lds
  s_add_u32 s10, s10, 122880
  s_add_u32 m0, s11, 13440
  s_nop 0
  buffer_load_dwordx4 v16, s[92:95], s10 offen lds
  s_add_u32 s10, s10, 122880
  s_add_u32 m0, s11, 14400
  s_nop 0
  buffer_load_dwordx4 v16, s[92:95], s10 offen lds
  s_add_u32 s10, s10, 122880
  s_mov_b64 exec, -1
  s_waitcnt vmcnt(28)
  ds_read_b64_tr_b16 a[20:21], v17 offset:15360
  ds_read_b64_tr_b16 a[22:23], v17 offset:15744
  ds_read_b64_tr_b16 a[100:101], v17 offset:15392
  ds_read_b64_tr_b16 a[102:103], v17 offset:15776
  ds_read_b64_tr_b16 a[180:181], v17 offset:15424
  ds_read_b64_tr_b16 a[182:183], v17 offset:15808
  s_waitcnt lgkmcnt(0)
  s_mov_b64 exec, s[82:83]
  s_add_u32 m0, s11, 15360
  s_nop 0
  buffer_load_dwordx4 v16, s[92:95], s10 offen lds
  s_add_u32 s10, s10, 122880
  s_add_u32 m0, s11, 16320
  s_nop 0
  buffer_load_dwordx4 v16, s[92:95], s10 offen lds
  s_add_u32 s10, s10, 122880
  s_add_u32 m0, s11, 17280
  s_nop 0
  buffer_load_dwordx4 v16, s[92:95], s10 offen lds
  s_add_u32 s10, s10, 122880
  s_mov_b64 exec, -1
  s_waitcnt vmcnt(28)
  ds_read_b64_tr_b16 a[24:25], v17 offset:18432
  ds_read_b64_tr_b16 a[26:27], v17 offset:18816
  ds_read_b64_tr_b16 a[104:105], v17 offset:18464
  ds_read_b64_tr_b16 a[106:107], v17 offset:18848
  ds_read_b64_tr_b16 a[184:185], v17 offset:18496
  ds_read_b64_tr_b16 a[186:187], v17 offset:18880
  s_waitcnt lgkmcnt(0)
  s_mov_b64 exec, s[82:83]
  s_add_u32 m0, s11, 18240
  s_nop 0
  buffer_load_dwordx4 v16, s[92:95], s10 offen lds
  s_add_u32 s10, s10, 122880
  s_add_u32 m0, s11, 19200
  s_nop 0
  buffer_load_dwordx4 v16, s[92:95], s10 offen lds
  s_add_u32 s10, s10, 122880
  s_add_u32 m0, s11, 20160
  s_nop 0
  buffer_load_dwordx4 v16, s[92:95], s10 offen lds
  s_add_u32 s10, s10, 122880
  s_mov_b64 exec, -1
  s_waitcnt vmcnt(28)
  ds_read_b64_tr_b16 a[28:29], v17 offset:21504
  ds_read_b64_tr_b16 a[30:31], v17 offset:21888
  ds_read_b64_tr_b16 a[108:109], v17 offset:21536
  ds_read_b64_tr_b16 a[110:111], v17 offset:21920
  ds_read_b64_tr_b16 a[188:189], v17 offset:21568
  ds_read_b64_tr_b16 a[190:191], v17 offset:21952
  s_waitcnt lgkmcnt(0)
  s_mov_b64 exec, s[82:83]
  s_add_u32 m0, s11, 21120
  s_nop 0
  buffer_load_dwordx4 v16, s[92:95], s10 offen lds
  s_add_u32 s10, s10, 122880
  s_add_u32 m0, s11, 22080
  s_nop 0
  buffer_load_dwordx4 v16, s[92:95], s10 offen lds
  s_add_u32 s10, s10, 122880
  s_add_u32 m0, s11, 23040
  s_nop 0
  buffer_load_dwordx4 v16, s[92:95], s10 offen lds
  s_add_u32 s10, s10, 122880
  s_mov_b64 exec, -1
  s_waitcnt vmcnt(28)
  ds_read_b64_tr_b16 a[32:33], v17 offset:24576
  ds_read_b64_tr_b16 a[34:35], v17 offset:24960
  ds_read_b64_tr_b16 a[112:113], v17 offset:24608
  ds_read_b64_tr_b16 a[114:115], v17 offset:24992
  ds_read_b64_tr_b16 a[192:193], v17 offset:24640
  ds_read_b64_tr_b16 a[194:195], v17 offset:25024
  s_waitcnt lgkmcnt(0)
  s_mov_b64 exec, s[82:83]
  s_add_u32 m0, s11, 24000
  s_nop 0
  buffer_load_dwordx4 v16, s[92:95], s10 offen lds
  s_add_u32 s10, s10, 122880
  s_add_u32 m0, s11, 24960
  s_nop 0
  buffer_load_dwordx4 v16, s[92:95], s10 offen lds
  s_add_u32 s10, s10, 122880
  s_add_u32 m0, s11, 25920
  s_nop 0
  buffer_load_dwordx4 v16, s[92:95], s10 offen lds
  s_add_u32 s10, s10, 122880
  s_mov_b64 exec, -1
  s_waitcnt vmcnt(28)
  ds_read_b64_tr_b16 a[36:37], v17 offset:27648
  ds_read_b64_tr_b16 a[38:39], v17 offset:28032
  ds_read_b64_tr_b16 a[116:117], v17 offset:27680
  ds_read_b64_tr_b16 a[118:119], v17 offset:28064
  ds_read_b64_tr_b16 a[196:197], v17 offset:27712
  ds_read_b64_tr_b16 a[198:199], v17 offset:28096
  s_waitcnt lgkmcnt(0)
  s_mov_b64 exec, s[82:83]
  s_add_u32 m0, s11, 26880
  s_nop 0
  buffer_load_dwordx4 v16, s[92:95], s10 offen lds
  s_add_u32 s10, s10, 122880
  s_add_u32 m0, s11, 27840
  s_nop 0
  buffer_load_dwordx4 v16, s[92:95], s10 offen lds
  s_add_u32 s10, s10, 122880
  s_add_u32 m0, s11, 28800
  s_nop 0
  buffer_load_dwordx4 v16, s[92:95], s10 offen lds
  s_add_u32 s10, s10, 122880
  s_add_u32 m0, s11, 29760
  s_nop 0
  buffer_load_dwordx4 v16, s[92:95], s10 offen lds
  s_add_u32 s10, s10, 122880
  s_mov_b64 exec, -1
  s_waitcnt vmcnt(28)
  ds_read_b64_tr_b16 a[40:41], v17 offset:0
  ds_read_b64_tr_b16 a[42:43], v17 offset:384
  ds_read_b64_tr_b16 a[120:121], v17 offset:32
  ds_read_b64_tr_b16 a[122:123], v17 offset:416
  ds_read_b64_tr_b16 a[200:201], v17 offset:64
  ds_read_b64_tr_b16 a[202:203], v17 offset:448
  s_waitcnt vmcnt(25)
  ds_read_b64_tr_b16 a[44:45], v17 offset:3072
  ds_read_b64_tr_b16 a[46:47], v17 offset:3456
  ds_read_b64_tr_b16 a[124:125], v17 offset:3104
  ds_read_b64_tr_b16 a[126:127], v17 offset:3488
  ds_read_b64_tr_b16 a[204:205], v17 offset:3136
  ds_read_b64_tr_b16 a[206:207], v17 offset:3520
  s_waitcnt vmcnt(22)
  ds_read_b64_tr_b16 a[48:49], v17 offset:6144
  ds_read_b64_tr_b16 a[50:51], v17 offset:6528
  ds_read_b64_tr_b16 a[128:129], v17 offset:6176
  ds_read_b64_tr_b16 a[130:131], v17 offset:6560
  ds_read_b64_tr_b16 a[208:209], v17 offset:6208
  ds_read_b64_tr_b16 a[210:211], v17 offset:6592
  s_waitcnt vmcnt(19)
  ds_read_b64_tr_b16 a[52:53], v17 offset:9216
  ds_read_b64_tr_b16 a[54:55], v17 offset:9600
  ds_read_b64_tr_b16 a[132:133], v17 offset:9248
  ds_read_b64_tr_b16 a[134:135], v17 offset:9632
  ds_read_b64_tr_b16 a[212:213], v17 offset:9280
  ds_read_b64_tr_b16 a[214:215], v17 offset:9664
  s_waitcnt vmcnt(16)
  ds_read_b64_tr_b16 a[56:57], v17 offset:12288
  ds_read_b64_tr_b16 a[58:59], v17 offset:12672
  ds_read_b64_tr_b16 a[136:137], v17 offset:12320
  ds_read_b64_tr_b16 a[138:139], v17 offset:12704
  ds_read_b64_tr_b16 a[216:217], v17 offset:12352
  ds_read_b64_tr_b16 a[218:219], v17 offset:12736
  s_waitcnt vmcnt(12)
  ds_read_b64_tr_b16 a[60:61], v17 offset:15360
  ds_read_b64_tr_b16 a[62:63], v17 offset:15744
  ds_read_b64_tr_b16 a[140:141], v17 offset:15392
  ds_read_b64_tr_b16 a[142:143], v17 offset:15776
  ds_read_b64_tr_b16 a[220:221], v17 offset:15424
  ds_read_b64_tr_b16 a[222:223], v17 offset:15808
  s_waitcnt vmcnt(9)
  ds_read_b64_tr_b16 a[64:65], v17 offset:18432
  ds_read_b64_tr_b16 a[66:67], v17 offset:18816
  ds_read_b64_tr_b16 a[144:145], v17 offset:18464
  ds_read_b64_tr_b16 a[146:147], v17 offset:18848
  ds_read_b64_tr_b16 a[224:225], v17 offset:18496
  ds_read_b64_tr_b16 a[226:227], v17 offset:18880
  s_waitcnt vmcnt(6)
  ds_read_b64_tr_b16 a[68:69], v17 offset:21504
  ds_read_b64_tr_b16 a[70:71], v17 offset:21888
  ds_read_b64_tr_b16 a[148:149], v17 offset:21536
  ds_read_b64_tr_b16 a[150:151], v17 offset:21920
  ds_read_b64_tr_b16 a[228:229], v17 offset:21568
  ds_read_b64_tr_b16 a[230:231], v17 offset:21952
  s_waitcnt vmcnt(3)
  ds_read_b64_tr_b16 a[72:73], v17 offset:24576
  ds_read_b64_tr_b16 a[74:75], v17 offset:24960
  ds_read_b64_tr_b16 a[152:153], v17 offset:24608
  ds_read_b64_tr_b16 a[154:155], v17 offset:24992
  ds_read_b64_tr_b16 a[232:233], v17 offset:24640
  ds_read_b64_tr_b16 a[234:235], v17 offset:25024
  s_waitcnt vmcnt(0)
  ds_read_b64_tr_b16 a[76:77], v17 offset:27648
  ds_read_b64_tr_b16 a[78:79], v17 offset:28032
  ds_read_b64_tr_b16 a[156:157], v17 offset:27680
  ds_read_b64_tr_b16 a[158:159], v17 offset:28064
  ds_read_b64_tr_b16 a[236:237], v17 offset:27712
  ds_read_b64_tr_b16 a[238:239], v17 offset:28096
  v_mov_b32 v18, 128
  s_mov_b32 s28, 0
mega_kernel_cen5:
  buffer_load_dwordx2 v[16:17], v18, s[44:47], 0 offen sc1
  s_waitcnt vmcnt(0)
  v_readfirstlane_b32 s69, v16
  v_readfirstlane_b32 s100, v16
  s_nop 0
  s_min_u32 vcc_lo, s69, s100
  s_cmp_lg_u32 vcc_lo, 0
  s_cbranch_scc1 mega_kernel_cen5_done
  s_sleep 4
  s_add_u32 s28, s28, 1
  s_cmp_lt_u32 s28, 262144
  s_cbranch_scc1 mega_kernel_cen5
  s_branch mega_fail
mega_kernel_cen5_done:
  s_lshr_b32 s69, s69, s68
  s_bfe_u32 s69, s69, 0x10008
  s_waitcnt lgkmcnt(0)
mega_kv_layer:
  s_cmp_eq_u32 s70, 0
  s_cbranch_scc1 mega_kernel_hw6_ok
  v_lshrrev_b32 v87, 2, v1
  v_lshlrev_b32 v87, 7, v87
  s_mov_b32 s30, 0
mega_kernel_hw6:
  s_mov_b32 s15, 53542944
  buffer_load_dwordx4 v[96:99], v87, s[4:7], s15 offen sc1
  s_waitcnt vmcnt(0)
  v_min3_u32 v96, v96, v97, v98
  v_min_u32 v96, v96, v99
  v_cmp_eq_u32 vcc, 0, v96
  s_nop 0
  s_cbranch_vccz mega_kernel_hw6_ok
  s_sleep 1
  s_add_u32 s30, s30, 1
  s_cmp_lt_u32 s30, 262144
  s_cbranch_scc1 mega_kernel_hw6
  s_branch mega_fail
mega_kernel_hw6_ok:
  v_lshlrev_b32 v2, 4, v1
  s_mul_i32 s13, s3, 10240
  s_mul_i32 s12, s70, 2662400
  s_add_u32 s12, s12, s13
  s_add_u32 s12, s12, 0
  s_add_u32 m0, s13, 0
  s_add_u32 s18, s12, 0
  buffer_load_dwordx4 v2, s[4:7], s18 offen offset:0 lds
  buffer_load_dwordx4 v2, s[4:7], s18 offen offset:1024 lds
  buffer_load_dwordx4 v2, s[4:7], s18 offen offset:2048 lds
  buffer_load_dwordx4 v2, s[4:7], s18 offen offset:3072 lds
  s_add_u32 m0, s13, 4096
  s_add_u32 s18, s12, 4096
  buffer_load_dwordx4 v2, s[4:7], s18 offen offset:0 lds
  buffer_load_dwordx4 v2, s[4:7], s18 offen offset:1024 lds
  buffer_load_dwordx4 v2, s[4:7], s18 offen offset:2048 lds
  buffer_load_dwordx4 v2, s[4:7], s18 offen offset:3072 lds
  s_add_u32 m0, s13, 8192
  s_add_u32 s18, s12, 8192
  buffer_load_dwordx4 v2, s[4:7], s18 offen offset:0 lds
  buffer_load_dwordx4 v2, s[4:7], s18 offen offset:1024 lds
  s_add_u32 s12, s12, 40960
  s_add_u32 s13, s13, 40960
  s_mov_b32 s19, 40960
  v_mov_b32 v7, 0
  s_lshl_b32 s15, s3, 10
  v_add_u32 v3, s15, v2
  s_and_b32 s9, s80, 3
  v_mov_b32 v5, v2
  s_mov_b32 s24, 0
  v_add_u32 v4, 4096, v3
  v_add_u32 v9, 8192, v3
  s_mul_i32 s14, s81, 49152
  s_mul_i32 s15, s9, 12288
  s_add_u32 s14, s14, s15
  s_add_u32 s14, s14, s78
  s_add_u32 s14, s14, 204800
  s_mov_b32 s20, 0
  s_mul_i32 s48, s81, 976896
  s_lshl_b32 s25, s81, 12
  s_lshl_b32 s15, s80, 7
  s_add_u32 s25, s25, s15
  s_lshl_b32 s15, s3, 2
  s_add_u32 s25, s25, s15
  s_add_u32 s25, s25, s71
  s_mul_i32 s23, s3, 3072
  s_add_u32 s29, s23, s78
  s_add_u32 s29, s29, 315392
  s_add_u32 s23, s23, 81920
  s_mul_i32 s15, s81, 3
  s_add_u32 s15, s15, s3
  s_lshl_b32 s16, s81, 1
  s_add_u32 s16, s16, 3
  s_mul_i32 s26, s9, 5
  s_add_u32 s26, s26, s15
  s_add_u32 s49, s81, 4
  s_cmp_lt_u32 s15, s16
  s_cselect_b32 s21, s49, 64
  s_cselect_b32 s22, 1, 0
  s_lshl_b32 s16, s9, 3
  s_add_u32 s16, s16, s15
  s_cmp_eq_u32 s16, 6
  s_cselect_b32 s27, 4, s9
  s_cselect_b32 s15, 5, s15
  s_cmp_eq_u32 s15, 5
  s_cselect_b32 s21, 9, s21
  s_cselect_b32 s22, 2, s22
  s_waitcnt vmcnt(0)
mega_kv_loop:
  s_barrier
  ds_read_b128 v[16:19], v5 offset:0
  ds_read_b128 v[20:23], v5 offset:20480
  ds_read_b128 v[24:27], v5 offset:1024
  ds_read_b128 v[28:31], v5 offset:21504
  ds_read_b128 v[32:35], v5 offset:2048
  ds_read_b128 v[36:39], v5 offset:22528
  s_waitcnt lgkmcnt(4)
  v_mfma_f32_16x16x32_bf16 v[48:51], a[0:3], v[16:19], 0
  ds_read_b128 v[40:43], v5 offset:3072
  v_mfma_f32_16x16x32_bf16 v[52:55], a[80:83], v[16:19], 0
  s_mov_b32 m0, s23
  s_add_u32 s18, s29, s48
  buffer_load_dwordx4 v2, s[4:7], s18 offen sc1 lds
  v_mfma_f32_16x16x32_bf16 v[56:59], a[160:163], v[16:19], 0
  v_mfma_f32_16x16x32_bf16 v[60:63], a[0:3], v[20:23], 0
  ds_read_b128 v[44:47], v5 offset:23552
  v_mfma_f32_16x16x32_bf16 v[64:67], a[80:83], v[20:23], 0
  s_add_u32 s17, s14, s20
  buffer_load_dwordx4 v2, s[4:7], s18 offen offset:1024 sc1 lds
  v_mfma_f32_16x16x32_bf16 v[68:71], a[160:163], v[20:23], 0
  s_waitcnt lgkmcnt(4)
  v_mfma_f32_16x16x32_bf16 v[48:51], a[4:7], v[24:27], v[48:51]
  ds_read_b128 v[16:19], v5 offset:4096
  v_mfma_f32_16x16x32_bf16 v[52:55], a[84:87], v[24:27], v[52:55]
  buffer_load_dwordx4 v2, s[4:7], s18 offen offset:2048 sc1 lds
  v_mfma_f32_16x16x32_bf16 v[56:59], a[164:167], v[24:27], v[56:59]
  v_mfma_f32_16x16x32_bf16 v[60:63], a[4:7], v[28:31], v[60:63]
  ds_read_b128 v[20:23], v5 offset:24576
  v_mfma_f32_16x16x32_bf16 v[64:67], a[84:87], v[28:31], v[64:67]
  v_mfma_f32_16x16x32_bf16 v[68:71], a[164:167], v[28:31], v[68:71]
  s_waitcnt lgkmcnt(4)
  v_mfma_f32_16x16x32_bf16 v[48:51], a[8:11], v[32:35], v[48:51]
  ds_read_b128 v[24:27], v5 offset:5120
  v_mfma_f32_16x16x32_bf16 v[52:55], a[88:91], v[32:35], v[52:55]
  v_mfma_f32_16x16x32_bf16 v[56:59], a[168:171], v[32:35], v[56:59]
  v_mfma_f32_16x16x32_bf16 v[60:63], a[8:11], v[36:39], v[60:63]
  ds_read_b128 v[28:31], v5 offset:25600
  v_mfma_f32_16x16x32_bf16 v[64:67], a[88:91], v[36:39], v[64:67]
  v_mfma_f32_16x16x32_bf16 v[68:71], a[168:171], v[36:39], v[68:71]
  s_waitcnt lgkmcnt(4)
  v_mfma_f32_16x16x32_bf16 v[48:51], a[12:15], v[40:43], v[48:51]
  ds_read_b128 v[32:35], v5 offset:6144
  v_mfma_f32_16x16x32_bf16 v[52:55], a[92:95], v[40:43], v[52:55]
  v_mfma_f32_16x16x32_bf16 v[56:59], a[172:175], v[40:43], v[56:59]
  v_mfma_f32_16x16x32_bf16 v[60:63], a[12:15], v[44:47], v[60:63]
  ds_read_b128 v[36:39], v5 offset:26624
  v_mfma_f32_16x16x32_bf16 v[64:67], a[92:95], v[44:47], v[64:67]
  v_mfma_f32_16x16x32_bf16 v[68:71], a[172:175], v[44:47], v[68:71]
  s_waitcnt lgkmcnt(4)
  v_mfma_f32_16x16x32_bf16 v[48:51], a[16:19], v[16:19], v[48:51]
  ds_read_b128 v[40:43], v5 offset:7168
  v_mfma_f32_16x16x32_bf16 v[52:55], a[96:99], v[16:19], v[52:55]
  v_mfma_f32_16x16x32_bf16 v[56:59], a[176:179], v[16:19], v[56:59]
  v_mfma_f32_16x16x32_bf16 v[60:63], a[16:19], v[20:23], v[60:63]
  ds_read_b128 v[44:47], v5 offset:27648
  v_mfma_f32_16x16x32_bf16 v[64:67], a[96:99], v[20:23], v[64:67]
  v_mfma_f32_16x16x32_bf16 v[68:71], a[176:179], v[20:23], v[68:71]
  s_waitcnt lgkmcnt(4)
  v_mfma_f32_16x16x32_bf16 v[48:51], a[20:23], v[24:27], v[48:51]
  ds_read_b128 v[16:19], v5 offset:8192
  v_mfma_f32_16x16x32_bf16 v[52:55], a[100:103], v[24:27], v[52:55]
  v_mfma_f32_16x16x32_bf16 v[56:59], a[180:183], v[24:27], v[56:59]
  v_mfma_f32_16x16x32_bf16 v[60:63], a[20:23], v[28:31], v[60:63]
  ds_read_b128 v[20:23], v5 offset:28672
  v_mfma_f32_16x16x32_bf16 v[64:67], a[100:103], v[28:31], v[64:67]
  v_mfma_f32_16x16x32_bf16 v[68:71], a[180:183], v[28:31], v[68:71]
  s_waitcnt lgkmcnt(4)
  v_mfma_f32_16x16x32_bf16 v[48:51], a[24:27], v[32:35], v[48:51]
  ds_read_b128 v[24:27], v5 offset:9216
  v_mfma_f32_16x16x32_bf16 v[52:55], a[104:107], v[32:35], v[52:55]
  v_mfma_f32_16x16x32_bf16 v[56:59], a[184:187], v[32:35], v[56:59]
  v_mfma_f32_16x16x32_bf16 v[60:63], a[24:27], v[36:39], v[60:63]
  ds_read_b128 v[28:31], v5 offset:29696
  v_mfma_f32_16x16x32_bf16 v[64:67], a[104:107], v[36:39], v[64:67]
  v_mfma_f32_16x16x32_bf16 v[68:71], a[184:187], v[36:39], v[68:71]
  s_waitcnt lgkmcnt(4)
  v_mfma_f32_16x16x32_bf16 v[48:51], a[28:31], v[40:43], v[48:51]
  ds_read_b128 v[32:35], v5 offset:10240
  v_mfma_f32_16x16x32_bf16 v[52:55], a[108:111], v[40:43], v[52:55]
  s_add_u32 m0, s13, 0
  s_add_u32 s18, s12, 0
  buffer_load_dwordx4 v2, s[4:7], s18 offen offset:0 lds
  v_mfma_f32_16x16x32_bf16 v[56:59], a[188:191], v[40:43], v[56:59]
  v_mfma_f32_16x16x32_bf16 v[60:63], a[28:31], v[44:47], v[60:63]
  ds_read_b128 v[36:39], v5 offset:30720
  v_mfma_f32_16x16x32_bf16 v[64:67], a[108:111], v[44:47], v[64:67]
  buffer_load_dwordx4 v2, s[4:7], s18 offen offset:1024 lds
  v_mfma_f32_16x16x32_bf16 v[68:71], a[188:191], v[44:47], v[68:71]
  s_waitcnt lgkmcnt(4)
  v_mfma_f32_16x16x32_bf16 v[48:51], a[32:35], v[16:19], v[48:51]
  ds_read_b128 v[40:43], v5 offset:11264
  v_mfma_f32_16x16x32_bf16 v[52:55], a[112:115], v[16:19], v[52:55]
  v_mfma_f32_16x16x32_bf16 v[56:59], a[192:195], v[16:19], v[56:59]
  buffer_load_dwordx4 v2, s[4:7], s18 offen offset:2048 lds
  v_mfma_f32_16x16x32_bf16 v[60:63], a[32:35], v[20:23], v[60:63]
  ds_read_b128 v[44:47], v5 offset:31744
  v_mfma_f32_16x16x32_bf16 v[64:67], a[112:115], v[20:23], v[64:67]
  v_mfma_f32_16x16x32_bf16 v[68:71], a[192:195], v[20:23], v[68:71]
  s_waitcnt lgkmcnt(4)
  v_mfma_f32_16x16x32_bf16 v[48:51], a[36:39], v[24:27], v[48:51]
  ds_read_b128 v[16:19], v5 offset:12288
  v_mfma_f32_16x16x32_bf16 v[52:55], a[116:119], v[24:27], v[52:55]
  buffer_load_dwordx4 v2, s[4:7], s18 offen offset:3072 lds
  v_mfma_f32_16x16x32_bf16 v[56:59], a[196:199], v[24:27], v[56:59]
  v_mfma_f32_16x16x32_bf16 v[60:63], a[36:39], v[28:31], v[60:63]
  ds_read_b128 v[20:23], v5 offset:32768
  v_mfma_f32_16x16x32_bf16 v[64:67], a[116:119], v[28:31], v[64:67]
  v_mfma_f32_16x16x32_bf16 v[68:71], a[196:199], v[28:31], v[68:71]
  s_add_u32 m0, s13, 4096
  s_add_u32 s18, s12, 4096
  buffer_load_dwordx4 v2, s[4:7], s18 offen offset:0 lds
  s_waitcnt vmcnt(5)
  s_barrier
  s_waitcnt lgkmcnt(4)
  v_mfma_f32_16x16x32_bf16 v[48:51], a[40:43], v[32:35], v[48:51]
  ds_read_b128 v[24:27], v5 offset:13312
  v_mfma_f32_16x16x32_bf16 v[52:55], a[120:123], v[32:35], v[52:55]
  v_mfma_f32_16x16x32_bf16 v[56:59], a[200:203], v[32:35], v[56:59]
  v_mfma_f32_16x16x32_bf16 v[60:63], a[40:43], v[36:39], v[60:63]
  ds_read_b128 v[28:31], v5 offset:33792
  v_mfma_f32_16x16x32_bf16 v[64:67], a[120:123], v[36:39], v[64:67]
  buffer_load_dwordx4 v2, s[4:7], s18 offen offset:1024 lds
  v_mfma_f32_16x16x32_bf16 v[68:71], a[200:203], v[36:39], v[68:71]
  s_waitcnt lgkmcnt(4)
  v_mfma_f32_16x16x32_bf16 v[48:51], a[44:47], v[40:43], v[48:51]
  ds_read_b128 v[32:35], v5 offset:14336
  v_mfma_f32_16x16x32_bf16 v[52:55], a[124:127], v[40:43], v[52:55]
  buffer_load_dwordx4 v2, s[4:7], s18 offen offset:2048 lds
  v_mfma_f32_16x16x32_bf16 v[56:59], a[204:207], v[40:43], v[56:59]
  v_mfma_f32_16x16x32_bf16 v[60:63], a[44:47], v[44:47], v[60:63]
  ds_read_b128 v[36:39], v5 offset:34816
  v_mfma_f32_16x16x32_bf16 v[64:67], a[124:127], v[44:47], v[64:67]
  v_mfma_f32_16x16x32_bf16 v[68:71], a[204:207], v[44:47], v[68:71]
  buffer_load_dwordx4 v2, s[4:7], s18 offen offset:3072 lds
  s_waitcnt lgkmcnt(4)
  v_mfma_f32_16x16x32_bf16 v[48:51], a[48:51], v[16:19], v[48:51]
  ds_read_b128 v[40:43], v5 offset:15360
  v_mfma_f32_16x16x32_bf16 v[52:55], a[128:131], v[16:19], v[52:55]
  v_mfma_f32_16x16x32_bf16 v[56:59], a[208:211], v[16:19], v[56:59]
  v_mfma_f32_16x16x32_bf16 v[60:63], a[48:51], v[20:23], v[60:63]
  ds_read_b128 v[44:47], v5 offset:35840
  v_mfma_f32_16x16x32_bf16 v[64:67], a[128:131], v[20:23], v[64:67]
  s_add_u32 m0, s13, 8192
  s_add_u32 s18, s12, 8192
  buffer_load_dwordx4 v2, s[4:7], s18 offen offset:0 lds
  v_mfma_f32_16x16x32_bf16 v[68:71], a[208:211], v[20:23], v[68:71]
  s_waitcnt lgkmcnt(4)
  v_mfma_f32_16x16x32_bf16 v[48:51], a[52:55], v[24:27], v[48:51]
  ds_read_b128 v[16:19], v5 offset:16384
  v_mfma_f32_16x16x32_bf16 v[52:55], a[132:135], v[24:27], v[52:55]
  v_mfma_f32_16x16x32_bf16 v[56:59], a[212:215], v[24:27], v[56:59]
  buffer_load_dwordx4 v2, s[4:7], s18 offen offset:1024 lds
  v_mfma_f32_16x16x32_bf16 v[60:63], a[52:55], v[28:31], v[60:63]
  ds_read_b128 v[20:23], v5 offset:36864
  v_mfma_f32_16x16x32_bf16 v[64:67], a[132:135], v[28:31], v[64:67]
  v_mfma_f32_16x16x32_bf16 v[68:71], a[212:215], v[28:31], v[68:71]
  s_waitcnt lgkmcnt(4)
  v_mfma_f32_16x16x32_bf16 v[48:51], a[56:59], v[32:35], v[48:51]
  ds_read_b128 v[24:27], v5 offset:17408
  v_mfma_f32_16x16x32_bf16 v[52:55], a[136:139], v[32:35], v[52:55]
  v_mfma_f32_16x16x32_bf16 v[56:59], a[216:219], v[32:35], v[56:59]
  v_mfma_f32_16x16x32_bf16 v[60:63], a[56:59], v[36:39], v[60:63]
  ds_read_b128 v[28:31], v5 offset:37888
  v_mfma_f32_16x16x32_bf16 v[64:67], a[136:139], v[36:39], v[64:67]
  v_mfma_f32_16x16x32_bf16 v[68:71], a[216:219], v[36:39], v[68:71]
  s_waitcnt lgkmcnt(4)
  v_mfma_f32_16x16x32_bf16 v[48:51], a[60:63], v[40:43], v[48:51]
  ds_read_b128 v[32:35], v5 offset:18432
  v_mfma_f32_16x16x32_bf16 v[52:55], a[140:143], v[40:43], v[52:55]
  v_mfma_f32_16x16x32_bf16 v[56:59], a[220:223], v[40:43], v[56:59]
  v_mfma_f32_16x16x32_bf16 v[60:63], a[60:63], v[44:47], v[60:63]
  ds_read_b128 v[36:39], v5 offset:38912
  v_mfma_f32_16x16x32_bf16 v[64:67], a[140:143], v[44:47], v[64:67]
  v_mfma_f32_16x16x32_bf16 v[68:71], a[220:223], v[44:47], v[68:71]
  s_waitcnt lgkmcnt(4)
  v_mfma_f32_16x16x32_bf16 v[48:51], a[64:67], v[16:19], v[48:51]
  ds_read_b128 v[40:43], v5 offset:19456
  v_mfma_f32_16x16x32_bf16 v[52:55], a[144:147], v[16:19], v[52:55]
  v_mfma_f32_16x16x32_bf16 v[56:59], a[224:227], v[16:19], v[56:59]
  v_mfma_f32_16x16x32_bf16 v[60:63], a[64:67], v[20:23], v[60:63]
  ds_read_b128 v[44:47], v5 offset:39936
  v_mfma_f32_16x16x32_bf16 v[64:67], a[144:147], v[20:23], v[64:67]
  v_mfma_f32_16x16x32_bf16 v[68:71], a[224:227], v[20:23], v[68:71]
  s_waitcnt lgkmcnt(4)
  v_mfma_f32_16x16x32_bf16 v[48:51], a[68:71], v[24:27], v[48:51]
  v_mfma_f32_16x16x32_bf16 v[52:55], a[148:151], v[24:27], v[52:55]
  v_mfma_f32_16x16x32_bf16 v[56:59], a[228:231], v[24:27], v[56:59]
  v_mfma_f32_16x16x32_bf16 v[60:63], a[68:71], v[28:31], v[60:63]
  v_mfma_f32_16x16x32_bf16 v[64:67], a[148:151], v[28:31], v[64:67]
  v_mfma_f32_16x16x32_bf16 v[68:71], a[228:231], v[28:31], v[68:71]
  s_waitcnt lgkmcnt(2)
  v_mfma_f32_16x16x32_bf16 v[48:51], a[72:75], v[32:35], v[48:51]
  v_mfma_f32_16x16x32_bf16 v[52:55], a[152:155], v[32:35], v[52:55]
  v_mfma_f32_16x16x32_bf16 v[56:59], a[232:235], v[32:35], v[56:59]
  v_mfma_f32_16x16x32_bf16 v[60:63], a[72:75], v[36:39], v[60:63]
  v_mfma_f32_16x16x32_bf16 v[64:67], a[152:155], v[36:39], v[64:67]
  v_mfma_f32_16x16x32_bf16 v[68:71], a[232:235], v[36:39], v[68:71]
  s_waitcnt lgkmcnt(0)
  v_mfma_f32_16x16x32_bf16 v[48:51], a[76:79], v[40:43], v[48:51]
  v_mfma_f32_16x16x32_bf16 v[52:55], a[156:159], v[40:43], v[52:55]
  v_mfma_f32_16x16x32_bf16 v[56:59], a[236:239], v[40:43], v[56:59]
  v_mfma_f32_16x16x32_bf16 v[60:63], a[76:79], v[44:47], v[60:63]
  v_mfma_f32_16x16x32_bf16 v[64:67], a[156:159], v[44:47], v[64:67]
  v_mfma_f32_16x16x32_bf16 v[68:71], a[236:239], v[44:47], v[68:71]
  v_add_u32 v5, s19, v5
  s_sub_u32 s13, s13, s19
  s_sub_u32 s19, 0, s19
  s_add_u32 s12, s12, 40960
  s_add_u32 s24, s24, 1
  v_cvt_pk_bf16_f32 v72, v48, v49
  v_cvt_pk_bf16_f32 v73, v50, v51
  v_cvt_pk_bf16_f32 v74, v52, v53
  v_cvt_pk_bf16_f32 v75, v54, v55
  v_cvt_pk_bf16_f32 v80, v56, v57
  v_cvt_pk_bf16_f32 v81, v58, v59
  buffer_store_dwordx4 v[72:75], v3, s[4:7], s17 offen
  v_cvt_pk_bf16_f32 v76, v60, v61
  v_cvt_pk_bf16_f32 v77, v62, v63
  v_cvt_pk_bf16_f32 v78, v64, v65
  v_cvt_pk_bf16_f32 v79, v66, v67
  v_cvt_pk_bf16_f32 v82, v68, v69
  v_cvt_pk_bf16_f32 v83, v70, v71
  buffer_store_dwordx4 v[76:79], v4, s[4:7], s17 offen
  buffer_store_dwordx4 v[80:83], v9, s[4:7], s17 offen
  s_waitcnt vmcnt(0)
  v_mov_b32 v8, s24
  s_mov_b64 exec, 1
  s_cmp_lg_u32 s69, 0
  s_cbranch_scc1 mega_kernel_pf7
  buffer_store_dword v8, v7, s[4:7], s25 offen
mega_kernel_pf7_b:
  s_mov_b64 exec, -1
  s_add_u32 s20, s20, 325632
  s_cmp_ge_u32 s20, 1302528
  s_cselect_b32 s20, 0, s20
  s_add_u32 s48, s48, 325632
  s_cmp_ge_u32 s48, 1302528
  s_cselect_b32 s48, 0, s48
  s_cmp_le_u32 s24, s49
  s_cbranch_scc1 mega_kv_early
mega_kv_eb:
  s_cmp_lt_u32 s24, s21
  s_cbranch_scc1 mega_kv_loop
  s_cmp_eq_u32 s22, 2
  s_cbranch_scc1 mega_kv_red
  s_cmp_eq_u32 s22, 1
  s_cbranch_scc1 mega_kv_tout
  s_branch mega_bl
mega_kv_early:
  s_cmp_eq_u32 s24, 2
  s_cbranch_scc0 mega_kv_e2
  s_cmp_eq_u32 s70, 0
  s_cbranch_scc1 mega_kernel_hw8_ok
  v_lshlrev_b32 v87, 7, v1
  s_mov_b32 s30, 0
mega_kernel_hw8:
  s_mov_b32 s15, 53542944
  buffer_load_dwordx4 v[96:99], v87, s[4:7], s15 offen sc1
  s_mov_b32 s15, 53551136
  buffer_load_dwordx4 v[100:103], v87, s[4:7], s15 offen sc1
  s_mov_b32 s15, 53559328
  buffer_load_dwordx4 v[104:107], v87, s[4:7], s15 offen sc1
  s_mov_b32 s15, 53567520
  buffer_load_dwordx4 v[108:111], v87, s[4:7], s15 offen sc1
  s_waitcnt vmcnt(0)
  v_min3_u32 v96, v96, v97, v98
  v_min3_u32 v96, v96, v99, v100
  v_min3_u32 v96, v96, v101, v102
  v_min3_u32 v96, v96, v103, v104
  v_min3_u32 v96, v96, v105, v106
  v_min3_u32 v96, v96, v107, v108
  v_min3_u32 v96, v96, v109, v110
  v_min_u32 v96, v96, v111
  v_cmp_eq_u32 vcc, 0, v96
  s_nop 0
  s_cbranch_vccz mega_kernel_hw8_ok
  s_sleep 1
  s_add_u32 s30, s30, 1
  s_cmp_lt_u32 s30, 262144
  s_cbranch_scc1 mega_kernel_hw8
  s_branch mega_fail
mega_kernel_hw8_ok:
mega_kv_e2:
  s_cmp_eq_u32 s24, s49
  s_cbranch_scc0 mega_kv_eb
  s_cmp_eq_u32 s70, 0
  s_cbranch_scc0 mega_kv_eb
  s_lshl_b32 s73, s81, 5
  s_add_u32 s73, s73, s80
  s_lshl_b32 s73, s73, 2
  s_add_u32 s73, s73, s3
  s_load_dwordx2 s[52:53], s[0:1], 64
  s_mov_b32 s54, 0x258000
  s_mov_b32 s55, 0x20000
  s_load_dwordx2 s[56:57], s[0:1], 72
  s_mov_b32 s58, 0x6400
  s_mov_b32 s59, 0x20000
  s_load_dwordx2 s[60:61], s[0:1], 80
  s_mov_b32 s62, 0xc8000
  s_mov_b32 s63, 0x20000
  s_waitcnt lgkmcnt(0)
mega_bj:
  s_cmp_ge_u32 s73, 520
  s_cbranch_scc1 mega_bjdone
  s_mov_b32 s43, s73
  s_add_u32 s73, s73, 256
  s_cmp_ge_u32 s43, 320
  s_cbranch_scc1 mega_bj1
  s_and_b32 s42, s43, 3
  s_lshr_b32 s43, s43, 2
  s_mul_hi_u32 s64, s43, 0x6666667
  s_mul_i32 s65, s64, 40
  s_sub_u32 s65, s43, s65
  s_mul_hi_u32 s66, s65, 0x33333334
  s_mul_i32 s67, s66, 5
  s_sub_u32 s67, s65, s67
  v_and_b32 v16, 15, v1
  v_lshrrev_b32 v17, 4, v1
  v_lshrrev_b32 v18, 2, v16
  v_and_b32 v19, 3, v16
  v_lshlrev_b32 v20, 3, v17
  v_mul_u32_u24 v21, 20, v18
  v_sub_u32 v20, v20, v21
  v_mul_i32_i24 v21, 40, v20
  v_mul_u32_u24 v22, 800, v18
  v_add_u32 v21, v21, v22
  v_lshl_add_u32 v21, v19, 1, v21
  s_mul_i32 s31, s66, 3200
  s_lshl_b32 s32, s67, 3
  s_add_u32 s31, s31, s32
  v_mov_b32 v23, 0x100000
  v_add_u32 v24, 0, v20
  v_cmp_gt_u32 vcc, 20, v24
  v_add_u32 v25, 0, v21
  s_nop 0
  v_cndmask_b32 v25, v23, v25, vcc
  buffer_load_ushort v46, v25, s[56:59], s31 offen
  v_add_u32 v24, 1, v20
  v_cmp_gt_u32 vcc, 20, v24
  v_add_u32 v25, 40, v21
  s_nop 0
  v_cndmask_b32 v25, v23, v25, vcc
  buffer_load_ushort v47, v25, s[56:59], s31 offen
  v_add_u32 v24, 2, v20
  v_cmp_gt_u32 vcc, 20, v24
  v_add_u32 v25, 80, v21
  s_nop 0
  v_cndmask_b32 v25, v23, v25, vcc
  buffer_load_ushort v48, v25, s[56:59], s31 offen
  v_add_u32 v24, 3, v20
  v_cmp_gt_u32 vcc, 20, v24
  v_add_u32 v25, 120, v21
  s_nop 0
  v_cndmask_b32 v25, v23, v25, vcc
  buffer_load_ushort v49, v25, s[56:59], s31 offen
  v_add_u32 v24, 4, v20
  v_cmp_gt_u32 vcc, 20, v24
  v_add_u32 v25, 160, v21
  s_nop 0
  v_cndmask_b32 v25, v23, v25, vcc
  buffer_load_ushort v50, v25, s[56:59], s31 offen
  v_add_u32 v24, 5, v20
  v_cmp_gt_u32 vcc, 20, v24
  v_add_u32 v25, 200, v21
  s_nop 0
  v_cndmask_b32 v25, v23, v25, vcc
  buffer_load_ushort v51, v25, s[56:59], s31 offen
  v_add_u32 v24, 6, v20
  v_cmp_gt_u32 vcc, 20, v24
  v_add_u32 v25, 240, v21
  s_nop 0
  v_cndmask_b32 v25, v23, v25, vcc
  buffer_load_ushort v52, v25, s[56:59], s31 offen
  v_add_u32 v24, 7, v20
  v_cmp_gt_u32 vcc, 20, v24
  v_add_u32 v25, 280, v21
  s_nop 0
  v_cndmask_b32 v25, v23, v25, vcc
  buffer_load_ushort v53, v25, s[56:59], s31 offen
  v_add_u32 v24, 32, v20
  v_cmp_gt_u32 vcc, 20, v24
  v_add_u32 v25, 1280, v21
  s_nop 0
  v_cndmask_b32 v25, v23, v25, vcc
  buffer_load_ushort v54, v25, s[56:59], s31 offen
  v_add_u32 v24, 33, v20
  v_cmp_gt_u32 vcc, 20, v24
  v_add_u32 v25, 1320, v21
  s_nop 0
  v_cndmask_b32 v25, v23, v25, vcc
  buffer_load_ushort v55, v25, s[56:59], s31 offen
  v_add_u32 v24, 34, v20
  v_cmp_gt_u32 vcc, 20, v24
  v_add_u32 v25, 1360, v21
  s_nop 0
  v_cndmask_b32 v25, v23, v25, vcc
  buffer_load_ushort v56, v25, s[56:59], s31 offen
  v_add_u32 v24, 35, v20
  v_cmp_gt_u32 vcc, 20, v24
  v_add_u32 v25, 1400, v21
  s_nop 0
  v_cndmask_b32 v25, v23, v25, vcc
  buffer_load_ushort v57, v25, s[56:59], s31 offen
  v_add_u32 v24, 36, v20
  v_cmp_gt_u32 vcc, 20, v24
  v_add_u32 v25, 1440, v21
  s_nop 0
  v_cndmask_b32 v25, v23, v25, vcc
  buffer_load_ushort v58, v25, s[56:59], s31 offen
  v_add_u32 v24, 37, v20
  v_cmp_gt_u32 vcc, 20, v24
  v_add_u32 v25, 1480, v21
  s_nop 0
  v_cndmask_b32 v25, v23, v25, vcc
  buffer_load_ushort v59, v25, s[56:59], s31 offen
  v_add_u32 v24, 38, v20
  v_cmp_gt_u32 vcc, 20, v24
  v_add_u32 v25, 1520, v21
  s_nop 0
  v_cndmask_b32 v25, v23, v25, vcc
  buffer_load_ushort v60, v25, s[56:59], s31 offen
  v_add_u32 v24, 39, v20
  v_cmp_gt_u32 vcc, 20, v24
  v_add_u32 v25, 1560, v21
  s_nop 0
  v_cndmask_b32 v25, v23, v25, vcc
  buffer_load_ushort v61, v25, s[56:59], s31 offen
  v_add_u32 v24, 64, v20
  v_cmp_gt_u32 vcc, 20, v24
  v_add_u32 v25, 2560, v21
  s_nop 0
  v_cndmask_b32 v25, v23, v25, vcc
  buffer_load_ushort v62, v25, s[56:59], s31 offen
  v_add_u32 v24, 65, v20
  v_cmp_gt_u32 vcc, 20, v24
  v_add_u32 v25, 2600, v21
  s_nop 0
  v_cndmask_b32 v25, v23, v25, vcc
  buffer_load_ushort v63, v25, s[56:59], s31 offen
  v_add_u32 v24, 66, v20
  v_cmp_gt_u32 vcc, 20, v24
  v_add_u32 v25, 2640, v21
  s_nop 0
  v_cndmask_b32 v25, v23, v25, vcc
  buffer_load_ushort v64, v25, s[56:59], s31 offen
  v_add_u32 v24, 67, v20
  v_cmp_gt_u32 vcc, 20, v24
  v_add_u32 v25, 2680, v21
  s_nop 0
  v_cndmask_b32 v25, v23, v25, vcc
  buffer_load_ushort v65, v25, s[56:59], s31 offen
  v_add_u32 v24, 68, v20
  v_cmp_gt_u32 vcc, 20, v24
  v_add_u32 v25, 2720, v21
  s_nop 0
  v_cndmask_b32 v25, v23, v25, vcc
  buffer_load_ushort v66, v25, s[56:59], s31 offen
  v_add_u32 v24, 69, v20
  v_cmp_gt_u32 vcc, 20, v24
  v_add_u32 v25, 2760, v21
  s_nop 0
  v_cndmask_b32 v25, v23, v25, vcc
  buffer_load_ushort v67, v25, s[56:59], s31 offen
  v_add_u32 v24, 70, v20
  v_cmp_gt_u32 vcc, 20, v24
  v_add_u32 v25, 2800, v21
  s_nop 0
  v_cndmask_b32 v25, v23, v25, vcc
  buffer_load_ushort v68, v25, s[56:59], s31 offen
  v_add_u32 v24, 71, v20
  v_cmp_gt_u32 vcc, 20, v24
  v_add_u32 v25, 2840, v21
  s_nop 0
  v_cndmask_b32 v25, v23, v25, vcc
  buffer_load_ushort v69, v25, s[56:59], s31 offen
  v_lshl_add_u32 v24, v18, 3, v19
  v_mul_u32_u24 v24, 3840, v24
  v_lshl_add_u32 v24, v17, 4, v24
  v_add_u32 v25, 15360, v24
  s_mul_i32 s32, s64, 1280
  s_mul_i32 s33, s66, 160
  s_add_u32 s32, s32, s33
  s_mul_i32 s33, s42, 614400
  s_add_u32 s32, s32, s33
  s_mul_i32 s33, s66, 307200
  s_mul_i32 s34, s64, 5
  s_add_u32 s34, s34, s67
  s_lshl_b32 s34, s34, 10
  s_add_u32 s33, s33, s34
  s_add_u32 s33, s33, 79888384
  s_mul_i32 s34, s42, 76800
  s_add_u32 s33, s33, s34
  v_lshlrev_b32 v26, 4, v1
  buffer_load_dwordx4 v[110:113], v24, s[52:55], s32 offen offset:0
  buffer_load_dwordx4 v[114:117], v24, s[52:55], s32 offen offset:64
  buffer_load_dwordx4 v[118:121], v24, s[52:55], s32 offen offset:128
  buffer_load_dwordx4 v[122:125], v25, s[52:55], s32 offen offset:0
  buffer_load_dwordx4 v[126:129], v25, s[52:55], s32 offen offset:64
  buffer_load_dwordx4 v[130:133], v25, s[52:55], s32 offen offset:128
  s_add_u32 s32, s32, 122880
  buffer_load_dwordx4 v[134:137], v24, s[52:55], s32 offen offset:0
  buffer_load_dwordx4 v[138:141], v24, s[52:55], s32 offen offset:64
  buffer_load_dwordx4 v[142:145], v24, s[52:55], s32 offen offset:128
  buffer_load_dwordx4 v[146:149], v25, s[52:55], s32 offen offset:0
  buffer_load_dwordx4 v[150:153], v25, s[52:55], s32 offen offset:64
  buffer_load_dwordx4 v[154:157], v25, s[52:55], s32 offen offset:128
  s_add_u32 s32, s32, 122880
  buffer_load_dwordx4 v[158:161], v24, s[52:55], s32 offen offset:0
  buffer_load_dwordx4 v[162:165], v24, s[52:55], s32 offen offset:64
  buffer_load_dwordx4 v[166:169], v24, s[52:55], s32 offen offset:128
  buffer_load_dwordx4 v[170:173], v25, s[52:55], s32 offen offset:0
  buffer_load_dwordx4 v[174:177], v25, s[52:55], s32 offen offset:64
  buffer_load_dwordx4 v[178:181], v25, s[52:55], s32 offen offset:128
  s_add_u32 s32, s32, 122880
  buffer_load_dwordx4 v[182:185], v24, s[52:55], s32 offen offset:0
  buffer_load_dwordx4 v[186:189], v24, s[52:55], s32 offen offset:64
  buffer_load_dwordx4 v[190:193], v24, s[52:55], s32 offen offset:128
  buffer_load_dwordx4 v[194:197], v25, s[52:55], s32 offen offset:0
  buffer_load_dwordx4 v[198:201], v25, s[52:55], s32 offen offset:64
  buffer_load_dwordx4 v[202:205], v25, s[52:55], s32 offen offset:128
  s_add_u32 s32, s32, 122880
  buffer_load_dwordx4 v[206:209], v24, s[52:55], s32 offen offset:0
  buffer_load_dwordx4 v[210:213], v24, s[52:55], s32 offen offset:64
  buffer_load_dwordx4 v[214:217], v24, s[52:55], s32 offen offset:128
  buffer_load_dwordx4 v[218:221], v25, s[52:55], s32 offen offset:0
  buffer_load_dwordx4 v[222:225], v25, s[52:55], s32 offen offset:64
  buffer_load_dwordx4 v[226:229], v25, s[52:55], s32 offen offset:128
  s_add_u32 s32, s32, 122880
  s_waitcnt vmcnt(30)
  v_lshl_or_b32 v30, v47, 16, v46
  v_lshl_or_b32 v31, v49, 16, v48
  v_lshl_or_b32 v32, v51, 16, v50
  v_lshl_or_b32 v33, v53, 16, v52
  v_lshl_or_b32 v34, v55, 16, v54
  v_lshl_or_b32 v35, v57, 16, v56
  v_lshl_or_b32 v36, v59, 16, v58
  v_lshl_or_b32 v37, v61, 16, v60
  v_lshl_or_b32 v38, v63, 16, v62
  v_lshl_or_b32 v39, v65, 16, v64
  v_lshl_or_b32 v40, v67, 16, v66
  v_lshl_or_b32 v41, v69, 16, v68
  s_waitcnt vmcnt(24)
  v_mfma_f32_16x16x32_bf16 v[70:73], v[110:113], v[30:33], 0
  v_mfma_f32_16x16x32_bf16 v[70:73], v[114:117], v[34:37], v[70:73]
  v_mfma_f32_16x16x32_bf16 v[70:73], v[118:121], v[38:41], v[70:73]
  v_mfma_f32_16x16x32_bf16 v[74:77], v[122:125], v[30:33], 0
  v_mfma_f32_16x16x32_bf16 v[74:77], v[126:129], v[34:37], v[74:77]
  v_mfma_f32_16x16x32_bf16 v[74:77], v[130:133], v[38:41], v[74:77]
  s_waitcnt vmcnt(18)
  v_mfma_f32_16x16x32_bf16 v[78:81], v[134:137], v[30:33], 0
  v_mfma_f32_16x16x32_bf16 v[78:81], v[138:141], v[34:37], v[78:81]
  v_mfma_f32_16x16x32_bf16 v[78:81], v[142:145], v[38:41], v[78:81]
  v_mfma_f32_16x16x32_bf16 v[82:85], v[146:149], v[30:33], 0
  v_mfma_f32_16x16x32_bf16 v[82:85], v[150:153], v[34:37], v[82:85]
  v_mfma_f32_16x16x32_bf16 v[82:85], v[154:157], v[38:41], v[82:85]
  s_waitcnt vmcnt(12)
  v_mfma_f32_16x16x32_bf16 v[86:89], v[158:161], v[30:33], 0
  v_mfma_f32_16x16x32_bf16 v[86:89], v[162:165], v[34:37], v[86:89]
  v_mfma_f32_16x16x32_bf16 v[86:89], v[166:169], v[38:41], v[86:89]
  v_mfma_f32_16x16x32_bf16 v[90:93], v[170:173], v[30:33], 0
  v_mfma_f32_16x16x32_bf16 v[90:93], v[174:177], v[34:37], v[90:93]
  v_mfma_f32_16x16x32_bf16 v[90:93], v[178:181], v[38:41], v[90:93]
  s_waitcnt vmcnt(6)
  v_mfma_f32_16x16x32_bf16 v[94:97], v[182:185], v[30:33], 0
  v_mfma_f32_16x16x32_bf16 v[94:97], v[186:189], v[34:37], v[94:97]
  v_mfma_f32_16x16x32_bf16 v[94:97], v[190:193], v[38:41], v[94:97]
  v_mfma_f32_16x16x32_bf16 v[98:101], v[194:197], v[30:33], 0
  v_mfma_f32_16x16x32_bf16 v[98:101], v[198:201], v[34:37], v[98:101]
  v_mfma_f32_16x16x32_bf16 v[98:101], v[202:205], v[38:41], v[98:101]
  s_waitcnt vmcnt(0)
  v_mfma_f32_16x16x32_bf16 v[102:105], v[206:209], v[30:33], 0
  v_mfma_f32_16x16x32_bf16 v[102:105], v[210:213], v[34:37], v[102:105]
  v_mfma_f32_16x16x32_bf16 v[102:105], v[214:217], v[38:41], v[102:105]
  v_mfma_f32_16x16x32_bf16 v[106:109], v[218:221], v[30:33], 0
  v_mfma_f32_16x16x32_bf16 v[106:109], v[222:225], v[34:37], v[106:109]
  v_mfma_f32_16x16x32_bf16 v[106:109], v[226:229], v[38:41], v[106:109]
  v_cvt_pk_bf16_f32 v70, v70, v71
  v_cvt_pk_bf16_f32 v71, v72, v73
  v_cvt_pk_bf16_f32 v72, v74, v75
  v_cvt_pk_bf16_f32 v73, v76, v77
  buffer_store_dwordx4 v[70:73], v26, s[4:7], s33 offen sc1
  s_add_u32 s33, s33, 15360
  v_cvt_pk_bf16_f32 v78, v78, v79
  v_cvt_pk_bf16_f32 v79, v80, v81
  v_cvt_pk_bf16_f32 v80, v82, v83
  v_cvt_pk_bf16_f32 v81, v84, v85
  buffer_store_dwordx4 v[78:81], v26, s[4:7], s33 offen sc1
  s_add_u32 s33, s33, 15360
  v_cvt_pk_bf16_f32 v86, v86, v87
  v_cvt_pk_bf16_f32 v87, v88, v89
  v_cvt_pk_bf16_f32 v88, v90, v91
  v_cvt_pk_bf16_f32 v89, v92, v93
  buffer_store_dwordx4 v[86:89], v26, s[4:7], s33 offen sc1
  s_add_u32 s33, s33, 15360
  v_cvt_pk_bf16_f32 v94, v94, v95
  v_cvt_pk_bf16_f32 v95, v96, v97
  v_cvt_pk_bf16_f32 v96, v98, v99
  v_cvt_pk_bf16_f32 v97, v100, v101
  buffer_store_dwordx4 v[94:97], v26, s[4:7], s33 offen sc1
  s_add_u32 s33, s33, 15360
  v_cvt_pk_bf16_f32 v102, v102, v103
  v_cvt_pk_bf16_f32 v103, v104, v105
  v_cvt_pk_bf16_f32 v104, v106, v107
  v_cvt_pk_bf16_f32 v105, v108, v109
  buffer_store_dwordx4 v[102:105], v26, s[4:7], s33 offen sc1
  s_add_u32 s33, s33, 15360
  s_branch mega_bj
mega_bj1:
  s_cmp_ge_u32 s43, 420
  s_cbranch_scc1 mega_bj2
  s_sub_u32 s43, s43, 320
  s_mul_hi_u32 s66, s43, 0x33333334
  s_mul_i32 s67, s66, 5
  s_sub_u32 s67, s43, s67
  s_mul_i32 s31, s66, 122880
  s_lshl_b32 s40, s67, 8
  s_add_u32 s31, s31, s40
  s_add_u32 s31, s31, 2560
  s_mov_b32 s32, 30720
  s_mov_b32 s33, 15360
  s_mov_b32 s34, 3840
  s_mul_i32 s35, s66, 15360
  s_add_u32 s35, s35, 79898624
  s_lshl_b32 s36, s67, 3
  v_lshlrev_b32 v16, 2, v1
  v_lshrrev_b32 v17, 3, v1
  v_add_u32 v17, s36, v17
  v_mul_u32_u24 v18, 205, v17
  v_lshrrev_b32 v18, 10, v18
  v_mul_u32_u24 v19, 5, v18
  v_sub_u32 v17, v17, v19
  v_lshlrev_b32 v17, 10, v17
  v_mul_u32_u24 v18, 307200, v18
  v_add_u32 v17, v17, v18
  v_and_b32 v18, 7, v1
  v_lshl_add_u32 v17, v18, 5, v17
  s_mov_b32 s37, 0x05040100
  s_mov_b32 s38, 0x07060302
  s_mov_b32 s39, s31
  buffer_load_dword v22, v16, s[52:55], s39 offen
  s_add_u32 s39, s39, s34
  buffer_load_dword v23, v16, s[52:55], s39 offen
  s_add_u32 s39, s39, s34
  buffer_load_dword v24, v16, s[52:55], s39 offen
  s_add_u32 s39, s39, s34
  buffer_load_dword v25, v16, s[52:55], s39 offen
  s_add_u32 s39, s31, s33
  buffer_load_dword v26, v16, s[52:55], s39 offen
  s_add_u32 s39, s39, s34
  buffer_load_dword v27, v16, s[52:55], s39 offen
  s_add_u32 s39, s39, s34
  buffer_load_dword v28, v16, s[52:55], s39 offen
  s_add_u32 s39, s39, s34
  buffer_load_dword v29, v16, s[52:55], s39 offen
  s_add_u32 s31, s31, s32
  s_mov_b32 s39, s31
  buffer_load_dword v30, v16, s[52:55], s39 offen
  s_add_u32 s39, s39, s34
  buffer_load_dword v31, v16, s[52:55], s39 offen
  s_add_u32 s39, s39, s34
  buffer_load_dword v32, v16, s[52:55], s39 offen
  s_add_u32 s39, s39, s34
  buffer_load_dword v33, v16, s[52:55], s39 offen
  s_add_u32 s39, s31, s33
  buffer_load_dword v34, v16, s[52:55], s39 offen
  s_add_u32 s39, s39, s34
  buffer_load_dword v35, v16, s[52:55], s39 offen
  s_add_u32 s39, s39, s34
  buffer_load_dword v36, v16, s[52:55], s39 offen
  s_add_u32 s39, s39, s34
  buffer_load_dword v37, v16, s[52:55], s39 offen
  s_add_u32 s31, s31, s32
  s_mov_b32 s39, s31
  buffer_load_dword v38, v16, s[52:55], s39 offen
  s_add_u32 s39, s39, s34
  buffer_load_dword v39, v16, s[52:55], s39 offen
  s_add_u32 s39, s39, s34
  buffer_load_dword v40, v16, s[52:55], s39 offen
  s_add_u32 s39, s39, s34
  buffer_load_dword v41, v16, s[52:55], s39 offen
  s_add_u32 s39, s31, s33
  buffer_load_dword v42, v16, s[52:55], s39 offen
  s_add_u32 s39, s39, s34
  buffer_load_dword v43, v16, s[52:55], s39 offen
  s_add_u32 s39, s39, s34
  buffer_load_dword v44, v16, s[52:55], s39 offen
  s_add_u32 s39, s39, s34
  buffer_load_dword v45, v16, s[52:55], s39 offen
  s_add_u32 s31, s31, s32
  s_mov_b32 s39, s31
  buffer_load_dword v46, v16, s[52:55], s39 offen
  s_add_u32 s39, s39, s34
  buffer_load_dword v47, v16, s[52:55], s39 offen
  s_add_u32 s39, s39, s34
  buffer_load_dword v48, v16, s[52:55], s39 offen
  s_add_u32 s39, s39, s34
  buffer_load_dword v49, v16, s[52:55], s39 offen
  s_add_u32 s39, s31, s33
  buffer_load_dword v50, v16, s[52:55], s39 offen
  s_add_u32 s39, s39, s34
  buffer_load_dword v51, v16, s[52:55], s39 offen
  s_add_u32 s39, s39, s34
  buffer_load_dword v52, v16, s[52:55], s39 offen
  s_add_u32 s39, s39, s34
  buffer_load_dword v53, v16, s[52:55], s39 offen
  s_waitcnt vmcnt(24)
  v_perm_b32 v54, v23, v22, s37
  v_perm_b32 v58, v23, v22, s38
  v_perm_b32 v55, v25, v24, s37
  v_perm_b32 v59, v25, v24, s38
  v_perm_b32 v56, v27, v26, s37
  v_perm_b32 v60, v27, v26, s38
  v_perm_b32 v57, v29, v28, s37
  v_perm_b32 v61, v29, v28, s38
  buffer_store_dwordx4 v[54:57], v17, s[4:7], s35 offen offset:0 sc1
  buffer_store_dwordx4 v[58:61], v17, s[4:7], s35 offen offset:16 sc1
  s_waitcnt vmcnt(18)
  v_perm_b32 v62, v31, v30, s37
  v_perm_b32 v66, v31, v30, s38
  v_perm_b32 v63, v33, v32, s37
  v_perm_b32 v67, v33, v32, s38
  v_perm_b32 v64, v35, v34, s37
  v_perm_b32 v68, v35, v34, s38
  v_perm_b32 v65, v37, v36, s37
  v_perm_b32 v69, v37, v36, s38
  buffer_store_dwordx4 v[62:65], v17, s[4:7], s35 offen offset:256 sc1
  buffer_store_dwordx4 v[66:69], v17, s[4:7], s35 offen offset:272 sc1
  s_waitcnt vmcnt(12)
  v_perm_b32 v70, v39, v38, s37
  v_perm_b32 v74, v39, v38, s38
  v_perm_b32 v71, v41, v40, s37
  v_perm_b32 v75, v41, v40, s38
  v_perm_b32 v72, v43, v42, s37
  v_perm_b32 v76, v43, v42, s38
  v_perm_b32 v73, v45, v44, s37
  v_perm_b32 v77, v45, v44, s38
  buffer_store_dwordx4 v[70:73], v17, s[4:7], s35 offen offset:512 sc1
  buffer_store_dwordx4 v[74:77], v17, s[4:7], s35 offen offset:528 sc1
  s_waitcnt vmcnt(6)
  v_perm_b32 v78, v47, v46, s37
  v_perm_b32 v82, v47, v46, s38
  v_perm_b32 v79, v49, v48, s37
  v_perm_b32 v83, v49, v48, s38
  v_perm_b32 v80, v51, v50, s37
  v_perm_b32 v84, v51, v50, s38
  v_perm_b32 v81, v53, v52, s37
  v_perm_b32 v85, v53, v52, s38
  buffer_store_dwordx4 v[78:81], v17, s[4:7], s35 offen offset:768 sc1
  buffer_store_dwordx4 v[82:85], v17, s[4:7], s35 offen offset:784 sc1
  s_branch mega_bj
mega_bj2:
  s_sub_u32 s43, s43, 420
  s_mul_hi_u32 s66, s43, 0x33333334
  s_mul_i32 s67, s66, 5
  s_sub_u32 s67, s43, s67
  s_mul_hi_u32 s64, s66, 0x33333334
  s_mul_i32 s65, s64, 5
  s_sub_u32 s65, s66, s65
  s_lshl_b32 s40, s65, 3
  s_add_u32 s41, s40, 60
  s_cmp_lt_u32 s65, 3
  s_cselect_b32 s40, s40, s41
  s_cmp_eq_u32 s65, 2
  s_cselect_b32 s33, 64, 4
  s_mul_i32 s33, s33, 1280
  s_mul_i32 s41, s64, 160
  s_add_u32 s40, s40, s41
  s_mul_i32 s31, s40, 1280
  s_lshl_b32 s40, s67, 8
  s_add_u32 s31, s31, s40
  s_mov_b32 s32, 25600
  s_mov_b32 s34, 1280
  s_mul_i32 s35, s67, 163840
  s_lshl_b32 s40, s66, 10
  s_add_u32 s35, s35, s40
  s_add_u32 s35, s35, 82345984
  s_mov_b32 s36, 20480
  v_lshlrev_b32 v16, 2, v1
  v_lshrrev_b32 v17, 3, v1
  v_mul_lo_u32 v17, v17, s36
  v_and_b32 v18, 7, v1
  v_lshl_add_u32 v17, v18, 5, v17
  s_mov_b32 s37, 0x05040100
  s_mov_b32 s38, 0x07060302
  s_mov_b32 s39, s31
  buffer_load_dword v22, v16, s[60:63], s39 offen
  s_add_u32 s39, s39, s34
  buffer_load_dword v23, v16, s[60:63], s39 offen
  s_add_u32 s39, s39, s34
  buffer_load_dword v24, v16, s[60:63], s39 offen
  s_add_u32 s39, s39, s34
  buffer_load_dword v25, v16, s[60:63], s39 offen
  s_add_u32 s39, s31, s33
  buffer_load_dword v26, v16, s[60:63], s39 offen
  s_add_u32 s39, s39, s34
  buffer_load_dword v27, v16, s[60:63], s39 offen
  s_add_u32 s39, s39, s34
  buffer_load_dword v28, v16, s[60:63], s39 offen
  s_add_u32 s39, s39, s34
  buffer_load_dword v29, v16, s[60:63], s39 offen
  s_add_u32 s31, s31, s32
  s_mov_b32 s39, s31
  buffer_load_dword v30, v16, s[60:63], s39 offen
  s_add_u32 s39, s39, s34
  buffer_load_dword v31, v16, s[60:63], s39 offen
  s_add_u32 s39, s39, s34
  buffer_load_dword v32, v16, s[60:63], s39 offen
  s_add_u32 s39, s39, s34
  buffer_load_dword v33, v16, s[60:63], s39 offen
  s_add_u32 s39, s31, s33
  buffer_load_dword v34, v16, s[60:63], s39 offen
  s_add_u32 s39, s39, s34
  buffer_load_dword v35, v16, s[60:63], s39 offen
  s_add_u32 s39, s39, s34
  buffer_load_dword v36, v16, s[60:63], s39 offen
  s_add_u32 s39, s39, s34
  buffer_load_dword v37, v16, s[60:63], s39 offen
  s_add_u32 s31, s31, s32
  s_mov_b32 s39, s31
  buffer_load_dword v38, v16, s[60:63], s39 offen
  s_add_u32 s39, s39, s34
  buffer_load_dword v39, v16, s[60:63], s39 offen
  s_add_u32 s39, s39, s34
  buffer_load_dword v40, v16, s[60:63], s39 offen
  s_add_u32 s39, s39, s34
  buffer_load_dword v41, v16, s[60:63], s39 offen
  s_add_u32 s39, s31, s33
  buffer_load_dword v42, v16, s[60:63], s39 offen
  s_add_u32 s39, s39, s34
  buffer_load_dword v43, v16, s[60:63], s39 offen
  s_add_u32 s39, s39, s34
  buffer_load_dword v44, v16, s[60:63], s39 offen
  s_add_u32 s39, s39, s34
  buffer_load_dword v45, v16, s[60:63], s39 offen
  s_add_u32 s31, s31, s32
  s_mov_b32 s39, s31
  buffer_load_dword v46, v16, s[60:63], s39 offen
  s_add_u32 s39, s39, s34
  buffer_load_dword v47, v16, s[60:63], s39 offen
  s_add_u32 s39, s39, s34
  buffer_load_dword v48, v16, s[60:63], s39 offen
  s_add_u32 s39, s39, s34
  buffer_load_dword v49, v16, s[60:63], s39 offen
  s_add_u32 s39, s31, s33
  buffer_load_dword v50, v16, s[60:63], s39 offen
  s_add_u32 s39, s39, s34
  buffer_load_dword v51, v16, s[60:63], s39 offen
  s_add_u32 s39, s39, s34
  buffer_load_dword v52, v16, s[60:63], s39 offen
  s_add_u32 s39, s39, s34
  buffer_load_dword v53, v16, s[60:63], s39 offen
  s_waitcnt vmcnt(24)
  v_perm_b32 v54, v23, v22, s37
  v_perm_b32 v58, v23, v22, s38
  v_perm_b32 v55, v25, v24, s37
  v_perm_b32 v59, v25, v24, s38
  v_perm_b32 v56, v27, v26, s37
  v_perm_b32 v60, v27, v26, s38
  v_perm_b32 v57, v29, v28, s37
  v_perm_b32 v61, v29, v28, s38
  buffer_store_dwordx4 v[54:57], v17, s[4:7], s35 offen offset:0 sc1
  buffer_store_dwordx4 v[58:61], v17, s[4:7], s35 offen offset:16 sc1
  s_waitcnt vmcnt(18)
  v_perm_b32 v62, v31, v30, s37
  v_perm_b32 v66, v31, v30, s38
  v_perm_b32 v63, v33, v32, s37
  v_perm_b32 v67, v33, v32, s38
  v_perm_b32 v64, v35, v34, s37
  v_perm_b32 v68, v35, v34, s38
  v_perm_b32 v65, v37, v36, s37
  v_perm_b32 v69, v37, v36, s38
  buffer_store_dwordx4 v[62:65], v17, s[4:7], s35 offen offset:256 sc1
  buffer_store_dwordx4 v[66:69], v17, s[4:7], s35 offen offset:272 sc1
  s_waitcnt vmcnt(12)
  v_perm_b32 v70, v39, v38, s37
  v_perm_b32 v74, v39, v38, s38
  v_perm_b32 v71, v41, v40, s37
  v_perm_b32 v75, v41, v40, s38
  v_perm_b32 v72, v43, v42, s37
  v_perm_b32 v76, v43, v42, s38
  v_perm_b32 v73, v45, v44, s37
  v_perm_b32 v77, v45, v44, s38
  buffer_store_dwordx4 v[70:73], v17, s[4:7], s35 offen offset:512 sc1
  buffer_store_dwordx4 v[74:77], v17, s[4:7], s35 offen offset:528 sc1
  s_waitcnt vmcnt(6)
  v_perm_b32 v78, v47, v46, s37
  v_perm_b32 v82, v47, v46, s38
  v_perm_b32 v79, v49, v48, s37
  v_perm_b32 v83, v49, v48, s38
  v_perm_b32 v80, v51, v50, s37
  v_perm_b32 v84, v51, v50, s38
  v_perm_b32 v81, v53, v52, s37
  v_perm_b32 v85, v53, v52, s38
  buffer_store_dwordx4 v[78:81], v17, s[4:7], s35 offen offset:768 sc1
  buffer_store_dwordx4 v[82:85], v17, s[4:7], s35 offen offset:784 sc1
  s_branch mega_bj
mega_bjdone:
  s_branch mega_kv_eb
mega_kv_tout:
  v_and_b32 v84, 15, v1
  v_and_b32 v86, 3, v1
  v_bfe_u32 v85, v1, 2, 1
  v_lshl_add_u32 v85, v85, 3, v86
  v_lshlrev_b32 v85, 4, v85
  v_bfe_u32 v87, v1, 3, 1
  v_lshl_add_u32 v85, v87, 10, v85
  v_lshrrev_b32 v87, 4, v1
  v_lshl_add_u32 v10, v87, 8, v85
  v_add_u32 v15, 20480, v2
  v_lshrrev_b32 v85, 2, v84
  v_lshlrev_b32 v85, 7, v85
  v_lshl_add_u32 v85, v86, 2, v85
  s_lshl_b32 s15, s68, 9
  v_add_u32 v85, s15, v85
  v_add_u32 v86, 8192, v85
  v_add_u32 v87, 16400, v85
  v_add_u32 v88, 12288, v85
  v_cmp_gt_u32 vcc, 32, v1
  s_nop 1
  v_cndmask_b32 v87, v88, v87, vcc
  s_lshl_b32 s15, s80, 7
  s_add_u32 s15, s15, 16384
  v_mov_b32 v85, s15
  v_cmp_gt_u32 vcc, 16, v1
  s_nop 1
  v_cndmask_b32 v11, v85, v86, vcc
  v_cndmask_b32 v12, v87, v86, vcc
  v_cndmask_b32 v13, 0, 1, vcc
  s_lshl_b32 s28, s26, 11
  s_add_u32 s28, s28, s78
  s_add_u32 s16, s78, 315392
  v_add_u32 v84, 81920, v2
  s_mul_i32 s31, s68, 40
  s_add_u32 s31, s31, s26
  s_lshl_b32 s31, s31, 10
  s_add_u32 s31, s31, 53673984
  s_mov_b32 s32, 0x40000000
  s_lshl_b32 s33, s26, 3
  s_add_u32 s33, s33, s68
  s_lshl_b32 s33, s33, 7
  s_add_u32 s33, s33, s71
  s_add_u32 s33, s33, 20480
  s_mov_b32 s34, 0
  s_add_u32 s51, s25, 16
  v_mov_b32 v14, 0
mega_kv_tl:
  s_add_u32 s36, s28, s48
  s_add_u32 s37, s36, 40960
  s_add_u32 s38, s36, 81920
  s_add_u32 s39, s36, 122880
  s_add_u32 s40, s36, 163840
  s_add_u32 s35, s34, 2
  s_add_u32 s50, s34, 1
  s_mov_b32 s30, 0
  s_branch mega_kernel_pv9_t
mega_kernel_pv9:
  buffer_load_dword v14, v11, s[4:7], s71 offen sc1
  s_waitcnt vmcnt(0)
mega_kernel_pv9_t:
  v_add_u32 v14, v14, v13
  v_cmp_gt_u32 vcc, s35, v14
  s_nop 0
  s_cbranch_vccz mega_kernel_pv9_ok
  s_sleep 2
  s_add_u32 s30, s30, 1
  s_cmp_lt_u32 s30, 262144
  s_cbranch_scc1 mega_kernel_pv9
  s_branch mega_fail
mega_kernel_pv9_ok:
  s_barrier
  ds_read_b128 v[16:19], v5 offset:0
  ds_read_b128 v[20:23], v5 offset:20480
  ds_read_b128 v[24:27], v5 offset:1024
  ds_read_b128 v[28:31], v5 offset:21504
  ds_read_b128 v[32:35], v5 offset:2048
  ds_read_b128 v[36:39], v5 offset:22528
  s_waitcnt lgkmcnt(4)
  v_mfma_f32_16x16x32_bf16 v[48:51], a[0:3], v[16:19], 0
  ds_read_b128 v[40:43], v5 offset:3072
  v_mfma_f32_16x16x32_bf16 v[52:55], a[80:83], v[16:19], 0
  s_mov_b32 m0, s23
  s_add_u32 s18, s29, s48
  buffer_load_dwordx4 v2, s[4:7], s18 offen sc1 lds
  v_mfma_f32_16x16x32_bf16 v[56:59], a[160:163], v[16:19], 0
  v_mfma_f32_16x16x32_bf16 v[60:63], a[0:3], v[20:23], 0
  ds_read_b128 v[44:47], v5 offset:23552
  v_mfma_f32_16x16x32_bf16 v[64:67], a[80:83], v[20:23], 0
  s_add_u32 s17, s14, s20
  buffer_load_dwordx4 v2, s[4:7], s18 offen offset:1024 sc1 lds
  v_mfma_f32_16x16x32_bf16 v[68:71], a[160:163], v[20:23], 0
  s_waitcnt lgkmcnt(4)
  v_mfma_f32_16x16x32_bf16 v[48:51], a[4:7], v[24:27], v[48:51]
  ds_read_b128 v[16:19], v5 offset:4096
  v_mfma_f32_16x16x32_bf16 v[52:55], a[84:87], v[24:27], v[52:55]
  buffer_load_dwordx4 v2, s[4:7], s18 offen offset:2048 sc1 lds
  v_mfma_f32_16x16x32_bf16 v[56:59], a[164:167], v[24:27], v[56:59]
  v_mfma_f32_16x16x32_bf16 v[60:63], a[4:7], v[28:31], v[60:63]
  ds_read_b128 v[20:23], v5 offset:24576
  v_mfma_f32_16x16x32_bf16 v[64:67], a[84:87], v[28:31], v[64:67]
  buffer_load_dwordx4 v[96:99], v10, s[4:7], s36 offen offset:0 sc1
  v_mfma_f32_16x16x32_bf16 v[68:71], a[164:167], v[28:31], v[68:71]
  s_waitcnt lgkmcnt(4)
  v_mfma_f32_16x16x32_bf16 v[48:51], a[8:11], v[32:35], v[48:51]
  ds_read_b128 v[24:27], v5 offset:5120
  v_mfma_f32_16x16x32_bf16 v[52:55], a[88:91], v[32:35], v[52:55]
  buffer_load_dwordx4 v[100:103], v10, s[4:7], s36 offen offset:64 sc1
  v_mfma_f32_16x16x32_bf16 v[56:59], a[168:171], v[32:35], v[56:59]
  v_mfma_f32_16x16x32_bf16 v[60:63], a[8:11], v[36:39], v[60:63]
  ds_read_b128 v[28:31], v5 offset:25600
  v_mfma_f32_16x16x32_bf16 v[64:67], a[88:91], v[36:39], v[64:67]
  buffer_load_dwordx4 v[104:107], v10, s[4:7], s37 offen offset:0 sc1
  v_mfma_f32_16x16x32_bf16 v[68:71], a[168:171], v[36:39], v[68:71]
  s_waitcnt lgkmcnt(4)
  v_mfma_f32_16x16x32_bf16 v[48:51], a[12:15], v[40:43], v[48:51]
  ds_read_b128 v[32:35], v5 offset:6144
  v_mfma_f32_16x16x32_bf16 v[52:55], a[92:95], v[40:43], v[52:55]
  buffer_load_dwordx4 v[108:111], v10, s[4:7], s37 offen offset:64 sc1
  v_mfma_f32_16x16x32_bf16 v[56:59], a[172:175], v[40:43], v[56:59]
  v_mfma_f32_16x16x32_bf16 v[60:63], a[12:15], v[44:47], v[60:63]
  ds_read_b128 v[36:39], v5 offset:26624
  v_mfma_f32_16x16x32_bf16 v[64:67], a[92:95], v[44:47], v[64:67]
  v_mfma_f32_16x16x32_bf16 v[68:71], a[172:175], v[44:47], v[68:71]
  buffer_load_dwordx4 v[112:115], v10, s[4:7], s38 offen offset:0 sc1
  s_waitcnt lgkmcnt(4)
  v_mfma_f32_16x16x32_bf16 v[48:51], a[16:19], v[16:19], v[48:51]
  ds_read_b128 v[40:43], v5 offset:7168
  v_mfma_f32_16x16x32_bf16 v[52:55], a[96:99], v[16:19], v[52:55]
  v_mfma_f32_16x16x32_bf16 v[56:59], a[176:179], v[16:19], v[56:59]
  buffer_load_dwordx4 v[116:119], v10, s[4:7], s38 offen offset:64 sc1
  v_mfma_f32_16x16x32_bf16 v[60:63], a[16:19], v[20:23], v[60:63]
  ds_read_b128 v[44:47], v5 offset:27648
  v_mfma_f32_16x16x32_bf16 v[64:67], a[96:99], v[20:23], v[64:67]
  v_mfma_f32_16x16x32_bf16 v[68:71], a[176:179], v[20:23], v[68:71]
  buffer_load_dwordx4 v[120:123], v10, s[4:7], s39 offen offset:0 sc1
  s_waitcnt lgkmcnt(4)
  v_mfma_f32_16x16x32_bf16 v[48:51], a[20:23], v[24:27], v[48:51]
  ds_read_b128 v[16:19], v5 offset:8192
  v_mfma_f32_16x16x32_bf16 v[52:55], a[100:103], v[24:27], v[52:55]
  v_mfma_f32_16x16x32_bf16 v[56:59], a[180:183], v[24:27], v[56:59]
  buffer_load_dwordx4 v[124:127], v10, s[4:7], s39 offen offset:64 sc1
  v_mfma_f32_16x16x32_bf16 v[60:63], a[20:23], v[28:31], v[60:63]
  ds_read_b128 v[20:23], v5 offset:28672
  v_mfma_f32_16x16x32_bf16 v[64:67], a[100:103], v[28:31], v[64:67]
  v_mfma_f32_16x16x32_bf16 v[68:71], a[180:183], v[28:31], v[68:71]
  buffer_load_dwordx4 v[128:131], v10, s[4:7], s40 offen offset:0 sc1
  s_waitcnt lgkmcnt(4)
  v_mfma_f32_16x16x32_bf16 v[48:51], a[24:27], v[32:35], v[48:51]
  ds_read_b128 v[24:27], v5 offset:9216
  v_mfma_f32_16x16x32_bf16 v[52:55], a[104:107], v[32:35], v[52:55]
  v_mfma_f32_16x16x32_bf16 v[56:59], a[184:187], v[32:35], v[56:59]
  buffer_load_dwordx4 v[132:135], v10, s[4:7], s40 offen offset:64 sc1
  v_mfma_f32_16x16x32_bf16 v[60:63], a[24:27], v[36:39], v[60:63]
  ds_read_b128 v[28:31], v5 offset:29696
  v_mfma_f32_16x16x32_bf16 v[64:67], a[104:107], v[36:39], v[64:67]
  v_mfma_f32_16x16x32_bf16 v[68:71], a[184:187], v[36:39], v[68:71]
  s_waitcnt lgkmcnt(4)
  v_mfma_f32_16x16x32_bf16 v[48:51], a[28:31], v[40:43], v[48:51]
  ds_read_b128 v[32:35], v5 offset:10240
  v_mfma_f32_16x16x32_bf16 v[52:55], a[108:111], v[40:43], v[52:55]
  s_add_u32 m0, s13, 0
  s_add_u32 s18, s12, 0
  buffer_load_dwordx4 v2, s[4:7], s18 offen offset:0 lds
  v_mfma_f32_16x16x32_bf16 v[56:59], a[188:191], v[40:43], v[56:59]
  v_mfma_f32_16x16x32_bf16 v[60:63], a[28:31], v[44:47], v[60:63]
  ds_read_b128 v[36:39], v5 offset:30720
  v_mfma_f32_16x16x32_bf16 v[64:67], a[108:111], v[44:47], v[64:67]
  buffer_load_dwordx4 v2, s[4:7], s18 offen offset:1024 lds
  v_mfma_f32_16x16x32_bf16 v[68:71], a[188:191], v[44:47], v[68:71]
  s_waitcnt lgkmcnt(4)
  v_mfma_f32_16x16x32_bf16 v[48:51], a[32:35], v[16:19], v[48:51]
  ds_read_b128 v[40:43], v5 offset:11264
  v_mfma_f32_16x16x32_bf16 v[52:55], a[112:115], v[16:19], v[52:55]
  v_mfma_f32_16x16x32_bf16 v[56:59], a[192:195], v[16:19], v[56:59]
  buffer_load_dwordx4 v2, s[4:7], s18 offen offset:2048 lds
  v_mfma_f32_16x16x32_bf16 v[60:63], a[32:35], v[20:23], v[60:63]
  ds_read_b128 v[44:47], v5 offset:31744
  v_mfma_f32_16x16x32_bf16 v[64:67], a[112:115], v[20:23], v[64:67]
  v_mfma_f32_16x16x32_bf16 v[68:71], a[192:195], v[20:23], v[68:71]
  s_waitcnt lgkmcnt(4)
  v_mfma_f32_16x16x32_bf16 v[48:51], a[36:39], v[24:27], v[48:51]
  ds_read_b128 v[16:19], v5 offset:12288
  v_mfma_f32_16x16x32_bf16 v[52:55], a[116:119], v[24:27], v[52:55]
  buffer_load_dwordx4 v2, s[4:7], s18 offen offset:3072 lds
  v_mfma_f32_16x16x32_bf16 v[56:59], a[196:199], v[24:27], v[56:59]
  v_mfma_f32_16x16x32_bf16 v[60:63], a[36:39], v[28:31], v[60:63]
  ds_read_b128 v[20:23], v5 offset:32768
  v_mfma_f32_16x16x32_bf16 v[64:67], a[116:119], v[28:31], v[64:67]
  v_mfma_f32_16x16x32_bf16 v[68:71], a[196:199], v[28:31], v[68:71]
  s_add_u32 m0, s13, 4096
  s_add_u32 s18, s12, 4096
  buffer_load_dwordx4 v2, s[4:7], s18 offen offset:0 lds
  s_waitcnt vmcnt(5)
  s_barrier
  v_mov_b32 v8, s50
  s_mov_b64 exec, 1
  s_cmp_lg_u32 s69, 0
  s_cbranch_scc1 mega_kernel_pf10
  buffer_store_dword v8, v7, s[4:7], s51 offen
mega_kernel_pf10_b:
  s_mov_b64 exec, -1
  s_waitcnt lgkmcnt(4)
  v_mfma_f32_16x16x32_bf16 v[48:51], a[40:43], v[32:35], v[48:51]
  ds_read_b128 v[24:27], v5 offset:13312
  v_mfma_f32_16x16x32_bf16 v[52:55], a[120:123], v[32:35], v[52:55]
  v_mfma_f32_16x16x32_bf16 v[56:59], a[200:203], v[32:35], v[56:59]
  v_mfma_f32_16x16x32_bf16 v[60:63], a[40:43], v[36:39], v[60:63]
  ds_read_b128 v[28:31], v5 offset:33792
  v_mfma_f32_16x16x32_bf16 v[64:67], a[120:123], v[36:39], v[64:67]
  buffer_load_dwordx4 v2, s[4:7], s18 offen offset:1024 lds
  v_mfma_f32_16x16x32_bf16 v[68:71], a[200:203], v[36:39], v[68:71]
  s_waitcnt lgkmcnt(4)
  v_mfma_f32_16x16x32_bf16 v[48:51], a[44:47], v[40:43], v[48:51]
  ds_read_b128 v[32:35], v5 offset:14336
  v_mfma_f32_16x16x32_bf16 v[52:55], a[124:127], v[40:43], v[52:55]
  buffer_load_dwordx4 v2, s[4:7], s18 offen offset:2048 lds
  v_mfma_f32_16x16x32_bf16 v[56:59], a[204:207], v[40:43], v[56:59]
  v_mfma_f32_16x16x32_bf16 v[60:63], a[44:47], v[44:47], v[60:63]
  ds_read_b128 v[36:39], v5 offset:34816
  v_mfma_f32_16x16x32_bf16 v[64:67], a[124:127], v[44:47], v[64:67]
  v_mfma_f32_16x16x32_bf16 v[68:71], a[204:207], v[44:47], v[68:71]
  buffer_load_dwordx4 v2, s[4:7], s18 offen offset:3072 lds
  s_waitcnt lgkmcnt(4)
  v_mfma_f32_16x16x32_bf16 v[48:51], a[48:51], v[16:19], v[48:51]
  ds_read_b128 v[40:43], v5 offset:15360
  v_mfma_f32_16x16x32_bf16 v[52:55], a[128:131], v[16:19], v[52:55]
  v_mfma_f32_16x16x32_bf16 v[56:59], a[208:211], v[16:19], v[56:59]
  v_mfma_f32_16x16x32_bf16 v[60:63], a[48:51], v[20:23], v[60:63]
  ds_read_b128 v[44:47], v5 offset:35840
  v_mfma_f32_16x16x32_bf16 v[64:67], a[128:131], v[20:23], v[64:67]
  s_add_u32 m0, s13, 8192
  s_add_u32 s18, s12, 8192
  buffer_load_dwordx4 v2, s[4:7], s18 offen offset:0 lds
  v_mfma_f32_16x16x32_bf16 v[68:71], a[208:211], v[20:23], v[68:71]
  s_waitcnt lgkmcnt(4)
  v_mfma_f32_16x16x32_bf16 v[48:51], a[52:55], v[24:27], v[48:51]
  ds_read_b128 v[16:19], v5 offset:16384
  v_mfma_f32_16x16x32_bf16 v[52:55], a[132:135], v[24:27], v[52:55]
  v_mfma_f32_16x16x32_bf16 v[56:59], a[212:215], v[24:27], v[56:59]
  buffer_load_dwordx4 v2, s[4:7], s18 offen offset:1024 lds
  v_mfma_f32_16x16x32_bf16 v[60:63], a[52:55], v[28:31], v[60:63]
  ds_read_b128 v[20:23], v5 offset:36864
  v_mfma_f32_16x16x32_bf16 v[64:67], a[132:135], v[28:31], v[64:67]
  v_mfma_f32_16x16x32_bf16 v[68:71], a[212:215], v[28:31], v[68:71]
  s_waitcnt lgkmcnt(4)
  v_mfma_f32_16x16x32_bf16 v[48:51], a[56:59], v[32:35], v[48:51]
  ds_read_b128 v[24:27], v5 offset:17408
  v_mfma_f32_16x16x32_bf16 v[52:55], a[136:139], v[32:35], v[52:55]
  buffer_store_dwordx4 v[192:195], v2, s[4:7], s32 offen sc1
  v_mfma_f32_16x16x32_bf16 v[56:59], a[216:219], v[32:35], v[56:59]
  buffer_store_dwordx4 v[196:199], v15, s[4:7], s32 offen sc1
  v_mfma_f32_16x16x32_bf16 v[60:63], a[56:59], v[36:39], v[60:63]
  ds_read_b128 v[28:31], v5 offset:37888
  v_mfma_f32_16x16x32_bf16 v[64:67], a[136:139], v[36:39], v[64:67]
  s_add_i32 s15, s34, -1
  s_max_i32 s15, s15, 0
  v_mov_b32 v8, s15
  s_mov_b64 exec, 1
  buffer_store_dword v8, v7, s[4:7], s33 offen sc1
  s_mov_b64 exec, -1
  v_mfma_f32_16x16x32_bf16 v[68:71], a[216:219], v[36:39], v[68:71]
  s_waitcnt lgkmcnt(4)
  v_mfma_f32_16x16x32_bf16 v[48:51], a[60:63], v[40:43], v[48:51]
  ds_read_b128 v[32:35], v5 offset:18432
  v_mfma_f32_16x16x32_bf16 v[52:55], a[140:143], v[40:43], v[52:55]
  v_mfma_f32_16x16x32_bf16 v[56:59], a[220:223], v[40:43], v[56:59]
  v_mfma_f32_16x16x32_bf16 v[60:63], a[60:63], v[44:47], v[60:63]
  ds_read_b128 v[36:39], v5 offset:38912
  v_mfma_f32_16x16x32_bf16 v[64:67], a[140:143], v[44:47], v[64:67]
  v_mfma_f32_16x16x32_bf16 v[68:71], a[220:223], v[44:47], v[68:71]
  s_waitcnt lgkmcnt(4)
  v_mfma_f32_16x16x32_bf16 v[48:51], a[64:67], v[16:19], v[48:51]
  ds_read_b128 v[40:43], v5 offset:19456
  v_mfma_f32_16x16x32_bf16 v[52:55], a[144:147], v[16:19], v[52:55]
  v_mfma_f32_16x16x32_bf16 v[56:59], a[224:227], v[16:19], v[56:59]
  v_mfma_f32_16x16x32_bf16 v[60:63], a[64:67], v[20:23], v[60:63]
  ds_read_b128 v[44:47], v5 offset:39936
  v_mfma_f32_16x16x32_bf16 v[64:67], a[144:147], v[20:23], v[64:67]
  v_mfma_f32_16x16x32_bf16 v[68:71], a[224:227], v[20:23], v[68:71]
  s_waitcnt lgkmcnt(4)
  v_mfma_f32_16x16x32_bf16 v[48:51], a[68:71], v[24:27], v[48:51]
  ds_read_b128 v[136:139], v84 offset:0
  v_mfma_f32_16x16x32_bf16 v[52:55], a[148:151], v[24:27], v[52:55]
  ds_read_b128 v[140:143], v84 offset:5120
  v_mfma_f32_16x16x32_bf16 v[56:59], a[228:231], v[24:27], v[56:59]
  ds_read_b128 v[144:147], v84 offset:1024
  v_mfma_f32_16x16x32_bf16 v[60:63], a[68:71], v[28:31], v[60:63]
  ds_read_b128 v[148:151], v84 offset:6144
  v_mfma_f32_16x16x32_bf16 v[64:67], a[148:151], v[28:31], v[64:67]
  ds_read_b128 v[152:155], v84 offset:2048
  v_mfma_f32_16x16x32_bf16 v[68:71], a[228:231], v[28:31], v[68:71]
  ds_read_b128 v[156:159], v84 offset:7168
  s_waitcnt lgkmcnt(8)
  v_mfma_f32_16x16x32_bf16 v[48:51], a[72:75], v[32:35], v[48:51]
  ds_read_b128 v[160:163], v84 offset:3072
  v_mfma_f32_16x16x32_bf16 v[52:55], a[152:155], v[32:35], v[52:55]
  ds_read_b128 v[164:167], v84 offset:8192
  v_mfma_f32_16x16x32_bf16 v[56:59], a[232:235], v[32:35], v[56:59]
  ds_read_b128 v[168:171], v84 offset:4096
  v_mfma_f32_16x16x32_bf16 v[60:63], a[72:75], v[36:39], v[60:63]
  ds_read_b128 v[172:175], v84 offset:9216
  v_mfma_f32_16x16x32_bf16 v[64:67], a[152:155], v[36:39], v[64:67]
  v_mfma_f32_16x16x32_bf16 v[68:71], a[232:235], v[36:39], v[68:71]
  s_waitcnt lgkmcnt(10)
  v_mfma_f32_16x16x32_bf16 v[48:51], a[76:79], v[40:43], v[48:51]
  v_mfma_f32_16x16x32_bf16 v[52:55], a[156:159], v[40:43], v[52:55]
  v_mfma_f32_16x16x32_bf16 v[56:59], a[236:239], v[40:43], v[56:59]
  v_mfma_f32_16x16x32_bf16 v[60:63], a[76:79], v[44:47], v[60:63]
  v_mfma_f32_16x16x32_bf16 v[64:67], a[156:159], v[44:47], v[64:67]
  v_mfma_f32_16x16x32_bf16 v[68:71], a[236:239], v[44:47], v[68:71]
  v_add_u32 v5, s19, v5
  s_sub_u32 s13, s13, s19
  s_sub_u32 s19, 0, s19
  s_add_u32 s12, s12, 40960
  s_add_u32 s24, s24, 1
  s_waitcnt lgkmcnt(0)
  v_mfma_f32_16x16x32_bf16 v[176:179], v[96:99], v[136:139], 0
  v_cvt_pk_bf16_f32 v72, v48, v49
  v_cvt_pk_bf16_f32 v73, v50, v51
  v_mfma_f32_16x16x32_bf16 v[184:187], v[96:99], v[140:143], 0
  v_cvt_pk_bf16_f32 v74, v52, v53
  v_cvt_pk_bf16_f32 v75, v54, v55
  v_mfma_f32_16x16x32_bf16 v[180:183], v[100:103], v[136:139], 0
  v_cvt_pk_bf16_f32 v80, v56, v57
  v_cvt_pk_bf16_f32 v81, v58, v59
  v_mfma_f32_16x16x32_bf16 v[188:191], v[100:103], v[140:143], 0
  buffer_store_dwordx4 v[72:75], v3, s[4:7], s17 offen
  v_cvt_pk_bf16_f32 v76, v60, v61
  v_mfma_f32_16x16x32_bf16 v[176:179], v[104:107], v[144:147], v[176:179]
  v_cvt_pk_bf16_f32 v77, v62, v63
  v_cvt_pk_bf16_f32 v78, v64, v65
  v_mfma_f32_16x16x32_bf16 v[184:187], v[104:107], v[148:151], v[184:187]
  v_cvt_pk_bf16_f32 v79, v66, v67
  v_cvt_pk_bf16_f32 v82, v68, v69
  v_mfma_f32_16x16x32_bf16 v[180:183], v[108:111], v[144:147], v[180:183]
  v_cvt_pk_bf16_f32 v83, v70, v71
  buffer_store_dwordx4 v[76:79], v4, s[4:7], s17 offen
  v_mfma_f32_16x16x32_bf16 v[188:191], v[108:111], v[148:151], v[188:191]
  buffer_store_dwordx4 v[80:83], v9, s[4:7], s17 offen
  buffer_load_dword v14, v11, s[4:7], s71 offen sc1
  v_mfma_f32_16x16x32_bf16 v[176:179], v[112:115], v[152:155], v[176:179]
  v_mfma_f32_16x16x32_bf16 v[184:187], v[112:115], v[156:159], v[184:187]
  v_mfma_f32_16x16x32_bf16 v[180:183], v[116:119], v[152:155], v[180:183]
  v_mfma_f32_16x16x32_bf16 v[188:191], v[116:119], v[156:159], v[188:191]
  v_mfma_f32_16x16x32_bf16 v[176:179], v[120:123], v[160:163], v[176:179]
  v_mfma_f32_16x16x32_bf16 v[184:187], v[120:123], v[164:167], v[184:187]
  v_mfma_f32_16x16x32_bf16 v[180:183], v[124:127], v[160:163], v[180:183]
  v_mfma_f32_16x16x32_bf16 v[188:191], v[124:127], v[164:167], v[188:191]
  v_mfma_f32_16x16x32_bf16 v[176:179], v[128:131], v[168:171], v[176:179]
  v_mfma_f32_16x16x32_bf16 v[184:187], v[128:131], v[172:175], v[184:187]
  v_mfma_f32_16x16x32_bf16 v[180:183], v[132:135], v[168:171], v[180:183]
  v_mfma_f32_16x16x32_bf16 v[188:191], v[132:135], v[172:175], v[188:191]
  v_cvt_pk_bf16_f32 v192, v176, v177
  v_cvt_pk_bf16_f32 v193, v178, v179
  s_nop 2
  v_cvt_pk_bf16_f32 v194, v180, v181
  v_cvt_pk_bf16_f32 v195, v182, v183
  v_cvt_pk_bf16_f32 v196, v184, v185
  v_cvt_pk_bf16_f32 v197, v186, v187
  v_cvt_pk_bf16_f32 v198, v188, v189
  v_cvt_pk_bf16_f32 v199, v190, v191
  s_mov_b32 s32, s31
  s_add_u32 s31, s31, 327680
  s_add_u32 s34, s34, 1
  s_waitcnt vmcnt(0)
  v_mov_b32 v8, s24
  s_mov_b64 exec, 1
  s_cmp_lg_u32 s69, 0
  s_cbranch_scc1 mega_kernel_pf11
  buffer_store_dword v8, v7, s[4:7], s25 offen
mega_kernel_pf11_b:
  s_mov_b64 exec, -1
  s_add_u32 s20, s20, 325632
  s_cmp_ge_u32 s20, 1302528
  s_cselect_b32 s20, 0, s20
  s_add_u32 s48, s48, 325632
  s_cmp_ge_u32 s48, 1302528
  s_cselect_b32 s48, 0, s48
  s_cmp_lt_u32 s24, 64
  s_cbranch_scc1 mega_kv_tl
  s_barrier
  s_lshr_b32 s9, s79, 6
  s_lshl_b32 s9, s9, 3
  s_lshr_b32 s8, 0x18001008, s9
  s_and_b32 s8, s8, 31
  s_add_u32 s8, s8, s68
  s_bfe_u32 s9, s79, 0x30003
  s_lshl_b32 s10, s8, 2
  s_add_u32 s10, s10, s3
  v_lshlrev_b32 v2, 4, v1
  v_add_u32 v3, 61440, v2
  v_and_b32 v4, 15, v1
  v_lshrrev_b32 v5, 4, v1
  s_lshl_b32 s13, s3, 13
  s_min_u32 s13, s13, 22528
  s_mul_i32 s12, s9, 307200
  s_add_u32 s12, s12, s13
  s_add_u32 s12, s12, 79888384
  s_mul_i32 s14, s9, 102400
  s_add_u32 s14, s14, 82345984
  s_add_u32 m0, s13, 0
  s_add_u32 s15, s12, 0
  buffer_load_dwordx4 v2, s[4:7], s15 offen offset:0 lds
  buffer_load_dwordx4 v2, s[4:7], s15 offen offset:1024 lds
  buffer_load_dwordx4 v2, s[4:7], s15 offen offset:2048 lds
  buffer_load_dwordx4 v2, s[4:7], s15 offen offset:3072 lds
  s_add_u32 m0, s13, 4096
  s_add_u32 s15, s12, 4096
  buffer_load_dwordx4 v2, s[4:7], s15 offen offset:0 lds
  buffer_load_dwordx4 v2, s[4:7], s15 offen offset:1024 lds
  buffer_load_dwordx4 v2, s[4:7], s15 offen offset:2048 lds
  buffer_load_dwordx4 v2, s[4:7], s15 offen offset:3072 lds
  s_add_u32 s12, s12, 30720
  s_add_u32 m0, s13, 30720
  s_add_u32 s15, s12, 0
  buffer_load_dwordx4 v2, s[4:7], s15 offen offset:0 lds
  buffer_load_dwordx4 v2, s[4:7], s15 offen offset:1024 lds
  buffer_load_dwordx4 v2, s[4:7], s15 offen offset:2048 lds
  buffer_load_dwordx4 v2, s[4:7], s15 offen offset:3072 lds
  s_add_u32 m0, s13, 34816
  s_add_u32 s15, s12, 4096
  buffer_load_dwordx4 v2, s[4:7], s15 offen offset:0 lds
  buffer_load_dwordx4 v2, s[4:7], s15 offen offset:1024 lds
  buffer_load_dwordx4 v2, s[4:7], s15 offen offset:2048 lds
  buffer_load_dwordx4 v2, s[4:7], s15 offen offset:3072 lds
  s_add_u32 s12, s12, 30720
  s_add_u32 m0, s13, 61440
  s_add_u32 s15, s12, 0
  buffer_load_dwordx4 v2, s[4:7], s15 offen offset:0 lds
  buffer_load_dwordx4 v2, s[4:7], s15 offen offset:1024 lds
  buffer_load_dwordx4 v2, s[4:7], s15 offen offset:2048 lds
  buffer_load_dwordx4 v2, s[4:7], s15 offen offset:3072 lds
  s_add_u32 m0, s13, 65536
  s_add_u32 s15, s12, 4096
  buffer_load_dwordx4 v2, s[4:7], s15 offen offset:0 lds
  buffer_load_dwordx4 v2, s[4:7], s15 offen offset:1024 lds
  buffer_load_dwordx4 v2, s[4:7], s15 offen offset:2048 lds
  buffer_load_dwordx4 v2, s[4:7], s15 offen offset:3072 lds
  s_add_u32 s12, s12, 30720
  s_mul_i32 s15, s3, 10240
  s_add_u32 s13, s15, 92160
  s_add_u32 s15, s15, s14
  s_add_u32 s15, s15, 61440
  s_add_u32 m0, s13, 0
  s_add_u32 s18, s15, 0
  buffer_load_dwordx4 v2, s[4:7], s18 offen offset:0 lds
  buffer_load_dwordx4 v2, s[4:7], s18 offen offset:1024 lds
  buffer_load_dwordx4 v2, s[4:7], s18 offen offset:2048 lds
  buffer_load_dwordx4 v2, s[4:7], s18 offen offset:3072 lds
  s_add_u32 m0, s13, 4096
  s_add_u32 s18, s15, 4096
  buffer_load_dwordx4 v2, s[4:7], s18 offen offset:0 lds
  buffer_load_dwordx4 v2, s[4:7], s18 offen offset:1024 lds
  buffer_load_dwordx4 v2, s[4:7], s18 offen offset:2048 lds
  buffer_load_dwordx4 v2, s[4:7], s18 offen offset:3072 lds
  s_add_u32 m0, s13, 8192
  s_add_u32 s18, s15, 8192
  buffer_load_dwordx4 v2, s[4:7], s18 offen offset:0 lds
  buffer_load_dwordx4 v2, s[4:7], s18 offen offset:1024 lds
mega_kv_tt:
  s_cmp_eq_u32 s34, 64
  s_cbranch_scc1 mega_kv_te
  s_add_u32 s36, s28, s48
  s_add_u32 s37, s36, 40960
  s_add_u32 s38, s36, 81920
  s_add_u32 s39, s36, 122880
  s_add_u32 s40, s36, 163840
  s_add_u32 s41, s16, s48
  s_add_u32 s42, s41, 4096
  s_add_u32 s43, s41, 8192
  s_add_u32 s35, s34, 2
  s_add_u32 s50, s34, 1
  s_cmp_ge_u32 s34, 62
  s_cselect_b64 vcc, -1, 0
  v_cndmask_b32 v11, v11, v12, vcc
  v_cndmask_b32 v13, v13, 1, vcc
  buffer_load_dword v14, v11, s[4:7], s71 offen sc1
  buffer_store_dwordx4 v[192:195], v2, s[4:7], s32 offen sc1
  buffer_store_dwordx4 v[196:199], v15, s[4:7], s32 offen sc1
  s_add_i32 s15, s34, -1
  s_max_i32 s15, s15, 0
  v_mov_b32 v8, s15
  s_mov_b64 exec, 1
  buffer_store_dword v8, v7, s[4:7], s33 offen sc1
  s_mov_b64 exec, -1
  buffer_load_dwordx4 v[96:99], v10, s[4:7], s36 offen offset:0 sc1
  buffer_load_dwordx4 v[100:103], v10, s[4:7], s36 offen offset:64 sc1
  buffer_load_dwordx4 v[104:107], v10, s[4:7], s37 offen offset:0 sc1
  buffer_load_dwordx4 v[108:111], v10, s[4:7], s37 offen offset:64 sc1
  buffer_load_dwordx4 v[112:115], v10, s[4:7], s38 offen offset:0 sc1
  buffer_load_dwordx4 v[116:119], v10, s[4:7], s38 offen offset:64 sc1
  buffer_load_dwordx4 v[120:123], v10, s[4:7], s39 offen offset:0 sc1
  buffer_load_dwordx4 v[124:127], v10, s[4:7], s39 offen offset:64 sc1
  s_waitcnt vmcnt(11)
  v_add_u32 v14, v14, v13
  v_cmp_gt_u32 vcc, s35, v14
  s_nop 0
  s_cbranch_vccz mega_kv_tg
  s_waitcnt vmcnt(8)
  s_add_i32 s15, s34, 0
  s_max_i32 s15, s15, 0
  v_mov_b32 v8, s15
  s_mov_b64 exec, 1
  buffer_store_dword v8, v7, s[4:7], s33 offen sc1
  s_mov_b64 exec, -1
  s_mov_b32 s30, 0
mega_kernel_pv12:
  buffer_load_dword v14, v11, s[4:7], s71 offen sc1
  s_waitcnt vmcnt(0)
mega_kernel_pv12_t:
  v_add_u32 v14, v14, v13
  v_cmp_gt_u32 vcc, s35, v14
  s_nop 0
  s_cbranch_vccz mega_kernel_pv12_ok
  s_sleep 1
  s_add_u32 s30, s30, 1
  s_cmp_lt_u32 s30, 262144
  s_cbranch_scc1 mega_kernel_pv12
  s_branch mega_fail
mega_kernel_pv12_ok:
mega_kv_tg:
  buffer_load_dwordx4 v[136:139], v2, s[4:7], s41 offen offset:0 sc1
  buffer_load_dwordx4 v[140:143], v2, s[4:7], s42 offen offset:1024 sc1
  buffer_load_dwordx4 v[144:147], v2, s[4:7], s41 offen offset:1024 sc1
  buffer_load_dwordx4 v[148:151], v2, s[4:7], s42 offen offset:2048 sc1
  buffer_load_dwordx4 v[152:155], v2, s[4:7], s41 offen offset:2048 sc1
  buffer_load_dwordx4 v[156:159], v2, s[4:7], s42 offen offset:3072 sc1
  buffer_load_dwordx4 v[160:163], v2, s[4:7], s41 offen offset:3072 sc1
  buffer_load_dwordx4 v[164:167], v2, s[4:7], s43 offen offset:0 sc1
  buffer_load_dwordx4 v[168:171], v2, s[4:7], s42 offen offset:0 sc1
  buffer_load_dwordx4 v[172:175], v2, s[4:7], s43 offen offset:1024 sc1
  buffer_load_dwordx4 v[128:131], v10, s[4:7], s40 offen offset:0 sc1
  buffer_load_dwordx4 v[132:135], v10, s[4:7], s40 offen offset:64 sc1
  s_waitcnt vmcnt(10)
  v_mfma_f32_16x16x32_bf16 v[176:179], v[96:99], v[136:139], 0
  v_mfma_f32_16x16x32_bf16 v[184:187], v[96:99], v[140:143], 0
  v_mfma_f32_16x16x32_bf16 v[180:183], v[100:103], v[136:139], 0
  v_mfma_f32_16x16x32_bf16 v[188:191], v[100:103], v[140:143], 0
  s_waitcnt vmcnt(8)
  v_mfma_f32_16x16x32_bf16 v[176:179], v[104:107], v[144:147], v[176:179]
  v_mfma_f32_16x16x32_bf16 v[184:187], v[104:107], v[148:151], v[184:187]
  v_mfma_f32_16x16x32_bf16 v[180:183], v[108:111], v[144:147], v[180:183]
  v_mfma_f32_16x16x32_bf16 v[188:191], v[108:111], v[148:151], v[188:191]
  s_waitcnt vmcnt(6)
  v_mfma_f32_16x16x32_bf16 v[176:179], v[112:115], v[152:155], v[176:179]
  v_mfma_f32_16x16x32_bf16 v[184:187], v[112:115], v[156:159], v[184:187]
  v_mfma_f32_16x16x32_bf16 v[180:183], v[116:119], v[152:155], v[180:183]
  v_mfma_f32_16x16x32_bf16 v[188:191], v[116:119], v[156:159], v[188:191]
  s_waitcnt vmcnt(4)
  v_mfma_f32_16x16x32_bf16 v[176:179], v[120:123], v[160:163], v[176:179]
  v_mfma_f32_16x16x32_bf16 v[184:187], v[120:123], v[164:167], v[184:187]
  v_mfma_f32_16x16x32_bf16 v[180:183], v[124:127], v[160:163], v[180:183]
  v_mfma_f32_16x16x32_bf16 v[188:191], v[124:127], v[164:167], v[188:191]
  s_waitcnt vmcnt(0)
  v_mfma_f32_16x16x32_bf16 v[176:179], v[128:131], v[168:171], v[176:179]
  v_mfma_f32_16x16x32_bf16 v[184:187], v[128:131], v[172:175], v[184:187]
  v_mfma_f32_16x16x32_bf16 v[180:183], v[132:135], v[168:171], v[180:183]
  v_mfma_f32_16x16x32_bf16 v[188:191], v[132:135], v[172:175], v[188:191]
  v_mov_b32 v8, s50
  s_mov_b64 exec, 1
  s_cmp_lg_u32 s69, 0
  s_cbranch_scc1 mega_kernel_pf13
  buffer_store_dword v8, v7, s[4:7], s51 offen
mega_kernel_pf13_b:
  s_mov_b64 exec, -1
  s_add_u32 s48, s48, 325632
  s_cmp_ge_u32 s48, 1302528
  s_cselect_b32 s48, 0, s48
  v_cvt_pk_bf16_f32 v192, v176, v177
  v_cvt_pk_bf16_f32 v193, v178, v179
  v_cvt_pk_bf16_f32 v194, v180, v181
  v_cvt_pk_bf16_f32 v195, v182, v183
  v_cvt_pk_bf16_f32 v196, v184, v185
  v_cvt_pk_bf16_f32 v197, v186, v187
  v_cvt_pk_bf16_f32 v198, v188, v189
  v_cvt_pk_bf16_f32 v199, v190, v191
  s_mov_b32 s32, s31
  s_add_u32 s31, s31, 327680
  s_add_u32 s34, s34, 1
  s_branch mega_kv_tt
mega_kv_te:
  buffer_store_dwordx4 v[192:195], v2, s[4:7], s32 offen sc1
  buffer_store_dwordx4 v[196:199], v15, s[4:7], s32 offen sc1
  s_add_i32 s15, s34, -1
  s_max_i32 s15, s15, 0
  v_mov_b32 v8, s15
  s_mov_b64 exec, 1
  buffer_store_dword v8, v7, s[4:7], s33 offen sc1
  s_mov_b64 exec, -1
  s_waitcnt vmcnt(0)
  s_add_i32 s15, s34, 0
  s_max_i32 s15, s15, 0
  v_mov_b32 v8, s15
  s_mov_b64 exec, 1
  buffer_store_dword v8, v7, s[4:7], s33 offen sc1
  s_mov_b64 exec, -1
  s_branch mega_blmain
mega_kv_red:
  s_mul_i32 s26, s68, 5
  s_add_u32 s26, s26, s27
  s_cmp_ge_u32 s26, 20
  s_cselect_b32 s15, 20, 0
  s_cselect_b32 s16, 20480, 0
  s_sub_u32 s27, s26, s15
  s_lshl_b32 s28, s26, 10
  s_add_u32 s31, s28, 53673984
  s_mul_i32 s32, s70, 2621440
  s_add_u32 s32, s32, s28
  s_add_u32 s32, s32, 28327936
  s_mul_i32 s38, s70, 327680
  s_lshl_b32 s39, s26, 7
  s_add_u32 s38, s38, s39
  s_add_u32 s38, s38, 41435136
  s_add_u32 s39, s39, s71
  s_add_u32 s39, s39, 40960
  v_lshlrev_b32 v84, 3, v1
  v_mov_b32 v12, 0x40000000
  v_cmp_gt_u32 vcc, 16, v1
  s_nop 1
  v_cndmask_b32 v12, v12, v84, vcc
  s_lshl_b32 s15, s27, 6
  s_add_u32 s16, s16, s15
  s_cmp_eq_u32 s70, 0
  s_cselect_b32 s33, s16, s28
  s_cselect_b64 vcc, -1, 0
  v_and_b32 v84, 15, v1
  v_mul_u32_u24 v84, 1280, v84
  v_lshrrev_b32 v85, 4, v1
  v_lshl_add_u32 v84, v85, 4, v84
  v_cndmask_b32 v10, v2, v84, vcc
  v_lshrrev_b32 v84, 3, v1
  v_lshlrev_b32 v84, 7, v84
  s_lshl_b32 s15, s27, 10
  s_add_u32 s15, s15, 20480
  v_add_u32 v11, s15, v84
  s_mov_b32 s35, 1
  s_mov_b32 s34, 0xffff0000
  v_mov_b32 v14, 0
  s_mov_b32 s36, 0x40000000
  s_mov_b32 s37, 0x40000000
  s_mov_b32 s40, 0x40000000
  s_mov_b32 s41, 0x40000000
mega_kv_rl:
  s_mov_b32 s30, 0
  s_branch mega_kernel_pv14_t
mega_kernel_pv14:
  buffer_load_dword v14, v11, s[4:7], s71 offen sc1
  s_waitcnt vmcnt(0)
mega_kernel_pv14_t:
  v_cmp_gt_u32 vcc, s35, v14
  s_nop 0
  s_cbranch_vccz mega_kernel_pv14_ok
  s_sleep 2
  s_add_u32 s30, s30, 1
  s_cmp_lt_u32 s30, 262144
  s_cbranch_scc1 mega_kernel_pv14
  s_branch mega_fail
mega_kernel_pv14_ok:
  v_mov_b32 v96, v152
  v_mov_b32 v97, v153
  v_mov_b32 v98, v154
  v_mov_b32 v99, v155
  v_mov_b32 v100, v156
  v_mov_b32 v101, v157
  v_mov_b32 v102, v158
  v_mov_b32 v103, v159
  v_mov_b32 v104, v160
  v_mov_b32 v105, v161
  v_mov_b32 v106, v162
  v_mov_b32 v107, v163
  v_mov_b32 v108, v164
  v_mov_b32 v109, v165
  v_mov_b32 v110, v166
  v_mov_b32 v111, v167
  v_mov_b32 v112, v168
  v_mov_b32 v113, v169
  v_mov_b32 v114, v170
  v_mov_b32 v115, v171
  v_mov_b32 v116, v172
  v_mov_b32 v117, v173
  v_mov_b32 v118, v174
  v_mov_b32 v119, v175
  v_mov_b32 v120, v176
  v_mov_b32 v121, v177
  v_mov_b32 v122, v178
  v_mov_b32 v123, v179
  v_mov_b32 v124, v180
  v_mov_b32 v125, v181
  v_mov_b32 v126, v182
  v_mov_b32 v127, v183
  v_mov_b32 v128, v184
  v_mov_b32 v129, v185
  v_mov_b32 v130, v186
  v_mov_b32 v131, v187
  s_barrier
  ds_read_b128 v[16:19], v5 offset:0
  ds_read_b128 v[20:23], v5 offset:20480
  ds_read_b128 v[24:27], v5 offset:1024
  ds_read_b128 v[28:31], v5 offset:21504
  ds_read_b128 v[32:35], v5 offset:2048
  ds_read_b128 v[36:39], v5 offset:22528
  s_waitcnt lgkmcnt(4)
  v_mfma_f32_16x16x32_bf16 v[48:51], a[0:3], v[16:19], 0
  ds_read_b128 v[40:43], v5 offset:3072
  v_lshlrev_b32 v132, 16, v96
  v_mfma_f32_16x16x32_bf16 v[52:55], a[80:83], v[16:19], 0
  s_mov_b32 m0, s23
  s_add_u32 s18, s29, s48
  buffer_load_dwordx4 v2, s[4:7], s18 offen sc1 lds
  v_mfma_f32_16x16x32_bf16 v[56:59], a[160:163], v[16:19], 0
  v_and_b32 v133, s34, v96
  v_lshlrev_b32 v134, 16, v97
  v_mfma_f32_16x16x32_bf16 v[60:63], a[0:3], v[20:23], 0
  ds_read_b128 v[44:47], v5 offset:23552
  v_and_b32 v135, s34, v97
  v_mfma_f32_16x16x32_bf16 v[64:67], a[80:83], v[20:23], 0
  s_add_u32 s17, s14, s20
  buffer_load_dwordx4 v2, s[4:7], s18 offen offset:1024 sc1 lds
  v_mfma_f32_16x16x32_bf16 v[68:71], a[160:163], v[20:23], 0
  v_lshlrev_b32 v136, 16, v98
  v_and_b32 v137, s34, v98
  s_waitcnt lgkmcnt(4)
  v_mfma_f32_16x16x32_bf16 v[48:51], a[4:7], v[24:27], v[48:51]
  ds_read_b128 v[16:19], v5 offset:4096
  v_lshlrev_b32 v138, 16, v99
  v_mfma_f32_16x16x32_bf16 v[52:55], a[84:87], v[24:27], v[52:55]
  buffer_load_dwordx4 v2, s[4:7], s18 offen offset:2048 sc1 lds
  v_mfma_f32_16x16x32_bf16 v[56:59], a[164:167], v[24:27], v[56:59]
  v_and_b32 v139, s34, v99
  v_lshlrev_b32 v140, 16, v100
  v_mfma_f32_16x16x32_bf16 v[60:63], a[4:7], v[28:31], v[60:63]
  ds_read_b128 v[20:23], v5 offset:24576
  v_and_b32 v141, s34, v100
  v_mfma_f32_16x16x32_bf16 v[64:67], a[84:87], v[28:31], v[64:67]
  v_add_f32 v132, v132, v140
  v_add_f32 v133, v133, v141
  v_mfma_f32_16x16x32_bf16 v[68:71], a[164:167], v[28:31], v[68:71]
  v_lshlrev_b32 v142, 16, v101
  v_and_b32 v143, s34, v101
  s_waitcnt lgkmcnt(4)
  v_mfma_f32_16x16x32_bf16 v[48:51], a[8:11], v[32:35], v[48:51]
  ds_read_b128 v[24:27], v5 offset:5120
  v_add_f32 v134, v134, v142
  v_mfma_f32_16x16x32_bf16 v[52:55], a[88:91], v[32:35], v[52:55]
  v_add_f32 v135, v135, v143
  v_lshlrev_b32 v140, 16, v102
  v_mfma_f32_16x16x32_bf16 v[56:59], a[168:171], v[32:35], v[56:59]
  v_and_b32 v141, s34, v102
  v_add_f32 v136, v136, v140
  v_mfma_f32_16x16x32_bf16 v[60:63], a[8:11], v[36:39], v[60:63]
  ds_read_b128 v[28:31], v5 offset:25600
  v_add_f32 v137, v137, v141
  v_mfma_f32_16x16x32_bf16 v[64:67], a[88:91], v[36:39], v[64:67]
  v_lshlrev_b32 v142, 16, v103
  v_and_b32 v143, s34, v103
  v_mfma_f32_16x16x32_bf16 v[68:71], a[168:171], v[36:39], v[68:71]
  v_add_f32 v138, v138, v142
  v_add_f32 v139, v139, v143
  s_waitcnt lgkmcnt(4)
  v_mfma_f32_16x16x32_bf16 v[48:51], a[12:15], v[40:43], v[48:51]
  ds_read_b128 v[32:35], v5 offset:6144
  v_lshlrev_b32 v140, 16, v104
  v_mfma_f32_16x16x32_bf16 v[52:55], a[92:95], v[40:43], v[52:55]
  v_and_b32 v141, s34, v104
  v_add_f32 v132, v132, v140
  v_mfma_f32_16x16x32_bf16 v[56:59], a[172:175], v[40:43], v[56:59]
  v_add_f32 v133, v133, v141
  v_lshlrev_b32 v142, 16, v105
  v_mfma_f32_16x16x32_bf16 v[60:63], a[12:15], v[44:47], v[60:63]
  ds_read_b128 v[36:39], v5 offset:26624
  v_and_b32 v143, s34, v105
  v_mfma_f32_16x16x32_bf16 v[64:67], a[92:95], v[44:47], v[64:67]
  v_add_f32 v134, v134, v142
  v_add_f32 v135, v135, v143
  v_mfma_f32_16x16x32_bf16 v[68:71], a[172:175], v[44:47], v[68:71]
  v_lshlrev_b32 v140, 16, v106
  v_and_b32 v141, s34, v106
  s_waitcnt lgkmcnt(4)
  v_mfma_f32_16x16x32_bf16 v[48:51], a[16:19], v[16:19], v[48:51]
  ds_read_b128 v[40:43], v5 offset:7168
  v_add_f32 v136, v136, v140
  v_mfma_f32_16x16x32_bf16 v[52:55], a[96:99], v[16:19], v[52:55]
  v_add_f32 v137, v137, v141
  v_lshlrev_b32 v142, 16, v107
  v_mfma_f32_16x16x32_bf16 v[56:59], a[176:179], v[16:19], v[56:59]
  v_and_b32 v143, s34, v107
  v_add_f32 v138, v138, v142
  v_mfma_f32_16x16x32_bf16 v[60:63], a[16:19], v[20:23], v[60:63]
  ds_read_b128 v[44:47], v5 offset:27648
  v_add_f32 v139, v139, v143
  v_mfma_f32_16x16x32_bf16 v[64:67], a[96:99], v[20:23], v[64:67]
  v_lshlrev_b32 v140, 16, v108
  v_and_b32 v141, s34, v108
  v_mfma_f32_16x16x32_bf16 v[68:71], a[176:179], v[20:23], v[68:71]
  v_add_f32 v132, v132, v140
  v_add_f32 v133, v133, v141
  s_waitcnt lgkmcnt(4)
  v_mfma_f32_16x16x32_bf16 v[48:51], a[20:23], v[24:27], v[48:51]
  ds_read_b128 v[16:19], v5 offset:8192
  v_lshlrev_b32 v142, 16, v109
  v_mfma_f32_16x16x32_bf16 v[52:55], a[100:103], v[24:27], v[52:55]
  v_and_b32 v143, s34, v109
  v_add_f32 v134, v134, v142
  v_mfma_f32_16x16x32_bf16 v[56:59], a[180:183], v[24:27], v[56:59]
  v_add_f32 v135, v135, v143
  v_lshlrev_b32 v140, 16, v110
  v_mfma_f32_16x16x32_bf16 v[60:63], a[20:23], v[28:31], v[60:63]
  ds_read_b128 v[20:23], v5 offset:28672
  v_and_b32 v141, s34, v110
  v_mfma_f32_16x16x32_bf16 v[64:67], a[100:103], v[28:31], v[64:67]
  v_add_f32 v136, v136, v140
  v_add_f32 v137, v137, v141
  v_mfma_f32_16x16x32_bf16 v[68:71], a[180:183], v[28:31], v[68:71]
  v_lshlrev_b32 v142, 16, v111
  v_and_b32 v143, s34, v111
  s_waitcnt lgkmcnt(4)
  v_mfma_f32_16x16x32_bf16 v[48:51], a[24:27], v[32:35], v[48:51]
  ds_read_b128 v[24:27], v5 offset:9216
  v_add_f32 v138, v138, v142
  v_mfma_f32_16x16x32_bf16 v[52:55], a[104:107], v[32:35], v[52:55]
  v_add_f32 v139, v139, v143
  v_lshlrev_b32 v140, 16, v112
  v_mfma_f32_16x16x32_bf16 v[56:59], a[184:187], v[32:35], v[56:59]
  v_and_b32 v141, s34, v112
  v_add_f32 v132, v132, v140
  v_mfma_f32_16x16x32_bf16 v[60:63], a[24:27], v[36:39], v[60:63]
  ds_read_b128 v[28:31], v5 offset:29696
  v_add_f32 v133, v133, v141
  v_mfma_f32_16x16x32_bf16 v[64:67], a[104:107], v[36:39], v[64:67]
  v_lshlrev_b32 v142, 16, v113
  v_and_b32 v143, s34, v113
  v_mfma_f32_16x16x32_bf16 v[68:71], a[184:187], v[36:39], v[68:71]
  v_add_f32 v134, v134, v142
  v_add_f32 v135, v135, v143
  s_waitcnt lgkmcnt(4)
  v_mfma_f32_16x16x32_bf16 v[48:51], a[28:31], v[40:43], v[48:51]
  ds_read_b128 v[32:35], v5 offset:10240
  v_lshlrev_b32 v140, 16, v114
  v_mfma_f32_16x16x32_bf16 v[52:55], a[108:111], v[40:43], v[52:55]
  s_add_u32 m0, s13, 0
  s_add_u32 s18, s12, 0
  buffer_load_dwordx4 v2, s[4:7], s18 offen offset:0 lds
  v_mfma_f32_16x16x32_bf16 v[56:59], a[188:191], v[40:43], v[56:59]
  v_and_b32 v141, s34, v114
  v_add_f32 v136, v136, v140
  v_mfma_f32_16x16x32_bf16 v[60:63], a[28:31], v[44:47], v[60:63]
  ds_read_b128 v[36:39], v5 offset:30720
  v_add_f32 v137, v137, v141
  v_mfma_f32_16x16x32_bf16 v[64:67], a[108:111], v[44:47], v[64:67]
  buffer_load_dwordx4 v2, s[4:7], s18 offen offset:1024 lds
  v_mfma_f32_16x16x32_bf16 v[68:71], a[188:191], v[44:47], v[68:71]
  v_lshlrev_b32 v142, 16, v115
  v_and_b32 v143, s34, v115
  s_waitcnt lgkmcnt(4)
  v_mfma_f32_16x16x32_bf16 v[48:51], a[32:35], v[16:19], v[48:51]
  ds_read_b128 v[40:43], v5 offset:11264
  v_add_f32 v138, v138, v142
  v_mfma_f32_16x16x32_bf16 v[52:55], a[112:115], v[16:19], v[52:55]
  v_add_f32 v139, v139, v143
  v_lshlrev_b32 v140, 16, v116
  v_mfma_f32_16x16x32_bf16 v[56:59], a[192:195], v[16:19], v[56:59]
  buffer_load_dwordx4 v2, s[4:7], s18 offen offset:2048 lds
  v_mfma_f32_16x16x32_bf16 v[60:63], a[32:35], v[20:23], v[60:63]
  ds_read_b128 v[44:47], v5 offset:31744
  v_and_b32 v141, s34, v116
  v_mfma_f32_16x16x32_bf16 v[64:67], a[112:115], v[20:23], v[64:67]
  v_add_f32 v132, v132, v140
  v_add_f32 v133, v133, v141
  v_mfma_f32_16x16x32_bf16 v[68:71], a[192:195], v[20:23], v[68:71]
  v_lshlrev_b32 v142, 16, v117
  v_and_b32 v143, s34, v117
  s_waitcnt lgkmcnt(4)
  v_mfma_f32_16x16x32_bf16 v[48:51], a[36:39], v[24:27], v[48:51]
  ds_read_b128 v[16:19], v5 offset:12288
  v_add_f32 v134, v134, v142
  v_mfma_f32_16x16x32_bf16 v[52:55], a[116:119], v[24:27], v[52:55]
  buffer_load_dwordx4 v2, s[4:7], s18 offen offset:3072 lds
  v_mfma_f32_16x16x32_bf16 v[56:59], a[196:199], v[24:27], v[56:59]
  v_add_f32 v135, v135, v143
  v_lshlrev_b32 v140, 16, v118
  v_mfma_f32_16x16x32_bf16 v[60:63], a[36:39], v[28:31], v[60:63]
  ds_read_b128 v[20:23], v5 offset:32768
  v_and_b32 v141, s34, v118
  v_mfma_f32_16x16x32_bf16 v[64:67], a[116:119], v[28:31], v[64:67]
  v_add_f32 v136, v136, v140
  v_add_f32 v137, v137, v141
  v_mfma_f32_16x16x32_bf16 v[68:71], a[196:199], v[28:31], v[68:71]
  s_add_u32 m0, s13, 4096
  s_add_u32 s18, s12, 4096
  buffer_load_dwordx4 v2, s[4:7], s18 offen offset:0 lds
  s_waitcnt vmcnt(5)
  s_barrier
  s_waitcnt lgkmcnt(4)
  v_mfma_f32_16x16x32_bf16 v[48:51], a[40:43], v[32:35], v[48:51]
  ds_read_b128 v[24:27], v5 offset:13312
  v_lshlrev_b32 v142, 16, v119
  v_mfma_f32_16x16x32_bf16 v[52:55], a[120:123], v[32:35], v[52:55]
  v_and_b32 v143, s34, v119
  v_add_f32 v138, v138, v142
  v_mfma_f32_16x16x32_bf16 v[56:59], a[200:203], v[32:35], v[56:59]
  v_add_f32 v139, v139, v143
  v_lshlrev_b32 v140, 16, v120
  v_mfma_f32_16x16x32_bf16 v[60:63], a[40:43], v[36:39], v[60:63]
  ds_read_b128 v[28:31], v5 offset:33792
  v_and_b32 v141, s34, v120
  v_mfma_f32_16x16x32_bf16 v[64:67], a[120:123], v[36:39], v[64:67]
  buffer_load_dwordx4 v2, s[4:7], s18 offen offset:1024 lds
  v_mfma_f32_16x16x32_bf16 v[68:71], a[200:203], v[36:39], v[68:71]
  v_add_f32 v132, v132, v140
  v_add_f32 v133, v133, v141
  s_waitcnt lgkmcnt(4)
  v_mfma_f32_16x16x32_bf16 v[48:51], a[44:47], v[40:43], v[48:51]
  ds_read_b128 v[32:35], v5 offset:14336
  v_lshlrev_b32 v142, 16, v121
  v_mfma_f32_16x16x32_bf16 v[52:55], a[124:127], v[40:43], v[52:55]
  buffer_load_dwordx4 v2, s[4:7], s18 offen offset:2048 lds
  v_mfma_f32_16x16x32_bf16 v[56:59], a[204:207], v[40:43], v[56:59]
  v_and_b32 v143, s34, v121
  v_add_f32 v134, v134, v142
  v_mfma_f32_16x16x32_bf16 v[60:63], a[44:47], v[44:47], v[60:63]
  ds_read_b128 v[36:39], v5 offset:34816
  v_add_f32 v135, v135, v143
  v_mfma_f32_16x16x32_bf16 v[64:67], a[124:127], v[44:47], v[64:67]
  v_lshlrev_b32 v140, 16, v122
  v_and_b32 v141, s34, v122
  v_mfma_f32_16x16x32_bf16 v[68:71], a[204:207], v[44:47], v[68:71]
  buffer_load_dwordx4 v2, s[4:7], s18 offen offset:3072 lds
  s_waitcnt lgkmcnt(4)
  v_mfma_f32_16x16x32_bf16 v[48:51], a[48:51], v[16:19], v[48:51]
  ds_read_b128 v[40:43], v5 offset:15360
  v_add_f32 v136, v136, v140
  v_mfma_f32_16x16x32_bf16 v[52:55], a[128:131], v[16:19], v[52:55]
  v_add_f32 v137, v137, v141
  v_lshlrev_b32 v142, 16, v123
  v_mfma_f32_16x16x32_bf16 v[56:59], a[208:211], v[16:19], v[56:59]
  v_and_b32 v143, s34, v123
  v_add_f32 v138, v138, v142
  v_mfma_f32_16x16x32_bf16 v[60:63], a[48:51], v[20:23], v[60:63]
  ds_read_b128 v[44:47], v5 offset:35840
  v_add_f32 v139, v139, v143
  v_mfma_f32_16x16x32_bf16 v[64:67], a[128:131], v[20:23], v[64:67]
  s_add_u32 m0, s13, 8192
  s_add_u32 s18, s12, 8192
  buffer_load_dwordx4 v2, s[4:7], s18 offen offset:0 lds
  v_mfma_f32_16x16x32_bf16 v[68:71], a[208:211], v[20:23], v[68:71]
  v_lshlrev_b32 v140, 16, v124
  v_and_b32 v141, s34, v124
  s_waitcnt lgkmcnt(4)
  v_mfma_f32_16x16x32_bf16 v[48:51], a[52:55], v[24:27], v[48:51]
  ds_read_b128 v[16:19], v5 offset:16384
  v_add_f32 v132, v132, v140
  v_mfma_f32_16x16x32_bf16 v[52:55], a[132:135], v[24:27], v[52:55]
  v_add_f32 v133, v133, v141
  v_lshlrev_b32 v142, 16, v125
  v_mfma_f32_16x16x32_bf16 v[56:59], a[212:215], v[24:27], v[56:59]
  buffer_load_dwordx4 v2, s[4:7], s18 offen offset:1024 lds
  v_mfma_f32_16x16x32_bf16 v[60:63], a[52:55], v[28:31], v[60:63]
  ds_read_b128 v[20:23], v5 offset:36864
  v_and_b32 v143, s34, v125
  v_mfma_f32_16x16x32_bf16 v[64:67], a[132:135], v[28:31], v[64:67]
  v_add_f32 v134, v134, v142
  v_add_f32 v135, v135, v143
  v_mfma_f32_16x16x32_bf16 v[68:71], a[212:215], v[28:31], v[68:71]
  v_lshlrev_b32 v140, 16, v126
  v_and_b32 v141, s34, v126
  s_waitcnt lgkmcnt(4)
  v_mfma_f32_16x16x32_bf16 v[48:51], a[56:59], v[32:35], v[48:51]
  ds_read_b128 v[24:27], v5 offset:17408
  v_add_f32 v136, v136, v140
  v_mfma_f32_16x16x32_bf16 v[52:55], a[136:139], v[32:35], v[52:55]
  buffer_store_dwordx4 v[144:147], v2, s[4:7], s40 offen sc1
  v_mfma_f32_16x16x32_bf16 v[56:59], a[216:219], v[32:35], v[56:59]
  buffer_store_dwordx2 v[148:149], v12, s[4:7], s41 offen sc1
  v_mfma_f32_16x16x32_bf16 v[60:63], a[56:59], v[36:39], v[60:63]
  ds_read_b128 v[28:31], v5 offset:37888
  v_add_f32 v137, v137, v141
  v_mfma_f32_16x16x32_bf16 v[64:67], a[136:139], v[36:39], v[64:67]
  s_add_i32 s15, s35, -3
  s_max_i32 s15, s15, 0
  v_mov_b32 v8, s15
  s_mov_b64 exec, 1
  buffer_store_dword v8, v7, s[4:7], s39 offen sc1
  s_mov_b64 exec, -1
  v_mfma_f32_16x16x32_bf16 v[68:71], a[216:219], v[36:39], v[68:71]
  buffer_load_dwordx4 v[152:155], v2, s[4:7], s31 offen sc1
  s_add_u32 s31, s31, 40960
  s_waitcnt lgkmcnt(4)
  v_mfma_f32_16x16x32_bf16 v[48:51], a[60:63], v[40:43], v[48:51]
  ds_read_b128 v[32:35], v5 offset:18432
  v_lshlrev_b32 v142, 16, v127
  v_mfma_f32_16x16x32_bf16 v[52:55], a[140:143], v[40:43], v[52:55]
  buffer_load_dwordx4 v[156:159], v2, s[4:7], s31 offen sc1
  s_add_u32 s31, s31, 40960
  v_mfma_f32_16x16x32_bf16 v[56:59], a[220:223], v[40:43], v[56:59]
  buffer_load_dwordx4 v[160:163], v2, s[4:7], s31 offen sc1
  s_add_u32 s31, s31, 40960
  v_mfma_f32_16x16x32_bf16 v[60:63], a[60:63], v[44:47], v[60:63]
  ds_read_b128 v[36:39], v5 offset:38912
  v_and_b32 v143, s34, v127
  v_mfma_f32_16x16x32_bf16 v[64:67], a[140:143], v[44:47], v[64:67]
  buffer_load_dwordx4 v[164:167], v2, s[4:7], s31 offen sc1
  s_add_u32 s31, s31, 40960
  v_mfma_f32_16x16x32_bf16 v[68:71], a[220:223], v[44:47], v[68:71]
  buffer_load_dwordx4 v[168:171], v2, s[4:7], s31 offen sc1
  s_add_u32 s31, s31, 40960
  s_waitcnt lgkmcnt(4)
  v_mfma_f32_16x16x32_bf16 v[48:51], a[64:67], v[16:19], v[48:51]
  ds_read_b128 v[40:43], v5 offset:19456
  v_add_f32 v138, v138, v142
  v_mfma_f32_16x16x32_bf16 v[52:55], a[144:147], v[16:19], v[52:55]
  buffer_load_dwordx4 v[172:175], v2, s[4:7], s31 offen sc1
  s_add_u32 s31, s31, 40960
  v_mfma_f32_16x16x32_bf16 v[56:59], a[224:227], v[16:19], v[56:59]
  buffer_load_dwordx4 v[176:179], v2, s[4:7], s31 offen sc1
  s_add_u32 s31, s31, 40960
  v_mfma_f32_16x16x32_bf16 v[60:63], a[64:67], v[20:23], v[60:63]
  ds_read_b128 v[44:47], v5 offset:39936
  v_add_f32 v139, v139, v143
  v_mfma_f32_16x16x32_bf16 v[64:67], a[144:147], v[20:23], v[64:67]
  buffer_load_dwordx4 v[180:183], v2, s[4:7], s31 offen sc1
  s_add_u32 s31, s31, 40960
  v_mfma_f32_16x16x32_bf16 v[68:71], a[224:227], v[20:23], v[68:71]
  buffer_load_dwordx4 v[184:187], v10, s[84:87], s33 offen sc1
  s_add_u32 s33, s33, 40960
  s_waitcnt lgkmcnt(4)
  v_mfma_f32_16x16x32_bf16 v[48:51], a[68:71], v[24:27], v[48:51]
  v_lshlrev_b32 v140, 16, v128
  v_mfma_f32_16x16x32_bf16 v[52:55], a[148:151], v[24:27], v[52:55]
  buffer_load_dword v14, v11, s[4:7], s71 offen sc1
  v_mfma_f32_16x16x32_bf16 v[56:59], a[228:231], v[24:27], v[56:59]
  v_and_b32 v141, s34, v128
  v_add_f32 v132, v132, v140
  v_mfma_f32_16x16x32_bf16 v[60:63], a[68:71], v[28:31], v[60:63]
  v_add_f32 v133, v133, v141
  v_mfma_f32_16x16x32_bf16 v[64:67], a[148:151], v[28:31], v[64:67]
  v_lshlrev_b32 v142, 16, v129
  v_and_b32 v143, s34, v129
  v_mfma_f32_16x16x32_bf16 v[68:71], a[228:231], v[28:31], v[68:71]
  v_add_f32 v134, v134, v142
  v_add_f32 v135, v135, v143
  s_waitcnt lgkmcnt(2)
  v_mfma_f32_16x16x32_bf16 v[48:51], a[72:75], v[32:35], v[48:51]
  v_lshlrev_b32 v140, 16, v130
  v_mfma_f32_16x16x32_bf16 v[52:55], a[152:155], v[32:35], v[52:55]
  v_and_b32 v141, s34, v130
  v_add_f32 v136, v136, v140
  v_mfma_f32_16x16x32_bf16 v[56:59], a[232:235], v[32:35], v[56:59]
  v_add_f32 v137, v137, v141
  v_lshlrev_b32 v142, 16, v131
  v_mfma_f32_16x16x32_bf16 v[60:63], a[72:75], v[36:39], v[60:63]
  v_and_b32 v143, s34, v131
  v_mfma_f32_16x16x32_bf16 v[64:67], a[152:155], v[36:39], v[64:67]
  v_add_f32 v138, v138, v142
  v_add_f32 v139, v139, v143
  v_mfma_f32_16x16x32_bf16 v[68:71], a[232:235], v[36:39], v[68:71]
  s_waitcnt lgkmcnt(0)
  v_mfma_f32_16x16x32_bf16 v[48:51], a[76:79], v[40:43], v[48:51]
  v_mfma_f32_16x16x32_bf16 v[52:55], a[156:159], v[40:43], v[52:55]
  v_mfma_f32_16x16x32_bf16 v[56:59], a[236:239], v[40:43], v[56:59]
  v_mfma_f32_16x16x32_bf16 v[60:63], a[76:79], v[44:47], v[60:63]
  v_mfma_f32_16x16x32_bf16 v[64:67], a[156:159], v[44:47], v[64:67]
  v_mfma_f32_16x16x32_bf16 v[68:71], a[236:239], v[44:47], v[68:71]
  v_add_u32 v5, s19, v5
  s_sub_u32 s13, s13, s19
  s_sub_u32 s19, 0, s19
  s_add_u32 s12, s12, 40960
  s_add_u32 s24, s24, 1
  v_cvt_pk_bf16_f32 v72, v48, v49
  v_cvt_pk_bf16_f32 v73, v50, v51
  v_cvt_pk_bf16_f32 v74, v52, v53
  v_cvt_pk_bf16_f32 v75, v54, v55
  v_cvt_pk_bf16_f32 v80, v56, v57
  v_cvt_pk_bf16_f32 v81, v58, v59
  buffer_store_dwordx4 v[72:75], v3, s[4:7], s17 offen
  v_cvt_pk_bf16_f32 v76, v60, v61
  v_cvt_pk_bf16_f32 v77, v62, v63
  v_cvt_pk_bf16_f32 v78, v64, v65
  v_cvt_pk_bf16_f32 v79, v66, v67
  v_cvt_pk_bf16_f32 v82, v68, v69
  v_cvt_pk_bf16_f32 v83, v70, v71
  buffer_store_dwordx4 v[76:79], v4, s[4:7], s17 offen
  buffer_store_dwordx4 v[80:83], v9, s[4:7], s17 offen
  v_cvt_pk_bf16_f32 v144, v132, v133
  v_cvt_pk_bf16_f32 v145, v134, v135
  v_cvt_pk_bf16_f32 v146, v136, v137
  v_cvt_pk_bf16_f32 v147, v138, v139
  v_pk_add_f32 v[140:141], v[132:133], v[134:135]
  v_pk_add_f32 v[142:143], v[136:137], v[138:139]
  v_pk_add_f32 v[140:141], v[140:141], v[142:143]
  v_add_f32 v148, v140, v141
  v_mov_b32 v140, v148
  s_nop 1
  v_permlane16_swap_b32 v148, v140
  v_add_f32 v148, v148, v140
  v_mov_b32 v140, v148
  s_nop 1
  v_permlane32_swap_b32 v148, v140
  v_add_f32 v148, v148, v140
  v_mul_f32 v148, 0x3d000000, v148
  v_sub_f32 v140, v132, v148
  v_mul_f32 v149, v140, v140
  v_sub_f32 v140, v133, v148
  v_fmac_f32 v149, v140, v140
  v_sub_f32 v140, v134, v148
  v_fmac_f32 v149, v140, v140
  v_sub_f32 v140, v135, v148
  v_fmac_f32 v149, v140, v140
  v_sub_f32 v140, v136, v148
  v_fmac_f32 v149, v140, v140
  v_sub_f32 v140, v137, v148
  v_fmac_f32 v149, v140, v140
  v_sub_f32 v140, v138, v148
  v_fmac_f32 v149, v140, v140
  v_sub_f32 v140, v139, v148
  v_fmac_f32 v149, v140, v140
  v_mov_b32 v140, v149
  s_nop 1
  v_permlane16_swap_b32 v149, v140
  v_add_f32 v149, v149, v140
  v_mov_b32 v140, v149
  s_nop 1
  v_permlane32_swap_b32 v149, v140
  v_add_f32 v149, v149, v140
  s_mov_b32 s40, s36
  s_mov_b32 s41, s37
  s_mov_b32 s36, s32
  s_mov_b32 s37, s38
  s_add_u32 s32, s32, 40960
  s_add_u32 s38, s38, 5120
  s_add_u32 s35, s35, 1
  s_waitcnt vmcnt(0)
  v_mov_b32 v8, s24
  s_mov_b64 exec, 1
  s_cmp_lg_u32 s69, 0
  s_cbranch_scc1 mega_kernel_pf15
  buffer_store_dword v8, v7, s[4:7], s25 offen
mega_kernel_pf15_b:
  s_mov_b64 exec, -1
  s_add_u32 s20, s20, 325632
  s_cmp_ge_u32 s20, 1302528
  s_cselect_b32 s20, 0, s20
  s_add_u32 s48, s48, 325632
  s_cmp_ge_u32 s48, 1302528
  s_cselect_b32 s48, 0, s48
  s_cmp_lt_u32 s24, 64
  s_cbranch_scc1 mega_kv_rl
  s_barrier
  s_lshr_b32 s9, s79, 6
  s_lshl_b32 s9, s9, 3
  s_lshr_b32 s8, 0x18001008, s9
  s_and_b32 s8, s8, 31
  s_add_u32 s8, s8, s68
  s_bfe_u32 s9, s79, 0x30003
  s_lshl_b32 s10, s8, 2
  s_add_u32 s10, s10, s3
  v_lshlrev_b32 v2, 4, v1
  v_add_u32 v3, 61440, v2
  v_and_b32 v4, 15, v1
  v_lshrrev_b32 v5, 4, v1
  s_lshl_b32 s13, s3, 13
  s_min_u32 s13, s13, 22528
  s_mul_i32 s12, s9, 307200
  s_add_u32 s12, s12, s13
  s_add_u32 s12, s12, 79888384
  s_mul_i32 s14, s9, 102400
  s_add_u32 s14, s14, 82345984
  s_add_u32 m0, s13, 0
  s_add_u32 s15, s12, 0
  buffer_load_dwordx4 v2, s[4:7], s15 offen offset:0 lds
  buffer_load_dwordx4 v2, s[4:7], s15 offen offset:1024 lds
  buffer_load_dwordx4 v2, s[4:7], s15 offen offset:2048 lds
  buffer_load_dwordx4 v2, s[4:7], s15 offen offset:3072 lds
  s_add_u32 m0, s13, 4096
  s_add_u32 s15, s12, 4096
  buffer_load_dwordx4 v2, s[4:7], s15 offen offset:0 lds
  buffer_load_dwordx4 v2, s[4:7], s15 offen offset:1024 lds
  buffer_load_dwordx4 v2, s[4:7], s15 offen offset:2048 lds
  buffer_load_dwordx4 v2, s[4:7], s15 offen offset:3072 lds
  s_add_u32 s12, s12, 30720
  s_add_u32 m0, s13, 30720
  s_add_u32 s15, s12, 0
  buffer_load_dwordx4 v2, s[4:7], s15 offen offset:0 lds
  buffer_load_dwordx4 v2, s[4:7], s15 offen offset:1024 lds
  buffer_load_dwordx4 v2, s[4:7], s15 offen offset:2048 lds
  buffer_load_dwordx4 v2, s[4:7], s15 offen offset:3072 lds
  s_add_u32 m0, s13, 34816
  s_add_u32 s15, s12, 4096
  buffer_load_dwordx4 v2, s[4:7], s15 offen offset:0 lds
  buffer_load_dwordx4 v2, s[4:7], s15 offen offset:1024 lds
  buffer_load_dwordx4 v2, s[4:7], s15 offen offset:2048 lds
  buffer_load_dwordx4 v2, s[4:7], s15 offen offset:3072 lds
  s_add_u32 s12, s12, 30720
  s_add_u32 m0, s13, 61440
  s_add_u32 s15, s12, 0
  buffer_load_dwordx4 v2, s[4:7], s15 offen offset:0 lds
  buffer_load_dwordx4 v2, s[4:7], s15 offen offset:1024 lds
  buffer_load_dwordx4 v2, s[4:7], s15 offen offset:2048 lds
  buffer_load_dwordx4 v2, s[4:7], s15 offen offset:3072 lds
  s_add_u32 m0, s13, 65536
  s_add_u32 s15, s12, 4096
  buffer_load_dwordx4 v2, s[4:7], s15 offen offset:0 lds
  buffer_load_dwordx4 v2, s[4:7], s15 offen offset:1024 lds
  buffer_load_dwordx4 v2, s[4:7], s15 offen offset:2048 lds
  buffer_load_dwordx4 v2, s[4:7], s15 offen offset:3072 lds
  s_add_u32 s12, s12, 30720
  s_mul_i32 s15, s3, 10240
  s_add_u32 s13, s15, 92160
  s_add_u32 s15, s15, s14
  s_add_u32 s15, s15, 61440
  s_add_u32 m0, s13, 0
  s_add_u32 s18, s15, 0
  buffer_load_dwordx4 v2, s[4:7], s18 offen offset:0 lds
  buffer_load_dwordx4 v2, s[4:7], s18 offen offset:1024 lds
  buffer_load_dwordx4 v2, s[4:7], s18 offen offset:2048 lds
  buffer_load_dwordx4 v2, s[4:7], s18 offen offset:3072 lds
  s_add_u32 m0, s13, 4096
  s_add_u32 s18, s15, 4096
  buffer_load_dwordx4 v2, s[4:7], s18 offen offset:0 lds
  buffer_load_dwordx4 v2, s[4:7], s18 offen offset:1024 lds
  buffer_load_dwordx4 v2, s[4:7], s18 offen offset:2048 lds
  buffer_load_dwordx4 v2, s[4:7], s18 offen offset:3072 lds
  s_add_u32 m0, s13, 8192
  s_add_u32 s18, s15, 8192
  buffer_load_dwordx4 v2, s[4:7], s18 offen offset:0 lds
  buffer_load_dwordx4 v2, s[4:7], s18 offen offset:1024 lds
  buffer_store_dwordx4 v[144:147], v2, s[4:7], s40 offen sc1
  buffer_store_dwordx2 v[148:149], v12, s[4:7], s41 offen sc1
mega_kv_rt:
  buffer_load_dword v14, v11, s[4:7], s71 offen sc1
  v_lshlrev_b32 v132, 16, v152
  v_and_b32 v133, s34, v152
  v_lshlrev_b32 v134, 16, v153
  v_and_b32 v135, s34, v153
  v_lshlrev_b32 v136, 16, v154
  v_and_b32 v137, s34, v154
  v_lshlrev_b32 v138, 16, v155
  v_and_b32 v139, s34, v155
  v_lshlrev_b32 v140, 16, v156
  v_and_b32 v141, s34, v156
  v_pk_add_f32 v[132:133], v[132:133], v[140:141]
  v_lshlrev_b32 v142, 16, v157
  v_and_b32 v143, s34, v157
  v_pk_add_f32 v[134:135], v[134:135], v[142:143]
  v_lshlrev_b32 v140, 16, v158
  v_and_b32 v141, s34, v158
  v_pk_add_f32 v[136:137], v[136:137], v[140:141]
  v_lshlrev_b32 v142, 16, v159
  v_and_b32 v143, s34, v159
  v_pk_add_f32 v[138:139], v[138:139], v[142:143]
  v_lshlrev_b32 v140, 16, v160
  v_and_b32 v141, s34, v160
  v_pk_add_f32 v[132:133], v[132:133], v[140:141]
  v_lshlrev_b32 v142, 16, v161
  v_and_b32 v143, s34, v161
  v_pk_add_f32 v[134:135], v[134:135], v[142:143]
  v_lshlrev_b32 v140, 16, v162
  v_and_b32 v141, s34, v162
  v_pk_add_f32 v[136:137], v[136:137], v[140:141]
  v_lshlrev_b32 v142, 16, v163
  v_and_b32 v143, s34, v163
  v_pk_add_f32 v[138:139], v[138:139], v[142:143]
  v_lshlrev_b32 v140, 16, v164
  v_and_b32 v141, s34, v164
  v_pk_add_f32 v[132:133], v[132:133], v[140:141]
  v_lshlrev_b32 v142, 16, v165
  v_and_b32 v143, s34, v165
  v_pk_add_f32 v[134:135], v[134:135], v[142:143]
  v_lshlrev_b32 v140, 16, v166
  v_and_b32 v141, s34, v166
  v_pk_add_f32 v[136:137], v[136:137], v[140:141]
  v_lshlrev_b32 v142, 16, v167
  v_and_b32 v143, s34, v167
  v_pk_add_f32 v[138:139], v[138:139], v[142:143]
  v_lshlrev_b32 v140, 16, v168
  v_and_b32 v141, s34, v168
  v_pk_add_f32 v[132:133], v[132:133], v[140:141]
  v_lshlrev_b32 v142, 16, v169
  v_and_b32 v143, s34, v169
  v_pk_add_f32 v[134:135], v[134:135], v[142:143]
  v_lshlrev_b32 v140, 16, v170
  v_and_b32 v141, s34, v170
  v_pk_add_f32 v[136:137], v[136:137], v[140:141]
  v_lshlrev_b32 v142, 16, v171
  v_and_b32 v143, s34, v171
  v_pk_add_f32 v[138:139], v[138:139], v[142:143]
  v_lshlrev_b32 v140, 16, v172
  v_and_b32 v141, s34, v172
  v_pk_add_f32 v[132:133], v[132:133], v[140:141]
  v_lshlrev_b32 v142, 16, v173
  v_and_b32 v143, s34, v173
  v_pk_add_f32 v[134:135], v[134:135], v[142:143]
  v_lshlrev_b32 v140, 16, v174
  v_and_b32 v141, s34, v174
  v_pk_add_f32 v[136:137], v[136:137], v[140:141]
  v_lshlrev_b32 v142, 16, v175
  v_and_b32 v143, s34, v175
  v_pk_add_f32 v[138:139], v[138:139], v[142:143]
  v_lshlrev_b32 v140, 16, v176
  v_and_b32 v141, s34, v176
  v_pk_add_f32 v[132:133], v[132:133], v[140:141]
  v_lshlrev_b32 v142, 16, v177
  v_and_b32 v143, s34, v177
  v_pk_add_f32 v[134:135], v[134:135], v[142:143]
  v_lshlrev_b32 v140, 16, v178
  v_and_b32 v141, s34, v178
  v_pk_add_f32 v[136:137], v[136:137], v[140:141]
  v_lshlrev_b32 v142, 16, v179
  v_and_b32 v143, s34, v179
  v_pk_add_f32 v[138:139], v[138:139], v[142:143]
  v_lshlrev_b32 v140, 16, v180
  v_and_b32 v141, s34, v180
  v_pk_add_f32 v[132:133], v[132:133], v[140:141]
  v_lshlrev_b32 v142, 16, v181
  v_and_b32 v143, s34, v181
  v_pk_add_f32 v[134:135], v[134:135], v[142:143]
  v_lshlrev_b32 v140, 16, v182
  v_and_b32 v141, s34, v182
  v_pk_add_f32 v[136:137], v[136:137], v[140:141]
  v_lshlrev_b32 v142, 16, v183
  v_and_b32 v143, s34, v183
  v_pk_add_f32 v[138:139], v[138:139], v[142:143]
  v_lshlrev_b32 v140, 16, v184
  v_and_b32 v141, s34, v184
  v_pk_add_f32 v[132:133], v[132:133], v[140:141]
  v_lshlrev_b32 v142, 16, v185
  v_and_b32 v143, s34, v185
  v_pk_add_f32 v[134:135], v[134:135], v[142:143]
  v_lshlrev_b32 v140, 16, v186
  v_and_b32 v141, s34, v186
  v_pk_add_f32 v[136:137], v[136:137], v[140:141]
  v_lshlrev_b32 v142, 16, v187
  v_and_b32 v143, s34, v187
  v_pk_add_f32 v[138:139], v[138:139], v[142:143]
  v_cvt_pk_bf16_f32 v144, v132, v133
  v_cvt_pk_bf16_f32 v145, v134, v135
  v_cvt_pk_bf16_f32 v146, v136, v137
  v_cvt_pk_bf16_f32 v147, v138, v139
  v_pk_add_f32 v[140:141], v[132:133], v[134:135]
  v_pk_add_f32 v[142:143], v[136:137], v[138:139]
  v_pk_add_f32 v[140:141], v[140:141], v[142:143]
  v_add_f32 v148, v140, v141
  v_mov_b32 v140, v148
  s_nop 1
  v_permlane16_swap_b32 v148, v140
  v_add_f32 v148, v148, v140
  v_mov_b32 v140, v148
  s_nop 1
  v_permlane32_swap_b32 v148, v140
  v_add_f32 v148, v148, v140
  v_mul_f32 v148, 0x3d000000, v148
  v_sub_f32 v140, v132, v148
  v_mul_f32 v149, v140, v140
  v_sub_f32 v140, v133, v148
  v_fmac_f32 v149, v140, v140
  v_sub_f32 v140, v134, v148
  v_fmac_f32 v149, v140, v140
  v_sub_f32 v140, v135, v148
  v_fmac_f32 v149, v140, v140
  v_sub_f32 v140, v136, v148
  v_fmac_f32 v149, v140, v140
  v_sub_f32 v140, v137, v148
  v_fmac_f32 v149, v140, v140
  v_sub_f32 v140, v138, v148
  v_fmac_f32 v149, v140, v140
  v_sub_f32 v140, v139, v148
  v_fmac_f32 v149, v140, v140
  v_mov_b32 v140, v149
  s_nop 1
  v_permlane16_swap_b32 v149, v140
  v_add_f32 v149, v149, v140
  v_mov_b32 v140, v149
  s_nop 1
  v_permlane32_swap_b32 v149, v140
  v_add_f32 v149, v149, v140
  s_mov_b32 s40, s36
  s_mov_b32 s41, s37
  s_cmp_gt_u32 s35, 64
  s_cbranch_scc1 mega_kv_rw
  s_waitcnt vmcnt(0)
  v_cmp_gt_u32 vcc, s35, v14
  s_nop 0
  s_cbranch_vccnz mega_kv_rw
  buffer_load_dwordx4 v[152:155], v2, s[4:7], s31 offen sc1
  s_add_u32 s31, s31, 40960
  buffer_load_dwordx4 v[156:159], v2, s[4:7], s31 offen sc1
  s_add_u32 s31, s31, 40960
  buffer_load_dwordx4 v[160:163], v2, s[4:7], s31 offen sc1
  s_add_u32 s31, s31, 40960
  buffer_load_dwordx4 v[164:167], v2, s[4:7], s31 offen sc1
  s_add_u32 s31, s31, 40960
  buffer_load_dwordx4 v[168:171], v2, s[4:7], s31 offen sc1
  s_add_u32 s31, s31, 40960
  buffer_load_dwordx4 v[172:175], v2, s[4:7], s31 offen sc1
  s_add_u32 s31, s31, 40960
  buffer_load_dwordx4 v[176:179], v2, s[4:7], s31 offen sc1
  s_add_u32 s31, s31, 40960
  buffer_load_dwordx4 v[180:183], v2, s[4:7], s31 offen sc1
  s_add_u32 s31, s31, 40960
  buffer_load_dwordx4 v[184:187], v10, s[84:87], s33 offen sc1
  s_add_u32 s33, s33, 40960
  buffer_store_dwordx4 v[144:147], v2, s[4:7], s40 offen sc1
  buffer_store_dwordx2 v[148:149], v12, s[4:7], s41 offen sc1
  s_add_i32 s15, s35, -2
  s_max_i32 s15, s15, 0
  v_mov_b32 v8, s15
  s_mov_b64 exec, 1
  buffer_store_dword v8, v7, s[4:7], s39 offen sc1
  s_mov_b64 exec, -1
  s_waitcnt vmcnt(3)
  s_branch mega_kv_rn
mega_kv_rw:
  buffer_store_dwordx4 v[144:147], v2, s[4:7], s40 offen sc1
  buffer_store_dwordx2 v[148:149], v12, s[4:7], s41 offen sc1
  s_waitcnt vmcnt(0)
  s_add_i32 s15, s35, -1
  s_max_i32 s15, s15, 0
  v_mov_b32 v8, s15
  s_mov_b64 exec, 1
  buffer_store_dword v8, v7, s[4:7], s39 offen sc1
  s_mov_b64 exec, -1
  s_cmp_gt_u32 s35, 64
  s_cbranch_scc1 mega_kv_re
  s_mov_b32 s30, 0
mega_kernel_pv16:
  buffer_load_dword v14, v11, s[4:7], s71 offen sc1
  s_waitcnt vmcnt(0)
mega_kernel_pv16_t:
  v_cmp_gt_u32 vcc, s35, v14
  s_nop 0
  s_cbranch_vccz mega_kernel_pv16_ok
  s_sleep 1
  s_add_u32 s30, s30, 1
  s_cmp_lt_u32 s30, 262144
  s_cbranch_scc1 mega_kernel_pv16
  s_branch mega_fail
mega_kernel_pv16_ok:
  buffer_load_dwordx4 v[152:155], v2, s[4:7], s31 offen sc1
  s_add_u32 s31, s31, 40960
  buffer_load_dwordx4 v[156:159], v2, s[4:7], s31 offen sc1
  s_add_u32 s31, s31, 40960
  buffer_load_dwordx4 v[160:163], v2, s[4:7], s31 offen sc1
  s_add_u32 s31, s31, 40960
  buffer_load_dwordx4 v[164:167], v2, s[4:7], s31 offen sc1
  s_add_u32 s31, s31, 40960
  buffer_load_dwordx4 v[168:171], v2, s[4:7], s31 offen sc1
  s_add_u32 s31, s31, 40960
  buffer_load_dwordx4 v[172:175], v2, s[4:7], s31 offen sc1
  s_add_u32 s31, s31, 40960
  buffer_load_dwordx4 v[176:179], v2, s[4:7], s31 offen sc1
  s_add_u32 s31, s31, 40960
  buffer_load_dwordx4 v[180:183], v2, s[4:7], s31 offen sc1
  s_add_u32 s31, s31, 40960
  buffer_load_dwordx4 v[184:187], v10, s[84:87], s33 offen sc1
  s_add_u32 s33, s33, 40960
  s_waitcnt vmcnt(0)
mega_kv_rn:
  s_mov_b32 s36, s32
  s_mov_b32 s37, s38
  s_add_u32 s32, s32, 40960
  s_add_u32 s38, s38, 5120
  s_add_u32 s35, s35, 1
  s_branch mega_kv_rt
mega_kv_re:
  s_branch mega_blmain
mega_urole:
  s_getreg_b32 s27, hwreg(HW_REG_XCC_ID)
  s_and_b32 s27, s27, 7
  s_mul_i32 s28, s27, s27
  s_lshl_b32 s28, s28, 14
  s_lshl_b32 s27, s27, 6
  s_add_u32 s27, s27, s28
  s_add_u32 s69, s27, 1
  s_lshl_b32 s29, s68, 2
  s_cmp_eq_u32 s3, 0
  s_cselect_b32 s29, s29, 4096
  v_mov_b32 v13, s29
  v_mov_b32 v12, s69
  s_mov_b64 exec, 1
  buffer_atomic_add v12, v13, s[44:47], 0 offen sc0 sc1
  s_mov_b64 exec, -1
  s_mul_i32 s10, s80, 245760
  s_mul_i32 s11, s3, 320
  s_add_u32 s10, s10, s11
  s_mul_i32 s11, s3, 30720
  v_mul_u32_u24 v18, 3277, v1
  v_lshrrev_b32 v18, 16, v18
  v_mul_u32_u24 v16, 20, v18
  v_sub_u32 v16, v1, v16
  v_lshlrev_b32 v16, 4, v16
  v_mul_u32_u24 v18, 1280, v18
  v_add_u32 v16, v16, v18
  v_lshrrev_b32 v18, 4, v1
  v_mul_u32_u24 v18, 4, v18
  v_bfe_u32 v17, v1, 2, 2
  v_add_u32 v18, v18, v17
  v_mul_u32_u24 v18, 320, v18
  v_and_b32 v17, 3, v1
  v_lshl_add_u32 v17, v17, 3, v18
  v_add_u32 v17, s11, v17
  s_mov_b64 exec, s[82:83]
  s_add_u32 m0, s11, 0
  s_nop 0
  buffer_load_dwordx4 v16, s[92:95], s10 offen lds
  s_add_u32 s10, s10, 3840
  s_add_u32 m0, s11, 960
  s_nop 0
  buffer_load_dwordx4 v16, s[92:95], s10 offen lds
  s_add_u32 s10, s10, 3840
  s_add_u32 m0, s11, 1920
  s_nop 0
  buffer_load_dwordx4 v16, s[92:95], s10 offen lds
  s_add_u32 s10, s10, 3840
  s_add_u32 m0, s11, 2880
  s_nop 0
  buffer_load_dwordx4 v16, s[92:95], s10 offen lds
  s_add_u32 s10, s10, 3840
  s_add_u32 m0, s11, 3840
  s_nop 0
  buffer_load_dwordx4 v16, s[92:95], s10 offen lds
  s_add_u32 s10, s10, 3840
  s_add_u32 m0, s11, 4800
  s_nop 0
  buffer_load_dwordx4 v16, s[92:95], s10 offen lds
  s_add_u32 s10, s10, 3840
  s_add_u32 m0, s11, 5760
  s_nop 0
  buffer_load_dwordx4 v16, s[92:95], s10 offen lds
  s_add_u32 s10, s10, 3840
  s_add_u32 m0, s11, 6720
  s_nop 0
  buffer_load_dwordx4 v16, s[92:95], s10 offen lds
  s_add_u32 s10, s10, 3840
  s_add_u32 m0, s11, 7680
  s_nop 0
  buffer_load_dwordx4 v16, s[92:95], s10 offen lds
  s_add_u32 s10, s10, 3840
  s_add_u32 m0, s11, 8640
  s_nop 0
  buffer_load_dwordx4 v16, s[92:95], s10 offen lds
  s_add_u32 s10, s10, 3840
  s_add_u32 m0, s11, 9600
  s_nop 0
  buffer_load_dwordx4 v16, s[92:95], s10 offen lds
  s_add_u32 s10, s10, 3840
  s_add_u32 m0, s11, 10560
  s_nop 0
  buffer_load_dwordx4 v16, s[92:95], s10 offen lds
  s_add_u32 s10, s10, 3840
  s_add_u32 m0, s11, 11520
  s_nop 0
  buffer_load_dwordx4 v16, s[92:95], s10 offen lds
  s_add_u32 s10, s10, 3840
  s_add_u32 m0, s11, 12480
  s_nop 0
  buffer_load_dwordx4 v16, s[92:95], s10 offen lds
  s_add_u32 s10, s10, 3840
  s_add_u32 m0, s11, 13440
  s_nop 0
  buffer_load_dwordx4 v16, s[92:95], s10 offen lds
  s_add_u32 s10, s10, 3840
  s_add_u32 m0, s11, 14400
  s_nop 0
  buffer_load_dwordx4 v16, s[92:95], s10 offen lds
  s_add_u32 s10, s10, 3840
  s_add_u32 m0, s11, 15360
  s_nop 0
  buffer_load_dwordx4 v16, s[92:95], s10 offen lds
  s_add_u32 s10, s10, 3840
  s_add_u32 m0, s11, 16320
  s_nop 0
  buffer_load_dwordx4 v16, s[92:95], s10 offen lds
  s_add_u32 s10, s10, 3840
  s_add_u32 m0, s11, 17280
  s_nop 0
  buffer_load_dwordx4 v16, s[92:95], s10 offen lds
  s_add_u32 s10, s10, 3840
  s_add_u32 m0, s11, 18240
  s_nop 0
  buffer_load_dwordx4 v16, s[92:95], s10 offen lds
  s_add_u32 s10, s10, 3840
  s_add_u32 m0, s11, 19200
  s_nop 0
  buffer_load_dwordx4 v16, s[92:95], s10 offen lds
  s_add_u32 s10, s10, 3840
  s_add_u32 m0, s11, 20160
  s_nop 0
  buffer_load_dwordx4 v16, s[92:95], s10 offen lds
  s_add_u32 s10, s10, 3840
  s_add_u32 m0, s11, 21120
  s_nop 0
  buffer_load_dwordx4 v16, s[92:95], s10 offen lds
  s_add_u32 s10, s10, 3840
  s_add_u32 m0, s11, 22080
  s_nop 0
  buffer_load_dwordx4 v16, s[92:95], s10 offen lds
  s_add_u32 s10, s10, 3840
  s_add_u32 m0, s11, 23040
  s_nop 0
  buffer_load_dwordx4 v16, s[92:95], s10 offen lds
  s_add_u32 s10, s10, 3840
  s_add_u32 m0, s11, 24000
  s_nop 0
  buffer_load_dwordx4 v16, s[92:95], s10 offen lds
  s_add_u32 s10, s10, 3840
  s_add_u32 m0, s11, 24960
  s_nop 0
  buffer_load_dwordx4 v16, s[92:95], s10 offen lds
  s_add_u32 s10, s10, 3840
  s_add_u32 m0, s11, 25920
  s_nop 0
  buffer_load_dwordx4 v16, s[92:95], s10 offen lds
  s_add_u32 s10, s10, 3840
  s_add_u32 m0, s11, 26880
  s_nop 0
  buffer_load_dwordx4 v16, s[92:95], s10 offen lds
  s_add_u32 s10, s10, 3840
  s_add_u32 m0, s11, 27840
  s_nop 0
  buffer_load_dwordx4 v16, s[92:95], s10 offen lds
  s_add_u32 s10, s10, 3840
  s_add_u32 m0, s11, 28800
  s_nop 0
  buffer_load_dwordx4 v16, s[92:95], s10 offen lds
  s_add_u32 s10, s10, 3840
  s_add_u32 m0, s11, 29760
  s_nop 0
  buffer_load_dwordx4 v16, s[92:95], s10 offen lds
  s_add_u32 s10, s10, 3840
  s_mov_b64 exec, -1
  s_waitcnt vmcnt(26)
  v_readfirstlane_b32 s27, v12
  s_nop 0
  s_and_b32 s28, s27, 63
  s_cmp_eq_u32 s28, 31
  s_cbranch_scc1 mega_kernel_cf17
mega_kernel_cf17_b:
  ds_read_b64_tr_b16 a[0:1], v17 offset:0
  ds_read_b64_tr_b16 a[24:25], v17 offset:32
  ds_read_b64_tr_b16 a[48:49], v17 offset:64
  ds_read_b64_tr_b16 a[72:73], v17 offset:96
  ds_read_b64_tr_b16 a[96:97], v17 offset:128
  ds_read_b64_tr_b16 a[120:121], v17 offset:160
  ds_read_b64_tr_b16 a[144:145], v17 offset:192
  ds_read_b64_tr_b16 a[168:169], v17 offset:224
  ds_read_b64_tr_b16 a[192:193], v17 offset:256
  ds_read_b64_tr_b16 a[216:217], v17 offset:288
  s_waitcnt lgkmcnt(0)
  s_mov_b64 exec, s[82:83]
  s_add_u32 m0, s11, 0
  s_nop 0
  buffer_load_dwordx4 v16, s[92:95], s10 offen lds
  s_add_u32 s10, s10, 3840
  s_add_u32 m0, s11, 960
  s_nop 0
  buffer_load_dwordx4 v16, s[92:95], s10 offen lds
  s_add_u32 s10, s10, 3840
  s_add_u32 m0, s11, 1920
  s_nop 0
  buffer_load_dwordx4 v16, s[92:95], s10 offen lds
  s_add_u32 s10, s10, 3840
  s_add_u32 m0, s11, 2880
  s_nop 0
  buffer_load_dwordx4 v16, s[92:95], s10 offen lds
  s_add_u32 s10, s10, 3840
  s_add_u32 m0, s11, 3840
  s_nop 0
  buffer_load_dwordx4 v16, s[92:95], s10 offen lds
  s_add_u32 s10, s10, 3840
  s_mov_b64 exec, -1
  s_waitcnt vmcnt(26)
  ds_read_b64_tr_b16 a[2:3], v17 offset:5120
  ds_read_b64_tr_b16 a[26:27], v17 offset:5152
  ds_read_b64_tr_b16 a[50:51], v17 offset:5184
  ds_read_b64_tr_b16 a[74:75], v17 offset:5216
  ds_read_b64_tr_b16 a[98:99], v17 offset:5248
  ds_read_b64_tr_b16 a[122:123], v17 offset:5280
  ds_read_b64_tr_b16 a[146:147], v17 offset:5312
  ds_read_b64_tr_b16 a[170:171], v17 offset:5344
  ds_read_b64_tr_b16 a[194:195], v17 offset:5376
  ds_read_b64_tr_b16 a[218:219], v17 offset:5408
  s_waitcnt lgkmcnt(0)
  s_mov_b64 exec, s[82:83]
  s_add_u32 m0, s11, 4800
  s_nop 0
  buffer_load_dwordx4 v16, s[92:95], s10 offen lds
  s_add_u32 s10, s10, 3840
  s_add_u32 m0, s11, 5760
  s_nop 0
  buffer_load_dwordx4 v16, s[92:95], s10 offen lds
  s_add_u32 s10, s10, 3840
  s_add_u32 m0, s11, 6720
  s_nop 0
  buffer_load_dwordx4 v16, s[92:95], s10 offen lds
  s_add_u32 s10, s10, 3840
  s_add_u32 m0, s11, 7680
  s_nop 0
  buffer_load_dwordx4 v16, s[92:95], s10 offen lds
  s_add_u32 s10, s10, 3840
  s_add_u32 m0, s11, 8640
  s_nop 0
  buffer_load_dwordx4 v16, s[92:95], s10 offen lds
  s_add_u32 s10, s10, 3840
  s_mov_b64 exec, -1
  s_waitcnt vmcnt(26)
  ds_read_b64_tr_b16 a[16:17], v17 offset:10240
  ds_read_b64_tr_b16 a[40:41], v17 offset:10272
  ds_read_b64_tr_b16 a[64:65], v17 offset:10304
  ds_read_b64_tr_b16 a[88:89], v17 offset:10336
  ds_read_b64_tr_b16 a[112:113], v17 offset:10368
  ds_read_b64_tr_b16 a[136:137], v17 offset:10400
  ds_read_b64_tr_b16 a[160:161], v17 offset:10432
  ds_read_b64_tr_b16 a[184:185], v17 offset:10464
  ds_read_b64_tr_b16 a[208:209], v17 offset:10496
  ds_read_b64_tr_b16 a[232:233], v17 offset:10528
  s_waitcnt lgkmcnt(0)
  s_mov_b64 exec, s[82:83]
  s_add_u32 m0, s11, 9600
  s_nop 0
  buffer_load_dwordx4 v16, s[92:95], s10 offen lds
  s_add_u32 s10, s10, 3840
  s_add_u32 m0, s11, 10560
  s_nop 0
  buffer_load_dwordx4 v16, s[92:95], s10 offen lds
  s_add_u32 s10, s10, 3840
  s_add_u32 m0, s11, 11520
  s_nop 0
  buffer_load_dwordx4 v16, s[92:95], s10 offen lds
  s_add_u32 s10, s10, 3840
  s_add_u32 m0, s11, 12480
  s_nop 0
  buffer_load_dwordx4 v16, s[92:95], s10 offen lds
  s_add_u32 s10, s10, 3840
  s_add_u32 m0, s11, 13440
  s_nop 0
  buffer_load_dwordx4 v16, s[92:95], s10 offen lds
  s_add_u32 s10, s10, 3840
  s_add_u32 m0, s11, 14400
  s_nop 0
  buffer_load_dwordx4 v16, s[92:95], s10 offen lds
  s_add_u32 s10, s10, 3840
  s_mov_b64 exec, -1
  s_waitcnt vmcnt(26)
  ds_read_b64_tr_b16 a[4:5], v17 offset:15360
  ds_read_b64_tr_b16 a[28:29], v17 offset:15392
  ds_read_b64_tr_b16 a[52:53], v17 offset:15424
  ds_read_b64_tr_b16 a[76:77], v17 offset:15456
  ds_read_b64_tr_b16 a[100:101], v17 offset:15488
  ds_read_b64_tr_b16 a[124:125], v17 offset:15520
  ds_read_b64_tr_b16 a[148:149], v17 offset:15552
  ds_read_b64_tr_b16 a[172:173], v17 offset:15584
  ds_read_b64_tr_b16 a[196:197], v17 offset:15616
  ds_read_b64_tr_b16 a[220:221], v17 offset:15648
  s_waitcnt lgkmcnt(0)
  s_mov_b64 exec, s[82:83]
  s_add_u32 m0, s11, 15360
  s_nop 0
  buffer_load_dwordx4 v16, s[92:95], s10 offen lds
  s_add_u32 s10, s10, 3840
  s_add_u32 m0, s11, 16320
  s_nop 0
  buffer_load_dwordx4 v16, s[92:95], s10 offen lds
  s_add_u32 s10, s10, 3840
  s_add_u32 m0, s11, 17280
  s_nop 0
  buffer_load_dwordx4 v16, s[92:95], s10 offen lds
  s_add_u32 s10, s10, 3840
  s_add_u32 m0, s11, 18240
  s_nop 0
  buffer_load_dwordx4 v16, s[92:95], s10 offen lds
  s_add_u32 s10, s10, 3840
  s_add_u32 m0, s11, 19200
  s_nop 0
  buffer_load_dwordx4 v16, s[92:95], s10 offen lds
  s_add_u32 s10, s10, 3840
  s_mov_b64 exec, -1
  s_waitcnt vmcnt(26)
  ds_read_b64_tr_b16 a[6:7], v17 offset:20480
  ds_read_b64_tr_b16 a[30:31], v17 offset:20512
  ds_read_b64_tr_b16 a[54:55], v17 offset:20544
  ds_read_b64_tr_b16 a[78:79], v17 offset:20576
  ds_read_b64_tr_b16 a[102:103], v17 offset:20608
  ds_read_b64_tr_b16 a[126:127], v17 offset:20640
  ds_read_b64_tr_b16 a[150:151], v17 offset:20672
  ds_read_b64_tr_b16 a[174:175], v17 offset:20704
  ds_read_b64_tr_b16 a[198:199], v17 offset:20736
  ds_read_b64_tr_b16 a[222:223], v17 offset:20768
  s_waitcnt lgkmcnt(0)
  s_mov_b64 exec, s[82:83]
  s_add_u32 m0, s11, 20160
  s_nop 0
  buffer_load_dwordx4 v16, s[92:95], s10 offen lds
  s_add_u32 s10, s10, 3840
  s_add_u32 m0, s11, 21120
  s_nop 0
  buffer_load_dwordx4 v16, s[92:95], s10 offen lds
  s_add_u32 s10, s10, 3840
  s_add_u32 m0, s11, 22080
  s_nop 0
  buffer_load_dwordx4 v16, s[92:95], s10 offen lds
  s_add_u32 s10, s10, 3840
  s_add_u32 m0, s11, 23040
  s_nop 0
  buffer_load_dwordx4 v16, s[92:95], s10 offen lds
  s_add_u32 s10, s10, 3840
  s_add_u32 m0, s11, 24000
  s_nop 0
  buffer_load_dwordx4 v16, s[92:95], s10 offen lds
  s_add_u32 s10, s10, 3840
  s_mov_b64 exec, -1
  s_waitcnt vmcnt(26)
  ds_read_b64_tr_b16 a[18:19], v17 offset:25600
  ds_read_b64_tr_b16 a[42:43], v17 offset:25632
  ds_read_b64_tr_b16 a[66:67], v17 offset:25664
  ds_read_b64_tr_b16 a[90:91], v17 offset:25696
  ds_read_b64_tr_b16 a[114:115], v17 offset:25728
  ds_read_b64_tr_b16 a[138:139], v17 offset:25760
  ds_read_b64_tr_b16 a[162:163], v17 offset:25792
  ds_read_b64_tr_b16 a[186:187], v17 offset:25824
  ds_read_b64_tr_b16 a[210:211], v17 offset:25856
  ds_read_b64_tr_b16 a[234:235], v17 offset:25888
  s_waitcnt lgkmcnt(0)
  s_mov_b64 exec, s[82:83]
  s_add_u32 m0, s11, 24960
  s_nop 0
  buffer_load_dwordx4 v16, s[92:95], s10 offen lds
  s_add_u32 s10, s10, 3840
  s_add_u32 m0, s11, 25920
  s_nop 0
  buffer_load_dwordx4 v16, s[92:95], s10 offen lds
  s_add_u32 s10, s10, 3840
  s_add_u32 m0, s11, 26880
  s_nop 0
  buffer_load_dwordx4 v16, s[92:95], s10 offen lds
  s_add_u32 s10, s10, 3840
  s_add_u32 m0, s11, 27840
  s_nop 0
  buffer_load_dwordx4 v16, s[92:95], s10 offen lds
  s_add_u32 s10, s10, 3840
  s_add_u32 m0, s11, 28800
  s_nop 0
  buffer_load_dwordx4 v16, s[92:95], s10 offen lds
  s_add_u32 s10, s10, 3840
  s_add_u32 m0, s11, 29760
  s_nop 0
  buffer_load_dwordx4 v16, s[92:95], s10 offen lds
  s_add_u32 s10, s10, 3840
  s_mov_b64 exec, -1
  s_waitcnt vmcnt(26)
  ds_read_b64_tr_b16 a[8:9], v17 offset:0
  ds_read_b64_tr_b16 a[32:33], v17 offset:32
  ds_read_b64_tr_b16 a[56:57], v17 offset:64
  ds_read_b64_tr_b16 a[80:81], v17 offset:96
  ds_read_b64_tr_b16 a[104:105], v17 offset:128
  ds_read_b64_tr_b16 a[128:129], v17 offset:160
  ds_read_b64_tr_b16 a[152:153], v17 offset:192
  ds_read_b64_tr_b16 a[176:177], v17 offset:224
  ds_read_b64_tr_b16 a[200:201], v17 offset:256
  ds_read_b64_tr_b16 a[224:225], v17 offset:288
  s_waitcnt vmcnt(21)
  ds_read_b64_tr_b16 a[10:11], v17 offset:5120
  ds_read_b64_tr_b16 a[34:35], v17 offset:5152
  ds_read_b64_tr_b16 a[58:59], v17 offset:5184
  ds_read_b64_tr_b16 a[82:83], v17 offset:5216
  ds_read_b64_tr_b16 a[106:107], v17 offset:5248
  ds_read_b64_tr_b16 a[130:131], v17 offset:5280
  ds_read_b64_tr_b16 a[154:155], v17 offset:5312
  ds_read_b64_tr_b16 a[178:179], v17 offset:5344
  ds_read_b64_tr_b16 a[202:203], v17 offset:5376
  ds_read_b64_tr_b16 a[226:227], v17 offset:5408
  s_waitcnt vmcnt(16)
  ds_read_b64_tr_b16 a[20:21], v17 offset:10240
  ds_read_b64_tr_b16 a[44:45], v17 offset:10272
  ds_read_b64_tr_b16 a[68:69], v17 offset:10304
  ds_read_b64_tr_b16 a[92:93], v17 offset:10336
  ds_read_b64_tr_b16 a[116:117], v17 offset:10368
  ds_read_b64_tr_b16 a[140:141], v17 offset:10400
  ds_read_b64_tr_b16 a[164:165], v17 offset:10432
  ds_read_b64_tr_b16 a[188:189], v17 offset:10464
  ds_read_b64_tr_b16 a[212:213], v17 offset:10496
  ds_read_b64_tr_b16 a[236:237], v17 offset:10528
  s_waitcnt vmcnt(10)
  ds_read_b64_tr_b16 a[12:13], v17 offset:15360
  ds_read_b64_tr_b16 a[36:37], v17 offset:15392
  ds_read_b64_tr_b16 a[60:61], v17 offset:15424
  ds_read_b64_tr_b16 a[84:85], v17 offset:15456
  ds_read_b64_tr_b16 a[108:109], v17 offset:15488
  ds_read_b64_tr_b16 a[132:133], v17 offset:15520
  ds_read_b64_tr_b16 a[156:157], v17 offset:15552
  ds_read_b64_tr_b16 a[180:181], v17 offset:15584
  ds_read_b64_tr_b16 a[204:205], v17 offset:15616
  ds_read_b64_tr_b16 a[228:229], v17 offset:15648
  s_waitcnt vmcnt(5)
  ds_read_b64_tr_b16 a[14:15], v17 offset:20480
  ds_read_b64_tr_b16 a[38:39], v17 offset:20512
  ds_read_b64_tr_b16 a[62:63], v17 offset:20544
  ds_read_b64_tr_b16 a[86:87], v17 offset:20576
  ds_read_b64_tr_b16 a[110:111], v17 offset:20608
  ds_read_b64_tr_b16 a[134:135], v17 offset:20640
  ds_read_b64_tr_b16 a[158:159], v17 offset:20672
  ds_read_b64_tr_b16 a[182:183], v17 offset:20704
  ds_read_b64_tr_b16 a[206:207], v17 offset:20736
  ds_read_b64_tr_b16 a[230:231], v17 offset:20768
  s_waitcnt vmcnt(0)
  ds_read_b64_tr_b16 a[22:23], v17 offset:25600
  ds_read_b64_tr_b16 a[46:47], v17 offset:25632
  ds_read_b64_tr_b16 a[70:71], v17 offset:25664
  ds_read_b64_tr_b16 a[94:95], v17 offset:25696
  ds_read_b64_tr_b16 a[118:119], v17 offset:25728
  ds_read_b64_tr_b16 a[142:143], v17 offset:25760
  ds_read_b64_tr_b16 a[166:167], v17 offset:25792
  ds_read_b64_tr_b16 a[190:191], v17 offset:25824
  ds_read_b64_tr_b16 a[214:215], v17 offset:25856
  ds_read_b64_tr_b16 a[238:239], v17 offset:25888
  s_waitcnt lgkmcnt(0)
  v_mov_b32 v18, 128
  s_mov_b32 s28, 0
mega_kernel_cen19:
  buffer_load_dwordx2 v[16:17], v18, s[44:47], 0 offen sc1
  s_waitcnt vmcnt(0)
  v_readfirstlane_b32 s69, v16
  v_readfirstlane_b32 s100, v17
  s_nop 0
  s_min_u32 vcc_lo, s69, s100
  s_cmp_lg_u32 vcc_lo, 0
  s_cbranch_scc1 mega_kernel_cen19_done
  s_sleep 4
  s_add_u32 s28, s28, 1
  s_cmp_lt_u32 s28, 262144
  s_cbranch_scc1 mega_kernel_cen19
  s_branch mega_fail
mega_kernel_cen19_done:
  s_lshr_b32 s69, s69, s68
  s_bfe_u32 s69, s69, 0x10008
  s_mov_b32 s28, 0
  s_bfe_u32 vcc_lo, s100, 0x40008
  s_cmp_lt_u32 vcc_lo, 4
  s_cselect_b32 vcc_lo, 1, 0
  s_or_b32 s28, s28, vcc_lo
  s_bfe_u32 vcc_lo, s100, 0x4000c
  s_cmp_lt_u32 vcc_lo, 4
  s_cselect_b32 vcc_lo, 2, 0
  s_or_b32 s28, s28, vcc_lo
  s_bfe_u32 vcc_lo, s100, 0x40010
  s_cmp_lt_u32 vcc_lo, 4
  s_cselect_b32 vcc_lo, 4, 0
  s_or_b32 s28, s28, vcc_lo
  s_bfe_u32 vcc_lo, s100, 0x40014
  s_cmp_lt_u32 vcc_lo, 4
  s_cselect_b32 vcc_lo, 8, 0
  s_or_b32 s28, s28, vcc_lo
  s_mov_b32 s100, s28
mega_u_layer:
  v_lshlrev_b32 v2, 4, v1
  v_mov_b32 v7, 0
  s_and_b32 s9, s80, 3
  s_mul_i32 s12, s9, 12288
  s_lshl_b32 s13, s3, 10
  s_add_u32 s12, s12, s13
  s_add_u32 s12, s12, s78
  s_add_u32 s12, s12, 253952
  s_add_u32 s13, s13, 122880
  v_add_u32 v5, 122880, v2
  s_mov_b32 s19, 12288
  s_mul_i32 s14, s9, 40960
  s_mul_i32 s15, s3, 10240
  s_add_u32 s14, s14, s15
  s_add_u32 s14, s14, s78
  s_lshl_b32 s21, s80, 7
  s_add_u32 s21, s21, s71
  s_lshl_b32 s15, s3, 2
  s_add_u32 s21, s21, s15
  s_add_u32 s21, s21, 12288
  v_bfe_u32 v8, v1, 4, 1
  v_sub_u32 v9, 2, v8
  v_and_b32 v6, 3, v1
  v_min_u32 v9, v9, v6
  v_lshlrev_b32 v9, 2, v9
  v_lshl_add_u32 v9, v8, 12, v9
  v_bfe_u32 v8, v1, 2, 2
  v_lshl_add_u32 v9, v8, 7, v9
  s_lshl_b32 s15, s68, 9
  s_add_u32 s15, s15, 16
  v_add_u32 v9, s15, v9
  v_mov_b32 v10, 4
  v_lshlrev_b32 v6, 2, v6
  s_lshl_b32 s15, s80, 7
  s_add_u32 s15, s15, 4096
  v_add_u32 v6, s15, v6
  s_and_b32 s26, s68, 3
  s_lshr_b32 s25, s100, s26
  s_lshr_b32 s27, s68, 2
  s_xor_b32 s25, s25, s27
  s_and_b32 s25, s25, 1
  s_lshl_b32 s25, s25, 13
  s_mul_i32 s26, s26, 2260992
  s_add_u32 s25, s25, s26
  s_add_u32 s26, s4, 45105151
  s_and_b32 s26, s26, 0xffe00000
  s_sub_u32 s26, s26, s4
  s_add_u32 s25, s25, s26
  s_lshl_b32 s26, s9, 2
  s_add_u32 s26, s26, s3
  s_lshr_b32 s27, s26, 3
  s_lshl_b32 s27, s27, 14
  s_and_b32 s26, s26, 7
  s_lshl_b32 s26, s26, 10
  s_add_u32 s25, s25, s26
  s_add_u32 s25, s25, s27
  s_mul_i32 s26, s70, 63
  s_add_u32 s26, s26, 2
  v_mov_b32 v12, -1
  v_mov_b32 v13, -1
  v_mov_b32 v14, -1
  v_mov_b32 v15, -1
  s_mov_b32 s20, 0
  s_mov_b32 s24, 1
mega_u_loop:
  s_mov_b32 s30, 0
mega_kernel_pv20:
  buffer_load_dword v8, v6, s[4:7], s71 offen sc1
  s_waitcnt vmcnt(0)
mega_kernel_pv20_t:
  v_cmp_gt_u32 vcc, s24, v8
  s_nop 0
  s_cbranch_vccz mega_kernel_pv20_ok
  s_sleep 1
  s_add_u32 s30, s30, 1
  s_cmp_lt_u32 s30, 262144
  s_cbranch_scc1 mega_kernel_pv20
  s_branch mega_fail
mega_kernel_pv20_ok:
  s_add_u32 s15, s12, s20
  s_add_u32 m0, s13, 0
  s_add_u32 s22, s15, 0
  buffer_load_dwordx4 v2, s[4:7], s22 offen sc1 lds
  s_add_u32 m0, s13, 4096
  s_add_u32 s22, s15, 4096
  buffer_load_dwordx4 v2, s[4:7], s22 offen sc1 lds
  s_add_u32 m0, s13, 8192
  s_add_u32 s22, s15, 8192
  buffer_load_dwordx4 v2, s[4:7], s22 offen sc1 lds
  s_waitcnt vmcnt(0)
mega_u_have:
  s_barrier
  ds_read_b128 v[16:19], v5 offset:0
  ds_read_b128 v[40:43], v5 offset:4096
  ds_read_b128 v[20:23], v5 offset:1024
  ds_read_b128 v[44:47], v5 offset:5120
  ds_read_b128 v[24:27], v5 offset:2048
  ds_read_b128 v[48:51], v5 offset:6144
  ds_read_b128 v[28:31], v5 offset:3072
  ds_read_b128 v[52:55], v5 offset:7168
  ds_read_b64 v[32:33], v5 offset:8192
  ds_read_b64 v[34:35], v5 offset:9216
  ds_read_b64 v[56:57], v5 offset:8200
  ds_read_b64 v[58:59], v5 offset:9224
  ds_read_b64 v[36:37], v5 offset:10240
  ds_read_b64 v[38:39], v5 offset:11264
  s_waitcnt lgkmcnt(12)
  ds_read_b64 v[60:61], v5 offset:10248
  ds_read_b64 v[62:63], v5 offset:11272
  s_mov_b32 s30, 0
mega_kernel_pv21:
  buffer_load_dword v8, v9, s[4:7], s71 offen sc1
  s_waitcnt vmcnt(0)
mega_kernel_pv21_t:
  v_add_u32 v8, v8, v10
  v_cmp_gt_u32 vcc, s24, v8
  s_nop 0
  s_cbranch_vccz mega_kernel_pv21_ok
  s_sleep 1
  s_add_u32 s30, s30, 1
  s_cmp_lt_u32 s30, 262144
  s_cbranch_scc1 mega_kernel_pv21
  s_branch mega_fail
mega_kernel_pv21_ok:
  s_waitcnt lgkmcnt(14)
  v_mfma_f32_16x16x32_bf16 v[112:115], v[16:19], a[0:3], 0
  s_add_u32 s16, s14, s20
  v_mfma_f32_16x16x32_bf16 v[116:119], v[40:43], a[0:3], 0
  s_add_u32 s17, s16, 4096
  s_waitcnt lgkmcnt(12)
  v_mfma_f32_16x16x32_bf16 v[112:115], v[20:23], a[4:7], v[112:115]
  s_add_u32 s18, s16, 8192
  v_mfma_f32_16x16x32_bf16 v[116:119], v[44:47], a[4:7], v[116:119]
  s_and_b32 s27, s26, 7
  s_waitcnt lgkmcnt(10)
  v_mfma_f32_16x16x32_bf16 v[112:115], v[24:27], a[8:11], v[112:115]
  s_mul_i32 s27, s27, 163840
  v_mfma_f32_16x16x32_bf16 v[116:119], v[48:51], a[8:11], v[116:119]
  s_add_u32 s27, s27, s25
  s_waitcnt lgkmcnt(8)
  v_mfma_f32_16x16x32_bf16 v[112:115], v[28:31], a[12:15], v[112:115]
  s_add_u32 s26, s26, 1
  v_mfma_f32_16x16x32_bf16 v[116:119], v[52:55], a[12:15], v[116:119]
  s_add_u32 s23, s24, 1
  s_waitcnt lgkmcnt(4)
  v_mfma_f32_16x16x32_bf16 v[112:115], v[32:35], a[16:19], v[112:115]
  v_add_u32 v5, s19, v5
  v_mfma_f32_16x16x32_bf16 v[116:119], v[56:59], a[16:19], v[116:119]
  s_waitcnt lgkmcnt(0)
  v_mfma_f32_16x16x32_bf16 v[112:115], v[36:39], a[20:23], v[112:115]
  buffer_store_dwordx4 v[12:15], v2, s[4:7], s27 offen sc1
  v_mfma_f32_16x16x32_bf16 v[116:119], v[60:63], a[20:23], v[116:119]
  s_add_u32 s27, s27, 32768
  v_mfma_f32_16x16x32_bf16 v[120:123], v[16:19], a[24:27], 0
  v_mfma_f32_16x16x32_bf16 v[124:127], v[40:43], a[24:27], 0
  s_add_u32 s13, s13, s19
  s_sub_u32 s19, 0, s19
  s_add_u32 s20, s20, 325632
  s_cmp_ge_u32 s20, 1302528
  s_cselect_b32 s20, 0, s20
  v_mfma_f32_16x16x32_bf16 v[120:123], v[20:23], a[28:31], v[120:123]
  v_mfma_f32_16x16x32_bf16 v[124:127], v[44:47], a[28:31], v[124:127]
  v_mfma_f32_16x16x32_bf16 v[120:123], v[24:27], a[32:35], v[120:123]
  v_cvt_pk_bf16_f32 v128, v112, v113
  v_mfma_f32_16x16x32_bf16 v[124:127], v[48:51], a[32:35], v[124:127]
  v_cvt_pk_bf16_f32 v129, v114, v115
  v_mfma_f32_16x16x32_bf16 v[120:123], v[28:31], a[36:39], v[120:123]
  v_cvt_pk_bf16_f32 v130, v116, v117
  v_mfma_f32_16x16x32_bf16 v[124:127], v[52:55], a[36:39], v[124:127]
  v_cvt_pk_bf16_f32 v131, v118, v119
  v_mfma_f32_16x16x32_bf16 v[120:123], v[32:35], a[40:43], v[120:123]
  buffer_store_dwordx4 v[128:131], v2, s[4:7], s16 offen offset:0
  v_mfma_f32_16x16x32_bf16 v[124:127], v[56:59], a[40:43], v[124:127]
  v_mfma_f32_16x16x32_bf16 v[120:123], v[36:39], a[44:47], v[120:123]
  buffer_store_dwordx4 v[12:15], v2, s[4:7], s27 offen sc1
  v_mfma_f32_16x16x32_bf16 v[124:127], v[60:63], a[44:47], v[124:127]
  s_add_u32 s27, s27, 32768
  v_mfma_f32_16x16x32_bf16 v[112:115], v[16:19], a[48:51], 0
  v_mfma_f32_16x16x32_bf16 v[116:119], v[40:43], a[48:51], 0
  v_mfma_f32_16x16x32_bf16 v[112:115], v[20:23], a[52:55], v[112:115]
  v_mfma_f32_16x16x32_bf16 v[116:119], v[44:47], a[52:55], v[116:119]
  v_mfma_f32_16x16x32_bf16 v[112:115], v[24:27], a[56:59], v[112:115]
  v_cvt_pk_bf16_f32 v132, v120, v121
  v_mfma_f32_16x16x32_bf16 v[116:119], v[48:51], a[56:59], v[116:119]
  v_cvt_pk_bf16_f32 v133, v122, v123
  v_mfma_f32_16x16x32_bf16 v[112:115], v[28:31], a[60:63], v[112:115]
  v_cvt_pk_bf16_f32 v134, v124, v125
  v_mfma_f32_16x16x32_bf16 v[116:119], v[52:55], a[60:63], v[116:119]
  v_cvt_pk_bf16_f32 v135, v126, v127
  v_mfma_f32_16x16x32_bf16 v[112:115], v[32:35], a[64:67], v[112:115]
  buffer_store_dwordx4 v[132:135], v2, s[4:7], s16 offen offset:1024
  v_mfma_f32_16x16x32_bf16 v[116:119], v[56:59], a[64:67], v[116:119]
  v_mfma_f32_16x16x32_bf16 v[112:115], v[36:39], a[68:71], v[112:115]
  buffer_store_dwordx4 v[12:15], v2, s[4:7], s27 offen sc1
  v_mfma_f32_16x16x32_bf16 v[116:119], v[60:63], a[68:71], v[116:119]
  s_add_u32 s27, s27, 32768
  v_mfma_f32_16x16x32_bf16 v[120:123], v[16:19], a[72:75], 0
  v_mfma_f32_16x16x32_bf16 v[124:127], v[40:43], a[72:75], 0
  v_mfma_f32_16x16x32_bf16 v[120:123], v[20:23], a[76:79], v[120:123]
  v_mfma_f32_16x16x32_bf16 v[124:127], v[44:47], a[76:79], v[124:127]
  v_mfma_f32_16x16x32_bf16 v[120:123], v[24:27], a[80:83], v[120:123]
  v_cvt_pk_bf16_f32 v128, v112, v113
  v_mfma_f32_16x16x32_bf16 v[124:127], v[48:51], a[80:83], v[124:127]
  v_cvt_pk_bf16_f32 v129, v114, v115
  v_mfma_f32_16x16x32_bf16 v[120:123], v[28:31], a[84:87], v[120:123]
  v_cvt_pk_bf16_f32 v130, v116, v117
  v_mfma_f32_16x16x32_bf16 v[124:127], v[52:55], a[84:87], v[124:127]
  v_cvt_pk_bf16_f32 v131, v118, v119
  v_mfma_f32_16x16x32_bf16 v[120:123], v[32:35], a[88:91], v[120:123]
  buffer_store_dwordx4 v[128:131], v2, s[4:7], s16 offen offset:2048
  v_mfma_f32_16x16x32_bf16 v[124:127], v[56:59], a[88:91], v[124:127]
  v_mfma_f32_16x16x32_bf16 v[120:123], v[36:39], a[92:95], v[120:123]
  buffer_store_dwordx4 v[12:15], v2, s[4:7], s27 offen sc1
  v_mfma_f32_16x16x32_bf16 v[124:127], v[60:63], a[92:95], v[124:127]
  s_add_u32 s27, s27, 32768
  v_mfma_f32_16x16x32_bf16 v[112:115], v[16:19], a[96:99], 0
  v_mfma_f32_16x16x32_bf16 v[116:119], v[40:43], a[96:99], 0
  v_mfma_f32_16x16x32_bf16 v[112:115], v[20:23], a[100:103], v[112:115]
  v_mfma_f32_16x16x32_bf16 v[116:119], v[44:47], a[100:103], v[116:119]
  v_mfma_f32_16x16x32_bf16 v[112:115], v[24:27], a[104:107], v[112:115]
  v_cvt_pk_bf16_f32 v132, v120, v121
  v_mfma_f32_16x16x32_bf16 v[116:119], v[48:51], a[104:107], v[116:119]
  v_cvt_pk_bf16_f32 v133, v122, v123
  v_mfma_f32_16x16x32_bf16 v[112:115], v[28:31], a[108:111], v[112:115]
  v_cvt_pk_bf16_f32 v134, v124, v125
  v_mfma_f32_16x16x32_bf16 v[116:119], v[52:55], a[108:111], v[116:119]
  v_cvt_pk_bf16_f32 v135, v126, v127
  v_mfma_f32_16x16x32_bf16 v[112:115], v[32:35], a[112:115], v[112:115]
  buffer_store_dwordx4 v[132:135], v2, s[4:7], s16 offen offset:3072
  v_mfma_f32_16x16x32_bf16 v[116:119], v[56:59], a[112:115], v[116:119]
  v_mfma_f32_16x16x32_bf16 v[112:115], v[36:39], a[116:119], v[112:115]
  buffer_store_dwordx4 v[12:15], v2, s[4:7], s27 offen sc1
  v_mfma_f32_16x16x32_bf16 v[116:119], v[60:63], a[116:119], v[116:119]
  s_add_u32 s27, s27, 32768
  v_mfma_f32_16x16x32_bf16 v[120:123], v[16:19], a[120:123], 0
  v_mfma_f32_16x16x32_bf16 v[124:127], v[40:43], a[120:123], 0
  v_mfma_f32_16x16x32_bf16 v[120:123], v[20:23], a[124:127], v[120:123]
  v_mfma_f32_16x16x32_bf16 v[124:127], v[44:47], a[124:127], v[124:127]
  v_mfma_f32_16x16x32_bf16 v[120:123], v[24:27], a[128:131], v[120:123]
  v_cvt_pk_bf16_f32 v128, v112, v113
  v_mfma_f32_16x16x32_bf16 v[124:127], v[48:51], a[128:131], v[124:127]
  v_cvt_pk_bf16_f32 v129, v114, v115
  v_mfma_f32_16x16x32_bf16 v[120:123], v[28:31], a[132:135], v[120:123]
  v_cvt_pk_bf16_f32 v130, v116, v117
  v_mfma_f32_16x16x32_bf16 v[124:127], v[52:55], a[132:135], v[124:127]
  v_cvt_pk_bf16_f32 v131, v118, v119
  v_mfma_f32_16x16x32_bf16 v[120:123], v[32:35], a[136:139], v[120:123]
  buffer_store_dwordx4 v[128:131], v2, s[4:7], s17 offen offset:0
  v_mfma_f32_16x16x32_bf16 v[124:127], v[56:59], a[136:139], v[124:127]
  v_mfma_f32_16x16x32_bf16 v[120:123], v[36:39], a[140:143], v[120:123]
  buffer_load_dword v8, v6, s[4:7], s71 offen sc1
  v_mfma_f32_16x16x32_bf16 v[124:127], v[60:63], a[140:143], v[124:127]
  v_mfma_f32_16x16x32_bf16 v[112:115], v[16:19], a[144:147], 0
  v_mfma_f32_16x16x32_bf16 v[116:119], v[40:43], a[144:147], 0
  v_mfma_f32_16x16x32_bf16 v[112:115], v[20:23], a[148:151], v[112:115]
  v_mfma_f32_16x16x32_bf16 v[116:119], v[44:47], a[148:151], v[116:119]
  v_mfma_f32_16x16x32_bf16 v[112:115], v[24:27], a[152:155], v[112:115]
  v_cvt_pk_bf16_f32 v132, v120, v121
  v_mfma_f32_16x16x32_bf16 v[116:119], v[48:51], a[152:155], v[116:119]
  v_cvt_pk_bf16_f32 v133, v122, v123
  v_mfma_f32_16x16x32_bf16 v[112:115], v[28:31], a[156:159], v[112:115]
  v_cvt_pk_bf16_f32 v134, v124, v125
  v_mfma_f32_16x16x32_bf16 v[116:119], v[52:55], a[156:159], v[116:119]
  v_cvt_pk_bf16_f32 v135, v126, v127
  v_mfma_f32_16x16x32_bf16 v[112:115], v[32:35], a[160:163], v[112:115]
  buffer_store_dwordx4 v[132:135], v2, s[4:7], s17 offen offset:1024
  v_mfma_f32_16x16x32_bf16 v[116:119], v[56:59], a[160:163], v[116:119]
  v_mfma_f32_16x16x32_bf16 v[112:115], v[36:39], a[164:167], v[112:115]
  v_mfma_f32_16x16x32_bf16 v[116:119], v[60:63], a[164:167], v[116:119]
  v_mfma_f32_16x16x32_bf16 v[120:123], v[16:19], a[168:171], 0
  v_mfma_f32_16x16x32_bf16 v[124:127], v[40:43], a[168:171], 0
  v_mfma_f32_16x16x32_bf16 v[120:123], v[20:23], a[172:175], v[120:123]
  v_mfma_f32_16x16x32_bf16 v[124:127], v[44:47], a[172:175], v[124:127]
  v_mfma_f32_16x16x32_bf16 v[120:123], v[24:27], a[176:179], v[120:123]
  v_cvt_pk_bf16_f32 v128, v112, v113
  v_mfma_f32_16x16x32_bf16 v[124:127], v[48:51], a[176:179], v[124:127]
  v_cvt_pk_bf16_f32 v129, v114, v115
  v_mfma_f32_16x16x32_bf16 v[120:123], v[28:31], a[180:183], v[120:123]
  v_cvt_pk_bf16_f32 v130, v116, v117
  v_mfma_f32_16x16x32_bf16 v[124:127], v[52:55], a[180:183], v[124:127]
  v_cvt_pk_bf16_f32 v131, v118, v119
  v_mfma_f32_16x16x32_bf16 v[120:123], v[32:35], a[184:187], v[120:123]
  buffer_store_dwordx4 v[128:131], v2, s[4:7], s17 offen offset:2048
  v_mfma_f32_16x16x32_bf16 v[124:127], v[56:59], a[184:187], v[124:127]
  v_mfma_f32_16x16x32_bf16 v[120:123], v[36:39], a[188:191], v[120:123]
  v_mfma_f32_16x16x32_bf16 v[124:127], v[60:63], a[188:191], v[124:127]
  v_mfma_f32_16x16x32_bf16 v[112:115], v[16:19], a[192:195], 0
  v_mfma_f32_16x16x32_bf16 v[116:119], v[40:43], a[192:195], 0
  v_mfma_f32_16x16x32_bf16 v[112:115], v[20:23], a[196:199], v[112:115]
  v_mfma_f32_16x16x32_bf16 v[116:119], v[44:47], a[196:199], v[116:119]
  v_mfma_f32_16x16x32_bf16 v[112:115], v[24:27], a[200:203], v[112:115]
  v_cvt_pk_bf16_f32 v132, v120, v121
  v_mfma_f32_16x16x32_bf16 v[116:119], v[48:51], a[200:203], v[116:119]
  v_cvt_pk_bf16_f32 v133, v122, v123
  v_mfma_f32_16x16x32_bf16 v[112:115], v[28:31], a[204:207], v[112:115]
  v_cvt_pk_bf16_f32 v134, v124, v125
  v_mfma_f32_16x16x32_bf16 v[116:119], v[52:55], a[204:207], v[116:119]
  v_cvt_pk_bf16_f32 v135, v126, v127
  v_mfma_f32_16x16x32_bf16 v[112:115], v[32:35], a[208:211], v[112:115]
  buffer_store_dwordx4 v[132:135], v2, s[4:7], s17 offen offset:3072
  v_mfma_f32_16x16x32_bf16 v[116:119], v[56:59], a[208:211], v[116:119]
  v_mfma_f32_16x16x32_bf16 v[112:115], v[36:39], a[212:215], v[112:115]
  v_mfma_f32_16x16x32_bf16 v[116:119], v[60:63], a[212:215], v[116:119]
  s_waitcnt vmcnt(3)
  v_cmp_gt_u32 vcc, s23, v8
  s_mov_b32 s28, 0
  s_cbranch_vccnz mega_u_nov
  s_add_u32 s15, s12, s20
  s_add_u32 m0, s13, 0
  s_add_u32 s22, s15, 0
  buffer_load_dwordx4 v2, s[4:7], s22 offen sc1 lds
  s_add_u32 m0, s13, 4096
  s_add_u32 s22, s15, 4096
  buffer_load_dwordx4 v2, s[4:7], s22 offen sc1 lds
  s_add_u32 m0, s13, 8192
  s_add_u32 s22, s15, 8192
  buffer_load_dwordx4 v2, s[4:7], s22 offen sc1 lds
  s_mov_b32 s28, 1
mega_u_nov:
  v_mfma_f32_16x16x32_bf16 v[120:123], v[16:19], a[216:219], 0
  v_mfma_f32_16x16x32_bf16 v[124:127], v[40:43], a[216:219], 0
  v_mfma_f32_16x16x32_bf16 v[120:123], v[20:23], a[220:223], v[120:123]
  v_mfma_f32_16x16x32_bf16 v[124:127], v[44:47], a[220:223], v[124:127]
  v_mfma_f32_16x16x32_bf16 v[120:123], v[24:27], a[224:227], v[120:123]
  v_cvt_pk_bf16_f32 v128, v112, v113
  v_mfma_f32_16x16x32_bf16 v[124:127], v[48:51], a[224:227], v[124:127]
  v_cvt_pk_bf16_f32 v129, v114, v115
  v_mfma_f32_16x16x32_bf16 v[120:123], v[28:31], a[228:231], v[120:123]
  v_cvt_pk_bf16_f32 v130, v116, v117
  v_mfma_f32_16x16x32_bf16 v[124:127], v[52:55], a[228:231], v[124:127]
  v_cvt_pk_bf16_f32 v131, v118, v119
  v_mfma_f32_16x16x32_bf16 v[120:123], v[32:35], a[232:235], v[120:123]
  buffer_store_dwordx4 v[128:131], v2, s[4:7], s18 offen offset:0
  v_mfma_f32_16x16x32_bf16 v[124:127], v[56:59], a[232:235], v[124:127]
  v_mfma_f32_16x16x32_bf16 v[120:123], v[36:39], a[236:239], v[120:123]
  v_mfma_f32_16x16x32_bf16 v[124:127], v[60:63], a[236:239], v[124:127]
  s_nop 4
  v_cvt_pk_bf16_f32 v132, v120, v121
  v_cvt_pk_bf16_f32 v133, v122, v123
  s_nop 0
  v_cvt_pk_bf16_f32 v134, v124, v125
  v_cvt_pk_bf16_f32 v135, v126, v127
  buffer_store_dwordx4 v[132:135], v2, s[4:7], s18 offen offset:1024
  s_waitcnt vmcnt(0)
  v_mov_b32 v8, s24
  s_mov_b64 exec, 1
  s_cmp_lg_u32 s69, 0
  s_cbranch_scc1 mega_kernel_pf22
  buffer_store_dword v8, v7, s[4:7], s21 offen
mega_kernel_pf22_b:
  s_mov_b64 exec, -1
  s_add_u32 s24, s24, 1
  s_cmp_eq_u32 s28, 1
  s_cbranch_scc1 mega_u_have
  s_cmp_le_u32 s24, 64
  s_cbranch_scc1 mega_u_loop
  s_branch mega_bl
mega_qrole:
  s_lshl_b32 s9, s80, 2
  s_add_u32 s9, s9, s3
  s_add_u32 s10, s9, 128
  v_and_b32 v2, 15, v1
  v_lshrrev_b32 v3, 4, v1
  v_mul_u32_u24 v4, 1280, v3
  v_lshl_add_u32 v4, v2, 4, v4
  s_mul_i32 s20, s10, 10240
  s_add_u32 s21, s20, 5120
  buffer_load_dwordx4 v[100:103], v4, s[84:87], s20 offen offset:0
  buffer_load_dwordx4 v[104:107], v4, s[84:87], s20 offen offset:256
  buffer_load_dwordx4 v[108:111], v4, s[84:87], s20 offen offset:512
  buffer_load_dwordx4 v[112:115], v4, s[84:87], s20 offen offset:768
  buffer_load_dwordx4 v[116:119], v4, s[84:87], s20 offen offset:1024
  buffer_load_dwordx4 v[120:123], v4, s[84:87], s21 offen offset:0
  buffer_load_dwordx4 v[124:127], v4, s[84:87], s21 offen offset:256
  buffer_load_dwordx4 v[128:131], v4, s[84:87], s21 offen offset:512
  buffer_load_dwordx4 v[132:135], v4, s[84:87], s21 offen offset:768
  buffer_load_dwordx4 v[136:139], v4, s[84:87], s21 offen offset:1024
  v_lshrrev_b32 v5, 2, v2
  v_lshlrev_b32 v5, 10, v5
  v_and_b32 v6, 3, v2
  v_lshl_add_u32 v5, v6, 8, v5
  v_lshl_add_u32 v96, v3, 4, v5
  v_lshlrev_b32 v3, 4, v1
  s_add_u32 s24, s4, 45105151
  s_and_b32 s24, s24, 0xffe00000
  s_sub_u32 s24, s24, s4
  s_and_b32 s25, s9, 3
  s_mul_i32 s25, s25, 2260992
  s_add_u32 s24, s24, s25
  s_lshr_b32 s25, s9, 2
  s_lshl_b32 s25, s25, 14
  s_add_u32 s24, s24, s25
  s_lshl_b32 s25, s9, 14
  s_add_u32 s26, s25, 41107456
  s_add_u32 s25, s25, 51593216
  s_cmp_lt_u32 s9, 80
  s_cselect_b32 s24, s24, s26
  s_cmp_lt_u32 s9, 116
  s_cselect_b32 s24, s24, s25
  s_cselect_b32 s25, -1, 0
  s_cmp_lt_u32 s9, 127
  s_cselect_b32 s24, s24, 0x40000000
  v_mov_b32 v8, s25
  v_mov_b32 v9, s25
  v_mov_b32 v10, s25
  v_mov_b32 v11, s25
  buffer_store_dwordx4 v[8:11], v3, s[4:7], s24 offen offset:0 sc1
  buffer_store_dwordx4 v[8:11], v3, s[4:7], s24 offen offset:1024 sc1
  buffer_store_dwordx4 v[8:11], v3, s[4:7], s24 offen offset:2048 sc1
  buffer_store_dwordx4 v[8:11], v3, s[4:7], s24 offen offset:3072 sc1
  s_add_u32 s24, s24, 4096
  buffer_store_dwordx4 v[8:11], v3, s[4:7], s24 offen offset:0 sc1
  buffer_store_dwordx4 v[8:11], v3, s[4:7], s24 offen offset:1024 sc1
  buffer_store_dwordx4 v[8:11], v3, s[4:7], s24 offen offset:2048 sc1
  buffer_store_dwordx4 v[8:11], v3, s[4:7], s24 offen offset:3072 sc1
  s_add_u32 s24, s24, 4096
  buffer_store_dwordx4 v[8:11], v3, s[4:7], s24 offen offset:0 sc1
  buffer_store_dwordx4 v[8:11], v3, s[4:7], s24 offen offset:1024 sc1
  buffer_store_dwordx4 v[8:11], v3, s[4:7], s24 offen offset:2048 sc1
  buffer_store_dwordx4 v[8:11], v3, s[4:7], s24 offen offset:3072 sc1
  s_add_u32 s24, s24, 4096
  buffer_store_dwordx4 v[8:11], v3, s[4:7], s24 offen offset:0 sc1
  buffer_store_dwordx4 v[8:11], v3, s[4:7], s24 offen offset:1024 sc1
  buffer_store_dwordx4 v[8:11], v3, s[4:7], s24 offen offset:2048 sc1
  buffer_store_dwordx4 v[8:11], v3, s[4:7], s24 offen offset:3072 sc1
  s_lshr_b32 s21, s10, 1
  s_mul_i32 s21, s21, 20480
  s_and_b32 s22, s10, 1
  s_lshl_b32 s22, s22, 7
  s_add_u32 s21, s21, s22
  s_add_u32 s21, s21, 0
  s_mov_b32 s30, 0xffff0000
  s_waitcnt vmcnt(16)
  s_mov_b32 s22, s21
  v_lshlrev_b32 v32, 16, v100
  v_and_b32 v33, s30, v100
  v_lshlrev_b32 v34, 16, v101
  v_and_b32 v35, s30, v101
  v_pk_add_f32 v[6:7], v[32:33], v[34:35]
  v_lshlrev_b32 v36, 16, v102
  v_and_b32 v37, s30, v102
  v_pk_add_f32 v[6:7], v[6:7], v[36:37]
  v_lshlrev_b32 v38, 16, v103
  v_and_b32 v39, s30, v103
  v_pk_add_f32 v[6:7], v[6:7], v[38:39]
  v_lshlrev_b32 v40, 16, v104
  v_and_b32 v41, s30, v104
  v_pk_add_f32 v[6:7], v[6:7], v[40:41]
  v_lshlrev_b32 v42, 16, v105
  v_and_b32 v43, s30, v105
  v_pk_add_f32 v[6:7], v[6:7], v[42:43]
  v_lshlrev_b32 v44, 16, v106
  v_and_b32 v45, s30, v106
  v_pk_add_f32 v[6:7], v[6:7], v[44:45]
  v_lshlrev_b32 v46, 16, v107
  v_and_b32 v47, s30, v107
  v_pk_add_f32 v[6:7], v[6:7], v[46:47]
  v_lshlrev_b32 v48, 16, v108
  v_and_b32 v49, s30, v108
  v_pk_add_f32 v[6:7], v[6:7], v[48:49]
  v_lshlrev_b32 v50, 16, v109
  v_and_b32 v51, s30, v109
  v_pk_add_f32 v[6:7], v[6:7], v[50:51]
  v_lshlrev_b32 v52, 16, v110
  v_and_b32 v53, s30, v110
  v_pk_add_f32 v[6:7], v[6:7], v[52:53]
  v_lshlrev_b32 v54, 16, v111
  v_and_b32 v55, s30, v111
  v_pk_add_f32 v[6:7], v[6:7], v[54:55]
  v_lshlrev_b32 v56, 16, v112
  v_and_b32 v57, s30, v112
  v_pk_add_f32 v[6:7], v[6:7], v[56:57]
  v_lshlrev_b32 v58, 16, v113
  v_and_b32 v59, s30, v113
  v_pk_add_f32 v[6:7], v[6:7], v[58:59]
  v_lshlrev_b32 v60, 16, v114
  v_and_b32 v61, s30, v114
  v_pk_add_f32 v[6:7], v[6:7], v[60:61]
  v_lshlrev_b32 v62, 16, v115
  v_and_b32 v63, s30, v115
  v_pk_add_f32 v[6:7], v[6:7], v[62:63]
  v_lshlrev_b32 v64, 16, v116
  v_and_b32 v65, s30, v116
  v_pk_add_f32 v[6:7], v[6:7], v[64:65]
  v_lshlrev_b32 v66, 16, v117
  v_and_b32 v67, s30, v117
  v_pk_add_f32 v[6:7], v[6:7], v[66:67]
  v_lshlrev_b32 v68, 16, v118
  v_and_b32 v69, s30, v118
  v_pk_add_f32 v[6:7], v[6:7], v[68:69]
  v_lshlrev_b32 v70, 16, v119
  v_and_b32 v71, s30, v119
  v_pk_add_f32 v[6:7], v[6:7], v[70:71]
  v_add_f32 v6, v6, v7
  s_nop 1
  v_add_f32_dpp v6, v6, v6 row_ror:8 row_mask:0xf bank_mask:0xf
  s_nop 1
  v_add_f32_dpp v6, v6, v6 row_ror:4 row_mask:0xf bank_mask:0xf
  s_nop 1
  v_add_f32_dpp v6, v6, v6 row_ror:2 row_mask:0xf bank_mask:0xf
  s_nop 1
  v_add_f32_dpp v6, v6, v6 row_ror:1 row_mask:0xf bank_mask:0xf
  v_mul_f32 v6, 0xbacccccd, v6
  v_mov_b32 v7, v6
  v_pk_add_f32 v[32:33], v[32:33], v[6:7]
  v_pk_mul_f32 v[28:29], v[32:33], v[32:33]
  v_pk_add_f32 v[34:35], v[34:35], v[6:7]
  v_pk_fma_f32 v[28:29], v[34:35], v[34:35], v[28:29]
  v_pk_add_f32 v[36:37], v[36:37], v[6:7]
  v_pk_fma_f32 v[28:29], v[36:37], v[36:37], v[28:29]
  v_pk_add_f32 v[38:39], v[38:39], v[6:7]
  v_pk_fma_f32 v[28:29], v[38:39], v[38:39], v[28:29]
  v_pk_add_f32 v[40:41], v[40:41], v[6:7]
  v_pk_fma_f32 v[28:29], v[40:41], v[40:41], v[28:29]
  v_pk_add_f32 v[42:43], v[42:43], v[6:7]
  v_pk_fma_f32 v[28:29], v[42:43], v[42:43], v[28:29]
  v_pk_add_f32 v[44:45], v[44:45], v[6:7]
  v_pk_fma_f32 v[28:29], v[44:45], v[44:45], v[28:29]
  v_pk_add_f32 v[46:47], v[46:47], v[6:7]
  v_pk_fma_f32 v[28:29], v[46:47], v[46:47], v[28:29]
  v_pk_add_f32 v[48:49], v[48:49], v[6:7]
  v_pk_fma_f32 v[28:29], v[48:49], v[48:49], v[28:29]
  v_pk_add_f32 v[50:51], v[50:51], v[6:7]
  v_pk_fma_f32 v[28:29], v[50:51], v[50:51], v[28:29]
  v_pk_add_f32 v[52:53], v[52:53], v[6:7]
  v_pk_fma_f32 v[28:29], v[52:53], v[52:53], v[28:29]
  v_pk_add_f32 v[54:55], v[54:55], v[6:7]
  v_pk_fma_f32 v[28:29], v[54:55], v[54:55], v[28:29]
  v_pk_add_f32 v[56:57], v[56:57], v[6:7]
  v_pk_fma_f32 v[28:29], v[56:57], v[56:57], v[28:29]
  v_pk_add_f32 v[58:59], v[58:59], v[6:7]
  v_pk_fma_f32 v[28:29], v[58:59], v[58:59], v[28:29]
  v_pk_add_f32 v[60:61], v[60:61], v[6:7]
  v_pk_fma_f32 v[28:29], v[60:61], v[60:61], v[28:29]
  v_pk_add_f32 v[62:63], v[62:63], v[6:7]
  v_pk_fma_f32 v[28:29], v[62:63], v[62:63], v[28:29]
  v_pk_add_f32 v[64:65], v[64:65], v[6:7]
  v_pk_fma_f32 v[28:29], v[64:65], v[64:65], v[28:29]
  v_pk_add_f32 v[66:67], v[66:67], v[6:7]
  v_pk_fma_f32 v[28:29], v[66:67], v[66:67], v[28:29]
  v_pk_add_f32 v[68:69], v[68:69], v[6:7]
  v_pk_fma_f32 v[28:29], v[68:69], v[68:69], v[28:29]
  v_pk_add_f32 v[70:71], v[70:71], v[6:7]
  v_pk_fma_f32 v[28:29], v[70:71], v[70:71], v[28:29]
  v_add_f32 v28, v28, v29
  s_nop 1
  v_add_f32_dpp v28, v28, v28 row_ror:8 row_mask:0xf bank_mask:0xf
  s_nop 1
  v_add_f32_dpp v28, v28, v28 row_ror:4 row_mask:0xf bank_mask:0xf
  s_nop 1
  v_add_f32_dpp v28, v28, v28 row_ror:2 row_mask:0xf bank_mask:0xf
  s_nop 1
  v_add_f32_dpp v28, v28, v28 row_ror:1 row_mask:0xf bank_mask:0xf
  v_mov_b32 v6, 0x3727c5ac
  v_fmac_f32 v6, 0x3acccccd, v28
  v_rsq_f32 v6, v6
  s_nop 0
  v_mov_b32 v7, v6
  v_pk_mul_f32 v[32:33], v[32:33], v[6:7]
  v_cvt_pk_bf16_f32 v100, v32, v33
  v_pk_mul_f32 v[34:35], v[34:35], v[6:7]
  v_cvt_pk_bf16_f32 v101, v34, v35
  v_pk_mul_f32 v[36:37], v[36:37], v[6:7]
  v_cvt_pk_bf16_f32 v102, v36, v37
  v_pk_mul_f32 v[38:39], v[38:39], v[6:7]
  v_cvt_pk_bf16_f32 v103, v38, v39
  buffer_store_dwordx4 v[100:103], v96, s[4:7], s22 offen offset:0 sc1
  s_add_u32 s22, s22, 4096
  v_pk_mul_f32 v[40:41], v[40:41], v[6:7]
  v_cvt_pk_bf16_f32 v104, v40, v41
  v_pk_mul_f32 v[42:43], v[42:43], v[6:7]
  v_cvt_pk_bf16_f32 v105, v42, v43
  v_pk_mul_f32 v[44:45], v[44:45], v[6:7]
  v_cvt_pk_bf16_f32 v106, v44, v45
  v_pk_mul_f32 v[46:47], v[46:47], v[6:7]
  v_cvt_pk_bf16_f32 v107, v46, v47
  buffer_store_dwordx4 v[104:107], v96, s[4:7], s22 offen offset:0 sc1
  s_add_u32 s22, s22, 4096
  v_pk_mul_f32 v[48:49], v[48:49], v[6:7]
  v_cvt_pk_bf16_f32 v108, v48, v49
  v_pk_mul_f32 v[50:51], v[50:51], v[6:7]
  v_cvt_pk_bf16_f32 v109, v50, v51
  v_pk_mul_f32 v[52:53], v[52:53], v[6:7]
  v_cvt_pk_bf16_f32 v110, v52, v53
  v_pk_mul_f32 v[54:55], v[54:55], v[6:7]
  v_cvt_pk_bf16_f32 v111, v54, v55
  buffer_store_dwordx4 v[108:111], v96, s[4:7], s22 offen offset:0 sc1
  s_add_u32 s22, s22, 4096
  v_pk_mul_f32 v[56:57], v[56:57], v[6:7]
  v_cvt_pk_bf16_f32 v112, v56, v57
  v_pk_mul_f32 v[58:59], v[58:59], v[6:7]
  v_cvt_pk_bf16_f32 v113, v58, v59
  v_pk_mul_f32 v[60:61], v[60:61], v[6:7]
  v_cvt_pk_bf16_f32 v114, v60, v61
  v_pk_mul_f32 v[62:63], v[62:63], v[6:7]
  v_cvt_pk_bf16_f32 v115, v62, v63
  buffer_store_dwordx4 v[112:115], v96, s[4:7], s22 offen offset:0 sc1
  s_add_u32 s22, s22, 4096
  v_pk_mul_f32 v[64:65], v[64:65], v[6:7]
  v_cvt_pk_bf16_f32 v116, v64, v65
  v_pk_mul_f32 v[66:67], v[66:67], v[6:7]
  v_cvt_pk_bf16_f32 v117, v66, v67
  v_pk_mul_f32 v[68:69], v[68:69], v[6:7]
  v_cvt_pk_bf16_f32 v118, v68, v69
  v_pk_mul_f32 v[70:71], v[70:71], v[6:7]
  v_cvt_pk_bf16_f32 v119, v70, v71
  buffer_store_dwordx4 v[116:119], v96, s[4:7], s22 offen offset:0 sc1
  s_add_u32 s22, s22, 4096
  s_mov_b32 s22, s21
  v_lshlrev_b32 v32, 16, v120
  v_and_b32 v33, s30, v120
  v_lshlrev_b32 v34, 16, v121
  v_and_b32 v35, s30, v121
  v_pk_add_f32 v[6:7], v[32:33], v[34:35]
  v_lshlrev_b32 v36, 16, v122
  v_and_b32 v37, s30, v122
  v_pk_add_f32 v[6:7], v[6:7], v[36:37]
  v_lshlrev_b32 v38, 16, v123
  v_and_b32 v39, s30, v123
  v_pk_add_f32 v[6:7], v[6:7], v[38:39]
  v_lshlrev_b32 v40, 16, v124
  v_and_b32 v41, s30, v124
  v_pk_add_f32 v[6:7], v[6:7], v[40:41]
  v_lshlrev_b32 v42, 16, v125
  v_and_b32 v43, s30, v125
  v_pk_add_f32 v[6:7], v[6:7], v[42:43]
  v_lshlrev_b32 v44, 16, v126
  v_and_b32 v45, s30, v126
  v_pk_add_f32 v[6:7], v[6:7], v[44:45]
  v_lshlrev_b32 v46, 16, v127
  v_and_b32 v47, s30, v127
  v_pk_add_f32 v[6:7], v[6:7], v[46:47]
  v_lshlrev_b32 v48, 16, v128
  v_and_b32 v49, s30, v128
  v_pk_add_f32 v[6:7], v[6:7], v[48:49]
  v_lshlrev_b32 v50, 16, v129
  v_and_b32 v51, s30, v129
  v_pk_add_f32 v[6:7], v[6:7], v[50:51]
  v_lshlrev_b32 v52, 16, v130
  v_and_b32 v53, s30, v130
  v_pk_add_f32 v[6:7], v[6:7], v[52:53]
  v_lshlrev_b32 v54, 16, v131
  v_and_b32 v55, s30, v131
  v_pk_add_f32 v[6:7], v[6:7], v[54:55]
  v_lshlrev_b32 v56, 16, v132
  v_and_b32 v57, s30, v132
  v_pk_add_f32 v[6:7], v[6:7], v[56:57]
  v_lshlrev_b32 v58, 16, v133
  v_and_b32 v59, s30, v133
  v_pk_add_f32 v[6:7], v[6:7], v[58:59]
  v_lshlrev_b32 v60, 16, v134
  v_and_b32 v61, s30, v134
  v_pk_add_f32 v[6:7], v[6:7], v[60:61]
  v_lshlrev_b32 v62, 16, v135
  v_and_b32 v63, s30, v135
  v_pk_add_f32 v[6:7], v[6:7], v[62:63]
  v_lshlrev_b32 v64, 16, v136
  v_and_b32 v65, s30, v136
  v_pk_add_f32 v[6:7], v[6:7], v[64:65]
  v_lshlrev_b32 v66, 16, v137
  v_and_b32 v67, s30, v137
  v_pk_add_f32 v[6:7], v[6:7], v[66:67]
  v_lshlrev_b32 v68, 16, v138
  v_and_b32 v69, s30, v138
  v_pk_add_f32 v[6:7], v[6:7], v[68:69]
  v_lshlrev_b32 v70, 16, v139
  v_and_b32 v71, s30, v139
  v_pk_add_f32 v[6:7], v[6:7], v[70:71]
  v_add_f32 v6, v6, v7
  s_nop 1
  v_add_f32_dpp v6, v6, v6 row_ror:8 row_mask:0xf bank_mask:0xf
  s_nop 1
  v_add_f32_dpp v6, v6, v6 row_ror:4 row_mask:0xf bank_mask:0xf
  s_nop 1
  v_add_f32_dpp v6, v6, v6 row_ror:2 row_mask:0xf bank_mask:0xf
  s_nop 1
  v_add_f32_dpp v6, v6, v6 row_ror:1 row_mask:0xf bank_mask:0xf
  v_mul_f32 v6, 0xbacccccd, v6
  v_mov_b32 v7, v6
  v_pk_add_f32 v[32:33], v[32:33], v[6:7]
  v_pk_mul_f32 v[28:29], v[32:33], v[32:33]
  v_pk_add_f32 v[34:35], v[34:35], v[6:7]
  v_pk_fma_f32 v[28:29], v[34:35], v[34:35], v[28:29]
  v_pk_add_f32 v[36:37], v[36:37], v[6:7]
  v_pk_fma_f32 v[28:29], v[36:37], v[36:37], v[28:29]
  v_pk_add_f32 v[38:39], v[38:39], v[6:7]
  v_pk_fma_f32 v[28:29], v[38:39], v[38:39], v[28:29]
  v_pk_add_f32 v[40:41], v[40:41], v[6:7]
  v_pk_fma_f32 v[28:29], v[40:41], v[40:41], v[28:29]
  v_pk_add_f32 v[42:43], v[42:43], v[6:7]
  v_pk_fma_f32 v[28:29], v[42:43], v[42:43], v[28:29]
  v_pk_add_f32 v[44:45], v[44:45], v[6:7]
  v_pk_fma_f32 v[28:29], v[44:45], v[44:45], v[28:29]
  v_pk_add_f32 v[46:47], v[46:47], v[6:7]
  v_pk_fma_f32 v[28:29], v[46:47], v[46:47], v[28:29]
  v_pk_add_f32 v[48:49], v[48:49], v[6:7]
  v_pk_fma_f32 v[28:29], v[48:49], v[48:49], v[28:29]
  v_pk_add_f32 v[50:51], v[50:51], v[6:7]
  v_pk_fma_f32 v[28:29], v[50:51], v[50:51], v[28:29]
  v_pk_add_f32 v[52:53], v[52:53], v[6:7]
  v_pk_fma_f32 v[28:29], v[52:53], v[52:53], v[28:29]
  v_pk_add_f32 v[54:55], v[54:55], v[6:7]
  v_pk_fma_f32 v[28:29], v[54:55], v[54:55], v[28:29]
  v_pk_add_f32 v[56:57], v[56:57], v[6:7]
  v_pk_fma_f32 v[28:29], v[56:57], v[56:57], v[28:29]
  v_pk_add_f32 v[58:59], v[58:59], v[6:7]
  v_pk_fma_f32 v[28:29], v[58:59], v[58:59], v[28:29]
  v_pk_add_f32 v[60:61], v[60:61], v[6:7]
  v_pk_fma_f32 v[28:29], v[60:61], v[60:61], v[28:29]
  v_pk_add_f32 v[62:63], v[62:63], v[6:7]
  v_pk_fma_f32 v[28:29], v[62:63], v[62:63], v[28:29]
  v_pk_add_f32 v[64:65], v[64:65], v[6:7]
  v_pk_fma_f32 v[28:29], v[64:65], v[64:65], v[28:29]
  v_pk_add_f32 v[66:67], v[66:67], v[6:7]
  v_pk_fma_f32 v[28:29], v[66:67], v[66:67], v[28:29]
  v_pk_add_f32 v[68:69], v[68:69], v[6:7]
  v_pk_fma_f32 v[28:29], v[68:69], v[68:69], v[28:29]
  v_pk_add_f32 v[70:71], v[70:71], v[6:7]
  v_pk_fma_f32 v[28:29], v[70:71], v[70:71], v[28:29]
  v_add_f32 v28, v28, v29
  s_nop 1
  v_add_f32_dpp v28, v28, v28 row_ror:8 row_mask:0xf bank_mask:0xf
  s_nop 1
  v_add_f32_dpp v28, v28, v28 row_ror:4 row_mask:0xf bank_mask:0xf
  s_nop 1
  v_add_f32_dpp v28, v28, v28 row_ror:2 row_mask:0xf bank_mask:0xf
  s_nop 1
  v_add_f32_dpp v28, v28, v28 row_ror:1 row_mask:0xf bank_mask:0xf
  v_mov_b32 v6, 0x3727c5ac
  v_fmac_f32 v6, 0x3acccccd, v28
  v_rsq_f32 v6, v6
  s_nop 0
  v_mov_b32 v7, v6
  v_pk_mul_f32 v[32:33], v[32:33], v[6:7]
  v_cvt_pk_bf16_f32 v120, v32, v33
  v_pk_mul_f32 v[34:35], v[34:35], v[6:7]
  v_cvt_pk_bf16_f32 v121, v34, v35
  v_pk_mul_f32 v[36:37], v[36:37], v[6:7]
  v_cvt_pk_bf16_f32 v122, v36, v37
  v_pk_mul_f32 v[38:39], v[38:39], v[6:7]
  v_cvt_pk_bf16_f32 v123, v38, v39
  buffer_store_dwordx4 v[120:123], v96, s[4:7], s22 offen offset:64 sc1
  s_add_u32 s22, s22, 4096
  v_pk_mul_f32 v[40:41], v[40:41], v[6:7]
  v_cvt_pk_bf16_f32 v124, v40, v41
  v_pk_mul_f32 v[42:43], v[42:43], v[6:7]
  v_cvt_pk_bf16_f32 v125, v42, v43
  v_pk_mul_f32 v[44:45], v[44:45], v[6:7]
  v_cvt_pk_bf16_f32 v126, v44, v45
  v_pk_mul_f32 v[46:47], v[46:47], v[6:7]
  v_cvt_pk_bf16_f32 v127, v46, v47
  buffer_store_dwordx4 v[124:127], v96, s[4:7], s22 offen offset:64 sc1
  s_add_u32 s22, s22, 4096
  v_pk_mul_f32 v[48:49], v[48:49], v[6:7]
  v_cvt_pk_bf16_f32 v128, v48, v49
  v_pk_mul_f32 v[50:51], v[50:51], v[6:7]
  v_cvt_pk_bf16_f32 v129, v50, v51
  v_pk_mul_f32 v[52:53], v[52:53], v[6:7]
  v_cvt_pk_bf16_f32 v130, v52, v53
  v_pk_mul_f32 v[54:55], v[54:55], v[6:7]
  v_cvt_pk_bf16_f32 v131, v54, v55
  buffer_store_dwordx4 v[128:131], v96, s[4:7], s22 offen offset:64 sc1
  s_add_u32 s22, s22, 4096
  v_pk_mul_f32 v[56:57], v[56:57], v[6:7]
  v_cvt_pk_bf16_f32 v132, v56, v57
  v_pk_mul_f32 v[58:59], v[58:59], v[6:7]
  v_cvt_pk_bf16_f32 v133, v58, v59
  v_pk_mul_f32 v[60:61], v[60:61], v[6:7]
  v_cvt_pk_bf16_f32 v134, v60, v61
  v_pk_mul_f32 v[62:63], v[62:63], v[6:7]
  v_cvt_pk_bf16_f32 v135, v62, v63
  buffer_store_dwordx4 v[132:135], v96, s[4:7], s22 offen offset:64 sc1
  s_add_u32 s22, s22, 4096
  v_pk_mul_f32 v[64:65], v[64:65], v[6:7]
  v_cvt_pk_bf16_f32 v136, v64, v65
  v_pk_mul_f32 v[66:67], v[66:67], v[6:7]
  v_cvt_pk_bf16_f32 v137, v66, v67
  v_pk_mul_f32 v[68:69], v[68:69], v[6:7]
  v_cvt_pk_bf16_f32 v138, v68, v69
  v_pk_mul_f32 v[70:71], v[70:71], v[6:7]
  v_cvt_pk_bf16_f32 v139, v70, v71
  buffer_store_dwordx4 v[136:139], v96, s[4:7], s22 offen offset:64 sc1
  s_add_u32 s22, s22, 4096
  s_waitcnt vmcnt(0)
  s_barrier
  s_getreg_b32 s27, hwreg(HW_REG_XCC_ID)
  s_and_b32 s27, s27, 7
  s_mul_i32 s28, s27, s27
  s_lshl_b32 s28, s28, 14
  s_lshl_b32 s27, s27, 6
  s_add_u32 s27, s27, s28
  s_add_u32 s69, s27, 1
  s_lshl_b32 s29, s68, 2
  s_cmp_eq_u32 s3, 0
  s_cselect_b32 s29, s29, 4096
  v_mov_b32 v13, s29
  v_mov_b32 v12, s69
  s_mov_b64 exec, 1
  buffer_atomic_add v12, v13, s[44:47], 0 offen sc0 sc1
  s_mov_b64 exec, -1
  s_waitcnt vmcnt(0)
  v_readfirstlane_b32 s27, v12
  s_nop 0
  s_and_b32 s28, s27, 63
  s_cmp_eq_u32 s28, 31
  s_cbranch_scc1 mega_kernel_cf23
mega_kernel_cf23_b:
  s_cmp_lg_u32 s3, 0
  s_cbranch_scc1 mega_q_np
  s_and_b32 s9, s80, 3
  s_add_u32 s20, s4, 45105151
  s_and_b32 s20, s20, 0xffe00000
  s_sub_u32 s20, s20, s4
  s_lshl_b32 s21, s9, 21
  s_add_u32 s20, s20, s21
  s_lshl_b32 s21, s68, 7
  s_add_u32 s20, s20, s21
  s_add_u32 s20, s20, 1982464
  v_mov_b32 v2, 0
  s_mov_b64 exec, 1
  s_mov_b32 s24, -1
  s_mov_b32 s25, -1
  s_mov_b32 s26, 0
  s_waitcnt vmcnt(0)
mega_q_ploop:
  s_memtime s[28:29]
  s_waitcnt lgkmcnt(0)
  buffer_store_dword v2, v2, s[4:7], s20 offen sc1
  s_waitcnt vmcnt(0)
  s_memtime s[30:31]
  s_waitcnt lgkmcnt(0)
  s_sub_u32 s30, s30, s28
  s_min_u32 s24, s24, s30
  s_add_u32 s20, s20, 8192
  s_memtime s[28:29]
  s_waitcnt lgkmcnt(0)
  buffer_store_dword v2, v2, s[4:7], s20 offen sc1
  s_waitcnt vmcnt(0)
  s_memtime s[30:31]
  s_waitcnt lgkmcnt(0)
  s_sub_u32 s30, s30, s28
  s_min_u32 s25, s25, s30
  s_sub_u32 s20, s20, 8192
  s_add_u32 s26, s26, 1
  s_cmp_lt_u32 s26, 3
  s_cbranch_scc1 mega_q_ploop
  s_getreg_b32 s26, hwreg(HW_REG_XCC_ID)
  s_sub_u32 s27, s26, s68
  s_add_u32 s27, s27, s9
  s_xor_b32 s26, s26, s27
  s_bfe_u32 s26, s26, 0x10002
  s_cmp_lt_u32 s24, s25
  s_cselect_b32 s27, 1, 0
  s_xor_b32 s27, s27, s26
  s_lshl_b32 s21, s9, 2
  s_add_u32 s21, s21, 8
  s_lshl_b32 s27, s27, s21
  s_add_u32 s27, s27, 1
  v_mov_b32 v2, s27
  s_nop 0
  v_readfirstlane_b32 s28, v2
  v_mov_b32 v3, 36
  buffer_atomic_add v2, v3, s[44:47], 0 offen sc0 sc1
  s_waitcnt vmcnt(0)
  v_add_u32 v2, s28, v2
  s_nop 0
  v_readfirstlane_b32 s28, v2
  s_nop 0
  s_and_b32 s28, s28, 255
  s_cmp_eq_u32 s28, 32
  s_cbranch_scc0 mega_kernel_la25
  buffer_store_dword v2, v3, s[44:47], 0 offen offset:96 sc1
  s_waitcnt vmcnt(0)
mega_kernel_la25:
  s_mov_b64 exec, -1
mega_q_np:
  s_barrier
  s_mul_i32 s10, s80, 384
  s_mul_i32 s11, s3, 96
  s_add_u32 s10, s10, s11
  s_mul_i32 s11, s3, 30720
  s_add_u32 s11, s11, 40960
  v_mul_u32_u24 v18, 10923, v1
  v_lshrrev_b32 v18, 16, v18
  v_mul_u32_u24 v16, 6, v18
  v_sub_u32 v16, v1, v16
  v_lshlrev_b32 v16, 4, v16
  v_mul_u32_u24 v18, 12288, v18
  v_add_u32 v16, v16, v18
  v_lshrrev_b32 v18, 4, v1
  v_mul_u32_u24 v18, 8, v18
  v_bfe_u32 v17, v1, 2, 2
  v_add_u32 v18, v18, v17
  v_mul_u32_u24 v18, 96, v18
  v_and_b32 v17, 3, v1
  v_lshl_add_u32 v17, v17, 3, v18
  v_add_u32 v17, s11, v17
  s_mov_b64 exec, s[82:83]
  s_add_u32 m0, s11, 0
  s_nop 0
  buffer_load_dwordx4 v16, s[92:95], s10 offen lds
  s_add_u32 s10, s10, 122880
  s_add_u32 m0, s11, 960
  s_nop 0
  buffer_load_dwordx4 v16, s[92:95], s10 offen lds
  s_add_u32 s10, s10, 122880
  s_add_u32 m0, s11, 1920
  s_nop 0
  buffer_load_dwordx4 v16, s[92:95], s10 offen lds
  s_add_u32 s10, s10, 122880
  s_add_u32 m0, s11, 2880
  s_nop 0
  buffer_load_dwordx4 v16, s[92:95], s10 offen lds
  s_add_u32 s10, s10, 122880
  s_add_u32 m0, s11, 3840
  s_nop 0
  buffer_load_dwordx4 v16, s[92:95], s10 offen lds
  s_add_u32 s10, s10, 122880
  s_add_u32 m0, s11, 4800
  s_nop 0
  buffer_load_dwordx4 v16, s[92:95], s10 offen lds
  s_add_u32 s10, s10, 122880
  s_add_u32 m0, s11, 5760
  s_nop 0
  buffer_load_dwordx4 v16, s[92:95], s10 offen lds
  s_add_u32 s10, s10, 122880
  s_add_u32 m0, s11, 6720
  s_nop 0
  buffer_load_dwordx4 v16, s[92:95], s10 offen lds
  s_add_u32 s10, s10, 122880
  s_add_u32 m0, s11, 7680
  s_nop 0
  buffer_load_dwordx4 v16, s[92:95], s10 offen lds
  s_add_u32 s10, s10, 122880
  s_add_u32 m0, s11, 8640
  s_nop 0
  buffer_load_dwordx4 v16, s[92:95], s10 offen lds
  s_add_u32 s10, s10, 122880
  s_add_u32 m0, s11, 9600
  s_nop 0
  buffer_load_dwordx4 v16, s[92:95], s10 offen lds
  s_add_u32 s10, s10, 122880
  s_add_u32 m0, s11, 10560
  s_nop 0
  buffer_load_dwordx4 v16, s[92:95], s10 offen lds
  s_add_u32 s10, s10, 122880
  s_add_u32 m0, s11, 11520
  s_nop 0
  buffer_load_dwordx4 v16, s[92:95], s10 offen lds
  s_add_u32 s10, s10, 122880
  s_add_u32 m0, s11, 12480
  s_nop 0
  buffer_load_dwordx4 v16, s[92:95], s10 offen lds
  s_add_u32 s10, s10, 122880
  s_add_u32 m0, s11, 13440
  s_nop 0
  buffer_load_dwordx4 v16, s[92:95], s10 offen lds
  s_add_u32 s10, s10, 122880
  s_add_u32 m0, s11, 14400
  s_nop 0
  buffer_load_dwordx4 v16, s[92:95], s10 offen lds
  s_add_u32 s10, s10, 122880
  s_add_u32 m0, s11, 15360
  s_nop 0
  buffer_load_dwordx4 v16, s[92:95], s10 offen lds
  s_add_u32 s10, s10, 122880
  s_add_u32 m0, s11, 16320
  s_nop 0
  buffer_load_dwordx4 v16, s[92:95], s10 offen lds
  s_add_u32 s10, s10, 122880
  s_add_u32 m0, s11, 17280
  s_nop 0
  buffer_load_dwordx4 v16, s[92:95], s10 offen lds
  s_add_u32 s10, s10, 122880
  s_add_u32 m0, s11, 18240
  s_nop 0
  buffer_load_dwordx4 v16, s[92:95], s10 offen lds
  s_add_u32 s10, s10, 122880
  s_add_u32 m0, s11, 19200
  s_nop 0
  buffer_load_dwordx4 v16, s[92:95], s10 offen lds
  s_add_u32 s10, s10, 122880
  s_add_u32 m0, s11, 20160
  s_nop 0
  buffer_load_dwordx4 v16, s[92:95], s10 offen lds
  s_add_u32 s10, s10, 122880
  s_add_u32 m0, s11, 21120
  s_nop 0
  buffer_load_dwordx4 v16, s[92:95], s10 offen lds
  s_add_u32 s10, s10, 122880
  s_add_u32 m0, s11, 22080
  s_nop 0
  buffer_load_dwordx4 v16, s[92:95], s10 offen lds
  s_add_u32 s10, s10, 122880
  s_add_u32 m0, s11, 23040
  s_nop 0
  buffer_load_dwordx4 v16, s[92:95], s10 offen lds
  s_add_u32 s10, s10, 122880
  s_add_u32 m0, s11, 24000
  s_nop 0
  buffer_load_dwordx4 v16, s[92:95], s10 offen lds
  s_add_u32 s10, s10, 122880
  s_add_u32 m0, s11, 24960
  s_nop 0
  buffer_load_dwordx4 v16, s[92:95], s10 offen lds
  s_add_u32 s10, s10, 122880
  s_add_u32 m0, s11, 25920
  s_nop 0
  buffer_load_dwordx4 v16, s[92:95], s10 offen lds
  s_add_u32 s10, s10, 122880
  s_add_u32 m0, s11, 26880
  s_nop 0
  buffer_load_dwordx4 v16, s[92:95], s10 offen lds
  s_add_u32 s10, s10, 122880
  s_add_u32 m0, s11, 27840
  s_nop 0
  buffer_load_dwordx4 v16, s[92:95], s10 offen lds
  s_add_u32 s10, s10, 122880
  s_add_u32 m0, s11, 28800
  s_nop 0
  buffer_load_dwordx4 v16, s[92:95], s10 offen lds
  s_add_u32 s10, s10, 122880
  s_add_u32 m0, s11, 29760
  s_nop 0
  buffer_load_dwordx4 v16, s[92:95], s10 offen lds
  s_add_u32 s10, s10, 122880
  s_mov_b64 exec, -1
  s_waitcnt vmcnt(28)
  ds_read_b64_tr_b16 a[0:1], v17 offset:0
  ds_read_b64_tr_b16 a[2:3], v17 offset:384
  ds_read_b64_tr_b16 a[80:81], v17 offset:32
  ds_read_b64_tr_b16 a[82:83], v17 offset:416
  ds_read_b64_tr_b16 a[160:161], v17 offset:64
  ds_read_b64_tr_b16 a[162:163], v17 offset:448
  s_waitcnt lgkmcnt(0)
  s_mov_b64 exec, s[82:83]
  s_add_u32 m0, s11, 0
  s_nop 0
  buffer_load_dwordx4 v16, s[92:95], s10 offen lds
  s_add_u32 s10, s10, 122880
  s_add_u32 m0, s11, 960
  s_nop 0
  buffer_load_dwordx4 v16, s[92:95], s10 offen lds
  s_add_u32 s10, s10, 122880
  s_add_u32 m0, s11, 1920
  s_nop 0
  buffer_load_dwordx4 v16, s[92:95], s10 offen lds
  s_add_u32 s10, s10, 122880
  s_mov_b64 exec, -1
  s_waitcnt vmcnt(28)
  ds_read_b64_tr_b16 a[4:5], v17 offset:3072
  ds_read_b64_tr_b16 a[6:7], v17 offset:3456
  ds_read_b64_tr_b16 a[84:85], v17 offset:3104
  ds_read_b64_tr_b16 a[86:87], v17 offset:3488
  ds_read_b64_tr_b16 a[164:165], v17 offset:3136
  ds_read_b64_tr_b16 a[166:167], v17 offset:3520
  s_waitcnt lgkmcnt(0)
  s_mov_b64 exec, s[82:83]
  s_add_u32 m0, s11, 2880
  s_nop 0
  buffer_load_dwordx4 v16, s[92:95], s10 offen lds
  s_add_u32 s10, s10, 122880
  s_add_u32 m0, s11, 3840
  s_nop 0
  buffer_load_dwordx4 v16, s[92:95], s10 offen lds
  s_add_u32 s10, s10, 122880
  s_add_u32 m0, s11, 4800
  s_nop 0
  buffer_load_dwordx4 v16, s[92:95], s10 offen lds
  s_add_u32 s10, s10, 122880
  s_mov_b64 exec, -1
  s_waitcnt vmcnt(28)
  ds_read_b64_tr_b16 a[8:9], v17 offset:6144
  ds_read_b64_tr_b16 a[10:11], v17 offset:6528
  ds_read_b64_tr_b16 a[88:89], v17 offset:6176
  ds_read_b64_tr_b16 a[90:91], v17 offset:6560
  ds_read_b64_tr_b16 a[168:169], v17 offset:6208
  ds_read_b64_tr_b16 a[170:171], v17 offset:6592
  s_waitcnt lgkmcnt(0)
  s_mov_b64 exec, s[82:83]
  s_add_u32 m0, s11, 5760
  s_nop 0
  buffer_load_dwordx4 v16, s[92:95], s10 offen lds
  s_add_u32 s10, s10, 122880
  s_add_u32 m0, s11, 6720
  s_nop 0
  buffer_load_dwordx4 v16, s[92:95], s10 offen lds
  s_add_u32 s10, s10, 122880
  s_add_u32 m0, s11, 7680
  s_nop 0
  buffer_load_dwordx4 v16, s[92:95], s10 offen lds
  s_add_u32 s10, s10, 122880
  s_mov_b64 exec, -1
  s_waitcnt vmcnt(28)
  ds_read_b64_tr_b16 a[12:13], v17 offset:9216
  ds_read_b64_tr_b16 a[14:15], v17 offset:9600
  ds_read_b64_tr_b16 a[92:93], v17 offset:9248
  ds_read_b64_tr_b16 a[94:95], v17 offset:9632
  ds_read_b64_tr_b16 a[172:173], v17 offset:9280
  ds_read_b64_tr_b16 a[174:175], v17 offset:9664
  s_waitcnt lgkmcnt(0)
  s_mov_b64 exec, s[82:83]
  s_add_u32 m0, s11, 8640
  s_nop 0
  buffer_load_dwordx4 v16, s[92:95], s10 offen lds
  s_add_u32 s10, s10, 122880
  s_add_u32 m0, s11, 9600
  s_nop 0
  buffer_load_dwordx4 v16, s[92:95], s10 offen lds
  s_add_u32 s10, s10, 122880
  s_add_u32 m0, s11, 10560
  s_nop 0
  buffer_load_dwordx4 v16, s[92:95], s10 offen lds
  s_add_u32 s10, s10, 122880
  s_mov_b64 exec, -1
  s_waitcnt vmcnt(28)
  ds_read_b64_tr_b16 a[16:17], v17 offset:12288
  ds_read_b64_tr_b16 a[18:19], v17 offset:12672
  ds_read_b64_tr_b16 a[96:97], v17 offset:12320
  ds_read_b64_tr_b16 a[98:99], v17 offset:12704
  ds_read_b64_tr_b16 a[176:177], v17 offset:12352
  ds_read_b64_tr_b16 a[178:179], v17 offset:12736
  s_waitcnt lgkmcnt(0)
  s_mov_b64 exec, s[82:83]
  s_add_u32 m0, s11, 11520
  s_nop 0
  buffer_load_dwordx4 v16, s[92:95], s10 offen lds
  s_add_u32 s10, s10, 122880
  s_add_u32 m0, s11, 12480
  s_nop 0
  buffer_load_dwordx4 v16, s[92:95], s10 offen lds
  s_add_u32 s10, s10, 122880
  s_add_u32 m0, s11, 13440
  s_nop 0
  buffer_load_dwordx4 v16, s[92:95], s10 offen lds
  s_add_u32 s10, s10, 122880
  s_add_u32 m0, s11, 14400
  s_nop 0
  buffer_load_dwordx4 v16, s[92:95], s10 offen lds
  s_add_u32 s10, s10, 122880
  s_mov_b64 exec, -1
  s_waitcnt vmcnt(28)
  ds_read_b64_tr_b16 a[20:21], v17 offset:15360
  ds_read_b64_tr_b16 a[22:23], v17 offset:15744
  ds_read_b64_tr_b16 a[100:101], v17 offset:15392
  ds_read_b64_tr_b16 a[102:103], v17 offset:15776
  ds_read_b64_tr_b16 a[180:181], v17 offset:15424
  ds_read_b64_tr_b16 a[182:183], v17 offset:15808
  s_waitcnt lgkmcnt(0)
  s_mov_b64 exec, s[82:83]
  s_add_u32 m0, s11, 15360
  s_nop 0
  buffer_load_dwordx4 v16, s[92:95], s10 offen lds
  s_add_u32 s10, s10, 122880
  s_add_u32 m0, s11, 16320
  s_nop 0
  buffer_load_dwordx4 v16, s[92:95], s10 offen lds
  s_add_u32 s10, s10, 122880
  s_add_u32 m0, s11, 17280
  s_nop 0
  buffer_load_dwordx4 v16, s[92:95], s10 offen lds
  s_add_u32 s10, s10, 122880
  s_mov_b64 exec, -1
  s_waitcnt vmcnt(28)
  ds_read_b64_tr_b16 a[24:25], v17 offset:18432
  ds_read_b64_tr_b16 a[26:27], v17 offset:18816
  ds_read_b64_tr_b16 a[104:105], v17 offset:18464
  ds_read_b64_tr_b16 a[106:107], v17 offset:18848
  ds_read_b64_tr_b16 a[184:185], v17 offset:18496
  ds_read_b64_tr_b16 a[186:187], v17 offset:18880
  s_waitcnt lgkmcnt(0)
  s_mov_b64 exec, s[82:83]
  s_add_u32 m0, s11, 18240
  s_nop 0
  buffer_load_dwordx4 v16, s[92:95], s10 offen lds
  s_add_u32 s10, s10, 122880
  s_add_u32 m0, s11, 19200
  s_nop 0
  buffer_load_dwordx4 v16, s[92:95], s10 offen lds
  s_add_u32 s10, s10, 122880
  s_add_u32 m0, s11, 20160
  s_nop 0
  buffer_load_dwordx4 v16, s[92:95], s10 offen lds
  s_add_u32 s10, s10, 122880
  s_mov_b64 exec, -1
  s_waitcnt vmcnt(28)
  ds_read_b64_tr_b16 a[28:29], v17 offset:21504
  ds_read_b64_tr_b16 a[30:31], v17 offset:21888
  ds_read_b64_tr_b16 a[108:109], v17 offset:21536
  ds_read_b64_tr_b16 a[110:111], v17 offset:21920
  ds_read_b64_tr_b16 a[188:189], v17 offset:21568
  ds_read_b64_tr_b16 a[190:191], v17 offset:21952
  s_waitcnt lgkmcnt(0)
  s_mov_b64 exec, s[82:83]
  s_add_u32 m0, s11, 21120
  s_nop 0
  buffer_load_dwordx4 v16, s[92:95], s10 offen lds
  s_add_u32 s10, s10, 122880
  s_add_u32 m0, s11, 22080
  s_nop 0
  buffer_load_dwordx4 v16, s[92:95], s10 offen lds
  s_add_u32 s10, s10, 122880
  s_add_u32 m0, s11, 23040
  s_nop 0
  buffer_load_dwordx4 v16, s[92:95], s10 offen lds
  s_add_u32 s10, s10, 122880
  s_mov_b64 exec, -1
  s_waitcnt vmcnt(28)
  ds_read_b64_tr_b16 a[32:33], v17 offset:24576
  ds_read_b64_tr_b16 a[34:35], v17 offset:24960
  ds_read_b64_tr_b16 a[112:113], v17 offset:24608
  ds_read_b64_tr_b16 a[114:115], v17 offset:24992
  ds_read_b64_tr_b16 a[192:193], v17 offset:24640
  ds_read_b64_tr_b16 a[194:195], v17 offset:25024
  s_waitcnt lgkmcnt(0)
  s_mov_b64 exec, s[82:83]
  s_add_u32 m0, s11, 24000
  s_nop 0
  buffer_load_dwordx4 v16, s[92:95], s10 offen lds
  s_add_u32 s10, s10, 122880
  s_add_u32 m0, s11, 24960
  s_nop 0
  buffer_load_dwordx4 v16, s[92:95], s10 offen lds
  s_add_u32 s10, s10, 122880
  s_add_u32 m0, s11, 25920
  s_nop 0
  buffer_load_dwordx4 v16, s[92:95], s10 offen lds
  s_add_u32 s10, s10, 122880
  s_mov_b64 exec, -1
  s_waitcnt vmcnt(28)
  ds_read_b64_tr_b16 a[36:37], v17 offset:27648
  ds_read_b64_tr_b16 a[38:39], v17 offset:28032
  ds_read_b64_tr_b16 a[116:117], v17 offset:27680
  ds_read_b64_tr_b16 a[118:119], v17 offset:28064
  ds_read_b64_tr_b16 a[196:197], v17 offset:27712
  ds_read_b64_tr_b16 a[198:199], v17 offset:28096
  s_waitcnt lgkmcnt(0)
  s_mov_b64 exec, s[82:83]
  s_add_u32 m0, s11, 26880
  s_nop 0
  buffer_load_dwordx4 v16, s[92:95], s10 offen lds
  s_add_u32 s10, s10, 122880
  s_add_u32 m0, s11, 27840
  s_nop 0
  buffer_load_dwordx4 v16, s[92:95], s10 offen lds
  s_add_u32 s10, s10, 122880
  s_add_u32 m0, s11, 28800
  s_nop 0
  buffer_load_dwordx4 v16, s[92:95], s10 offen lds
  s_add_u32 s10, s10, 122880
  s_add_u32 m0, s11, 29760
  s_nop 0
  buffer_load_dwordx4 v16, s[92:95], s10 offen lds
  s_add_u32 s10, s10, 122880
  s_mov_b64 exec, -1
  s_waitcnt vmcnt(28)
  ds_read_b64_tr_b16 a[40:41], v17 offset:0
  ds_read_b64_tr_b16 a[42:43], v17 offset:384
  ds_read_b64_tr_b16 a[120:121], v17 offset:32
  ds_read_b64_tr_b16 a[122:123], v17 offset:416
  ds_read_b64_tr_b16 a[200:201], v17 offset:64
  ds_read_b64_tr_b16 a[202:203], v17 offset:448
  s_waitcnt vmcnt(25)
  ds_read_b64_tr_b16 a[44:45], v17 offset:3072
  ds_read_b64_tr_b16 a[46:47], v17 offset:3456
  ds_read_b64_tr_b16 a[124:125], v17 offset:3104
  ds_read_b64_tr_b16 a[126:127], v17 offset:3488
  ds_read_b64_tr_b16 a[204:205], v17 offset:3136
  ds_read_b64_tr_b16 a[206:207], v17 offset:3520
  s_waitcnt vmcnt(22)
  ds_read_b64_tr_b16 a[48:49], v17 offset:6144
  ds_read_b64_tr_b16 a[50:51], v17 offset:6528
  ds_read_b64_tr_b16 a[128:129], v17 offset:6176
  ds_read_b64_tr_b16 a[130:131], v17 offset:6560
  ds_read_b64_tr_b16 a[208:209], v17 offset:6208
  ds_read_b64_tr_b16 a[210:211], v17 offset:6592
  s_waitcnt vmcnt(19)
  ds_read_b64_tr_b16 a[52:53], v17 offset:9216
  ds_read_b64_tr_b16 a[54:55], v17 offset:9600
  ds_read_b64_tr_b16 a[132:133], v17 offset:9248
  ds_read_b64_tr_b16 a[134:135], v17 offset:9632
  ds_read_b64_tr_b16 a[212:213], v17 offset:9280
  ds_read_b64_tr_b16 a[214:215], v17 offset:9664
  s_waitcnt vmcnt(16)
  ds_read_b64_tr_b16 a[56:57], v17 offset:12288
  ds_read_b64_tr_b16 a[58:59], v17 offset:12672
  ds_read_b64_tr_b16 a[136:137], v17 offset:12320
  ds_read_b64_tr_b16 a[138:139], v17 offset:12704
  ds_read_b64_tr_b16 a[216:217], v17 offset:12352
  ds_read_b64_tr_b16 a[218:219], v17 offset:12736
  s_waitcnt vmcnt(12)
  ds_read_b64_tr_b16 a[60:61], v17 offset:15360
  ds_read_b64_tr_b16 a[62:63], v17 offset:15744
  ds_read_b64_tr_b16 a[140:141], v17 offset:15392
  ds_read_b64_tr_b16 a[142:143], v17 offset:15776
  ds_read_b64_tr_b16 a[220:221], v17 offset:15424
  ds_read_b64_tr_b16 a[222:223], v17 offset:15808
  s_waitcnt vmcnt(9)
  ds_read_b64_tr_b16 a[64:65], v17 offset:18432
  ds_read_b64_tr_b16 a[66:67], v17 offset:18816
  ds_read_b64_tr_b16 a[144:145], v17 offset:18464
  ds_read_b64_tr_b16 a[146:147], v17 offset:18848
  ds_read_b64_tr_b16 a[224:225], v17 offset:18496
  ds_read_b64_tr_b16 a[226:227], v17 offset:18880
  s_waitcnt vmcnt(6)
  ds_read_b64_tr_b16 a[68:69], v17 offset:21504
  ds_read_b64_tr_b16 a[70:71], v17 offset:21888
  ds_read_b64_tr_b16 a[148:149], v17 offset:21536
  ds_read_b64_tr_b16 a[150:151], v17 offset:21920
  ds_read_b64_tr_b16 a[228:229], v17 offset:21568
  ds_read_b64_tr_b16 a[230:231], v17 offset:21952
  s_waitcnt vmcnt(3)
  ds_read_b64_tr_b16 a[72:73], v17 offset:24576
  ds_read_b64_tr_b16 a[74:75], v17 offset:24960
  ds_read_b64_tr_b16 a[152:153], v17 offset:24608
  ds_read_b64_tr_b16 a[154:155], v17 offset:24992
  ds_read_b64_tr_b16 a[232:233], v17 offset:24640
  ds_read_b64_tr_b16 a[234:235], v17 offset:25024
  s_waitcnt vmcnt(0)
  ds_read_b64_tr_b16 a[76:77], v17 offset:27648
  ds_read_b64_tr_b16 a[78:79], v17 offset:28032
  ds_read_b64_tr_b16 a[156:157], v17 offset:27680
  ds_read_b64_tr_b16 a[158:159], v17 offset:28064
  ds_read_b64_tr_b16 a[236:237], v17 offset:27712
  ds_read_b64_tr_b16 a[238:239], v17 offset:28096
  v_mov_b32 v18, 128
  s_mov_b32 s28, 0
mega_kernel_cen26:
  buffer_load_dwordx2 v[16:17], v18, s[44:47], 0 offen sc1
  s_waitcnt vmcnt(0)
  v_readfirstlane_b32 s69, v16
  v_readfirstlane_b32 s100, v16
  s_nop 0
  s_min_u32 vcc_lo, s69, s100
  s_cmp_lg_u32 vcc_lo, 0
  s_cbranch_scc1 mega_kernel_cen26_done
  s_sleep 4
  s_add_u32 s28, s28, 1
  s_cmp_lt_u32 s28, 262144
  s_cbranch_scc1 mega_kernel_cen26
  s_branch mega_fail
mega_kernel_cen26_done:
  s_lshr_b32 s69, s69, s68
  s_bfe_u32 s69, s69, 0x10008
  s_waitcnt lgkmcnt(0)
mega_q_layer:
  s_cmp_eq_u32 s70, 0
  s_cbranch_scc1 mega_kernel_hw27_ok
  v_lshrrev_b32 v87, 2, v1
  v_lshlrev_b32 v87, 7, v87
  s_mov_b32 s30, 0
mega_kernel_hw27:
  s_mov_b32 s15, 53542944
  buffer_load_dwordx4 v[96:99], v87, s[4:7], s15 offen sc1
  s_waitcnt vmcnt(0)
  v_min3_u32 v96, v96, v97, v98
  v_min_u32 v96, v96, v99
  v_cmp_eq_u32 vcc, 0, v96
  s_nop 0
  s_cbranch_vccz mega_kernel_hw27_ok
  s_sleep 1
  s_add_u32 s30, s30, 1
  s_cmp_lt_u32 s30, 262144
  s_cbranch_scc1 mega_kernel_hw27
  s_branch mega_fail
mega_kernel_hw27_ok:
  v_lshlrev_b32 v2, 4, v1
  s_mul_i32 s13, s3, 10240
  s_mul_i32 s12, s70, 2662400
  s_add_u32 s12, s12, s13
  s_add_u32 s12, s12, 0
  s_add_u32 m0, s13, 0
  s_add_u32 s18, s12, 0
  buffer_load_dwordx4 v2, s[4:7], s18 offen offset:0 lds
  buffer_load_dwordx4 v2, s[4:7], s18 offen offset:1024 lds
  buffer_load_dwordx4 v2, s[4:7], s18 offen offset:2048 lds
  buffer_load_dwordx4 v2, s[4:7], s18 offen offset:3072 lds
  s_add_u32 m0, s13, 4096
  s_add_u32 s18, s12, 4096
  buffer_load_dwordx4 v2, s[4:7], s18 offen offset:0 lds
  buffer_load_dwordx4 v2, s[4:7], s18 offen offset:1024 lds
  buffer_load_dwordx4 v2, s[4:7], s18 offen offset:2048 lds
  buffer_load_dwordx4 v2, s[4:7], s18 offen offset:3072 lds
  s_add_u32 m0, s13, 8192
  s_add_u32 s18, s12, 8192
  buffer_load_dwordx4 v2, s[4:7], s18 offen offset:0 lds
  buffer_load_dwordx4 v2, s[4:7], s18 offen offset:1024 lds
  s_add_u32 s12, s12, 40960
  s_add_u32 s13, s13, 40960
  s_mov_b32 s19, 40960
  v_mov_b32 v7, 0
  s_lshl_b32 s15, s3, 10
  v_add_u32 v3, s15, v2
  s_and_b32 s9, s80, 3
  v_mov_b32 v5, v2
  s_mov_b32 s24, 0
  s_lshr_b32 s15, s3, 1
  s_add_u32 s15, s15, 4
  s_lshl_b32 s15, s15, 10
  s_and_b32 s16, s3, 1
  s_lshl_b32 s16, s16, 3
  s_add_u32 s15, s15, s16
  v_add_u32 v4, s15, v2
  v_and_b32 v9, 15, v1
  v_lshrrev_b32 v10, 4, v1
  v_and_b32 v11, 7, v1
  v_lshlrev_b32 v11, 4, v11
  v_lshl_add_u32 v11, v10, 7, v11
  v_lshrrev_b32 v8, 1, v11
  v_add_u32 v3, 122880, v3
  v_add_u32 v4, 122880, v4
  s_mul_i32 s26, s3, 6144
  s_add_u32 s26, s26, 122880
  v_add_u32 v12, s26, v2
  v_mov_b32 v13, 0xd04e79ff
  v_lshlrev_b32 v14, 2, v10
  v_add_u32 v15, 0, v14
  v_cmp_le_u32 s[32:33], v15, v9
  v_add_u32 v15, 1, v14
  v_cmp_le_u32 s[34:35], v15, v9
  v_add_u32 v15, 2, v14
  v_cmp_le_u32 s[36:37], v15, v9
  v_add_u32 v15, 3, v14
  v_cmp_le_u32 s[38:39], v15, v9
  s_mov_b32 s40, -1
  s_mov_b32 s41, 0
  s_mov_b32 s42, 0x3dd53b95
  s_lshr_b32 s31, s3, 1
  s_mul_i32 s20, s31, 325632
  s_add_u32 s60, s31, 1
  s_mul_i32 s26, s9, 12288
  s_add_u32 s26, s26, s78
  s_add_u32 s26, s26, 204800
  s_mul_i32 s27, s9, 3072
  s_add_u32 s27, s27, s78
  s_add_u32 s27, s27, 303104
  s_and_b32 s28, s3, 1
  s_mul_i32 s28, s28, 5120
  s_add_u32 s28, s28, s78
  s_add_u32 s28, s28, 315392
  s_lshl_b32 s29, s9, 10
  v_add_u32 v14, s29, v2
  s_lshl_b32 s29, s9, 8
  s_add_u32 s29, s29, 4096
  v_lshlrev_b32 v15, 3, v10
  v_lshl_add_u32 v15, v9, 4, v15
  v_add_u32 v15, s29, v15
  s_lshl_b32 s48, s80, 7
  v_and_b32 v84, 3, v1
  v_lshlrev_b32 v84, 2, v84
  v_add_u32 v84, s48, v84
  v_add_u32 v85, 16384, v84
  s_lshl_b32 s50, s3, 2
  s_add_u32 s50, s50, s48
  s_add_u32 s50, s50, s71
  s_add_u32 s50, s50, 8192
  s_mov_b32 s62, 0
  s_waitcnt vmcnt(0)
  s_barrier
  ds_read_b128 v[16:19], v5 offset:0
  ds_read_b128 v[20:23], v5 offset:20480
  ds_read_b128 v[24:27], v5 offset:1024
  ds_read_b128 v[28:31], v5 offset:21504
  ds_read_b128 v[32:35], v5 offset:2048
  ds_read_b128 v[36:39], v5 offset:22528
  s_waitcnt lgkmcnt(4)
  v_mfma_f32_16x16x32_bf16 v[48:51], a[0:3], v[16:19], 0
  ds_read_b128 v[40:43], v5 offset:3072
  v_mfma_f32_16x16x32_bf16 v[52:55], a[80:83], v[16:19], 0
  s_add_u32 m0, s13, 0
  s_add_u32 s18, s12, 0
  buffer_load_dwordx4 v2, s[4:7], s18 offen offset:0 lds
  v_mfma_f32_16x16x32_bf16 v[56:59], a[160:163], v[16:19], 0
  v_mfma_f32_16x16x32_bf16 v[60:63], a[0:3], v[20:23], 0
  ds_read_b128 v[44:47], v5 offset:23552
  v_mfma_f32_16x16x32_bf16 v[64:67], a[80:83], v[20:23], 0
  v_mfma_f32_16x16x32_bf16 v[68:71], a[160:163], v[20:23], 0
  s_waitcnt lgkmcnt(4)
  v_mfma_f32_16x16x32_bf16 v[48:51], a[4:7], v[24:27], v[48:51]
  ds_read_b128 v[16:19], v5 offset:4096
  v_mfma_f32_16x16x32_bf16 v[52:55], a[84:87], v[24:27], v[52:55]
  v_mfma_f32_16x16x32_bf16 v[56:59], a[164:167], v[24:27], v[56:59]
  buffer_load_dwordx4 v2, s[4:7], s18 offen offset:1024 lds
  v_mfma_f32_16x16x32_bf16 v[60:63], a[4:7], v[28:31], v[60:63]
  ds_read_b128 v[20:23], v5 offset:24576
  v_mfma_f32_16x16x32_bf16 v[64:67], a[84:87], v[28:31], v[64:67]
  v_mfma_f32_16x16x32_bf16 v[68:71], a[164:167], v[28:31], v[68:71]
  s_waitcnt lgkmcnt(4)
  v_mfma_f32_16x16x32_bf16 v[48:51], a[8:11], v[32:35], v[48:51]
  ds_read_b128 v[24:27], v5 offset:5120
  v_mfma_f32_16x16x32_bf16 v[52:55], a[88:91], v[32:35], v[52:55]
  v_mfma_f32_16x16x32_bf16 v[56:59], a[168:171], v[32:35], v[56:59]
  v_mfma_f32_16x16x32_bf16 v[60:63], a[8:11], v[36:39], v[60:63]
  ds_read_b128 v[28:31], v5 offset:25600
  v_mfma_f32_16x16x32_bf16 v[64:67], a[88:91], v[36:39], v[64:67]
  v_mfma_f32_16x16x32_bf16 v[68:71], a[168:171], v[36:39], v[68:71]
  buffer_load_dwordx4 v2, s[4:7], s18 offen offset:2048 lds
  s_waitcnt lgkmcnt(4)
  v_mfma_f32_16x16x32_bf16 v[48:51], a[12:15], v[40:43], v[48:51]
  ds_read_b128 v[32:35], v5 offset:6144
  v_mfma_f32_16x16x32_bf16 v[52:55], a[92:95], v[40:43], v[52:55]
  v_mfma_f32_16x16x32_bf16 v[56:59], a[172:175], v[40:43], v[56:59]
  v_mfma_f32_16x16x32_bf16 v[60:63], a[12:15], v[44:47], v[60:63]
  ds_read_b128 v[36:39], v5 offset:26624
  v_mfma_f32_16x16x32_bf16 v[64:67], a[92:95], v[44:47], v[64:67]
  v_mfma_f32_16x16x32_bf16 v[68:71], a[172:175], v[44:47], v[68:71]
  s_waitcnt lgkmcnt(4)
  v_mfma_f32_16x16x32_bf16 v[48:51], a[16:19], v[16:19], v[48:51]
  ds_read_b128 v[40:43], v5 offset:7168
  v_mfma_f32_16x16x32_bf16 v[52:55], a[96:99], v[16:19], v[52:55]
  buffer_load_dwordx4 v2, s[4:7], s18 offen offset:3072 lds
  v_mfma_f32_16x16x32_bf16 v[56:59], a[176:179], v[16:19], v[56:59]
  v_mfma_f32_16x16x32_bf16 v[60:63], a[16:19], v[20:23], v[60:63]
  ds_read_b128 v[44:47], v5 offset:27648
  v_mfma_f32_16x16x32_bf16 v[64:67], a[96:99], v[20:23], v[64:67]
  v_mfma_f32_16x16x32_bf16 v[68:71], a[176:179], v[20:23], v[68:71]
  s_waitcnt lgkmcnt(4)
  v_mfma_f32_16x16x32_bf16 v[48:51], a[20:23], v[24:27], v[48:51]
  ds_read_b128 v[16:19], v5 offset:8192
  v_mfma_f32_16x16x32_bf16 v[52:55], a[100:103], v[24:27], v[52:55]
  v_mfma_f32_16x16x32_bf16 v[56:59], a[180:183], v[24:27], v[56:59]
  v_mfma_f32_16x16x32_bf16 v[60:63], a[20:23], v[28:31], v[60:63]
  ds_read_b128 v[20:23], v5 offset:28672
  v_mfma_f32_16x16x32_bf16 v[64:67], a[100:103], v[28:31], v[64:67]
  s_add_u32 m0, s13, 4096
  s_add_u32 s18, s12, 4096
  buffer_load_dwordx4 v2, s[4:7], s18 offen offset:0 lds
  v_mfma_f32_16x16x32_bf16 v[68:71], a[180:183], v[28:31], v[68:71]
  s_waitcnt lgkmcnt(4)
  v_mfma_f32_16x16x32_bf16 v[48:51], a[24:27], v[32:35], v[48:51]
  ds_read_b128 v[24:27], v5 offset:9216
  v_mfma_f32_16x16x32_bf16 v[52:55], a[104:107], v[32:35], v[52:55]
  v_mfma_f32_16x16x32_bf16 v[56:59], a[184:187], v[32:35], v[56:59]
  v_mfma_f32_16x16x32_bf16 v[60:63], a[24:27], v[36:39], v[60:63]
  ds_read_b128 v[28:31], v5 offset:29696
  v_mfma_f32_16x16x32_bf16 v[64:67], a[104:107], v[36:39], v[64:67]
  v_mfma_f32_16x16x32_bf16 v[68:71], a[184:187], v[36:39], v[68:71]
  s_waitcnt lgkmcnt(4)
  v_mfma_f32_16x16x32_bf16 v[48:51], a[28:31], v[40:43], v[48:51]
  ds_read_b128 v[32:35], v5 offset:10240
  v_mfma_f32_16x16x32_bf16 v[52:55], a[108:111], v[40:43], v[52:55]
  buffer_load_dwordx4 v2, s[4:7], s18 offen offset:1024 lds
  v_mfma_f32_16x16x32_bf16 v[56:59], a[188:191], v[40:43], v[56:59]
  v_mfma_f32_16x16x32_bf16 v[60:63], a[28:31], v[44:47], v[60:63]
  ds_read_b128 v[36:39], v5 offset:30720
  v_mfma_f32_16x16x32_bf16 v[64:67], a[108:111], v[44:47], v[64:67]
  v_mfma_f32_16x16x32_bf16 v[68:71], a[188:191], v[44:47], v[68:71]
  s_waitcnt lgkmcnt(4)
  v_mfma_f32_16x16x32_bf16 v[48:51], a[32:35], v[16:19], v[48:51]
  ds_read_b128 v[40:43], v5 offset:11264
  v_mfma_f32_16x16x32_bf16 v[52:55], a[112:115], v[16:19], v[52:55]
  v_mfma_f32_16x16x32_bf16 v[56:59], a[192:195], v[16:19], v[56:59]
  buffer_load_dwordx4 v2, s[4:7], s18 offen offset:2048 lds
  v_mfma_f32_16x16x32_bf16 v[60:63], a[32:35], v[20:23], v[60:63]
  ds_read_b128 v[44:47], v5 offset:31744
  v_mfma_f32_16x16x32_bf16 v[64:67], a[112:115], v[20:23], v[64:67]
  v_mfma_f32_16x16x32_bf16 v[68:71], a[192:195], v[20:23], v[68:71]
  s_waitcnt lgkmcnt(4)
  v_mfma_f32_16x16x32_bf16 v[48:51], a[36:39], v[24:27], v[48:51]
  ds_read_b128 v[16:19], v5 offset:12288
  v_mfma_f32_16x16x32_bf16 v[52:55], a[116:119], v[24:27], v[52:55]
  v_mfma_f32_16x16x32_bf16 v[56:59], a[196:199], v[24:27], v[56:59]
  v_mfma_f32_16x16x32_bf16 v[60:63], a[36:39], v[28:31], v[60:63]
  ds_read_b128 v[20:23], v5 offset:32768
  v_mfma_f32_16x16x32_bf16 v[64:67], a[116:119], v[28:31], v[64:67]
  v_mfma_f32_16x16x32_bf16 v[68:71], a[196:199], v[28:31], v[68:71]
  buffer_load_dwordx4 v2, s[4:7], s18 offen offset:3072 lds
  s_waitcnt lgkmcnt(4)
  v_mfma_f32_16x16x32_bf16 v[48:51], a[40:43], v[32:35], v[48:51]
  ds_read_b128 v[24:27], v5 offset:13312
  v_mfma_f32_16x16x32_bf16 v[52:55], a[120:123], v[32:35], v[52:55]
  v_mfma_f32_16x16x32_bf16 v[56:59], a[200:203], v[32:35], v[56:59]
  v_mfma_f32_16x16x32_bf16 v[60:63], a[40:43], v[36:39], v[60:63]
  ds_read_b128 v[28:31], v5 offset:33792
  v_mfma_f32_16x16x32_bf16 v[64:67], a[120:123], v[36:39], v[64:67]
  v_mfma_f32_16x16x32_bf16 v[68:71], a[200:203], v[36:39], v[68:71]
  s_waitcnt lgkmcnt(4)
  v_mfma_f32_16x16x32_bf16 v[48:51], a[44:47], v[40:43], v[48:51]
  ds_read_b128 v[32:35], v5 offset:14336
  v_mfma_f32_16x16x32_bf16 v[52:55], a[124:127], v[40:43], v[52:55]
  s_add_u32 m0, s13, 8192
  s_add_u32 s18, s12, 8192
  buffer_load_dwordx4 v2, s[4:7], s18 offen offset:0 lds
  v_mfma_f32_16x16x32_bf16 v[56:59], a[204:207], v[40:43], v[56:59]
  v_mfma_f32_16x16x32_bf16 v[60:63], a[44:47], v[44:47], v[60:63]
  ds_read_b128 v[36:39], v5 offset:34816
  v_mfma_f32_16x16x32_bf16 v[64:67], a[124:127], v[44:47], v[64:67]
  v_mfma_f32_16x16x32_bf16 v[68:71], a[204:207], v[44:47], v[68:71]
  s_waitcnt lgkmcnt(4)
  v_mfma_f32_16x16x32_bf16 v[48:51], a[48:51], v[16:19], v[48:51]
  ds_read_b128 v[40:43], v5 offset:15360
  v_mfma_f32_16x16x32_bf16 v[52:55], a[128:131], v[16:19], v[52:55]
  v_mfma_f32_16x16x32_bf16 v[56:59], a[208:211], v[16:19], v[56:59]
  v_mfma_f32_16x16x32_bf16 v[60:63], a[48:51], v[20:23], v[60:63]
  ds_read_b128 v[44:47], v5 offset:35840
  v_mfma_f32_16x16x32_bf16 v[64:67], a[128:131], v[20:23], v[64:67]
  buffer_load_dwordx4 v2, s[4:7], s18 offen offset:1024 lds
  v_mfma_f32_16x16x32_bf16 v[68:71], a[208:211], v[20:23], v[68:71]
  s_waitcnt lgkmcnt(4)
  v_mfma_f32_16x16x32_bf16 v[48:51], a[52:55], v[24:27], v[48:51]
  ds_read_b128 v[16:19], v5 offset:16384
  v_mfma_f32_16x16x32_bf16 v[52:55], a[132:135], v[24:27], v[52:55]
  v_mfma_f32_16x16x32_bf16 v[56:59], a[212:215], v[24:27], v[56:59]
  v_mfma_f32_16x16x32_bf16 v[60:63], a[52:55], v[28:31], v[60:63]
  ds_read_b128 v[20:23], v5 offset:36864
  v_mfma_f32_16x16x32_bf16 v[64:67], a[132:135], v[28:31], v[64:67]
  v_mfma_f32_16x16x32_bf16 v[68:71], a[212:215], v[28:31], v[68:71]
  s_waitcnt lgkmcnt(4)
  v_mfma_f32_16x16x32_bf16 v[48:51], a[56:59], v[32:35], v[48:51]
  ds_read_b128 v[24:27], v5 offset:17408
  v_mfma_f32_16x16x32_bf16 v[52:55], a[136:139], v[32:35], v[52:55]
  v_mfma_f32_16x16x32_bf16 v[56:59], a[216:219], v[32:35], v[56:59]
  v_mfma_f32_16x16x32_bf16 v[60:63], a[56:59], v[36:39], v[60:63]
  ds_read_b128 v[28:31], v5 offset:37888
  v_mfma_f32_16x16x32_bf16 v[64:67], a[136:139], v[36:39], v[64:67]
  v_mfma_f32_16x16x32_bf16 v[68:71], a[216:219], v[36:39], v[68:71]
  s_waitcnt lgkmcnt(4)
  v_mfma_f32_16x16x32_bf16 v[48:51], a[60:63], v[40:43], v[48:51]
  ds_read_b128 v[32:35], v5 offset:18432
  v_mfma_f32_16x16x32_bf16 v[52:55], a[140:143], v[40:43], v[52:55]
  v_mfma_f32_16x16x32_bf16 v[56:59], a[220:223], v[40:43], v[56:59]
  v_mfma_f32_16x16x32_bf16 v[60:63], a[60:63], v[44:47], v[60:63]
  ds_read_b128 v[36:39], v5 offset:38912
  v_mfma_f32_16x16x32_bf16 v[64:67], a[140:143], v[44:47], v[64:67]
  v_mfma_f32_16x16x32_bf16 v[68:71], a[220:223], v[44:47], v[68:71]
  s_waitcnt lgkmcnt(4)
  v_mfma_f32_16x16x32_bf16 v[48:51], a[64:67], v[16:19], v[48:51]
  ds_read_b128 v[40:43], v5 offset:19456
  v_mfma_f32_16x16x32_bf16 v[52:55], a[144:147], v[16:19], v[52:55]
  v_mfma_f32_16x16x32_bf16 v[56:59], a[224:227], v[16:19], v[56:59]
  v_mfma_f32_16x16x32_bf16 v[60:63], a[64:67], v[20:23], v[60:63]
  ds_read_b128 v[44:47], v5 offset:39936
  v_mfma_f32_16x16x32_bf16 v[64:67], a[144:147], v[20:23], v[64:67]
  v_mfma_f32_16x16x32_bf16 v[68:71], a[224:227], v[20:23], v[68:71]
  s_waitcnt lgkmcnt(4)
  v_mfma_f32_16x16x32_bf16 v[48:51], a[68:71], v[24:27], v[48:51]
  v_mfma_f32_16x16x32_bf16 v[52:55], a[148:151], v[24:27], v[52:55]
  v_mfma_f32_16x16x32_bf16 v[56:59], a[228:231], v[24:27], v[56:59]
  v_mfma_f32_16x16x32_bf16 v[60:63], a[68:71], v[28:31], v[60:63]
  v_mfma_f32_16x16x32_bf16 v[64:67], a[148:151], v[28:31], v[64:67]
  v_mfma_f32_16x16x32_bf16 v[68:71], a[228:231], v[28:31], v[68:71]
  s_waitcnt lgkmcnt(2)
  v_mfma_f32_16x16x32_bf16 v[48:51], a[72:75], v[32:35], v[48:51]
  v_mfma_f32_16x16x32_bf16 v[52:55], a[152:155], v[32:35], v[52:55]
  v_mfma_f32_16x16x32_bf16 v[56:59], a[232:235], v[32:35], v[56:59]
  v_mfma_f32_16x16x32_bf16 v[60:63], a[72:75], v[36:39], v[60:63]
  v_mfma_f32_16x16x32_bf16 v[64:67], a[152:155], v[36:39], v[64:67]
  v_mfma_f32_16x16x32_bf16 v[68:71], a[232:235], v[36:39], v[68:71]
  s_waitcnt lgkmcnt(0)
  v_mfma_f32_16x16x32_bf16 v[48:51], a[76:79], v[40:43], v[48:51]
  v_mfma_f32_16x16x32_bf16 v[52:55], a[156:159], v[40:43], v[52:55]
  v_mfma_f32_16x16x32_bf16 v[56:59], a[236:239], v[40:43], v[56:59]
  v_mfma_f32_16x16x32_bf16 v[60:63], a[76:79], v[44:47], v[60:63]
  v_mfma_f32_16x16x32_bf16 v[64:67], a[156:159], v[44:47], v[64:67]
  v_mfma_f32_16x16x32_bf16 v[68:71], a[236:239], v[44:47], v[68:71]
  v_add_u32 v5, s19, v5
  s_sub_u32 s13, s13, s19
  s_sub_u32 s19, 0, s19
  s_add_u32 s12, s12, 40960
  s_add_u32 s24, s24, 1
  v_cvt_pk_bf16_f32 v96, v48, v49
  v_cvt_pk_bf16_f32 v97, v50, v51
  v_cvt_pk_bf16_f32 v98, v52, v53
  v_cvt_pk_bf16_f32 v99, v54, v55
  v_cvt_pk_bf16_f32 v100, v56, v57
  v_cvt_pk_bf16_f32 v101, v58, v59
  ds_write_b128 v3, v[96:99] offset:0
  ds_write_b64 v4, v[100:101] offset:0
  v_cvt_pk_bf16_f32 v104, v60, v61
  v_cvt_pk_bf16_f32 v105, v62, v63
  v_cvt_pk_bf16_f32 v106, v64, v65
  v_cvt_pk_bf16_f32 v107, v66, v67
  v_cvt_pk_bf16_f32 v108, v68, v69
  v_cvt_pk_bf16_f32 v109, v70, v71
  ds_write_b128 v3, v[104:107] offset:6144
  ds_write_b64 v4, v[108:109] offset:6144
  s_waitcnt vmcnt(0)
  s_barrier
  ds_read_b128 v[16:19], v5 offset:0
  ds_read_b128 v[20:23], v5 offset:20480
  ds_read_b128 v[24:27], v5 offset:1024
  ds_read_b128 v[28:31], v5 offset:21504
  ds_read_b128 v[32:35], v5 offset:2048
  ds_read_b128 v[36:39], v5 offset:22528
  s_waitcnt lgkmcnt(4)
  v_mfma_f32_16x16x32_bf16 v[48:51], a[0:3], v[16:19], 0
  ds_read_b128 v[40:43], v5 offset:3072
  v_mfma_f32_16x16x32_bf16 v[52:55], a[80:83], v[16:19], 0
  s_add_u32 m0, s13, 0
  s_add_u32 s18, s12, 0
  buffer_load_dwordx4 v2, s[4:7], s18 offen offset:0 lds
  v_mfma_f32_16x16x32_bf16 v[56:59], a[160:163], v[16:19], 0
  v_mfma_f32_16x16x32_bf16 v[60:63], a[0:3], v[20:23], 0
  ds_read_b128 v[44:47], v5 offset:23552
  v_mfma_f32_16x16x32_bf16 v[64:67], a[80:83], v[20:23], 0
  v_mfma_f32_16x16x32_bf16 v[68:71], a[160:163], v[20:23], 0
  s_waitcnt lgkmcnt(4)
  v_mfma_f32_16x16x32_bf16 v[48:51], a[4:7], v[24:27], v[48:51]
  ds_read_b128 v[16:19], v5 offset:4096
  v_mfma_f32_16x16x32_bf16 v[52:55], a[84:87], v[24:27], v[52:55]
  v_mfma_f32_16x16x32_bf16 v[56:59], a[164:167], v[24:27], v[56:59]
  v_mfma_f32_16x16x32_bf16 v[60:63], a[4:7], v[28:31], v[60:63]
  ds_read_b128 v[20:23], v5 offset:24576
  v_mfma_f32_16x16x32_bf16 v[64:67], a[84:87], v[28:31], v[64:67]
  buffer_load_dwordx4 v2, s[4:7], s18 offen offset:1024 lds
  v_mfma_f32_16x16x32_bf16 v[68:71], a[164:167], v[28:31], v[68:71]
  s_waitcnt lgkmcnt(4)
  v_mfma_f32_16x16x32_bf16 v[48:51], a[8:11], v[32:35], v[48:51]
  ds_read_b128 v[24:27], v5 offset:5120
  v_mfma_f32_16x16x32_bf16 v[52:55], a[88:91], v[32:35], v[52:55]
  v_mfma_f32_16x16x32_bf16 v[56:59], a[168:171], v[32:35], v[56:59]
  v_mfma_f32_16x16x32_bf16 v[60:63], a[8:11], v[36:39], v[60:63]
  ds_read_b128 v[28:31], v5 offset:25600
  v_mfma_f32_16x16x32_bf16 v[64:67], a[88:91], v[36:39], v[64:67]
  v_mfma_f32_16x16x32_bf16 v[68:71], a[168:171], v[36:39], v[68:71]
  s_waitcnt lgkmcnt(4)
  v_mfma_f32_16x16x32_bf16 v[48:51], a[12:15], v[40:43], v[48:51]
  ds_read_b128 v[32:35], v5 offset:6144
  v_mfma_f32_16x16x32_bf16 v[52:55], a[92:95], v[40:43], v[52:55]
  v_mfma_f32_16x16x32_bf16 v[56:59], a[172:175], v[40:43], v[56:59]
  buffer_load_dwordx4 v2, s[4:7], s18 offen offset:2048 lds
  v_mfma_f32_16x16x32_bf16 v[60:63], a[12:15], v[44:47], v[60:63]
  ds_read_b128 v[36:39], v5 offset:26624
  v_mfma_f32_16x16x32_bf16 v[64:67], a[92:95], v[44:47], v[64:67]
  v_mfma_f32_16x16x32_bf16 v[68:71], a[172:175], v[44:47], v[68:71]
  s_waitcnt lgkmcnt(4)
  v_mfma_f32_16x16x32_bf16 v[48:51], a[16:19], v[16:19], v[48:51]
  ds_read_b128 v[40:43], v5 offset:7168
  v_mfma_f32_16x16x32_bf16 v[52:55], a[96:99], v[16:19], v[52:55]
  v_mfma_f32_16x16x32_bf16 v[56:59], a[176:179], v[16:19], v[56:59]
  v_mfma_f32_16x16x32_bf16 v[60:63], a[16:19], v[20:23], v[60:63]
  ds_read_b128 v[44:47], v5 offset:27648
  v_mfma_f32_16x16x32_bf16 v[64:67], a[96:99], v[20:23], v[64:67]
  v_mfma_f32_16x16x32_bf16 v[68:71], a[176:179], v[20:23], v[68:71]
  s_waitcnt lgkmcnt(4)
  v_mfma_f32_16x16x32_bf16 v[48:51], a[20:23], v[24:27], v[48:51]
  ds_read_b128 v[16:19], v5 offset:8192
  v_mfma_f32_16x16x32_bf16 v[52:55], a[100:103], v[24:27], v[52:55]
  buffer_load_dwordx4 v2, s[4:7], s18 offen offset:3072 lds
  v_mfma_f32_16x16x32_bf16 v[56:59], a[180:183], v[24:27], v[56:59]
  v_mfma_f32_16x16x32_bf16 v[60:63], a[20:23], v[28:31], v[60:63]
  ds_read_b128 v[20:23], v5 offset:28672
  v_mfma_f32_16x16x32_bf16 v[64:67], a[100:103], v[28:31], v[64:67]
  v_mfma_f32_16x16x32_bf16 v[68:71], a[180:183], v[28:31], v[68:71]
  s_waitcnt lgkmcnt(4)
  v_mfma_f32_16x16x32_bf16 v[48:51], a[24:27], v[32:35], v[48:51]
  ds_read_b128 v[24:27], v5 offset:9216
  v_mfma_f32_16x16x32_bf16 v[52:55], a[104:107], v[32:35], v[52:55]
  v_mfma_f32_16x16x32_bf16 v[56:59], a[184:187], v[32:35], v[56:59]
  v_mfma_f32_16x16x32_bf16 v[60:63], a[24:27], v[36:39], v[60:63]
  ds_read_b128 v[28:31], v5 offset:29696
  v_mfma_f32_16x16x32_bf16 v[64:67], a[104:107], v[36:39], v[64:67]
  v_mfma_f32_16x16x32_bf16 v[68:71], a[184:187], v[36:39], v[68:71]
  s_add_u32 m0, s13, 4096
  s_add_u32 s18, s12, 4096
  buffer_load_dwordx4 v2, s[4:7], s18 offen offset:0 lds
  s_waitcnt lgkmcnt(4)
  v_mfma_f32_16x16x32_bf16 v[48:51], a[28:31], v[40:43], v[48:51]
  ds_read_b128 v[32:35], v5 offset:10240
  v_mfma_f32_16x16x32_bf16 v[52:55], a[108:111], v[40:43], v[52:55]
  v_mfma_f32_16x16x32_bf16 v[56:59], a[188:191], v[40:43], v[56:59]
  v_mfma_f32_16x16x32_bf16 v[60:63], a[28:31], v[44:47], v[60:63]
  ds_read_b128 v[36:39], v5 offset:30720
  v_mfma_f32_16x16x32_bf16 v[64:67], a[108:111], v[44:47], v[64:67]
  v_mfma_f32_16x16x32_bf16 v[68:71], a[188:191], v[44:47], v[68:71]
  s_waitcnt lgkmcnt(4)
  v_mfma_f32_16x16x32_bf16 v[48:51], a[32:35], v[16:19], v[48:51]
  ds_read_b128 v[40:43], v5 offset:11264
  v_mfma_f32_16x16x32_bf16 v[52:55], a[112:115], v[16:19], v[52:55]
  v_mfma_f32_16x16x32_bf16 v[56:59], a[192:195], v[16:19], v[56:59]
  v_mfma_f32_16x16x32_bf16 v[60:63], a[32:35], v[20:23], v[60:63]
  ds_read_b128 v[44:47], v5 offset:31744
  v_mfma_f32_16x16x32_bf16 v[64:67], a[112:115], v[20:23], v[64:67]
  buffer_load_dwordx4 v2, s[4:7], s18 offen offset:1024 lds
  v_mfma_f32_16x16x32_bf16 v[68:71], a[192:195], v[20:23], v[68:71]
  s_waitcnt lgkmcnt(4)
  v_mfma_f32_16x16x32_bf16 v[48:51], a[36:39], v[24:27], v[48:51]
  ds_read_b128 v[16:19], v5 offset:12288
  v_mfma_f32_16x16x32_bf16 v[52:55], a[116:119], v[24:27], v[52:55]
  v_mfma_f32_16x16x32_bf16 v[56:59], a[196:199], v[24:27], v[56:59]
  v_mfma_f32_16x16x32_bf16 v[60:63], a[36:39], v[28:31], v[60:63]
  ds_read_b128 v[20:23], v5 offset:32768
  v_mfma_f32_16x16x32_bf16 v[64:67], a[116:119], v[28:31], v[64:67]
  v_mfma_f32_16x16x32_bf16 v[68:71], a[196:199], v[28:31], v[68:71]
  s_waitcnt lgkmcnt(4)
  v_mfma_f32_16x16x32_bf16 v[48:51], a[40:43], v[32:35], v[48:51]
  ds_read_b128 v[24:27], v5 offset:13312
  v_mfma_f32_16x16x32_bf16 v[52:55], a[120:123], v[32:35], v[52:55]
  buffer_load_dwordx4 v2, s[4:7], s18 offen offset:2048 lds
  v_mfma_f32_16x16x32_bf16 v[56:59], a[200:203], v[32:35], v[56:59]
  v_mfma_f32_16x16x32_bf16 v[60:63], a[40:43], v[36:39], v[60:63]
  ds_read_b128 v[28:31], v5 offset:33792
  v_mfma_f32_16x16x32_bf16 v[64:67], a[120:123], v[36:39], v[64:67]
  v_mfma_f32_16x16x32_bf16 v[68:71], a[200:203], v[36:39], v[68:71]
  s_waitcnt lgkmcnt(4)
  v_mfma_f32_16x16x32_bf16 v[48:51], a[44:47], v[40:43], v[48:51]
  ds_read_b128 v[32:35], v5 offset:14336
  v_mfma_f32_16x16x32_bf16 v[52:55], a[124:127], v[40:43], v[52:55]
  v_mfma_f32_16x16x32_bf16 v[56:59], a[204:207], v[40:43], v[56:59]
  v_mfma_f32_16x16x32_bf16 v[60:63], a[44:47], v[44:47], v[60:63]
  ds_read_b128 v[36:39], v5 offset:34816
  v_mfma_f32_16x16x32_bf16 v[64:67], a[124:127], v[44:47], v[64:67]
  v_mfma_f32_16x16x32_bf16 v[68:71], a[204:207], v[44:47], v[68:71]
  buffer_load_dwordx4 v2, s[4:7], s18 offen offset:3072 lds
  s_waitcnt lgkmcnt(4)
  v_mfma_f32_16x16x32_bf16 v[48:51], a[48:51], v[16:19], v[48:51]
  ds_read_b128 v[40:43], v5 offset:15360
  v_mfma_f32_16x16x32_bf16 v[52:55], a[128:131], v[16:19], v[52:55]
  v_mfma_f32_16x16x32_bf16 v[56:59], a[208:211], v[16:19], v[56:59]
  v_mfma_f32_16x16x32_bf16 v[60:63], a[48:51], v[20:23], v[60:63]
  ds_read_b128 v[44:47], v5 offset:35840
  v_mfma_f32_16x16x32_bf16 v[64:67], a[128:131], v[20:23], v[64:67]
  v_mfma_f32_16x16x32_bf16 v[68:71], a[208:211], v[20:23], v[68:71]
  s_waitcnt lgkmcnt(4)
  v_mfma_f32_16x16x32_bf16 v[48:51], a[52:55], v[24:27], v[48:51]
  ds_read_b128 v[16:19], v5 offset:16384
  v_mfma_f32_16x16x32_bf16 v[52:55], a[132:135], v[24:27], v[52:55]
  v_mfma_f32_16x16x32_bf16 v[56:59], a[212:215], v[24:27], v[56:59]
  v_mfma_f32_16x16x32_bf16 v[60:63], a[52:55], v[28:31], v[60:63]
  ds_read_b128 v[20:23], v5 offset:36864
  v_mfma_f32_16x16x32_bf16 v[64:67], a[132:135], v[28:31], v[64:67]
  s_add_u32 m0, s13, 8192
  s_add_u32 s18, s12, 8192
  buffer_load_dwordx4 v2, s[4:7], s18 offen offset:0 lds
  v_mfma_f32_16x16x32_bf16 v[68:71], a[212:215], v[28:31], v[68:71]
  s_waitcnt lgkmcnt(4)
  v_mfma_f32_16x16x32_bf16 v[48:51], a[56:59], v[32:35], v[48:51]
  ds_read_b128 v[24:27], v5 offset:17408
  v_mfma_f32_16x16x32_bf16 v[52:55], a[136:139], v[32:35], v[52:55]
  v_mfma_f32_16x16x32_bf16 v[56:59], a[216:219], v[32:35], v[56:59]
  v_mfma_f32_16x16x32_bf16 v[60:63], a[56:59], v[36:39], v[60:63]
  ds_read_b128 v[28:31], v5 offset:37888
  v_mfma_f32_16x16x32_bf16 v[64:67], a[136:139], v[36:39], v[64:67]
  v_mfma_f32_16x16x32_bf16 v[68:71], a[216:219], v[36:39], v[68:71]
  s_waitcnt lgkmcnt(4)
  v_mfma_f32_16x16x32_bf16 v[48:51], a[60:63], v[40:43], v[48:51]
  ds_read_b128 v[32:35], v5 offset:18432
  v_mfma_f32_16x16x32_bf16 v[52:55], a[140:143], v[40:43], v[52:55]
  v_mfma_f32_16x16x32_bf16 v[56:59], a[220:223], v[40:43], v[56:59]
  buffer_load_dwordx4 v2, s[4:7], s18 offen offset:1024 lds
  v_mfma_f32_16x16x32_bf16 v[60:63], a[60:63], v[44:47], v[60:63]
  ds_read_b128 v[36:39], v5 offset:38912
  v_mfma_f32_16x16x32_bf16 v[64:67], a[140:143], v[44:47], v[64:67]
  v_mfma_f32_16x16x32_bf16 v[68:71], a[220:223], v[44:47], v[68:71]
  s_waitcnt lgkmcnt(4)
  v_mfma_f32_16x16x32_bf16 v[48:51], a[64:67], v[16:19], v[48:51]
  ds_read_b128 v[40:43], v5 offset:19456
  v_mfma_f32_16x16x32_bf16 v[52:55], a[144:147], v[16:19], v[52:55]
  v_mfma_f32_16x16x32_bf16 v[56:59], a[224:227], v[16:19], v[56:59]
  v_mfma_f32_16x16x32_bf16 v[60:63], a[64:67], v[20:23], v[60:63]
  ds_read_b128 v[44:47], v5 offset:39936
  v_mfma_f32_16x16x32_bf16 v[64:67], a[144:147], v[20:23], v[64:67]
  v_mfma_f32_16x16x32_bf16 v[68:71], a[224:227], v[20:23], v[68:71]
  s_waitcnt lgkmcnt(4)
  v_mfma_f32_16x16x32_bf16 v[48:51], a[68:71], v[24:27], v[48:51]
  v_mfma_f32_16x16x32_bf16 v[52:55], a[148:151], v[24:27], v[52:55]
  v_mfma_f32_16x16x32_bf16 v[56:59], a[228:231], v[24:27], v[56:59]
  v_mfma_f32_16x16x32_bf16 v[60:63], a[68:71], v[28:31], v[60:63]
  v_mfma_f32_16x16x32_bf16 v[64:67], a[148:151], v[28:31], v[64:67]
  v_mfma_f32_16x16x32_bf16 v[68:71], a[228:231], v[28:31], v[68:71]
  s_waitcnt lgkmcnt(2)
  v_mfma_f32_16x16x32_bf16 v[48:51], a[72:75], v[32:35], v[48:51]
  v_mfma_f32_16x16x32_bf16 v[52:55], a[152:155], v[32:35], v[52:55]
  v_mfma_f32_16x16x32_bf16 v[56:59], a[232:235], v[32:35], v[56:59]
  v_mfma_f32_16x16x32_bf16 v[60:63], a[72:75], v[36:39], v[60:63]
  v_mfma_f32_16x16x32_bf16 v[64:67], a[152:155], v[36:39], v[64:67]
  v_mfma_f32_16x16x32_bf16 v[68:71], a[232:235], v[36:39], v[68:71]
  s_waitcnt lgkmcnt(0)
  v_mfma_f32_16x16x32_bf16 v[48:51], a[76:79], v[40:43], v[48:51]
  v_mfma_f32_16x16x32_bf16 v[52:55], a[156:159], v[40:43], v[52:55]
  v_mfma_f32_16x16x32_bf16 v[56:59], a[236:239], v[40:43], v[56:59]
  v_mfma_f32_16x16x32_bf16 v[60:63], a[76:79], v[44:47], v[60:63]
  v_mfma_f32_16x16x32_bf16 v[64:67], a[156:159], v[44:47], v[64:67]
  v_mfma_f32_16x16x32_bf16 v[68:71], a[236:239], v[44:47], v[68:71]
  v_add_u32 v5, s19, v5
  s_sub_u32 s13, s13, s19
  s_sub_u32 s19, 0, s19
  s_add_u32 s12, s12, 40960
  s_add_u32 s24, s24, 1
  v_cvt_pk_bf16_f32 v96, v48, v49
  v_cvt_pk_bf16_f32 v97, v50, v51
  v_cvt_pk_bf16_f32 v98, v52, v53
  v_cvt_pk_bf16_f32 v99, v54, v55
  v_cvt_pk_bf16_f32 v100, v56, v57
  v_cvt_pk_bf16_f32 v101, v58, v59
  ds_write_b128 v3, v[96:99] offset:12288
  ds_write_b64 v4, v[100:101] offset:12288
  v_cvt_pk_bf16_f32 v104, v60, v61
  v_cvt_pk_bf16_f32 v105, v62, v63
  v_cvt_pk_bf16_f32 v106, v64, v65
  v_cvt_pk_bf16_f32 v107, v66, v67
  v_cvt_pk_bf16_f32 v108, v68, v69
  v_cvt_pk_bf16_f32 v109, v70, v71
  ds_write_b128 v3, v[104:107] offset:18432
  ds_write_b64 v4, v[108:109] offset:18432
  s_waitcnt lgkmcnt(0)
  s_barrier
  ds_read_b128 v[232:235], v12 offset:0
  ds_read_b128 v[236:239], v12 offset:1024
  ds_read_b128 v[240:243], v12 offset:2048
  ds_read_b128 v[244:247], v12 offset:3072
  ds_read_b128 v[248:251], v12 offset:4096
  ds_read_b128 v[252:255], v12 offset:5120
  s_cmp_eq_u32 s70, 0
  s_cbranch_scc1 mega_kernel_hw28_ok
  v_lshlrev_b32 v87, 7, v1
  s_mov_b32 s30, 0
mega_kernel_hw28:
  s_mov_b32 s15, 53542944
  buffer_load_dwordx4 v[96:99], v87, s[4:7], s15 offen sc1
  s_mov_b32 s15, 53551136
  buffer_load_dwordx4 v[100:103], v87, s[4:7], s15 offen sc1
  s_mov_b32 s15, 53559328
  buffer_load_dwordx4 v[104:107], v87, s[4:7], s15 offen sc1
  s_mov_b32 s15, 53567520
  buffer_load_dwordx4 v[108:111], v87, s[4:7], s15 offen sc1
  s_waitcnt vmcnt(0)
  v_min3_u32 v96, v96, v97, v98
  v_min3_u32 v96, v96, v99, v100
  v_min3_u32 v96, v96, v101, v102
  v_min3_u32 v96, v96, v103, v104
  v_min3_u32 v96, v96, v105, v106
  v_min3_u32 v96, v96, v107, v108
  v_min3_u32 v96, v96, v109, v110
  v_min_u32 v96, v96, v111
  v_cmp_eq_u32 vcc, 0, v96
  s_nop 0
  s_cbranch_vccz mega_kernel_hw28_ok
  s_sleep 1
  s_add_u32 s30, s30, 1
  s_cmp_lt_u32 s30, 262144
  s_cbranch_scc1 mega_kernel_hw28
  s_branch mega_fail
mega_kernel_hw28_ok:
  s_waitcnt vmcnt(0)
mega_q_loop:
  s_waitcnt lgkmcnt(0)
  v_mov_b32 v112, v232
  v_mov_b32 v113, v233
  v_mov_b32 v114, v234
  v_mov_b32 v115, v235
  v_mov_b32 v116, v236
  v_mov_b32 v117, v237
  v_mov_b32 v118, v238
  v_mov_b32 v119, v239
  v_mov_b32 v120, v240
  v_mov_b32 v121, v241
  v_mov_b32 v122, v242
  v_mov_b32 v123, v243
  v_mov_b32 v124, v244
  v_mov_b32 v125, v245
  v_mov_b32 v126, v246
  v_mov_b32 v127, v247
  v_mov_b32 v128, v248
  v_mov_b32 v129, v249
  v_mov_b32 v130, v250
  v_mov_b32 v131, v251
  v_mov_b32 v132, v252
  v_mov_b32 v133, v253
  v_mov_b32 v134, v254
  v_mov_b32 v135, v255
  s_cmp_eq_u32 s62, 62
  s_cbranch_scc1 mega_q_last
  s_barrier
  ds_read_b128 v[16:19], v5 offset:0
  ds_read_b128 v[20:23], v5 offset:20480
  ds_read_b128 v[24:27], v5 offset:1024
  ds_read_b128 v[28:31], v5 offset:21504
  ds_read_b128 v[32:35], v5 offset:2048
  ds_read_b128 v[36:39], v5 offset:22528
  s_waitcnt lgkmcnt(4)
  v_mfma_f32_16x16x32_bf16 v[48:51], a[0:3], v[16:19], 0
  ds_read_b128 v[40:43], v5 offset:3072
  v_mfma_f32_16x16x32_bf16 v[52:55], a[80:83], v[16:19], 0
  s_add_u32 m0, s13, 0
  s_add_u32 s18, s12, 0
  buffer_load_dwordx4 v2, s[4:7], s18 offen offset:0 lds
  v_mfma_f32_16x16x32_bf16 v[56:59], a[160:163], v[16:19], 0
  v_mfma_f32_16x16x32_bf16 v[60:63], a[0:3], v[20:23], 0
  ds_read_b128 v[44:47], v5 offset:23552
  v_mfma_f32_16x16x32_bf16 v[64:67], a[80:83], v[20:23], 0
  v_mfma_f32_16x16x32_bf16 v[68:71], a[160:163], v[20:23], 0
  s_waitcnt lgkmcnt(4)
  v_mfma_f32_16x16x32_bf16 v[48:51], a[4:7], v[24:27], v[48:51]
  ds_read_b128 v[16:19], v5 offset:4096
  v_mfma_f32_16x16x32_bf16 v[52:55], a[84:87], v[24:27], v[52:55]
  v_mfma_f32_16x16x32_bf16 v[56:59], a[164:167], v[24:27], v[56:59]
  buffer_load_dwordx4 v2, s[4:7], s18 offen offset:1024 lds
  v_mfma_f32_16x16x32_bf16 v[60:63], a[4:7], v[28:31], v[60:63]
  ds_read_b128 v[20:23], v5 offset:24576
  v_mfma_f32_16x16x32_bf16 v[64:67], a[84:87], v[28:31], v[64:67]
  v_mfma_f32_16x16x32_bf16 v[68:71], a[164:167], v[28:31], v[68:71]
  s_waitcnt lgkmcnt(4)
  v_mfma_f32_16x16x32_bf16 v[48:51], a[8:11], v[32:35], v[48:51]
  ds_read_b128 v[24:27], v5 offset:5120
  v_mfma_f32_16x16x32_bf16 v[52:55], a[88:91], v[32:35], v[52:55]
  v_mfma_f32_16x16x32_bf16 v[56:59], a[168:171], v[32:35], v[56:59]
  v_mfma_f32_16x16x32_bf16 v[60:63], a[8:11], v[36:39], v[60:63]
  ds_read_b128 v[28:31], v5 offset:25600
  v_mfma_f32_16x16x32_bf16 v[64:67], a[88:91], v[36:39], v[64:67]
  v_mfma_f32_16x16x32_bf16 v[68:71], a[168:171], v[36:39], v[68:71]
  buffer_load_dwordx4 v2, s[4:7], s18 offen offset:2048 lds
  s_waitcnt lgkmcnt(4)
  v_mfma_f32_16x16x32_bf16 v[48:51], a[12:15], v[40:43], v[48:51]
  ds_read_b128 v[32:35], v5 offset:6144
  v_mfma_f32_16x16x32_bf16 v[52:55], a[92:95], v[40:43], v[52:55]
  v_mfma_f32_16x16x32_bf16 v[56:59], a[172:175], v[40:43], v[56:59]
  v_mfma_f32_16x16x32_bf16 v[60:63], a[12:15], v[44:47], v[60:63]
  ds_read_b128 v[36:39], v5 offset:26624
  v_mfma_f32_16x16x32_bf16 v[64:67], a[92:95], v[44:47], v[64:67]
  v_mfma_f32_16x16x32_bf16 v[68:71], a[172:175], v[44:47], v[68:71]
  s_waitcnt lgkmcnt(4)
  v_mfma_f32_16x16x32_bf16 v[48:51], a[16:19], v[16:19], v[48:51]
  ds_read_b128 v[40:43], v5 offset:7168
  v_mfma_f32_16x16x32_bf16 v[52:55], a[96:99], v[16:19], v[52:55]
  buffer_load_dwordx4 v2, s[4:7], s18 offen offset:3072 lds
  v_mfma_f32_16x16x32_bf16 v[56:59], a[176:179], v[16:19], v[56:59]
  v_mfma_f32_16x16x32_bf16 v[60:63], a[16:19], v[20:23], v[60:63]
  ds_read_b128 v[44:47], v5 offset:27648
  v_mfma_f32_16x16x32_bf16 v[64:67], a[96:99], v[20:23], v[64:67]
  v_mfma_f32_16x16x32_bf16 v[68:71], a[176:179], v[20:23], v[68:71]
  s_waitcnt lgkmcnt(4)
  v_mfma_f32_16x16x32_bf16 v[48:51], a[20:23], v[24:27], v[48:51]
  ds_read_b128 v[16:19], v5 offset:8192
  v_mfma_f32_16x16x32_bf16 v[52:55], a[100:103], v[24:27], v[52:55]
  v_mfma_f32_16x16x32_bf16 v[56:59], a[180:183], v[24:27], v[56:59]
  v_mfma_f32_16x16x32_bf16 v[60:63], a[20:23], v[28:31], v[60:63]
  ds_read_b128 v[20:23], v5 offset:28672
  v_mfma_f32_16x16x32_bf16 v[64:67], a[100:103], v[28:31], v[64:67]
  s_add_u32 m0, s13, 4096
  s_add_u32 s18, s12, 4096
  buffer_load_dwordx4 v2, s[4:7], s18 offen offset:0 lds
  v_mfma_f32_16x16x32_bf16 v[68:71], a[180:183], v[28:31], v[68:71]
  s_waitcnt lgkmcnt(4)
  v_mfma_f32_16x16x32_bf16 v[48:51], a[24:27], v[32:35], v[48:51]
  ds_read_b128 v[24:27], v5 offset:9216
  v_mfma_f32_16x16x32_bf16 v[52:55], a[104:107], v[32:35], v[52:55]
  v_mfma_f32_16x16x32_bf16 v[56:59], a[184:187], v[32:35], v[56:59]
  v_mfma_f32_16x16x32_bf16 v[60:63], a[24:27], v[36:39], v[60:63]
  ds_read_b128 v[28:31], v5 offset:29696
  v_mfma_f32_16x16x32_bf16 v[64:67], a[104:107], v[36:39], v[64:67]
  v_mfma_f32_16x16x32_bf16 v[68:71], a[184:187], v[36:39], v[68:71]
  s_waitcnt lgkmcnt(4)
  v_mfma_f32_16x16x32_bf16 v[48:51], a[28:31], v[40:43], v[48:51]
  ds_read_b128 v[32:35], v5 offset:10240
  v_mfma_f32_16x16x32_bf16 v[52:55], a[108:111], v[40:43], v[52:55]
  buffer_load_dwordx4 v2, s[4:7], s18 offen offset:1024 lds
  v_mfma_f32_16x16x32_bf16 v[56:59], a[188:191], v[40:43], v[56:59]
  v_mfma_f32_16x16x32_bf16 v[60:63], a[28:31], v[44:47], v[60:63]
  ds_read_b128 v[36:39], v5 offset:30720
  v_mfma_f32_16x16x32_bf16 v[64:67], a[108:111], v[44:47], v[64:67]
  v_mfma_f32_16x16x32_bf16 v[68:71], a[188:191], v[44:47], v[68:71]
  s_waitcnt lgkmcnt(4)
  v_mfma_f32_16x16x32_bf16 v[48:51], a[32:35], v[16:19], v[48:51]
  ds_read_b128 v[40:43], v5 offset:11264
  v_mfma_f32_16x16x32_bf16 v[52:55], a[112:115], v[16:19], v[52:55]
  v_mfma_f32_16x16x32_bf16 v[56:59], a[192:195], v[16:19], v[56:59]
  buffer_load_dwordx4 v2, s[4:7], s18 offen offset:2048 lds
  v_mfma_f32_16x16x32_bf16 v[60:63], a[32:35], v[20:23], v[60:63]
  ds_read_b128 v[44:47], v5 offset:31744
  v_mfma_f32_16x16x32_bf16 v[64:67], a[112:115], v[20:23], v[64:67]
  v_mfma_f32_16x16x32_bf16 v[68:71], a[192:195], v[20:23], v[68:71]
  s_waitcnt lgkmcnt(4)
  v_mfma_f32_16x16x32_bf16 v[48:51], a[36:39], v[24:27], v[48:51]
  ds_read_b128 v[16:19], v5 offset:12288
  v_mfma_f32_16x16x32_bf16 v[52:55], a[116:119], v[24:27], v[52:55]
  v_mfma_f32_16x16x32_bf16 v[56:59], a[196:199], v[24:27], v[56:59]
  v_mfma_f32_16x16x32_bf16 v[60:63], a[36:39], v[28:31], v[60:63]
  ds_read_b128 v[20:23], v5 offset:32768
  v_mfma_f32_16x16x32_bf16 v[64:67], a[116:119], v[28:31], v[64:67]
  v_mfma_f32_16x16x32_bf16 v[68:71], a[196:199], v[28:31], v[68:71]
  buffer_load_dwordx4 v2, s[4:7], s18 offen offset:3072 lds
  s_waitcnt lgkmcnt(4)
  v_mfma_f32_16x16x32_bf16 v[48:51], a[40:43], v[32:35], v[48:51]
  ds_read_b128 v[24:27], v5 offset:13312
  v_mfma_f32_16x16x32_bf16 v[52:55], a[120:123], v[32:35], v[52:55]
  v_mfma_f32_16x16x32_bf16 v[56:59], a[200:203], v[32:35], v[56:59]
  v_mfma_f32_16x16x32_bf16 v[60:63], a[40:43], v[36:39], v[60:63]
  ds_read_b128 v[28:31], v5 offset:33792
  v_mfma_f32_16x16x32_bf16 v[64:67], a[120:123], v[36:39], v[64:67]
  v_mfma_f32_16x16x32_bf16 v[68:71], a[200:203], v[36:39], v[68:71]
  s_waitcnt lgkmcnt(4)
  v_mfma_f32_16x16x32_bf16 v[48:51], a[44:47], v[40:43], v[48:51]
  ds_read_b128 v[32:35], v5 offset:14336
  v_mfma_f32_16x16x32_bf16 v[52:55], a[124:127], v[40:43], v[52:55]
  s_add_u32 m0, s13, 8192
  s_add_u32 s18, s12, 8192
  buffer_load_dwordx4 v2, s[4:7], s18 offen offset:0 lds
  v_mfma_f32_16x16x32_bf16 v[56:59], a[204:207], v[40:43], v[56:59]
  v_mfma_f32_16x16x32_bf16 v[60:63], a[44:47], v[44:47], v[60:63]
  ds_read_b128 v[36:39], v5 offset:34816
  v_mfma_f32_16x16x32_bf16 v[64:67], a[124:127], v[44:47], v[64:67]
  v_mfma_f32_16x16x32_bf16 v[68:71], a[204:207], v[44:47], v[68:71]
  s_waitcnt lgkmcnt(4)
  v_mfma_f32_16x16x32_bf16 v[48:51], a[48:51], v[16:19], v[48:51]
  ds_read_b128 v[40:43], v5 offset:15360
  v_mfma_f32_16x16x32_bf16 v[52:55], a[128:131], v[16:19], v[52:55]
  v_mfma_f32_16x16x32_bf16 v[56:59], a[208:211], v[16:19], v[56:59]
  v_mfma_f32_16x16x32_bf16 v[60:63], a[48:51], v[20:23], v[60:63]
  ds_read_b128 v[44:47], v5 offset:35840
  v_mfma_f32_16x16x32_bf16 v[64:67], a[128:131], v[20:23], v[64:67]
  buffer_load_dwordx4 v2, s[4:7], s18 offen offset:1024 lds
  v_mfma_f32_16x16x32_bf16 v[68:71], a[208:211], v[20:23], v[68:71]
  s_waitcnt lgkmcnt(4)
  v_mfma_f32_16x16x32_bf16 v[48:51], a[52:55], v[24:27], v[48:51]
  ds_read_b128 v[16:19], v5 offset:16384
  v_mfma_f32_16x16x32_bf16 v[52:55], a[132:135], v[24:27], v[52:55]
  v_mfma_f32_16x16x32_bf16 v[56:59], a[212:215], v[24:27], v[56:59]
  v_mfma_f32_16x16x32_bf16 v[60:63], a[52:55], v[28:31], v[60:63]
  ds_read_b128 v[20:23], v5 offset:36864
  v_mfma_f32_16x16x32_bf16 v[64:67], a[132:135], v[28:31], v[64:67]
  v_mfma_f32_16x16x32_bf16 v[68:71], a[212:215], v[28:31], v[68:71]
  s_waitcnt lgkmcnt(4)
  v_mfma_f32_16x16x32_bf16 v[48:51], a[56:59], v[32:35], v[48:51]
  ds_read_b128 v[24:27], v5 offset:17408
  v_mfma_f32_16x16x32_bf16 v[52:55], a[136:139], v[32:35], v[52:55]
  buffer_load_dword v86, v84, s[4:7], s71 offen sc1
  v_mfma_f32_16x16x32_bf16 v[56:59], a[216:219], v[32:35], v[56:59]
  v_mfma_f32_16x16x32_bf16 v[60:63], a[56:59], v[36:39], v[60:63]
  ds_read_b128 v[28:31], v5 offset:37888
  v_mfma_f32_16x16x32_bf16 v[64:67], a[136:139], v[36:39], v[64:67]
  v_mfma_f32_16x16x32_bf16 v[68:71], a[216:219], v[36:39], v[68:71]
  s_waitcnt lgkmcnt(4)
  v_mfma_f32_16x16x32_bf16 v[48:51], a[60:63], v[40:43], v[48:51]
  ds_read_b128 v[32:35], v5 offset:18432
  v_mfma_f32_16x16x32_bf16 v[52:55], a[140:143], v[40:43], v[52:55]
  v_mfma_f32_16x16x32_bf16 v[56:59], a[220:223], v[40:43], v[56:59]
  v_mfma_f32_16x16x32_bf16 v[60:63], a[60:63], v[44:47], v[60:63]
  ds_read_b128 v[36:39], v5 offset:38912
  v_mfma_f32_16x16x32_bf16 v[64:67], a[140:143], v[44:47], v[64:67]
  v_mfma_f32_16x16x32_bf16 v[68:71], a[220:223], v[44:47], v[68:71]
  s_waitcnt lgkmcnt(4)
  v_mfma_f32_16x16x32_bf16 v[48:51], a[64:67], v[16:19], v[48:51]
  ds_read_b128 v[40:43], v5 offset:19456
  v_mfma_f32_16x16x32_bf16 v[52:55], a[144:147], v[16:19], v[52:55]
  v_mfma_f32_16x16x32_bf16 v[56:59], a[224:227], v[16:19], v[56:59]
  v_mfma_f32_16x16x32_bf16 v[60:63], a[64:67], v[20:23], v[60:63]
  ds_read_b128 v[44:47], v5 offset:39936
  v_mfma_f32_16x16x32_bf16 v[64:67], a[144:147], v[20:23], v[64:67]
  v_mfma_f32_16x16x32_bf16 v[68:71], a[224:227], v[20:23], v[68:71]
  s_waitcnt lgkmcnt(4)
  v_mfma_f32_16x16x32_bf16 v[48:51], a[68:71], v[24:27], v[48:51]
  v_mfma_f32_16x16x32_bf16 v[52:55], a[148:151], v[24:27], v[52:55]
  v_mfma_f32_16x16x32_bf16 v[56:59], a[228:231], v[24:27], v[56:59]
  v_mfma_f32_16x16x32_bf16 v[60:63], a[68:71], v[28:31], v[60:63]
  v_mfma_f32_16x16x32_bf16 v[64:67], a[148:151], v[28:31], v[64:67]
  v_mfma_f32_16x16x32_bf16 v[68:71], a[228:231], v[28:31], v[68:71]
  s_waitcnt lgkmcnt(2)
  v_mfma_f32_16x16x32_bf16 v[48:51], a[72:75], v[32:35], v[48:51]
  v_mfma_f32_16x16x32_bf16 v[52:55], a[152:155], v[32:35], v[52:55]
  v_mfma_f32_16x16x32_bf16 v[56:59], a[232:235], v[32:35], v[56:59]
  v_mfma_f32_16x16x32_bf16 v[60:63], a[72:75], v[36:39], v[60:63]
  v_mfma_f32_16x16x32_bf16 v[64:67], a[152:155], v[36:39], v[64:67]
  v_mfma_f32_16x16x32_bf16 v[68:71], a[232:235], v[36:39], v[68:71]
  s_waitcnt lgkmcnt(0)
  v_mfma_f32_16x16x32_bf16 v[48:51], a[76:79], v[40:43], v[48:51]
  v_mfma_f32_16x16x32_bf16 v[52:55], a[156:159], v[40:43], v[52:55]
  v_mfma_f32_16x16x32_bf16 v[56:59], a[236:239], v[40:43], v[56:59]
  v_mfma_f32_16x16x32_bf16 v[60:63], a[76:79], v[44:47], v[60:63]
  v_mfma_f32_16x16x32_bf16 v[64:67], a[156:159], v[44:47], v[64:67]
  v_mfma_f32_16x16x32_bf16 v[68:71], a[236:239], v[44:47], v[68:71]
  v_add_u32 v5, s19, v5
  s_sub_u32 s13, s13, s19
  s_sub_u32 s19, 0, s19
  s_add_u32 s12, s12, 40960
  s_add_u32 s24, s24, 1
  v_cvt_pk_bf16_f32 v96, v48, v49
  v_cvt_pk_bf16_f32 v97, v50, v51
  v_cvt_pk_bf16_f32 v98, v52, v53
  v_cvt_pk_bf16_f32 v99, v54, v55
  v_cvt_pk_bf16_f32 v100, v56, v57
  v_cvt_pk_bf16_f32 v101, v58, v59
  ds_write_b128 v3, v[96:99] offset:0
  ds_write_b64 v4, v[100:101] offset:0
  v_cvt_pk_bf16_f32 v104, v60, v61
  v_cvt_pk_bf16_f32 v105, v62, v63
  v_cvt_pk_bf16_f32 v106, v64, v65
  v_cvt_pk_bf16_f32 v107, v66, v67
  v_cvt_pk_bf16_f32 v108, v68, v69
  v_cvt_pk_bf16_f32 v109, v70, v71
  ds_write_b128 v3, v[104:107] offset:6144
  ds_write_b64 v4, v[108:109] offset:6144
  s_waitcnt vmcnt(0)
  s_add_u32 s52, s26, s20
  s_add_u32 s53, s52, 4096
  s_add_u32 s54, s52, 8192
  s_mov_b32 s30, 0
  s_branch mega_kernel_pv29_t
mega_kernel_pv29:
  buffer_load_dword v86, v84, s[4:7], s71 offen sc1
  s_waitcnt vmcnt(0)
mega_kernel_pv29_t:
  v_cmp_gt_u32 vcc, s60, v86
  s_nop 0
  s_cbranch_vccz mega_kernel_pv29_ok
  s_sleep 2
  s_add_u32 s30, s30, 1
  s_cmp_lt_u32 s30, 262144
  s_cbranch_scc1 mega_kernel_pv29
  s_branch mega_fail
mega_kernel_pv29_ok:
  s_barrier
  ds_read_b128 v[16:19], v5 offset:0
  ds_read_b128 v[20:23], v5 offset:20480
  ds_read_b128 v[24:27], v5 offset:1024
  ds_read_b128 v[28:31], v5 offset:21504
  ds_read_b128 v[32:35], v5 offset:2048
  ds_read_b128 v[36:39], v5 offset:22528
  s_waitcnt lgkmcnt(4)
  v_mfma_f32_16x16x32_bf16 v[48:51], a[0:3], v[16:19], 0
  ds_read_b128 v[40:43], v5 offset:3072
  v_mfma_f32_16x16x32_bf16 v[52:55], a[80:83], v[16:19], 0
  s_add_u32 m0, s13, 0
  s_add_u32 s18, s12, 0
  buffer_load_dwordx4 v2, s[4:7], s18 offen offset:0 lds
  v_mfma_f32_16x16x32_bf16 v[56:59], a[160:163], v[16:19], 0
  v_mfma_f32_16x16x32_bf16 v[60:63], a[0:3], v[20:23], 0
  ds_read_b128 v[44:47], v5 offset:23552
  v_mfma_f32_16x16x32_bf16 v[64:67], a[80:83], v[20:23], 0
  buffer_load_dwordx4 v[136:139], v2, s[4:7], s52 offen offset:0 sc1
  v_mfma_f32_16x16x32_bf16 v[68:71], a[160:163], v[20:23], 0
  s_waitcnt lgkmcnt(4)
  v_mfma_f32_16x16x32_bf16 v[48:51], a[4:7], v[24:27], v[48:51]
  ds_read_b128 v[16:19], v5 offset:4096
  v_mfma_f32_16x16x32_bf16 v[52:55], a[84:87], v[24:27], v[52:55]
  v_mfma_f32_16x16x32_bf16 v[56:59], a[164:167], v[24:27], v[56:59]
  buffer_load_dwordx4 v2, s[4:7], s18 offen offset:1024 lds
  v_mfma_f32_16x16x32_bf16 v[60:63], a[4:7], v[28:31], v[60:63]
  ds_read_b128 v[20:23], v5 offset:24576
  v_mfma_f32_16x16x32_bf16 v[64:67], a[84:87], v[28:31], v[64:67]
  v_mfma_f32_16x16x32_bf16 v[68:71], a[164:167], v[28:31], v[68:71]
  buffer_load_dwordx4 v[140:143], v2, s[4:7], s52 offen offset:1024 sc1
  s_waitcnt lgkmcnt(4)
  v_mfma_f32_16x16x32_bf16 v[48:51], a[8:11], v[32:35], v[48:51]
  ds_read_b128 v[24:27], v5 offset:5120
  v_mfma_f32_16x16x32_bf16 v[52:55], a[88:91], v[32:35], v[52:55]
  v_mfma_f32_16x16x32_bf16 v[56:59], a[168:171], v[32:35], v[56:59]
  v_mfma_f32_16x16x32_bf16 v[60:63], a[8:11], v[36:39], v[60:63]
  ds_read_b128 v[28:31], v5 offset:25600
  v_mfma_f32_16x16x32_bf16 v[64:67], a[88:91], v[36:39], v[64:67]
  buffer_load_dwordx4 v[144:147], v2, s[4:7], s52 offen offset:2048 sc1
  v_mfma_f32_16x16x32_bf16 v[68:71], a[168:171], v[36:39], v[68:71]
  s_waitcnt lgkmcnt(4)
  v_mfma_f32_16x16x32_bf16 v[48:51], a[12:15], v[40:43], v[48:51]
  ds_read_b128 v[32:35], v5 offset:6144
  v_mfma_f32_16x16x32_bf16 v[52:55], a[92:95], v[40:43], v[52:55]
  v_mfma_f32_16x16x32_bf16 v[56:59], a[172:175], v[40:43], v[56:59]
  buffer_load_dwordx4 v2, s[4:7], s18 offen offset:2048 lds
  v_mfma_f32_16x16x32_bf16 v[60:63], a[12:15], v[44:47], v[60:63]
  ds_read_b128 v[36:39], v5 offset:26624
  v_mfma_f32_16x16x32_bf16 v[64:67], a[92:95], v[44:47], v[64:67]
  v_mfma_f32_16x16x32_bf16 v[68:71], a[172:175], v[44:47], v[68:71]
  buffer_load_dwordx4 v[148:151], v2, s[4:7], s52 offen offset:3072 sc1
  s_waitcnt lgkmcnt(4)
  v_mfma_f32_16x16x32_bf16 v[48:51], a[16:19], v[16:19], v[48:51]
  ds_read_b128 v[40:43], v5 offset:7168
  v_mfma_f32_16x16x32_bf16 v[52:55], a[96:99], v[16:19], v[52:55]
  v_mfma_f32_16x16x32_bf16 v[56:59], a[176:179], v[16:19], v[56:59]
  v_mfma_f32_16x16x32_bf16 v[60:63], a[16:19], v[20:23], v[60:63]
  ds_read_b128 v[44:47], v5 offset:27648
  v_mfma_f32_16x16x32_bf16 v[64:67], a[96:99], v[20:23], v[64:67]
  buffer_load_dwordx2 v[152:153], v2, s[4:7], s54 offen offset:0 sc1
  v_mfma_f32_16x16x32_bf16 v[68:71], a[176:179], v[20:23], v[68:71]
  s_waitcnt lgkmcnt(4)
  v_mfma_f32_16x16x32_bf16 v[48:51], a[20:23], v[24:27], v[48:51]
  ds_read_b128 v[16:19], v5 offset:8192
  v_mfma_f32_16x16x32_bf16 v[52:55], a[100:103], v[24:27], v[52:55]
  buffer_load_dwordx4 v2, s[4:7], s18 offen offset:3072 lds
  v_mfma_f32_16x16x32_bf16 v[56:59], a[180:183], v[24:27], v[56:59]
  v_mfma_f32_16x16x32_bf16 v[60:63], a[20:23], v[28:31], v[60:63]
  ds_read_b128 v[20:23], v5 offset:28672
  v_mfma_f32_16x16x32_bf16 v[64:67], a[100:103], v[28:31], v[64:67]
  v_mfma_f32_16x16x32_bf16 v[68:71], a[180:183], v[28:31], v[68:71]
  buffer_load_dwordx2 v[154:155], v2, s[4:7], s54 offen offset:1024 sc1
  s_waitcnt lgkmcnt(4)
  v_mfma_f32_16x16x32_bf16 v[48:51], a[24:27], v[32:35], v[48:51]
  ds_read_b128 v[24:27], v5 offset:9216
  v_mfma_f32_16x16x32_bf16 v[52:55], a[104:107], v[32:35], v[52:55]
  v_mfma_f32_16x16x32_bf16 v[56:59], a[184:187], v[32:35], v[56:59]
  v_mfma_f32_16x16x32_bf16 v[60:63], a[24:27], v[36:39], v[60:63]
  ds_read_b128 v[28:31], v5 offset:29696
  v_mfma_f32_16x16x32_bf16 v[64:67], a[104:107], v[36:39], v[64:67]
  s_add_u32 m0, s13, 4096
  s_add_u32 s18, s12, 4096
  buffer_load_dwordx4 v2, s[4:7], s18 offen offset:0 lds
  v_mfma_f32_16x16x32_bf16 v[68:71], a[184:187], v[36:39], v[68:71]
  s_waitcnt lgkmcnt(4)
  v_mfma_f32_16x16x32_bf16 v[48:51], a[28:31], v[40:43], v[48:51]
  ds_read_b128 v[32:35], v5 offset:10240
  v_mfma_f32_16x16x32_bf16 v[52:55], a[108:111], v[40:43], v[52:55]
  buffer_load_dwordx2 v[156:157], v2, s[4:7], s54 offen offset:2048 sc1
  v_mfma_f32_16x16x32_bf16 v[56:59], a[188:191], v[40:43], v[56:59]
  v_mfma_f32_16x16x32_bf16 v[60:63], a[28:31], v[44:47], v[60:63]
  ds_read_b128 v[36:39], v5 offset:30720
  v_mfma_f32_16x16x32_bf16 v[64:67], a[108:111], v[44:47], v[64:67]
  v_mfma_f32_16x16x32_bf16 v[68:71], a[188:191], v[44:47], v[68:71]
  buffer_load_dwordx2 v[158:159], v2, s[4:7], s54 offen offset:3072 sc1
  s_waitcnt lgkmcnt(4)
  v_mfma_f32_16x16x32_bf16 v[48:51], a[32:35], v[16:19], v[48:51]
  ds_read_b128 v[40:43], v5 offset:11264
  v_mfma_f32_16x16x32_bf16 v[52:55], a[112:115], v[16:19], v[52:55]
  v_mfma_f32_16x16x32_bf16 v[56:59], a[192:195], v[16:19], v[56:59]
  v_mfma_f32_16x16x32_bf16 v[60:63], a[32:35], v[20:23], v[60:63]
  ds_read_b128 v[44:47], v5 offset:31744
  v_mfma_f32_16x16x32_bf16 v[64:67], a[112:115], v[20:23], v[64:67]
  buffer_load_dwordx4 v2, s[4:7], s18 offen offset:1024 lds
  v_mfma_f32_16x16x32_bf16 v[68:71], a[192:195], v[20:23], v[68:71]
  s_waitcnt lgkmcnt(4)
  v_mfma_f32_16x16x32_bf16 v[48:51], a[36:39], v[24:27], v[48:51]
  ds_read_b128 v[16:19], v5 offset:12288
  v_mfma_f32_16x16x32_bf16 v[52:55], a[116:119], v[24:27], v[52:55]
  buffer_load_dwordx4 v[160:163], v2, s[4:7], s53 offen offset:0 sc1
  v_mfma_f32_16x16x32_bf16 v[56:59], a[196:199], v[24:27], v[56:59]
  v_mfma_f32_16x16x32_bf16 v[60:63], a[36:39], v[28:31], v[60:63]
  ds_read_b128 v[20:23], v5 offset:32768
  v_mfma_f32_16x16x32_bf16 v[64:67], a[116:119], v[28:31], v[64:67]
  v_mfma_f32_16x16x32_bf16 v[68:71], a[196:199], v[28:31], v[68:71]
  buffer_load_dwordx4 v[164:167], v2, s[4:7], s53 offen offset:1024 sc1
  s_waitcnt lgkmcnt(4)
  v_mfma_f32_16x16x32_bf16 v[48:51], a[40:43], v[32:35], v[48:51]
  ds_read_b128 v[24:27], v5 offset:13312
  v_mfma_f32_16x16x32_bf16 v[52:55], a[120:123], v[32:35], v[52:55]
  v_mfma_f32_16x16x32_bf16 v[56:59], a[200:203], v[32:35], v[56:59]
  buffer_load_dwordx4 v2, s[4:7], s18 offen offset:2048 lds
  v_mfma_f32_16x16x32_bf16 v[60:63], a[40:43], v[36:39], v[60:63]
  ds_read_b128 v[28:31], v5 offset:33792
  v_mfma_f32_16x16x32_bf16 v[64:67], a[120:123], v[36:39], v[64:67]
  v_mfma_f32_16x16x32_bf16 v[68:71], a[200:203], v[36:39], v[68:71]
  s_waitcnt lgkmcnt(4)
  v_mfma_f32_16x16x32_bf16 v[48:51], a[44:47], v[40:43], v[48:51]
  ds_read_b128 v[32:35], v5 offset:14336
  v_mfma_f32_16x16x32_bf16 v[52:55], a[124:127], v[40:43], v[52:55]
  buffer_load_dwordx4 v[168:171], v2, s[4:7], s53 offen offset:2048 sc1
  v_mfma_f32_16x16x32_bf16 v[56:59], a[204:207], v[40:43], v[56:59]
  v_mfma_f32_16x16x32_bf16 v[60:63], a[44:47], v[44:47], v[60:63]
  ds_read_b128 v[36:39], v5 offset:34816
  v_mfma_f32_16x16x32_bf16 v[64:67], a[124:127], v[44:47], v[64:67]
  v_mfma_f32_16x16x32_bf16 v[68:71], a[204:207], v[44:47], v[68:71]
  buffer_load_dwordx4 v2, s[4:7], s18 offen offset:3072 lds
  s_waitcnt lgkmcnt(4)
  v_mfma_f32_16x16x32_bf16 v[48:51], a[48:51], v[16:19], v[48:51]
  ds_read_b128 v[40:43], v5 offset:15360
  v_mfma_f32_16x16x32_bf16 v[52:55], a[128:131], v[16:19], v[52:55]
  v_mfma_f32_16x16x32_bf16 v[56:59], a[208:211], v[16:19], v[56:59]
  buffer_load_dwordx4 v[172:175], v2, s[4:7], s53 offen offset:3072 sc1
  v_mfma_f32_16x16x32_bf16 v[60:63], a[48:51], v[20:23], v[60:63]
  ds_read_b128 v[44:47], v5 offset:35840
  v_mfma_f32_16x16x32_bf16 v[64:67], a[128:131], v[20:23], v[64:67]
  v_mfma_f32_16x16x32_bf16 v[68:71], a[208:211], v[20:23], v[68:71]
  s_waitcnt lgkmcnt(4)
  v_mfma_f32_16x16x32_bf16 v[48:51], a[52:55], v[24:27], v[48:51]
  ds_read_b128 v[16:19], v5 offset:16384
  v_mfma_f32_16x16x32_bf16 v[52:55], a[132:135], v[24:27], v[52:55]
  buffer_load_dwordx2 v[176:177], v2, s[4:7], s54 offen offset:8 sc1
  v_mfma_f32_16x16x32_bf16 v[56:59], a[212:215], v[24:27], v[56:59]
  v_mfma_f32_16x16x32_bf16 v[60:63], a[52:55], v[28:31], v[60:63]
  ds_read_b128 v[20:23], v5 offset:36864
  v_mfma_f32_16x16x32_bf16 v[64:67], a[132:135], v[28:31], v[64:67]
  s_add_u32 m0, s13, 8192
  s_add_u32 s18, s12, 8192
  buffer_load_dwordx4 v2, s[4:7], s18 offen offset:0 lds
  v_mfma_f32_16x16x32_bf16 v[68:71], a[212:215], v[28:31], v[68:71]
  s_waitcnt lgkmcnt(4)
  v_mfma_f32_16x16x32_bf16 v[48:51], a[56:59], v[32:35], v[48:51]
  ds_read_b128 v[24:27], v5 offset:17408
  v_mfma_f32_16x16x32_bf16 v[52:55], a[136:139], v[32:35], v[52:55]
  v_mfma_f32_16x16x32_bf16 v[56:59], a[216:219], v[32:35], v[56:59]
  buffer_load_dwordx2 v[178:179], v2, s[4:7], s54 offen offset:1032 sc1
  v_mfma_f32_16x16x32_bf16 v[60:63], a[56:59], v[36:39], v[60:63]
  ds_read_b128 v[28:31], v5 offset:37888
  v_mfma_f32_16x16x32_bf16 v[64:67], a[136:139], v[36:39], v[64:67]
  v_mfma_f32_16x16x32_bf16 v[68:71], a[216:219], v[36:39], v[68:71]
  s_waitcnt lgkmcnt(4)
  v_mfma_f32_16x16x32_bf16 v[48:51], a[60:63], v[40:43], v[48:51]
  ds_read_b128 v[32:35], v5 offset:18432
  v_mfma_f32_16x16x32_bf16 v[52:55], a[140:143], v[40:43], v[52:55]
  buffer_load_dwordx2 v[180:181], v2, s[4:7], s54 offen offset:2056 sc1
  v_mfma_f32_16x16x32_bf16 v[56:59], a[220:223], v[40:43], v[56:59]
  v_mfma_f32_16x16x32_bf16 v[60:63], a[60:63], v[44:47], v[60:63]
  ds_read_b128 v[36:39], v5 offset:38912
  v_mfma_f32_16x16x32_bf16 v[64:67], a[140:143], v[44:47], v[64:67]
  buffer_load_dwordx4 v2, s[4:7], s18 offen offset:1024 lds
  v_mfma_f32_16x16x32_bf16 v[68:71], a[220:223], v[44:47], v[68:71]
  s_waitcnt lgkmcnt(4)
  v_mfma_f32_16x16x32_bf16 v[48:51], a[64:67], v[16:19], v[48:51]
  ds_read_b128 v[40:43], v5 offset:19456
  v_mfma_f32_16x16x32_bf16 v[52:55], a[144:147], v[16:19], v[52:55]
  v_mfma_f32_16x16x32_bf16 v[56:59], a[224:227], v[16:19], v[56:59]
  buffer_load_dwordx2 v[182:183], v2, s[4:7], s54 offen offset:3080 sc1
  v_mfma_f32_16x16x32_bf16 v[60:63], a[64:67], v[20:23], v[60:63]
  ds_read_b128 v[44:47], v5 offset:39936
  v_mfma_f32_16x16x32_bf16 v[64:67], a[144:147], v[20:23], v[64:67]
  v_mfma_f32_16x16x32_bf16 v[68:71], a[224:227], v[20:23], v[68:71]
  s_waitcnt lgkmcnt(4)
  v_mfma_f32_16x16x32_bf16 v[48:51], a[68:71], v[24:27], v[48:51]
  v_mfma_f32_16x16x32_bf16 v[52:55], a[148:151], v[24:27], v[52:55]
  v_mfma_f32_16x16x32_bf16 v[56:59], a[228:231], v[24:27], v[56:59]
  v_mfma_f32_16x16x32_bf16 v[60:63], a[68:71], v[28:31], v[60:63]
  v_mfma_f32_16x16x32_bf16 v[64:67], a[148:151], v[28:31], v[64:67]
  v_mfma_f32_16x16x32_bf16 v[68:71], a[228:231], v[28:31], v[68:71]
  s_waitcnt lgkmcnt(2)
  v_mfma_f32_16x16x32_bf16 v[48:51], a[72:75], v[32:35], v[48:51]
  v_mfma_f32_16x16x32_bf16 v[52:55], a[152:155], v[32:35], v[52:55]
  v_mfma_f32_16x16x32_bf16 v[56:59], a[232:235], v[32:35], v[56:59]
  v_mfma_f32_16x16x32_bf16 v[60:63], a[72:75], v[36:39], v[60:63]
  v_mfma_f32_16x16x32_bf16 v[64:67], a[152:155], v[36:39], v[64:67]
  v_mfma_f32_16x16x32_bf16 v[68:71], a[232:235], v[36:39], v[68:71]
  s_waitcnt lgkmcnt(0)
  v_mfma_f32_16x16x32_bf16 v[48:51], a[76:79], v[40:43], v[48:51]
  v_mfma_f32_16x16x32_bf16 v[52:55], a[156:159], v[40:43], v[52:55]
  v_mfma_f32_16x16x32_bf16 v[56:59], a[236:239], v[40:43], v[56:59]
  v_mfma_f32_16x16x32_bf16 v[60:63], a[76:79], v[44:47], v[60:63]
  v_mfma_f32_16x16x32_bf16 v[64:67], a[156:159], v[44:47], v[64:67]
  v_mfma_f32_16x16x32_bf16 v[68:71], a[236:239], v[44:47], v[68:71]
  v_add_u32 v5, s19, v5
  s_sub_u32 s13, s13, s19
  s_sub_u32 s19, 0, s19
  s_add_u32 s12, s12, 40960
  s_add_u32 s24, s24, 1
  v_cvt_pk_bf16_f32 v96, v48, v49
  v_cvt_pk_bf16_f32 v97, v50, v51
  v_cvt_pk_bf16_f32 v98, v52, v53
  v_cvt_pk_bf16_f32 v99, v54, v55
  v_cvt_pk_bf16_f32 v100, v56, v57
  v_cvt_pk_bf16_f32 v101, v58, v59
  ds_write_b128 v3, v[96:99] offset:12288
  ds_write_b64 v4, v[100:101] offset:12288
  v_cvt_pk_bf16_f32 v104, v60, v61
  v_cvt_pk_bf16_f32 v105, v62, v63
  v_cvt_pk_bf16_f32 v106, v64, v65
  v_cvt_pk_bf16_f32 v107, v66, v67
  v_cvt_pk_bf16_f32 v108, v68, v69
  v_cvt_pk_bf16_f32 v109, v70, v71
  ds_write_b128 v3, v[104:107] offset:18432
  ds_write_b64 v4, v[108:109] offset:18432
  s_waitcnt lgkmcnt(0)
  s_barrier
  ds_read_b128 v[232:235], v12 offset:0
  ds_read_b128 v[236:239], v12 offset:1024
  ds_read_b128 v[240:243], v12 offset:2048
  ds_read_b128 v[244:247], v12 offset:3072
  ds_read_b128 v[248:251], v12 offset:4096
  ds_read_b128 v[252:255], v12 offset:5120
  s_branch mega_q_sc
mega_q_last:
  s_add_u32 s52, s26, s20
  s_add_u32 s53, s52, 4096
  s_add_u32 s54, s52, 8192
  s_mov_b32 s30, 0
mega_kernel_pv30:
  buffer_load_dword v86, v84, s[4:7], s71 offen sc1
  s_waitcnt vmcnt(0)
mega_kernel_pv30_t:
  v_cmp_gt_u32 vcc, s60, v86
  s_nop 0
  s_cbranch_vccz mega_kernel_pv30_ok
  s_sleep 2
  s_add_u32 s30, s30, 1
  s_cmp_lt_u32 s30, 262144
  s_cbranch_scc1 mega_kernel_pv30
  s_branch mega_fail
mega_kernel_pv30_ok:
  buffer_load_dwordx4 v[136:139], v2, s[4:7], s52 offen offset:0 sc1
  buffer_load_dwordx4 v[140:143], v2, s[4:7], s52 offen offset:1024 sc1
  buffer_load_dwordx4 v[144:147], v2, s[4:7], s52 offen offset:2048 sc1
  buffer_load_dwordx4 v[148:151], v2, s[4:7], s52 offen offset:3072 sc1
  buffer_load_dwordx2 v[152:153], v2, s[4:7], s54 offen offset:0 sc1
  buffer_load_dwordx2 v[154:155], v2, s[4:7], s54 offen offset:1024 sc1
  buffer_load_dwordx2 v[156:157], v2, s[4:7], s54 offen offset:2048 sc1
  buffer_load_dwordx2 v[158:159], v2, s[4:7], s54 offen offset:3072 sc1
  buffer_load_dwordx4 v[160:163], v2, s[4:7], s53 offen offset:0 sc1
  buffer_load_dwordx4 v[164:167], v2, s[4:7], s53 offen offset:1024 sc1
  buffer_load_dwordx4 v[168:171], v2, s[4:7], s53 offen offset:2048 sc1
  buffer_load_dwordx4 v[172:175], v2, s[4:7], s53 offen offset:3072 sc1
  buffer_load_dwordx2 v[176:177], v2, s[4:7], s54 offen offset:8 sc1
  buffer_load_dwordx2 v[178:179], v2, s[4:7], s54 offen offset:1032 sc1
  buffer_load_dwordx2 v[180:181], v2, s[4:7], s54 offen offset:2056 sc1
  buffer_load_dwordx2 v[182:183], v2, s[4:7], s54 offen offset:3080 sc1
  v_add_u32 v87, 12288, v84
  s_mov_b32 s63, 64
  s_mov_b32 s30, 0
mega_kernel_pv31:
  buffer_load_dword v86, v87, s[4:7], s71 offen sc1
  s_waitcnt vmcnt(0)
mega_kernel_pv31_t:
  v_cmp_gt_u32 vcc, s63, v86
  s_nop 0
  s_cbranch_vccz mega_kernel_pv31_ok
  s_sleep 2
  s_add_u32 s30, s30, 1
  s_cmp_lt_u32 s30, 262144
  s_cbranch_scc1 mega_kernel_pv31
  s_branch mega_fail
mega_kernel_pv31_ok:
mega_q_sc:
  s_waitcnt vmcnt(0)
  v_mfma_f32_16x16x32_bf16 v[208:211], v[136:139], v[112:115], 0
  v_mfma_f32_16x16x32_bf16 v[212:215], v[160:163], v[112:115], 0
  v_mfma_f32_16x16x32_bf16 v[208:211], v[140:143], v[116:119], v[208:211]
  v_mfma_f32_16x16x32_bf16 v[212:215], v[164:167], v[116:119], v[212:215]
  v_mfma_f32_16x16x32_bf16 v[208:211], v[144:147], v[120:123], v[208:211]
  v_mfma_f32_16x16x32_bf16 v[212:215], v[168:171], v[120:123], v[212:215]
  v_mfma_f32_16x16x32_bf16 v[208:211], v[148:151], v[124:127], v[208:211]
  v_mfma_f32_16x16x32_bf16 v[212:215], v[172:175], v[124:127], v[212:215]
  v_mfma_f32_16x16x32_bf16 v[208:211], v[152:155], v[128:131], v[208:211]
  v_mfma_f32_16x16x32_bf16 v[212:215], v[176:179], v[128:131], v[212:215]
  v_mfma_f32_16x16x32_bf16 v[208:211], v[156:159], v[132:135], v[208:211]
  v_mfma_f32_16x16x32_bf16 v[212:215], v[180:183], v[132:135], v[212:215]
  s_add_u32 s52, s27, s20
  s_add_u32 s53, s28, s20
  s_mov_b32 s30, 0
mega_kernel_pv32:
  buffer_load_dword v86, v85, s[4:7], s71 offen sc1
  s_waitcnt vmcnt(0)
mega_kernel_pv32_t:
  v_cmp_gt_u32 vcc, s60, v86
  s_nop 0
  s_cbranch_vccz mega_kernel_pv32_ok
  s_sleep 1
  s_add_u32 s30, s30, 1
  s_cmp_lt_u32 s30, 262144
  s_cbranch_scc1 mega_kernel_pv32
  s_branch mega_fail
mega_kernel_pv32_ok:
  buffer_load_dwordx4 v[184:187], v11, s[4:7], s52 offen offset:0 sc1
  buffer_load_dwordx4 v[188:191], v11, s[4:7], s52 offen offset:512 sc1
  buffer_load_dwordx4 v[192:195], v11, s[4:7], s52 offen offset:1024 sc1
  buffer_load_dwordx4 v[196:199], v11, s[4:7], s52 offen offset:1536 sc1
  buffer_load_dwordx2 v[200:201], v8, s[4:7], s52 offen offset:2048 sc1
  buffer_load_dwordx2 v[202:203], v8, s[4:7], s52 offen offset:2304 sc1
  buffer_load_dwordx2 v[204:205], v8, s[4:7], s52 offen offset:2560 sc1
  buffer_load_dwordx2 v[206:207], v8, s[4:7], s52 offen offset:2816 sc1
  s_bitcmp0_b32 s3, 0
  s_cselect_b64 s[56:57], s[32:33], -1
  s_cselect_b64 s[58:59], 0, s[32:33]
  v_cndmask_b32 v208, v13, v208, s[56:57]
  v_cndmask_b32 v212, v13, v212, s[58:59]
  s_cselect_b64 s[56:57], s[34:35], -1
  s_cselect_b64 s[58:59], 0, s[34:35]
  v_cndmask_b32 v209, v13, v209, s[56:57]
  v_cndmask_b32 v213, v13, v213, s[58:59]
  s_cselect_b64 s[56:57], s[36:37], -1
  s_cselect_b64 s[58:59], 0, s[36:37]
  v_cndmask_b32 v210, v13, v210, s[56:57]
  v_cndmask_b32 v214, v13, v214, s[58:59]
  s_cselect_b64 s[56:57], s[38:39], -1
  s_cselect_b64 s[58:59], 0, s[38:39]
  v_cndmask_b32 v211, v13, v211, s[56:57]
  v_cndmask_b32 v215, v13, v215, s[58:59]
  v_max3_f32 v220, v208, v209, v210
  v_max3_f32 v220, v220, v211, v212
  v_max3_f32 v220, v220, v213, v214
  v_max_f32 v220, v220, v215
  s_waitcnt vmcnt(7)
  v_mfma_f32_16x16x32_bf16 v[216:219], v[184:187], v[112:115], 0
  s_waitcnt vmcnt(6)
  v_mfma_f32_16x16x32_bf16 v[216:219], v[188:191], v[116:119], v[216:219]
  s_waitcnt vmcnt(5)
  v_mfma_f32_16x16x32_bf16 v[216:219], v[192:195], v[120:123], v[216:219]
  s_waitcnt vmcnt(4)
  v_mfma_f32_16x16x32_bf16 v[216:219], v[196:199], v[124:127], v[216:219]
  s_waitcnt vmcnt(2)
  v_mfma_f32_16x16x32_bf16 v[216:219], v[200:203], v[128:131], v[216:219]
  s_waitcnt vmcnt(0)
  v_mfma_f32_16x16x32_bf16 v[216:219], v[204:207], v[132:135], v[216:219]
  s_nop 7
  v_cndmask_b32 v216, v13, v216, s[40:41]
  v_cndmask_b32 v217, v13, v217, s[40:41]
  v_cndmask_b32 v218, v13, v218, s[40:41]
  v_cndmask_b32 v219, v13, v219, s[40:41]
  v_max3_f32 v220, v220, v216, v217
  v_max3_f32 v220, v220, v218, v219
  v_mov_b32 v221, v220
  s_nop 1
  v_permlane16_swap_b32 v220, v221
  v_max_f32 v220, v220, v221
  v_mov_b32 v221, v220
  s_nop 1
  v_permlane32_swap_b32 v220, v221
  v_max_f32 v220, v220, v221
  v_mul_f32 v220, s42, v220
  v_fma_f32 v208, v208, s42, -v220
  v_fma_f32 v209, v209, s42, -v220
  v_fma_f32 v210, v210, s42, -v220
  v_fma_f32 v211, v211, s42, -v220
  v_fma_f32 v212, v212, s42, -v220
  v_fma_f32 v213, v213, s42, -v220
  v_fma_f32 v214, v214, s42, -v220
  v_fma_f32 v215, v215, s42, -v220
  v_fma_f32 v216, v216, s42, -v220
  v_fma_f32 v217, v217, s42, -v220
  v_fma_f32 v218, v218, s42, -v220
  v_fma_f32 v219, v219, s42, -v220
  v_exp_f32 v208, v208
  v_exp_f32 v209, v209
  v_exp_f32 v210, v210
  v_exp_f32 v211, v211
  v_exp_f32 v212, v212
  v_exp_f32 v213, v213
  v_exp_f32 v214, v214
  v_exp_f32 v215, v215
  v_exp_f32 v216, v216
  v_exp_f32 v217, v217
  v_exp_f32 v218, v218
  v_exp_f32 v219, v219
  v_cndmask_b32 v216, 0, v216, s[40:41]
  v_cndmask_b32 v217, 0, v217, s[40:41]
  v_cndmask_b32 v218, 0, v218, s[40:41]
  v_cndmask_b32 v219, 0, v219, s[40:41]
  v_add_f32 v220, v208, v209
  v_add_f32 v220, v220, v210
  v_add_f32 v220, v220, v211
  v_add_f32 v220, v220, v212
  v_add_f32 v220, v220, v213
  v_add_f32 v220, v220, v214
  v_add_f32 v220, v220, v215
  v_add_f32 v220, v220, v216
  v_add_f32 v220, v220, v217
  v_add_f32 v220, v220, v218
  v_add_f32 v220, v220, v219
  v_mov_b32 v221, v220
  s_nop 1
  v_permlane16_swap_b32 v220, v221
  v_add_f32 v220, v220, v221
  v_mov_b32 v221, v220
  s_nop 1
  v_permlane32_swap_b32 v220, v221
  v_add_f32 v220, v220, v221
  v_rcp_f32 v220, v220
  s_nop 0
  v_mul_f32 v208, v208, v220
  v_mul_f32 v209, v209, v220
  v_mul_f32 v210, v210, v220
  v_mul_f32 v211, v211, v220
  v_mul_f32 v212, v212, v220
  v_mul_f32 v213, v213, v220
  v_mul_f32 v214, v214, v220
  v_mul_f32 v215, v215, v220
  v_mul_f32 v216, v216, v220
  v_mul_f32 v217, v217, v220
  v_mul_f32 v218, v218, v220
  v_mul_f32 v219, v219, v220
  v_cvt_pk_bf16_f32 v224, v208, v209
  v_cvt_pk_bf16_f32 v225, v210, v211
  v_cvt_pk_bf16_f32 v226, v212, v213
  v_cvt_pk_bf16_f32 v227, v214, v215
  v_cvt_pk_bf16_f32 v228, v216, v217
  v_cvt_pk_bf16_f32 v229, v218, v219
  buffer_store_dwordx4 v[224:227], v14, s[4:7], s53 offen
  s_mov_b64 exec, s[40:41]
  buffer_store_dwordx2 v[228:229], v15, s[4:7], s53 offen
  s_mov_b64 exec, -1
  s_add_u32 s20, s20, 651264
  s_cmp_ge_u32 s20, 1302528
  s_cselect_b32 s30, 1302528, 0
  s_sub_u32 s20, s20, s30
  s_add_u32 s61, s60, 1
  s_add_u32 s60, s60, 2
  s_add_u32 s62, s62, 2
  s_waitcnt vmcnt(0)
  v_mov_b32 v220, s61
  s_mov_b64 exec, 1
  s_cmp_lg_u32 s69, 0
  s_cbranch_scc1 mega_kernel_pf33
  buffer_store_dword v220, v7, s[4:7], s50 offen
mega_kernel_pf33_b:
  s_mov_b64 exec, -1
  s_cmp_lt_u32 s62, 64
  s_cbranch_scc1 mega_q_loop
  s_branch mega_bl
mega_kernel_cf1:
  s_cmp_lg_u32 s3, 0
  s_cbranch_scc1 mega_kernel_cf1_b
  s_mul_i32 s28, s69, 31
  s_cmp_eq_u32 s27, s28
  s_cselect_b32 s27, 0, 256
  s_lshl_b32 s27, s27, s68
  s_add_u32 s27, s27, 1
  s_mov_b64 exec, 1
  v_mov_b32 v12, s27
  s_nop 0
  v_readfirstlane_b32 s28, v12
  v_mov_b32 v13, 32
  buffer_atomic_add v12, v13, s[44:47], 0 offen sc0 sc1
  s_waitcnt vmcnt(0)
  v_add_u32 v12, s28, v12
  s_nop 0
  v_readfirstlane_b32 s28, v12
  s_nop 0
  s_and_b32 s28, s28, 255
  s_cmp_eq_u32 s28, 8
  s_cbranch_scc0 mega_kernel_la2
  buffer_store_dword v12, v13, s[44:47], 0 offen offset:96 sc1
  s_waitcnt vmcnt(0)
mega_kernel_la2:
  s_mov_b64 exec, -1
  s_branch mega_kernel_cf1_b
mega_kernel_cf3:
  s_cmp_lg_u32 s3, 0
  s_cbranch_scc1 mega_kernel_cf3_b
  s_mul_i32 s28, s69, 31
  s_cmp_eq_u32 s27, s28
  s_cselect_b32 s27, 0, 256
  s_lshl_b32 s27, s27, s68
  s_add_u32 s27, s27, 1
  s_mov_b64 exec, 1
  v_mov_b32 v12, s27
  s_nop 0
  v_readfirstlane_b32 s28, v12
  v_mov_b32 v13, 32
  buffer_atomic_add v12, v13, s[44:47], 0 offen sc0 sc1
  s_waitcnt vmcnt(0)
  v_add_u32 v12, s28, v12
  s_nop 0
  v_readfirstlane_b32 s28, v12
  s_nop 0
  s_and_b32 s28, s28, 255
  s_cmp_eq_u32 s28, 8
  s_cbranch_scc0 mega_kernel_la4
  buffer_store_dword v12, v13, s[44:47], 0 offen offset:96 sc1
  s_waitcnt vmcnt(0)
mega_kernel_la4:
  s_mov_b64 exec, -1
  s_branch mega_kernel_cf3_b
mega_kernel_pf7:
  buffer_wbl2 sc1
  s_waitcnt vmcnt(0)
  buffer_store_dword v8, v7, s[4:7], s25 offen sc1
  s_branch mega_kernel_pf7_b
mega_kernel_pf10:
  buffer_store_dword v8, v7, s[4:7], s51 offen sc1
  s_branch mega_kernel_pf10_b
mega_kernel_pf11:
  buffer_wbl2 sc1
  s_waitcnt vmcnt(0)
  buffer_store_dword v8, v7, s[4:7], s25 offen sc1
  s_branch mega_kernel_pf11_b
mega_kernel_pf13:
  buffer_store_dword v8, v7, s[4:7], s51 offen sc1
  s_branch mega_kernel_pf13_b
mega_kernel_pf15:
  buffer_wbl2 sc1
  s_waitcnt vmcnt(0)
  buffer_store_dword v8, v7, s[4:7], s25 offen sc1
  s_branch mega_kernel_pf15_b
mega_kernel_cf17:
  s_cmp_lg_u32 s3, 0
  s_cbranch_scc1 mega_kernel_cf17_b
  s_mul_i32 s28, s69, 31
  s_cmp_eq_u32 s27, s28
  s_cselect_b32 s27, 0, 256
  s_lshl_b32 s27, s27, s68
  s_add_u32 s27, s27, 1
  s_mov_b64 exec, 1
  v_mov_b32 v12, s27
  s_nop 0
  v_readfirstlane_b32 s28, v12
  v_mov_b32 v13, 32
  buffer_atomic_add v12, v13, s[44:47], 0 offen sc0 sc1
  s_waitcnt vmcnt(0)
  v_add_u32 v12, s28, v12
  s_nop 0
  v_readfirstlane_b32 s28, v12
  s_nop 0
  s_and_b32 s28, s28, 255
  s_cmp_eq_u32 s28, 8
  s_cbranch_scc0 mega_kernel_la18
  buffer_store_dword v12, v13, s[44:47], 0 offen offset:96 sc1
  s_waitcnt vmcnt(0)
mega_kernel_la18:
  s_mov_b64 exec, -1
  s_branch mega_kernel_cf17_b
mega_kernel_pf22:
  buffer_wbl2 sc1
  s_waitcnt vmcnt(0)
  buffer_store_dword v8, v7, s[4:7], s21 offen sc1
  s_branch mega_kernel_pf22_b
mega_kernel_cf23:
  s_cmp_lg_u32 s3, 0
  s_cbranch_scc1 mega_kernel_cf23_b
  s_mul_i32 s28, s69, 31
  s_cmp_eq_u32 s27, s28
  s_cselect_b32 s27, 0, 256
  s_lshl_b32 s27, s27, s68
  s_add_u32 s27, s27, 1
  s_mov_b64 exec, 1
  v_mov_b32 v12, s27
  s_nop 0
  v_readfirstlane_b32 s28, v12
  v_mov_b32 v13, 32
  buffer_atomic_add v12, v13, s[44:47], 0 offen sc0 sc1
  s_waitcnt vmcnt(0)
  v_add_u32 v12, s28, v12
  s_nop 0
  v_readfirstlane_b32 s28, v12
  s_nop 0
  s_and_b32 s28, s28, 255
  s_cmp_eq_u32 s28, 8
  s_cbranch_scc0 mega_kernel_la24
  buffer_store_dword v12, v13, s[44:47], 0 offen offset:96 sc1
  s_waitcnt vmcnt(0)
mega_kernel_la24:
  s_mov_b64 exec, -1
  s_branch mega_kernel_cf23_b
mega_kernel_pf33:
  buffer_wbl2 sc1
  s_waitcnt vmcnt(0)
  buffer_store_dword v220, v7, s[4:7], s50 offen sc1
  s_branch mega_kernel_pf33_b
mega_bl:
  s_barrier
  s_lshr_b32 s9, s79, 6
  s_lshl_b32 s9, s9, 3
  s_lshr_b32 s8, 0x18001008, s9
  s_and_b32 s8, s8, 31
  s_add_u32 s8, s8, s68
  s_bfe_u32 s9, s79, 0x30003
  s_lshl_b32 s10, s8, 2
  s_add_u32 s10, s10, s3
  v_lshlrev_b32 v2, 4, v1
  v_add_u32 v3, 61440, v2
  v_and_b32 v4, 15, v1
  v_lshrrev_b32 v5, 4, v1
  s_lshl_b32 s13, s3, 13
  s_min_u32 s13, s13, 22528
  s_mul_i32 s12, s9, 307200
  s_add_u32 s12, s12, s13
  s_add_u32 s12, s12, 79888384
  s_mul_i32 s14, s9, 102400
  s_add_u32 s14, s14, 82345984
  s_add_u32 m0, s13, 0
  s_add_u32 s15, s12, 0
  buffer_load_dwordx4 v2, s[4:7], s15 offen offset:0 lds
  buffer_load_dwordx4 v2, s[4:7], s15 offen offset:1024 lds
  buffer_load_dwordx4 v2, s[4:7], s15 offen offset:2048 lds
  buffer_load_dwordx4 v2, s[4:7], s15 offen offset:3072 lds
  s_add_u32 m0, s13, 4096
  s_add_u32 s15, s12, 4096
  buffer_load_dwordx4 v2, s[4:7], s15 offen offset:0 lds
  buffer_load_dwordx4 v2, s[4:7], s15 offen offset:1024 lds
  buffer_load_dwordx4 v2, s[4:7], s15 offen offset:2048 lds
  buffer_load_dwordx4 v2, s[4:7], s15 offen offset:3072 lds
  s_add_u32 s12, s12, 30720
  s_add_u32 m0, s13, 30720
  s_add_u32 s15, s12, 0
  buffer_load_dwordx4 v2, s[4:7], s15 offen offset:0 lds
  buffer_load_dwordx4 v2, s[4:7], s15 offen offset:1024 lds
  buffer_load_dwordx4 v2, s[4:7], s15 offen offset:2048 lds
  buffer_load_dwordx4 v2, s[4:7], s15 offen offset:3072 lds
  s_add_u32 m0, s13, 34816
  s_add_u32 s15, s12, 4096
  buffer_load_dwordx4 v2, s[4:7], s15 offen offset:0 lds
  buffer_load_dwordx4 v2, s[4:7], s15 offen offset:1024 lds
  buffer_load_dwordx4 v2, s[4:7], s15 offen offset:2048 lds
  buffer_load_dwordx4 v2, s[4:7], s15 offen offset:3072 lds
  s_add_u32 s12, s12, 30720
  s_add_u32 m0, s13, 61440
  s_add_u32 s15, s12, 0
  buffer_load_dwordx4 v2, s[4:7], s15 offen offset:0 lds
  buffer_load_dwordx4 v2, s[4:7], s15 offen offset:1024 lds
  buffer_load_dwordx4 v2, s[4:7], s15 offen offset:2048 lds
  buffer_load_dwordx4 v2, s[4:7], s15 offen offset:3072 lds
  s_add_u32 m0, s13, 65536
  s_add_u32 s15, s12, 4096
  buffer_load_dwordx4 v2, s[4:7], s15 offen offset:0 lds
  buffer_load_dwordx4 v2, s[4:7], s15 offen offset:1024 lds
  buffer_load_dwordx4 v2, s[4:7], s15 offen offset:2048 lds
  buffer_load_dwordx4 v2, s[4:7], s15 offen offset:3072 lds
  s_add_u32 s12, s12, 30720
  s_mul_i32 s15, s3, 10240
  s_add_u32 s13, s15, 92160
  s_add_u32 s15, s15, s14
  s_add_u32 s15, s15, 61440
  s_add_u32 m0, s13, 0
  s_add_u32 s18, s15, 0
  buffer_load_dwordx4 v2, s[4:7], s18 offen offset:0 lds
  buffer_load_dwordx4 v2, s[4:7], s18 offen offset:1024 lds
  buffer_load_dwordx4 v2, s[4:7], s18 offen offset:2048 lds
  buffer_load_dwordx4 v2, s[4:7], s18 offen offset:3072 lds
  s_add_u32 m0, s13, 4096
  s_add_u32 s18, s15, 4096
  buffer_load_dwordx4 v2, s[4:7], s18 offen offset:0 lds
  buffer_load_dwordx4 v2, s[4:7], s18 offen offset:1024 lds
  buffer_load_dwordx4 v2, s[4:7], s18 offen offset:2048 lds
  buffer_load_dwordx4 v2, s[4:7], s18 offen offset:3072 lds
  s_add_u32 m0, s13, 8192
  s_add_u32 s18, s15, 8192
  buffer_load_dwordx4 v2, s[4:7], s18 offen offset:0 lds
  buffer_load_dwordx4 v2, s[4:7], s18 offen offset:1024 lds
mega_blmain:
  s_load_dwordx2 s[24:25], s[0:1], 88
  s_mov_b32 s26, 0x280000
  s_mov_b32 s27, 0x20000
  s_lshr_b32 s9, s79, 6
  s_lshl_b32 s9, s9, 3
  s_lshr_b32 s8, 0x18001008, s9
  s_and_b32 s8, s8, 31
  s_add_u32 s8, s8, s68
  s_bfe_u32 s9, s79, 0x30003
  s_lshl_b32 s10, s8, 2
  s_add_u32 s10, s10, s3
  v_lshlrev_b32 v2, 4, v1
  v_add_u32 v3, 61440, v2
  v_and_b32 v4, 15, v1
  v_lshrrev_b32 v5, 4, v1
  s_lshl_b32 s13, s3, 13
  s_min_u32 s13, s13, 22528
  s_mul_i32 s12, s9, 307200
  s_add_u32 s12, s12, s13
  s_add_u32 s12, s12, 79888384
  s_mul_i32 s14, s9, 102400
  s_add_u32 s14, s14, 82345984
  s_add_u32 s12, s12, 92160
  s_mul_i32 s22, s70, 2621440
  s_mul_i32 s11, s10, 20480
  s_add_u32 s23, s11, s22
  s_add_u32 s19, s23, 28327936
  s_lshl_b32 s17, s8, 3
  s_add_u32 s17, s17, s9
  s_lshl_b32 s17, s17, 7
  s_lshl_b32 s15, s3, 2
  s_add_u32 s17, s17, s15
  s_add_u32 s17, s17, s71
  s_add_u32 s17, s17, 49152
  v_mov_b32 v14, 1
  v_mov_b32 v15, 0x40000000
  v_cmp_eq_u32 vcc, 0, v1
  s_nop 1
  v_cndmask_b32 v15, v15, 0, vcc
  s_mov_b32 s31, 0x3fb8aa3b
  s_mov_b32 s29, 0xffff0000
  v_min_u32 v6, 19, v1
  s_and_b32 s15, s10, 1
  s_mul_i32 s15, s15, 20
  v_add_u32 v6, s15, v6
  v_lshlrev_b32 v6, 7, v6
  v_add_u32 v6, 40960, v6
  s_lshr_b32 s15, s10, 1
  s_add_u32 s15, s15, 1
  s_mov_b32 s30, 0
mega_kernel_pg34:
  buffer_load_dword v8, v6, s[4:7], s71 offen offset:0 sc1
  s_waitcnt vmcnt(0)
  v_cmp_gt_u32 vcc, s15, v8
  s_nop 0
  s_cbranch_vccz mega_kernel_pg34_ok
  s_sleep 1
  s_add_u32 s30, s30, 1
  s_cmp_lt_u32 s30, 262144
  s_cbranch_scc1 mega_kernel_pg34
  s_branch mega_fail
mega_kernel_pg34_ok:
  s_mul_i32 s15, s70, 327680
  s_mul_i32 s16, s10, 2560
  s_add_u32 s15, s15, s16
  s_add_u32 s15, s15, 41435136
  v_mul_u32_u24 v6, 640, v5
  v_lshl_add_u32 v6, v4, 3, v6
  buffer_load_dwordx2 v[48:49], v6, s[4:7], s15 offen offset:0 sc1
  buffer_load_dwordx2 v[50:51], v6, s[4:7], s15 offen offset:128 sc1
  buffer_load_dwordx2 v[52:53], v6, s[4:7], s15 offen offset:256 sc1
  buffer_load_dwordx2 v[54:55], v6, s[4:7], s15 offen offset:384 sc1
  buffer_load_dwordx2 v[56:57], v6, s[4:7], s15 offen offset:512 sc1
  s_add_u32 s18, s19, 0
  buffer_load_dwordx4 v[16:19], v2, s[4:7], s18 offen offset:0 sc1
  buffer_load_dwordx4 v[20:23], v2, s[4:7], s18 offen offset:1024 sc1
  buffer_load_dwordx4 v[24:27], v2, s[4:7], s18 offen offset:2048 sc1
  buffer_load_dwordx4 v[28:31], v2, s[4:7], s18 offen offset:3072 sc1
  s_add_u32 s18, s19, 4096
  buffer_load_dwordx4 v[32:35], v2, s[4:7], s18 offen offset:0 sc1
  buffer_load_dwordx4 v[36:39], v2, s[4:7], s18 offen offset:1024 sc1
  buffer_load_dwordx4 v[40:43], v2, s[4:7], s18 offen offset:2048 sc1
  buffer_load_dwordx4 v[44:47], v2, s[4:7], s18 offen offset:3072 sc1
  s_waitcnt vmcnt(8)
  v_add_f32 v9, v48, v50
  v_add_f32 v9, v9, v52
  v_add_f32 v9, v9, v54
  v_add_f32 v9, v9, v56
  v_mov_b32 v10, v9
  s_nop 1
  v_permlane16_swap_b32 v9, v10
  v_add_f32 v9, v9, v10
  v_mov_b32 v10, v9
  s_nop 1
  v_permlane32_swap_b32 v9, v10
  v_add_f32 v9, v9, v10
  v_mul_f32 v9, 0x3d4ccccd, v9
  v_sub_f32 v10, v48, v9
  v_mul_f32 v8, v10, v10
  v_sub_f32 v10, v50, v9
  v_fmac_f32 v8, v10, v10
  v_sub_f32 v10, v52, v9
  v_fmac_f32 v8, v10, v10
  v_sub_f32 v10, v54, v9
  v_fmac_f32 v8, v10, v10
  v_sub_f32 v10, v56, v9
  v_fmac_f32 v8, v10, v10
  v_mul_f32 v8, 0x42000000, v8
  v_add_f32 v8, v8, v49
  v_add_f32 v8, v8, v51
  v_add_f32 v8, v8, v53
  v_add_f32 v8, v8, v55
  v_add_f32 v8, v8, v57
  v_mov_b32 v10, v8
  s_nop 1
  v_permlane16_swap_b32 v8, v10
  v_add_f32 v8, v8, v10
  v_mov_b32 v10, v8
  s_nop 1
  v_permlane32_swap_b32 v8, v10
  v_add_f32 v8, v8, v10
  v_mov_b32 v10, 0x3727c5ac
  v_fmac_f32 v10, 0x3acccccd, v8
  v_rsq_f32 v8, v10
  s_nop 0
  v_mul_f32 v9, v9, v8
  v_sub_f32 v9, 0, v9
  s_waitcnt vmcnt(7)
  v_lshlrev_b32 v10, 16, v16
  v_and_b32 v11, s29, v16
  v_fma_f32 v10, v10, v8, v9
  v_fma_f32 v11, v11, v8, v9
  v_cvt_pk_bf16_f32 v16, v10, v11
  v_lshlrev_b32 v12, 16, v17
  v_and_b32 v13, s29, v17
  v_fma_f32 v12, v12, v8, v9
  v_fma_f32 v13, v13, v8, v9
  v_cvt_pk_bf16_f32 v17, v12, v13
  v_lshlrev_b32 v10, 16, v18
  v_and_b32 v11, s29, v18
  v_fma_f32 v10, v10, v8, v9
  v_fma_f32 v11, v11, v8, v9
  v_cvt_pk_bf16_f32 v18, v10, v11
  v_lshlrev_b32 v12, 16, v19
  v_and_b32 v13, s29, v19
  v_fma_f32 v12, v12, v8, v9
  v_fma_f32 v13, v13, v8, v9
  v_cvt_pk_bf16_f32 v19, v12, v13
  s_barrier
  ds_read_b128 v[48:51], v2 offset:0
  ds_read_b128 v[52:55], v2 offset:1024
  ds_read_b128 v[56:59], v2 offset:2048
  ds_read_b128 v[60:63], v2 offset:3072
  ds_read_b128 v[64:67], v2 offset:4096
  s_waitcnt vmcnt(6)
  s_waitcnt lgkmcnt(3)
  v_mfma_f32_16x16x32_bf16 v[72:75], v[48:51], v[16:19], 0
  ds_read_b128 v[68:71], v2 offset:5120
  v_lshlrev_b32 v10, 16, v20
  v_and_b32 v11, s29, v20
  v_mfma_f32_16x16x32_bf16 v[76:79], v[52:55], v[16:19], 0
  ds_read_b128 v[48:51], v2 offset:6144
  v_fma_f32 v10, v10, v8, v9
  v_fma_f32 v11, v11, v8, v9
  s_waitcnt lgkmcnt(3)
  v_mfma_f32_16x16x32_bf16 v[80:83], v[56:59], v[16:19], 0
  ds_read_b128 v[52:55], v2 offset:7168
  v_cvt_pk_bf16_f32 v20, v10, v11
  v_lshlrev_b32 v12, 16, v21
  v_mfma_f32_16x16x32_bf16 v[84:87], v[60:63], v[16:19], 0
  ds_read_b128 v[56:59], v2 offset:8192
  v_and_b32 v13, s29, v21
  v_fma_f32 v12, v12, v8, v9
  s_waitcnt lgkmcnt(3)
  v_mfma_f32_16x16x32_bf16 v[88:91], v[64:67], v[16:19], 0
  ds_read_b128 v[60:63], v2 offset:9216
  v_fma_f32 v13, v13, v8, v9
  v_cvt_pk_bf16_f32 v21, v12, v13
  v_mfma_f32_16x16x32_bf16 v[92:95], v[68:71], v[16:19], 0
  ds_read_b128 v[64:67], v2 offset:10240
  v_lshlrev_b32 v10, 16, v22
  v_and_b32 v11, s29, v22
  s_waitcnt lgkmcnt(3)
  v_mfma_f32_16x16x32_bf16 v[96:99], v[48:51], v[16:19], 0
  ds_read_b128 v[68:71], v2 offset:11264
  v_fma_f32 v10, v10, v8, v9
  v_fma_f32 v11, v11, v8, v9
  v_mfma_f32_16x16x32_bf16 v[100:103], v[52:55], v[16:19], 0
  ds_read_b128 v[48:51], v2 offset:12288
  v_cvt_pk_bf16_f32 v22, v10, v11
  v_lshlrev_b32 v12, 16, v23
  s_waitcnt lgkmcnt(3)
  v_mfma_f32_16x16x32_bf16 v[104:107], v[56:59], v[16:19], 0
  ds_read_b128 v[52:55], v2 offset:13312
  v_and_b32 v13, s29, v23
  v_fma_f32 v12, v12, v8, v9
  v_mfma_f32_16x16x32_bf16 v[108:111], v[60:63], v[16:19], 0
  ds_read_b128 v[56:59], v2 offset:14336
  v_fma_f32 v13, v13, v8, v9
  v_cvt_pk_bf16_f32 v23, v12, v13
  s_waitcnt lgkmcnt(3)
  v_mfma_f32_16x16x32_bf16 v[112:115], v[16:19], v[64:67], 0
  ds_read_b128 v[60:63], v2 offset:15360
  v_mfma_f32_16x16x32_bf16 v[116:119], v[16:19], v[68:71], 0
  ds_read_b128 v[64:67], v2 offset:16384
  s_waitcnt lgkmcnt(3)
  v_mfma_f32_16x16x32_bf16 v[120:123], v[16:19], v[48:51], 0
  ds_read_b128 v[68:71], v2 offset:17408
  v_mfma_f32_16x16x32_bf16 v[124:127], v[16:19], v[52:55], 0
  ds_read_b128 v[48:51], v2 offset:18432
  s_waitcnt lgkmcnt(3)
  v_mfma_f32_16x16x32_bf16 v[128:131], v[16:19], v[56:59], 0
  ds_read_b128 v[52:55], v2 offset:19456
  s_waitcnt vmcnt(5)
  v_mfma_f32_16x16x32_bf16 v[72:75], v[60:63], v[20:23], v[72:75]
  ds_read_b128 v[56:59], v2 offset:20480
  s_add_u32 s18, s19, 8192
  buffer_load_dwordx4 v[16:19], v2, s[4:7], s18 offen offset:0 sc1
  s_waitcnt lgkmcnt(3)
  v_mfma_f32_16x16x32_bf16 v[76:79], v[64:67], v[20:23], v[76:79]
  ds_read_b128 v[60:63], v2 offset:21504
  v_lshlrev_b32 v10, 16, v24
  v_and_b32 v11, s29, v24
  v_mfma_f32_16x16x32_bf16 v[80:83], v[68:71], v[20:23], v[80:83]
  ds_read_b128 v[64:67], v2 offset:22528
  v_fma_f32 v10, v10, v8, v9
  v_fma_f32 v11, v11, v8, v9
  s_waitcnt lgkmcnt(3)
  v_mfma_f32_16x16x32_bf16 v[84:87], v[48:51], v[20:23], v[84:87]
  ds_read_b128 v[68:71], v2 offset:23552
  v_cvt_pk_bf16_f32 v24, v10, v11
  v_lshlrev_b32 v12, 16, v25
  v_mfma_f32_16x16x32_bf16 v[88:91], v[52:55], v[20:23], v[88:91]
  ds_read_b128 v[48:51], v2 offset:24576
  v_and_b32 v13, s29, v25
  v_fma_f32 v12, v12, v8, v9
  s_waitcnt lgkmcnt(3)
  v_mfma_f32_16x16x32_bf16 v[92:95], v[56:59], v[20:23], v[92:95]
  ds_read_b128 v[52:55], v2 offset:25600
  v_fma_f32 v13, v13, v8, v9
  v_cvt_pk_bf16_f32 v25, v12, v13
  v_mfma_f32_16x16x32_bf16 v[96:99], v[60:63], v[20:23], v[96:99]
  ds_read_b128 v[56:59], v2 offset:26624
  v_lshlrev_b32 v10, 16, v26
  v_and_b32 v11, s29, v26
  s_waitcnt lgkmcnt(3)
  v_mfma_f32_16x16x32_bf16 v[100:103], v[64:67], v[20:23], v[100:103]
  ds_read_b128 v[60:63], v2 offset:27648
  v_fma_f32 v10, v10, v8, v9
  v_fma_f32 v11, v11, v8, v9
  v_mfma_f32_16x16x32_bf16 v[104:107], v[68:71], v[20:23], v[104:107]
  ds_read_b128 v[64:67], v2 offset:28672
  v_cvt_pk_bf16_f32 v26, v10, v11
  v_lshlrev_b32 v12, 16, v27
  s_waitcnt lgkmcnt(3)
  v_mfma_f32_16x16x32_bf16 v[108:111], v[48:51], v[20:23], v[108:111]
  ds_read_b128 v[68:71], v2 offset:29696
  v_and_b32 v13, s29, v27
  v_fma_f32 v12, v12, v8, v9
  v_mfma_f32_16x16x32_bf16 v[112:115], v[20:23], v[52:55], v[112:115]
  v_fma_f32 v13, v13, v8, v9
  v_cvt_pk_bf16_f32 v27, v12, v13
  s_waitcnt lgkmcnt(2)
  v_mfma_f32_16x16x32_bf16 v[116:119], v[20:23], v[56:59], v[116:119]
  v_mfma_f32_16x16x32_bf16 v[120:123], v[20:23], v[60:63], v[120:123]
  s_waitcnt lgkmcnt(0)
  v_mfma_f32_16x16x32_bf16 v[124:127], v[20:23], v[64:67], v[124:127]
  v_mfma_f32_16x16x32_bf16 v[128:131], v[20:23], v[68:71], v[128:131]
  s_barrier
  ds_read_b128 v[48:51], v2 offset:30720
  ds_read_b128 v[52:55], v2 offset:31744
  ds_read_b128 v[56:59], v2 offset:32768
  ds_read_b128 v[60:63], v2 offset:33792
  ds_read_b128 v[64:67], v2 offset:34816
  s_waitcnt vmcnt(5)
  s_waitcnt lgkmcnt(3)
  v_mfma_f32_16x16x32_bf16 v[72:75], v[48:51], v[24:27], v[72:75]
  ds_read_b128 v[68:71], v2 offset:35840
  buffer_load_dwordx4 v[20:23], v2, s[4:7], s18 offen offset:1024 sc1
  v_mfma_f32_16x16x32_bf16 v[76:79], v[52:55], v[24:27], v[76:79]
  ds_read_b128 v[48:51], v2 offset:36864
  v_lshlrev_b32 v10, 16, v28
  v_and_b32 v11, s29, v28
  s_waitcnt lgkmcnt(3)
  v_mfma_f32_16x16x32_bf16 v[80:83], v[56:59], v[24:27], v[80:83]
  ds_read_b128 v[52:55], v2 offset:37888
  v_fma_f32 v10, v10, v8, v9
  v_fma_f32 v11, v11, v8, v9
  v_mfma_f32_16x16x32_bf16 v[84:87], v[60:63], v[24:27], v[84:87]
  ds_read_b128 v[56:59], v2 offset:38912
  s_add_u32 m0, s13, 0
  s_add_u32 s15, s12, 0
  buffer_load_dwordx4 v2, s[4:7], s15 offen offset:0 lds
  s_waitcnt lgkmcnt(3)
  v_mfma_f32_16x16x32_bf16 v[88:91], v[64:67], v[24:27], v[88:91]
  ds_read_b128 v[60:63], v2 offset:39936
  v_cvt_pk_bf16_f32 v28, v10, v11
  v_lshlrev_b32 v12, 16, v29
  v_mfma_f32_16x16x32_bf16 v[92:95], v[68:71], v[24:27], v[92:95]
  ds_read_b128 v[64:67], v2 offset:40960
  v_and_b32 v13, s29, v29
  v_fma_f32 v12, v12, v8, v9
  s_waitcnt lgkmcnt(3)
  v_mfma_f32_16x16x32_bf16 v[96:99], v[48:51], v[24:27], v[96:99]
  ds_read_b128 v[68:71], v2 offset:41984
  buffer_load_dwordx4 v2, s[4:7], s15 offen offset:1024 lds
  v_mfma_f32_16x16x32_bf16 v[100:103], v[52:55], v[24:27], v[100:103]
  ds_read_b128 v[48:51], v2 offset:43008
  v_fma_f32 v13, v13, v8, v9
  v_cvt_pk_bf16_f32 v29, v12, v13
  s_waitcnt lgkmcnt(3)
  v_mfma_f32_16x16x32_bf16 v[104:107], v[56:59], v[24:27], v[104:107]
  ds_read_b128 v[52:55], v2 offset:44032
  v_lshlrev_b32 v10, 16, v30
  v_and_b32 v11, s29, v30
  v_mfma_f32_16x16x32_bf16 v[108:111], v[60:63], v[24:27], v[108:111]
  ds_read_b128 v[56:59], v2 offset:45056
  buffer_load_dwordx4 v2, s[4:7], s15 offen offset:2048 lds
  s_waitcnt lgkmcnt(3)
  v_mfma_f32_16x16x32_bf16 v[112:115], v[24:27], v[64:67], v[112:115]
  ds_read_b128 v[60:63], v2 offset:46080
  v_fma_f32 v10, v10, v8, v9
  v_fma_f32 v11, v11, v8, v9
  v_mfma_f32_16x16x32_bf16 v[116:119], v[24:27], v[68:71], v[116:119]
  ds_read_b128 v[64:67], v2 offset:47104
  v_cvt_pk_bf16_f32 v30, v10, v11
  v_lshlrev_b32 v12, 16, v31
  s_waitcnt lgkmcnt(3)
  v_mfma_f32_16x16x32_bf16 v[120:123], v[24:27], v[48:51], v[120:123]
  ds_read_b128 v[68:71], v2 offset:48128
  buffer_load_dwordx4 v2, s[4:7], s15 offen offset:3072 lds
  v_mfma_f32_16x16x32_bf16 v[124:127], v[24:27], v[52:55], v[124:127]
  ds_read_b128 v[48:51], v2 offset:49152
  v_and_b32 v13, s29, v31
  v_fma_f32 v12, v12, v8, v9
  s_waitcnt lgkmcnt(3)
  v_mfma_f32_16x16x32_bf16 v[128:131], v[24:27], v[56:59], v[128:131]
  ds_read_b128 v[52:55], v2 offset:50176
  v_fma_f32 v13, v13, v8, v9
  v_cvt_pk_bf16_f32 v31, v12, v13
  s_waitcnt vmcnt(9)
  s_nop 0
  v_mfma_f32_16x16x32_bf16 v[72:75], v[60:63], v[28:31], v[72:75]
  ds_read_b128 v[56:59], v2 offset:51200
  buffer_load_dwordx4 v[24:27], v2, s[4:7], s18 offen offset:2048 sc1
  s_waitcnt lgkmcnt(3)
  v_mfma_f32_16x16x32_bf16 v[76:79], v[64:67], v[28:31], v[76:79]
  ds_read_b128 v[60:63], v2 offset:52224
  v_lshlrev_b32 v10, 16, v32
  v_and_b32 v11, s29, v32
  v_mfma_f32_16x16x32_bf16 v[80:83], v[68:71], v[28:31], v[80:83]
  ds_read_b128 v[64:67], v2 offset:53248
  v_fma_f32 v10, v10, v8, v9
  v_fma_f32 v11, v11, v8, v9
  s_waitcnt lgkmcnt(3)
  v_mfma_f32_16x16x32_bf16 v[84:87], v[48:51], v[28:31], v[84:87]
  ds_read_b128 v[68:71], v2 offset:54272
  s_add_u32 m0, s13, 4096
  s_add_u32 s15, s12, 4096
  buffer_load_dwordx4 v2, s[4:7], s15 offen offset:0 lds
  v_mfma_f32_16x16x32_bf16 v[88:91], v[52:55], v[28:31], v[88:91]
  ds_read_b128 v[48:51], v2 offset:55296
  v_cvt_pk_bf16_f32 v32, v10, v11
  v_lshlrev_b32 v12, 16, v33
  s_waitcnt lgkmcnt(3)
  v_mfma_f32_16x16x32_bf16 v[92:95], v[56:59], v[28:31], v[92:95]
  ds_read_b128 v[52:55], v2 offset:56320
  v_and_b32 v13, s29, v33
  v_fma_f32 v12, v12, v8, v9
  v_mfma_f32_16x16x32_bf16 v[96:99], v[60:63], v[28:31], v[96:99]
  ds_read_b128 v[56:59], v2 offset:57344
  buffer_load_dwordx4 v2, s[4:7], s15 offen offset:1024 lds
  s_waitcnt lgkmcnt(3)
  v_mfma_f32_16x16x32_bf16 v[100:103], v[64:67], v[28:31], v[100:103]
  ds_read_b128 v[60:63], v2 offset:58368
  v_fma_f32 v13, v13, v8, v9
  v_cvt_pk_bf16_f32 v33, v12, v13
  v_mfma_f32_16x16x32_bf16 v[104:107], v[68:71], v[28:31], v[104:107]
  ds_read_b128 v[64:67], v2 offset:59392
  v_lshlrev_b32 v10, 16, v34
  v_and_b32 v11, s29, v34
  s_waitcnt lgkmcnt(3)
  v_mfma_f32_16x16x32_bf16 v[108:111], v[48:51], v[28:31], v[108:111]
  ds_read_b128 v[68:71], v2 offset:60416
  buffer_load_dwordx4 v2, s[4:7], s15 offen offset:2048 lds
  v_mfma_f32_16x16x32_bf16 v[112:115], v[28:31], v[52:55], v[112:115]
  v_fma_f32 v10, v10, v8, v9
  v_fma_f32 v11, v11, v8, v9
  s_waitcnt lgkmcnt(2)
  v_mfma_f32_16x16x32_bf16 v[116:119], v[28:31], v[56:59], v[116:119]
  v_cvt_pk_bf16_f32 v34, v10, v11
  v_lshlrev_b32 v12, 16, v35
  v_mfma_f32_16x16x32_bf16 v[120:123], v[28:31], v[60:63], v[120:123]
  buffer_load_dwordx4 v2, s[4:7], s15 offen offset:3072 lds
  s_add_u32 s12, s12, 30720
  s_waitcnt lgkmcnt(0)
  v_mfma_f32_16x16x32_bf16 v[124:127], v[28:31], v[64:67], v[124:127]
  v_and_b32 v13, s29, v35
  v_fma_f32 v12, v12, v8, v9
  v_mfma_f32_16x16x32_bf16 v[128:131], v[28:31], v[68:71], v[128:131]
  v_fma_f32 v13, v13, v8, v9
  v_cvt_pk_bf16_f32 v35, v12, v13
  s_barrier
  ds_read_b128 v[48:51], v3 offset:0
  ds_read_b128 v[52:55], v3 offset:1024
  ds_read_b128 v[56:59], v3 offset:2048
  ds_read_b128 v[60:63], v3 offset:3072
  ds_read_b128 v[64:67], v3 offset:4096
  s_waitcnt vmcnt(13)
  s_waitcnt lgkmcnt(3)
  v_mfma_f32_16x16x32_bf16 v[72:75], v[48:51], v[32:35], v[72:75]
  ds_read_b128 v[68:71], v3 offset:5120
  buffer_load_dwordx4 v[28:31], v2, s[4:7], s18 offen offset:3072 sc1
  v_mfma_f32_16x16x32_bf16 v[76:79], v[52:55], v[32:35], v[76:79]
  ds_read_b128 v[48:51], v3 offset:6144
  v_lshlrev_b32 v10, 16, v36
  v_and_b32 v11, s29, v36
  s_waitcnt lgkmcnt(3)
  v_mfma_f32_16x16x32_bf16 v[80:83], v[56:59], v[32:35], v[80:83]
  ds_read_b128 v[52:55], v3 offset:7168
  v_fma_f32 v10, v10, v8, v9
  v_fma_f32 v11, v11, v8, v9
  v_mfma_f32_16x16x32_bf16 v[84:87], v[60:63], v[32:35], v[84:87]
  ds_read_b128 v[56:59], v3 offset:8192
  s_add_u32 m0, s13, 30720
  s_add_u32 s15, s12, 0
  buffer_load_dwordx4 v2, s[4:7], s15 offen offset:0 lds
  s_waitcnt lgkmcnt(3)
  v_mfma_f32_16x16x32_bf16 v[88:91], v[64:67], v[32:35], v[88:91]
  ds_read_b128 v[60:63], v3 offset:9216
  v_cvt_pk_bf16_f32 v36, v10, v11
  v_lshlrev_b32 v12, 16, v37
  v_mfma_f32_16x16x32_bf16 v[92:95], v[68:71], v[32:35], v[92:95]
  ds_read_b128 v[64:67], v3 offset:10240
  v_and_b32 v13, s29, v37
  v_fma_f32 v12, v12, v8, v9
  s_waitcnt lgkmcnt(3)
  v_mfma_f32_16x16x32_bf16 v[96:99], v[48:51], v[32:35], v[96:99]
  ds_read_b128 v[68:71], v3 offset:11264
  buffer_load_dwordx4 v2, s[4:7], s15 offen offset:1024 lds
  v_mfma_f32_16x16x32_bf16 v[100:103], v[52:55], v[32:35], v[100:103]
  ds_read_b128 v[48:51], v3 offset:12288
  v_fma_f32 v13, v13, v8, v9
  v_cvt_pk_bf16_f32 v37, v12, v13
  s_waitcnt lgkmcnt(3)
  v_mfma_f32_16x16x32_bf16 v[104:107], v[56:59], v[32:35], v[104:107]
  ds_read_b128 v[52:55], v3 offset:13312
  v_lshlrev_b32 v10, 16, v38
  v_and_b32 v11, s29, v38
  v_mfma_f32_16x16x32_bf16 v[108:111], v[60:63], v[32:35], v[108:111]
  ds_read_b128 v[56:59], v3 offset:14336
  buffer_load_dwordx4 v2, s[4:7], s15 offen offset:2048 lds
  s_waitcnt lgkmcnt(3)
  v_mfma_f32_16x16x32_bf16 v[112:115], v[32:35], v[64:67], v[112:115]
  ds_read_b128 v[60:63], v3 offset:15360
  v_fma_f32 v10, v10, v8, v9
  v_fma_f32 v11, v11, v8, v9
  v_mfma_f32_16x16x32_bf16 v[116:119], v[32:35], v[68:71], v[116:119]
  ds_read_b128 v[64:67], v3 offset:16384
  v_cvt_pk_bf16_f32 v38, v10, v11
  v_lshlrev_b32 v12, 16, v39
  s_waitcnt lgkmcnt(3)
  v_mfma_f32_16x16x32_bf16 v[120:123], v[32:35], v[48:51], v[120:123]
  ds_read_b128 v[68:71], v3 offset:17408
  buffer_load_dwordx4 v2, s[4:7], s15 offen offset:3072 lds
  v_mfma_f32_16x16x32_bf16 v[124:127], v[32:35], v[52:55], v[124:127]
  ds_read_b128 v[48:51], v3 offset:18432
  v_and_b32 v13, s29, v39
  v_fma_f32 v12, v12, v8, v9
  s_waitcnt lgkmcnt(3)
  v_mfma_f32_16x16x32_bf16 v[128:131], v[32:35], v[56:59], v[128:131]
  ds_read_b128 v[52:55], v3 offset:19456
  v_fma_f32 v13, v13, v8, v9
  v_cvt_pk_bf16_f32 v39, v12, v13
  s_waitcnt vmcnt(17)
  s_nop 0
  v_mfma_f32_16x16x32_bf16 v[72:75], v[60:63], v[36:39], v[72:75]
  ds_read_b128 v[56:59], v3 offset:20480
  s_add_u32 s18, s19, 12288
  buffer_load_dwordx4 v[32:35], v2, s[4:7], s18 offen offset:0 sc1
  s_waitcnt lgkmcnt(3)
  v_mfma_f32_16x16x32_bf16 v[76:79], v[64:67], v[36:39], v[76:79]
  ds_read_b128 v[60:63], v3 offset:21504
  v_lshlrev_b32 v10, 16, v40
  v_and_b32 v11, s29, v40
  v_mfma_f32_16x16x32_bf16 v[80:83], v[68:71], v[36:39], v[80:83]
  ds_read_b128 v[64:67], v3 offset:22528
  v_fma_f32 v10, v10, v8, v9
  v_fma_f32 v11, v11, v8, v9
  s_waitcnt lgkmcnt(3)
  v_mfma_f32_16x16x32_bf16 v[84:87], v[48:51], v[36:39], v[84:87]
  ds_read_b128 v[68:71], v3 offset:23552
  s_add_u32 m0, s13, 34816
  s_add_u32 s15, s12, 4096
  buffer_load_dwordx4 v2, s[4:7], s15 offen offset:0 lds
  v_mfma_f32_16x16x32_bf16 v[88:91], v[52:55], v[36:39], v[88:91]
  ds_read_b128 v[48:51], v3 offset:24576
  v_cvt_pk_bf16_f32 v40, v10, v11
  v_lshlrev_b32 v12, 16, v41
  s_waitcnt lgkmcnt(3)
  v_mfma_f32_16x16x32_bf16 v[92:95], v[56:59], v[36:39], v[92:95]
  ds_read_b128 v[52:55], v3 offset:25600
  v_and_b32 v13, s29, v41
  v_fma_f32 v12, v12, v8, v9
  v_mfma_f32_16x16x32_bf16 v[96:99], v[60:63], v[36:39], v[96:99]
  ds_read_b128 v[56:59], v3 offset:26624
  buffer_load_dwordx4 v2, s[4:7], s15 offen offset:1024 lds
  s_waitcnt lgkmcnt(3)
  v_mfma_f32_16x16x32_bf16 v[100:103], v[64:67], v[36:39], v[100:103]
  ds_read_b128 v[60:63], v3 offset:27648
  v_fma_f32 v13, v13, v8, v9
  v_cvt_pk_bf16_f32 v41, v12, v13
  v_mfma_f32_16x16x32_bf16 v[104:107], v[68:71], v[36:39], v[104:107]
  ds_read_b128 v[64:67], v3 offset:28672
  v_lshlrev_b32 v10, 16, v42
  v_and_b32 v11, s29, v42
  s_waitcnt lgkmcnt(3)
  v_mfma_f32_16x16x32_bf16 v[108:111], v[48:51], v[36:39], v[108:111]
  ds_read_b128 v[68:71], v3 offset:29696
  buffer_load_dwordx4 v2, s[4:7], s15 offen offset:2048 lds
  v_mfma_f32_16x16x32_bf16 v[112:115], v[36:39], v[52:55], v[112:115]
  v_fma_f32 v10, v10, v8, v9
  v_fma_f32 v11, v11, v8, v9
  s_waitcnt lgkmcnt(2)
  v_mfma_f32_16x16x32_bf16 v[116:119], v[36:39], v[56:59], v[116:119]
  v_cvt_pk_bf16_f32 v42, v10, v11
  v_lshlrev_b32 v12, 16, v43
  v_mfma_f32_16x16x32_bf16 v[120:123], v[36:39], v[60:63], v[120:123]
  buffer_load_dwordx4 v2, s[4:7], s15 offen offset:3072 lds
  s_add_u32 s12, s12, 30720
  s_waitcnt lgkmcnt(0)
  v_mfma_f32_16x16x32_bf16 v[124:127], v[36:39], v[64:67], v[124:127]
  v_and_b32 v13, s29, v43
  v_fma_f32 v12, v12, v8, v9
  v_mfma_f32_16x16x32_bf16 v[128:131], v[36:39], v[68:71], v[128:131]
  v_fma_f32 v13, v13, v8, v9
  v_cvt_pk_bf16_f32 v43, v12, v13
  s_waitcnt vmcnt(10)
  s_barrier
  ds_read_b128 v[48:51], v2 offset:0
  ds_read_b128 v[52:55], v2 offset:1024
  ds_read_b128 v[56:59], v2 offset:2048
  ds_read_b128 v[60:63], v2 offset:3072
  ds_read_b128 v[64:67], v2 offset:4096
  s_waitcnt vmcnt(21)
  s_waitcnt lgkmcnt(3)
  v_mfma_f32_16x16x32_bf16 v[72:75], v[48:51], v[40:43], v[72:75]
  ds_read_b128 v[68:71], v2 offset:5120
  buffer_load_dwordx4 v[36:39], v2, s[4:7], s18 offen offset:1024 sc1
  v_mfma_f32_16x16x32_bf16 v[76:79], v[52:55], v[40:43], v[76:79]
  ds_read_b128 v[48:51], v2 offset:6144
  v_lshlrev_b32 v10, 16, v44
  v_and_b32 v11, s29, v44
  s_waitcnt lgkmcnt(3)
  v_mfma_f32_16x16x32_bf16 v[80:83], v[56:59], v[40:43], v[80:83]
  ds_read_b128 v[52:55], v2 offset:7168
  v_fma_f32 v10, v10, v8, v9
  v_fma_f32 v11, v11, v8, v9
  v_mfma_f32_16x16x32_bf16 v[84:87], v[60:63], v[40:43], v[84:87]
  ds_read_b128 v[56:59], v2 offset:8192
  s_add_u32 m0, s13, 61440
  s_add_u32 s15, s12, 0
  buffer_load_dwordx4 v2, s[4:7], s15 offen offset:0 lds
  s_waitcnt lgkmcnt(3)
  v_mfma_f32_16x16x32_bf16 v[88:91], v[64:67], v[40:43], v[88:91]
  ds_read_b128 v[60:63], v2 offset:9216
  v_cvt_pk_bf16_f32 v44, v10, v11
  v_lshlrev_b32 v12, 16, v45
  v_mfma_f32_16x16x32_bf16 v[92:95], v[68:71], v[40:43], v[92:95]
  ds_read_b128 v[64:67], v2 offset:10240
  v_and_b32 v13, s29, v45
  v_fma_f32 v12, v12, v8, v9
  s_waitcnt lgkmcnt(3)
  v_mfma_f32_16x16x32_bf16 v[96:99], v[48:51], v[40:43], v[96:99]
  ds_read_b128 v[68:71], v2 offset:11264
  buffer_load_dwordx4 v2, s[4:7], s15 offen offset:1024 lds
  v_mfma_f32_16x16x32_bf16 v[100:103], v[52:55], v[40:43], v[100:103]
  ds_read_b128 v[48:51], v2 offset:12288
  v_fma_f32 v13, v13, v8, v9
  v_cvt_pk_bf16_f32 v45, v12, v13
  s_waitcnt lgkmcnt(3)
  v_mfma_f32_16x16x32_bf16 v[104:107], v[56:59], v[40:43], v[104:107]
  ds_read_b128 v[52:55], v2 offset:13312
  v_lshlrev_b32 v10, 16, v46
  v_and_b32 v11, s29, v46
  v_mfma_f32_16x16x32_bf16 v[108:111], v[60:63], v[40:43], v[108:111]
  ds_read_b128 v[56:59], v2 offset:14336
  buffer_load_dwordx4 v2, s[4:7], s15 offen offset:2048 lds
  s_waitcnt lgkmcnt(3)
  v_mfma_f32_16x16x32_bf16 v[112:115], v[40:43], v[64:67], v[112:115]
  ds_read_b128 v[60:63], v2 offset:15360
  v_fma_f32 v10, v10, v8, v9
  v_fma_f32 v11, v11, v8, v9
  v_mfma_f32_16x16x32_bf16 v[116:119], v[40:43], v[68:71], v[116:119]
  ds_read_b128 v[64:67], v2 offset:16384
  v_cvt_pk_bf16_f32 v46, v10, v11
  v_lshlrev_b32 v12, 16, v47
  s_waitcnt lgkmcnt(3)
  v_mfma_f32_16x16x32_bf16 v[120:123], v[40:43], v[48:51], v[120:123]
  ds_read_b128 v[68:71], v2 offset:17408
  buffer_load_dwordx4 v2, s[4:7], s15 offen offset:3072 lds
  v_mfma_f32_16x16x32_bf16 v[124:127], v[40:43], v[52:55], v[124:127]
  ds_read_b128 v[48:51], v2 offset:18432
  v_and_b32 v13, s29, v47
  v_fma_f32 v12, v12, v8, v9
  s_waitcnt lgkmcnt(3)
  v_mfma_f32_16x16x32_bf16 v[128:131], v[40:43], v[56:59], v[128:131]
  ds_read_b128 v[52:55], v2 offset:19456
  v_fma_f32 v13, v13, v8, v9
  v_cvt_pk_bf16_f32 v47, v12, v13
  s_waitcnt vmcnt(25)
  s_nop 0
  v_mfma_f32_16x16x32_bf16 v[72:75], v[60:63], v[44:47], v[72:75]
  ds_read_b128 v[56:59], v2 offset:20480
  buffer_load_dwordx4 v[40:43], v2, s[4:7], s18 offen offset:2048 sc1
  s_waitcnt lgkmcnt(3)
  v_mfma_f32_16x16x32_bf16 v[76:79], v[64:67], v[44:47], v[76:79]
  ds_read_b128 v[60:63], v2 offset:21504
  v_lshlrev_b32 v10, 16, v16
  v_and_b32 v11, s29, v16
  v_mfma_f32_16x16x32_bf16 v[80:83], v[68:71], v[44:47], v[80:83]
  ds_read_b128 v[64:67], v2 offset:22528
  v_fma_f32 v10, v10, v8, v9
  v_fma_f32 v11, v11, v8, v9
  s_waitcnt lgkmcnt(3)
  v_mfma_f32_16x16x32_bf16 v[84:87], v[48:51], v[44:47], v[84:87]
  ds_read_b128 v[68:71], v2 offset:23552
  s_add_u32 m0, s13, 65536
  s_add_u32 s15, s12, 4096
  buffer_load_dwordx4 v2, s[4:7], s15 offen offset:0 lds
  v_mfma_f32_16x16x32_bf16 v[88:91], v[52:55], v[44:47], v[88:91]
  ds_read_b128 v[48:51], v2 offset:24576
  v_cvt_pk_bf16_f32 v16, v10, v11
  v_lshlrev_b32 v12, 16, v17
  s_waitcnt lgkmcnt(3)
  v_mfma_f32_16x16x32_bf16 v[92:95], v[56:59], v[44:47], v[92:95]
  ds_read_b128 v[52:55], v2 offset:25600
  v_and_b32 v13, s29, v17
  v_fma_f32 v12, v12, v8, v9
  v_mfma_f32_16x16x32_bf16 v[96:99], v[60:63], v[44:47], v[96:99]
  ds_read_b128 v[56:59], v2 offset:26624
  buffer_load_dwordx4 v2, s[4:7], s15 offen offset:1024 lds
  s_waitcnt lgkmcnt(3)
  v_mfma_f32_16x16x32_bf16 v[100:103], v[64:67], v[44:47], v[100:103]
  ds_read_b128 v[60:63], v2 offset:27648
  v_fma_f32 v13, v13, v8, v9
  v_cvt_pk_bf16_f32 v17, v12, v13
  v_mfma_f32_16x16x32_bf16 v[104:107], v[68:71], v[44:47], v[104:107]
  ds_read_b128 v[64:67], v2 offset:28672
  v_lshlrev_b32 v10, 16, v18
  v_and_b32 v11, s29, v18
  s_waitcnt lgkmcnt(3)
  v_mfma_f32_16x16x32_bf16 v[108:111], v[48:51], v[44:47], v[108:111]
  ds_read_b128 v[68:71], v2 offset:29696
  buffer_load_dwordx4 v2, s[4:7], s15 offen offset:2048 lds
  v_mfma_f32_16x16x32_bf16 v[112:115], v[44:47], v[52:55], v[112:115]
  v_fma_f32 v10, v10, v8, v9
  v_fma_f32 v11, v11, v8, v9
  s_waitcnt lgkmcnt(2)
  v_mfma_f32_16x16x32_bf16 v[116:119], v[44:47], v[56:59], v[116:119]
  v_cvt_pk_bf16_f32 v18, v10, v11
  v_lshlrev_b32 v12, 16, v19
  v_mfma_f32_16x16x32_bf16 v[120:123], v[44:47], v[60:63], v[120:123]
  buffer_load_dwordx4 v2, s[4:7], s15 offen offset:3072 lds
  s_add_u32 s12, s12, 30720
  s_waitcnt lgkmcnt(0)
  v_mfma_f32_16x16x32_bf16 v[124:127], v[44:47], v[64:67], v[124:127]
  v_and_b32 v13, s29, v19
  v_fma_f32 v12, v12, v8, v9
  v_mfma_f32_16x16x32_bf16 v[128:131], v[44:47], v[68:71], v[128:131]
  v_fma_f32 v13, v13, v8, v9
  v_cvt_pk_bf16_f32 v19, v12, v13
  s_waitcnt vmcnt(10)
  s_barrier
  ds_read_b128 v[48:51], v2 offset:30720
  ds_read_b128 v[52:55], v2 offset:31744
  ds_read_b128 v[56:59], v2 offset:32768
  ds_read_b128 v[60:63], v2 offset:33792
  ds_read_b128 v[64:67], v2 offset:34816
  s_waitcnt vmcnt(29)
  s_waitcnt lgkmcnt(3)
  v_mfma_f32_16x16x32_bf16 v[72:75], v[48:51], v[16:19], v[72:75]
  ds_read_b128 v[68:71], v2 offset:35840
  buffer_load_dwordx4 v[44:47], v2, s[4:7], s18 offen offset:3072 sc1
  v_mfma_f32_16x16x32_bf16 v[76:79], v[52:55], v[16:19], v[76:79]
  ds_read_b128 v[48:51], v2 offset:36864
  v_lshlrev_b32 v10, 16, v20
  v_and_b32 v11, s29, v20
  s_waitcnt lgkmcnt(3)
  v_mfma_f32_16x16x32_bf16 v[80:83], v[56:59], v[16:19], v[80:83]
  ds_read_b128 v[52:55], v2 offset:37888
  v_fma_f32 v10, v10, v8, v9
  v_fma_f32 v11, v11, v8, v9
  v_mfma_f32_16x16x32_bf16 v[84:87], v[60:63], v[16:19], v[84:87]
  ds_read_b128 v[56:59], v2 offset:38912
  s_add_u32 m0, s13, 0
  s_add_u32 s15, s12, 0
  buffer_load_dwordx4 v2, s[4:7], s15 offen offset:0 lds
  s_waitcnt lgkmcnt(3)
  v_mfma_f32_16x16x32_bf16 v[88:91], v[64:67], v[16:19], v[88:91]
  ds_read_b128 v[60:63], v2 offset:39936
  v_cvt_pk_bf16_f32 v20, v10, v11
  v_lshlrev_b32 v12, 16, v21
  v_mfma_f32_16x16x32_bf16 v[92:95], v[68:71], v[16:19], v[92:95]
  ds_read_b128 v[64:67], v2 offset:40960
  v_and_b32 v13, s29, v21
  v_fma_f32 v12, v12, v8, v9
  s_waitcnt lgkmcnt(3)
  v_mfma_f32_16x16x32_bf16 v[96:99], v[48:51], v[16:19], v[96:99]
  ds_read_b128 v[68:71], v2 offset:41984
  buffer_load_dwordx4 v2, s[4:7], s15 offen offset:1024 lds
  v_mfma_f32_16x16x32_bf16 v[100:103], v[52:55], v[16:19], v[100:103]
  ds_read_b128 v[48:51], v2 offset:43008
  v_fma_f32 v13, v13, v8, v9
  v_cvt_pk_bf16_f32 v21, v12, v13
  s_waitcnt lgkmcnt(3)
  v_mfma_f32_16x16x32_bf16 v[104:107], v[56:59], v[16:19], v[104:107]
  ds_read_b128 v[52:55], v2 offset:44032
  v_lshlrev_b32 v10, 16, v22
  v_and_b32 v11, s29, v22
  v_mfma_f32_16x16x32_bf16 v[108:111], v[60:63], v[16:19], v[108:111]
  ds_read_b128 v[56:59], v2 offset:45056
  buffer_load_dwordx4 v2, s[4:7], s15 offen offset:2048 lds
  s_waitcnt lgkmcnt(3)
  v_mfma_f32_16x16x32_bf16 v[112:115], v[16:19], v[64:67], v[112:115]
  ds_read_b128 v[60:63], v2 offset:46080
  v_fma_f32 v10, v10, v8, v9
  v_fma_f32 v11, v11, v8, v9
  v_mfma_f32_16x16x32_bf16 v[116:119], v[16:19], v[68:71], v[116:119]
  ds_read_b128 v[64:67], v2 offset:47104
  v_cvt_pk_bf16_f32 v22, v10, v11
  v_lshlrev_b32 v12, 16, v23
  s_waitcnt lgkmcnt(3)
  v_mfma_f32_16x16x32_bf16 v[120:123], v[16:19], v[48:51], v[120:123]
  ds_read_b128 v[68:71], v2 offset:48128
  buffer_load_dwordx4 v2, s[4:7], s15 offen offset:3072 lds
  v_mfma_f32_16x16x32_bf16 v[124:127], v[16:19], v[52:55], v[124:127]
  ds_read_b128 v[48:51], v2 offset:49152
  v_and_b32 v13, s29, v23
  v_fma_f32 v12, v12, v8, v9
  s_waitcnt lgkmcnt(3)
  v_mfma_f32_16x16x32_bf16 v[128:131], v[16:19], v[56:59], v[128:131]
  ds_read_b128 v[52:55], v2 offset:50176
  v_fma_f32 v13, v13, v8, v9
  v_cvt_pk_bf16_f32 v23, v12, v13
  s_waitcnt vmcnt(29)
  s_nop 0
  v_mfma_f32_16x16x32_bf16 v[72:75], v[60:63], v[20:23], v[72:75]
  ds_read_b128 v[56:59], v2 offset:51200
  s_add_u32 s18, s19, 16384
  buffer_load_dwordx4 v[16:19], v2, s[4:7], s18 offen offset:0 sc1
  s_waitcnt lgkmcnt(3)
  v_mfma_f32_16x16x32_bf16 v[76:79], v[64:67], v[20:23], v[76:79]
  ds_read_b128 v[60:63], v2 offset:52224
  v_lshlrev_b32 v10, 16, v24
  v_and_b32 v11, s29, v24
  v_mfma_f32_16x16x32_bf16 v[80:83], v[68:71], v[20:23], v[80:83]
  ds_read_b128 v[64:67], v2 offset:53248
  v_fma_f32 v10, v10, v8, v9
  v_fma_f32 v11, v11, v8, v9
  s_waitcnt lgkmcnt(3)
  v_mfma_f32_16x16x32_bf16 v[84:87], v[48:51], v[20:23], v[84:87]
  ds_read_b128 v[68:71], v2 offset:54272
  s_add_u32 m0, s13, 4096
  s_add_u32 s15, s12, 4096
  buffer_load_dwordx4 v2, s[4:7], s15 offen offset:0 lds
  v_mfma_f32_16x16x32_bf16 v[88:91], v[52:55], v[20:23], v[88:91]
  ds_read_b128 v[48:51], v2 offset:55296
  v_cvt_pk_bf16_f32 v24, v10, v11
  v_lshlrev_b32 v12, 16, v25
  s_waitcnt lgkmcnt(3)
  v_mfma_f32_16x16x32_bf16 v[92:95], v[56:59], v[20:23], v[92:95]
  ds_read_b128 v[52:55], v2 offset:56320
  v_and_b32 v13, s29, v25
  v_fma_f32 v12, v12, v8, v9
  v_mfma_f32_16x16x32_bf16 v[96:99], v[60:63], v[20:23], v[96:99]
  ds_read_b128 v[56:59], v2 offset:57344
  buffer_load_dwordx4 v2, s[4:7], s15 offen offset:1024 lds
  s_waitcnt lgkmcnt(3)
  v_mfma_f32_16x16x32_bf16 v[100:103], v[64:67], v[20:23], v[100:103]
  ds_read_b128 v[60:63], v2 offset:58368
  v_fma_f32 v13, v13, v8, v9
  v_cvt_pk_bf16_f32 v25, v12, v13
  v_mfma_f32_16x16x32_bf16 v[104:107], v[68:71], v[20:23], v[104:107]
  ds_read_b128 v[64:67], v2 offset:59392
  v_lshlrev_b32 v10, 16, v26
  v_and_b32 v11, s29, v26
  s_waitcnt lgkmcnt(3)
  v_mfma_f32_16x16x32_bf16 v[108:111], v[48:51], v[20:23], v[108:111]
  ds_read_b128 v[68:71], v2 offset:60416
  buffer_load_dwordx4 v2, s[4:7], s15 offen offset:2048 lds
  v_mfma_f32_16x16x32_bf16 v[112:115], v[20:23], v[52:55], v[112:115]
  v_fma_f32 v10, v10, v8, v9
  v_fma_f32 v11, v11, v8, v9
  s_waitcnt lgkmcnt(2)
  v_mfma_f32_16x16x32_bf16 v[116:119], v[20:23], v[56:59], v[116:119]
  v_cvt_pk_bf16_f32 v26, v10, v11
  v_lshlrev_b32 v12, 16, v27
  v_mfma_f32_16x16x32_bf16 v[120:123], v[20:23], v[60:63], v[120:123]
  buffer_load_dwordx4 v2, s[4:7], s15 offen offset:3072 lds
  s_add_u32 s12, s12, 30720
  s_waitcnt lgkmcnt(0)
  v_mfma_f32_16x16x32_bf16 v[124:127], v[20:23], v[64:67], v[124:127]
  v_and_b32 v13, s29, v27
  v_fma_f32 v12, v12, v8, v9
  v_mfma_f32_16x16x32_bf16 v[128:131], v[20:23], v[68:71], v[128:131]
  v_fma_f32 v13, v13, v8, v9
  v_cvt_pk_bf16_f32 v27, v12, v13
  s_waitcnt vmcnt(10)
  s_barrier
  ds_read_b128 v[48:51], v3 offset:0
  ds_read_b128 v[52:55], v3 offset:1024
  ds_read_b128 v[56:59], v3 offset:2048
  ds_read_b128 v[60:63], v3 offset:3072
  ds_read_b128 v[64:67], v3 offset:4096
  s_waitcnt vmcnt(29)
  s_waitcnt lgkmcnt(3)
  v_mfma_f32_16x16x32_bf16 v[72:75], v[48:51], v[24:27], v[72:75]
  ds_read_b128 v[68:71], v3 offset:5120
  buffer_load_dwordx4 v[20:23], v2, s[4:7], s18 offen offset:1024 sc1
  v_mfma_f32_16x16x32_bf16 v[76:79], v[52:55], v[24:27], v[76:79]
  ds_read_b128 v[48:51], v3 offset:6144
  v_lshlrev_b32 v10, 16, v28
  v_and_b32 v11, s29, v28
  s_waitcnt lgkmcnt(3)
  v_mfma_f32_16x16x32_bf16 v[80:83], v[56:59], v[24:27], v[80:83]
  ds_read_b128 v[52:55], v3 offset:7168
  v_fma_f32 v10, v10, v8, v9
  v_fma_f32 v11, v11, v8, v9
  v_mfma_f32_16x16x32_bf16 v[84:87], v[60:63], v[24:27], v[84:87]
  ds_read_b128 v[56:59], v3 offset:8192
  s_add_u32 m0, s13, 30720
  s_add_u32 s15, s12, 0
  buffer_load_dwordx4 v2, s[4:7], s15 offen offset:0 lds
  s_waitcnt lgkmcnt(3)
  v_mfma_f32_16x16x32_bf16 v[88:91], v[64:67], v[24:27], v[88:91]
  ds_read_b128 v[60:63], v3 offset:9216
  v_cvt_pk_bf16_f32 v28, v10, v11
  v_lshlrev_b32 v12, 16, v29
  v_mfma_f32_16x16x32_bf16 v[92:95], v[68:71], v[24:27], v[92:95]
  ds_read_b128 v[64:67], v3 offset:10240
  v_and_b32 v13, s29, v29
  v_fma_f32 v12, v12, v8, v9
  s_waitcnt lgkmcnt(3)
  v_mfma_f32_16x16x32_bf16 v[96:99], v[48:51], v[24:27], v[96:99]
  ds_read_b128 v[68:71], v3 offset:11264
  buffer_load_dwordx4 v2, s[4:7], s15 offen offset:1024 lds
  v_mfma_f32_16x16x32_bf16 v[100:103], v[52:55], v[24:27], v[100:103]
  ds_read_b128 v[48:51], v3 offset:12288
  v_fma_f32 v13, v13, v8, v9
  v_cvt_pk_bf16_f32 v29, v12, v13
  s_waitcnt lgkmcnt(3)
  v_mfma_f32_16x16x32_bf16 v[104:107], v[56:59], v[24:27], v[104:107]
  ds_read_b128 v[52:55], v3 offset:13312
  v_lshlrev_b32 v10, 16, v30
  v_and_b32 v11, s29, v30
  v_mfma_f32_16x16x32_bf16 v[108:111], v[60:63], v[24:27], v[108:111]
  ds_read_b128 v[56:59], v3 offset:14336
  buffer_load_dwordx4 v2, s[4:7], s15 offen offset:2048 lds
  s_waitcnt lgkmcnt(3)
  v_mfma_f32_16x16x32_bf16 v[112:115], v[24:27], v[64:67], v[112:115]
  ds_read_b128 v[60:63], v3 offset:15360
  v_fma_f32 v10, v10, v8, v9
  v_fma_f32 v11, v11, v8, v9
  v_mfma_f32_16x16x32_bf16 v[116:119], v[24:27], v[68:71], v[116:119]
  ds_read_b128 v[64:67], v3 offset:16384
  v_cvt_pk_bf16_f32 v30, v10, v11
  v_lshlrev_b32 v12, 16, v31
  s_waitcnt lgkmcnt(3)
  v_mfma_f32_16x16x32_bf16 v[120:123], v[24:27], v[48:51], v[120:123]
  ds_read_b128 v[68:71], v3 offset:17408
  buffer_load_dwordx4 v2, s[4:7], s15 offen offset:3072 lds
  v_mfma_f32_16x16x32_bf16 v[124:127], v[24:27], v[52:55], v[124:127]
  ds_read_b128 v[48:51], v3 offset:18432
  v_and_b32 v13, s29, v31
  v_fma_f32 v12, v12, v8, v9
  s_waitcnt lgkmcnt(3)
  v_mfma_f32_16x16x32_bf16 v[128:131], v[24:27], v[56:59], v[128:131]
  ds_read_b128 v[52:55], v3 offset:19456
  v_fma_f32 v13, v13, v8, v9
  v_cvt_pk_bf16_f32 v31, v12, v13
  s_waitcnt vmcnt(29)
  s_nop 0
  v_mfma_f32_16x16x32_bf16 v[72:75], v[60:63], v[28:31], v[72:75]
  ds_read_b128 v[56:59], v3 offset:20480
  buffer_load_dwordx4 v[24:27], v2, s[4:7], s18 offen offset:2048 sc1
  s_waitcnt lgkmcnt(3)
  v_mfma_f32_16x16x32_bf16 v[76:79], v[64:67], v[28:31], v[76:79]
  ds_read_b128 v[60:63], v3 offset:21504
  v_lshlrev_b32 v10, 16, v32
  v_and_b32 v11, s29, v32
  v_mfma_f32_16x16x32_bf16 v[80:83], v[68:71], v[28:31], v[80:83]
  ds_read_b128 v[64:67], v3 offset:22528
  v_fma_f32 v10, v10, v8, v9
  v_fma_f32 v11, v11, v8, v9
  s_waitcnt lgkmcnt(3)
  v_mfma_f32_16x16x32_bf16 v[84:87], v[48:51], v[28:31], v[84:87]
  ds_read_b128 v[68:71], v3 offset:23552
  s_add_u32 m0, s13, 34816
  s_add_u32 s15, s12, 4096
  buffer_load_dwordx4 v2, s[4:7], s15 offen offset:0 lds
  v_mfma_f32_16x16x32_bf16 v[88:91], v[52:55], v[28:31], v[88:91]
  ds_read_b128 v[48:51], v3 offset:24576
  v_cvt_pk_bf16_f32 v32, v10, v11
  v_lshlrev_b32 v12, 16, v33
  s_waitcnt lgkmcnt(3)
  v_mfma_f32_16x16x32_bf16 v[92:95], v[56:59], v[28:31], v[92:95]
  ds_read_b128 v[52:55], v3 offset:25600
  v_and_b32 v13, s29, v33
  v_fma_f32 v12, v12, v8, v9
  v_mfma_f32_16x16x32_bf16 v[96:99], v[60:63], v[28:31], v[96:99]
  ds_read_b128 v[56:59], v3 offset:26624
  buffer_load_dwordx4 v2, s[4:7], s15 offen offset:1024 lds
  s_waitcnt lgkmcnt(3)
  v_mfma_f32_16x16x32_bf16 v[100:103], v[64:67], v[28:31], v[100:103]
  ds_read_b128 v[60:63], v3 offset:27648
  v_fma_f32 v13, v13, v8, v9
  v_cvt_pk_bf16_f32 v33, v12, v13
  v_mfma_f32_16x16x32_bf16 v[104:107], v[68:71], v[28:31], v[104:107]
  ds_read_b128 v[64:67], v3 offset:28672
  v_lshlrev_b32 v10, 16, v34
  v_and_b32 v11, s29, v34
  s_waitcnt lgkmcnt(3)
  v_mfma_f32_16x16x32_bf16 v[108:111], v[48:51], v[28:31], v[108:111]
  ds_read_b128 v[68:71], v3 offset:29696
  buffer_load_dwordx4 v2, s[4:7], s15 offen offset:2048 lds
  v_mfma_f32_16x16x32_bf16 v[112:115], v[28:31], v[52:55], v[112:115]
  v_fma_f32 v10, v10, v8, v9
  v_fma_f32 v11, v11, v8, v9
  s_waitcnt lgkmcnt(2)
  v_mfma_f32_16x16x32_bf16 v[116:119], v[28:31], v[56:59], v[116:119]
  v_cvt_pk_bf16_f32 v34, v10, v11
  v_lshlrev_b32 v12, 16, v35
  v_mfma_f32_16x16x32_bf16 v[120:123], v[28:31], v[60:63], v[120:123]
  buffer_load_dwordx4 v2, s[4:7], s15 offen offset:3072 lds
  s_add_u32 s12, s12, 30720
  s_waitcnt lgkmcnt(0)
  v_mfma_f32_16x16x32_bf16 v[124:127], v[28:31], v[64:67], v[124:127]
  v_and_b32 v13, s29, v35
  v_fma_f32 v12, v12, v8, v9
  v_mfma_f32_16x16x32_bf16 v[128:131], v[28:31], v[68:71], v[128:131]
  v_fma_f32 v13, v13, v8, v9
  v_cvt_pk_bf16_f32 v35, v12, v13
  s_waitcnt vmcnt(10)
  s_barrier
  ds_read_b128 v[48:51], v2 offset:0
  ds_read_b128 v[52:55], v2 offset:1024
  ds_read_b128 v[56:59], v2 offset:2048
  ds_read_b128 v[60:63], v2 offset:3072
  ds_read_b128 v[64:67], v2 offset:4096
  s_waitcnt vmcnt(29)
  s_waitcnt lgkmcnt(3)
  v_mfma_f32_16x16x32_bf16 v[72:75], v[48:51], v[32:35], v[72:75]
  ds_read_b128 v[68:71], v2 offset:5120
  buffer_load_dwordx4 v[28:31], v2, s[4:7], s18 offen offset:3072 sc1
  v_mfma_f32_16x16x32_bf16 v[76:79], v[52:55], v[32:35], v[76:79]
  ds_read_b128 v[48:51], v2 offset:6144
  v_lshlrev_b32 v10, 16, v36
  v_and_b32 v11, s29, v36
  s_waitcnt lgkmcnt(3)
  v_mfma_f32_16x16x32_bf16 v[80:83], v[56:59], v[32:35], v[80:83]
  ds_read_b128 v[52:55], v2 offset:7168
  v_fma_f32 v10, v10, v8, v9
  v_fma_f32 v11, v11, v8, v9
  v_mfma_f32_16x16x32_bf16 v[84:87], v[60:63], v[32:35], v[84:87]
  ds_read_b128 v[56:59], v2 offset:8192
  s_add_u32 m0, s13, 61440
  s_add_u32 s15, s12, 0
  buffer_load_dwordx4 v2, s[4:7], s15 offen offset:0 lds
  s_waitcnt lgkmcnt(3)
  v_mfma_f32_16x16x32_bf16 v[88:91], v[64:67], v[32:35], v[88:91]
  ds_read_b128 v[60:63], v2 offset:9216
  v_cvt_pk_bf16_f32 v36, v10, v11
  v_lshlrev_b32 v12, 16, v37
  v_mfma_f32_16x16x32_bf16 v[92:95], v[68:71], v[32:35], v[92:95]
  ds_read_b128 v[64:67], v2 offset:10240
  v_and_b32 v13, s29, v37
  v_fma_f32 v12, v12, v8, v9
  s_waitcnt lgkmcnt(3)
  v_mfma_f32_16x16x32_bf16 v[96:99], v[48:51], v[32:35], v[96:99]
  ds_read_b128 v[68:71], v2 offset:11264
  buffer_load_dwordx4 v2, s[4:7], s15 offen offset:1024 lds
  v_mfma_f32_16x16x32_bf16 v[100:103], v[52:55], v[32:35], v[100:103]
  ds_read_b128 v[48:51], v2 offset:12288
  v_fma_f32 v13, v13, v8, v9
  v_cvt_pk_bf16_f32 v37, v12, v13
  s_waitcnt lgkmcnt(3)
  v_mfma_f32_16x16x32_bf16 v[104:107], v[56:59], v[32:35], v[104:107]
  ds_read_b128 v[52:55], v2 offset:13312
  v_lshlrev_b32 v10, 16, v38
  v_and_b32 v11, s29, v38
  v_mfma_f32_16x16x32_bf16 v[108:111], v[60:63], v[32:35], v[108:111]
  ds_read_b128 v[56:59], v2 offset:14336
  buffer_load_dwordx4 v2, s[4:7], s15 offen offset:2048 lds
  s_waitcnt lgkmcnt(3)
  v_mfma_f32_16x16x32_bf16 v[112:115], v[32:35], v[64:67], v[112:115]
  ds_read_b128 v[60:63], v2 offset:15360
  v_fma_f32 v10, v10, v8, v9
  v_fma_f32 v11, v11, v8, v9
  v_mfma_f32_16x16x32_bf16 v[116:119], v[32:35], v[68:71], v[116:119]
  ds_read_b128 v[64:67], v2 offset:16384
  v_cvt_pk_bf16_f32 v38, v10, v11
  v_lshlrev_b32 v12, 16, v39
  s_waitcnt lgkmcnt(3)
  v_mfma_f32_16x16x32_bf16 v[120:123], v[32:35], v[48:51], v[120:123]
  ds_read_b128 v[68:71], v2 offset:17408
  buffer_load_dwordx4 v2, s[4:7], s15 offen offset:3072 lds
  v_mfma_f32_16x16x32_bf16 v[124:127], v[32:35], v[52:55], v[124:127]
  ds_read_b128 v[48:51], v2 offset:18432
  v_and_b32 v13, s29, v39
  v_fma_f32 v12, v12, v8, v9
  s_waitcnt lgkmcnt(3)
  v_mfma_f32_16x16x32_bf16 v[128:131], v[32:35], v[56:59], v[128:131]
  ds_read_b128 v[52:55], v2 offset:19456
  v_fma_f32 v13, v13, v8, v9
  v_cvt_pk_bf16_f32 v39, v12, v13
  s_waitcnt vmcnt(29)
  s_nop 0
  v_mfma_f32_16x16x32_bf16 v[72:75], v[60:63], v[36:39], v[72:75]
  ds_read_b128 v[56:59], v2 offset:20480
  s_add_u32 m0, s13, 65536
  s_add_u32 s15, s12, 4096
  buffer_load_dwordx4 v2, s[4:7], s15 offen offset:0 lds
  s_waitcnt lgkmcnt(3)
  v_mfma_f32_16x16x32_bf16 v[76:79], v[64:67], v[36:39], v[76:79]
  ds_read_b128 v[60:63], v2 offset:21504
  v_lshlrev_b32 v10, 16, v40
  v_and_b32 v11, s29, v40
  v_mfma_f32_16x16x32_bf16 v[80:83], v[68:71], v[36:39], v[80:83]
  ds_read_b128 v[64:67], v2 offset:22528
  v_fma_f32 v10, v10, v8, v9
  v_fma_f32 v11, v11, v8, v9
  s_waitcnt lgkmcnt(3)
  v_mfma_f32_16x16x32_bf16 v[84:87], v[48:51], v[36:39], v[84:87]
  ds_read_b128 v[68:71], v2 offset:23552
  buffer_load_dwordx4 v2, s[4:7], s15 offen offset:1024 lds
  v_mfma_f32_16x16x32_bf16 v[88:91], v[52:55], v[36:39], v[88:91]
  ds_read_b128 v[48:51], v2 offset:24576
  v_cvt_pk_bf16_f32 v40, v10, v11
  v_lshlrev_b32 v12, 16, v41
  s_waitcnt lgkmcnt(3)
  v_mfma_f32_16x16x32_bf16 v[92:95], v[56:59], v[36:39], v[92:95]
  ds_read_b128 v[52:55], v2 offset:25600
  v_and_b32 v13, s29, v41
  v_fma_f32 v12, v12, v8, v9
  v_mfma_f32_16x16x32_bf16 v[96:99], v[60:63], v[36:39], v[96:99]
  ds_read_b128 v[56:59], v2 offset:26624
  buffer_load_dwordx4 v2, s[4:7], s15 offen offset:2048 lds
  s_waitcnt lgkmcnt(3)
  v_mfma_f32_16x16x32_bf16 v[100:103], v[64:67], v[36:39], v[100:103]
  ds_read_b128 v[60:63], v2 offset:27648
  v_fma_f32 v13, v13, v8, v9
  v_cvt_pk_bf16_f32 v41, v12, v13
  v_mfma_f32_16x16x32_bf16 v[104:107], v[68:71], v[36:39], v[104:107]
  ds_read_b128 v[64:67], v2 offset:28672
  v_lshlrev_b32 v10, 16, v42
  v_and_b32 v11, s29, v42
  s_waitcnt lgkmcnt(3)
  v_mfma_f32_16x16x32_bf16 v[108:111], v[48:51], v[36:39], v[108:111]
  ds_read_b128 v[68:71], v2 offset:29696
  buffer_load_dwordx4 v2, s[4:7], s15 offen offset:3072 lds
  s_add_u32 s12, s12, 30720
  v_mfma_f32_16x16x32_bf16 v[112:115], v[36:39], v[52:55], v[112:115]
  v_fma_f32 v10, v10, v8, v9
  v_fma_f32 v11, v11, v8, v9
  s_waitcnt lgkmcnt(2)
  v_mfma_f32_16x16x32_bf16 v[116:119], v[36:39], v[56:59], v[116:119]
  v_cvt_pk_bf16_f32 v42, v10, v11
  v_lshlrev_b32 v12, 16, v43
  v_mfma_f32_16x16x32_bf16 v[120:123], v[36:39], v[60:63], v[120:123]
  v_and_b32 v13, s29, v43
  v_fma_f32 v12, v12, v8, v9
  s_waitcnt lgkmcnt(0)
  v_mfma_f32_16x16x32_bf16 v[124:127], v[36:39], v[64:67], v[124:127]
  v_fma_f32 v13, v13, v8, v9
  v_cvt_pk_bf16_f32 v43, v12, v13
  v_mfma_f32_16x16x32_bf16 v[128:131], v[36:39], v[68:71], v[128:131]
  s_waitcnt vmcnt(9)
  s_barrier
  ds_read_b128 v[48:51], v2 offset:30720
  ds_read_b128 v[52:55], v2 offset:31744
  ds_read_b128 v[56:59], v2 offset:32768
  ds_read_b128 v[60:63], v2 offset:33792
  ds_read_b128 v[64:67], v2 offset:34816
  s_waitcnt vmcnt(28)
  s_waitcnt lgkmcnt(3)
  v_mfma_f32_16x16x32_bf16 v[72:75], v[48:51], v[40:43], v[72:75]
  ds_read_b128 v[68:71], v2 offset:35840
  s_add_u32 m0, s13, 0
  s_add_u32 s15, s12, 0
  buffer_load_dwordx4 v2, s[4:7], s15 offen offset:0 lds
  v_mfma_f32_16x16x32_bf16 v[76:79], v[52:55], v[40:43], v[76:79]
  ds_read_b128 v[48:51], v2 offset:36864
  v_lshlrev_b32 v10, 16, v44
  v_and_b32 v11, s29, v44
  s_waitcnt lgkmcnt(3)
  v_mfma_f32_16x16x32_bf16 v[80:83], v[56:59], v[40:43], v[80:83]
  ds_read_b128 v[52:55], v2 offset:37888
  v_fma_f32 v10, v10, v8, v9
  v_fma_f32 v11, v11, v8, v9
  v_mfma_f32_16x16x32_bf16 v[84:87], v[60:63], v[40:43], v[84:87]
  ds_read_b128 v[56:59], v2 offset:38912
  buffer_load_dwordx4 v2, s[4:7], s15 offen offset:1024 lds
  s_waitcnt lgkmcnt(3)
  v_mfma_f32_16x16x32_bf16 v[88:91], v[64:67], v[40:43], v[88:91]
  ds_read_b128 v[60:63], v2 offset:39936
  v_cvt_pk_bf16_f32 v44, v10, v11
  v_lshlrev_b32 v12, 16, v45
  v_mfma_f32_16x16x32_bf16 v[92:95], v[68:71], v[40:43], v[92:95]
  ds_read_b128 v[64:67], v2 offset:40960
  v_and_b32 v13, s29, v45
  v_fma_f32 v12, v12, v8, v9
  s_waitcnt lgkmcnt(3)
  v_mfma_f32_16x16x32_bf16 v[96:99], v[48:51], v[40:43], v[96:99]
  ds_read_b128 v[68:71], v2 offset:41984
  buffer_load_dwordx4 v2, s[4:7], s15 offen offset:2048 lds
  v_mfma_f32_16x16x32_bf16 v[100:103], v[52:55], v[40:43], v[100:103]
  ds_read_b128 v[48:51], v2 offset:43008
  v_fma_f32 v13, v13, v8, v9
  v_cvt_pk_bf16_f32 v45, v12, v13
  s_waitcnt lgkmcnt(3)
  v_mfma_f32_16x16x32_bf16 v[104:107], v[56:59], v[40:43], v[104:107]
  ds_read_b128 v[52:55], v2 offset:44032
  v_lshlrev_b32 v10, 16, v46
  v_and_b32 v11, s29, v46
  v_mfma_f32_16x16x32_bf16 v[108:111], v[60:63], v[40:43], v[108:111]
  ds_read_b128 v[56:59], v2 offset:45056
  buffer_load_dwordx4 v2, s[4:7], s15 offen offset:3072 lds
  s_waitcnt lgkmcnt(3)
  v_mfma_f32_16x16x32_bf16 v[112:115], v[40:43], v[64:67], v[112:115]
  ds_read_b128 v[60:63], v2 offset:46080
  v_fma_f32 v10, v10, v8, v9
  v_fma_f32 v11, v11, v8, v9
  v_mfma_f32_16x16x32_bf16 v[116:119], v[40:43], v[68:71], v[116:119]
  ds_read_b128 v[64:67], v2 offset:47104
  v_cvt_pk_bf16_f32 v46, v10, v11
  v_lshlrev_b32 v12, 16, v47
  s_waitcnt lgkmcnt(3)
  v_mfma_f32_16x16x32_bf16 v[120:123], v[40:43], v[48:51], v[120:123]
  ds_read_b128 v[68:71], v2 offset:48128
  s_add_u32 m0, s13, 4096
  s_add_u32 s15, s12, 4096
  buffer_load_dwordx4 v2, s[4:7], s15 offen offset:0 lds
  v_mfma_f32_16x16x32_bf16 v[124:127], v[40:43], v[52:55], v[124:127]
  ds_read_b128 v[48:51], v2 offset:49152
  v_and_b32 v13, s29, v47
  v_fma_f32 v12, v12, v8, v9
  s_waitcnt lgkmcnt(3)
  v_mfma_f32_16x16x32_bf16 v[128:131], v[40:43], v[56:59], v[128:131]
  ds_read_b128 v[52:55], v2 offset:50176
  v_fma_f32 v13, v13, v8, v9
  v_cvt_pk_bf16_f32 v47, v12, v13
  s_waitcnt vmcnt(28)
  s_nop 0
  v_mfma_f32_16x16x32_bf16 v[72:75], v[60:63], v[44:47], v[72:75]
  ds_read_b128 v[56:59], v2 offset:51200
  buffer_load_dwordx4 v2, s[4:7], s15 offen offset:1024 lds
  s_waitcnt lgkmcnt(3)
  v_mfma_f32_16x16x32_bf16 v[76:79], v[64:67], v[44:47], v[76:79]
  ds_read_b128 v[60:63], v2 offset:52224
  v_lshlrev_b32 v10, 16, v16
  v_and_b32 v11, s29, v16
  v_mfma_f32_16x16x32_bf16 v[80:83], v[68:71], v[44:47], v[80:83]
  ds_read_b128 v[64:67], v2 offset:53248
  v_fma_f32 v10, v10, v8, v9
  v_fma_f32 v11, v11, v8, v9
  s_waitcnt lgkmcnt(3)
  v_mfma_f32_16x16x32_bf16 v[84:87], v[48:51], v[44:47], v[84:87]
  ds_read_b128 v[68:71], v2 offset:54272
  buffer_load_dwordx4 v2, s[4:7], s15 offen offset:2048 lds
  v_mfma_f32_16x16x32_bf16 v[88:91], v[52:55], v[44:47], v[88:91]
  ds_read_b128 v[48:51], v2 offset:55296
  v_cvt_pk_bf16_f32 v16, v10, v11
  v_lshlrev_b32 v12, 16, v17
  s_waitcnt lgkmcnt(3)
  v_mfma_f32_16x16x32_bf16 v[92:95], v[56:59], v[44:47], v[92:95]
  ds_read_b128 v[52:55], v2 offset:56320
  v_and_b32 v13, s29, v17
  v_fma_f32 v12, v12, v8, v9
  v_mfma_f32_16x16x32_bf16 v[96:99], v[60:63], v[44:47], v[96:99]
  ds_read_b128 v[56:59], v2 offset:57344
  buffer_load_dwordx4 v2, s[4:7], s15 offen offset:3072 lds
  s_add_u32 s12, s12, 30720
  s_waitcnt lgkmcnt(3)
  v_mfma_f32_16x16x32_bf16 v[100:103], v[64:67], v[44:47], v[100:103]
  ds_read_b128 v[60:63], v2 offset:58368
  v_fma_f32 v13, v13, v8, v9
  v_cvt_pk_bf16_f32 v17, v12, v13
  v_mfma_f32_16x16x32_bf16 v[104:107], v[68:71], v[44:47], v[104:107]
  ds_read_b128 v[64:67], v2 offset:59392
  v_lshlrev_b32 v10, 16, v18
  v_and_b32 v11, s29, v18
  s_waitcnt lgkmcnt(3)
  v_mfma_f32_16x16x32_bf16 v[108:111], v[48:51], v[44:47], v[108:111]
  ds_read_b128 v[68:71], v2 offset:60416
  v_fma_f32 v10, v10, v8, v9
  v_fma_f32 v11, v11, v8, v9
  v_mfma_f32_16x16x32_bf16 v[112:115], v[44:47], v[52:55], v[112:115]
  v_cvt_pk_bf16_f32 v18, v10, v11
  v_lshlrev_b32 v12, 16, v19
  s_waitcnt lgkmcnt(2)
  v_mfma_f32_16x16x32_bf16 v[116:119], v[44:47], v[56:59], v[116:119]
  v_and_b32 v13, s29, v19
  v_fma_f32 v12, v12, v8, v9
  v_mfma_f32_16x16x32_bf16 v[120:123], v[44:47], v[60:63], v[120:123]
  v_fma_f32 v13, v13, v8, v9
  v_cvt_pk_bf16_f32 v19, v12, v13
  s_waitcnt lgkmcnt(0)
  v_mfma_f32_16x16x32_bf16 v[124:127], v[44:47], v[64:67], v[124:127]
  v_mfma_f32_16x16x32_bf16 v[128:131], v[44:47], v[68:71], v[128:131]
  s_waitcnt vmcnt(8)
  s_barrier
  ds_read_b128 v[48:51], v3 offset:0
  ds_read_b128 v[52:55], v3 offset:1024
  ds_read_b128 v[56:59], v3 offset:2048
  ds_read_b128 v[60:63], v3 offset:3072
  ds_read_b128 v[64:67], v3 offset:4096
  s_waitcnt vmcnt(26)
  s_waitcnt lgkmcnt(3)
  v_mfma_f32_16x16x32_bf16 v[72:75], v[48:51], v[16:19], v[72:75]
  ds_read_b128 v[68:71], v3 offset:5120
  s_add_u32 m0, s13, 30720
  s_add_u32 s12, s14, s13
  s_add_u32 s15, s12, 0
  buffer_load_dwordx4 v2, s[4:7], s15 offen offset:0 lds
  v_mfma_f32_16x16x32_bf16 v[76:79], v[52:55], v[16:19], v[76:79]
  ds_read_b128 v[48:51], v3 offset:6144
  v_lshlrev_b32 v10, 16, v20
  v_and_b32 v11, s29, v20
  s_waitcnt lgkmcnt(3)
  v_mfma_f32_16x16x32_bf16 v[80:83], v[56:59], v[16:19], v[80:83]
  ds_read_b128 v[52:55], v3 offset:7168
  v_fma_f32 v10, v10, v8, v9
  v_fma_f32 v11, v11, v8, v9
  v_mfma_f32_16x16x32_bf16 v[84:87], v[60:63], v[16:19], v[84:87]
  ds_read_b128 v[56:59], v3 offset:8192
  buffer_load_dwordx4 v2, s[4:7], s15 offen offset:1024 lds
  s_waitcnt lgkmcnt(3)
  v_mfma_f32_16x16x32_bf16 v[88:91], v[64:67], v[16:19], v[88:91]
  ds_read_b128 v[60:63], v3 offset:9216
  v_cvt_pk_bf16_f32 v20, v10, v11
  v_lshlrev_b32 v12, 16, v21
  v_mfma_f32_16x16x32_bf16 v[92:95], v[68:71], v[16:19], v[92:95]
  ds_read_b128 v[64:67], v3 offset:10240
  v_and_b32 v13, s29, v21
  v_fma_f32 v12, v12, v8, v9
  s_waitcnt lgkmcnt(3)
  v_mfma_f32_16x16x32_bf16 v[96:99], v[48:51], v[16:19], v[96:99]
  ds_read_b128 v[68:71], v3 offset:11264
  buffer_load_dwordx4 v2, s[4:7], s15 offen offset:2048 lds
  v_mfma_f32_16x16x32_bf16 v[100:103], v[52:55], v[16:19], v[100:103]
  ds_read_b128 v[48:51], v3 offset:12288
  v_fma_f32 v13, v13, v8, v9
  v_cvt_pk_bf16_f32 v21, v12, v13
  s_waitcnt lgkmcnt(3)
  v_mfma_f32_16x16x32_bf16 v[104:107], v[56:59], v[16:19], v[104:107]
  ds_read_b128 v[52:55], v3 offset:13312
  v_lshlrev_b32 v10, 16, v22
  v_and_b32 v11, s29, v22
  v_mfma_f32_16x16x32_bf16 v[108:111], v[60:63], v[16:19], v[108:111]
  ds_read_b128 v[56:59], v3 offset:14336
  buffer_load_dwordx4 v2, s[4:7], s15 offen offset:3072 lds
  s_waitcnt lgkmcnt(3)
  v_mfma_f32_16x16x32_bf16 v[112:115], v[16:19], v[64:67], v[112:115]
  ds_read_b128 v[60:63], v3 offset:15360
  v_fma_f32 v10, v10, v8, v9
  v_fma_f32 v11, v11, v8, v9
  v_mfma_f32_16x16x32_bf16 v[116:119], v[16:19], v[68:71], v[116:119]
  ds_read_b128 v[64:67], v3 offset:16384
  v_cvt_pk_bf16_f32 v22, v10, v11
  v_lshlrev_b32 v12, 16, v23
  s_waitcnt lgkmcnt(3)
  v_mfma_f32_16x16x32_bf16 v[120:123], v[16:19], v[48:51], v[120:123]
  ds_read_b128 v[68:71], v3 offset:17408
  s_add_u32 m0, s13, 34816
  s_add_u32 s15, s12, 4096
  buffer_load_dwordx4 v2, s[4:7], s15 offen offset:0 lds
  v_mfma_f32_16x16x32_bf16 v[124:127], v[16:19], v[52:55], v[124:127]
  ds_read_b128 v[48:51], v3 offset:18432
  v_and_b32 v13, s29, v23
  v_fma_f32 v12, v12, v8, v9
  s_waitcnt lgkmcnt(3)
  v_mfma_f32_16x16x32_bf16 v[128:131], v[16:19], v[56:59], v[128:131]
  ds_read_b128 v[52:55], v3 offset:19456
  v_fma_f32 v13, v13, v8, v9
  v_cvt_pk_bf16_f32 v23, v12, v13
  s_waitcnt vmcnt(26)
  s_nop 0
  v_mfma_f32_16x16x32_bf16 v[72:75], v[60:63], v[20:23], v[72:75]
  ds_read_b128 v[56:59], v3 offset:20480
  buffer_load_dwordx4 v2, s[4:7], s15 offen offset:1024 lds
  s_waitcnt lgkmcnt(3)
  v_mfma_f32_16x16x32_bf16 v[76:79], v[64:67], v[20:23], v[76:79]
  ds_read_b128 v[60:63], v3 offset:21504
  v_lshlrev_b32 v10, 16, v24
  v_and_b32 v11, s29, v24
  v_mfma_f32_16x16x32_bf16 v[80:83], v[68:71], v[20:23], v[80:83]
  ds_read_b128 v[64:67], v3 offset:22528
  v_fma_f32 v10, v10, v8, v9
  v_fma_f32 v11, v11, v8, v9
  s_waitcnt lgkmcnt(3)
  v_mfma_f32_16x16x32_bf16 v[84:87], v[48:51], v[20:23], v[84:87]
  ds_read_b128 v[68:71], v3 offset:23552
  buffer_load_dwordx4 v2, s[4:7], s15 offen offset:2048 lds
  v_mfma_f32_16x16x32_bf16 v[88:91], v[52:55], v[20:23], v[88:91]
  ds_read_b128 v[48:51], v3 offset:24576
  v_cvt_pk_bf16_f32 v24, v10, v11
  v_lshlrev_b32 v12, 16, v25
  s_waitcnt lgkmcnt(3)
  v_mfma_f32_16x16x32_bf16 v[92:95], v[56:59], v[20:23], v[92:95]
  ds_read_b128 v[52:55], v3 offset:25600
  v_and_b32 v13, s29, v25
  v_fma_f32 v12, v12, v8, v9
  v_mfma_f32_16x16x32_bf16 v[96:99], v[60:63], v[20:23], v[96:99]
  ds_read_b128 v[56:59], v3 offset:26624
  buffer_load_dwordx4 v2, s[4:7], s15 offen offset:3072 lds
  s_add_u32 s12, s12, 30720
  s_waitcnt lgkmcnt(3)
  v_mfma_f32_16x16x32_bf16 v[100:103], v[64:67], v[20:23], v[100:103]
  ds_read_b128 v[60:63], v3 offset:27648
  v_fma_f32 v13, v13, v8, v9
  v_cvt_pk_bf16_f32 v25, v12, v13
  v_mfma_f32_16x16x32_bf16 v[104:107], v[68:71], v[20:23], v[104:107]
  ds_read_b128 v[64:67], v3 offset:28672
  v_lshlrev_b32 v10, 16, v26
  v_and_b32 v11, s29, v26
  s_waitcnt lgkmcnt(3)
  v_mfma_f32_16x16x32_bf16 v[108:111], v[48:51], v[20:23], v[108:111]
  ds_read_b128 v[68:71], v3 offset:29696
  v_fma_f32 v10, v10, v8, v9
  v_fma_f32 v11, v11, v8, v9
  v_mfma_f32_16x16x32_bf16 v[112:115], v[20:23], v[52:55], v[112:115]
  v_cvt_pk_bf16_f32 v26, v10, v11
  v_lshlrev_b32 v12, 16, v27
  s_waitcnt lgkmcnt(2)
  v_mfma_f32_16x16x32_bf16 v[116:119], v[20:23], v[56:59], v[116:119]
  v_and_b32 v13, s29, v27
  v_fma_f32 v12, v12, v8, v9
  v_mfma_f32_16x16x32_bf16 v[120:123], v[20:23], v[60:63], v[120:123]
  v_fma_f32 v13, v13, v8, v9
  v_cvt_pk_bf16_f32 v27, v12, v13
  s_waitcnt lgkmcnt(0)
  v_mfma_f32_16x16x32_bf16 v[124:127], v[20:23], v[64:67], v[124:127]
  v_mfma_f32_16x16x32_bf16 v[128:131], v[20:23], v[68:71], v[128:131]
  s_waitcnt vmcnt(8)
  s_barrier
  ds_read_b128 v[48:51], v2 offset:0
  ds_read_b128 v[52:55], v2 offset:1024
  ds_read_b128 v[56:59], v2 offset:2048
  ds_read_b128 v[60:63], v2 offset:3072
  ds_read_b128 v[64:67], v2 offset:4096
  s_waitcnt vmcnt(24)
  s_waitcnt lgkmcnt(3)
  v_mfma_f32_16x16x32_bf16 v[72:75], v[48:51], v[24:27], v[72:75]
  ds_read_b128 v[68:71], v2 offset:5120
  s_add_u32 m0, s13, 61440
  s_add_u32 s15, s12, 0
  buffer_load_dwordx4 v2, s[4:7], s15 offen offset:0 lds
  v_mfma_f32_16x16x32_bf16 v[76:79], v[52:55], v[24:27], v[76:79]
  ds_read_b128 v[48:51], v2 offset:6144
  v_lshlrev_b32 v10, 16, v28
  v_and_b32 v11, s29, v28
  s_waitcnt lgkmcnt(3)
  v_mfma_f32_16x16x32_bf16 v[80:83], v[56:59], v[24:27], v[80:83]
  ds_read_b128 v[52:55], v2 offset:7168
  v_fma_f32 v10, v10, v8, v9
  v_fma_f32 v11, v11, v8, v9
  v_mfma_f32_16x16x32_bf16 v[84:87], v[60:63], v[24:27], v[84:87]
  ds_read_b128 v[56:59], v2 offset:8192
  buffer_load_dwordx4 v2, s[4:7], s15 offen offset:1024 lds
  s_waitcnt lgkmcnt(3)
  v_mfma_f32_16x16x32_bf16 v[88:91], v[64:67], v[24:27], v[88:91]
  ds_read_b128 v[60:63], v2 offset:9216
  v_cvt_pk_bf16_f32 v28, v10, v11
  v_lshlrev_b32 v12, 16, v29
  v_mfma_f32_16x16x32_bf16 v[92:95], v[68:71], v[24:27], v[92:95]
  ds_read_b128 v[64:67], v2 offset:10240
  v_and_b32 v13, s29, v29
  v_fma_f32 v12, v12, v8, v9
  s_waitcnt lgkmcnt(3)
  v_mfma_f32_16x16x32_bf16 v[96:99], v[48:51], v[24:27], v[96:99]
  ds_read_b128 v[68:71], v2 offset:11264
  buffer_load_dwordx4 v2, s[4:7], s15 offen offset:2048 lds
  v_mfma_f32_16x16x32_bf16 v[100:103], v[52:55], v[24:27], v[100:103]
  ds_read_b128 v[48:51], v2 offset:12288
  v_fma_f32 v13, v13, v8, v9
  v_cvt_pk_bf16_f32 v29, v12, v13
  s_waitcnt lgkmcnt(3)
  v_mfma_f32_16x16x32_bf16 v[104:107], v[56:59], v[24:27], v[104:107]
  ds_read_b128 v[52:55], v2 offset:13312
  v_lshlrev_b32 v10, 16, v30
  v_and_b32 v11, s29, v30
  v_mfma_f32_16x16x32_bf16 v[108:111], v[60:63], v[24:27], v[108:111]
  ds_read_b128 v[56:59], v2 offset:14336
  buffer_load_dwordx4 v2, s[4:7], s15 offen offset:3072 lds
  s_waitcnt lgkmcnt(3)
  v_mfma_f32_16x16x32_bf16 v[112:115], v[24:27], v[64:67], v[112:115]
  ds_read_b128 v[60:63], v2 offset:15360
  v_fma_f32 v10, v10, v8, v9
  v_fma_f32 v11, v11, v8, v9
  v_mfma_f32_16x16x32_bf16 v[116:119], v[24:27], v[68:71], v[116:119]
  ds_read_b128 v[64:67], v2 offset:16384
  v_cvt_pk_bf16_f32 v30, v10, v11
  v_lshlrev_b32 v12, 16, v31
  s_waitcnt lgkmcnt(3)
  v_mfma_f32_16x16x32_bf16 v[120:123], v[24:27], v[48:51], v[120:123]
  ds_read_b128 v[68:71], v2 offset:17408
  s_add_u32 m0, s13, 65536
  s_add_u32 s15, s12, 4096
  buffer_load_dwordx4 v2, s[4:7], s15 offen offset:0 lds
  v_mfma_f32_16x16x32_bf16 v[124:127], v[24:27], v[52:55], v[124:127]
  ds_read_b128 v[48:51], v2 offset:18432
  v_and_b32 v13, s29, v31
  v_fma_f32 v12, v12, v8, v9
  s_waitcnt lgkmcnt(3)
  v_mfma_f32_16x16x32_bf16 v[128:131], v[24:27], v[56:59], v[128:131]
  ds_read_b128 v[52:55], v2 offset:19456
  v_fma_f32 v13, v13, v8, v9
  v_cvt_pk_bf16_f32 v31, v12, v13
  s_nop 1
  v_mfma_f32_16x16x32_bf16 v[72:75], v[60:63], v[28:31], v[72:75]
  ds_read_b128 v[56:59], v2 offset:20480
  buffer_load_dwordx4 v2, s[4:7], s15 offen offset:1024 lds
  s_waitcnt lgkmcnt(3)
  v_mfma_f32_16x16x32_bf16 v[76:79], v[64:67], v[28:31], v[76:79]
  ds_read_b128 v[60:63], v2 offset:21504
  v_mfma_f32_16x16x32_bf16 v[80:83], v[68:71], v[28:31], v[80:83]
  ds_read_b128 v[64:67], v2 offset:22528
  s_waitcnt lgkmcnt(3)
  v_mfma_f32_16x16x32_bf16 v[84:87], v[48:51], v[28:31], v[84:87]
  ds_read_b128 v[68:71], v2 offset:23552
  buffer_load_dwordx4 v2, s[4:7], s15 offen offset:2048 lds
  v_mfma_f32_16x16x32_bf16 v[88:91], v[52:55], v[28:31], v[88:91]
  ds_read_b128 v[48:51], v2 offset:24576
  s_waitcnt lgkmcnt(3)
  v_mfma_f32_16x16x32_bf16 v[92:95], v[56:59], v[28:31], v[92:95]
  ds_read_b128 v[52:55], v2 offset:25600
  v_mfma_f32_16x16x32_bf16 v[96:99], v[60:63], v[28:31], v[96:99]
  ds_read_b128 v[56:59], v2 offset:26624
  buffer_load_dwordx4 v2, s[4:7], s15 offen offset:3072 lds
  s_add_u32 s12, s12, 30720
  s_waitcnt lgkmcnt(3)
  v_mfma_f32_16x16x32_bf16 v[100:103], v[64:67], v[28:31], v[100:103]
  ds_read_b128 v[60:63], v2 offset:27648
  v_mfma_f32_16x16x32_bf16 v[104:107], v[68:71], v[28:31], v[104:107]
  ds_read_b128 v[64:67], v2 offset:28672
  s_waitcnt lgkmcnt(3)
  v_mfma_f32_16x16x32_bf16 v[108:111], v[48:51], v[28:31], v[108:111]
  ds_read_b128 v[68:71], v2 offset:29696
  v_mfma_f32_16x16x32_bf16 v[112:115], v[28:31], v[52:55], v[112:115]
  s_waitcnt lgkmcnt(2)
  v_mfma_f32_16x16x32_bf16 v[116:119], v[28:31], v[56:59], v[116:119]
  v_mfma_f32_16x16x32_bf16 v[120:123], v[28:31], v[60:63], v[120:123]
  s_waitcnt lgkmcnt(0)
  v_mfma_f32_16x16x32_bf16 v[124:127], v[28:31], v[64:67], v[124:127]
  v_mfma_f32_16x16x32_bf16 v[128:131], v[28:31], v[68:71], v[128:131]
  v_max3_f32 v8, v92, v93, v94
  v_max3_f32 v8, v8, v95, v96
  v_max3_f32 v8, v8, v97, v98
  v_max3_f32 v8, v8, v99, v100
  v_max3_f32 v8, v8, v101, v102
  v_max3_f32 v8, v8, v103, v104
  v_max3_f32 v8, v8, v105, v106
  v_max3_f32 v8, v8, v107, v108
  v_max3_f32 v8, v8, v109, v110
  v_max_f32 v8, v8, v111
  v_min3_f32 v9, v92, v93, v94
  v_min3_f32 v9, v9, v95, v96
  v_min3_f32 v9, v9, v97, v98
  v_min3_f32 v9, v9, v99, v100
  v_min3_f32 v9, v9, v101, v102
  v_min3_f32 v9, v9, v103, v104
  v_min3_f32 v9, v9, v105, v106
  v_min3_f32 v9, v9, v107, v108
  v_min3_f32 v9, v9, v109, v110
  v_min_f32 v9, v9, v111
  v_mul_f32 v8, s31, v8
  v_mul_f32 v9, s31, v9
  v_fma_f32 v16, v92, s31, -v8
  v_fma_f32 v36, -v92, s31, v9
  v_fma_f32 v17, v93, s31, -v8
  v_fma_f32 v37, -v93, s31, v9
  v_fma_f32 v18, v94, s31, -v8
  v_fma_f32 v38, -v94, s31, v9
  v_fma_f32 v19, v95, s31, -v8
  v_fma_f32 v39, -v95, s31, v9
  v_fma_f32 v20, v96, s31, -v8
  v_fma_f32 v40, -v96, s31, v9
  v_fma_f32 v21, v97, s31, -v8
  v_fma_f32 v41, -v97, s31, v9
  v_fma_f32 v22, v98, s31, -v8
  v_fma_f32 v42, -v98, s31, v9
  v_fma_f32 v23, v99, s31, -v8
  v_fma_f32 v43, -v99, s31, v9
  v_fma_f32 v24, v100, s31, -v8
  v_fma_f32 v44, -v100, s31, v9
  v_fma_f32 v25, v101, s31, -v8
  v_fma_f32 v45, -v101, s31, v9
  v_fma_f32 v26, v102, s31, -v8
  v_fma_f32 v46, -v102, s31, v9
  v_fma_f32 v27, v103, s31, -v8
  v_fma_f32 v47, -v103, s31, v9
  v_fma_f32 v28, v104, s31, -v8
  v_fma_f32 v48, -v104, s31, v9
  v_fma_f32 v29, v105, s31, -v8
  v_fma_f32 v49, -v105, s31, v9
  v_fma_f32 v30, v106, s31, -v8
  v_fma_f32 v50, -v106, s31, v9
  v_fma_f32 v31, v107, s31, -v8
  v_fma_f32 v51, -v107, s31, v9
  v_fma_f32 v32, v108, s31, -v8
  v_fma_f32 v52, -v108, s31, v9
  v_fma_f32 v33, v109, s31, -v8
  v_fma_f32 v53, -v109, s31, v9
  v_fma_f32 v34, v110, s31, -v8
  v_fma_f32 v54, -v110, s31, v9
  v_fma_f32 v35, v111, s31, -v8
  v_fma_f32 v55, -v111, s31, v9
  v_exp_f32 v16, v16
  v_exp_f32 v17, v17
  v_exp_f32 v18, v18
  v_exp_f32 v19, v19
  v_exp_f32 v20, v20
  v_exp_f32 v21, v21
  v_exp_f32 v22, v22
  v_exp_f32 v23, v23
  v_exp_f32 v24, v24
  v_exp_f32 v25, v25
  v_exp_f32 v26, v26
  v_exp_f32 v27, v27
  v_exp_f32 v28, v28
  v_exp_f32 v29, v29
  v_exp_f32 v30, v30
  v_exp_f32 v31, v31
  v_exp_f32 v32, v32
  v_exp_f32 v33, v33
  v_exp_f32 v34, v34
  v_exp_f32 v35, v35
  v_exp_f32 v36, v36
  v_exp_f32 v37, v37
  v_exp_f32 v38, v38
  v_exp_f32 v39, v39
  v_exp_f32 v40, v40
  v_exp_f32 v41, v41
  v_exp_f32 v42, v42
  v_exp_f32 v43, v43
  v_exp_f32 v44, v44
  v_exp_f32 v45, v45
  v_exp_f32 v46, v46
  v_exp_f32 v47, v47
  v_exp_f32 v48, v48
  v_exp_f32 v49, v49
  v_exp_f32 v50, v50
  v_exp_f32 v51, v51
  v_exp_f32 v52, v52
  v_exp_f32 v53, v53
  v_exp_f32 v54, v54
  v_exp_f32 v55, v55
  v_pk_add_f32 v[8:9], v[16:17], v[18:19]
  v_pk_add_f32 v[8:9], v[8:9], v[20:21]
  v_pk_add_f32 v[8:9], v[8:9], v[22:23]
  v_pk_add_f32 v[8:9], v[8:9], v[24:25]
  v_pk_add_f32 v[8:9], v[8:9], v[26:27]
  v_pk_add_f32 v[8:9], v[8:9], v[28:29]
  v_pk_add_f32 v[8:9], v[8:9], v[30:31]
  v_pk_add_f32 v[8:9], v[8:9], v[32:33]
  v_pk_add_f32 v[8:9], v[8:9], v[34:35]
  v_add_f32 v8, v8, v9
  v_rcp_f32 v8, v8
  s_nop 0
  v_mov_b32 v9, v8
  v_pk_mul_f32 v[16:17], v[16:17], v[8:9]
  v_cvt_pk_bf16_f32 v92, v16, v17
  v_pk_mul_f32 v[18:19], v[18:19], v[8:9]
  v_cvt_pk_bf16_f32 v93, v18, v19
  v_pk_mul_f32 v[20:21], v[20:21], v[8:9]
  v_cvt_pk_bf16_f32 v94, v20, v21
  v_pk_mul_f32 v[22:23], v[22:23], v[8:9]
  v_cvt_pk_bf16_f32 v95, v22, v23
  v_pk_mul_f32 v[24:25], v[24:25], v[8:9]
  v_cvt_pk_bf16_f32 v96, v24, v25
  v_pk_mul_f32 v[26:27], v[26:27], v[8:9]
  v_cvt_pk_bf16_f32 v97, v26, v27
  v_pk_mul_f32 v[28:29], v[28:29], v[8:9]
  v_cvt_pk_bf16_f32 v98, v28, v29
  v_pk_mul_f32 v[30:31], v[30:31], v[8:9]
  v_cvt_pk_bf16_f32 v99, v30, v31
  v_pk_mul_f32 v[32:33], v[32:33], v[8:9]
  v_cvt_pk_bf16_f32 v100, v32, v33
  v_pk_mul_f32 v[34:35], v[34:35], v[8:9]
  v_cvt_pk_bf16_f32 v101, v34, v35
  v_pk_add_f32 v[10:11], v[36:37], v[38:39]
  v_pk_add_f32 v[10:11], v[10:11], v[40:41]
  v_pk_add_f32 v[10:11], v[10:11], v[42:43]
  v_pk_add_f32 v[10:11], v[10:11], v[44:45]
  v_pk_add_f32 v[10:11], v[10:11], v[46:47]
  v_pk_add_f32 v[10:11], v[10:11], v[48:49]
  v_pk_add_f32 v[10:11], v[10:11], v[50:51]
  v_pk_add_f32 v[10:11], v[10:11], v[52:53]
  v_pk_add_f32 v[10:11], v[10:11], v[54:55]
  v_add_f32 v10, v10, v11
  v_rcp_f32 v10, v10
  s_nop 0
  v_mov_b32 v11, v10
  v_pk_mul_f32 v[36:37], v[36:37], v[10:11]
  v_cvt_pk_bf16_f32 v102, v36, v37
  v_pk_mul_f32 v[38:39], v[38:39], v[10:11]
  v_cvt_pk_bf16_f32 v103, v38, v39
  v_pk_mul_f32 v[40:41], v[40:41], v[10:11]
  v_cvt_pk_bf16_f32 v104, v40, v41
  v_pk_mul_f32 v[42:43], v[42:43], v[10:11]
  v_cvt_pk_bf16_f32 v105, v42, v43
  v_pk_mul_f32 v[44:45], v[44:45], v[10:11]
  v_cvt_pk_bf16_f32 v106, v44, v45
  v_pk_mul_f32 v[46:47], v[46:47], v[10:11]
  v_cvt_pk_bf16_f32 v107, v46, v47
  v_pk_mul_f32 v[48:49], v[48:49], v[10:11]
  v_cvt_pk_bf16_f32 v108, v48, v49
  v_pk_mul_f32 v[50:51], v[50:51], v[10:11]
  v_cvt_pk_bf16_f32 v109, v50, v51
  v_pk_mul_f32 v[52:53], v[52:53], v[10:11]
  v_cvt_pk_bf16_f32 v110, v52, v53
  v_pk_mul_f32 v[54:55], v[54:55], v[10:11]
  v_cvt_pk_bf16_f32 v111, v54, v55
  s_lshl_b32 s15, s3, 2
  v_add_u32 v7, s15, v5
  v_mul_u32_u24 v7, 1536, v7
  v_mul_u32_u24 v12, 96, v4
  v_add_u32 v7, v7, v12
  v_lshlrev_b32 v12, 3, v1
  s_mul_i32 s15, s3, 2560
  s_add_u32 s15, s15, 133120
  v_add_u32 v13, s15, v12
  s_barrier
  ds_write_b128 v7, v[92:95] offset:0
  ds_write_b128 v7, v[96:99] offset:16
  ds_write_b128 v7, v[100:103] offset:32
  ds_write_b128 v7, v[104:107] offset:48
  ds_write_b128 v7, v[108:111] offset:64
  v_cvt_pk_bf16_f32 v112, v112, v113
  v_cvt_pk_bf16_f32 v113, v114, v115
  ds_write_b64 v13, v[112:113] offset:0
  v_cvt_pk_bf16_f32 v116, v116, v117
  v_cvt_pk_bf16_f32 v117, v118, v119
  ds_write_b64 v13, v[116:117] offset:512
  v_cvt_pk_bf16_f32 v120, v120, v121
  v_cvt_pk_bf16_f32 v121, v122, v123
  ds_write_b64 v13, v[120:121] offset:1024
  v_cvt_pk_bf16_f32 v124, v124, v125
  v_cvt_pk_bf16_f32 v125, v126, v127
  ds_write_b64 v13, v[124:125] offset:1536
  v_cvt_pk_bf16_f32 v128, v128, v129
  v_cvt_pk_bf16_f32 v129, v130, v131
  ds_write_b64 v13, v[128:129] offset:2048
  v_lshrrev_b32 v7, 2, v1
  v_mul_u32_u24 v7, 96, v7
  v_and_b32 v13, 3, v1
  v_lshl_add_u32 v7, v13, 3, v7
  s_mul_i32 s15, s3, 1536
  v_add_u32 v7, s15, v7
  s_lshl_b32 s15, s3, 9
  s_add_u32 s15, s15, 133120
  v_add_u32 v13, s15, v12
  s_mov_b32 s15, 0x80008000
  s_mov_b32 s16, 0x00010001
  s_cmp_lt_u32 s3, 3
  s_cselect_b32 s32, 0, s16
  s_cselect_b32 s33, 0, s16
  s_cselect_b32 s34, s15, 0
  s_cselect_b32 s35, s15, 0
  v_mov_b32 v10, 0x3f803f80
  s_waitcnt lgkmcnt(0)
  s_barrier
  ds_read_b64 v[40:41], v13 offset:0
  ds_read_b64 v[42:43], v13 offset:2560
  ds_read_b64 v[44:45], v13 offset:512
  ds_read_b64 v[46:47], v13 offset:3072
  ds_read_b64 v[48:49], v13 offset:5120
  ds_read_b64 v[50:51], v13 offset:7680
  ds_read_b64 v[52:53], v13 offset:5632
  ds_read_b64 v[54:55], v13 offset:8192
  ds_read_b64_tr_b16 v[16:17], v7 offset:0
  ds_read_b64_tr_b16 v[18:19], v7 offset:6144
  ds_read_b64_tr_b16 v[20:21], v7 offset:32
  ds_read_b64_tr_b16 v[22:23], v7 offset:6176
  ds_read_b64_tr_b16 v[24:25], v7 offset:64
  ds_read_b64_tr_b16 v[26:27], v7 offset:6208
  s_waitcnt lgkmcnt(6)
  ds_read_b64_tr_b16 v[28:29], v7 offset:12288
  ds_read_b64_tr_b16 v[30:31], v7 offset:18432
  ds_read_b64_tr_b16 v[32:33], v7 offset:12320
  ds_read_b64_tr_b16 v[34:35], v7 offset:18464
  ds_read_b64_tr_b16 v[36:37], v7 offset:12352
  ds_read_b64_tr_b16 v[38:39], v7 offset:18496
  v_cndmask_b32 v40, v40, v10, s[32:33]
  v_cndmask_b32 v41, v41, v10, s[32:33]
  v_cndmask_b32 v42, v42, v10, s[32:33]
  v_cndmask_b32 v43, v43, v10, s[32:33]
  v_cndmask_b32 v44, v44, v10, s[34:35]
  v_cndmask_b32 v45, v45, v10, s[34:35]
  v_cndmask_b32 v46, v46, v10, s[34:35]
  v_cndmask_b32 v47, v47, v10, s[34:35]
  v_cndmask_b32 v48, v48, v10, s[32:33]
  v_cndmask_b32 v49, v49, v10, s[32:33]
  v_cndmask_b32 v50, v50, v10, s[32:33]
  v_cndmask_b32 v51, v51, v10, s[32:33]
  v_cndmask_b32 v52, v52, v10, s[34:35]
  v_cndmask_b32 v53, v53, v10, s[34:35]
  v_cndmask_b32 v54, v54, v10, s[34:35]
  v_cndmask_b32 v55, v55, v10, s[34:35]
  s_mul_i32 s20, s70, 6291456
  s_mul_i32 s15, s9, 24576
  s_add_u32 s20, s20, s15
  s_add_u32 s20, s20, 15745024
  s_lshl_b32 s15, s8, 5
  s_add_u32 s15, s15, s3
  s_mul_i32 s15, s15, 6144
  s_add_u32 s15, s15, s20
  s_add_u32 s16, s15, 4096
  s_waitcnt lgkmcnt(0)
  v_mfma_f32_16x16x32_bf16 v[92:95], v[16:19], v[40:43], 0
  v_mfma_f32_16x16x32_bf16 v[92:95], v[28:31], v[48:51], v[92:95]
  v_mfma_f32_16x16x32_bf16 v[96:99], v[16:19], v[44:47], 0
  v_mfma_f32_16x16x32_bf16 v[96:99], v[28:31], v[52:55], v[96:99]
  v_mfma_f32_16x16x32_bf16 v[100:103], v[20:23], v[40:43], 0
  v_mfma_f32_16x16x32_bf16 v[100:103], v[32:35], v[48:51], v[100:103]
  v_mfma_f32_16x16x32_bf16 v[104:107], v[20:23], v[44:47], 0
  v_mfma_f32_16x16x32_bf16 v[104:107], v[32:35], v[52:55], v[104:107]
  v_mfma_f32_16x16x32_bf16 v[108:111], v[24:27], v[40:43], 0
  v_mfma_f32_16x16x32_bf16 v[108:111], v[36:39], v[48:51], v[108:111]
  v_mfma_f32_16x16x32_bf16 v[112:115], v[24:27], v[44:47], 0
  v_mfma_f32_16x16x32_bf16 v[112:115], v[36:39], v[52:55], v[112:115]
  buffer_store_dwordx4 v[92:95], v2, s[4:7], s15 offen offset:0 sc1
  buffer_store_dwordx4 v[96:99], v2, s[4:7], s15 offen offset:1024 sc1
  buffer_store_dwordx4 v[100:103], v2, s[4:7], s15 offen offset:2048 sc1
  buffer_store_dwordx4 v[104:107], v2, s[4:7], s15 offen offset:3072 sc1
  buffer_store_dwordx4 v[108:111], v2, s[4:7], s16 offen offset:0 sc1
  s_nop 2
  buffer_store_dwordx4 v[112:115], v2, s[4:7], s16 offen offset:1024 sc1
  s_mul_hi_u32 s15, s8, 0x33333334
  s_mul_i32 s16, s15, 5
  s_sub_u32 s16, s8, s16
  s_lshl_b32 s18, s3, 1
  v_lshrrev_b32 v16, 3, v4
  v_add_u32 v16, s18, v16
  v_and_b32 v17, 3, v4
  s_lshl_b32 s18, s15, 2
  v_lshl_add_u32 v18, v16, 2, v17
  v_add_u32 v18, s18, v18
  v_cmp_gt_u32 vcc, 3, v16
  s_nop 1
  v_cndmask_b32 v19, 0, 31, vcc
  s_cmp_eq_u32 s15, 5
  s_cselect_b64 vcc, -1, 0
  v_cndmask_b32 v18, v18, v19, vcc
  v_bfe_u32 v19, v4, 2, 1
  s_lshl_b32 s16, s16, 1
  v_add_u32 v20, s16, v19
  v_lshrrev_b32 v21, 2, v20
  v_lshrrev_b32 v22, 4, v18
  v_lshl_add_u32 v22, v21, 1, v22
  v_lshlrev_b32 v22, 10, v22
  v_and_b32 v18, 15, v18
  v_lshl_add_u32 v22, v18, 4, v22
  v_and_b32 v20, 3, v20
  v_lshl_add_u32 v22, v20, 8, v22
  v_mul_u32_u24 v20, 6144, v16
  v_mul_u32_u24 v21, 1572864, v5
  v_add3_u32 v6, v22, v20, v21
  v_lshlrev_b32 v7, 6, v16
  v_lshl_add_u32 v7, v17, 4, v7
  v_lshl_add_u32 v7, v19, 3, v7
  s_lshl_b32 s18, s8, 8
  v_add_u32 v7, s18, v7
  v_lshrrev_b32 v12, 1, v5
  v_lshlrev_b32 v12, 8, v12
  v_lshl_add_u32 v12, v4, 4, v12
  v_and_b32 v13, 1, v5
  v_lshl_add_u32 v12, v13, 3, v12
  s_mul_i32 s18, s9, 2560
  s_add_u32 s19, s19, s18
  buffer_load_dwordx2 v[120:121], v12, s[4:7], s19 offen offset:0 sc1
  buffer_load_dwordx2 v[122:123], v12, s[4:7], s19 offen offset:512 sc1
  buffer_load_dwordx2 v[124:125], v12, s[4:7], s19 offen offset:1024 sc1
  buffer_load_dwordx2 v[126:127], v12, s[4:7], s19 offen offset:1536 sc1
  buffer_load_dwordx2 v[128:129], v12, s[4:7], s19 offen offset:2048 sc1
  s_lshr_b32 s36, s9, 1
  s_mul_i32 s36, s36, 5120
  s_add_u32 s37, s23, 36192256
  s_add_u32 s36, s36, s37
  s_and_b32 s38, s9, 1
  s_mul_i32 s39, s38, 3072
  s_add_u32 s39, s39, s36
  s_lshl_b32 s38, s38, 3
  s_add_u32 s38, s38, s36
  buffer_load_dwordx4 v[56:59], v2, s[4:7], s39 offen sc1
  buffer_load_dwordx4 v[60:63], v2, s[4:7], s39 offen offset:1024 sc1
  buffer_load_dwordx4 v[64:67], v2, s[4:7], s36 offen offset:2048 sc1
  s_lshl_b32 s40, s10, 10
  s_add_u32 s40, s40, 42876928
  buffer_load_dwordx4 v[68:71], v2, s[4:7], s40 offen sc1
  s_lshl_b32 s41, s8, 7
  s_add_u32 s41, s41, s71
  s_add_u32 s41, s41, 81920
  buffer_load_dword v116, v15, s[4:7], s41 offen sc1
  s_waitcnt vmcnt(10)
  s_barrier
  s_cmp_lg_u32 s3, 0
  s_cbranch_scc1 mega_b_nf0
  buffer_store_dword v14, v15, s[4:7], s17 offen offset:0 sc1
mega_b_nf0:
  v_max3_f32 v8, v72, v73, v74
  v_max3_f32 v8, v8, v75, v76
  v_max3_f32 v8, v8, v77, v78
  v_max3_f32 v8, v8, v79, v80
  v_max3_f32 v8, v8, v81, v82
  v_max3_f32 v8, v8, v83, v84
  v_max3_f32 v8, v8, v85, v86
  v_max3_f32 v8, v8, v87, v88
  v_max3_f32 v8, v8, v89, v90
  v_max_f32 v8, v8, v91
  v_min3_f32 v9, v72, v73, v74
  v_min3_f32 v9, v9, v75, v76
  v_min3_f32 v9, v9, v77, v78
  v_min3_f32 v9, v9, v79, v80
  v_min3_f32 v9, v9, v81, v82
  v_min3_f32 v9, v9, v83, v84
  v_min3_f32 v9, v9, v85, v86
  v_min3_f32 v9, v9, v87, v88
  v_min3_f32 v9, v9, v89, v90
  v_min_f32 v9, v9, v91
  v_mul_f32 v8, s31, v8
  v_mul_f32 v9, s31, v9
  v_fma_f32 v16, v72, s31, -v8
  v_fma_f32 v36, -v72, s31, v9
  v_fma_f32 v17, v73, s31, -v8
  v_fma_f32 v37, -v73, s31, v9
  v_fma_f32 v18, v74, s31, -v8
  v_fma_f32 v38, -v74, s31, v9
  v_fma_f32 v19, v75, s31, -v8
  v_fma_f32 v39, -v75, s31, v9
  v_fma_f32 v20, v76, s31, -v8
  v_fma_f32 v40, -v76, s31, v9
  v_fma_f32 v21, v77, s31, -v8
  v_fma_f32 v41, -v77, s31, v9
  v_fma_f32 v22, v78, s31, -v8
  v_fma_f32 v42, -v78, s31, v9
  v_fma_f32 v23, v79, s31, -v8
  v_fma_f32 v43, -v79, s31, v9
  v_fma_f32 v24, v80, s31, -v8
  v_fma_f32 v44, -v80, s31, v9
  v_fma_f32 v25, v81, s31, -v8
  v_fma_f32 v45, -v81, s31, v9
  v_fma_f32 v26, v82, s31, -v8
  v_fma_f32 v46, -v82, s31, v9
  v_fma_f32 v27, v83, s31, -v8
  v_fma_f32 v47, -v83, s31, v9
  v_fma_f32 v28, v84, s31, -v8
  v_fma_f32 v48, -v84, s31, v9
  v_fma_f32 v29, v85, s31, -v8
  v_fma_f32 v49, -v85, s31, v9
  v_fma_f32 v30, v86, s31, -v8
  v_fma_f32 v50, -v86, s31, v9
  v_fma_f32 v31, v87, s31, -v8
  v_fma_f32 v51, -v87, s31, v9
  v_fma_f32 v32, v88, s31, -v8
  v_fma_f32 v52, -v88, s31, v9
  v_fma_f32 v33, v89, s31, -v8
  v_fma_f32 v53, -v89, s31, v9
  v_fma_f32 v34, v90, s31, -v8
  v_fma_f32 v54, -v90, s31, v9
  v_fma_f32 v35, v91, s31, -v8
  v_fma_f32 v55, -v91, s31, v9
  v_exp_f32 v16, v16
  v_exp_f32 v17, v17
  v_exp_f32 v18, v18
  v_exp_f32 v19, v19
  v_exp_f32 v20, v20
  v_exp_f32 v21, v21
  v_exp_f32 v22, v22
  v_exp_f32 v23, v23
  v_exp_f32 v24, v24
  v_exp_f32 v25, v25
  v_exp_f32 v26, v26
  v_exp_f32 v27, v27
  v_exp_f32 v28, v28
  v_exp_f32 v29, v29
  v_exp_f32 v30, v30
  v_exp_f32 v31, v31
  v_exp_f32 v32, v32
  v_exp_f32 v33, v33
  v_exp_f32 v34, v34
  v_exp_f32 v35, v35
  v_exp_f32 v36, v36
  v_exp_f32 v37, v37
  v_exp_f32 v38, v38
  v_exp_f32 v39, v39
  v_exp_f32 v40, v40
  v_exp_f32 v41, v41
  v_exp_f32 v42, v42
  v_exp_f32 v43, v43
  v_exp_f32 v44, v44
  v_exp_f32 v45, v45
  v_exp_f32 v46, v46
  v_exp_f32 v47, v47
  v_exp_f32 v48, v48
  v_exp_f32 v49, v49
  v_exp_f32 v50, v50
  v_exp_f32 v51, v51
  v_exp_f32 v52, v52
  v_exp_f32 v53, v53
  v_exp_f32 v54, v54
  v_exp_f32 v55, v55
  v_pk_add_f32 v[8:9], v[16:17], v[18:19]
  v_pk_add_f32 v[8:9], v[8:9], v[20:21]
  v_pk_add_f32 v[8:9], v[8:9], v[22:23]
  v_pk_add_f32 v[8:9], v[8:9], v[24:25]
  v_pk_add_f32 v[8:9], v[8:9], v[26:27]
  v_pk_add_f32 v[8:9], v[8:9], v[28:29]
  v_pk_add_f32 v[8:9], v[8:9], v[30:31]
  v_pk_add_f32 v[8:9], v[8:9], v[32:33]
  v_pk_add_f32 v[8:9], v[8:9], v[34:35]
  v_add_f32 v8, v8, v9
  v_rcp_f32 v8, v8
  s_nop 0
  v_mov_b32 v9, v8
  v_pk_mul_f32 v[16:17], v[16:17], v[8:9]
  v_cvt_pk_bf16_f32 v72, v16, v17
  v_pk_mul_f32 v[18:19], v[18:19], v[8:9]
  v_cvt_pk_bf16_f32 v73, v18, v19
  v_pk_mul_f32 v[20:21], v[20:21], v[8:9]
  v_cvt_pk_bf16_f32 v74, v20, v21
  v_pk_mul_f32 v[22:23], v[22:23], v[8:9]
  v_cvt_pk_bf16_f32 v75, v22, v23
  v_pk_mul_f32 v[24:25], v[24:25], v[8:9]
  v_cvt_pk_bf16_f32 v76, v24, v25
  v_pk_mul_f32 v[26:27], v[26:27], v[8:9]
  v_cvt_pk_bf16_f32 v77, v26, v27
  v_pk_mul_f32 v[28:29], v[28:29], v[8:9]
  v_cvt_pk_bf16_f32 v78, v28, v29
  v_pk_mul_f32 v[30:31], v[30:31], v[8:9]
  v_cvt_pk_bf16_f32 v79, v30, v31
  v_pk_mul_f32 v[32:33], v[32:33], v[8:9]
  v_cvt_pk_bf16_f32 v80, v32, v33
  v_pk_mul_f32 v[34:35], v[34:35], v[8:9]
  v_cvt_pk_bf16_f32 v81, v34, v35
  v_pk_add_f32 v[10:11], v[36:37], v[38:39]
  v_pk_add_f32 v[10:11], v[10:11], v[40:41]
  v_pk_add_f32 v[10:11], v[10:11], v[42:43]
  v_pk_add_f32 v[10:11], v[10:11], v[44:45]
  v_pk_add_f32 v[10:11], v[10:11], v[46:47]
  v_pk_add_f32 v[10:11], v[10:11], v[48:49]
  v_pk_add_f32 v[10:11], v[10:11], v[50:51]
  v_pk_add_f32 v[10:11], v[10:11], v[52:53]
  v_pk_add_f32 v[10:11], v[10:11], v[54:55]
  v_add_f32 v10, v10, v11
  v_rcp_f32 v10, v10
  s_nop 0
  v_mov_b32 v11, v10
  v_pk_mul_f32 v[36:37], v[36:37], v[10:11]
  v_cvt_pk_bf16_f32 v82, v36, v37
  v_pk_mul_f32 v[38:39], v[38:39], v[10:11]
  v_cvt_pk_bf16_f32 v83, v38, v39
  v_pk_mul_f32 v[40:41], v[40:41], v[10:11]
  v_cvt_pk_bf16_f32 v84, v40, v41
  v_pk_mul_f32 v[42:43], v[42:43], v[10:11]
  v_cvt_pk_bf16_f32 v85, v42, v43
  v_pk_mul_f32 v[44:45], v[44:45], v[10:11]
  v_cvt_pk_bf16_f32 v86, v44, v45
  v_pk_mul_f32 v[46:47], v[46:47], v[10:11]
  v_cvt_pk_bf16_f32 v87, v46, v47
  v_pk_mul_f32 v[48:49], v[48:49], v[10:11]
  v_cvt_pk_bf16_f32 v88, v48, v49
  v_pk_mul_f32 v[50:51], v[50:51], v[10:11]
  v_cvt_pk_bf16_f32 v89, v50, v51
  v_pk_mul_f32 v[52:53], v[52:53], v[10:11]
  v_cvt_pk_bf16_f32 v90, v52, v53
  v_pk_mul_f32 v[54:55], v[54:55], v[10:11]
  v_cvt_pk_bf16_f32 v91, v54, v55
  s_lshl_b32 s21, s70, 16
  s_mul_i32 s15, s9, 7680
  s_add_u32 s21, s21, s15
  s_add_u32 s21, s21, 42745856
  v_lshrrev_b32 v8, 1, v1
  v_lshlrev_b32 v8, 10, v8
  s_lshl_b32 s15, s9, 7
  s_add_u32 s15, s15, 49152
  v_add_u32 v8, s15, v8
  s_cmp_ge_u32 s3, 2
  s_cbranch_scc1 mega_b_nored
  s_mov_b32 s30, 0
mega_kernel_pg35:
  buffer_load_dword v16, v8, s[4:7], s71 offen offset:0 sc1
  s_waitcnt vmcnt(0)
  v_cmp_gt_u32 vcc, 1, v16
  s_nop 0
  s_cbranch_vccz mega_kernel_pg35_ok
  s_sleep 1
  s_add_u32 s30, s30, 1
  s_cmp_lt_u32 s30, 262144
  s_cbranch_scc1 mega_kernel_pg35
  s_branch mega_fail
mega_kernel_pg35_ok:
  s_cmp_ge_u32 s8, 30
  s_cbranch_scc1 mega_b_nored
  buffer_load_dwordx4 v[16:19], v6, s[4:7], s20 offen sc1
  s_add_u32 s20, s20, 196608
  buffer_load_dwordx4 v[20:23], v6, s[4:7], s20 offen sc1
  s_add_u32 s20, s20, 196608
  buffer_load_dwordx4 v[24:27], v6, s[4:7], s20 offen sc1
  s_add_u32 s20, s20, 196608
  buffer_load_dwordx4 v[28:31], v6, s[4:7], s20 offen sc1
  s_add_u32 s20, s20, 196608
  buffer_load_dwordx4 v[32:35], v6, s[4:7], s20 offen sc1
  s_add_u32 s20, s20, 196608
  buffer_load_dwordx4 v[36:39], v6, s[4:7], s20 offen sc1
  s_add_u32 s20, s20, 196608
  buffer_load_dwordx4 v[40:43], v6, s[4:7], s20 offen sc1
  s_add_u32 s20, s20, 196608
  buffer_load_dwordx4 v[44:47], v6, s[4:7], s20 offen sc1
  s_waitcnt vmcnt(0)
  v_pk_add_f32 v[16:17], v[16:17], v[32:33]
  v_pk_add_f32 v[18:19], v[18:19], v[34:35]
  v_pk_add_f32 v[20:21], v[20:21], v[36:37]
  v_pk_add_f32 v[22:23], v[22:23], v[38:39]
  v_pk_add_f32 v[24:25], v[24:25], v[40:41]
  v_pk_add_f32 v[26:27], v[26:27], v[42:43]
  v_pk_add_f32 v[28:29], v[28:29], v[44:45]
  v_pk_add_f32 v[30:31], v[30:31], v[46:47]
  v_pk_add_f32 v[16:17], v[16:17], v[24:25]
  v_pk_add_f32 v[18:19], v[18:19], v[26:27]
  v_pk_add_f32 v[20:21], v[20:21], v[28:29]
  v_pk_add_f32 v[22:23], v[22:23], v[30:31]
  v_pk_add_f32 v[16:17], v[16:17], v[20:21]
  v_pk_add_f32 v[18:19], v[18:19], v[22:23]
  v_mov_b32 v20, v16
  v_mov_b32 v21, v17
  v_mov_b32 v22, v18
  v_mov_b32 v23, v19
  v_permlane16_swap_b32 v16, v20
  v_permlane16_swap_b32 v17, v21
  v_permlane16_swap_b32 v18, v22
  v_permlane16_swap_b32 v19, v23
  v_add_f32 v16, v16, v20
  v_add_f32 v17, v17, v21
  v_add_f32 v18, v18, v22
  v_add_f32 v19, v19, v23
  v_mov_b32 v20, v16
  v_mov_b32 v21, v17
  v_mov_b32 v22, v18
  v_mov_b32 v23, v19
  v_permlane32_swap_b32 v16, v20
  v_permlane32_swap_b32 v17, v21
  v_permlane32_swap_b32 v18, v22
  v_permlane32_swap_b32 v19, v23
  v_add_f32 v16, v16, v20
  v_add_f32 v17, v17, v21
  v_add_f32 v18, v18, v22
  v_add_f32 v19, v19, v23
  v_cvt_pk_bf16_f32 v16, v16, v17
  v_cvt_pk_bf16_f32 v17, v18, v19
  v_min_u32 v16, -2, v16
  v_min_u32 v17, -2, v17
  s_mov_b64 exec, 0xffff
  buffer_store_dwordx2 v[16:17], v7, s[4:7], s21 offen sc1
  s_mov_b64 exec, -1
mega_b_nored:
  s_lshl_b32 s15, s3, 11
  v_add_u32 v13, s15, v2
  v_add_u32 v7, 1024, v13
  v_min_u32 v7, 7664, v7
  v_mov_b32 v6, v13
  v_mov_b32 v16, 0
  v_mov_b32 v17, 0
  v_mov_b32 v18, 0
  v_mov_b32 v19, 0
  v_mov_b32 v20, 0
  v_mov_b32 v21, 0
  v_mov_b32 v22, 0
  v_mov_b32 v23, 0
  v_mov_b32 v24, 0
  v_mov_b32 v25, 0
  v_mov_b32 v26, 0
  v_mov_b32 v27, 0
  v_mov_b32 v28, 0
  v_mov_b32 v29, 0
  v_mov_b32 v30, 0
  v_mov_b32 v31, 0
  v_mov_b32 v32, 0
  v_mov_b32 v33, 0
  v_mov_b32 v34, 0
  v_mov_b32 v35, 0
  v_mov_b32 v36, 0
  v_mov_b32 v37, 0
  v_mov_b32 v38, 0
  v_mov_b32 v39, 0
  v_mov_b32 v40, 0
  v_mov_b32 v41, 0
  v_mov_b32 v42, 0
  v_mov_b32 v43, 0
  v_mov_b32 v44, 0
  v_mov_b32 v45, 0
  v_mov_b32 v46, 0
  v_mov_b32 v47, 0
  v_mov_b32 v48, 0
  v_mov_b32 v49, 0
  v_mov_b32 v50, 0
  v_mov_b32 v51, 0
  v_mov_b32 v52, 0
  v_mov_b32 v53, 0
  v_mov_b32 v54, 0
  v_mov_b32 v55, 0
  v_lshrrev_b32 v8, 2, v4
  v_cmp_eq_u32 s[32:33], v8, v5
  v_lshlrev_b32 v11, 4, v4
  s_barrier
  s_mov_b32 s30, 0
mega_kernel_kv36:
  buffer_load_dwordx4 v[56:59], v6, s[4:7], s21 offen sc1
  buffer_load_dwordx4 v[60:63], v7, s[4:7], s21 offen sc1
  s_waitcnt vmcnt(0)
  v_max3_u32 v8, v56, v57, v58
  v_max3_u32 v8, v8, v59, v60
  v_max3_u32 v8, v8, v61, v62
  v_max_u32 v8, v8, v63
  v_cmp_eq_u32 vcc, -1, v8
  s_nop 0
  s_cbranch_vccz mega_kernel_kv36_ok
  s_sleep 1
  s_add_u32 s30, s30, 1
  s_cmp_lt_u32 s30, 262144
  s_cbranch_scc1 mega_kernel_kv36
  s_branch mega_fail
mega_kernel_kv36_ok:
  ds_write_b128 v13, v[56:59] offset:0
  ds_write_b128 v13, v[60:63] offset:1024
  s_waitcnt lgkmcnt(0)
  s_barrier
  s_mov_b64 exec, s[32:33]
  ds_read_b128 v[36:39], v11 offset:6400
  ds_read_b128 v[40:43], v11 offset:6656
  ds_read_b128 v[44:47], v11 offset:6912
  ds_read_b128 v[48:51], v11 offset:7168
  ds_read_b128 v[52:55], v11 offset:7424
  s_mov_b64 exec, -1
  s_mov_b64 exec, s[32:33]
  ds_read_b128 v[16:19], v11 offset:0
  ds_read_b128 v[20:23], v11 offset:256
  ds_read_b128 v[24:27], v11 offset:512
  ds_read_b128 v[28:31], v11 offset:768
  ds_read_b128 v[32:35], v11 offset:1024
  s_mov_b64 exec, -1
  s_waitcnt lgkmcnt(5)
  v_mfma_f32_16x16x32_bf16 v[112:115], v[36:39], v[72:75], 0
  v_mfma_f32_16x16x32_bf16 v[112:115], v[40:43], v[76:79], v[112:115]
  v_mfma_f32_16x16x32_bf16 v[112:115], v[44:47], v[80:83], v[112:115]
  v_mfma_f32_16x16x32_bf16 v[112:115], v[48:51], v[84:87], v[112:115]
  v_mfma_f32_16x16x32_bf16 v[112:115], v[52:55], v[88:91], v[112:115]
  s_mov_b64 exec, s[32:33]
  ds_read_b128 v[36:39], v11 offset:1280
  ds_read_b128 v[40:43], v11 offset:1536
  ds_read_b128 v[44:47], v11 offset:1792
  ds_read_b128 v[48:51], v11 offset:2048
  ds_read_b128 v[52:55], v11 offset:2304
  s_mov_b64 exec, -1
  s_waitcnt lgkmcnt(5)
  v_mfma_f32_16x16x32_bf16 v[92:95], v[16:19], v[72:75], 0
  v_mfma_f32_16x16x32_bf16 v[92:95], v[20:23], v[76:79], v[92:95]
  v_mfma_f32_16x16x32_bf16 v[92:95], v[24:27], v[80:83], v[92:95]
  v_mfma_f32_16x16x32_bf16 v[92:95], v[28:31], v[84:87], v[92:95]
  v_mfma_f32_16x16x32_bf16 v[92:95], v[32:35], v[88:91], v[92:95]
  s_mov_b64 exec, s[32:33]
  ds_read_b128 v[16:19], v11 offset:2560
  ds_read_b128 v[20:23], v11 offset:2816
  ds_read_b128 v[24:27], v11 offset:3072
  ds_read_b128 v[28:31], v11 offset:3328
  ds_read_b128 v[32:35], v11 offset:3584
  s_mov_b64 exec, -1
  v_add_f32 v8, 0x358637bd, v112
  v_rcp_f32 v8, v8
  s_waitcnt lgkmcnt(5)
  v_mfma_f32_16x16x32_bf16 v[96:99], v[36:39], v[72:75], 0
  v_mfma_f32_16x16x32_bf16 v[96:99], v[40:43], v[76:79], v[96:99]
  v_mfma_f32_16x16x32_bf16 v[96:99], v[44:47], v[80:83], v[96:99]
  v_mfma_f32_16x16x32_bf16 v[96:99], v[48:51], v[84:87], v[96:99]
  v_mfma_f32_16x16x32_bf16 v[96:99], v[52:55], v[88:91], v[96:99]
  s_mov_b64 exec, s[32:33]
  ds_read_b128 v[36:39], v11 offset:3840
  ds_read_b128 v[40:43], v11 offset:4096
  ds_read_b128 v[44:47], v11 offset:4352
  ds_read_b128 v[48:51], v11 offset:4608
  ds_read_b128 v[52:55], v11 offset:4864
  s_mov_b64 exec, -1
  s_waitcnt lgkmcnt(5)
  v_mfma_f32_16x16x32_bf16 v[100:103], v[16:19], v[72:75], 0
  v_mfma_f32_16x16x32_bf16 v[100:103], v[20:23], v[76:79], v[100:103]
  v_mfma_f32_16x16x32_bf16 v[100:103], v[24:27], v[80:83], v[100:103]
  v_mfma_f32_16x16x32_bf16 v[100:103], v[28:31], v[84:87], v[100:103]
  v_mfma_f32_16x16x32_bf16 v[100:103], v[32:35], v[88:91], v[100:103]
  s_mov_b64 exec, s[32:33]
  ds_read_b128 v[16:19], v11 offset:5120
  ds_read_b128 v[20:23], v11 offset:5376
  ds_read_b128 v[24:27], v11 offset:5632
  ds_read_b128 v[28:31], v11 offset:5888
  ds_read_b128 v[32:35], v11 offset:6144
  s_mov_b64 exec, -1
  s_waitcnt lgkmcnt(5)
  v_mfma_f32_16x16x32_bf16 v[104:107], v[36:39], v[72:75], 0
  v_mfma_f32_16x16x32_bf16 v[104:107], v[40:43], v[76:79], v[104:107]
  v_mfma_f32_16x16x32_bf16 v[104:107], v[44:47], v[80:83], v[104:107]
  v_mfma_f32_16x16x32_bf16 v[104:107], v[48:51], v[84:87], v[104:107]
  v_mfma_f32_16x16x32_bf16 v[104:107], v[52:55], v[88:91], v[104:107]
  s_waitcnt lgkmcnt(0)
  v_mfma_f32_16x16x32_bf16 v[108:111], v[16:19], v[72:75], 0
  v_mfma_f32_16x16x32_bf16 v[108:111], v[20:23], v[76:79], v[108:111]
  v_mfma_f32_16x16x32_bf16 v[108:111], v[24:27], v[80:83], v[108:111]
  v_mfma_f32_16x16x32_bf16 v[108:111], v[28:31], v[84:87], v[108:111]
  v_mfma_f32_16x16x32_bf16 v[108:111], v[32:35], v[88:91], v[108:111]
  v_pk_mul_f32 v[92:93], v[92:93], v[8:9] op_sel_hi:[1,0]
  s_nop 0
  v_cvt_pk_bf16_f32 v56, v92, v93
  v_pk_mul_f32 v[94:95], v[94:95], v[8:9] op_sel_hi:[1,0]
  s_nop 0
  v_cvt_pk_bf16_f32 v57, v94, v95
  v_pk_mul_f32 v[96:97], v[96:97], v[8:9] op_sel_hi:[1,0]
  s_nop 0
  v_cvt_pk_bf16_f32 v58, v96, v97
  v_pk_mul_f32 v[98:99], v[98:99], v[8:9] op_sel_hi:[1,0]
  s_nop 0
  v_cvt_pk_bf16_f32 v59, v98, v99
  v_pk_mul_f32 v[100:101], v[100:101], v[8:9] op_sel_hi:[1,0]
  s_nop 0
  v_cvt_pk_bf16_f32 v60, v100, v101
  v_pk_mul_f32 v[102:103], v[102:103], v[8:9] op_sel_hi:[1,0]
  s_nop 0
  v_cvt_pk_bf16_f32 v61, v102, v103
  v_pk_mul_f32 v[104:105], v[104:105], v[8:9] op_sel_hi:[1,0]
  s_nop 0
  v_cvt_pk_bf16_f32 v62, v104, v105
  v_pk_mul_f32 v[106:107], v[106:107], v[8:9] op_sel_hi:[1,0]
  s_nop 0
  v_cvt_pk_bf16_f32 v63, v106, v107
  v_pk_mul_f32 v[108:109], v[108:109], v[8:9] op_sel_hi:[1,0]
  s_nop 0
  v_cvt_pk_bf16_f32 v64, v108, v109
  v_pk_mul_f32 v[110:111], v[110:111], v[8:9] op_sel_hi:[1,0]
  s_nop 0
  v_cvt_pk_bf16_f32 v65, v110, v111
  s_bitcmp1_b32 s9, 0
  s_cbranch_scc1 mega_b_odd
  s_cmp_lg_u32 s69, 0
  s_cbranch_scc1 mega_kernel_ls37
  buffer_store_dwordx4 v[56:59], v2, s[4:7], s39 offen
  buffer_store_dwordx4 v[60:63], v2, s[4:7], s39 offen offset:1024
  buffer_store_dwordx2 v[64:65], v2, s[4:7], s38 offen offset:2048
mega_kernel_ls37_b:
  s_branch mega_b_ost
mega_b_odd:
  s_cmp_lg_u32 s69, 0
  s_cbranch_scc1 mega_kernel_ls38
  buffer_store_dwordx4 v[58:61], v2, s[4:7], s39 offen
  buffer_store_dwordx4 v[62:65], v2, s[4:7], s39 offen offset:1024
  buffer_store_dwordx2 v[56:57], v2, s[4:7], s38 offen offset:2048
mega_kernel_ls38_b:
mega_b_ost:
  v_and_b32 v8, 7, v1
  v_lshlrev_b32 v8, 4, v8
  s_lshl_b32 s15, s8, 7
  s_lshl_b32 s16, s3, 2
  s_add_u32 s15, s15, s16
  s_add_u32 s15, s15, 81920
  v_add_u32 v8, s15, v8
  s_lshl_b32 s15, s9, 4
  s_add_u32 s15, s15, s16
  s_add_u32 s41, s41, s15
  s_mov_b32 s20, s37
  v_add_u32 v6, 30720, v2
  v_add_u32 v7, 92160, v2
  s_waitcnt vmcnt(0)
  s_cmp_lg_u32 s69, 0
  s_cbranch_scc1 mega_kernel_ls39
  buffer_store_dword v14, v15, s[4:7], s41 offen
mega_kernel_ls39_b:
  s_mov_b32 s30, 0
mega_kernel_pg40:
  buffer_load_dword v9, v8, s[4:7], s71 offen offset:0 sc1
  s_waitcnt vmcnt(0)
  v_cmp_gt_u32 vcc, 1, v9
  s_nop 0
  s_cbranch_vccz mega_kernel_pg40_ok
  s_add_u32 s30, s30, 1
  s_cmp_lt_u32 s30, 262144
  s_cbranch_scc1 mega_kernel_pg40
  s_branch mega_fail
mega_kernel_pg40_ok:
  s_add_u32 s15, s20, 0
  buffer_load_dwordx4 v[16:19], v2, s[4:7], s15 offen offset:0 sc1
  buffer_load_dwordx4 v[20:23], v2, s[4:7], s15 offen offset:1024 sc1
  buffer_load_dwordx4 v[24:27], v2, s[4:7], s15 offen offset:2048 sc1
  buffer_load_dwordx4 v[28:31], v2, s[4:7], s15 offen offset:3072 sc1
  s_add_u32 s15, s20, 4096
  buffer_load_dwordx4 v[32:35], v2, s[4:7], s15 offen offset:0 sc1
  buffer_load_dwordx4 v[36:39], v2, s[4:7], s15 offen offset:1024 sc1
  buffer_load_dwordx4 v[40:43], v2, s[4:7], s15 offen offset:2048 sc1
  buffer_load_dwordx4 v[44:47], v2, s[4:7], s15 offen offset:3072 sc1
  s_add_u32 s15, s20, 8192
  buffer_load_dwordx4 v[48:51], v2, s[4:7], s15 offen offset:0 sc1
  buffer_load_dwordx4 v[52:55], v2, s[4:7], s15 offen offset:1024 sc1
  buffer_load_dwordx4 v[56:59], v2, s[4:7], s15 offen offset:2048 sc1
  ds_read_b128 v[60:63], v6 offset:0
  ds_read_b128 v[64:67], v6 offset:20480
  ds_read_b128 v[68:71], v6 offset:40960
  ds_read_b128 v[72:75], v7 offset:0
  ds_read_b128 v[76:79], v7 offset:20480
  ds_read_b128 v[80:83], v6 offset:1024
  ds_read_b128 v[84:87], v6 offset:21504
  ds_read_b128 v[88:91], v6 offset:41984
  s_waitcnt vmcnt(10)
  s_waitcnt lgkmcnt(6)
  v_mfma_f32_16x16x32_bf16 v[96:99], v[60:63], v[16:19], 0
  ds_read_b128 v[92:95], v7 offset:1024
  v_mfma_f32_16x16x32_bf16 v[100:103], v[64:67], v[16:19], 0
  ds_read_b128 v[60:63], v7 offset:21504
  s_waitcnt lgkmcnt(6)
  v_mfma_f32_16x16x32_bf16 v[104:107], v[68:71], v[16:19], 0
  ds_read_b128 v[64:67], v6 offset:2048
  v_mfma_f32_16x16x32_bf16 v[108:111], v[72:75], v[16:19], 0
  ds_read_b128 v[68:71], v6 offset:22528
  s_waitcnt lgkmcnt(6)
  v_mfma_f32_16x16x32_bf16 v[112:115], v[76:79], v[16:19], 0
  ds_read_b128 v[72:75], v6 offset:43008
  s_waitcnt vmcnt(9)
  v_mfma_f32_16x16x32_bf16 v[96:99], v[80:83], v[20:23], v[96:99]
  ds_read_b128 v[76:79], v7 offset:2048
  buffer_load_dwordx4 v[16:19], v2, s[4:7], s15 offen offset:3072 sc1
  s_waitcnt lgkmcnt(6)
  v_mfma_f32_16x16x32_bf16 v[100:103], v[84:87], v[20:23], v[100:103]
  ds_read_b128 v[80:83], v7 offset:22528
  v_mfma_f32_16x16x32_bf16 v[104:107], v[88:91], v[20:23], v[104:107]
  ds_read_b128 v[84:87], v6 offset:3072
  s_waitcnt lgkmcnt(6)
  v_mfma_f32_16x16x32_bf16 v[108:111], v[92:95], v[20:23], v[108:111]
  ds_read_b128 v[88:91], v6 offset:23552
  v_mfma_f32_16x16x32_bf16 v[112:115], v[60:63], v[20:23], v[112:115]
  ds_read_b128 v[92:95], v6 offset:44032
  s_waitcnt vmcnt(9)
  s_waitcnt lgkmcnt(6)
  v_mfma_f32_16x16x32_bf16 v[96:99], v[64:67], v[24:27], v[96:99]
  ds_read_b128 v[60:63], v7 offset:3072
  s_add_u32 s15, s20, 12288
  buffer_load_dwordx4 v[20:23], v2, s[4:7], s15 offen offset:0 sc1
  v_mfma_f32_16x16x32_bf16 v[100:103], v[68:71], v[24:27], v[100:103]
  ds_read_b128 v[64:67], v7 offset:23552
  s_waitcnt lgkmcnt(6)
  v_mfma_f32_16x16x32_bf16 v[104:107], v[72:75], v[24:27], v[104:107]
  ds_read_b128 v[68:71], v6 offset:4096
  v_mfma_f32_16x16x32_bf16 v[108:111], v[76:79], v[24:27], v[108:111]
  ds_read_b128 v[72:75], v6 offset:24576
  s_waitcnt lgkmcnt(6)
  v_mfma_f32_16x16x32_bf16 v[112:115], v[80:83], v[24:27], v[112:115]
  ds_read_b128 v[76:79], v6 offset:45056
  s_waitcnt vmcnt(9)
  v_mfma_f32_16x16x32_bf16 v[96:99], v[84:87], v[28:31], v[96:99]
  ds_read_b128 v[80:83], v7 offset:4096
  buffer_load_dwordx4 v[24:27], v2, s[4:7], s15 offen offset:1024 sc1
  s_waitcnt lgkmcnt(6)
  v_mfma_f32_16x16x32_bf16 v[100:103], v[88:91], v[28:31], v[100:103]
  ds_read_b128 v[84:87], v7 offset:24576
  v_mfma_f32_16x16x32_bf16 v[104:107], v[92:95], v[28:31], v[104:107]
  ds_read_b128 v[88:91], v6 offset:5120
  s_waitcnt lgkmcnt(6)
  v_mfma_f32_16x16x32_bf16 v[108:111], v[60:63], v[28:31], v[108:111]
  ds_read_b128 v[92:95], v6 offset:25600
  v_mfma_f32_16x16x32_bf16 v[112:115], v[64:67], v[28:31], v[112:115]
  ds_read_b128 v[60:63], v6 offset:46080
  s_waitcnt vmcnt(9)
  s_waitcnt lgkmcnt(6)
  v_mfma_f32_16x16x32_bf16 v[96:99], v[68:71], v[32:35], v[96:99]
  ds_read_b128 v[64:67], v7 offset:5120
  buffer_load_dwordx4 v[28:31], v2, s[4:7], s15 offen offset:2048 sc1
  v_mfma_f32_16x16x32_bf16 v[100:103], v[72:75], v[32:35], v[100:103]
  ds_read_b128 v[68:71], v7 offset:25600
  s_waitcnt lgkmcnt(6)
  v_mfma_f32_16x16x32_bf16 v[104:107], v[76:79], v[32:35], v[104:107]
  ds_read_b128 v[72:75], v6 offset:6144
  v_mfma_f32_16x16x32_bf16 v[108:111], v[80:83], v[32:35], v[108:111]
  ds_read_b128 v[76:79], v6 offset:26624
  s_waitcnt lgkmcnt(6)
  v_mfma_f32_16x16x32_bf16 v[112:115], v[84:87], v[32:35], v[112:115]
  ds_read_b128 v[80:83], v6 offset:47104
  s_waitcnt vmcnt(9)
  v_mfma_f32_16x16x32_bf16 v[96:99], v[88:91], v[36:39], v[96:99]
  ds_read_b128 v[84:87], v7 offset:6144
  buffer_load_dwordx4 v[32:35], v2, s[4:7], s15 offen offset:3072 sc1
  s_waitcnt lgkmcnt(6)
  v_mfma_f32_16x16x32_bf16 v[100:103], v[92:95], v[36:39], v[100:103]
  ds_read_b128 v[88:91], v7 offset:26624
  v_mfma_f32_16x16x32_bf16 v[104:107], v[60:63], v[36:39], v[104:107]
  ds_read_b128 v[92:95], v6 offset:7168
  s_waitcnt lgkmcnt(6)
  v_mfma_f32_16x16x32_bf16 v[108:111], v[64:67], v[36:39], v[108:111]
  ds_read_b128 v[60:63], v6 offset:27648
  v_mfma_f32_16x16x32_bf16 v[112:115], v[68:71], v[36:39], v[112:115]
  ds_read_b128 v[64:67], v6 offset:48128
  s_waitcnt vmcnt(9)
  s_waitcnt lgkmcnt(6)
  v_mfma_f32_16x16x32_bf16 v[96:99], v[72:75], v[40:43], v[96:99]
  ds_read_b128 v[68:71], v7 offset:7168
  s_add_u32 s15, s20, 16384
  buffer_load_dwordx4 v[36:39], v2, s[4:7], s15 offen offset:0 sc1
  v_mfma_f32_16x16x32_bf16 v[100:103], v[76:79], v[40:43], v[100:103]
  ds_read_b128 v[72:75], v7 offset:27648
  s_waitcnt lgkmcnt(6)
  v_mfma_f32_16x16x32_bf16 v[104:107], v[80:83], v[40:43], v[104:107]
  ds_read_b128 v[76:79], v6 offset:8192
  v_mfma_f32_16x16x32_bf16 v[108:111], v[84:87], v[40:43], v[108:111]
  ds_read_b128 v[80:83], v6 offset:28672
  s_waitcnt lgkmcnt(6)
  v_mfma_f32_16x16x32_bf16 v[112:115], v[88:91], v[40:43], v[112:115]
  ds_read_b128 v[84:87], v6 offset:49152
  s_waitcnt vmcnt(9)
  v_mfma_f32_16x16x32_bf16 v[96:99], v[92:95], v[44:47], v[96:99]
  ds_read_b128 v[88:91], v7 offset:8192
  buffer_load_dwordx4 v[40:43], v2, s[4:7], s15 offen offset:1024 sc1
  s_waitcnt lgkmcnt(6)
  v_mfma_f32_16x16x32_bf16 v[100:103], v[60:63], v[44:47], v[100:103]
  ds_read_b128 v[92:95], v7 offset:28672
  v_mfma_f32_16x16x32_bf16 v[104:107], v[64:67], v[44:47], v[104:107]
  ds_read_b128 v[60:63], v6 offset:9216
  s_waitcnt lgkmcnt(6)
  v_mfma_f32_16x16x32_bf16 v[108:111], v[68:71], v[44:47], v[108:111]
  ds_read_b128 v[64:67], v6 offset:29696
  v_mfma_f32_16x16x32_bf16 v[112:115], v[72:75], v[44:47], v[112:115]
  ds_read_b128 v[68:71], v6 offset:50176
  s_waitcnt vmcnt(9)
  s_waitcnt lgkmcnt(6)
  v_mfma_f32_16x16x32_bf16 v[96:99], v[76:79], v[48:51], v[96:99]
  ds_read_b128 v[72:75], v7 offset:9216
  buffer_load_dwordx4 v[44:47], v2, s[4:7], s15 offen offset:2048 sc1
  v_mfma_f32_16x16x32_bf16 v[100:103], v[80:83], v[48:51], v[100:103]
  ds_read_b128 v[76:79], v7 offset:29696
  s_waitcnt lgkmcnt(6)
  v_mfma_f32_16x16x32_bf16 v[104:107], v[84:87], v[48:51], v[104:107]
  ds_read_b128 v[80:83], v6 offset:10240
  v_mfma_f32_16x16x32_bf16 v[108:111], v[88:91], v[48:51], v[108:111]
  ds_read_b128 v[84:87], v6 offset:30720
  s_waitcnt lgkmcnt(6)
  v_mfma_f32_16x16x32_bf16 v[112:115], v[92:95], v[48:51], v[112:115]
  ds_read_b128 v[88:91], v6 offset:51200
  s_waitcnt vmcnt(9)
  v_mfma_f32_16x16x32_bf16 v[96:99], v[60:63], v[52:55], v[96:99]
  ds_read_b128 v[92:95], v7 offset:10240
  buffer_load_dwordx4 v[48:51], v2, s[4:7], s15 offen offset:3072 sc1
  s_waitcnt lgkmcnt(6)
  v_mfma_f32_16x16x32_bf16 v[100:103], v[64:67], v[52:55], v[100:103]
  ds_read_b128 v[60:63], v7 offset:30720
  v_mfma_f32_16x16x32_bf16 v[104:107], v[68:71], v[52:55], v[104:107]
  ds_read_b128 v[64:67], v6 offset:11264
  s_waitcnt lgkmcnt(6)
  v_mfma_f32_16x16x32_bf16 v[108:111], v[72:75], v[52:55], v[108:111]
  ds_read_b128 v[68:71], v6 offset:31744
  v_mfma_f32_16x16x32_bf16 v[112:115], v[76:79], v[52:55], v[112:115]
  ds_read_b128 v[72:75], v6 offset:52224
  s_waitcnt vmcnt(9)
  s_waitcnt lgkmcnt(6)
  v_mfma_f32_16x16x32_bf16 v[96:99], v[80:83], v[56:59], v[96:99]
  ds_read_b128 v[76:79], v7 offset:11264
  v_mfma_f32_16x16x32_bf16 v[100:103], v[84:87], v[56:59], v[100:103]
  ds_read_b128 v[80:83], v7 offset:31744
  s_waitcnt lgkmcnt(6)
  v_mfma_f32_16x16x32_bf16 v[104:107], v[88:91], v[56:59], v[104:107]
  ds_read_b128 v[84:87], v6 offset:12288
  v_mfma_f32_16x16x32_bf16 v[108:111], v[92:95], v[56:59], v[108:111]
  ds_read_b128 v[88:91], v6 offset:32768
  s_waitcnt lgkmcnt(6)
  v_mfma_f32_16x16x32_bf16 v[112:115], v[60:63], v[56:59], v[112:115]
  ds_read_b128 v[92:95], v6 offset:53248
  s_waitcnt vmcnt(8)
  v_mfma_f32_16x16x32_bf16 v[96:99], v[64:67], v[16:19], v[96:99]
  ds_read_b128 v[60:63], v7 offset:12288
  s_waitcnt lgkmcnt(6)
  v_mfma_f32_16x16x32_bf16 v[100:103], v[68:71], v[16:19], v[100:103]
  ds_read_b128 v[64:67], v7 offset:32768
  v_mfma_f32_16x16x32_bf16 v[104:107], v[72:75], v[16:19], v[104:107]
  ds_read_b128 v[68:71], v6 offset:13312
  s_waitcnt lgkmcnt(6)
  v_mfma_f32_16x16x32_bf16 v[108:111], v[76:79], v[16:19], v[108:111]
  ds_read_b128 v[72:75], v6 offset:33792
  v_mfma_f32_16x16x32_bf16 v[112:115], v[80:83], v[16:19], v[112:115]
  ds_read_b128 v[76:79], v6 offset:54272
  s_waitcnt vmcnt(7)
  s_waitcnt lgkmcnt(6)
  v_mfma_f32_16x16x32_bf16 v[96:99], v[84:87], v[20:23], v[96:99]
  ds_read_b128 v[80:83], v7 offset:13312
  v_mfma_f32_16x16x32_bf16 v[100:103], v[88:91], v[20:23], v[100:103]
  ds_read_b128 v[84:87], v7 offset:33792
  s_waitcnt lgkmcnt(6)
  v_mfma_f32_16x16x32_bf16 v[104:107], v[92:95], v[20:23], v[104:107]
  ds_read_b128 v[88:91], v6 offset:14336
  v_mfma_f32_16x16x32_bf16 v[108:111], v[60:63], v[20:23], v[108:111]
  ds_read_b128 v[92:95], v6 offset:34816
  s_waitcnt lgkmcnt(6)
  v_mfma_f32_16x16x32_bf16 v[112:115], v[64:67], v[20:23], v[112:115]
  ds_read_b128 v[60:63], v6 offset:55296
  s_waitcnt vmcnt(6)
  v_mfma_f32_16x16x32_bf16 v[96:99], v[68:71], v[24:27], v[96:99]
  ds_read_b128 v[64:67], v7 offset:14336
  s_waitcnt lgkmcnt(6)
  v_mfma_f32_16x16x32_bf16 v[100:103], v[72:75], v[24:27], v[100:103]
  ds_read_b128 v[68:71], v7 offset:34816
  v_mfma_f32_16x16x32_bf16 v[104:107], v[76:79], v[24:27], v[104:107]
  ds_read_b128 v[72:75], v6 offset:15360
  s_waitcnt lgkmcnt(6)
  v_mfma_f32_16x16x32_bf16 v[108:111], v[80:83], v[24:27], v[108:111]
  ds_read_b128 v[76:79], v6 offset:35840
  v_mfma_f32_16x16x32_bf16 v[112:115], v[84:87], v[24:27], v[112:115]
  ds_read_b128 v[80:83], v6 offset:56320
  s_waitcnt vmcnt(5)
  s_waitcnt lgkmcnt(6)
  v_mfma_f32_16x16x32_bf16 v[96:99], v[88:91], v[28:31], v[96:99]
  ds_read_b128 v[84:87], v7 offset:15360
  v_mfma_f32_16x16x32_bf16 v[100:103], v[92:95], v[28:31], v[100:103]
  ds_read_b128 v[88:91], v7 offset:35840
  s_waitcnt lgkmcnt(6)
  v_mfma_f32_16x16x32_bf16 v[104:107], v[60:63], v[28:31], v[104:107]
  ds_read_b128 v[92:95], v6 offset:16384
  v_mfma_f32_16x16x32_bf16 v[108:111], v[64:67], v[28:31], v[108:111]
  ds_read_b128 v[60:63], v6 offset:36864
  s_waitcnt lgkmcnt(6)
  v_mfma_f32_16x16x32_bf16 v[112:115], v[68:71], v[28:31], v[112:115]
  ds_read_b128 v[64:67], v6 offset:57344
  s_waitcnt vmcnt(4)
  v_mfma_f32_16x16x32_bf16 v[96:99], v[72:75], v[32:35], v[96:99]
  ds_read_b128 v[68:71], v7 offset:16384
  s_waitcnt lgkmcnt(6)
  v_mfma_f32_16x16x32_bf16 v[100:103], v[76:79], v[32:35], v[100:103]
  ds_read_b128 v[72:75], v7 offset:36864
  v_mfma_f32_16x16x32_bf16 v[104:107], v[80:83], v[32:35], v[104:107]
  ds_read_b128 v[76:79], v6 offset:17408
  s_waitcnt lgkmcnt(6)
  v_mfma_f32_16x16x32_bf16 v[108:111], v[84:87], v[32:35], v[108:111]
  ds_read_b128 v[80:83], v6 offset:37888
  v_mfma_f32_16x16x32_bf16 v[112:115], v[88:91], v[32:35], v[112:115]
  ds_read_b128 v[84:87], v6 offset:58368
  s_waitcnt vmcnt(3)
  s_waitcnt lgkmcnt(6)
  v_mfma_f32_16x16x32_bf16 v[96:99], v[92:95], v[36:39], v[96:99]
  ds_read_b128 v[88:91], v7 offset:17408
  v_mfma_f32_16x16x32_bf16 v[100:103], v[60:63], v[36:39], v[100:103]
  ds_read_b128 v[92:95], v7 offset:37888
  s_waitcnt lgkmcnt(6)
  v_mfma_f32_16x16x32_bf16 v[104:107], v[64:67], v[36:39], v[104:107]
  ds_read_b128 v[60:63], v6 offset:18432
  v_mfma_f32_16x16x32_bf16 v[108:111], v[68:71], v[36:39], v[108:111]
  ds_read_b128 v[64:67], v6 offset:38912
  s_waitcnt lgkmcnt(6)
  v_mfma_f32_16x16x32_bf16 v[112:115], v[72:75], v[36:39], v[112:115]
  ds_read_b128 v[68:71], v6 offset:59392
  s_waitcnt vmcnt(2)
  v_mfma_f32_16x16x32_bf16 v[96:99], v[76:79], v[40:43], v[96:99]
  ds_read_b128 v[72:75], v7 offset:18432
  s_waitcnt lgkmcnt(6)
  v_mfma_f32_16x16x32_bf16 v[100:103], v[80:83], v[40:43], v[100:103]
  ds_read_b128 v[76:79], v7 offset:38912
  v_mfma_f32_16x16x32_bf16 v[104:107], v[84:87], v[40:43], v[104:107]
  ds_read_b128 v[80:83], v6 offset:19456
  s_waitcnt lgkmcnt(6)
  v_mfma_f32_16x16x32_bf16 v[108:111], v[88:91], v[40:43], v[108:111]
  ds_read_b128 v[84:87], v6 offset:39936
  v_mfma_f32_16x16x32_bf16 v[112:115], v[92:95], v[40:43], v[112:115]
  ds_read_b128 v[88:91], v6 offset:60416
  s_waitcnt vmcnt(1)
  s_waitcnt lgkmcnt(6)
  v_mfma_f32_16x16x32_bf16 v[96:99], v[60:63], v[44:47], v[96:99]
  ds_read_b128 v[92:95], v7 offset:19456
  v_mfma_f32_16x16x32_bf16 v[100:103], v[64:67], v[44:47], v[100:103]
  ds_read_b128 v[60:63], v7 offset:39936
  s_waitcnt lgkmcnt(6)
  v_mfma_f32_16x16x32_bf16 v[104:107], v[68:71], v[44:47], v[104:107]
  v_mfma_f32_16x16x32_bf16 v[108:111], v[72:75], v[44:47], v[108:111]
  s_waitcnt lgkmcnt(4)
  v_mfma_f32_16x16x32_bf16 v[112:115], v[76:79], v[44:47], v[112:115]
  s_waitcnt vmcnt(0)
  v_mfma_f32_16x16x32_bf16 v[96:99], v[80:83], v[48:51], v[96:99]
  s_waitcnt lgkmcnt(2)
  v_mfma_f32_16x16x32_bf16 v[100:103], v[84:87], v[48:51], v[100:103]
  v_mfma_f32_16x16x32_bf16 v[104:107], v[88:91], v[48:51], v[104:107]
  s_waitcnt lgkmcnt(0)
  v_mfma_f32_16x16x32_bf16 v[108:111], v[92:95], v[48:51], v[108:111]
  v_mfma_f32_16x16x32_bf16 v[112:115], v[60:63], v[48:51], v[112:115]
  v_lshlrev_b32 v10, 16, v120
  v_and_b32 v11, s29, v120
  v_pk_add_f32 v[96:97], v[96:97], v[10:11]
  v_cvt_pk_bf16_f32 v120, v96, v97
  v_lshlrev_b32 v10, 16, v121
  v_and_b32 v11, s29, v121
  v_pk_add_f32 v[98:99], v[98:99], v[10:11]
  v_cvt_pk_bf16_f32 v121, v98, v99
  v_lshlrev_b32 v10, 16, v122
  v_and_b32 v11, s29, v122
  v_pk_add_f32 v[100:101], v[100:101], v[10:11]
  v_cvt_pk_bf16_f32 v122, v100, v101
  v_lshlrev_b32 v10, 16, v123
  v_and_b32 v11, s29, v123
  v_pk_add_f32 v[102:103], v[102:103], v[10:11]
  v_cvt_pk_bf16_f32 v123, v102, v103
  v_lshlrev_b32 v10, 16, v124
  v_and_b32 v11, s29, v124
  v_pk_add_f32 v[104:105], v[104:105], v[10:11]
  v_cvt_pk_bf16_f32 v124, v104, v105
  v_lshlrev_b32 v10, 16, v125
  v_and_b32 v11, s29, v125
  v_pk_add_f32 v[106:107], v[106:107], v[10:11]
  v_cvt_pk_bf16_f32 v125, v106, v107
  v_lshlrev_b32 v10, 16, v126
  v_and_b32 v11, s29, v126
  v_pk_add_f32 v[108:109], v[108:109], v[10:11]
  v_cvt_pk_bf16_f32 v126, v108, v109
  v_lshlrev_b32 v10, 16, v127
  v_and_b32 v11, s29, v127
  v_pk_add_f32 v[110:111], v[110:111], v[10:11]
  v_cvt_pk_bf16_f32 v127, v110, v111
  v_lshlrev_b32 v10, 16, v128
  v_and_b32 v11, s29, v128
  v_pk_add_f32 v[112:113], v[112:113], v[10:11]
  v_cvt_pk_bf16_f32 v128, v112, v113
  v_lshlrev_b32 v10, 16, v129
  v_and_b32 v11, s29, v129
  v_pk_add_f32 v[114:115], v[114:115], v[10:11]
  v_cvt_pk_bf16_f32 v129, v114, v115
  s_cmp_eq_u32 s70, 0
  s_cbranch_scc1 mega_b_mid
  v_mul_u32_u24 v6, 1280, v4
  v_lshl_add_u32 v6, v5, 3, v6
  s_mul_i32 s15, s9, 160
  s_add_u32 s15, s15, s11
  s_waitcnt lgkmcnt(0)
  buffer_store_dwordx2 v[120:121], v6, s[24:27], s15 offen offset:0
  buffer_store_dwordx2 v[122:123], v6, s[24:27], s15 offen offset:32
  buffer_store_dwordx2 v[124:125], v6, s[24:27], s15 offen offset:64
  buffer_store_dwordx2 v[126:127], v6, s[24:27], s15 offen offset:96
  buffer_store_dwordx2 v[128:129], v6, s[24:27], s15 offen offset:128
  s_branch mega_b_done
mega_b_mid:
  v_pk_add_f32 v[8:9], v[96:97], v[98:99]
  v_pk_add_f32 v[8:9], v[8:9], v[100:101]
  v_pk_add_f32 v[8:9], v[8:9], v[102:103]
  v_pk_add_f32 v[8:9], v[8:9], v[104:105]
  v_pk_add_f32 v[8:9], v[8:9], v[106:107]
  v_pk_add_f32 v[8:9], v[8:9], v[108:109]
  v_pk_add_f32 v[8:9], v[8:9], v[110:111]
  v_pk_add_f32 v[8:9], v[8:9], v[112:113]
  v_pk_add_f32 v[8:9], v[8:9], v[114:115]
  v_add_f32 v8, v8, v9
  v_mov_b32 v10, v8
  s_nop 1
  v_permlane16_swap_b32 v8, v10
  v_add_f32 v8, v8, v10
  v_mov_b32 v10, v8
  s_nop 1
  v_permlane32_swap_b32 v8, v10
  v_add_f32 v8, v8, v10
  v_mul_f32 v8, 0x3c4ccccd, v8
  v_sub_f32 v10, v96, v8
  v_mul_f32 v9, v10, v10
  v_sub_f32 v10, v97, v8
  v_fmac_f32 v9, v10, v10
  v_sub_f32 v10, v98, v8
  v_fmac_f32 v9, v10, v10
  v_sub_f32 v10, v99, v8
  v_fmac_f32 v9, v10, v10
  v_sub_f32 v10, v100, v8
  v_fmac_f32 v9, v10, v10
  v_sub_f32 v10, v101, v8
  v_fmac_f32 v9, v10, v10
  v_sub_f32 v10, v102, v8
  v_fmac_f32 v9, v10, v10
  v_sub_f32 v10, v103, v8
  v_fmac_f32 v9, v10, v10
  v_sub_f32 v10, v104, v8
  v_fmac_f32 v9, v10, v10
  v_sub_f32 v10, v105, v8
  v_fmac_f32 v9, v10, v10
  v_sub_f32 v10, v106, v8
  v_fmac_f32 v9, v10, v10
  v_sub_f32 v10, v107, v8
  v_fmac_f32 v9, v10, v10
  v_sub_f32 v10, v108, v8
  v_fmac_f32 v9, v10, v10
  v_sub_f32 v10, v109, v8
  v_fmac_f32 v9, v10, v10
  v_sub_f32 v10, v110, v8
  v_fmac_f32 v9, v10, v10
  v_sub_f32 v10, v111, v8
  v_fmac_f32 v9, v10, v10
  v_sub_f32 v10, v112, v8
  v_fmac_f32 v9, v10, v10
  v_sub_f32 v10, v113, v8
  v_fmac_f32 v9, v10, v10
  v_sub_f32 v10, v114, v8
  v_fmac_f32 v9, v10, v10
  v_sub_f32 v10, v115, v8
  v_fmac_f32 v9, v10, v10
  v_mov_b32 v10, v9
  s_nop 1
  v_permlane16_swap_b32 v9, v10
  v_add_f32 v9, v9, v10
  v_mov_b32 v10, v9
  s_nop 1
  v_permlane32_swap_b32 v9, v10
  v_add_f32 v9, v9, v10
  v_and_b32 v8, -2, v8
  v_and_b32 v9, -2, v9
  s_mov_b32 s15, s40
  s_lshl_b32 s16, s9, 7
  s_add_u32 s16, s16, s15
  v_lshlrev_b32 v6, 3, v4
  s_mov_b64 exec, 0xffff
  s_cmp_lg_u32 s69, 0
  s_cbranch_scc1 mega_kernel_ls41
  buffer_store_dwordx2 v[8:9], v6, s[4:7], s16 offen
mega_kernel_ls41_b:
  s_mov_b64 exec, -1
  v_lshl_add_u32 v6, v5, 8, v6
  s_mul_i32 s18, s9, 2560
  s_add_u32 s18, s18, s11
  s_add_u32 s19, s18, 33570816
  s_add_u32 s18, s18, 2662400
  s_mov_b32 s30, 0
mega_kernel_st42:
  buffer_load_dwordx2 v[16:17], v6, s[4:7], s15 offen offset:0 sc1
  buffer_load_dwordx2 v[18:19], v6, s[4:7], s15 offen offset:128 sc1
  s_waitcnt vmcnt(0)
  v_or3_b32 v10, v16, v17, v18
  v_or_b32 v10, v10, v19
  v_and_b32 v10, 1, v10
  v_cmp_ne_u32 vcc, 0, v10
  s_nop 0
  s_cbranch_vccz mega_kernel_st42_ok
  s_add_u32 s30, s30, 1
  s_cmp_lt_u32 s30, 262144
  s_cbranch_scc1 mega_kernel_st42
  s_branch mega_fail
mega_kernel_st42_ok:
  v_add_f32 v9, v16, v18
  v_mov_b32 v10, v9
  s_nop 1
  v_permlane16_swap_b32 v9, v10
  v_add_f32 v9, v9, v10
  v_mov_b32 v10, v9
  s_nop 1
  v_permlane32_swap_b32 v9, v10
  v_add_f32 v9, v9, v10
  v_mul_f32 v9, 0x3e000000, v9
  v_sub_f32 v10, v16, v9
  v_mul_f32 v8, v10, v10
  v_sub_f32 v10, v18, v9
  v_fmac_f32 v8, v10, v10
  v_mul_f32 v8, 0x42a00000, v8
  v_add_f32 v8, v8, v17
  v_add_f32 v8, v8, v19
  v_mov_b32 v10, v8
  s_nop 1
  v_permlane16_swap_b32 v8, v10
  v_add_f32 v8, v8, v10
  v_mov_b32 v10, v8
  s_nop 1
  v_permlane32_swap_b32 v8, v10
  v_add_f32 v8, v8, v10
  v_mov_b32 v10, 0x3727c5ac
  v_fmac_f32 v10, 0x3acccccd, v8
  v_rsq_f32 v8, v10
  s_nop 0
  v_mul_f32 v9, v9, v8
  v_sub_f32 v9, 0, v9
  v_fma_f32 v96, v96, v8, v9
  v_fma_f32 v97, v97, v8, v9
  v_fma_f32 v98, v98, v8, v9
  v_fma_f32 v99, v99, v8, v9
  v_cvt_pk_bf16_f32 v20, v96, v97
  v_cvt_pk_bf16_f32 v21, v98, v99
  buffer_store_dwordx2 v[20:21], v12, s[4:7], s18 offen offset:0 sc1
  v_fma_f32 v100, v100, v8, v9
  v_fma_f32 v101, v101, v8, v9
  v_fma_f32 v102, v102, v8, v9
  v_fma_f32 v103, v103, v8, v9
  v_cvt_pk_bf16_f32 v22, v100, v101
  v_cvt_pk_bf16_f32 v23, v102, v103
  buffer_store_dwordx2 v[22:23], v12, s[4:7], s18 offen offset:512 sc1
  v_fma_f32 v104, v104, v8, v9
  v_fma_f32 v105, v105, v8, v9
  v_fma_f32 v106, v106, v8, v9
  v_fma_f32 v107, v107, v8, v9
  v_cvt_pk_bf16_f32 v24, v104, v105
  v_cvt_pk_bf16_f32 v25, v106, v107
  buffer_store_dwordx2 v[24:25], v12, s[4:7], s18 offen offset:1024 sc1
  v_fma_f32 v108, v108, v8, v9
  v_fma_f32 v109, v109, v8, v9
  v_fma_f32 v110, v110, v8, v9
  v_fma_f32 v111, v111, v8, v9
  v_cvt_pk_bf16_f32 v26, v108, v109
  v_cvt_pk_bf16_f32 v27, v110, v111
  buffer_store_dwordx2 v[26:27], v12, s[4:7], s18 offen offset:1536 sc1
  v_fma_f32 v112, v112, v8, v9
  v_fma_f32 v113, v113, v8, v9
  v_fma_f32 v114, v114, v8, v9
  v_fma_f32 v115, v115, v8, v9
  v_cvt_pk_bf16_f32 v28, v112, v113
  v_cvt_pk_bf16_f32 v29, v114, v115
  buffer_store_dwordx2 v[28:29], v12, s[4:7], s18 offen offset:2048 sc1
  buffer_store_dwordx2 v[120:121], v12, s[4:7], s19 offen offset:0 sc1
  buffer_store_dwordx2 v[122:123], v12, s[4:7], s19 offen offset:512 sc1
  buffer_store_dwordx2 v[124:125], v12, s[4:7], s19 offen offset:1024 sc1
  buffer_store_dwordx2 v[126:127], v12, s[4:7], s19 offen offset:1536 sc1
  buffer_store_dwordx2 v[128:129], v12, s[4:7], s19 offen offset:2048 sc1
  s_waitcnt vmcnt(0)
  buffer_store_dword v14, v15, s[4:7], s17 offen offset:32 sc1
mega_b_done:
  s_cmp_lg_u32 s70, 0
  s_cbranch_scc1 mega_end
  s_mov_b32 s70, 1
  s_mov_b32 s71, 53583872
  s_add_u32 s84, s4, 33570816
  s_addc_u32 s85, s5, 0
  s_barrier
  s_cmp_lt_u32 s2, 128
  s_cbranch_scc1 mega_rec_layer
  s_cmp_eq_u32 s81, 2
  s_cbranch_scc1 mega_q_layer
  s_cmp_eq_u32 s81, 3
  s_cbranch_scc1 mega_u_layer
  s_branch mega_kv_layer
mega_kernel_ls37:
  buffer_store_dwordx4 v[56:59], v2, s[4:7], s39 offen sc1
  buffer_store_dwordx4 v[60:63], v2, s[4:7], s39 offen offset:1024 sc1
  buffer_store_dwordx2 v[64:65], v2, s[4:7], s38 offen offset:2048 sc1
  s_branch mega_kernel_ls37_b
mega_kernel_ls38:
  buffer_store_dwordx4 v[58:61], v2, s[4:7], s39 offen sc1
  buffer_store_dwordx4 v[62:65], v2, s[4:7], s39 offen offset:1024 sc1
  buffer_store_dwordx2 v[56:57], v2, s[4:7], s38 offen offset:2048 sc1
  s_branch mega_kernel_ls38_b
mega_kernel_ls39:
  buffer_store_dword v14, v15, s[4:7], s41 offen sc1
  s_branch mega_kernel_ls39_b
mega_kernel_ls41:
  buffer_store_dwordx2 v[8:9], v6, s[4:7], s16 offen sc1
  s_branch mega_kernel_ls41_b
mega_rec:
  s_mov_b64 s[52:53], s[12:13]
  s_mov_b64 s[56:57], s[14:15]
  s_mov_b32 s54, 0x780000
  s_mov_b32 s55, 0x20000
  s_mov_b32 s58, 0x780000
  s_mov_b32 s59, 0x20000
  s_lshr_b32 s9, s2, 3
  s_lshr_b32 s10, s9, 2
  s_lshl_b32 s27, s68, 2
  s_add_u32 s10, s10, s27
  s_and_b32 s11, s9, 3
  s_add_u32 s27, s27, s3
  s_mul_i32 s60, s27, 245760
  s_mul_i32 s28, s9, 80
  s_add_u32 s60, s60, s28
  s_mul_i32 s61, s3, 25600
  s_add_u32 s61, s61, 61440
  s_mul_i32 s62, s27, 384
  v_mul_u32_u24 v10, 13108, v1
  v_lshrrev_b32 v10, 16, v10
  v_mul_u32_u24 v6, 5, v10
  v_sub_u32 v6, v1, v6
  v_lshlrev_b32 v6, 4, v6
  v_mul_u32_u24 v10, 1280, v10
  v_add_u32 v6, v6, v10
  v_lshrrev_b32 v10, 4, v1
  v_mul_u32_u24 v10, 8, v10
  v_bfe_u32 v7, v1, 2, 2
  v_add_u32 v10, v10, v7
  v_mul_u32_u24 v10, 80, v10
  v_and_b32 v7, 3, v1
  v_lshl_add_u32 v7, v7, 3, v10
  s_mul_i32 s64, s3, 15360
  v_add_u32 v7, s64, v7
  s_mov_b64 exec, s[82:83]
  s_add_u32 m0, s64, 0
  s_nop 0
  buffer_load_dwordx4 v6, s[56:59], s60 offen lds
  s_add_u32 s60, s60, 15360
  s_add_u32 m0, s64, 960
  s_nop 0
  buffer_load_dwordx4 v6, s[56:59], s60 offen lds
  s_add_u32 s60, s60, 15360
  s_add_u32 m0, s64, 1920
  s_nop 0
  buffer_load_dwordx4 v6, s[56:59], s60 offen lds
  s_add_u32 s60, s60, 15360
  s_add_u32 m0, s64, 2880
  s_nop 0
  buffer_load_dwordx4 v6, s[56:59], s60 offen lds
  s_add_u32 s60, s60, 15360
  s_add_u32 m0, s64, 3840
  s_nop 0
  buffer_load_dwordx4 v6, s[56:59], s60 offen lds
  s_add_u32 s60, s60, 15360
  s_add_u32 m0, s64, 4800
  s_nop 0
  buffer_load_dwordx4 v6, s[56:59], s60 offen lds
  s_add_u32 s60, s60, 15360
  s_add_u32 m0, s64, 5760
  s_nop 0
  buffer_load_dwordx4 v6, s[56:59], s60 offen lds
  s_add_u32 s60, s60, 15360
  s_add_u32 m0, s64, 6720
  s_nop 0
  buffer_load_dwordx4 v6, s[56:59], s60 offen lds
  s_add_u32 s60, s60, 15360
  s_add_u32 m0, s64, 7680
  s_nop 0
  buffer_load_dwordx4 v6, s[56:59], s60 offen lds
  s_add_u32 s60, s60, 15360
  s_add_u32 m0, s64, 8640
  s_nop 0
  buffer_load_dwordx4 v6, s[56:59], s60 offen lds
  s_add_u32 s60, s60, 15360
  s_add_u32 m0, s64, 9600
  s_nop 0
  buffer_load_dwordx4 v6, s[56:59], s60 offen lds
  s_add_u32 s60, s60, 15360
  s_add_u32 m0, s64, 10560
  s_nop 0
  buffer_load_dwordx4 v6, s[56:59], s60 offen lds
  s_add_u32 s60, s60, 15360
  s_add_u32 m0, s64, 11520
  s_nop 0
  buffer_load_dwordx4 v6, s[56:59], s60 offen lds
  s_add_u32 s60, s60, 15360
  s_add_u32 m0, s64, 12480
  s_nop 0
  buffer_load_dwordx4 v6, s[56:59], s60 offen lds
  s_add_u32 s60, s60, 15360
  s_add_u32 m0, s64, 13440
  s_nop 0
  buffer_load_dwordx4 v6, s[56:59], s60 offen lds
  s_add_u32 s60, s60, 15360
  s_add_u32 m0, s64, 14400
  s_nop 0
  buffer_load_dwordx4 v6, s[56:59], s60 offen lds
  s_add_u32 s60, s60, 15360
  s_mov_b64 exec, -1
  v_add_u32 v10, 0, v1
  v_mul_u32_u24 v11, 2731, v10
  v_lshrrev_b32 v11, 16, v11
  v_mul_u32_u24 v12, 24, v11
  v_sub_u32 v10, v10, v12
  v_mul_u32_u24 v11, 12288, v11
  v_lshl_add_u32 v2, v10, 4, v11
  v_add_u32 v10, 64, v1
  v_mul_u32_u24 v11, 2731, v10
  v_lshrrev_b32 v11, 16, v11
  v_mul_u32_u24 v12, 24, v11
  v_sub_u32 v10, v10, v12
  v_mul_u32_u24 v11, 12288, v11
  v_lshl_add_u32 v3, v10, 4, v11
  v_add_u32 v10, 128, v1
  v_mul_u32_u24 v11, 2731, v10
  v_lshrrev_b32 v11, 16, v11
  v_mul_u32_u24 v12, 24, v11
  v_sub_u32 v10, v10, v12
  v_mul_u32_u24 v11, 12288, v11
  v_lshl_add_u32 v4, v10, 4, v11
  s_add_u32 s63, s62, 0
  s_add_u32 m0, s61, 0
  s_nop 0
  buffer_load_dwordx4 v2, s[52:55], s63 offen lds
  s_add_u32 m0, s61, 1024
  s_nop 0
  buffer_load_dwordx4 v3, s[52:55], s63 offen lds
  s_add_u32 m0, s61, 2048
  s_nop 0
  buffer_load_dwordx4 v4, s[52:55], s63 offen lds
  s_add_u32 s63, s62, 98304
  s_add_u32 m0, s61, 3104
  s_nop 0
  buffer_load_dwordx4 v2, s[52:55], s63 offen lds
  s_add_u32 m0, s61, 4128
  s_nop 0
  buffer_load_dwordx4 v3, s[52:55], s63 offen lds
  s_add_u32 m0, s61, 5152
  s_nop 0
  buffer_load_dwordx4 v4, s[52:55], s63 offen lds
  s_add_u32 s63, s62, 196608
  s_add_u32 m0, s61, 6208
  s_nop 0
  buffer_load_dwordx4 v2, s[52:55], s63 offen lds
  s_add_u32 m0, s61, 7232
  s_nop 0
  buffer_load_dwordx4 v3, s[52:55], s63 offen lds
  s_add_u32 m0, s61, 8256
  s_nop 0
  buffer_load_dwordx4 v4, s[52:55], s63 offen lds
  s_add_u32 s63, s62, 294912
  s_add_u32 m0, s61, 9312
  s_nop 0
  buffer_load_dwordx4 v2, s[52:55], s63 offen lds
  s_add_u32 m0, s61, 10336
  s_nop 0
  buffer_load_dwordx4 v3, s[52:55], s63 offen lds
  s_add_u32 m0, s61, 11360
  s_nop 0
  buffer_load_dwordx4 v4, s[52:55], s63 offen lds
  s_add_u32 s63, s62, 491520
  s_add_u32 m0, s61, 12416
  s_nop 0
  buffer_load_dwordx4 v2, s[52:55], s63 offen lds
  s_add_u32 m0, s61, 13440
  s_nop 0
  buffer_load_dwordx4 v3, s[52:55], s63 offen lds
  s_add_u32 m0, s61, 14464
  s_nop 0
  buffer_load_dwordx4 v4, s[52:55], s63 offen lds
  s_add_u32 s63, s62, 589824
  s_add_u32 m0, s61, 15520
  s_nop 0
  buffer_load_dwordx4 v2, s[52:55], s63 offen lds
  s_add_u32 m0, s61, 16544
  s_nop 0
  buffer_load_dwordx4 v3, s[52:55], s63 offen lds
  s_add_u32 m0, s61, 17568
  s_nop 0
  buffer_load_dwordx4 v4, s[52:55], s63 offen lds
  s_add_u32 s63, s62, 688128
  s_add_u32 m0, s61, 18624
  s_nop 0
  buffer_load_dwordx4 v2, s[52:55], s63 offen lds
  s_add_u32 m0, s61, 19648
  s_nop 0
  buffer_load_dwordx4 v3, s[52:55], s63 offen lds
  s_add_u32 m0, s61, 20672
  s_nop 0
  buffer_load_dwordx4 v4, s[52:55], s63 offen lds
  s_add_u32 s63, s62, 786432
  s_add_u32 m0, s61, 21728
  s_nop 0
  buffer_load_dwordx4 v2, s[52:55], s63 offen lds
  s_add_u32 m0, s61, 22752
  s_nop 0
  buffer_load_dwordx4 v3, s[52:55], s63 offen lds
  s_add_u32 m0, s61, 23776
  s_nop 0
  buffer_load_dwordx4 v4, s[52:55], s63 offen lds
  s_getreg_b32 s27, hwreg(HW_REG_XCC_ID)
  s_and_b32 s27, s27, 7
  s_mul_i32 s28, s27, s27
  s_lshl_b32 s28, s28, 14
  s_lshl_b32 s27, s27, 6
  s_add_u32 s27, s27, s28
  s_add_u32 s69, s27, 1
  s_lshl_b32 s29, s68, 2
  s_cmp_eq_u32 s3, 0
  s_cselect_b32 s29, s29, 4096
  v_mov_b32 v89, s29
  v_mov_b32 v88, s69
  s_mov_b64 exec, 1
  buffer_atomic_add v88, v89, s[44:47], 0 offen sc0 sc1
  s_mov_b64 exec, -1
  v_bfe_u32 v10, v1, 3, 1
  v_bfe_u32 v11, v1, 1, 1
  v_lshl_add_u32 v10, v10, 1, v11
  v_mul_u32_u24 v5, 3104, v10
  v_bfe_u32 v10, v1, 2, 1
  v_and_b32 v11, 1, v1
  v_lshl_add_u32 v10, v10, 2, v11
  v_mul_u32_u24 v10, 384, v10
  v_lshrrev_b32 v11, 4, v1
  v_lshl_add_u32 v10, v11, 4, v10
  v_add3_u32 v5, v5, v10, s61
  s_mul_i32 s48, s10, 384
  s_mul_i32 s28, s11, 96
  s_add_u32 s48, s48, s28
  s_mul_i32 s28, s3, 1966080
  s_add_u32 s48, s48, s28
  s_mov_b32 s49, s48
  s_mul_i32 s50, s3, 15360
  s_add_u32 s51, s50, 61440
  v_mul_u32_u24 v10, 10923, v1
  v_lshrrev_b32 v10, 16, v10
  v_mul_u32_u24 v8, 6, v10
  v_sub_u32 v8, v1, v8
  v_lshlrev_b32 v8, 4, v8
  v_mul_u32_u24 v10, 12288, v10
  v_add_u32 v8, v8, v10
  v_lshrrev_b32 v10, 4, v1
  v_mul_u32_u24 v10, 8, v10
  v_bfe_u32 v9, v1, 2, 2
  v_add_u32 v10, v10, v9
  v_mul_u32_u24 v10, 96, v10
  v_and_b32 v9, 3, v1
  v_lshl_add_u32 v9, v9, 3, v10
  s_waitcnt vmcnt(25)
  ds_read_b64_tr_b16 v[136:137], v7 offset:0
  ds_read_b64_tr_b16 v[138:139], v7 offset:320
  ds_read_b64_tr_b16 v[160:161], v7 offset:32
  ds_read_b64_tr_b16 v[162:163], v7 offset:352
  ds_read_b64_tr_b16 v[184:185], v7 offset:64
  ds_read_b64_tr_b16 v[186:187], v7 offset:384
  ds_read_b64_tr_b16 v[140:141], v7 offset:2560
  ds_read_b64_tr_b16 v[142:143], v7 offset:2880
  ds_read_b64_tr_b16 v[164:165], v7 offset:2592
  ds_read_b64_tr_b16 v[166:167], v7 offset:2912
  ds_read_b64_tr_b16 v[188:189], v7 offset:2624
  ds_read_b64_tr_b16 v[190:191], v7 offset:2944
  ds_read_b64_tr_b16 v[144:145], v7 offset:5120
  ds_read_b64_tr_b16 v[146:147], v7 offset:5440
  ds_read_b64_tr_b16 v[168:169], v7 offset:5152
  ds_read_b64_tr_b16 v[170:171], v7 offset:5472
  ds_read_b64_tr_b16 v[192:193], v7 offset:5184
  ds_read_b64_tr_b16 v[194:195], v7 offset:5504
  ds_read_b64_tr_b16 v[148:149], v7 offset:7680
  ds_read_b64_tr_b16 v[150:151], v7 offset:8000
  ds_read_b64_tr_b16 v[172:173], v7 offset:7712
  ds_read_b64_tr_b16 v[174:175], v7 offset:8032
  ds_read_b64_tr_b16 v[196:197], v7 offset:7744
  ds_read_b64_tr_b16 v[198:199], v7 offset:8064
  ds_read_b64_tr_b16 v[152:153], v7 offset:10240
  ds_read_b64_tr_b16 v[154:155], v7 offset:10560
  ds_read_b64_tr_b16 v[176:177], v7 offset:10272
  ds_read_b64_tr_b16 v[178:179], v7 offset:10592
  ds_read_b64_tr_b16 v[200:201], v7 offset:10304
  ds_read_b64_tr_b16 v[202:203], v7 offset:10624
  ds_read_b64_tr_b16 v[156:157], v7 offset:12800
  ds_read_b64_tr_b16 v[158:159], v7 offset:13120
  ds_read_b64_tr_b16 v[180:181], v7 offset:12832
  ds_read_b64_tr_b16 v[182:183], v7 offset:13152
  ds_read_b64_tr_b16 v[204:205], v7 offset:12864
  ds_read_b64_tr_b16 v[206:207], v7 offset:13184
  s_waitcnt vmcnt(13)
  ds_read_b128 v[16:19], v5 offset:0
  ds_read_b128 v[20:23], v5 offset:64
  ds_read_b128 v[24:27], v5 offset:128
  ds_read_b128 v[28:31], v5 offset:192
  ds_read_b128 v[32:35], v5 offset:256
  ds_read_b128 v[36:39], v5 offset:320
  s_waitcnt lgkmcnt(0)
  v_mfma_f32_16x16x32_bf16 v[64:67], v[16:19], v[136:139], 0
  ds_read_b128 v[40:43], v5 offset:768
  v_mfma_f32_16x16x32_bf16 v[68:71], v[16:19], v[160:163], 0
  ds_read_b128 v[44:47], v5 offset:832
  v_mfma_f32_16x16x32_bf16 v[72:75], v[16:19], v[184:187], 0
  ds_read_b128 v[48:51], v5 offset:896
  v_mfma_f32_16x16x32_bf16 v[64:67], v[20:23], v[140:143], v[64:67]
  ds_read_b128 v[52:55], v5 offset:960
  v_mfma_f32_16x16x32_bf16 v[68:71], v[20:23], v[164:167], v[68:71]
  ds_read_b128 v[56:59], v5 offset:1024
  v_mfma_f32_16x16x32_bf16 v[72:75], v[20:23], v[188:191], v[72:75]
  ds_read_b128 v[60:63], v5 offset:1088
  v_mfma_f32_16x16x32_bf16 v[64:67], v[24:27], v[144:147], v[64:67]
  v_mfma_f32_16x16x32_bf16 v[68:71], v[24:27], v[168:171], v[68:71]
  v_mfma_f32_16x16x32_bf16 v[72:75], v[24:27], v[192:195], v[72:75]
  v_mfma_f32_16x16x32_bf16 v[64:67], v[28:31], v[148:151], v[64:67]
  v_mfma_f32_16x16x32_bf16 v[68:71], v[28:31], v[172:175], v[68:71]
  v_mfma_f32_16x16x32_bf16 v[72:75], v[28:31], v[196:199], v[72:75]
  v_mfma_f32_16x16x32_bf16 v[64:67], v[32:35], v[152:155], v[64:67]
  v_mfma_f32_16x16x32_bf16 v[68:71], v[32:35], v[176:179], v[68:71]
  v_mfma_f32_16x16x32_bf16 v[72:75], v[32:35], v[200:203], v[72:75]
  v_mfma_f32_16x16x32_bf16 v[64:67], v[36:39], v[156:159], v[64:67]
  v_mfma_f32_16x16x32_bf16 v[68:71], v[36:39], v[180:183], v[68:71]
  v_mfma_f32_16x16x32_bf16 v[72:75], v[36:39], v[204:207], v[72:75]
  s_waitcnt lgkmcnt(0)
  s_waitcnt vmcnt(0)
  v_readfirstlane_b32 s27, v88
  s_nop 0
  s_and_b32 s28, s27, 63
  s_cmp_eq_u32 s28, 31
  s_cbranch_scc1 mega_kernel_cf43
mega_kernel_cf43_b:
  v_mfma_f32_16x16x32_bf16 v[76:79], v[40:43], v[136:139], 0
  ds_read_b128 v[16:19], v5 offset:12416
  v_mfma_f32_16x16x32_bf16 v[80:83], v[40:43], v[160:163], 0
  ds_read_b128 v[20:23], v5 offset:12480
  v_mfma_f32_16x16x32_bf16 v[84:87], v[40:43], v[184:187], 0
  ds_read_b128 v[24:27], v5 offset:12544
  v_mfma_f32_16x16x32_bf16 v[76:79], v[44:47], v[140:143], v[76:79]
  ds_read_b128 v[28:31], v5 offset:12608
  v_cvt_pk_bf16_f32 v64, v64, v65
  v_mfma_f32_16x16x32_bf16 v[80:83], v[44:47], v[164:167], v[80:83]
  ds_read_b128 v[32:35], v5 offset:12672
  v_cvt_pk_bf16_f32 v65, v66, v67
  v_mfma_f32_16x16x32_bf16 v[84:87], v[44:47], v[188:191], v[84:87]
  ds_read_b128 v[36:39], v5 offset:12736
  v_accvgpr_write_b32 a0, v64
  v_mfma_f32_16x16x32_bf16 v[76:79], v[48:51], v[144:147], v[76:79]
  s_add_u32 s63, s62, 983040
  s_add_u32 m0, s61, 0
  s_nop 0
  buffer_load_dwordx4 v2, s[52:55], s63 offen lds
  v_accvgpr_write_b32 a1, v65
  v_mfma_f32_16x16x32_bf16 v[80:83], v[48:51], v[168:171], v[80:83]
  s_add_u32 m0, s61, 1024
  s_nop 0
  buffer_load_dwordx4 v3, s[52:55], s63 offen lds
  v_cvt_pk_bf16_f32 v68, v68, v69
  v_mfma_f32_16x16x32_bf16 v[84:87], v[48:51], v[192:195], v[84:87]
  s_add_u32 m0, s61, 2048
  s_nop 0
  buffer_load_dwordx4 v4, s[52:55], s63 offen lds
  v_cvt_pk_bf16_f32 v69, v70, v71
  v_mfma_f32_16x16x32_bf16 v[76:79], v[52:55], v[148:151], v[76:79]
  s_add_u32 s63, s62, 1081344
  s_add_u32 m0, s61, 3104
  s_nop 0
  buffer_load_dwordx4 v2, s[52:55], s63 offen lds
  v_accvgpr_write_b32 a80, v68
  v_mfma_f32_16x16x32_bf16 v[80:83], v[52:55], v[172:175], v[80:83]
  s_add_u32 m0, s61, 4128
  s_nop 0
  buffer_load_dwordx4 v3, s[52:55], s63 offen lds
  v_accvgpr_write_b32 a81, v69
  v_mfma_f32_16x16x32_bf16 v[84:87], v[52:55], v[196:199], v[84:87]
  s_add_u32 m0, s61, 5152
  s_nop 0
  buffer_load_dwordx4 v4, s[52:55], s63 offen lds
  v_cvt_pk_bf16_f32 v72, v72, v73
  v_mfma_f32_16x16x32_bf16 v[76:79], v[56:59], v[152:155], v[76:79]
  s_add_u32 s63, s62, 1179648
  s_add_u32 m0, s61, 6208
  s_nop 0
  buffer_load_dwordx4 v2, s[52:55], s63 offen lds
  v_cvt_pk_bf16_f32 v73, v74, v75
  v_mfma_f32_16x16x32_bf16 v[80:83], v[56:59], v[176:179], v[80:83]
  s_add_u32 m0, s61, 7232
  s_nop 0
  buffer_load_dwordx4 v3, s[52:55], s63 offen lds
  v_accvgpr_write_b32 a160, v72
  v_mfma_f32_16x16x32_bf16 v[84:87], v[56:59], v[200:203], v[84:87]
  s_add_u32 m0, s61, 8256
  s_nop 0
  buffer_load_dwordx4 v4, s[52:55], s63 offen lds
  v_accvgpr_write_b32 a161, v73
  v_mfma_f32_16x16x32_bf16 v[76:79], v[60:63], v[156:159], v[76:79]
  s_add_u32 s63, s62, 1277952
  s_add_u32 m0, s61, 9312
  s_nop 0
  buffer_load_dwordx4 v2, s[52:55], s63 offen lds
  v_mfma_f32_16x16x32_bf16 v[80:83], v[60:63], v[180:183], v[80:83]
  s_add_u32 m0, s61, 10336
  s_nop 0
  buffer_load_dwordx4 v3, s[52:55], s63 offen lds
  v_mfma_f32_16x16x32_bf16 v[84:87], v[60:63], v[204:207], v[84:87]
  s_add_u32 m0, s61, 11360
  s_nop 0
  buffer_load_dwordx4 v4, s[52:55], s63 offen lds
  s_waitcnt lgkmcnt(0)
  v_mfma_f32_16x16x32_bf16 v[64:67], v[16:19], v[136:139], 0
  ds_read_b128 v[40:43], v5 offset:13184
  v_mfma_f32_16x16x32_bf16 v[68:71], v[16:19], v[160:163], 0
  ds_read_b128 v[44:47], v5 offset:13248
  v_mfma_f32_16x16x32_bf16 v[72:75], v[16:19], v[184:187], 0
  ds_read_b128 v[48:51], v5 offset:13312
  v_mfma_f32_16x16x32_bf16 v[64:67], v[20:23], v[140:143], v[64:67]
  ds_read_b128 v[52:55], v5 offset:13376
  v_cvt_pk_bf16_f32 v76, v76, v77
  v_mfma_f32_16x16x32_bf16 v[68:71], v[20:23], v[164:167], v[68:71]
  ds_read_b128 v[56:59], v5 offset:13440
  v_cvt_pk_bf16_f32 v77, v78, v79
  v_mfma_f32_16x16x32_bf16 v[72:75], v[20:23], v[188:191], v[72:75]
  ds_read_b128 v[60:63], v5 offset:13504
  v_accvgpr_write_b32 a2, v76
  v_mfma_f32_16x16x32_bf16 v[64:67], v[24:27], v[144:147], v[64:67]
  v_accvgpr_write_b32 a3, v77
  v_mfma_f32_16x16x32_bf16 v[68:71], v[24:27], v[168:171], v[68:71]
  v_cvt_pk_bf16_f32 v80, v80, v81
  v_mfma_f32_16x16x32_bf16 v[72:75], v[24:27], v[192:195], v[72:75]
  v_cvt_pk_bf16_f32 v81, v82, v83
  v_mfma_f32_16x16x32_bf16 v[64:67], v[28:31], v[148:151], v[64:67]
  v_accvgpr_write_b32 a82, v80
  v_mfma_f32_16x16x32_bf16 v[68:71], v[28:31], v[172:175], v[68:71]
  v_accvgpr_write_b32 a83, v81
  v_mfma_f32_16x16x32_bf16 v[72:75], v[28:31], v[196:199], v[72:75]
  v_cvt_pk_bf16_f32 v84, v84, v85
  v_mfma_f32_16x16x32_bf16 v[64:67], v[32:35], v[152:155], v[64:67]
  v_cvt_pk_bf16_f32 v85, v86, v87
  v_mfma_f32_16x16x32_bf16 v[68:71], v[32:35], v[176:179], v[68:71]
  v_accvgpr_write_b32 a162, v84
  v_mfma_f32_16x16x32_bf16 v[72:75], v[32:35], v[200:203], v[72:75]
  v_accvgpr_write_b32 a163, v85
  v_mfma_f32_16x16x32_bf16 v[64:67], v[36:39], v[156:159], v[64:67]
  v_mfma_f32_16x16x32_bf16 v[68:71], v[36:39], v[180:183], v[68:71]
  v_mfma_f32_16x16x32_bf16 v[72:75], v[36:39], v[204:207], v[72:75]
  s_waitcnt lgkmcnt(0)
  s_waitcnt vmcnt(0)
  v_mfma_f32_16x16x32_bf16 v[76:79], v[40:43], v[136:139], 0
  ds_read_b128 v[16:19], v5 offset:0
  v_mfma_f32_16x16x32_bf16 v[80:83], v[40:43], v[160:163], 0
  ds_read_b128 v[20:23], v5 offset:64
  v_mfma_f32_16x16x32_bf16 v[84:87], v[40:43], v[184:187], 0
  ds_read_b128 v[24:27], v5 offset:128
  v_mfma_f32_16x16x32_bf16 v[76:79], v[44:47], v[140:143], v[76:79]
  ds_read_b128 v[28:31], v5 offset:192
  v_cvt_pk_bf16_f32 v64, v64, v65
  v_mfma_f32_16x16x32_bf16 v[80:83], v[44:47], v[164:167], v[80:83]
  ds_read_b128 v[32:35], v5 offset:256
  v_cvt_pk_bf16_f32 v65, v66, v67
  v_mfma_f32_16x16x32_bf16 v[84:87], v[44:47], v[188:191], v[84:87]
  ds_read_b128 v[36:39], v5 offset:320
  v_accvgpr_write_b32 a4, v64
  v_mfma_f32_16x16x32_bf16 v[76:79], v[48:51], v[144:147], v[76:79]
  s_add_u32 s63, s62, 1474560
  s_add_u32 m0, s61, 12416
  s_nop 0
  buffer_load_dwordx4 v2, s[52:55], s63 offen lds
  v_accvgpr_write_b32 a5, v65
  v_mfma_f32_16x16x32_bf16 v[80:83], v[48:51], v[168:171], v[80:83]
  s_add_u32 m0, s61, 13440
  s_nop 0
  buffer_load_dwordx4 v3, s[52:55], s63 offen lds
  v_cvt_pk_bf16_f32 v68, v68, v69
  v_mfma_f32_16x16x32_bf16 v[84:87], v[48:51], v[192:195], v[84:87]
  s_add_u32 m0, s61, 14464
  s_nop 0
  buffer_load_dwordx4 v4, s[52:55], s63 offen lds
  v_cvt_pk_bf16_f32 v69, v70, v71
  v_mfma_f32_16x16x32_bf16 v[76:79], v[52:55], v[148:151], v[76:79]
  s_add_u32 s63, s62, 1572864
  s_add_u32 m0, s61, 15520
  s_nop 0
  buffer_load_dwordx4 v2, s[52:55], s63 offen lds
  v_accvgpr_write_b32 a84, v68
  v_mfma_f32_16x16x32_bf16 v[80:83], v[52:55], v[172:175], v[80:83]
  s_add_u32 m0, s61, 16544
  s_nop 0
  buffer_load_dwordx4 v3, s[52:55], s63 offen lds
  v_accvgpr_write_b32 a85, v69
  v_mfma_f32_16x16x32_bf16 v[84:87], v[52:55], v[196:199], v[84:87]
  s_add_u32 m0, s61, 17568
  s_nop 0
  buffer_load_dwordx4 v4, s[52:55], s63 offen lds
  v_cvt_pk_bf16_f32 v72, v72, v73
  v_mfma_f32_16x16x32_bf16 v[76:79], v[56:59], v[152:155], v[76:79]
  s_add_u32 s63, s62, 1671168
  s_add_u32 m0, s61, 18624
  s_nop 0
  buffer_load_dwordx4 v2, s[52:55], s63 offen lds
  v_cvt_pk_bf16_f32 v73, v74, v75
  v_mfma_f32_16x16x32_bf16 v[80:83], v[56:59], v[176:179], v[80:83]
  s_add_u32 m0, s61, 19648
  s_nop 0
  buffer_load_dwordx4 v3, s[52:55], s63 offen lds
  v_accvgpr_write_b32 a164, v72
  v_mfma_f32_16x16x32_bf16 v[84:87], v[56:59], v[200:203], v[84:87]
  s_add_u32 m0, s61, 20672
  s_nop 0
  buffer_load_dwordx4 v4, s[52:55], s63 offen lds
  v_accvgpr_write_b32 a165, v73
  v_mfma_f32_16x16x32_bf16 v[76:79], v[60:63], v[156:159], v[76:79]
  s_add_u32 s63, s62, 1769472
  s_add_u32 m0, s61, 21728
  s_nop 0
  buffer_load_dwordx4 v2, s[52:55], s63 offen lds
  v_mfma_f32_16x16x32_bf16 v[80:83], v[60:63], v[180:183], v[80:83]
  s_add_u32 m0, s61, 22752
  s_nop 0
  buffer_load_dwordx4 v3, s[52:55], s63 offen lds
  v_mfma_f32_16x16x32_bf16 v[84:87], v[60:63], v[204:207], v[84:87]
  s_add_u32 m0, s61, 23776
  s_nop 0
  buffer_load_dwordx4 v4, s[52:55], s63 offen lds
  s_waitcnt lgkmcnt(0)
  v_mfma_f32_16x16x32_bf16 v[64:67], v[16:19], v[136:139], 0
  ds_read_b128 v[40:43], v5 offset:768
  v_mfma_f32_16x16x32_bf16 v[68:71], v[16:19], v[160:163], 0
  ds_read_b128 v[44:47], v5 offset:832
  v_mfma_f32_16x16x32_bf16 v[72:75], v[16:19], v[184:187], 0
  ds_read_b128 v[48:51], v5 offset:896
  v_mfma_f32_16x16x32_bf16 v[64:67], v[20:23], v[140:143], v[64:67]
  ds_read_b128 v[52:55], v5 offset:960
  v_cvt_pk_bf16_f32 v76, v76, v77
  v_mfma_f32_16x16x32_bf16 v[68:71], v[20:23], v[164:167], v[68:71]
  ds_read_b128 v[56:59], v5 offset:1024
  v_cvt_pk_bf16_f32 v77, v78, v79
  v_mfma_f32_16x16x32_bf16 v[72:75], v[20:23], v[188:191], v[72:75]
  ds_read_b128 v[60:63], v5 offset:1088
  v_accvgpr_write_b32 a6, v76
  v_mfma_f32_16x16x32_bf16 v[64:67], v[24:27], v[144:147], v[64:67]
  v_accvgpr_write_b32 a7, v77
  v_mfma_f32_16x16x32_bf16 v[68:71], v[24:27], v[168:171], v[68:71]
  v_cvt_pk_bf16_f32 v80, v80, v81
  v_mfma_f32_16x16x32_bf16 v[72:75], v[24:27], v[192:195], v[72:75]
  v_cvt_pk_bf16_f32 v81, v82, v83
  v_mfma_f32_16x16x32_bf16 v[64:67], v[28:31], v[148:151], v[64:67]
  v_accvgpr_write_b32 a86, v80
  v_mfma_f32_16x16x32_bf16 v[68:71], v[28:31], v[172:175], v[68:71]
  v_accvgpr_write_b32 a87, v81
  v_mfma_f32_16x16x32_bf16 v[72:75], v[28:31], v[196:199], v[72:75]
  v_cvt_pk_bf16_f32 v84, v84, v85
  v_mfma_f32_16x16x32_bf16 v[64:67], v[32:35], v[152:155], v[64:67]
  v_cvt_pk_bf16_f32 v85, v86, v87
  v_mfma_f32_16x16x32_bf16 v[68:71], v[32:35], v[176:179], v[68:71]
  v_accvgpr_write_b32 a166, v84
  v_mfma_f32_16x16x32_bf16 v[72:75], v[32:35], v[200:203], v[72:75]
  v_accvgpr_write_b32 a167, v85
  v_mfma_f32_16x16x32_bf16 v[64:67], v[36:39], v[156:159], v[64:67]
  v_mfma_f32_16x16x32_bf16 v[68:71], v[36:39], v[180:183], v[68:71]
  v_mfma_f32_16x16x32_bf16 v[72:75], v[36:39], v[204:207], v[72:75]
  s_waitcnt lgkmcnt(0)
  s_waitcnt vmcnt(0)
  v_mfma_f32_16x16x32_bf16 v[76:79], v[40:43], v[136:139], 0
  ds_read_b128 v[16:19], v5 offset:12416
  v_mfma_f32_16x16x32_bf16 v[80:83], v[40:43], v[160:163], 0
  ds_read_b128 v[20:23], v5 offset:12480
  v_mfma_f32_16x16x32_bf16 v[84:87], v[40:43], v[184:187], 0
  ds_read_b128 v[24:27], v5 offset:12544
  v_mfma_f32_16x16x32_bf16 v[76:79], v[44:47], v[140:143], v[76:79]
  ds_read_b128 v[28:31], v5 offset:12608
  v_cvt_pk_bf16_f32 v64, v64, v65
  v_mfma_f32_16x16x32_bf16 v[80:83], v[44:47], v[164:167], v[80:83]
  ds_read_b128 v[32:35], v5 offset:12672
  v_cvt_pk_bf16_f32 v65, v66, v67
  v_mfma_f32_16x16x32_bf16 v[84:87], v[44:47], v[188:191], v[84:87]
  ds_read_b128 v[36:39], v5 offset:12736
  v_accvgpr_write_b32 a8, v64
  v_mfma_f32_16x16x32_bf16 v[76:79], v[48:51], v[144:147], v[76:79]
  s_add_u32 s63, s62, 1966080
  s_add_u32 m0, s61, 0
  s_nop 0
  buffer_load_dwordx4 v2, s[52:55], s63 offen lds
  v_accvgpr_write_b32 a9, v65
  v_mfma_f32_16x16x32_bf16 v[80:83], v[48:51], v[168:171], v[80:83]
  s_add_u32 m0, s61, 1024
  s_nop 0
  buffer_load_dwordx4 v3, s[52:55], s63 offen lds
  v_cvt_pk_bf16_f32 v68, v68, v69
  v_mfma_f32_16x16x32_bf16 v[84:87], v[48:51], v[192:195], v[84:87]
  s_add_u32 m0, s61, 2048
  s_nop 0
  buffer_load_dwordx4 v4, s[52:55], s63 offen lds
  v_cvt_pk_bf16_f32 v69, v70, v71
  v_mfma_f32_16x16x32_bf16 v[76:79], v[52:55], v[148:151], v[76:79]
  s_add_u32 s63, s62, 2064384
  s_add_u32 m0, s61, 3104
  s_nop 0
  buffer_load_dwordx4 v2, s[52:55], s63 offen lds
  v_accvgpr_write_b32 a88, v68
  v_mfma_f32_16x16x32_bf16 v[80:83], v[52:55], v[172:175], v[80:83]
  s_add_u32 m0, s61, 4128
  s_nop 0
  buffer_load_dwordx4 v3, s[52:55], s63 offen lds
  v_accvgpr_write_b32 a89, v69
  v_mfma_f32_16x16x32_bf16 v[84:87], v[52:55], v[196:199], v[84:87]
  s_add_u32 m0, s61, 5152
  s_nop 0
  buffer_load_dwordx4 v4, s[52:55], s63 offen lds
  v_cvt_pk_bf16_f32 v72, v72, v73
  v_mfma_f32_16x16x32_bf16 v[76:79], v[56:59], v[152:155], v[76:79]
  s_add_u32 s63, s62, 2162688
  s_add_u32 m0, s61, 6208
  s_nop 0
  buffer_load_dwordx4 v2, s[52:55], s63 offen lds
  v_cvt_pk_bf16_f32 v73, v74, v75
  v_mfma_f32_16x16x32_bf16 v[80:83], v[56:59], v[176:179], v[80:83]
  s_add_u32 m0, s61, 7232
  s_nop 0
  buffer_load_dwordx4 v3, s[52:55], s63 offen lds
  v_accvgpr_write_b32 a168, v72
  v_mfma_f32_16x16x32_bf16 v[84:87], v[56:59], v[200:203], v[84:87]
  s_add_u32 m0, s61, 8256
  s_nop 0
  buffer_load_dwordx4 v4, s[52:55], s63 offen lds
  v_accvgpr_write_b32 a169, v73
  v_mfma_f32_16x16x32_bf16 v[76:79], v[60:63], v[156:159], v[76:79]
  s_add_u32 s63, s62, 2260992
  s_add_u32 m0, s61, 9312
  s_nop 0
  buffer_load_dwordx4 v2, s[52:55], s63 offen lds
  v_mfma_f32_16x16x32_bf16 v[80:83], v[60:63], v[180:183], v[80:83]
  s_add_u32 m0, s61, 10336
  s_nop 0
  buffer_load_dwordx4 v3, s[52:55], s63 offen lds
  v_mfma_f32_16x16x32_bf16 v[84:87], v[60:63], v[204:207], v[84:87]
  s_add_u32 m0, s61, 11360
  s_nop 0
  buffer_load_dwordx4 v4, s[52:55], s63 offen lds
  s_waitcnt lgkmcnt(0)
  v_mfma_f32_16x16x32_bf16 v[64:67], v[16:19], v[136:139], 0
  ds_read_b128 v[40:43], v5 offset:13184
  v_mfma_f32_16x16x32_bf16 v[68:71], v[16:19], v[160:163], 0
  ds_read_b128 v[44:47], v5 offset:13248
  v_mfma_f32_16x16x32_bf16 v[72:75], v[16:19], v[184:187], 0
  ds_read_b128 v[48:51], v5 offset:13312
  v_mfma_f32_16x16x32_bf16 v[64:67], v[20:23], v[140:143], v[64:67]
  ds_read_b128 v[52:55], v5 offset:13376
  v_cvt_pk_bf16_f32 v76, v76, v77
  v_mfma_f32_16x16x32_bf16 v[68:71], v[20:23], v[164:167], v[68:71]
  ds_read_b128 v[56:59], v5 offset:13440
  v_cvt_pk_bf16_f32 v77, v78, v79
  v_mfma_f32_16x16x32_bf16 v[72:75], v[20:23], v[188:191], v[72:75]
  ds_read_b128 v[60:63], v5 offset:13504
  v_accvgpr_write_b32 a10, v76
  v_mfma_f32_16x16x32_bf16 v[64:67], v[24:27], v[144:147], v[64:67]
  v_accvgpr_write_b32 a11, v77
  v_mfma_f32_16x16x32_bf16 v[68:71], v[24:27], v[168:171], v[68:71]
  v_cvt_pk_bf16_f32 v80, v80, v81
  v_mfma_f32_16x16x32_bf16 v[72:75], v[24:27], v[192:195], v[72:75]
  v_cvt_pk_bf16_f32 v81, v82, v83
  v_mfma_f32_16x16x32_bf16 v[64:67], v[28:31], v[148:151], v[64:67]
  v_accvgpr_write_b32 a90, v80
  v_mfma_f32_16x16x32_bf16 v[68:71], v[28:31], v[172:175], v[68:71]
  v_accvgpr_write_b32 a91, v81
  v_mfma_f32_16x16x32_bf16 v[72:75], v[28:31], v[196:199], v[72:75]
  v_cvt_pk_bf16_f32 v84, v84, v85
  v_mfma_f32_16x16x32_bf16 v[64:67], v[32:35], v[152:155], v[64:67]
  v_cvt_pk_bf16_f32 v85, v86, v87
  v_mfma_f32_16x16x32_bf16 v[68:71], v[32:35], v[176:179], v[68:71]
  v_accvgpr_write_b32 a170, v84
  v_mfma_f32_16x16x32_bf16 v[72:75], v[32:35], v[200:203], v[72:75]
  v_accvgpr_write_b32 a171, v85
  v_mfma_f32_16x16x32_bf16 v[64:67], v[36:39], v[156:159], v[64:67]
  v_mfma_f32_16x16x32_bf16 v[68:71], v[36:39], v[180:183], v[68:71]
  v_mfma_f32_16x16x32_bf16 v[72:75], v[36:39], v[204:207], v[72:75]
  s_waitcnt lgkmcnt(0)
  s_waitcnt vmcnt(0)
  v_mfma_f32_16x16x32_bf16 v[76:79], v[40:43], v[136:139], 0
  ds_read_b128 v[16:19], v5 offset:0
  v_mfma_f32_16x16x32_bf16 v[80:83], v[40:43], v[160:163], 0
  ds_read_b128 v[20:23], v5 offset:64
  v_mfma_f32_16x16x32_bf16 v[84:87], v[40:43], v[184:187], 0
  ds_read_b128 v[24:27], v5 offset:128
  v_mfma_f32_16x16x32_bf16 v[76:79], v[44:47], v[140:143], v[76:79]
  ds_read_b128 v[28:31], v5 offset:192
  v_cvt_pk_bf16_f32 v64, v64, v65
  v_mfma_f32_16x16x32_bf16 v[80:83], v[44:47], v[164:167], v[80:83]
  ds_read_b128 v[32:35], v5 offset:256
  v_cvt_pk_bf16_f32 v65, v66, v67
  v_mfma_f32_16x16x32_bf16 v[84:87], v[44:47], v[188:191], v[84:87]
  ds_read_b128 v[36:39], v5 offset:320
  v_accvgpr_write_b32 a12, v64
  v_mfma_f32_16x16x32_bf16 v[76:79], v[48:51], v[144:147], v[76:79]
  s_add_u32 s63, s62, 2457600
  s_add_u32 m0, s61, 12416
  s_nop 0
  buffer_load_dwordx4 v2, s[52:55], s63 offen lds
  v_accvgpr_write_b32 a13, v65
  v_mfma_f32_16x16x32_bf16 v[80:83], v[48:51], v[168:171], v[80:83]
  s_add_u32 m0, s61, 13440
  s_nop 0
  buffer_load_dwordx4 v3, s[52:55], s63 offen lds
  v_cvt_pk_bf16_f32 v68, v68, v69
  v_mfma_f32_16x16x32_bf16 v[84:87], v[48:51], v[192:195], v[84:87]
  s_add_u32 m0, s61, 14464
  s_nop 0
  buffer_load_dwordx4 v4, s[52:55], s63 offen lds
  v_cvt_pk_bf16_f32 v69, v70, v71
  v_mfma_f32_16x16x32_bf16 v[76:79], v[52:55], v[148:151], v[76:79]
  s_add_u32 s63, s62, 2555904
  s_add_u32 m0, s61, 15520
  s_nop 0
  buffer_load_dwordx4 v2, s[52:55], s63 offen lds
  v_accvgpr_write_b32 a92, v68
  v_mfma_f32_16x16x32_bf16 v[80:83], v[52:55], v[172:175], v[80:83]
  s_add_u32 m0, s61, 16544
  s_nop 0
  buffer_load_dwordx4 v3, s[52:55], s63 offen lds
  v_accvgpr_write_b32 a93, v69
  v_mfma_f32_16x16x32_bf16 v[84:87], v[52:55], v[196:199], v[84:87]
  s_add_u32 m0, s61, 17568
  s_nop 0
  buffer_load_dwordx4 v4, s[52:55], s63 offen lds
  v_cvt_pk_bf16_f32 v72, v72, v73
  v_mfma_f32_16x16x32_bf16 v[76:79], v[56:59], v[152:155], v[76:79]
  s_add_u32 s63, s62, 2654208
  s_add_u32 m0, s61, 18624
  s_nop 0
  buffer_load_dwordx4 v2, s[52:55], s63 offen lds
  v_cvt_pk_bf16_f32 v73, v74, v75
  v_mfma_f32_16x16x32_bf16 v[80:83], v[56:59], v[176:179], v[80:83]
  s_add_u32 m0, s61, 19648
  s_nop 0
  buffer_load_dwordx4 v3, s[52:55], s63 offen lds
  v_accvgpr_write_b32 a172, v72
  v_mfma_f32_16x16x32_bf16 v[84:87], v[56:59], v[200:203], v[84:87]
  s_add_u32 m0, s61, 20672
  s_nop 0
  buffer_load_dwordx4 v4, s[52:55], s63 offen lds
  v_accvgpr_write_b32 a173, v73
  v_mfma_f32_16x16x32_bf16 v[76:79], v[60:63], v[156:159], v[76:79]
  s_add_u32 s63, s62, 2752512
  s_add_u32 m0, s61, 21728
  s_nop 0
  buffer_load_dwordx4 v2, s[52:55], s63 offen lds
  v_mfma_f32_16x16x32_bf16 v[80:83], v[60:63], v[180:183], v[80:83]
  s_add_u32 m0, s61, 22752
  s_nop 0
  buffer_load_dwordx4 v3, s[52:55], s63 offen lds
  v_mfma_f32_16x16x32_bf16 v[84:87], v[60:63], v[204:207], v[84:87]
  s_add_u32 m0, s61, 23776
  s_nop 0
  buffer_load_dwordx4 v4, s[52:55], s63 offen lds
  s_waitcnt lgkmcnt(0)
  v_mfma_f32_16x16x32_bf16 v[64:67], v[16:19], v[136:139], 0
  ds_read_b128 v[40:43], v5 offset:768
  v_mfma_f32_16x16x32_bf16 v[68:71], v[16:19], v[160:163], 0
  ds_read_b128 v[44:47], v5 offset:832
  v_mfma_f32_16x16x32_bf16 v[72:75], v[16:19], v[184:187], 0
  ds_read_b128 v[48:51], v5 offset:896
  v_mfma_f32_16x16x32_bf16 v[64:67], v[20:23], v[140:143], v[64:67]
  ds_read_b128 v[52:55], v5 offset:960
  v_cvt_pk_bf16_f32 v76, v76, v77
  v_mfma_f32_16x16x32_bf16 v[68:71], v[20:23], v[164:167], v[68:71]
  ds_read_b128 v[56:59], v5 offset:1024
  v_cvt_pk_bf16_f32 v77, v78, v79
  v_mfma_f32_16x16x32_bf16 v[72:75], v[20:23], v[188:191], v[72:75]
  ds_read_b128 v[60:63], v5 offset:1088
  v_accvgpr_write_b32 a14, v76
  v_mfma_f32_16x16x32_bf16 v[64:67], v[24:27], v[144:147], v[64:67]
  v_accvgpr_write_b32 a15, v77
  v_mfma_f32_16x16x32_bf16 v[68:71], v[24:27], v[168:171], v[68:71]
  v_cvt_pk_bf16_f32 v80, v80, v81
  v_mfma_f32_16x16x32_bf16 v[72:75], v[24:27], v[192:195], v[72:75]
  v_cvt_pk_bf16_f32 v81, v82, v83
  v_mfma_f32_16x16x32_bf16 v[64:67], v[28:31], v[148:151], v[64:67]
  v_accvgpr_write_b32 a94, v80
  v_mfma_f32_16x16x32_bf16 v[68:71], v[28:31], v[172:175], v[68:71]
  v_accvgpr_write_b32 a95, v81
  v_mfma_f32_16x16x32_bf16 v[72:75], v[28:31], v[196:199], v[72:75]
  v_cvt_pk_bf16_f32 v84, v84, v85
  v_mfma_f32_16x16x32_bf16 v[64:67], v[32:35], v[152:155], v[64:67]
  v_cvt_pk_bf16_f32 v85, v86, v87
  v_mfma_f32_16x16x32_bf16 v[68:71], v[32:35], v[176:179], v[68:71]
  v_accvgpr_write_b32 a174, v84
  v_mfma_f32_16x16x32_bf16 v[72:75], v[32:35], v[200:203], v[72:75]
  v_accvgpr_write_b32 a175, v85
  v_mfma_f32_16x16x32_bf16 v[64:67], v[36:39], v[156:159], v[64:67]
  v_mfma_f32_16x16x32_bf16 v[68:71], v[36:39], v[180:183], v[68:71]
  v_mfma_f32_16x16x32_bf16 v[72:75], v[36:39], v[204:207], v[72:75]
  s_waitcnt lgkmcnt(0)
  s_waitcnt vmcnt(0)
  v_mfma_f32_16x16x32_bf16 v[76:79], v[40:43], v[136:139], 0
  ds_read_b128 v[16:19], v5 offset:12416
  v_mfma_f32_16x16x32_bf16 v[80:83], v[40:43], v[160:163], 0
  ds_read_b128 v[20:23], v5 offset:12480
  v_mfma_f32_16x16x32_bf16 v[84:87], v[40:43], v[184:187], 0
  ds_read_b128 v[24:27], v5 offset:12544
  v_mfma_f32_16x16x32_bf16 v[76:79], v[44:47], v[140:143], v[76:79]
  ds_read_b128 v[28:31], v5 offset:12608
  v_cvt_pk_bf16_f32 v64, v64, v65
  v_mfma_f32_16x16x32_bf16 v[80:83], v[44:47], v[164:167], v[80:83]
  ds_read_b128 v[32:35], v5 offset:12672
  v_cvt_pk_bf16_f32 v65, v66, v67
  v_mfma_f32_16x16x32_bf16 v[84:87], v[44:47], v[188:191], v[84:87]
  ds_read_b128 v[36:39], v5 offset:12736
  v_accvgpr_write_b32 a16, v64
  v_mfma_f32_16x16x32_bf16 v[76:79], v[48:51], v[144:147], v[76:79]
  s_add_u32 s63, s62, 2949120
  s_add_u32 m0, s61, 0
  s_nop 0
  buffer_load_dwordx4 v2, s[52:55], s63 offen lds
  v_accvgpr_write_b32 a17, v65
  v_mfma_f32_16x16x32_bf16 v[80:83], v[48:51], v[168:171], v[80:83]
  s_add_u32 m0, s61, 1024
  s_nop 0
  buffer_load_dwordx4 v3, s[52:55], s63 offen lds
  v_cvt_pk_bf16_f32 v68, v68, v69
  v_mfma_f32_16x16x32_bf16 v[84:87], v[48:51], v[192:195], v[84:87]
  s_add_u32 m0, s61, 2048
  s_nop 0
  buffer_load_dwordx4 v4, s[52:55], s63 offen lds
  v_cvt_pk_bf16_f32 v69, v70, v71
  v_mfma_f32_16x16x32_bf16 v[76:79], v[52:55], v[148:151], v[76:79]
  s_add_u32 s63, s62, 3047424
  s_add_u32 m0, s61, 3104
  s_nop 0
  buffer_load_dwordx4 v2, s[52:55], s63 offen lds
  v_accvgpr_write_b32 a96, v68
  v_mfma_f32_16x16x32_bf16 v[80:83], v[52:55], v[172:175], v[80:83]
  s_add_u32 m0, s61, 4128
  s_nop 0
  buffer_load_dwordx4 v3, s[52:55], s63 offen lds
  v_accvgpr_write_b32 a97, v69
  v_mfma_f32_16x16x32_bf16 v[84:87], v[52:55], v[196:199], v[84:87]
  s_add_u32 m0, s61, 5152
  s_nop 0
  buffer_load_dwordx4 v4, s[52:55], s63 offen lds
  v_cvt_pk_bf16_f32 v72, v72, v73
  v_mfma_f32_16x16x32_bf16 v[76:79], v[56:59], v[152:155], v[76:79]
  s_add_u32 s63, s62, 3145728
  s_add_u32 m0, s61, 6208
  s_nop 0
  buffer_load_dwordx4 v2, s[52:55], s63 offen lds
  v_cvt_pk_bf16_f32 v73, v74, v75
  v_mfma_f32_16x16x32_bf16 v[80:83], v[56:59], v[176:179], v[80:83]
  s_add_u32 m0, s61, 7232
  s_nop 0
  buffer_load_dwordx4 v3, s[52:55], s63 offen lds
  v_accvgpr_write_b32 a176, v72
  v_mfma_f32_16x16x32_bf16 v[84:87], v[56:59], v[200:203], v[84:87]
  s_add_u32 m0, s61, 8256
  s_nop 0
  buffer_load_dwordx4 v4, s[52:55], s63 offen lds
  v_accvgpr_write_b32 a177, v73
  v_mfma_f32_16x16x32_bf16 v[76:79], v[60:63], v[156:159], v[76:79]
  s_add_u32 s63, s62, 3244032
  s_add_u32 m0, s61, 9312
  s_nop 0
  buffer_load_dwordx4 v2, s[52:55], s63 offen lds
  v_mfma_f32_16x16x32_bf16 v[80:83], v[60:63], v[180:183], v[80:83]
  s_add_u32 m0, s61, 10336
  s_nop 0
  buffer_load_dwordx4 v3, s[52:55], s63 offen lds
  v_mfma_f32_16x16x32_bf16 v[84:87], v[60:63], v[204:207], v[84:87]
  s_add_u32 m0, s61, 11360
  s_nop 0
  buffer_load_dwordx4 v4, s[52:55], s63 offen lds
  s_waitcnt lgkmcnt(0)
  v_mfma_f32_16x16x32_bf16 v[64:67], v[16:19], v[136:139], 0
  ds_read_b128 v[40:43], v5 offset:13184
  v_mfma_f32_16x16x32_bf16 v[68:71], v[16:19], v[160:163], 0
  ds_read_b128 v[44:47], v5 offset:13248
  v_mfma_f32_16x16x32_bf16 v[72:75], v[16:19], v[184:187], 0
  ds_read_b128 v[48:51], v5 offset:13312
  v_mfma_f32_16x16x32_bf16 v[64:67], v[20:23], v[140:143], v[64:67]
  ds_read_b128 v[52:55], v5 offset:13376
  v_cvt_pk_bf16_f32 v76, v76, v77
  v_mfma_f32_16x16x32_bf16 v[68:71], v[20:23], v[164:167], v[68:71]
  ds_read_b128 v[56:59], v5 offset:13440
  v_cvt_pk_bf16_f32 v77, v78, v79
  v_mfma_f32_16x16x32_bf16 v[72:75], v[20:23], v[188:191], v[72:75]
  ds_read_b128 v[60:63], v5 offset:13504
  v_accvgpr_write_b32 a18, v76
  v_mfma_f32_16x16x32_bf16 v[64:67], v[24:27], v[144:147], v[64:67]
  v_accvgpr_write_b32 a19, v77
  v_mfma_f32_16x16x32_bf16 v[68:71], v[24:27], v[168:171], v[68:71]
  v_cvt_pk_bf16_f32 v80, v80, v81
  v_mfma_f32_16x16x32_bf16 v[72:75], v[24:27], v[192:195], v[72:75]
  v_cvt_pk_bf16_f32 v81, v82, v83
  v_mfma_f32_16x16x32_bf16 v[64:67], v[28:31], v[148:151], v[64:67]
  v_accvgpr_write_b32 a98, v80
  v_mfma_f32_16x16x32_bf16 v[68:71], v[28:31], v[172:175], v[68:71]
  v_accvgpr_write_b32 a99, v81
  v_mfma_f32_16x16x32_bf16 v[72:75], v[28:31], v[196:199], v[72:75]
  v_cvt_pk_bf16_f32 v84, v84, v85
  v_mfma_f32_16x16x32_bf16 v[64:67], v[32:35], v[152:155], v[64:67]
  v_cvt_pk_bf16_f32 v85, v86, v87
  v_mfma_f32_16x16x32_bf16 v[68:71], v[32:35], v[176:179], v[68:71]
  v_accvgpr_write_b32 a178, v84
  v_mfma_f32_16x16x32_bf16 v[72:75], v[32:35], v[200:203], v[72:75]
  v_accvgpr_write_b32 a179, v85
  v_mfma_f32_16x16x32_bf16 v[64:67], v[36:39], v[156:159], v[64:67]
  v_mfma_f32_16x16x32_bf16 v[68:71], v[36:39], v[180:183], v[68:71]
  v_mfma_f32_16x16x32_bf16 v[72:75], v[36:39], v[204:207], v[72:75]
  s_waitcnt lgkmcnt(0)
  s_waitcnt vmcnt(0)
  v_mfma_f32_16x16x32_bf16 v[76:79], v[40:43], v[136:139], 0
  ds_read_b128 v[16:19], v5 offset:0
  v_mfma_f32_16x16x32_bf16 v[80:83], v[40:43], v[160:163], 0
  ds_read_b128 v[20:23], v5 offset:64
  v_mfma_f32_16x16x32_bf16 v[84:87], v[40:43], v[184:187], 0
  ds_read_b128 v[24:27], v5 offset:128
  v_mfma_f32_16x16x32_bf16 v[76:79], v[44:47], v[140:143], v[76:79]
  ds_read_b128 v[28:31], v5 offset:192
  v_cvt_pk_bf16_f32 v64, v64, v65
  v_mfma_f32_16x16x32_bf16 v[80:83], v[44:47], v[164:167], v[80:83]
  ds_read_b128 v[32:35], v5 offset:256
  v_cvt_pk_bf16_f32 v65, v66, v67
  v_mfma_f32_16x16x32_bf16 v[84:87], v[44:47], v[188:191], v[84:87]
  ds_read_b128 v[36:39], v5 offset:320
  v_accvgpr_write_b32 a20, v64
  v_mfma_f32_16x16x32_bf16 v[76:79], v[48:51], v[144:147], v[76:79]
  s_add_u32 s63, s62, 3440640
  s_add_u32 m0, s61, 12416
  s_nop 0
  buffer_load_dwordx4 v2, s[52:55], s63 offen lds
  v_accvgpr_write_b32 a21, v65
  v_mfma_f32_16x16x32_bf16 v[80:83], v[48:51], v[168:171], v[80:83]
  s_add_u32 m0, s61, 13440
  s_nop 0
  buffer_load_dwordx4 v3, s[52:55], s63 offen lds
  v_cvt_pk_bf16_f32 v68, v68, v69
  v_mfma_f32_16x16x32_bf16 v[84:87], v[48:51], v[192:195], v[84:87]
  s_add_u32 m0, s61, 14464
  s_nop 0
  buffer_load_dwordx4 v4, s[52:55], s63 offen lds
  v_cvt_pk_bf16_f32 v69, v70, v71
  v_mfma_f32_16x16x32_bf16 v[76:79], v[52:55], v[148:151], v[76:79]
  s_add_u32 s63, s62, 3538944
  s_add_u32 m0, s61, 15520
  s_nop 0
  buffer_load_dwordx4 v2, s[52:55], s63 offen lds
  v_accvgpr_write_b32 a100, v68
  v_mfma_f32_16x16x32_bf16 v[80:83], v[52:55], v[172:175], v[80:83]
  s_add_u32 m0, s61, 16544
  s_nop 0
  buffer_load_dwordx4 v3, s[52:55], s63 offen lds
  v_accvgpr_write_b32 a101, v69
  v_mfma_f32_16x16x32_bf16 v[84:87], v[52:55], v[196:199], v[84:87]
  s_add_u32 m0, s61, 17568
  s_nop 0
  buffer_load_dwordx4 v4, s[52:55], s63 offen lds
  v_cvt_pk_bf16_f32 v72, v72, v73
  v_mfma_f32_16x16x32_bf16 v[76:79], v[56:59], v[152:155], v[76:79]
  s_add_u32 s63, s62, 3637248
  s_add_u32 m0, s61, 18624
  s_nop 0
  buffer_load_dwordx4 v2, s[52:55], s63 offen lds
  v_cvt_pk_bf16_f32 v73, v74, v75
  v_mfma_f32_16x16x32_bf16 v[80:83], v[56:59], v[176:179], v[80:83]
  s_add_u32 m0, s61, 19648
  s_nop 0
  buffer_load_dwordx4 v3, s[52:55], s63 offen lds
  v_accvgpr_write_b32 a180, v72
  v_mfma_f32_16x16x32_bf16 v[84:87], v[56:59], v[200:203], v[84:87]
  s_add_u32 m0, s61, 20672
  s_nop 0
  buffer_load_dwordx4 v4, s[52:55], s63 offen lds
  v_accvgpr_write_b32 a181, v73
  v_mfma_f32_16x16x32_bf16 v[76:79], v[60:63], v[156:159], v[76:79]
  s_add_u32 s63, s62, 3735552
  s_add_u32 m0, s61, 21728
  s_nop 0
  buffer_load_dwordx4 v2, s[52:55], s63 offen lds
  v_mfma_f32_16x16x32_bf16 v[80:83], v[60:63], v[180:183], v[80:83]
  s_add_u32 m0, s61, 22752
  s_nop 0
  buffer_load_dwordx4 v3, s[52:55], s63 offen lds
  v_mfma_f32_16x16x32_bf16 v[84:87], v[60:63], v[204:207], v[84:87]
  s_add_u32 m0, s61, 23776
  s_nop 0
  buffer_load_dwordx4 v4, s[52:55], s63 offen lds
  s_waitcnt lgkmcnt(0)
  v_mfma_f32_16x16x32_bf16 v[64:67], v[16:19], v[136:139], 0
  ds_read_b128 v[40:43], v5 offset:768
  v_mfma_f32_16x16x32_bf16 v[68:71], v[16:19], v[160:163], 0
  ds_read_b128 v[44:47], v5 offset:832
  v_mfma_f32_16x16x32_bf16 v[72:75], v[16:19], v[184:187], 0
  ds_read_b128 v[48:51], v5 offset:896
  v_mfma_f32_16x16x32_bf16 v[64:67], v[20:23], v[140:143], v[64:67]
  ds_read_b128 v[52:55], v5 offset:960
  v_cvt_pk_bf16_f32 v76, v76, v77
  v_mfma_f32_16x16x32_bf16 v[68:71], v[20:23], v[164:167], v[68:71]
  ds_read_b128 v[56:59], v5 offset:1024
  v_cvt_pk_bf16_f32 v77, v78, v79
  v_mfma_f32_16x16x32_bf16 v[72:75], v[20:23], v[188:191], v[72:75]
  ds_read_b128 v[60:63], v5 offset:1088
  v_accvgpr_write_b32 a22, v76
  v_mfma_f32_16x16x32_bf16 v[64:67], v[24:27], v[144:147], v[64:67]
  v_accvgpr_write_b32 a23, v77
  v_mfma_f32_16x16x32_bf16 v[68:71], v[24:27], v[168:171], v[68:71]
  v_cvt_pk_bf16_f32 v80, v80, v81
  v_mfma_f32_16x16x32_bf16 v[72:75], v[24:27], v[192:195], v[72:75]
  v_cvt_pk_bf16_f32 v81, v82, v83
  v_mfma_f32_16x16x32_bf16 v[64:67], v[28:31], v[148:151], v[64:67]
  v_accvgpr_write_b32 a102, v80
  v_mfma_f32_16x16x32_bf16 v[68:71], v[28:31], v[172:175], v[68:71]
  v_accvgpr_write_b32 a103, v81
  v_mfma_f32_16x16x32_bf16 v[72:75], v[28:31], v[196:199], v[72:75]
  v_cvt_pk_bf16_f32 v84, v84, v85
  v_mfma_f32_16x16x32_bf16 v[64:67], v[32:35], v[152:155], v[64:67]
  v_cvt_pk_bf16_f32 v85, v86, v87
  v_mfma_f32_16x16x32_bf16 v[68:71], v[32:35], v[176:179], v[68:71]
  v_accvgpr_write_b32 a182, v84
  v_mfma_f32_16x16x32_bf16 v[72:75], v[32:35], v[200:203], v[72:75]
  v_accvgpr_write_b32 a183, v85
  v_mfma_f32_16x16x32_bf16 v[64:67], v[36:39], v[156:159], v[64:67]
  v_mfma_f32_16x16x32_bf16 v[68:71], v[36:39], v[180:183], v[68:71]
  v_mfma_f32_16x16x32_bf16 v[72:75], v[36:39], v[204:207], v[72:75]
  s_waitcnt lgkmcnt(0)
  s_waitcnt vmcnt(0)
  v_mfma_f32_16x16x32_bf16 v[76:79], v[40:43], v[136:139], 0
  ds_read_b128 v[16:19], v5 offset:12416
  v_mfma_f32_16x16x32_bf16 v[80:83], v[40:43], v[160:163], 0
  ds_read_b128 v[20:23], v5 offset:12480
  v_mfma_f32_16x16x32_bf16 v[84:87], v[40:43], v[184:187], 0
  ds_read_b128 v[24:27], v5 offset:12544
  v_mfma_f32_16x16x32_bf16 v[76:79], v[44:47], v[140:143], v[76:79]
  ds_read_b128 v[28:31], v5 offset:12608
  v_cvt_pk_bf16_f32 v64, v64, v65
  v_mfma_f32_16x16x32_bf16 v[80:83], v[44:47], v[164:167], v[80:83]
  ds_read_b128 v[32:35], v5 offset:12672
  v_cvt_pk_bf16_f32 v65, v66, v67
  v_mfma_f32_16x16x32_bf16 v[84:87], v[44:47], v[188:191], v[84:87]
  ds_read_b128 v[36:39], v5 offset:12736
  v_accvgpr_write_b32 a24, v64
  v_mfma_f32_16x16x32_bf16 v[76:79], v[48:51], v[144:147], v[76:79]
  s_add_u32 s63, s62, 3932160
  s_add_u32 m0, s61, 0
  s_nop 0
  buffer_load_dwordx4 v2, s[52:55], s63 offen lds
  v_accvgpr_write_b32 a25, v65
  v_mfma_f32_16x16x32_bf16 v[80:83], v[48:51], v[168:171], v[80:83]
  s_add_u32 m0, s61, 1024
  s_nop 0
  buffer_load_dwordx4 v3, s[52:55], s63 offen lds
  v_cvt_pk_bf16_f32 v68, v68, v69
  v_mfma_f32_16x16x32_bf16 v[84:87], v[48:51], v[192:195], v[84:87]
  s_add_u32 m0, s61, 2048
  s_nop 0
  buffer_load_dwordx4 v4, s[52:55], s63 offen lds
  v_cvt_pk_bf16_f32 v69, v70, v71
  v_mfma_f32_16x16x32_bf16 v[76:79], v[52:55], v[148:151], v[76:79]
  s_add_u32 s63, s62, 4030464
  s_add_u32 m0, s61, 3104
  s_nop 0
  buffer_load_dwordx4 v2, s[52:55], s63 offen lds
  v_accvgpr_write_b32 a104, v68
  v_mfma_f32_16x16x32_bf16 v[80:83], v[52:55], v[172:175], v[80:83]
  s_add_u32 m0, s61, 4128
  s_nop 0
  buffer_load_dwordx4 v3, s[52:55], s63 offen lds
  v_accvgpr_write_b32 a105, v69
  v_mfma_f32_16x16x32_bf16 v[84:87], v[52:55], v[196:199], v[84:87]
  s_add_u32 m0, s61, 5152
  s_nop 0
  buffer_load_dwordx4 v4, s[52:55], s63 offen lds
  v_cvt_pk_bf16_f32 v72, v72, v73
  v_mfma_f32_16x16x32_bf16 v[76:79], v[56:59], v[152:155], v[76:79]
  s_add_u32 s63, s62, 4128768
  s_add_u32 m0, s61, 6208
  s_nop 0
  buffer_load_dwordx4 v2, s[52:55], s63 offen lds
  v_cvt_pk_bf16_f32 v73, v74, v75
  v_mfma_f32_16x16x32_bf16 v[80:83], v[56:59], v[176:179], v[80:83]
  s_add_u32 m0, s61, 7232
  s_nop 0
  buffer_load_dwordx4 v3, s[52:55], s63 offen lds
  v_accvgpr_write_b32 a184, v72
  v_mfma_f32_16x16x32_bf16 v[84:87], v[56:59], v[200:203], v[84:87]
  s_add_u32 m0, s61, 8256
  s_nop 0
  buffer_load_dwordx4 v4, s[52:55], s63 offen lds
  v_accvgpr_write_b32 a185, v73
  v_mfma_f32_16x16x32_bf16 v[76:79], v[60:63], v[156:159], v[76:79]
  s_add_u32 s63, s62, 4227072
  s_add_u32 m0, s61, 9312
  s_nop 0
  buffer_load_dwordx4 v2, s[52:55], s63 offen lds
  v_mfma_f32_16x16x32_bf16 v[80:83], v[60:63], v[180:183], v[80:83]
  s_add_u32 m0, s61, 10336
  s_nop 0
  buffer_load_dwordx4 v3, s[52:55], s63 offen lds
  v_mfma_f32_16x16x32_bf16 v[84:87], v[60:63], v[204:207], v[84:87]
  s_add_u32 m0, s61, 11360
  s_nop 0
  buffer_load_dwordx4 v4, s[52:55], s63 offen lds
  s_waitcnt lgkmcnt(0)
  v_mfma_f32_16x16x32_bf16 v[64:67], v[16:19], v[136:139], 0
  ds_read_b128 v[40:43], v5 offset:13184
  v_mfma_f32_16x16x32_bf16 v[68:71], v[16:19], v[160:163], 0
  ds_read_b128 v[44:47], v5 offset:13248
  v_mfma_f32_16x16x32_bf16 v[72:75], v[16:19], v[184:187], 0
  ds_read_b128 v[48:51], v5 offset:13312
  v_mfma_f32_16x16x32_bf16 v[64:67], v[20:23], v[140:143], v[64:67]
  ds_read_b128 v[52:55], v5 offset:13376
  v_cvt_pk_bf16_f32 v76, v76, v77
  v_mfma_f32_16x16x32_bf16 v[68:71], v[20:23], v[164:167], v[68:71]
  ds_read_b128 v[56:59], v5 offset:13440
  v_cvt_pk_bf16_f32 v77, v78, v79
  v_mfma_f32_16x16x32_bf16 v[72:75], v[20:23], v[188:191], v[72:75]
  ds_read_b128 v[60:63], v5 offset:13504
  v_accvgpr_write_b32 a26, v76
  v_mfma_f32_16x16x32_bf16 v[64:67], v[24:27], v[144:147], v[64:67]
  v_accvgpr_write_b32 a27, v77
  v_mfma_f32_16x16x32_bf16 v[68:71], v[24:27], v[168:171], v[68:71]
  v_cvt_pk_bf16_f32 v80, v80, v81
  v_mfma_f32_16x16x32_bf16 v[72:75], v[24:27], v[192:195], v[72:75]
  v_cvt_pk_bf16_f32 v81, v82, v83
  v_mfma_f32_16x16x32_bf16 v[64:67], v[28:31], v[148:151], v[64:67]
  v_accvgpr_write_b32 a106, v80
  v_mfma_f32_16x16x32_bf16 v[68:71], v[28:31], v[172:175], v[68:71]
  v_accvgpr_write_b32 a107, v81
  v_mfma_f32_16x16x32_bf16 v[72:75], v[28:31], v[196:199], v[72:75]
  v_cvt_pk_bf16_f32 v84, v84, v85
  v_mfma_f32_16x16x32_bf16 v[64:67], v[32:35], v[152:155], v[64:67]
  v_cvt_pk_bf16_f32 v85, v86, v87
  v_mfma_f32_16x16x32_bf16 v[68:71], v[32:35], v[176:179], v[68:71]
  v_accvgpr_write_b32 a186, v84
  v_mfma_f32_16x16x32_bf16 v[72:75], v[32:35], v[200:203], v[72:75]
  v_accvgpr_write_b32 a187, v85
  v_mfma_f32_16x16x32_bf16 v[64:67], v[36:39], v[156:159], v[64:67]
  v_mfma_f32_16x16x32_bf16 v[68:71], v[36:39], v[180:183], v[68:71]
  v_mfma_f32_16x16x32_bf16 v[72:75], v[36:39], v[204:207], v[72:75]
  s_waitcnt lgkmcnt(0)
  s_waitcnt vmcnt(0)
  v_mfma_f32_16x16x32_bf16 v[76:79], v[40:43], v[136:139], 0
  ds_read_b128 v[16:19], v5 offset:0
  v_mfma_f32_16x16x32_bf16 v[80:83], v[40:43], v[160:163], 0
  ds_read_b128 v[20:23], v5 offset:64
  v_mfma_f32_16x16x32_bf16 v[84:87], v[40:43], v[184:187], 0
  ds_read_b128 v[24:27], v5 offset:128
  v_mfma_f32_16x16x32_bf16 v[76:79], v[44:47], v[140:143], v[76:79]
  ds_read_b128 v[28:31], v5 offset:192
  v_cvt_pk_bf16_f32 v64, v64, v65
  v_mfma_f32_16x16x32_bf16 v[80:83], v[44:47], v[164:167], v[80:83]
  ds_read_b128 v[32:35], v5 offset:256
  v_cvt_pk_bf16_f32 v65, v66, v67
  v_mfma_f32_16x16x32_bf16 v[84:87], v[44:47], v[188:191], v[84:87]
  ds_read_b128 v[36:39], v5 offset:320
  v_accvgpr_write_b32 a28, v64
  v_mfma_f32_16x16x32_bf16 v[76:79], v[48:51], v[144:147], v[76:79]
  s_add_u32 s63, s62, 4423680
  s_add_u32 m0, s61, 12416
  s_nop 0
  buffer_load_dwordx4 v2, s[52:55], s63 offen lds
  v_accvgpr_write_b32 a29, v65
  v_mfma_f32_16x16x32_bf16 v[80:83], v[48:51], v[168:171], v[80:83]
  s_add_u32 m0, s61, 13440
  s_nop 0
  buffer_load_dwordx4 v3, s[52:55], s63 offen lds
  v_cvt_pk_bf16_f32 v68, v68, v69
  v_mfma_f32_16x16x32_bf16 v[84:87], v[48:51], v[192:195], v[84:87]
  s_add_u32 m0, s61, 14464
  s_nop 0
  buffer_load_dwordx4 v4, s[52:55], s63 offen lds
  v_cvt_pk_bf16_f32 v69, v70, v71
  v_mfma_f32_16x16x32_bf16 v[76:79], v[52:55], v[148:151], v[76:79]
  s_add_u32 s63, s62, 4521984
  s_add_u32 m0, s61, 15520
  s_nop 0
  buffer_load_dwordx4 v2, s[52:55], s63 offen lds
  v_accvgpr_write_b32 a108, v68
  v_mfma_f32_16x16x32_bf16 v[80:83], v[52:55], v[172:175], v[80:83]
  s_add_u32 m0, s61, 16544
  s_nop 0
  buffer_load_dwordx4 v3, s[52:55], s63 offen lds
  v_accvgpr_write_b32 a109, v69
  v_mfma_f32_16x16x32_bf16 v[84:87], v[52:55], v[196:199], v[84:87]
  s_add_u32 m0, s61, 17568
  s_nop 0
  buffer_load_dwordx4 v4, s[52:55], s63 offen lds
  v_cvt_pk_bf16_f32 v72, v72, v73
  v_mfma_f32_16x16x32_bf16 v[76:79], v[56:59], v[152:155], v[76:79]
  s_add_u32 s63, s62, 4620288
  s_add_u32 m0, s61, 18624
  s_nop 0
  buffer_load_dwordx4 v2, s[52:55], s63 offen lds
  v_cvt_pk_bf16_f32 v73, v74, v75
  v_mfma_f32_16x16x32_bf16 v[80:83], v[56:59], v[176:179], v[80:83]
  s_add_u32 m0, s61, 19648
  s_nop 0
  buffer_load_dwordx4 v3, s[52:55], s63 offen lds
  v_accvgpr_write_b32 a188, v72
  v_mfma_f32_16x16x32_bf16 v[84:87], v[56:59], v[200:203], v[84:87]
  s_add_u32 m0, s61, 20672
  s_nop 0
  buffer_load_dwordx4 v4, s[52:55], s63 offen lds
  v_accvgpr_write_b32 a189, v73
  v_mfma_f32_16x16x32_bf16 v[76:79], v[60:63], v[156:159], v[76:79]
  s_add_u32 s63, s62, 4718592
  s_add_u32 m0, s61, 21728
  s_nop 0
  buffer_load_dwordx4 v2, s[52:55], s63 offen lds
  v_mfma_f32_16x16x32_bf16 v[80:83], v[60:63], v[180:183], v[80:83]
  s_add_u32 m0, s61, 22752
  s_nop 0
  buffer_load_dwordx4 v3, s[52:55], s63 offen lds
  v_mfma_f32_16x16x32_bf16 v[84:87], v[60:63], v[204:207], v[84:87]
  s_add_u32 m0, s61, 23776
  s_nop 0
  buffer_load_dwordx4 v4, s[52:55], s63 offen lds
  s_waitcnt lgkmcnt(0)
  v_mfma_f32_16x16x32_bf16 v[64:67], v[16:19], v[136:139], 0
  ds_read_b128 v[40:43], v5 offset:768
  v_mfma_f32_16x16x32_bf16 v[68:71], v[16:19], v[160:163], 0
  ds_read_b128 v[44:47], v5 offset:832
  v_mfma_f32_16x16x32_bf16 v[72:75], v[16:19], v[184:187], 0
  ds_read_b128 v[48:51], v5 offset:896
  v_mfma_f32_16x16x32_bf16 v[64:67], v[20:23], v[140:143], v[64:67]
  ds_read_b128 v[52:55], v5 offset:960
  v_cvt_pk_bf16_f32 v76, v76, v77
  v_mfma_f32_16x16x32_bf16 v[68:71], v[20:23], v[164:167], v[68:71]
  ds_read_b128 v[56:59], v5 offset:1024
  v_cvt_pk_bf16_f32 v77, v78, v79
  v_mfma_f32_16x16x32_bf16 v[72:75], v[20:23], v[188:191], v[72:75]
  ds_read_b128 v[60:63], v5 offset:1088
  v_accvgpr_write_b32 a30, v76
  v_mfma_f32_16x16x32_bf16 v[64:67], v[24:27], v[144:147], v[64:67]
  v_accvgpr_write_b32 a31, v77
  v_mfma_f32_16x16x32_bf16 v[68:71], v[24:27], v[168:171], v[68:71]
  v_cvt_pk_bf16_f32 v80, v80, v81
  v_mfma_f32_16x16x32_bf16 v[72:75], v[24:27], v[192:195], v[72:75]
  v_cvt_pk_bf16_f32 v81, v82, v83
  v_mfma_f32_16x16x32_bf16 v[64:67], v[28:31], v[148:151], v[64:67]
  v_accvgpr_write_b32 a110, v80
  v_mfma_f32_16x16x32_bf16 v[68:71], v[28:31], v[172:175], v[68:71]
  v_accvgpr_write_b32 a111, v81
  v_mfma_f32_16x16x32_bf16 v[72:75], v[28:31], v[196:199], v[72:75]
  v_cvt_pk_bf16_f32 v84, v84, v85
  v_mfma_f32_16x16x32_bf16 v[64:67], v[32:35], v[152:155], v[64:67]
  v_cvt_pk_bf16_f32 v85, v86, v87
  v_mfma_f32_16x16x32_bf16 v[68:71], v[32:35], v[176:179], v[68:71]
  v_accvgpr_write_b32 a190, v84
  v_mfma_f32_16x16x32_bf16 v[72:75], v[32:35], v[200:203], v[72:75]
  v_accvgpr_write_b32 a191, v85
  v_mfma_f32_16x16x32_bf16 v[64:67], v[36:39], v[156:159], v[64:67]
  v_mfma_f32_16x16x32_bf16 v[68:71], v[36:39], v[180:183], v[68:71]
  v_mfma_f32_16x16x32_bf16 v[72:75], v[36:39], v[204:207], v[72:75]
  s_waitcnt lgkmcnt(0)
  s_waitcnt vmcnt(0)
  v_mfma_f32_16x16x32_bf16 v[76:79], v[40:43], v[136:139], 0
  ds_read_b128 v[16:19], v5 offset:12416
  v_mfma_f32_16x16x32_bf16 v[80:83], v[40:43], v[160:163], 0
  ds_read_b128 v[20:23], v5 offset:12480
  v_mfma_f32_16x16x32_bf16 v[84:87], v[40:43], v[184:187], 0
  ds_read_b128 v[24:27], v5 offset:12544
  v_mfma_f32_16x16x32_bf16 v[76:79], v[44:47], v[140:143], v[76:79]
  ds_read_b128 v[28:31], v5 offset:12608
  v_cvt_pk_bf16_f32 v64, v64, v65
  v_mfma_f32_16x16x32_bf16 v[80:83], v[44:47], v[164:167], v[80:83]
  ds_read_b128 v[32:35], v5 offset:12672
  v_cvt_pk_bf16_f32 v65, v66, v67
  v_mfma_f32_16x16x32_bf16 v[84:87], v[44:47], v[188:191], v[84:87]
  ds_read_b128 v[36:39], v5 offset:12736
  v_accvgpr_write_b32 a32, v64
  v_mfma_f32_16x16x32_bf16 v[76:79], v[48:51], v[144:147], v[76:79]
  s_add_u32 s63, s62, 4915200
  s_add_u32 m0, s61, 0
  s_nop 0
  buffer_load_dwordx4 v2, s[52:55], s63 offen lds
  v_accvgpr_write_b32 a33, v65
  v_mfma_f32_16x16x32_bf16 v[80:83], v[48:51], v[168:171], v[80:83]
  s_add_u32 m0, s61, 1024
  s_nop 0
  buffer_load_dwordx4 v3, s[52:55], s63 offen lds
  v_cvt_pk_bf16_f32 v68, v68, v69
  v_mfma_f32_16x16x32_bf16 v[84:87], v[48:51], v[192:195], v[84:87]
  s_add_u32 m0, s61, 2048
  s_nop 0
  buffer_load_dwordx4 v4, s[52:55], s63 offen lds
  v_cvt_pk_bf16_f32 v69, v70, v71
  v_mfma_f32_16x16x32_bf16 v[76:79], v[52:55], v[148:151], v[76:79]
  s_add_u32 s63, s62, 5013504
  s_add_u32 m0, s61, 3104
  s_nop 0
  buffer_load_dwordx4 v2, s[52:55], s63 offen lds
  v_accvgpr_write_b32 a112, v68
  v_mfma_f32_16x16x32_bf16 v[80:83], v[52:55], v[172:175], v[80:83]
  s_add_u32 m0, s61, 4128
  s_nop 0
  buffer_load_dwordx4 v3, s[52:55], s63 offen lds
  v_accvgpr_write_b32 a113, v69
  v_mfma_f32_16x16x32_bf16 v[84:87], v[52:55], v[196:199], v[84:87]
  s_add_u32 m0, s61, 5152
  s_nop 0
  buffer_load_dwordx4 v4, s[52:55], s63 offen lds
  v_cvt_pk_bf16_f32 v72, v72, v73
  v_mfma_f32_16x16x32_bf16 v[76:79], v[56:59], v[152:155], v[76:79]
  s_add_u32 s63, s62, 5111808
  s_add_u32 m0, s61, 6208
  s_nop 0
  buffer_load_dwordx4 v2, s[52:55], s63 offen lds
  v_cvt_pk_bf16_f32 v73, v74, v75
  v_mfma_f32_16x16x32_bf16 v[80:83], v[56:59], v[176:179], v[80:83]
  s_add_u32 m0, s61, 7232
  s_nop 0
  buffer_load_dwordx4 v3, s[52:55], s63 offen lds
  v_accvgpr_write_b32 a192, v72
  v_mfma_f32_16x16x32_bf16 v[84:87], v[56:59], v[200:203], v[84:87]
  s_add_u32 m0, s61, 8256
  s_nop 0
  buffer_load_dwordx4 v4, s[52:55], s63 offen lds
  v_accvgpr_write_b32 a193, v73
  v_mfma_f32_16x16x32_bf16 v[76:79], v[60:63], v[156:159], v[76:79]
  s_add_u32 s63, s62, 5210112
  s_add_u32 m0, s61, 9312
  s_nop 0
  buffer_load_dwordx4 v2, s[52:55], s63 offen lds
  v_mfma_f32_16x16x32_bf16 v[80:83], v[60:63], v[180:183], v[80:83]
  s_add_u32 m0, s61, 10336
  s_nop 0
  buffer_load_dwordx4 v3, s[52:55], s63 offen lds
  v_mfma_f32_16x16x32_bf16 v[84:87], v[60:63], v[204:207], v[84:87]
  s_add_u32 m0, s61, 11360
  s_nop 0
  buffer_load_dwordx4 v4, s[52:55], s63 offen lds
  s_waitcnt lgkmcnt(0)
  v_mfma_f32_16x16x32_bf16 v[64:67], v[16:19], v[136:139], 0
  ds_read_b128 v[40:43], v5 offset:13184
  v_mfma_f32_16x16x32_bf16 v[68:71], v[16:19], v[160:163], 0
  ds_read_b128 v[44:47], v5 offset:13248
  v_mfma_f32_16x16x32_bf16 v[72:75], v[16:19], v[184:187], 0
  ds_read_b128 v[48:51], v5 offset:13312
  v_mfma_f32_16x16x32_bf16 v[64:67], v[20:23], v[140:143], v[64:67]
  ds_read_b128 v[52:55], v5 offset:13376
  v_cvt_pk_bf16_f32 v76, v76, v77
  v_mfma_f32_16x16x32_bf16 v[68:71], v[20:23], v[164:167], v[68:71]
  ds_read_b128 v[56:59], v5 offset:13440
  v_cvt_pk_bf16_f32 v77, v78, v79
  v_mfma_f32_16x16x32_bf16 v[72:75], v[20:23], v[188:191], v[72:75]
  ds_read_b128 v[60:63], v5 offset:13504
  v_accvgpr_write_b32 a34, v76
  v_mfma_f32_16x16x32_bf16 v[64:67], v[24:27], v[144:147], v[64:67]
  v_accvgpr_write_b32 a35, v77
  v_mfma_f32_16x16x32_bf16 v[68:71], v[24:27], v[168:171], v[68:71]
  v_cvt_pk_bf16_f32 v80, v80, v81
  v_mfma_f32_16x16x32_bf16 v[72:75], v[24:27], v[192:195], v[72:75]
  v_cvt_pk_bf16_f32 v81, v82, v83
  v_mfma_f32_16x16x32_bf16 v[64:67], v[28:31], v[148:151], v[64:67]
  v_accvgpr_write_b32 a114, v80
  v_mfma_f32_16x16x32_bf16 v[68:71], v[28:31], v[172:175], v[68:71]
  v_accvgpr_write_b32 a115, v81
  v_mfma_f32_16x16x32_bf16 v[72:75], v[28:31], v[196:199], v[72:75]
  v_cvt_pk_bf16_f32 v84, v84, v85
  v_mfma_f32_16x16x32_bf16 v[64:67], v[32:35], v[152:155], v[64:67]
  v_cvt_pk_bf16_f32 v85, v86, v87
  v_mfma_f32_16x16x32_bf16 v[68:71], v[32:35], v[176:179], v[68:71]
  v_accvgpr_write_b32 a194, v84
  v_mfma_f32_16x16x32_bf16 v[72:75], v[32:35], v[200:203], v[72:75]
  v_accvgpr_write_b32 a195, v85
  v_mfma_f32_16x16x32_bf16 v[64:67], v[36:39], v[156:159], v[64:67]
  v_mfma_f32_16x16x32_bf16 v[68:71], v[36:39], v[180:183], v[68:71]
  v_mfma_f32_16x16x32_bf16 v[72:75], v[36:39], v[204:207], v[72:75]
  s_waitcnt lgkmcnt(0)
  s_waitcnt vmcnt(0)
  v_mfma_f32_16x16x32_bf16 v[76:79], v[40:43], v[136:139], 0
  ds_read_b128 v[16:19], v5 offset:0
  v_mfma_f32_16x16x32_bf16 v[80:83], v[40:43], v[160:163], 0
  ds_read_b128 v[20:23], v5 offset:64
  v_mfma_f32_16x16x32_bf16 v[84:87], v[40:43], v[184:187], 0
  ds_read_b128 v[24:27], v5 offset:128
  v_mfma_f32_16x16x32_bf16 v[76:79], v[44:47], v[140:143], v[76:79]
  ds_read_b128 v[28:31], v5 offset:192
  v_cvt_pk_bf16_f32 v64, v64, v65
  v_mfma_f32_16x16x32_bf16 v[80:83], v[44:47], v[164:167], v[80:83]
  ds_read_b128 v[32:35], v5 offset:256
  v_cvt_pk_bf16_f32 v65, v66, v67
  v_mfma_f32_16x16x32_bf16 v[84:87], v[44:47], v[188:191], v[84:87]
  ds_read_b128 v[36:39], v5 offset:320
  v_accvgpr_write_b32 a36, v64
  v_mfma_f32_16x16x32_bf16 v[76:79], v[48:51], v[144:147], v[76:79]
  s_add_u32 s63, s62, 5406720
  s_add_u32 m0, s61, 12416
  s_nop 0
  buffer_load_dwordx4 v2, s[52:55], s63 offen lds
  v_accvgpr_write_b32 a37, v65
  v_mfma_f32_16x16x32_bf16 v[80:83], v[48:51], v[168:171], v[80:83]
  s_add_u32 m0, s61, 13440
  s_nop 0
  buffer_load_dwordx4 v3, s[52:55], s63 offen lds
  v_cvt_pk_bf16_f32 v68, v68, v69
  v_mfma_f32_16x16x32_bf16 v[84:87], v[48:51], v[192:195], v[84:87]
  s_add_u32 m0, s61, 14464
  s_nop 0
  buffer_load_dwordx4 v4, s[52:55], s63 offen lds
  v_cvt_pk_bf16_f32 v69, v70, v71
  v_mfma_f32_16x16x32_bf16 v[76:79], v[52:55], v[148:151], v[76:79]
  s_add_u32 s63, s62, 5505024
  s_add_u32 m0, s61, 15520
  s_nop 0
  buffer_load_dwordx4 v2, s[52:55], s63 offen lds
  v_accvgpr_write_b32 a116, v68
  v_mfma_f32_16x16x32_bf16 v[80:83], v[52:55], v[172:175], v[80:83]
  s_add_u32 m0, s61, 16544
  s_nop 0
  buffer_load_dwordx4 v3, s[52:55], s63 offen lds
  v_accvgpr_write_b32 a117, v69
  v_mfma_f32_16x16x32_bf16 v[84:87], v[52:55], v[196:199], v[84:87]
  s_add_u32 m0, s61, 17568
  s_nop 0
  buffer_load_dwordx4 v4, s[52:55], s63 offen lds
  v_cvt_pk_bf16_f32 v72, v72, v73
  v_mfma_f32_16x16x32_bf16 v[76:79], v[56:59], v[152:155], v[76:79]
  s_add_u32 s63, s62, 5603328
  s_add_u32 m0, s61, 18624
  s_nop 0
  buffer_load_dwordx4 v2, s[52:55], s63 offen lds
  v_cvt_pk_bf16_f32 v73, v74, v75
  v_mfma_f32_16x16x32_bf16 v[80:83], v[56:59], v[176:179], v[80:83]
  s_add_u32 m0, s61, 19648
  s_nop 0
  buffer_load_dwordx4 v3, s[52:55], s63 offen lds
  v_accvgpr_write_b32 a196, v72
  v_mfma_f32_16x16x32_bf16 v[84:87], v[56:59], v[200:203], v[84:87]
  s_add_u32 m0, s61, 20672
  s_nop 0
  buffer_load_dwordx4 v4, s[52:55], s63 offen lds
  v_accvgpr_write_b32 a197, v73
  v_mfma_f32_16x16x32_bf16 v[76:79], v[60:63], v[156:159], v[76:79]
  s_add_u32 s63, s62, 5701632
  s_add_u32 m0, s61, 21728
  s_nop 0
  buffer_load_dwordx4 v2, s[52:55], s63 offen lds
  v_mfma_f32_16x16x32_bf16 v[80:83], v[60:63], v[180:183], v[80:83]
  s_add_u32 m0, s61, 22752
  s_nop 0
  buffer_load_dwordx4 v3, s[52:55], s63 offen lds
  v_mfma_f32_16x16x32_bf16 v[84:87], v[60:63], v[204:207], v[84:87]
  s_add_u32 m0, s61, 23776
  s_nop 0
  buffer_load_dwordx4 v4, s[52:55], s63 offen lds
  s_waitcnt lgkmcnt(0)
  v_mfma_f32_16x16x32_bf16 v[64:67], v[16:19], v[136:139], 0
  ds_read_b128 v[40:43], v5 offset:768
  v_mfma_f32_16x16x32_bf16 v[68:71], v[16:19], v[160:163], 0
  ds_read_b128 v[44:47], v5 offset:832
  v_mfma_f32_16x16x32_bf16 v[72:75], v[16:19], v[184:187], 0
  ds_read_b128 v[48:51], v5 offset:896
  v_mfma_f32_16x16x32_bf16 v[64:67], v[20:23], v[140:143], v[64:67]
  ds_read_b128 v[52:55], v5 offset:960
  v_cvt_pk_bf16_f32 v76, v76, v77
  v_mfma_f32_16x16x32_bf16 v[68:71], v[20:23], v[164:167], v[68:71]
  ds_read_b128 v[56:59], v5 offset:1024
  v_cvt_pk_bf16_f32 v77, v78, v79
  v_mfma_f32_16x16x32_bf16 v[72:75], v[20:23], v[188:191], v[72:75]
  ds_read_b128 v[60:63], v5 offset:1088
  v_accvgpr_write_b32 a38, v76
  v_mfma_f32_16x16x32_bf16 v[64:67], v[24:27], v[144:147], v[64:67]
  v_accvgpr_write_b32 a39, v77
  v_mfma_f32_16x16x32_bf16 v[68:71], v[24:27], v[168:171], v[68:71]
  v_cvt_pk_bf16_f32 v80, v80, v81
  v_mfma_f32_16x16x32_bf16 v[72:75], v[24:27], v[192:195], v[72:75]
  v_cvt_pk_bf16_f32 v81, v82, v83
  v_mfma_f32_16x16x32_bf16 v[64:67], v[28:31], v[148:151], v[64:67]
  v_accvgpr_write_b32 a118, v80
  v_mfma_f32_16x16x32_bf16 v[68:71], v[28:31], v[172:175], v[68:71]
  v_accvgpr_write_b32 a119, v81
  v_mfma_f32_16x16x32_bf16 v[72:75], v[28:31], v[196:199], v[72:75]
  v_cvt_pk_bf16_f32 v84, v84, v85
  v_mfma_f32_16x16x32_bf16 v[64:67], v[32:35], v[152:155], v[64:67]
  v_cvt_pk_bf16_f32 v85, v86, v87
  v_mfma_f32_16x16x32_bf16 v[68:71], v[32:35], v[176:179], v[68:71]
  v_accvgpr_write_b32 a198, v84
  v_mfma_f32_16x16x32_bf16 v[72:75], v[32:35], v[200:203], v[72:75]
  v_accvgpr_write_b32 a199, v85
  v_mfma_f32_16x16x32_bf16 v[64:67], v[36:39], v[156:159], v[64:67]
  v_mfma_f32_16x16x32_bf16 v[68:71], v[36:39], v[180:183], v[68:71]
  v_mfma_f32_16x16x32_bf16 v[72:75], v[36:39], v[204:207], v[72:75]
  s_waitcnt lgkmcnt(0)
  s_waitcnt vmcnt(0)
  v_mfma_f32_16x16x32_bf16 v[76:79], v[40:43], v[136:139], 0
  ds_read_b128 v[16:19], v5 offset:12416
  v_mfma_f32_16x16x32_bf16 v[80:83], v[40:43], v[160:163], 0
  ds_read_b128 v[20:23], v5 offset:12480
  v_mfma_f32_16x16x32_bf16 v[84:87], v[40:43], v[184:187], 0
  ds_read_b128 v[24:27], v5 offset:12544
  v_mfma_f32_16x16x32_bf16 v[76:79], v[44:47], v[140:143], v[76:79]
  ds_read_b128 v[28:31], v5 offset:12608
  v_cvt_pk_bf16_f32 v64, v64, v65
  v_mfma_f32_16x16x32_bf16 v[80:83], v[44:47], v[164:167], v[80:83]
  ds_read_b128 v[32:35], v5 offset:12672
  v_cvt_pk_bf16_f32 v65, v66, v67
  v_mfma_f32_16x16x32_bf16 v[84:87], v[44:47], v[188:191], v[84:87]
  ds_read_b128 v[36:39], v5 offset:12736
  v_accvgpr_write_b32 a40, v64
  v_mfma_f32_16x16x32_bf16 v[76:79], v[48:51], v[144:147], v[76:79]
  s_add_u32 s63, s62, 5898240
  s_add_u32 m0, s61, 0
  s_nop 0
  buffer_load_dwordx4 v2, s[52:55], s63 offen lds
  v_accvgpr_write_b32 a41, v65
  v_mfma_f32_16x16x32_bf16 v[80:83], v[48:51], v[168:171], v[80:83]
  s_add_u32 m0, s61, 1024
  s_nop 0
  buffer_load_dwordx4 v3, s[52:55], s63 offen lds
  v_cvt_pk_bf16_f32 v68, v68, v69
  v_mfma_f32_16x16x32_bf16 v[84:87], v[48:51], v[192:195], v[84:87]
  s_add_u32 m0, s61, 2048
  s_nop 0
  buffer_load_dwordx4 v4, s[52:55], s63 offen lds
  v_cvt_pk_bf16_f32 v69, v70, v71
  v_mfma_f32_16x16x32_bf16 v[76:79], v[52:55], v[148:151], v[76:79]
  s_add_u32 s63, s62, 5996544
  s_add_u32 m0, s61, 3104
  s_nop 0
  buffer_load_dwordx4 v2, s[52:55], s63 offen lds
  v_accvgpr_write_b32 a120, v68
  v_mfma_f32_16x16x32_bf16 v[80:83], v[52:55], v[172:175], v[80:83]
  s_add_u32 m0, s61, 4128
  s_nop 0
  buffer_load_dwordx4 v3, s[52:55], s63 offen lds
  v_accvgpr_write_b32 a121, v69
  v_mfma_f32_16x16x32_bf16 v[84:87], v[52:55], v[196:199], v[84:87]
  s_add_u32 m0, s61, 5152
  s_nop 0
  buffer_load_dwordx4 v4, s[52:55], s63 offen lds
  v_cvt_pk_bf16_f32 v72, v72, v73
  v_mfma_f32_16x16x32_bf16 v[76:79], v[56:59], v[152:155], v[76:79]
  s_add_u32 s63, s62, 6094848
  s_add_u32 m0, s61, 6208
  s_nop 0
  buffer_load_dwordx4 v2, s[52:55], s63 offen lds
  v_cvt_pk_bf16_f32 v73, v74, v75
  v_mfma_f32_16x16x32_bf16 v[80:83], v[56:59], v[176:179], v[80:83]
  s_add_u32 m0, s61, 7232
  s_nop 0
  buffer_load_dwordx4 v3, s[52:55], s63 offen lds
  v_accvgpr_write_b32 a200, v72
  v_mfma_f32_16x16x32_bf16 v[84:87], v[56:59], v[200:203], v[84:87]
  s_add_u32 m0, s61, 8256
  s_nop 0
  buffer_load_dwordx4 v4, s[52:55], s63 offen lds
  v_accvgpr_write_b32 a201, v73
  v_mfma_f32_16x16x32_bf16 v[76:79], v[60:63], v[156:159], v[76:79]
  s_add_u32 s63, s62, 6193152
  s_add_u32 m0, s61, 9312
  s_nop 0
  buffer_load_dwordx4 v2, s[52:55], s63 offen lds
  v_mfma_f32_16x16x32_bf16 v[80:83], v[60:63], v[180:183], v[80:83]
  s_add_u32 m0, s61, 10336
  s_nop 0
  buffer_load_dwordx4 v3, s[52:55], s63 offen lds
  v_mfma_f32_16x16x32_bf16 v[84:87], v[60:63], v[204:207], v[84:87]
  s_add_u32 m0, s61, 11360
  s_nop 0
  buffer_load_dwordx4 v4, s[52:55], s63 offen lds
  s_waitcnt lgkmcnt(0)
  v_mfma_f32_16x16x32_bf16 v[64:67], v[16:19], v[136:139], 0
  ds_read_b128 v[40:43], v5 offset:13184
  v_mfma_f32_16x16x32_bf16 v[68:71], v[16:19], v[160:163], 0
  ds_read_b128 v[44:47], v5 offset:13248
  v_mfma_f32_16x16x32_bf16 v[72:75], v[16:19], v[184:187], 0
  ds_read_b128 v[48:51], v5 offset:13312
  v_mfma_f32_16x16x32_bf16 v[64:67], v[20:23], v[140:143], v[64:67]
  ds_read_b128 v[52:55], v5 offset:13376
  v_cvt_pk_bf16_f32 v76, v76, v77
  v_mfma_f32_16x16x32_bf16 v[68:71], v[20:23], v[164:167], v[68:71]
  ds_read_b128 v[56:59], v5 offset:13440
  v_cvt_pk_bf16_f32 v77, v78, v79
  v_mfma_f32_16x16x32_bf16 v[72:75], v[20:23], v[188:191], v[72:75]
  ds_read_b128 v[60:63], v5 offset:13504
  v_accvgpr_write_b32 a42, v76
  v_mfma_f32_16x16x32_bf16 v[64:67], v[24:27], v[144:147], v[64:67]
  v_accvgpr_write_b32 a43, v77
  v_mfma_f32_16x16x32_bf16 v[68:71], v[24:27], v[168:171], v[68:71]
  v_cvt_pk_bf16_f32 v80, v80, v81
  v_mfma_f32_16x16x32_bf16 v[72:75], v[24:27], v[192:195], v[72:75]
  v_cvt_pk_bf16_f32 v81, v82, v83
  v_mfma_f32_16x16x32_bf16 v[64:67], v[28:31], v[148:151], v[64:67]
  v_accvgpr_write_b32 a122, v80
  v_mfma_f32_16x16x32_bf16 v[68:71], v[28:31], v[172:175], v[68:71]
  v_accvgpr_write_b32 a123, v81
  v_mfma_f32_16x16x32_bf16 v[72:75], v[28:31], v[196:199], v[72:75]
  v_cvt_pk_bf16_f32 v84, v84, v85
  v_mfma_f32_16x16x32_bf16 v[64:67], v[32:35], v[152:155], v[64:67]
  v_cvt_pk_bf16_f32 v85, v86, v87
  v_mfma_f32_16x16x32_bf16 v[68:71], v[32:35], v[176:179], v[68:71]
  v_accvgpr_write_b32 a202, v84
  v_mfma_f32_16x16x32_bf16 v[72:75], v[32:35], v[200:203], v[72:75]
  v_accvgpr_write_b32 a203, v85
  v_mfma_f32_16x16x32_bf16 v[64:67], v[36:39], v[156:159], v[64:67]
  v_mfma_f32_16x16x32_bf16 v[68:71], v[36:39], v[180:183], v[68:71]
  v_mfma_f32_16x16x32_bf16 v[72:75], v[36:39], v[204:207], v[72:75]
  s_waitcnt lgkmcnt(0)
  s_waitcnt vmcnt(0)
  v_mfma_f32_16x16x32_bf16 v[76:79], v[40:43], v[136:139], 0
  ds_read_b128 v[16:19], v5 offset:0
  v_mfma_f32_16x16x32_bf16 v[80:83], v[40:43], v[160:163], 0
  ds_read_b128 v[20:23], v5 offset:64
  v_mfma_f32_16x16x32_bf16 v[84:87], v[40:43], v[184:187], 0
  ds_read_b128 v[24:27], v5 offset:128
  v_mfma_f32_16x16x32_bf16 v[76:79], v[44:47], v[140:143], v[76:79]
  ds_read_b128 v[28:31], v5 offset:192
  v_cvt_pk_bf16_f32 v64, v64, v65
  v_mfma_f32_16x16x32_bf16 v[80:83], v[44:47], v[164:167], v[80:83]
  ds_read_b128 v[32:35], v5 offset:256
  v_cvt_pk_bf16_f32 v65, v66, v67
  v_mfma_f32_16x16x32_bf16 v[84:87], v[44:47], v[188:191], v[84:87]
  ds_read_b128 v[36:39], v5 offset:320
  v_accvgpr_write_b32 a44, v64
  v_mfma_f32_16x16x32_bf16 v[76:79], v[48:51], v[144:147], v[76:79]
  s_add_u32 s63, s62, 6389760
  s_add_u32 m0, s61, 12416
  s_nop 0
  buffer_load_dwordx4 v2, s[52:55], s63 offen lds
  v_accvgpr_write_b32 a45, v65
  v_mfma_f32_16x16x32_bf16 v[80:83], v[48:51], v[168:171], v[80:83]
  s_add_u32 m0, s61, 13440
  s_nop 0
  buffer_load_dwordx4 v3, s[52:55], s63 offen lds
  v_cvt_pk_bf16_f32 v68, v68, v69
  v_mfma_f32_16x16x32_bf16 v[84:87], v[48:51], v[192:195], v[84:87]
  s_add_u32 m0, s61, 14464
  s_nop 0
  buffer_load_dwordx4 v4, s[52:55], s63 offen lds
  v_cvt_pk_bf16_f32 v69, v70, v71
  v_mfma_f32_16x16x32_bf16 v[76:79], v[52:55], v[148:151], v[76:79]
  s_add_u32 s63, s62, 6488064
  s_add_u32 m0, s61, 15520
  s_nop 0
  buffer_load_dwordx4 v2, s[52:55], s63 offen lds
  v_accvgpr_write_b32 a124, v68
  v_mfma_f32_16x16x32_bf16 v[80:83], v[52:55], v[172:175], v[80:83]
  s_add_u32 m0, s61, 16544
  s_nop 0
  buffer_load_dwordx4 v3, s[52:55], s63 offen lds
  v_accvgpr_write_b32 a125, v69
  v_mfma_f32_16x16x32_bf16 v[84:87], v[52:55], v[196:199], v[84:87]
  s_add_u32 m0, s61, 17568
  s_nop 0
  buffer_load_dwordx4 v4, s[52:55], s63 offen lds
  v_cvt_pk_bf16_f32 v72, v72, v73
  v_mfma_f32_16x16x32_bf16 v[76:79], v[56:59], v[152:155], v[76:79]
  s_add_u32 s63, s62, 6586368
  s_add_u32 m0, s61, 18624
  s_nop 0
  buffer_load_dwordx4 v2, s[52:55], s63 offen lds
  v_cvt_pk_bf16_f32 v73, v74, v75
  v_mfma_f32_16x16x32_bf16 v[80:83], v[56:59], v[176:179], v[80:83]
  s_add_u32 m0, s61, 19648
  s_nop 0
  buffer_load_dwordx4 v3, s[52:55], s63 offen lds
  v_accvgpr_write_b32 a204, v72
  v_mfma_f32_16x16x32_bf16 v[84:87], v[56:59], v[200:203], v[84:87]
  s_add_u32 m0, s61, 20672
  s_nop 0
  buffer_load_dwordx4 v4, s[52:55], s63 offen lds
  v_accvgpr_write_b32 a205, v73
  v_mfma_f32_16x16x32_bf16 v[76:79], v[60:63], v[156:159], v[76:79]
  s_add_u32 s63, s62, 6684672
  s_add_u32 m0, s61, 21728
  s_nop 0
  buffer_load_dwordx4 v2, s[52:55], s63 offen lds
  v_mfma_f32_16x16x32_bf16 v[80:83], v[60:63], v[180:183], v[80:83]
  s_add_u32 m0, s61, 22752
  s_nop 0
  buffer_load_dwordx4 v3, s[52:55], s63 offen lds
  v_mfma_f32_16x16x32_bf16 v[84:87], v[60:63], v[204:207], v[84:87]
  s_add_u32 m0, s61, 23776
  s_nop 0
  buffer_load_dwordx4 v4, s[52:55], s63 offen lds
  s_waitcnt lgkmcnt(0)
  v_mfma_f32_16x16x32_bf16 v[64:67], v[16:19], v[136:139], 0
  ds_read_b128 v[40:43], v5 offset:768
  v_mfma_f32_16x16x32_bf16 v[68:71], v[16:19], v[160:163], 0
  ds_read_b128 v[44:47], v5 offset:832
  v_mfma_f32_16x16x32_bf16 v[72:75], v[16:19], v[184:187], 0
  ds_read_b128 v[48:51], v5 offset:896
  v_mfma_f32_16x16x32_bf16 v[64:67], v[20:23], v[140:143], v[64:67]
  ds_read_b128 v[52:55], v5 offset:960
  v_cvt_pk_bf16_f32 v76, v76, v77
  v_mfma_f32_16x16x32_bf16 v[68:71], v[20:23], v[164:167], v[68:71]
  ds_read_b128 v[56:59], v5 offset:1024
  v_cvt_pk_bf16_f32 v77, v78, v79
  v_mfma_f32_16x16x32_bf16 v[72:75], v[20:23], v[188:191], v[72:75]
  ds_read_b128 v[60:63], v5 offset:1088
  v_accvgpr_write_b32 a46, v76
  v_mfma_f32_16x16x32_bf16 v[64:67], v[24:27], v[144:147], v[64:67]
  v_accvgpr_write_b32 a47, v77
  v_mfma_f32_16x16x32_bf16 v[68:71], v[24:27], v[168:171], v[68:71]
  v_cvt_pk_bf16_f32 v80, v80, v81
  v_mfma_f32_16x16x32_bf16 v[72:75], v[24:27], v[192:195], v[72:75]
  v_cvt_pk_bf16_f32 v81, v82, v83
  v_mfma_f32_16x16x32_bf16 v[64:67], v[28:31], v[148:151], v[64:67]
  v_accvgpr_write_b32 a126, v80
  v_mfma_f32_16x16x32_bf16 v[68:71], v[28:31], v[172:175], v[68:71]
  v_accvgpr_write_b32 a127, v81
  v_mfma_f32_16x16x32_bf16 v[72:75], v[28:31], v[196:199], v[72:75]
  v_cvt_pk_bf16_f32 v84, v84, v85
  v_mfma_f32_16x16x32_bf16 v[64:67], v[32:35], v[152:155], v[64:67]
  v_cvt_pk_bf16_f32 v85, v86, v87
  v_mfma_f32_16x16x32_bf16 v[68:71], v[32:35], v[176:179], v[68:71]
  v_accvgpr_write_b32 a206, v84
  v_mfma_f32_16x16x32_bf16 v[72:75], v[32:35], v[200:203], v[72:75]
  v_accvgpr_write_b32 a207, v85
  v_mfma_f32_16x16x32_bf16 v[64:67], v[36:39], v[156:159], v[64:67]
  v_mfma_f32_16x16x32_bf16 v[68:71], v[36:39], v[180:183], v[68:71]
  v_mfma_f32_16x16x32_bf16 v[72:75], v[36:39], v[204:207], v[72:75]
  s_mov_b64 exec, s[82:83]
  s_add_u32 m0, s50, 0
  s_nop 0
  buffer_load_dwordx4 v8, s[92:95], s48 offen lds
  s_add_u32 s48, s48, 122880
  s_mov_b64 exec, -1
  s_mov_b64 exec, s[82:83]
  s_add_u32 m0, s50, 960
  s_nop 0
  buffer_load_dwordx4 v8, s[92:95], s48 offen lds
  s_add_u32 s48, s48, 122880
  s_mov_b64 exec, -1
  s_waitcnt lgkmcnt(0)
  s_waitcnt vmcnt(2)
  v_mfma_f32_16x16x32_bf16 v[76:79], v[40:43], v[136:139], 0
  ds_read_b128 v[16:19], v5 offset:12416
  v_mfma_f32_16x16x32_bf16 v[80:83], v[40:43], v[160:163], 0
  ds_read_b128 v[20:23], v5 offset:12480
  v_mfma_f32_16x16x32_bf16 v[84:87], v[40:43], v[184:187], 0
  ds_read_b128 v[24:27], v5 offset:12544
  v_mfma_f32_16x16x32_bf16 v[76:79], v[44:47], v[140:143], v[76:79]
  ds_read_b128 v[28:31], v5 offset:12608
  v_cvt_pk_bf16_f32 v64, v64, v65
  v_mfma_f32_16x16x32_bf16 v[80:83], v[44:47], v[164:167], v[80:83]
  ds_read_b128 v[32:35], v5 offset:12672
  v_cvt_pk_bf16_f32 v65, v66, v67
  v_mfma_f32_16x16x32_bf16 v[84:87], v[44:47], v[188:191], v[84:87]
  ds_read_b128 v[36:39], v5 offset:12736
  v_accvgpr_write_b32 a48, v64
  v_mfma_f32_16x16x32_bf16 v[76:79], v[48:51], v[144:147], v[76:79]
  s_add_u32 s63, s62, 6881280
  s_add_u32 m0, s61, 0
  s_nop 0
  buffer_load_dwordx4 v2, s[52:55], s63 offen lds
  v_accvgpr_write_b32 a49, v65
  v_mfma_f32_16x16x32_bf16 v[80:83], v[48:51], v[168:171], v[80:83]
  s_add_u32 m0, s61, 1024
  s_nop 0
  buffer_load_dwordx4 v3, s[52:55], s63 offen lds
  v_cvt_pk_bf16_f32 v68, v68, v69
  v_mfma_f32_16x16x32_bf16 v[84:87], v[48:51], v[192:195], v[84:87]
  s_add_u32 m0, s61, 2048
  s_nop 0
  buffer_load_dwordx4 v4, s[52:55], s63 offen lds
  v_cvt_pk_bf16_f32 v69, v70, v71
  v_mfma_f32_16x16x32_bf16 v[76:79], v[52:55], v[148:151], v[76:79]
  s_add_u32 s63, s62, 6979584
  s_add_u32 m0, s61, 3104
  s_nop 0
  buffer_load_dwordx4 v2, s[52:55], s63 offen lds
  v_accvgpr_write_b32 a128, v68
  v_mfma_f32_16x16x32_bf16 v[80:83], v[52:55], v[172:175], v[80:83]
  s_add_u32 m0, s61, 4128
  s_nop 0
  buffer_load_dwordx4 v3, s[52:55], s63 offen lds
  v_accvgpr_write_b32 a129, v69
  v_mfma_f32_16x16x32_bf16 v[84:87], v[52:55], v[196:199], v[84:87]
  s_add_u32 m0, s61, 5152
  s_nop 0
  buffer_load_dwordx4 v4, s[52:55], s63 offen lds
  v_cvt_pk_bf16_f32 v72, v72, v73
  v_mfma_f32_16x16x32_bf16 v[76:79], v[56:59], v[152:155], v[76:79]
  s_add_u32 s63, s62, 7077888
  s_add_u32 m0, s61, 6208
  s_nop 0
  buffer_load_dwordx4 v2, s[52:55], s63 offen lds
  v_cvt_pk_bf16_f32 v73, v74, v75
  v_mfma_f32_16x16x32_bf16 v[80:83], v[56:59], v[176:179], v[80:83]
  s_add_u32 m0, s61, 7232
  s_nop 0
  buffer_load_dwordx4 v3, s[52:55], s63 offen lds
  v_accvgpr_write_b32 a208, v72
  v_mfma_f32_16x16x32_bf16 v[84:87], v[56:59], v[200:203], v[84:87]
  s_add_u32 m0, s61, 8256
  s_nop 0
  buffer_load_dwordx4 v4, s[52:55], s63 offen lds
  v_accvgpr_write_b32 a209, v73
  v_mfma_f32_16x16x32_bf16 v[76:79], v[60:63], v[156:159], v[76:79]
  s_add_u32 s63, s62, 7176192
  s_add_u32 m0, s61, 9312
  s_nop 0
  buffer_load_dwordx4 v2, s[52:55], s63 offen lds
  v_mfma_f32_16x16x32_bf16 v[80:83], v[60:63], v[180:183], v[80:83]
  s_add_u32 m0, s61, 10336
  s_nop 0
  buffer_load_dwordx4 v3, s[52:55], s63 offen lds
  v_mfma_f32_16x16x32_bf16 v[84:87], v[60:63], v[204:207], v[84:87]
  s_add_u32 m0, s61, 11360
  s_nop 0
  buffer_load_dwordx4 v4, s[52:55], s63 offen lds
  s_waitcnt lgkmcnt(0)
  v_mfma_f32_16x16x32_bf16 v[64:67], v[16:19], v[136:139], 0
  ds_read_b128 v[40:43], v5 offset:13184
  v_mfma_f32_16x16x32_bf16 v[68:71], v[16:19], v[160:163], 0
  ds_read_b128 v[44:47], v5 offset:13248
  v_mfma_f32_16x16x32_bf16 v[72:75], v[16:19], v[184:187], 0
  ds_read_b128 v[48:51], v5 offset:13312
  v_mfma_f32_16x16x32_bf16 v[64:67], v[20:23], v[140:143], v[64:67]
  ds_read_b128 v[52:55], v5 offset:13376
  v_cvt_pk_bf16_f32 v76, v76, v77
  v_mfma_f32_16x16x32_bf16 v[68:71], v[20:23], v[164:167], v[68:71]
  ds_read_b128 v[56:59], v5 offset:13440
  v_cvt_pk_bf16_f32 v77, v78, v79
  v_mfma_f32_16x16x32_bf16 v[72:75], v[20:23], v[188:191], v[72:75]
  ds_read_b128 v[60:63], v5 offset:13504
  v_accvgpr_write_b32 a50, v76
  v_mfma_f32_16x16x32_bf16 v[64:67], v[24:27], v[144:147], v[64:67]
  v_accvgpr_write_b32 a51, v77
  v_mfma_f32_16x16x32_bf16 v[68:71], v[24:27], v[168:171], v[68:71]
  v_cvt_pk_bf16_f32 v80, v80, v81
  v_mfma_f32_16x16x32_bf16 v[72:75], v[24:27], v[192:195], v[72:75]
  v_cvt_pk_bf16_f32 v81, v82, v83
  v_mfma_f32_16x16x32_bf16 v[64:67], v[28:31], v[148:151], v[64:67]
  v_accvgpr_write_b32 a130, v80
  v_mfma_f32_16x16x32_bf16 v[68:71], v[28:31], v[172:175], v[68:71]
  v_accvgpr_write_b32 a131, v81
  v_mfma_f32_16x16x32_bf16 v[72:75], v[28:31], v[196:199], v[72:75]
  v_cvt_pk_bf16_f32 v84, v84, v85
  v_mfma_f32_16x16x32_bf16 v[64:67], v[32:35], v[152:155], v[64:67]
  v_cvt_pk_bf16_f32 v85, v86, v87
  v_mfma_f32_16x16x32_bf16 v[68:71], v[32:35], v[176:179], v[68:71]
  v_accvgpr_write_b32 a210, v84
  v_mfma_f32_16x16x32_bf16 v[72:75], v[32:35], v[200:203], v[72:75]
  v_accvgpr_write_b32 a211, v85
  v_mfma_f32_16x16x32_bf16 v[64:67], v[36:39], v[156:159], v[64:67]
  v_mfma_f32_16x16x32_bf16 v[68:71], v[36:39], v[180:183], v[68:71]
  v_mfma_f32_16x16x32_bf16 v[72:75], v[36:39], v[204:207], v[72:75]
  s_mov_b64 exec, s[82:83]
  s_add_u32 m0, s50, 1920
  s_nop 0
  buffer_load_dwordx4 v8, s[92:95], s48 offen lds
  s_add_u32 s48, s48, 122880
  s_mov_b64 exec, -1
  s_mov_b64 exec, s[82:83]
  s_add_u32 m0, s50, 2880
  s_nop 0
  buffer_load_dwordx4 v8, s[92:95], s48 offen lds
  s_add_u32 s48, s48, 122880
  s_mov_b64 exec, -1
  s_waitcnt lgkmcnt(0)
  s_waitcnt vmcnt(2)
  v_mfma_f32_16x16x32_bf16 v[76:79], v[40:43], v[136:139], 0
  ds_read_b128 v[16:19], v5 offset:0
  v_mfma_f32_16x16x32_bf16 v[80:83], v[40:43], v[160:163], 0
  ds_read_b128 v[20:23], v5 offset:64
  v_mfma_f32_16x16x32_bf16 v[84:87], v[40:43], v[184:187], 0
  ds_read_b128 v[24:27], v5 offset:128
  v_mfma_f32_16x16x32_bf16 v[76:79], v[44:47], v[140:143], v[76:79]
  ds_read_b128 v[28:31], v5 offset:192
  v_cvt_pk_bf16_f32 v64, v64, v65
  v_mfma_f32_16x16x32_bf16 v[80:83], v[44:47], v[164:167], v[80:83]
  ds_read_b128 v[32:35], v5 offset:256
  v_cvt_pk_bf16_f32 v65, v66, v67
  v_mfma_f32_16x16x32_bf16 v[84:87], v[44:47], v[188:191], v[84:87]
  ds_read_b128 v[36:39], v5 offset:320
  v_accvgpr_write_b32 a52, v64
  v_mfma_f32_16x16x32_bf16 v[76:79], v[48:51], v[144:147], v[76:79]
  s_add_u32 s63, s62, 7372800
  s_add_u32 m0, s61, 12416
  s_nop 0
  buffer_load_dwordx4 v2, s[52:55], s63 offen lds
  v_accvgpr_write_b32 a53, v65
  v_mfma_f32_16x16x32_bf16 v[80:83], v[48:51], v[168:171], v[80:83]
  s_add_u32 m0, s61, 13440
  s_nop 0
  buffer_load_dwordx4 v3, s[52:55], s63 offen lds
  v_cvt_pk_bf16_f32 v68, v68, v69
  v_mfma_f32_16x16x32_bf16 v[84:87], v[48:51], v[192:195], v[84:87]
  s_add_u32 m0, s61, 14464
  s_nop 0
  buffer_load_dwordx4 v4, s[52:55], s63 offen lds
  v_cvt_pk_bf16_f32 v69, v70, v71
  v_mfma_f32_16x16x32_bf16 v[76:79], v[52:55], v[148:151], v[76:79]
  s_add_u32 s63, s62, 7471104
  s_add_u32 m0, s61, 15520
  s_nop 0
  buffer_load_dwordx4 v2, s[52:55], s63 offen lds
  v_accvgpr_write_b32 a132, v68
  v_mfma_f32_16x16x32_bf16 v[80:83], v[52:55], v[172:175], v[80:83]
  s_add_u32 m0, s61, 16544
  s_nop 0
  buffer_load_dwordx4 v3, s[52:55], s63 offen lds
  v_accvgpr_write_b32 a133, v69
  v_mfma_f32_16x16x32_bf16 v[84:87], v[52:55], v[196:199], v[84:87]
  s_add_u32 m0, s61, 17568
  s_nop 0
  buffer_load_dwordx4 v4, s[52:55], s63 offen lds
  v_cvt_pk_bf16_f32 v72, v72, v73
  v_mfma_f32_16x16x32_bf16 v[76:79], v[56:59], v[152:155], v[76:79]
  s_add_u32 s63, s62, 7569408
  s_add_u32 m0, s61, 18624
  s_nop 0
  buffer_load_dwordx4 v2, s[52:55], s63 offen lds
  v_cvt_pk_bf16_f32 v73, v74, v75
  v_mfma_f32_16x16x32_bf16 v[80:83], v[56:59], v[176:179], v[80:83]
  s_add_u32 m0, s61, 19648
  s_nop 0
  buffer_load_dwordx4 v3, s[52:55], s63 offen lds
  v_accvgpr_write_b32 a212, v72
  v_mfma_f32_16x16x32_bf16 v[84:87], v[56:59], v[200:203], v[84:87]
  s_add_u32 m0, s61, 20672
  s_nop 0
  buffer_load_dwordx4 v4, s[52:55], s63 offen lds
  v_accvgpr_write_b32 a213, v73
  v_mfma_f32_16x16x32_bf16 v[76:79], v[60:63], v[156:159], v[76:79]
  s_add_u32 s63, s62, 7667712
  s_add_u32 m0, s61, 21728
  s_nop 0
  buffer_load_dwordx4 v2, s[52:55], s63 offen lds
  v_mfma_f32_16x16x32_bf16 v[80:83], v[60:63], v[180:183], v[80:83]
  s_add_u32 m0, s61, 22752
  s_nop 0
  buffer_load_dwordx4 v3, s[52:55], s63 offen lds
  v_mfma_f32_16x16x32_bf16 v[84:87], v[60:63], v[204:207], v[84:87]
  s_add_u32 m0, s61, 23776
  s_nop 0
  buffer_load_dwordx4 v4, s[52:55], s63 offen lds
  s_waitcnt lgkmcnt(0)
  v_mfma_f32_16x16x32_bf16 v[64:67], v[16:19], v[136:139], 0
  ds_read_b128 v[40:43], v5 offset:768
  v_mfma_f32_16x16x32_bf16 v[68:71], v[16:19], v[160:163], 0
  ds_read_b128 v[44:47], v5 offset:832
  v_mfma_f32_16x16x32_bf16 v[72:75], v[16:19], v[184:187], 0
  ds_read_b128 v[48:51], v5 offset:896
  v_mfma_f32_16x16x32_bf16 v[64:67], v[20:23], v[140:143], v[64:67]
  ds_read_b128 v[52:55], v5 offset:960
  v_cvt_pk_bf16_f32 v76, v76, v77
  v_mfma_f32_16x16x32_bf16 v[68:71], v[20:23], v[164:167], v[68:71]
  ds_read_b128 v[56:59], v5 offset:1024
  v_cvt_pk_bf16_f32 v77, v78, v79
  v_mfma_f32_16x16x32_bf16 v[72:75], v[20:23], v[188:191], v[72:75]
  ds_read_b128 v[60:63], v5 offset:1088
  v_accvgpr_write_b32 a54, v76
  v_mfma_f32_16x16x32_bf16 v[64:67], v[24:27], v[144:147], v[64:67]
  v_accvgpr_write_b32 a55, v77
  v_mfma_f32_16x16x32_bf16 v[68:71], v[24:27], v[168:171], v[68:71]
  v_cvt_pk_bf16_f32 v80, v80, v81
  v_mfma_f32_16x16x32_bf16 v[72:75], v[24:27], v[192:195], v[72:75]
  v_cvt_pk_bf16_f32 v81, v82, v83
  v_mfma_f32_16x16x32_bf16 v[64:67], v[28:31], v[148:151], v[64:67]
  v_accvgpr_write_b32 a134, v80
  v_mfma_f32_16x16x32_bf16 v[68:71], v[28:31], v[172:175], v[68:71]
  v_accvgpr_write_b32 a135, v81
  v_mfma_f32_16x16x32_bf16 v[72:75], v[28:31], v[196:199], v[72:75]
  v_cvt_pk_bf16_f32 v84, v84, v85
  v_mfma_f32_16x16x32_bf16 v[64:67], v[32:35], v[152:155], v[64:67]
  v_cvt_pk_bf16_f32 v85, v86, v87
  v_mfma_f32_16x16x32_bf16 v[68:71], v[32:35], v[176:179], v[68:71]
  v_accvgpr_write_b32 a214, v84
  v_mfma_f32_16x16x32_bf16 v[72:75], v[32:35], v[200:203], v[72:75]
  v_accvgpr_write_b32 a215, v85
  v_mfma_f32_16x16x32_bf16 v[64:67], v[36:39], v[156:159], v[64:67]
  v_mfma_f32_16x16x32_bf16 v[68:71], v[36:39], v[180:183], v[68:71]
  v_mfma_f32_16x16x32_bf16 v[72:75], v[36:39], v[204:207], v[72:75]
  s_mov_b64 exec, s[82:83]
  s_add_u32 m0, s50, 3840
  s_nop 0
  buffer_load_dwordx4 v8, s[92:95], s48 offen lds
  s_add_u32 s48, s48, 122880
  s_mov_b64 exec, -1
  s_mov_b64 exec, s[82:83]
  s_add_u32 m0, s50, 4800
  s_nop 0
  buffer_load_dwordx4 v8, s[92:95], s48 offen lds
  s_add_u32 s48, s48, 122880
  s_mov_b64 exec, -1
  s_waitcnt lgkmcnt(0)
  s_waitcnt vmcnt(2)
  v_mfma_f32_16x16x32_bf16 v[76:79], v[40:43], v[136:139], 0
  ds_read_b128 v[16:19], v5 offset:12416
  v_mfma_f32_16x16x32_bf16 v[80:83], v[40:43], v[160:163], 0
  ds_read_b128 v[20:23], v5 offset:12480
  v_mfma_f32_16x16x32_bf16 v[84:87], v[40:43], v[184:187], 0
  ds_read_b128 v[24:27], v5 offset:12544
  v_mfma_f32_16x16x32_bf16 v[76:79], v[44:47], v[140:143], v[76:79]
  ds_read_b128 v[28:31], v5 offset:12608
  v_cvt_pk_bf16_f32 v64, v64, v65
  v_mfma_f32_16x16x32_bf16 v[80:83], v[44:47], v[164:167], v[80:83]
  ds_read_b128 v[32:35], v5 offset:12672
  v_cvt_pk_bf16_f32 v65, v66, v67
  v_mfma_f32_16x16x32_bf16 v[84:87], v[44:47], v[188:191], v[84:87]
  ds_read_b128 v[36:39], v5 offset:12736
  v_accvgpr_write_b32 a56, v64
  v_mfma_f32_16x16x32_bf16 v[76:79], v[48:51], v[144:147], v[76:79]
  s_add_u32 s63, s62, 393216
  s_add_u32 m0, s61, 0
  s_nop 0
  buffer_load_dwordx4 v2, s[52:55], s63 offen lds
  v_accvgpr_write_b32 a57, v65
  v_mfma_f32_16x16x32_bf16 v[80:83], v[48:51], v[168:171], v[80:83]
  s_add_u32 m0, s61, 1024
  s_nop 0
  buffer_load_dwordx4 v3, s[52:55], s63 offen lds
  v_cvt_pk_bf16_f32 v68, v68, v69
  v_mfma_f32_16x16x32_bf16 v[84:87], v[48:51], v[192:195], v[84:87]
  s_add_u32 m0, s61, 2048
  s_nop 0
  buffer_load_dwordx4 v4, s[52:55], s63 offen lds
  v_cvt_pk_bf16_f32 v69, v70, v71
  v_mfma_f32_16x16x32_bf16 v[76:79], v[52:55], v[148:151], v[76:79]
  s_add_u32 s63, s62, 884736
  s_add_u32 m0, s61, 3104
  s_nop 0
  buffer_load_dwordx4 v2, s[52:55], s63 offen lds
  v_accvgpr_write_b32 a136, v68
  v_mfma_f32_16x16x32_bf16 v[80:83], v[52:55], v[172:175], v[80:83]
  s_add_u32 m0, s61, 4128
  s_nop 0
  buffer_load_dwordx4 v3, s[52:55], s63 offen lds
  v_accvgpr_write_b32 a137, v69
  v_mfma_f32_16x16x32_bf16 v[84:87], v[52:55], v[196:199], v[84:87]
  s_add_u32 m0, s61, 5152
  s_nop 0
  buffer_load_dwordx4 v4, s[52:55], s63 offen lds
  v_cvt_pk_bf16_f32 v72, v72, v73
  v_mfma_f32_16x16x32_bf16 v[76:79], v[56:59], v[152:155], v[76:79]
  s_add_u32 s63, s62, 1376256
  s_add_u32 m0, s61, 6208
  s_nop 0
  buffer_load_dwordx4 v2, s[52:55], s63 offen lds
  v_cvt_pk_bf16_f32 v73, v74, v75
  v_mfma_f32_16x16x32_bf16 v[80:83], v[56:59], v[176:179], v[80:83]
  s_add_u32 m0, s61, 7232
  s_nop 0
  buffer_load_dwordx4 v3, s[52:55], s63 offen lds
  v_accvgpr_write_b32 a216, v72
  v_mfma_f32_16x16x32_bf16 v[84:87], v[56:59], v[200:203], v[84:87]
  s_add_u32 m0, s61, 8256
  s_nop 0
  buffer_load_dwordx4 v4, s[52:55], s63 offen lds
  v_accvgpr_write_b32 a217, v73
  v_mfma_f32_16x16x32_bf16 v[76:79], v[60:63], v[156:159], v[76:79]
  s_add_u32 s63, s62, 1867776
  s_add_u32 m0, s61, 9312
  s_nop 0
  buffer_load_dwordx4 v2, s[52:55], s63 offen lds
  v_mfma_f32_16x16x32_bf16 v[80:83], v[60:63], v[180:183], v[80:83]
  s_add_u32 m0, s61, 10336
  s_nop 0
  buffer_load_dwordx4 v3, s[52:55], s63 offen lds
  v_mfma_f32_16x16x32_bf16 v[84:87], v[60:63], v[204:207], v[84:87]
  s_add_u32 m0, s61, 11360
  s_nop 0
  buffer_load_dwordx4 v4, s[52:55], s63 offen lds
  s_waitcnt lgkmcnt(0)
  v_mfma_f32_16x16x32_bf16 v[64:67], v[16:19], v[136:139], 0
  ds_read_b128 v[40:43], v5 offset:13184
  v_mfma_f32_16x16x32_bf16 v[68:71], v[16:19], v[160:163], 0
  ds_read_b128 v[44:47], v5 offset:13248
  v_mfma_f32_16x16x32_bf16 v[72:75], v[16:19], v[184:187], 0
  ds_read_b128 v[48:51], v5 offset:13312
  v_mfma_f32_16x16x32_bf16 v[64:67], v[20:23], v[140:143], v[64:67]
  ds_read_b128 v[52:55], v5 offset:13376
  v_cvt_pk_bf16_f32 v76, v76, v77
  v_mfma_f32_16x16x32_bf16 v[68:71], v[20:23], v[164:167], v[68:71]
  ds_read_b128 v[56:59], v5 offset:13440
  v_cvt_pk_bf16_f32 v77, v78, v79
  v_mfma_f32_16x16x32_bf16 v[72:75], v[20:23], v[188:191], v[72:75]
  ds_read_b128 v[60:63], v5 offset:13504
  v_accvgpr_write_b32 a58, v76
  v_mfma_f32_16x16x32_bf16 v[64:67], v[24:27], v[144:147], v[64:67]
  v_accvgpr_write_b32 a59, v77
  v_mfma_f32_16x16x32_bf16 v[68:71], v[24:27], v[168:171], v[68:71]
  v_cvt_pk_bf16_f32 v80, v80, v81
  v_mfma_f32_16x16x32_bf16 v[72:75], v[24:27], v[192:195], v[72:75]
  v_cvt_pk_bf16_f32 v81, v82, v83
  v_mfma_f32_16x16x32_bf16 v[64:67], v[28:31], v[148:151], v[64:67]
  v_accvgpr_write_b32 a138, v80
  v_mfma_f32_16x16x32_bf16 v[68:71], v[28:31], v[172:175], v[68:71]
  v_accvgpr_write_b32 a139, v81
  v_mfma_f32_16x16x32_bf16 v[72:75], v[28:31], v[196:199], v[72:75]
  v_cvt_pk_bf16_f32 v84, v84, v85
  v_mfma_f32_16x16x32_bf16 v[64:67], v[32:35], v[152:155], v[64:67]
  v_cvt_pk_bf16_f32 v85, v86, v87
  v_mfma_f32_16x16x32_bf16 v[68:71], v[32:35], v[176:179], v[68:71]
  v_accvgpr_write_b32 a218, v84
  v_mfma_f32_16x16x32_bf16 v[72:75], v[32:35], v[200:203], v[72:75]
  v_accvgpr_write_b32 a219, v85
  v_mfma_f32_16x16x32_bf16 v[64:67], v[36:39], v[156:159], v[64:67]
  v_mfma_f32_16x16x32_bf16 v[68:71], v[36:39], v[180:183], v[68:71]
  v_mfma_f32_16x16x32_bf16 v[72:75], v[36:39], v[204:207], v[72:75]
  s_mov_b64 exec, s[82:83]
  s_add_u32 m0, s50, 5760
  s_nop 0
  buffer_load_dwordx4 v8, s[92:95], s48 offen lds
  s_add_u32 s48, s48, 122880
  s_mov_b64 exec, -1
  s_mov_b64 exec, s[82:83]
  s_add_u32 m0, s50, 6720
  s_nop 0
  buffer_load_dwordx4 v8, s[92:95], s48 offen lds
  s_add_u32 s48, s48, 122880
  s_mov_b64 exec, -1
  s_waitcnt lgkmcnt(0)
  s_waitcnt vmcnt(2)
  v_mfma_f32_16x16x32_bf16 v[76:79], v[40:43], v[136:139], 0
  ds_read_b128 v[16:19], v5 offset:0
  v_mfma_f32_16x16x32_bf16 v[80:83], v[40:43], v[160:163], 0
  ds_read_b128 v[20:23], v5 offset:64
  v_mfma_f32_16x16x32_bf16 v[84:87], v[40:43], v[184:187], 0
  ds_read_b128 v[24:27], v5 offset:128
  v_mfma_f32_16x16x32_bf16 v[76:79], v[44:47], v[140:143], v[76:79]
  ds_read_b128 v[28:31], v5 offset:192
  v_cvt_pk_bf16_f32 v64, v64, v65
  v_mfma_f32_16x16x32_bf16 v[80:83], v[44:47], v[164:167], v[80:83]
  ds_read_b128 v[32:35], v5 offset:256
  v_cvt_pk_bf16_f32 v65, v66, v67
  v_mfma_f32_16x16x32_bf16 v[84:87], v[44:47], v[188:191], v[84:87]
  ds_read_b128 v[36:39], v5 offset:320
  v_accvgpr_write_b32 a60, v64
  v_mfma_f32_16x16x32_bf16 v[76:79], v[48:51], v[144:147], v[76:79]
  s_add_u32 s63, s62, 2359296
  s_add_u32 m0, s61, 12416
  s_nop 0
  buffer_load_dwordx4 v2, s[52:55], s63 offen lds
  v_accvgpr_write_b32 a61, v65
  v_mfma_f32_16x16x32_bf16 v[80:83], v[48:51], v[168:171], v[80:83]
  s_add_u32 m0, s61, 13440
  s_nop 0
  buffer_load_dwordx4 v3, s[52:55], s63 offen lds
  v_cvt_pk_bf16_f32 v68, v68, v69
  v_mfma_f32_16x16x32_bf16 v[84:87], v[48:51], v[192:195], v[84:87]
  s_add_u32 m0, s61, 14464
  s_nop 0
  buffer_load_dwordx4 v4, s[52:55], s63 offen lds
  v_cvt_pk_bf16_f32 v69, v70, v71
  v_mfma_f32_16x16x32_bf16 v[76:79], v[52:55], v[148:151], v[76:79]
  s_add_u32 s63, s62, 2850816
  s_add_u32 m0, s61, 15520
  s_nop 0
  buffer_load_dwordx4 v2, s[52:55], s63 offen lds
  v_accvgpr_write_b32 a140, v68
  v_mfma_f32_16x16x32_bf16 v[80:83], v[52:55], v[172:175], v[80:83]
  s_add_u32 m0, s61, 16544
  s_nop 0
  buffer_load_dwordx4 v3, s[52:55], s63 offen lds
  v_accvgpr_write_b32 a141, v69
  v_mfma_f32_16x16x32_bf16 v[84:87], v[52:55], v[196:199], v[84:87]
  s_add_u32 m0, s61, 17568
  s_nop 0
  buffer_load_dwordx4 v4, s[52:55], s63 offen lds
  v_cvt_pk_bf16_f32 v72, v72, v73
  v_mfma_f32_16x16x32_bf16 v[76:79], v[56:59], v[152:155], v[76:79]
  s_add_u32 s63, s62, 3342336
  s_add_u32 m0, s61, 18624
  s_nop 0
  buffer_load_dwordx4 v2, s[52:55], s63 offen lds
  v_cvt_pk_bf16_f32 v73, v74, v75
  v_mfma_f32_16x16x32_bf16 v[80:83], v[56:59], v[176:179], v[80:83]
  s_add_u32 m0, s61, 19648
  s_nop 0
  buffer_load_dwordx4 v3, s[52:55], s63 offen lds
  v_accvgpr_write_b32 a220, v72
  v_mfma_f32_16x16x32_bf16 v[84:87], v[56:59], v[200:203], v[84:87]
  s_add_u32 m0, s61, 20672
  s_nop 0
  buffer_load_dwordx4 v4, s[52:55], s63 offen lds
  v_accvgpr_write_b32 a221, v73
  v_mfma_f32_16x16x32_bf16 v[76:79], v[60:63], v[156:159], v[76:79]
  s_add_u32 s63, s62, 3833856
  s_add_u32 m0, s61, 21728
  s_nop 0
  buffer_load_dwordx4 v2, s[52:55], s63 offen lds
  v_mfma_f32_16x16x32_bf16 v[80:83], v[60:63], v[180:183], v[80:83]
  s_add_u32 m0, s61, 22752
  s_nop 0
  buffer_load_dwordx4 v3, s[52:55], s63 offen lds
  v_mfma_f32_16x16x32_bf16 v[84:87], v[60:63], v[204:207], v[84:87]
  s_add_u32 m0, s61, 23776
  s_nop 0
  buffer_load_dwordx4 v4, s[52:55], s63 offen lds
  s_waitcnt lgkmcnt(0)
  v_mfma_f32_16x16x32_bf16 v[64:67], v[16:19], v[136:139], 0
  ds_read_b128 v[40:43], v5 offset:768
  v_mfma_f32_16x16x32_bf16 v[68:71], v[16:19], v[160:163], 0
  ds_read_b128 v[44:47], v5 offset:832
  v_mfma_f32_16x16x32_bf16 v[72:75], v[16:19], v[184:187], 0
  ds_read_b128 v[48:51], v5 offset:896
  v_mfma_f32_16x16x32_bf16 v[64:67], v[20:23], v[140:143], v[64:67]
  ds_read_b128 v[52:55], v5 offset:960
  v_cvt_pk_bf16_f32 v76, v76, v77
  v_mfma_f32_16x16x32_bf16 v[68:71], v[20:23], v[164:167], v[68:71]
  ds_read_b128 v[56:59], v5 offset:1024
  v_cvt_pk_bf16_f32 v77, v78, v79
  v_mfma_f32_16x16x32_bf16 v[72:75], v[20:23], v[188:191], v[72:75]
  ds_read_b128 v[60:63], v5 offset:1088
  v_accvgpr_write_b32 a62, v76
  v_mfma_f32_16x16x32_bf16 v[64:67], v[24:27], v[144:147], v[64:67]
  v_accvgpr_write_b32 a63, v77
  v_mfma_f32_16x16x32_bf16 v[68:71], v[24:27], v[168:171], v[68:71]
  v_cvt_pk_bf16_f32 v80, v80, v81
  v_mfma_f32_16x16x32_bf16 v[72:75], v[24:27], v[192:195], v[72:75]
  v_cvt_pk_bf16_f32 v81, v82, v83
  v_mfma_f32_16x16x32_bf16 v[64:67], v[28:31], v[148:151], v[64:67]
  v_accvgpr_write_b32 a142, v80
  v_mfma_f32_16x16x32_bf16 v[68:71], v[28:31], v[172:175], v[68:71]
  v_accvgpr_write_b32 a143, v81
  v_mfma_f32_16x16x32_bf16 v[72:75], v[28:31], v[196:199], v[72:75]
  v_cvt_pk_bf16_f32 v84, v84, v85
  v_mfma_f32_16x16x32_bf16 v[64:67], v[32:35], v[152:155], v[64:67]
  v_cvt_pk_bf16_f32 v85, v86, v87
  v_mfma_f32_16x16x32_bf16 v[68:71], v[32:35], v[176:179], v[68:71]
  v_accvgpr_write_b32 a222, v84
  v_mfma_f32_16x16x32_bf16 v[72:75], v[32:35], v[200:203], v[72:75]
  v_accvgpr_write_b32 a223, v85
  v_mfma_f32_16x16x32_bf16 v[64:67], v[36:39], v[156:159], v[64:67]
  v_mfma_f32_16x16x32_bf16 v[68:71], v[36:39], v[180:183], v[68:71]
  v_mfma_f32_16x16x32_bf16 v[72:75], v[36:39], v[204:207], v[72:75]
  s_mov_b64 exec, s[82:83]
  s_add_u32 m0, s50, 7680
  s_nop 0
  buffer_load_dwordx4 v8, s[92:95], s48 offen lds
  s_add_u32 s48, s48, 122880
  s_mov_b64 exec, -1
  s_mov_b64 exec, s[82:83]
  s_add_u32 m0, s50, 8640
  s_nop 0
  buffer_load_dwordx4 v8, s[92:95], s48 offen lds
  s_add_u32 s48, s48, 122880
  s_mov_b64 exec, -1
  s_waitcnt lgkmcnt(0)
  s_waitcnt vmcnt(2)
  v_mfma_f32_16x16x32_bf16 v[76:79], v[40:43], v[136:139], 0
  ds_read_b128 v[16:19], v5 offset:12416
  v_mfma_f32_16x16x32_bf16 v[80:83], v[40:43], v[160:163], 0
  ds_read_b128 v[20:23], v5 offset:12480
  v_mfma_f32_16x16x32_bf16 v[84:87], v[40:43], v[184:187], 0
  ds_read_b128 v[24:27], v5 offset:12544
  v_mfma_f32_16x16x32_bf16 v[76:79], v[44:47], v[140:143], v[76:79]
  ds_read_b128 v[28:31], v5 offset:12608
  v_cvt_pk_bf16_f32 v64, v64, v65
  v_mfma_f32_16x16x32_bf16 v[80:83], v[44:47], v[164:167], v[80:83]
  ds_read_b128 v[32:35], v5 offset:12672
  v_cvt_pk_bf16_f32 v65, v66, v67
  v_mfma_f32_16x16x32_bf16 v[84:87], v[44:47], v[188:191], v[84:87]
  ds_read_b128 v[36:39], v5 offset:12736
  v_accvgpr_write_b32 a64, v64
  v_mfma_f32_16x16x32_bf16 v[76:79], v[48:51], v[144:147], v[76:79]
  s_add_u32 s63, s62, 4325376
  s_add_u32 m0, s61, 0
  s_nop 0
  buffer_load_dwordx4 v2, s[52:55], s63 offen lds
  v_accvgpr_write_b32 a65, v65
  v_mfma_f32_16x16x32_bf16 v[80:83], v[48:51], v[168:171], v[80:83]
  s_add_u32 m0, s61, 1024
  s_nop 0
  buffer_load_dwordx4 v3, s[52:55], s63 offen lds
  v_cvt_pk_bf16_f32 v68, v68, v69
  v_mfma_f32_16x16x32_bf16 v[84:87], v[48:51], v[192:195], v[84:87]
  s_add_u32 m0, s61, 2048
  s_nop 0
  buffer_load_dwordx4 v4, s[52:55], s63 offen lds
  v_cvt_pk_bf16_f32 v69, v70, v71
  v_mfma_f32_16x16x32_bf16 v[76:79], v[52:55], v[148:151], v[76:79]
  s_add_u32 s63, s62, 4816896
  s_add_u32 m0, s61, 3104
  s_nop 0
  buffer_load_dwordx4 v2, s[52:55], s63 offen lds
  v_accvgpr_write_b32 a144, v68
  v_mfma_f32_16x16x32_bf16 v[80:83], v[52:55], v[172:175], v[80:83]
  s_add_u32 m0, s61, 4128
  s_nop 0
  buffer_load_dwordx4 v3, s[52:55], s63 offen lds
  v_accvgpr_write_b32 a145, v69
  v_mfma_f32_16x16x32_bf16 v[84:87], v[52:55], v[196:199], v[84:87]
  s_add_u32 m0, s61, 5152
  s_nop 0
  buffer_load_dwordx4 v4, s[52:55], s63 offen lds
  v_cvt_pk_bf16_f32 v72, v72, v73
  v_mfma_f32_16x16x32_bf16 v[76:79], v[56:59], v[152:155], v[76:79]
  s_add_u32 s63, s62, 5308416
  s_add_u32 m0, s61, 6208
  s_nop 0
  buffer_load_dwordx4 v2, s[52:55], s63 offen lds
  v_cvt_pk_bf16_f32 v73, v74, v75
  v_mfma_f32_16x16x32_bf16 v[80:83], v[56:59], v[176:179], v[80:83]
  s_add_u32 m0, s61, 7232
  s_nop 0
  buffer_load_dwordx4 v3, s[52:55], s63 offen lds
  v_accvgpr_write_b32 a224, v72
  v_mfma_f32_16x16x32_bf16 v[84:87], v[56:59], v[200:203], v[84:87]
  s_add_u32 m0, s61, 8256
  s_nop 0
  buffer_load_dwordx4 v4, s[52:55], s63 offen lds
  v_accvgpr_write_b32 a225, v73
  v_mfma_f32_16x16x32_bf16 v[76:79], v[60:63], v[156:159], v[76:79]
  s_add_u32 s63, s62, 5799936
  s_add_u32 m0, s61, 9312
  s_nop 0
  buffer_load_dwordx4 v2, s[52:55], s63 offen lds
  v_mfma_f32_16x16x32_bf16 v[80:83], v[60:63], v[180:183], v[80:83]
  s_add_u32 m0, s61, 10336
  s_nop 0
  buffer_load_dwordx4 v3, s[52:55], s63 offen lds
  v_mfma_f32_16x16x32_bf16 v[84:87], v[60:63], v[204:207], v[84:87]
  s_add_u32 m0, s61, 11360
  s_nop 0
  buffer_load_dwordx4 v4, s[52:55], s63 offen lds
  s_waitcnt lgkmcnt(0)
  v_mfma_f32_16x16x32_bf16 v[64:67], v[16:19], v[136:139], 0
  ds_read_b128 v[40:43], v5 offset:13184
  v_mfma_f32_16x16x32_bf16 v[68:71], v[16:19], v[160:163], 0
  ds_read_b128 v[44:47], v5 offset:13248
  v_mfma_f32_16x16x32_bf16 v[72:75], v[16:19], v[184:187], 0
  ds_read_b128 v[48:51], v5 offset:13312
  v_mfma_f32_16x16x32_bf16 v[64:67], v[20:23], v[140:143], v[64:67]
  ds_read_b128 v[52:55], v5 offset:13376
  v_cvt_pk_bf16_f32 v76, v76, v77
  v_mfma_f32_16x16x32_bf16 v[68:71], v[20:23], v[164:167], v[68:71]
  ds_read_b128 v[56:59], v5 offset:13440
  v_cvt_pk_bf16_f32 v77, v78, v79
  v_mfma_f32_16x16x32_bf16 v[72:75], v[20:23], v[188:191], v[72:75]
  ds_read_b128 v[60:63], v5 offset:13504
  v_accvgpr_write_b32 a66, v76
  v_mfma_f32_16x16x32_bf16 v[64:67], v[24:27], v[144:147], v[64:67]
  v_accvgpr_write_b32 a67, v77
  v_mfma_f32_16x16x32_bf16 v[68:71], v[24:27], v[168:171], v[68:71]
  v_cvt_pk_bf16_f32 v80, v80, v81
  v_mfma_f32_16x16x32_bf16 v[72:75], v[24:27], v[192:195], v[72:75]
  v_cvt_pk_bf16_f32 v81, v82, v83
  v_mfma_f32_16x16x32_bf16 v[64:67], v[28:31], v[148:151], v[64:67]
  v_accvgpr_write_b32 a146, v80
  v_mfma_f32_16x16x32_bf16 v[68:71], v[28:31], v[172:175], v[68:71]
  v_accvgpr_write_b32 a147, v81
  v_mfma_f32_16x16x32_bf16 v[72:75], v[28:31], v[196:199], v[72:75]
  v_cvt_pk_bf16_f32 v84, v84, v85
  v_mfma_f32_16x16x32_bf16 v[64:67], v[32:35], v[152:155], v[64:67]
  v_cvt_pk_bf16_f32 v85, v86, v87
  v_mfma_f32_16x16x32_bf16 v[68:71], v[32:35], v[176:179], v[68:71]
  v_accvgpr_write_b32 a226, v84
  v_mfma_f32_16x16x32_bf16 v[72:75], v[32:35], v[200:203], v[72:75]
  v_accvgpr_write_b32 a227, v85
  v_mfma_f32_16x16x32_bf16 v[64:67], v[36:39], v[156:159], v[64:67]
  v_mfma_f32_16x16x32_bf16 v[68:71], v[36:39], v[180:183], v[68:71]
  v_mfma_f32_16x16x32_bf16 v[72:75], v[36:39], v[204:207], v[72:75]
  s_mov_b64 exec, s[82:83]
  s_add_u32 m0, s50, 9600
  s_nop 0
  buffer_load_dwordx4 v8, s[92:95], s48 offen lds
  s_add_u32 s48, s48, 122880
  s_mov_b64 exec, -1
  s_mov_b64 exec, s[82:83]
  s_add_u32 m0, s50, 10560
  s_nop 0
  buffer_load_dwordx4 v8, s[92:95], s48 offen lds
  s_add_u32 s48, s48, 122880
  s_mov_b64 exec, -1
  s_waitcnt lgkmcnt(0)
  s_waitcnt vmcnt(2)
  v_mfma_f32_16x16x32_bf16 v[76:79], v[40:43], v[136:139], 0
  ds_read_b128 v[16:19], v5 offset:0
  v_mfma_f32_16x16x32_bf16 v[80:83], v[40:43], v[160:163], 0
  ds_read_b128 v[20:23], v5 offset:64
  v_mfma_f32_16x16x32_bf16 v[84:87], v[40:43], v[184:187], 0
  ds_read_b128 v[24:27], v5 offset:128
  v_mfma_f32_16x16x32_bf16 v[76:79], v[44:47], v[140:143], v[76:79]
  ds_read_b128 v[28:31], v5 offset:192
  v_cvt_pk_bf16_f32 v64, v64, v65
  v_mfma_f32_16x16x32_bf16 v[80:83], v[44:47], v[164:167], v[80:83]
  ds_read_b128 v[32:35], v5 offset:256
  v_cvt_pk_bf16_f32 v65, v66, v67
  v_mfma_f32_16x16x32_bf16 v[84:87], v[44:47], v[188:191], v[84:87]
  ds_read_b128 v[36:39], v5 offset:320
  v_accvgpr_write_b32 a68, v64
  v_mfma_f32_16x16x32_bf16 v[76:79], v[48:51], v[144:147], v[76:79]
  s_add_u32 s63, s62, 6291456
  s_add_u32 m0, s61, 12416
  s_nop 0
  buffer_load_dwordx4 v2, s[52:55], s63 offen lds
  v_accvgpr_write_b32 a69, v65
  v_mfma_f32_16x16x32_bf16 v[80:83], v[48:51], v[168:171], v[80:83]
  s_add_u32 m0, s61, 13440
  s_nop 0
  buffer_load_dwordx4 v3, s[52:55], s63 offen lds
  v_cvt_pk_bf16_f32 v68, v68, v69
  v_mfma_f32_16x16x32_bf16 v[84:87], v[48:51], v[192:195], v[84:87]
  s_add_u32 m0, s61, 14464
  s_nop 0
  buffer_load_dwordx4 v4, s[52:55], s63 offen lds
  v_cvt_pk_bf16_f32 v69, v70, v71
  v_mfma_f32_16x16x32_bf16 v[76:79], v[52:55], v[148:151], v[76:79]
  s_add_u32 s63, s62, 6782976
  s_add_u32 m0, s61, 15520
  s_nop 0
  buffer_load_dwordx4 v2, s[52:55], s63 offen lds
  v_accvgpr_write_b32 a148, v68
  v_mfma_f32_16x16x32_bf16 v[80:83], v[52:55], v[172:175], v[80:83]
  s_add_u32 m0, s61, 16544
  s_nop 0
  buffer_load_dwordx4 v3, s[52:55], s63 offen lds
  v_accvgpr_write_b32 a149, v69
  v_mfma_f32_16x16x32_bf16 v[84:87], v[52:55], v[196:199], v[84:87]
  s_add_u32 m0, s61, 17568
  s_nop 0
  buffer_load_dwordx4 v4, s[52:55], s63 offen lds
  v_cvt_pk_bf16_f32 v72, v72, v73
  v_mfma_f32_16x16x32_bf16 v[76:79], v[56:59], v[152:155], v[76:79]
  s_add_u32 s63, s62, 7274496
  s_add_u32 m0, s61, 18624
  s_nop 0
  buffer_load_dwordx4 v2, s[52:55], s63 offen lds
  v_cvt_pk_bf16_f32 v73, v74, v75
  v_mfma_f32_16x16x32_bf16 v[80:83], v[56:59], v[176:179], v[80:83]
  s_add_u32 m0, s61, 19648
  s_nop 0
  buffer_load_dwordx4 v3, s[52:55], s63 offen lds
  v_accvgpr_write_b32 a228, v72
  v_mfma_f32_16x16x32_bf16 v[84:87], v[56:59], v[200:203], v[84:87]
  s_add_u32 m0, s61, 20672
  s_nop 0
  buffer_load_dwordx4 v4, s[52:55], s63 offen lds
  v_accvgpr_write_b32 a229, v73
  v_mfma_f32_16x16x32_bf16 v[76:79], v[60:63], v[156:159], v[76:79]
  s_add_u32 s63, s62, 7766016
  s_add_u32 m0, s61, 21728
  s_nop 0
  buffer_load_dwordx4 v2, s[52:55], s63 offen lds
  v_mfma_f32_16x16x32_bf16 v[80:83], v[60:63], v[180:183], v[80:83]
  s_add_u32 m0, s61, 22752
  s_nop 0
  buffer_load_dwordx4 v3, s[52:55], s63 offen lds
  v_mfma_f32_16x16x32_bf16 v[84:87], v[60:63], v[204:207], v[84:87]
  s_add_u32 m0, s61, 23776
  s_nop 0
  buffer_load_dwordx4 v4, s[52:55], s63 offen lds
  s_waitcnt lgkmcnt(0)
  v_mfma_f32_16x16x32_bf16 v[64:67], v[16:19], v[136:139], 0
  ds_read_b128 v[40:43], v5 offset:768
  v_mfma_f32_16x16x32_bf16 v[68:71], v[16:19], v[160:163], 0
  ds_read_b128 v[44:47], v5 offset:832
  v_mfma_f32_16x16x32_bf16 v[72:75], v[16:19], v[184:187], 0
  ds_read_b128 v[48:51], v5 offset:896
  v_mfma_f32_16x16x32_bf16 v[64:67], v[20:23], v[140:143], v[64:67]
  ds_read_b128 v[52:55], v5 offset:960
  v_cvt_pk_bf16_f32 v76, v76, v77
  v_mfma_f32_16x16x32_bf16 v[68:71], v[20:23], v[164:167], v[68:71]
  ds_read_b128 v[56:59], v5 offset:1024
  v_cvt_pk_bf16_f32 v77, v78, v79
  v_mfma_f32_16x16x32_bf16 v[72:75], v[20:23], v[188:191], v[72:75]
  ds_read_b128 v[60:63], v5 offset:1088
  v_accvgpr_write_b32 a70, v76
  v_mfma_f32_16x16x32_bf16 v[64:67], v[24:27], v[144:147], v[64:67]
  v_accvgpr_write_b32 a71, v77
  v_mfma_f32_16x16x32_bf16 v[68:71], v[24:27], v[168:171], v[68:71]
  v_cvt_pk_bf16_f32 v80, v80, v81
  v_mfma_f32_16x16x32_bf16 v[72:75], v[24:27], v[192:195], v[72:75]
  v_cvt_pk_bf16_f32 v81, v82, v83
  v_mfma_f32_16x16x32_bf16 v[64:67], v[28:31], v[148:151], v[64:67]
  v_accvgpr_write_b32 a150, v80
  v_mfma_f32_16x16x32_bf16 v[68:71], v[28:31], v[172:175], v[68:71]
  v_accvgpr_write_b32 a151, v81
  v_mfma_f32_16x16x32_bf16 v[72:75], v[28:31], v[196:199], v[72:75]
  v_cvt_pk_bf16_f32 v84, v84, v85
  v_mfma_f32_16x16x32_bf16 v[64:67], v[32:35], v[152:155], v[64:67]
  v_cvt_pk_bf16_f32 v85, v86, v87
  v_mfma_f32_16x16x32_bf16 v[68:71], v[32:35], v[176:179], v[68:71]
  v_accvgpr_write_b32 a230, v84
  v_mfma_f32_16x16x32_bf16 v[72:75], v[32:35], v[200:203], v[72:75]
  v_accvgpr_write_b32 a231, v85
  v_mfma_f32_16x16x32_bf16 v[64:67], v[36:39], v[156:159], v[64:67]
  v_mfma_f32_16x16x32_bf16 v[68:71], v[36:39], v[180:183], v[68:71]
  v_mfma_f32_16x16x32_bf16 v[72:75], v[36:39], v[204:207], v[72:75]
  s_mov_b64 exec, s[82:83]
  s_add_u32 m0, s50, 11520
  s_nop 0
  buffer_load_dwordx4 v8, s[92:95], s48 offen lds
  s_add_u32 s48, s48, 122880
  s_mov_b64 exec, -1
  s_mov_b64 exec, s[82:83]
  s_add_u32 m0, s50, 12480
  s_nop 0
  buffer_load_dwordx4 v8, s[92:95], s48 offen lds
  s_add_u32 s48, s48, 122880
  s_mov_b64 exec, -1
  s_waitcnt lgkmcnt(0)
  s_waitcnt vmcnt(2)
  v_mfma_f32_16x16x32_bf16 v[76:79], v[40:43], v[136:139], 0
  ds_read_b128 v[16:19], v5 offset:12416
  v_mfma_f32_16x16x32_bf16 v[80:83], v[40:43], v[160:163], 0
  ds_read_b128 v[20:23], v5 offset:12480
  v_mfma_f32_16x16x32_bf16 v[84:87], v[40:43], v[184:187], 0
  ds_read_b128 v[24:27], v5 offset:12544
  v_mfma_f32_16x16x32_bf16 v[76:79], v[44:47], v[140:143], v[76:79]
  ds_read_b128 v[28:31], v5 offset:12608
  v_cvt_pk_bf16_f32 v64, v64, v65
  v_mfma_f32_16x16x32_bf16 v[80:83], v[44:47], v[164:167], v[80:83]
  ds_read_b128 v[32:35], v5 offset:12672
  v_cvt_pk_bf16_f32 v65, v66, v67
  v_mfma_f32_16x16x32_bf16 v[84:87], v[44:47], v[188:191], v[84:87]
  ds_read_b128 v[36:39], v5 offset:12736
  v_accvgpr_write_b32 a72, v64
  v_mfma_f32_16x16x32_bf16 v[76:79], v[48:51], v[144:147], v[76:79]
  v_accvgpr_write_b32 a73, v65
  v_mfma_f32_16x16x32_bf16 v[80:83], v[48:51], v[168:171], v[80:83]
  v_cvt_pk_bf16_f32 v68, v68, v69
  v_mfma_f32_16x16x32_bf16 v[84:87], v[48:51], v[192:195], v[84:87]
  v_cvt_pk_bf16_f32 v69, v70, v71
  v_mfma_f32_16x16x32_bf16 v[76:79], v[52:55], v[148:151], v[76:79]
  v_accvgpr_write_b32 a152, v68
  v_mfma_f32_16x16x32_bf16 v[80:83], v[52:55], v[172:175], v[80:83]
  v_accvgpr_write_b32 a153, v69
  v_mfma_f32_16x16x32_bf16 v[84:87], v[52:55], v[196:199], v[84:87]
  v_cvt_pk_bf16_f32 v72, v72, v73
  v_mfma_f32_16x16x32_bf16 v[76:79], v[56:59], v[152:155], v[76:79]
  v_cvt_pk_bf16_f32 v73, v74, v75
  v_mfma_f32_16x16x32_bf16 v[80:83], v[56:59], v[176:179], v[80:83]
  v_accvgpr_write_b32 a232, v72
  v_mfma_f32_16x16x32_bf16 v[84:87], v[56:59], v[200:203], v[84:87]
  v_accvgpr_write_b32 a233, v73
  v_mfma_f32_16x16x32_bf16 v[76:79], v[60:63], v[156:159], v[76:79]
  v_mfma_f32_16x16x32_bf16 v[80:83], v[60:63], v[180:183], v[80:83]
  v_mfma_f32_16x16x32_bf16 v[84:87], v[60:63], v[204:207], v[84:87]
  s_waitcnt lgkmcnt(0)
  v_mfma_f32_16x16x32_bf16 v[64:67], v[16:19], v[136:139], 0
  ds_read_b128 v[40:43], v5 offset:13184
  v_mfma_f32_16x16x32_bf16 v[68:71], v[16:19], v[160:163], 0
  ds_read_b128 v[44:47], v5 offset:13248
  v_mfma_f32_16x16x32_bf16 v[72:75], v[16:19], v[184:187], 0
  ds_read_b128 v[48:51], v5 offset:13312
  v_mfma_f32_16x16x32_bf16 v[64:67], v[20:23], v[140:143], v[64:67]
  ds_read_b128 v[52:55], v5 offset:13376
  v_cvt_pk_bf16_f32 v76, v76, v77
  v_mfma_f32_16x16x32_bf16 v[68:71], v[20:23], v[164:167], v[68:71]
  ds_read_b128 v[56:59], v5 offset:13440
  v_cvt_pk_bf16_f32 v77, v78, v79
  v_mfma_f32_16x16x32_bf16 v[72:75], v[20:23], v[188:191], v[72:75]
  ds_read_b128 v[60:63], v5 offset:13504
  v_accvgpr_write_b32 a74, v76
  v_mfma_f32_16x16x32_bf16 v[64:67], v[24:27], v[144:147], v[64:67]
  v_accvgpr_write_b32 a75, v77
  v_mfma_f32_16x16x32_bf16 v[68:71], v[24:27], v[168:171], v[68:71]
  v_cvt_pk_bf16_f32 v80, v80, v81
  v_mfma_f32_16x16x32_bf16 v[72:75], v[24:27], v[192:195], v[72:75]
  v_cvt_pk_bf16_f32 v81, v82, v83
  v_mfma_f32_16x16x32_bf16 v[64:67], v[28:31], v[148:151], v[64:67]
  v_accvgpr_write_b32 a154, v80
  v_mfma_f32_16x16x32_bf16 v[68:71], v[28:31], v[172:175], v[68:71]
  v_accvgpr_write_b32 a155, v81
  v_mfma_f32_16x16x32_bf16 v[72:75], v[28:31], v[196:199], v[72:75]
  v_cvt_pk_bf16_f32 v84, v84, v85
  v_mfma_f32_16x16x32_bf16 v[64:67], v[32:35], v[152:155], v[64:67]
  v_cvt_pk_bf16_f32 v85, v86, v87
  v_mfma_f32_16x16x32_bf16 v[68:71], v[32:35], v[176:179], v[68:71]
  v_accvgpr_write_b32 a234, v84
  v_mfma_f32_16x16x32_bf16 v[72:75], v[32:35], v[200:203], v[72:75]
  v_accvgpr_write_b32 a235, v85
  v_mfma_f32_16x16x32_bf16 v[64:67], v[36:39], v[156:159], v[64:67]
  v_mfma_f32_16x16x32_bf16 v[68:71], v[36:39], v[180:183], v[68:71]
  v_mfma_f32_16x16x32_bf16 v[72:75], v[36:39], v[204:207], v[72:75]
  s_mov_b64 exec, s[82:83]
  s_add_u32 m0, s50, 13440
  s_nop 0
  buffer_load_dwordx4 v8, s[92:95], s48 offen lds
  s_add_u32 s48, s48, 122880
  s_mov_b64 exec, -1
  s_mov_b64 exec, s[82:83]
  s_add_u32 m0, s50, 14400
  s_nop 0
  buffer_load_dwordx4 v8, s[92:95], s48 offen lds
  s_add_u32 s48, s48, 122880
  s_mov_b64 exec, -1
  s_waitcnt lgkmcnt(0)
  s_barrier
  s_mov_b64 exec, s[82:83]
  s_add_u32 m0, s51, 0
  s_nop 0
  buffer_load_dwordx4 v8, s[96:99], s49 offen lds
  s_add_u32 s49, s49, 122880
  s_add_u32 m0, s51, 960
  s_nop 0
  buffer_load_dwordx4 v8, s[96:99], s49 offen lds
  s_add_u32 s49, s49, 122880
  s_add_u32 m0, s51, 1920
  s_nop 0
  buffer_load_dwordx4 v8, s[96:99], s49 offen lds
  s_add_u32 s49, s49, 122880
  s_add_u32 m0, s51, 2880
  s_nop 0
  buffer_load_dwordx4 v8, s[96:99], s49 offen lds
  s_add_u32 s49, s49, 122880
  s_add_u32 m0, s51, 3840
  s_nop 0
  buffer_load_dwordx4 v8, s[96:99], s49 offen lds
  s_add_u32 s49, s49, 122880
  s_add_u32 m0, s51, 4800
  s_nop 0
  buffer_load_dwordx4 v8, s[96:99], s49 offen lds
  s_add_u32 s49, s49, 122880
  s_add_u32 m0, s51, 5760
  s_nop 0
  buffer_load_dwordx4 v8, s[96:99], s49 offen lds
  s_add_u32 s49, s49, 122880
  s_add_u32 m0, s51, 6720
  s_nop 0
  buffer_load_dwordx4 v8, s[96:99], s49 offen lds
  s_add_u32 s49, s49, 122880
  s_add_u32 m0, s51, 7680
  s_nop 0
  buffer_load_dwordx4 v8, s[96:99], s49 offen lds
  s_add_u32 s49, s49, 122880
  s_add_u32 m0, s51, 8640
  s_nop 0
  buffer_load_dwordx4 v8, s[96:99], s49 offen lds
  s_add_u32 s49, s49, 122880
  s_add_u32 m0, s51, 9600
  s_nop 0
  buffer_load_dwordx4 v8, s[96:99], s49 offen lds
  s_add_u32 s49, s49, 122880
  s_add_u32 m0, s51, 10560
  s_nop 0
  buffer_load_dwordx4 v8, s[96:99], s49 offen lds
  s_add_u32 s49, s49, 122880
  s_add_u32 m0, s51, 11520
  s_nop 0
  buffer_load_dwordx4 v8, s[96:99], s49 offen lds
  s_add_u32 s49, s49, 122880
  s_add_u32 m0, s51, 12480
  s_nop 0
  buffer_load_dwordx4 v8, s[96:99], s49 offen lds
  s_add_u32 s49, s49, 122880
  s_add_u32 m0, s51, 13440
  s_nop 0
  buffer_load_dwordx4 v8, s[96:99], s49 offen lds
  s_add_u32 s49, s49, 122880
  s_add_u32 m0, s51, 14400
  s_nop 0
  buffer_load_dwordx4 v8, s[96:99], s49 offen lds
  s_add_u32 s49, s49, 122880
  s_mov_b64 exec, -1
  v_mfma_f32_16x16x32_bf16 v[76:79], v[40:43], v[136:139], 0
  v_mfma_f32_16x16x32_bf16 v[80:83], v[40:43], v[160:163], 0
  v_mfma_f32_16x16x32_bf16 v[84:87], v[40:43], v[184:187], 0
  v_mfma_f32_16x16x32_bf16 v[76:79], v[44:47], v[140:143], v[76:79]
  v_cvt_pk_bf16_f32 v64, v64, v65
  v_mfma_f32_16x16x32_bf16 v[80:83], v[44:47], v[164:167], v[80:83]
  v_cvt_pk_bf16_f32 v65, v66, v67
  v_mfma_f32_16x16x32_bf16 v[84:87], v[44:47], v[188:191], v[84:87]
  v_accvgpr_write_b32 a76, v64
  v_mfma_f32_16x16x32_bf16 v[76:79], v[48:51], v[144:147], v[76:79]
  v_accvgpr_write_b32 a77, v65
  v_mfma_f32_16x16x32_bf16 v[80:83], v[48:51], v[168:171], v[80:83]
  v_cvt_pk_bf16_f32 v68, v68, v69
  v_mfma_f32_16x16x32_bf16 v[84:87], v[48:51], v[192:195], v[84:87]
  v_cvt_pk_bf16_f32 v69, v70, v71
  v_mfma_f32_16x16x32_bf16 v[76:79], v[52:55], v[148:151], v[76:79]
  v_accvgpr_write_b32 a156, v68
  v_mfma_f32_16x16x32_bf16 v[80:83], v[52:55], v[172:175], v[80:83]
  v_accvgpr_write_b32 a157, v69
  v_mfma_f32_16x16x32_bf16 v[84:87], v[52:55], v[196:199], v[84:87]
  v_cvt_pk_bf16_f32 v72, v72, v73
  v_mfma_f32_16x16x32_bf16 v[76:79], v[56:59], v[152:155], v[76:79]
  v_cvt_pk_bf16_f32 v73, v74, v75
  v_mfma_f32_16x16x32_bf16 v[80:83], v[56:59], v[176:179], v[80:83]
  v_accvgpr_write_b32 a236, v72
  v_mfma_f32_16x16x32_bf16 v[84:87], v[56:59], v[200:203], v[84:87]
  v_accvgpr_write_b32 a237, v73
  v_mfma_f32_16x16x32_bf16 v[76:79], v[60:63], v[156:159], v[76:79]
  v_mfma_f32_16x16x32_bf16 v[80:83], v[60:63], v[180:183], v[80:83]
  v_mfma_f32_16x16x32_bf16 v[84:87], v[60:63], v[204:207], v[84:87]
  s_nop 0
  v_cvt_pk_bf16_f32 v76, v76, v77
  v_cvt_pk_bf16_f32 v77, v78, v79
  v_accvgpr_write_b32 a78, v76
  v_accvgpr_write_b32 a79, v77
  v_cvt_pk_bf16_f32 v80, v80, v81
  v_cvt_pk_bf16_f32 v81, v82, v83
  v_accvgpr_write_b32 a158, v80
  v_accvgpr_write_b32 a159, v81
  v_cvt_pk_bf16_f32 v84, v84, v85
  v_cvt_pk_bf16_f32 v85, v86, v87
  v_accvgpr_write_b32 a238, v84
  v_accvgpr_write_b32 a239, v85
  v_lshlrev_b32 v2, 4, v1
  s_lshr_b32 s27, s3, 1
  s_mul_i32 s27, s27, 20480
  s_and_b32 s28, s3, 1
  s_lshl_b32 s28, s28, 7
  s_add_u32 s27, s27, s28
  s_add_u32 s27, s27, 122880
  v_add_u32 v22, s27, v2
  s_mov_b32 exec_lo, 0x00ff00ff
  s_mov_b32 exec_hi, 0x00ff00ff
  ds_write_b128 v22, a[160:163] offset:0
  ds_write_b128 v22, a[164:167] offset:1024
  ds_write_b128 v22, a[168:171] offset:2048
  ds_write_b128 v22, a[172:175] offset:3072
  ds_write_b128 v22, a[176:179] offset:4096
  ds_write_b128 v22, a[180:183] offset:5120
  ds_write_b128 v22, a[184:187] offset:6144
  ds_write_b128 v22, a[188:191] offset:7168
  ds_write_b128 v22, a[192:195] offset:8192
  ds_write_b128 v22, a[196:199] offset:9216
  ds_write_b128 v22, a[200:203] offset:10240
  ds_write_b128 v22, a[204:207] offset:11264
  ds_write_b128 v22, a[208:211] offset:12288
  ds_write_b128 v22, a[212:215] offset:13312
  ds_write_b128 v22, a[216:219] offset:14336
  ds_write_b128 v22, a[220:223] offset:15360
  ds_write_b128 v22, a[224:227] offset:16384
  ds_write_b128 v22, a[228:231] offset:17408
  ds_write_b128 v22, a[232:235] offset:18432
  ds_write_b128 v22, a[236:239] offset:19456
  s_mov_b64 exec, -1
  v_mov_b32 v18, 128
  s_mov_b32 s29, 0
mega_kernel_cen45:
  buffer_load_dwordx2 v[16:17], v18, s[44:47], 0 offen sc1
  s_waitcnt vmcnt(0)
  v_readfirstlane_b32 s69, v16
  v_readfirstlane_b32 s100, v17
  s_nop 0
  s_min_u32 vcc_lo, s69, s100
  s_cmp_lg_u32 vcc_lo, 0
  s_cbranch_scc1 mega_kernel_cen45_done
  s_sleep 4
  s_add_u32 s29, s29, 1
  s_cmp_lt_u32 s29, 262144
  s_cbranch_scc1 mega_kernel_cen45
  s_branch mega_fail
mega_kernel_cen45_done:
  s_lshr_b32 s69, s69, s68
  s_bfe_u32 s69, s69, 0x10008
  s_mov_b32 s29, 0
  s_bfe_u32 vcc_lo, s100, 0x40008
  s_cmp_lt_u32 vcc_lo, 4
  s_cselect_b32 vcc_lo, 1, 0
  s_or_b32 s29, s29, vcc_lo
  s_bfe_u32 vcc_lo, s100, 0x4000c
  s_cmp_lt_u32 vcc_lo, 4
  s_cselect_b32 vcc_lo, 2, 0
  s_or_b32 s29, s29, vcc_lo
  s_bfe_u32 vcc_lo, s100, 0x40010
  s_cmp_lt_u32 vcc_lo, 4
  s_cselect_b32 vcc_lo, 4, 0
  s_or_b32 s29, s29, vcc_lo
  s_bfe_u32 vcc_lo, s100, 0x40014
  s_cmp_lt_u32 vcc_lo, 4
  s_cselect_b32 vcc_lo, 8, 0
  s_or_b32 s29, s29, vcc_lo
  s_mov_b32 s100, s29
mega_rec_layer:
  s_lshr_b32 s9, s2, 3
  s_and_b32 s11, s9, 3
  s_lshr_b32 s10, s9, 2
  s_lshl_b32 s27, s68, 2
  s_add_u32 s10, s10, s27
  v_and_b32 v16, 15, v1
  v_lshrrev_b32 v17, 4, v1
  v_and_b32 v18, 7, v1
  v_lshrrev_b32 v19, 3, v16
  v_lshlrev_b32 v2, 4, v1
  v_add_u32 v23, 122880, v2
  s_mov_b32 s26, 0x3dd53b95
  s_mov_b32 s42, 0xff00ff00
  s_mov_b32 s43, 0xff00ff00
  v_bfe_u32 v20, v1, 1, 1
  v_mul_u32_u24 v20, 0xaaaa, v20
  v_add_u32 v9, 0x4444, v20
  s_lshr_b32 s27, s3, 1
  s_lshl_b32 s27, s27, 10
  s_and_b32 s28, s3, 1
  s_lshl_b32 s28, s28, 3
  s_add_u32 s27, s27, s28
  v_add_u32 v3, s27, v2
  v_mul_u32_u24 v20, 640, v17
  v_lshl_add_u32 v4, v16, 4, v20
  v_lshrrev_b32 v21, 2, v16
  v_lshl_add_u32 v5, v21, 5, v20
  v_and_b32 v21, 1, v16
  v_lshl_add_u32 v5, v21, 4, v5
  v_lshl_add_u32 v20, v19, 2, v17
  v_and_b32 v6, 3, v1
  v_lshlrev_b32 v6, 8, v6
  v_lshl_add_u32 v6, v20, 4, v6
  v_and_b32 v21, 4, v1
  v_lshl_add_u32 v6, v21, 1, v6
  s_lshl_b32 s27, s3, 10
  v_add_u32 v6, s27, v6
  v_lshlrev_b32 v7, 1, v18
  v_lshl_add_u32 v7, v20, 4, v7
  s_lshl_b32 s28, s3, 8
  v_add_u32 v7, s28, v7
  v_lshlrev_b32 v8, 2, v17
  v_lshl_add_u32 v8, v16, 4, v8
  v_add_u32 v8, s28, v8
  v_bfe_u32 v20, v1, 2, 1
  v_and_b32 v21, 1, v17
  v_lshl_add_u32 v20, v21, 2, v20
  v_lshrrev_b32 v21, 1, v17
  v_lshl_add_u32 v21, v21, 1, v19
  v_lshl_add_u32 v24, v21, 3, v20
  v_mul_u32_u24 v21, 40, v21
  v_add_u32 v26, v21, v20
  v_and_b32 v20, 3, v1
  v_lshlrev_b32 v20, 3, v20
  v_mul_u32_u24 v24, 96, v24
  v_add_u32 v24, v24, v20
  v_add_u32 v24, 0, v24
  v_add_u32 v25, 61440, v24
  v_mul_u32_u24 v26, 96, v26
  v_add_u32 v26, v26, v20
  v_add_u32 v26, 0, v26
  v_add_u32 v27, 61440, v26
  v_and_b32 v20, 1, v1
  v_lshlrev_b32 v20, 4, v20
  v_mov_b32 v21, 0x3f80
  v_lshlrev_b32 v20, v20, v21
  v_lshrrev_b32 v21, 1, v16
  v_cmp_eq_u32 vcc, 0, v21
  s_nop 1
  v_cndmask_b32 v28, 0, v20, vcc
  v_cmp_eq_u32 vcc, 4, v21
  s_nop 1
  v_cndmask_b32 v32, 0, v20, vcc
  v_or_b32 v36, v28, v32
  v_cmp_eq_u32 vcc, 1, v21
  s_nop 1
  v_cndmask_b32 v29, 0, v20, vcc
  v_cmp_eq_u32 vcc, 5, v21
  s_nop 1
  v_cndmask_b32 v33, 0, v20, vcc
  v_or_b32 v37, v29, v33
  v_cmp_eq_u32 vcc, 2, v21
  s_nop 1
  v_cndmask_b32 v30, 0, v20, vcc
  v_cmp_eq_u32 vcc, 6, v21
  s_nop 1
  v_cndmask_b32 v34, 0, v20, vcc
  v_or_b32 v38, v30, v34
  v_cmp_eq_u32 vcc, 3, v21
  s_nop 1
  v_cndmask_b32 v31, 0, v20, vcc
  v_cmp_eq_u32 vcc, 7, v21
  s_nop 1
  v_cndmask_b32 v35, 0, v20, vcc
  v_or_b32 v39, v31, v35
  v_cmp_eq_u32 vcc, v17, v21
  s_nop 1
  v_cndmask_b32 v40, 0, v20, vcc
  v_add_u32 v41, 4, v17
  v_cmp_eq_u32 vcc, v41, v21
  s_nop 1
  v_cndmask_b32 v41, 0, v20, vcc
  v_mov_b32 v42, v40
  v_mov_b32 v43, v41
  s_mul_i32 s27, s68, 20480
  s_mul_i32 s28, s70, 163840
  s_add_u32 s27, s27, s28
  s_add_u32 s17, s27, 42090496
  s_add_u32 s16, s17, 10240
  s_add_u32 s27, s27, 42418176
  s_mul_i32 s28, s9, 640
  s_add_u32 s18, s27, s28
  s_add_u32 s19, s18, 10240
  s_mul_i32 s28, s3, 2560
  s_add_u32 s20, s27, s28
  s_add_u32 s21, s20, 10240
  s_mul_i32 s29, s68, 1302528
  s_add_u32 s29, s29, 5324800
  s_lshr_b32 s28, s9, 2
  s_mul_i32 s22, s28, 12288
  s_lshl_b32 s27, s11, 10
  s_add_u32 s22, s22, s27
  s_add_u32 s22, s22, s29
  s_add_u32 s22, s22, 204800
  s_mul_i32 s23, s28, 3072
  s_add_u32 s23, s23, s29
  s_add_u32 s23, s23, 303104
  s_mov_b32 s24, s29
  s_add_u32 s25, s24, 163840
  s_mov_b32 s72, 0
  s_mov_b32 s12, 0
  s_mov_b32 s76, 0
  s_lshl_b32 s27, s10, 7
  s_lshl_b32 s28, s11, 2
  s_add_u32 s54, s27, s28
  s_add_u32 s77, s54, s71
  s_add_u32 s77, s77, 16384
  s_getreg_b32 s27, hwreg(HW_REG_XCC_ID)
  s_sub_u32 s28, s27, s68
  s_mov_b32 s31, s100
  s_add_u32 s29, s28, 0
  s_xor_b32 s29, s29, s27
  s_bfe_u32 s29, s29, 0x10002
  s_lshl_b32 s29, s29, 0
  s_xor_b32 s31, s31, s29
  s_add_u32 s29, s28, 1
  s_xor_b32 s29, s29, s27
  s_bfe_u32 s29, s29, 0x10002
  s_lshl_b32 s29, s29, 1
  s_xor_b32 s31, s31, s29
  s_add_u32 s29, s28, 2
  s_xor_b32 s29, s29, s27
  s_bfe_u32 s29, s29, 0x10002
  s_lshl_b32 s29, s29, 2
  s_xor_b32 s31, s31, s29
  s_add_u32 s29, s28, 3
  s_xor_b32 s29, s29, s27
  s_bfe_u32 s29, s29, 0x10002
  s_lshl_b32 s29, s29, 3
  s_xor_b32 s31, s31, s29
  s_add_u32 s30, s4, 45105151
  s_and_b32 s30, s30, 0xffe00000
  s_sub_u32 s30, s30, s4
  s_lshl_b32 s27, s9, 1
  s_add_u32 s27, s27, s3
  s_lshr_b32 s28, s27, 2
  s_lshl_b32 s28, s28, 14
  s_and_b32 s27, s27, 3
  s_lshl_b32 s27, s27, 11
  s_add_u32 s27, s27, s28
  s_lshr_b32 s28, s9, 3
  s_add_u32 s28, s28, 8
  s_lshl_b32 s28, s28, 14
  s_and_b32 s29, s9, 7
  s_lshl_b32 s29, s29, 10
  s_add_u32 s28, s28, s29
  s_cmp_lt_u32 s3, 2
  s_cselect_b32 s27, s27, s28
  s_cselect_b32 s28, 8, 7
  s_lshl_b32 s29, s68, s28
  s_add_u32 s30, s30, s27
  s_and_b32 s27, s68, 3
  s_lshr_b32 s28, s31, s27
  s_and_b32 s28, s28, 1
  s_lshl_b32 s28, s28, 13
  s_mul_i32 s27, s27, 2260992
  s_add_u32 s32, s30, s27
  s_add_u32 s32, s32, s28
  s_add_u32 s30, s30, s29
  s_mul_i32 s39, s70, 63
  s_sub_u32 s39, s39, 1
  s_mov_b32 s15, 0
  s_mov_b32 s78, 0
  s_mov_b32 s75, 0
  s_mov_b32 s80, 0
  s_waitcnt vmcnt(0) lgkmcnt(0)
  s_barrier
  s_cmp_eq_u32 s3, 1
  s_cbranch_scc1 mega_pro1
  s_cmp_eq_u32 s3, 2
  s_cbranch_scc1 mega_pro2
  s_cmp_eq_u32 s3, 3
  s_cbranch_scc1 mega_pro3
  s_cmp_lg_u32 s70, 0
  s_cbranch_scc1 mega_now0
  ds_read_b64_tr_b16 v[136:137], v24 offset:0
  ds_read_b64_tr_b16 v[138:139], v24 offset:192
  ds_read_b64_tr_b16 v[140:141], v24 offset:3840
  ds_read_b64_tr_b16 v[142:143], v24 offset:4032
  ds_read_b64_tr_b16 v[144:145], v25 offset:0
  ds_read_b64_tr_b16 v[146:147], v25 offset:192
  ds_read_b64_tr_b16 v[148:149], v25 offset:3840
  ds_read_b64_tr_b16 v[150:151], v25 offset:4032
  ds_read_b64_tr_b16 v[152:153], v24 offset:7680
  ds_read_b64_tr_b16 v[154:155], v24 offset:7872
  ds_read_b64_tr_b16 v[156:157], v24 offset:11520
  ds_read_b64_tr_b16 v[158:159], v24 offset:11712
  ds_read_b64_tr_b16 v[160:161], v25 offset:7680
  ds_read_b64_tr_b16 v[162:163], v25 offset:7872
  ds_read_b64_tr_b16 v[164:165], v25 offset:11520
  ds_read_b64_tr_b16 v[166:167], v25 offset:11712
  ds_read_b64_tr_b16 v[168:169], v24 offset:15360
  ds_read_b64_tr_b16 v[170:171], v24 offset:15552
  ds_read_b64_tr_b16 v[172:173], v24 offset:19200
  ds_read_b64_tr_b16 v[174:175], v24 offset:19392
  ds_read_b64_tr_b16 v[176:177], v25 offset:15360
  ds_read_b64_tr_b16 v[178:179], v25 offset:15552
  ds_read_b64_tr_b16 v[180:181], v25 offset:19200
  ds_read_b64_tr_b16 v[182:183], v25 offset:19392
  ds_read_b64_tr_b16 v[184:185], v24 offset:32
  ds_read_b64_tr_b16 v[186:187], v24 offset:224
  ds_read_b64_tr_b16 v[188:189], v24 offset:3872
  ds_read_b64_tr_b16 v[190:191], v24 offset:4064
  ds_read_b64_tr_b16 v[192:193], v25 offset:32
  ds_read_b64_tr_b16 v[194:195], v25 offset:224
  ds_read_b64_tr_b16 v[196:197], v25 offset:3872
  ds_read_b64_tr_b16 v[198:199], v25 offset:4064
  ds_read_b64_tr_b16 v[200:201], v24 offset:7712
  ds_read_b64_tr_b16 v[202:203], v24 offset:7904
  ds_read_b64_tr_b16 v[204:205], v24 offset:11552
  ds_read_b64_tr_b16 v[206:207], v24 offset:11744
  ds_read_b64_tr_b16 v[208:209], v25 offset:7712
  ds_read_b64_tr_b16 v[210:211], v25 offset:7904
  ds_read_b64_tr_b16 v[212:213], v25 offset:11552
  ds_read_b64_tr_b16 v[214:215], v25 offset:11744
  ds_read_b64_tr_b16 v[216:217], v24 offset:15392
  ds_read_b64_tr_b16 v[218:219], v24 offset:15584
  ds_read_b64_tr_b16 v[220:221], v24 offset:19232
  ds_read_b64_tr_b16 v[222:223], v24 offset:19424
  ds_read_b64_tr_b16 v[224:225], v24 offset:64
  ds_read_b64_tr_b16 v[226:227], v24 offset:256
  ds_read_b64_tr_b16 v[228:229], v24 offset:3904
  ds_read_b64_tr_b16 v[230:231], v24 offset:4096
  ds_read_b64_tr_b16 v[232:233], v25 offset:64
  ds_read_b64_tr_b16 v[234:235], v25 offset:256
  ds_read_b64_tr_b16 v[236:237], v25 offset:3904
  ds_read_b64_tr_b16 v[238:239], v25 offset:4096
  ds_read_b64_tr_b16 v[240:241], v24 offset:7744
  ds_read_b64_tr_b16 v[242:243], v24 offset:7936
  ds_read_b64_tr_b16 v[244:245], v24 offset:11584
  ds_read_b64_tr_b16 v[246:247], v24 offset:11776
  ds_read_b64_tr_b16 v[248:249], v25 offset:7744
  ds_read_b64_tr_b16 v[250:251], v25 offset:7936
  ds_read_b64_tr_b16 v[252:253], v25 offset:11584
  ds_read_b64_tr_b16 v[254:255], v25 offset:11776
mega_now0:
  v_accvgpr_write_b32 a160, v28
  v_accvgpr_write_b32 a161, v29
  v_accvgpr_write_b32 a162, v30
  v_accvgpr_write_b32 a163, v31
  v_accvgpr_write_b32 a164, v32
  v_accvgpr_write_b32 a165, v33
  v_accvgpr_write_b32 a166, v34
  v_accvgpr_write_b32 a167, v35
  v_accvgpr_write_b32 a168, v36
  v_accvgpr_write_b32 a169, v37
  v_accvgpr_write_b32 a170, v38
  v_accvgpr_write_b32 a171, v39
  v_accvgpr_write_b32 a172, v40
  v_accvgpr_write_b32 a173, v41
  v_accvgpr_write_b32 a174, v42
  v_accvgpr_write_b32 a175, v43
  v_lshrrev_b32 v20, 1, v18
  v_lshlrev_b32 v44, 6, v20
  v_and_b32 v20, 1, v18
  v_lshl_add_u32 v44, v20, 4, v44
  v_lshlrev_b32 v12, 8, v17
  v_lshl_add_u32 v12, v18, 4, v12
  v_add_u32 v13, 0, v2
  s_mul_i32 s27, s9, 40
  s_add_u32 s27, s27, 0
  v_add_u32 v20, s27, v16
  v_lshrrev_b32 v66, 4, v20
  v_lshlrev_b32 v66, 10, v66
  v_and_b32 v20, 15, v20
  v_lshl_add_u32 v66, v20, 4, v66
  v_lshl_add_u32 v66, v17, 8, v66
  v_lshlrev_b32 v10, 6, v18
  v_lshl_add_u32 v10, v17, 4, v10
  v_add_u32 v10, 0, v10
  v_cmp_gt_u32 vcc, 8, v16
  v_mov_b32 v0, 0x40000000
  s_nop 0
  v_cndmask_b32 v10, v0, v10, vcc
  v_and_b32 v20, 3, v16
  v_lshlrev_b32 v11, 6, v20
  v_lshrrev_b32 v20, 2, v16
  v_lshl_add_u32 v11, v20, 4, v11
  v_lshl_add_u32 v11, v17, 8, v11
  v_lshrrev_b32 v20, 1, v17
  v_lshl_add_u32 v61, v20, 5, v44
  v_and_b32 v20, 1, v17
  v_lshl_add_u32 v20, v20, 1, v19
  v_mul_u32_u24 v134, 2260992, v20
  v_add_u32 v61, v134, v61
  v_lshrrev_b32 v20, v20, s31
  v_and_b32 v20, 1, v20
  v_lshl_add_u32 v134, v20, 13, v61
  v_xor_b32 v61, 8192, v134
  v_mov_b32 v62, v2
  v_lshlrev_b32 v63, 4, v16
  v_lshl_add_u32 v63, v17, 3, v63
  s_lshl_b32 s27, s9, 9
  s_add_u32 s27, s27, 0
  v_add_u32 v63, s27, v63
  v_cmp_gt_u32 vcc, 32, v1
  v_mov_b32 v0, 0x40000000
  s_nop 0
  v_cndmask_b32 v63, v0, v63, vcc
  v_mov_b32 v118, 0
  v_mov_b32 v119, 0
  v_mov_b32 v126, 0
  v_mov_b32 v127, 0
  v_mov_b32 v132, -1
  v_mov_b32 v133, -1
  s_waitcnt lgkmcnt(0)
  s_barrier
  v_mov_b32 v0, 0xbdd53b95
  v_mov_b32 v28, 0
  v_mov_b32 v29, 0
  v_mov_b32 v30, 0
  v_mov_b32 v31, 0
  v_mov_b32 v32, 0
  v_mov_b32 v33, 0
  v_mov_b32 v34, 0
  v_mov_b32 v35, 0
  v_mov_b32 v36, 0
  v_mov_b32 v37, 0
  v_mov_b32 v38, 0
  v_mov_b32 v39, 0
  v_mov_b32 v40, 0
  v_mov_b32 v41, 0
  v_mov_b32 v42, 0
  v_mov_b32 v43, 0
  v_mov_b32 v44, 0
  v_mov_b32 v45, 0
  v_mov_b32 v46, 0
  v_mov_b32 v47, 0
  v_mov_b32 v48, 0
  v_mov_b32 v49, 0
  v_mov_b32 v50, 0
  v_mov_b32 v51, 0
  v_mov_b32 v52, 0
  v_mov_b32 v53, 0
  v_mov_b32 v54, 0
  v_mov_b32 v55, 0
  v_mov_b32 v56, 0
  v_mov_b32 v57, 0
  v_mov_b32 v58, 0
  v_mov_b32 v59, 0
  s_add_u32 s13, s17, 0
  s_add_u32 s14, s17, 2048
  s_cmp_eq_u32 s69, 0
  s_cbranch_scc1 mega_loop0
  s_branch mega_loop4
mega_pro1:
  s_cmp_lg_u32 s70, 0
  s_cbranch_scc1 mega_now1
  ds_read_b64_tr_b16 v[136:137], v24 offset:23104
  ds_read_b64_tr_b16 v[138:139], v24 offset:23296
  ds_read_b64_tr_b16 v[140:141], v24 offset:26944
  ds_read_b64_tr_b16 v[142:143], v24 offset:27136
  ds_read_b64_tr_b16 v[144:145], v25 offset:23104
  ds_read_b64_tr_b16 v[146:147], v25 offset:23296
  ds_read_b64_tr_b16 v[148:149], v25 offset:26944
  ds_read_b64_tr_b16 v[150:151], v25 offset:27136
  ds_read_b64_tr_b16 v[152:153], v24 offset:30784
  ds_read_b64_tr_b16 v[154:155], v24 offset:30976
  ds_read_b64_tr_b16 v[156:157], v24 offset:34624
  ds_read_b64_tr_b16 v[158:159], v24 offset:34816
  ds_read_b64_tr_b16 v[160:161], v25 offset:30784
  ds_read_b64_tr_b16 v[162:163], v25 offset:30976
  ds_read_b64_tr_b16 v[164:165], v25 offset:34624
  ds_read_b64_tr_b16 v[166:167], v25 offset:34816
  ds_read_b64_tr_b16 v[168:169], v24 offset:15424
  ds_read_b64_tr_b16 v[170:171], v24 offset:15616
  ds_read_b64_tr_b16 v[172:173], v24 offset:19264
  ds_read_b64_tr_b16 v[174:175], v24 offset:19456
  ds_read_b64_tr_b16 v[176:177], v25 offset:15424
  ds_read_b64_tr_b16 v[178:179], v25 offset:15616
  ds_read_b64_tr_b16 v[180:181], v25 offset:19264
  ds_read_b64_tr_b16 v[182:183], v25 offset:19456
  ds_read_b64_tr_b16 v[184:185], v24 offset:23072
  ds_read_b64_tr_b16 v[186:187], v24 offset:23264
  ds_read_b64_tr_b16 v[188:189], v24 offset:26912
  ds_read_b64_tr_b16 v[190:191], v24 offset:27104
  ds_read_b64_tr_b16 v[192:193], v25 offset:23072
  ds_read_b64_tr_b16 v[194:195], v25 offset:23264
  ds_read_b64_tr_b16 v[196:197], v25 offset:26912
  ds_read_b64_tr_b16 v[198:199], v25 offset:27104
  ds_read_b64_tr_b16 v[200:201], v24 offset:30752
  ds_read_b64_tr_b16 v[202:203], v24 offset:30944
  ds_read_b64_tr_b16 v[204:205], v24 offset:34592
  ds_read_b64_tr_b16 v[206:207], v24 offset:34784
  ds_read_b64_tr_b16 v[208:209], v25 offset:30752
  ds_read_b64_tr_b16 v[210:211], v25 offset:30944
  ds_read_b64_tr_b16 v[212:213], v25 offset:34592
  ds_read_b64_tr_b16 v[214:215], v25 offset:34784
  ds_read_b64_tr_b16 v[216:217], v25 offset:15392
  ds_read_b64_tr_b16 v[218:219], v25 offset:15584
  ds_read_b64_tr_b16 v[220:221], v25 offset:19232
  ds_read_b64_tr_b16 v[222:223], v25 offset:19424
  ds_read_b64_tr_b16 v[224:225], v24 offset:23040
  ds_read_b64_tr_b16 v[226:227], v24 offset:23232
  ds_read_b64_tr_b16 v[228:229], v24 offset:26880
  ds_read_b64_tr_b16 v[230:231], v24 offset:27072
  ds_read_b64_tr_b16 v[232:233], v25 offset:23040
  ds_read_b64_tr_b16 v[234:235], v25 offset:23232
  ds_read_b64_tr_b16 v[236:237], v25 offset:26880
  ds_read_b64_tr_b16 v[238:239], v25 offset:27072
  ds_read_b64_tr_b16 v[240:241], v24 offset:30720
  ds_read_b64_tr_b16 v[242:243], v24 offset:30912
  ds_read_b64_tr_b16 v[244:245], v24 offset:34560
  ds_read_b64_tr_b16 v[246:247], v24 offset:34752
  ds_read_b64_tr_b16 v[248:249], v25 offset:30720
  ds_read_b64_tr_b16 v[250:251], v25 offset:30912
  ds_read_b64_tr_b16 v[252:253], v25 offset:34560
  ds_read_b64_tr_b16 v[254:255], v25 offset:34752
mega_now1:
  v_accvgpr_write_b32 a160, v28
  v_accvgpr_write_b32 a161, v29
  v_accvgpr_write_b32 a162, v30
  v_accvgpr_write_b32 a163, v31
  v_accvgpr_write_b32 a164, v32
  v_accvgpr_write_b32 a165, v33
  v_accvgpr_write_b32 a166, v34
  v_accvgpr_write_b32 a167, v35
  v_accvgpr_write_b32 a168, v36
  v_accvgpr_write_b32 a169, v37
  v_accvgpr_write_b32 a170, v38
  v_accvgpr_write_b32 a171, v39
  v_accvgpr_write_b32 a172, v40
  v_accvgpr_write_b32 a173, v41
  v_accvgpr_write_b32 a174, v42
  v_accvgpr_write_b32 a175, v43
  v_lshrrev_b32 v20, 1, v18
  v_lshlrev_b32 v44, 6, v20
  v_and_b32 v20, 1, v18
  v_lshl_add_u32 v44, v20, 4, v44
  v_lshlrev_b32 v12, 8, v17
  v_lshl_add_u32 v12, v18, 4, v12
  v_add_u32 v13, 1024, v2
  s_mul_i32 s27, s9, 40
  s_add_u32 s27, s27, 16
  v_add_u32 v20, s27, v16
  v_lshrrev_b32 v66, 4, v20
  v_lshlrev_b32 v66, 10, v66
  v_and_b32 v20, 15, v20
  v_lshl_add_u32 v66, v20, 4, v66
  v_lshl_add_u32 v66, v17, 8, v66
  v_lshlrev_b32 v10, 6, v18
  v_lshl_add_u32 v10, v17, 4, v10
  v_add_u32 v10, 8, v10
  v_cmp_gt_u32 vcc, 8, v16
  v_mov_b32 v0, 0x40000000
  s_nop 0
  v_cndmask_b32 v10, v0, v10, vcc
  v_and_b32 v20, 3, v16
  v_lshlrev_b32 v11, 6, v20
  v_lshrrev_b32 v20, 2, v16
  v_lshl_add_u32 v11, v20, 4, v11
  v_lshl_add_u32 v11, v17, 8, v11
  v_lshrrev_b32 v20, 1, v17
  v_lshl_add_u32 v61, v20, 5, v44
  v_and_b32 v20, 1, v17
  v_lshl_add_u32 v20, v20, 1, v19
  v_mul_u32_u24 v134, 2260992, v20
  v_add_u32 v61, v134, v61
  v_lshrrev_b32 v20, v20, s31
  v_and_b32 v20, 1, v20
  v_lshl_add_u32 v134, v20, 13, v61
  v_xor_b32 v61, 8192, v134
  v_mov_b32 v62, v2
  v_lshlrev_b32 v63, 4, v16
  v_lshl_add_u32 v63, v17, 3, v63
  s_lshl_b32 s27, s9, 9
  s_add_u32 s27, s27, 256
  v_add_u32 v63, s27, v63
  v_cmp_gt_u32 vcc, 32, v1
  v_mov_b32 v0, 0x40000000
  s_nop 0
  v_cndmask_b32 v63, v0, v63, vcc
  v_mov_b32 v118, 0
  v_mov_b32 v119, 0
  v_mov_b32 v126, 0
  v_mov_b32 v127, 0
  v_mov_b32 v132, -1
  v_mov_b32 v133, -1
  s_waitcnt lgkmcnt(0)
  s_barrier
  v_mov_b32 v0, 0xbdd53b95
  v_mov_b32 v28, 0
  v_mov_b32 v29, 0
  v_mov_b32 v30, 0
  v_mov_b32 v31, 0
  v_mov_b32 v32, 0
  v_mov_b32 v33, 0
  v_mov_b32 v34, 0
  v_mov_b32 v35, 0
  v_mov_b32 v36, 0
  v_mov_b32 v37, 0
  v_mov_b32 v38, 0
  v_mov_b32 v39, 0
  v_mov_b32 v40, 0
  v_mov_b32 v41, 0
  v_mov_b32 v42, 0
  v_mov_b32 v43, 0
  v_mov_b32 v44, 0
  v_mov_b32 v45, 0
  v_mov_b32 v46, 0
  v_mov_b32 v47, 0
  v_mov_b32 v48, 0
  v_mov_b32 v49, 0
  v_mov_b32 v50, 0
  v_mov_b32 v51, 0
  v_mov_b32 v52, 0
  v_mov_b32 v53, 0
  v_mov_b32 v54, 0
  v_mov_b32 v55, 0
  v_mov_b32 v56, 0
  v_mov_b32 v57, 0
  v_mov_b32 v58, 0
  v_mov_b32 v59, 0
  s_add_u32 s13, s17, 3072
  s_add_u32 s14, s17, 2048
  s_cmp_eq_u32 s69, 0
  s_cbranch_scc1 mega_loop1
  s_branch mega_loop5
mega_pro2:
  s_cmp_lg_u32 s70, 0
  s_cbranch_scc1 mega_now2
  ds_read_b64_tr_b16 v[136:137], v24 offset:38400
  ds_read_b64_tr_b16 v[138:139], v24 offset:38592
  ds_read_b64_tr_b16 v[140:141], v24 offset:42240
  ds_read_b64_tr_b16 v[142:143], v24 offset:42432
  ds_read_b64_tr_b16 v[144:145], v25 offset:38400
  ds_read_b64_tr_b16 v[146:147], v25 offset:38592
  ds_read_b64_tr_b16 v[148:149], v25 offset:42240
  ds_read_b64_tr_b16 v[150:151], v25 offset:42432
  ds_read_b64_tr_b16 v[152:153], v24 offset:46080
  ds_read_b64_tr_b16 v[154:155], v24 offset:46272
  ds_read_b64_tr_b16 v[156:157], v24 offset:49920
  ds_read_b64_tr_b16 v[158:159], v24 offset:50112
  ds_read_b64_tr_b16 v[160:161], v25 offset:46080
  ds_read_b64_tr_b16 v[162:163], v25 offset:46272
  ds_read_b64_tr_b16 v[164:165], v25 offset:49920
  ds_read_b64_tr_b16 v[166:167], v25 offset:50112
  ds_read_b64_tr_b16 v[168:169], v24 offset:53760
  ds_read_b64_tr_b16 v[170:171], v24 offset:53952
  ds_read_b64_tr_b16 v[172:173], v24 offset:57600
  ds_read_b64_tr_b16 v[174:175], v24 offset:57792
  ds_read_b64_tr_b16 v[176:177], v25 offset:53760
  ds_read_b64_tr_b16 v[178:179], v25 offset:53952
  ds_read_b64_tr_b16 v[180:181], v25 offset:57600
  ds_read_b64_tr_b16 v[182:183], v25 offset:57792
  ds_read_b64_tr_b16 v[184:185], v24 offset:38432
  ds_read_b64_tr_b16 v[186:187], v24 offset:38624
  ds_read_b64_tr_b16 v[188:189], v24 offset:42272
  ds_read_b64_tr_b16 v[190:191], v24 offset:42464
  ds_read_b64_tr_b16 v[192:193], v25 offset:38432
  ds_read_b64_tr_b16 v[194:195], v25 offset:38624
  ds_read_b64_tr_b16 v[196:197], v25 offset:42272
  ds_read_b64_tr_b16 v[198:199], v25 offset:42464
  ds_read_b64_tr_b16 v[200:201], v24 offset:46112
  ds_read_b64_tr_b16 v[202:203], v24 offset:46304
  ds_read_b64_tr_b16 v[204:205], v24 offset:49952
  ds_read_b64_tr_b16 v[206:207], v24 offset:50144
  ds_read_b64_tr_b16 v[208:209], v25 offset:46112
  ds_read_b64_tr_b16 v[210:211], v25 offset:46304
  ds_read_b64_tr_b16 v[212:213], v25 offset:49952
  ds_read_b64_tr_b16 v[214:215], v25 offset:50144
  ds_read_b64_tr_b16 v[216:217], v24 offset:53792
  ds_read_b64_tr_b16 v[218:219], v24 offset:53984
  ds_read_b64_tr_b16 v[220:221], v24 offset:57632
  ds_read_b64_tr_b16 v[222:223], v24 offset:57824
  ds_read_b64_tr_b16 v[224:225], v24 offset:38464
  ds_read_b64_tr_b16 v[226:227], v24 offset:38656
  ds_read_b64_tr_b16 v[228:229], v24 offset:42304
  ds_read_b64_tr_b16 v[230:231], v24 offset:42496
  ds_read_b64_tr_b16 v[232:233], v25 offset:38464
  ds_read_b64_tr_b16 v[234:235], v25 offset:38656
  ds_read_b64_tr_b16 v[236:237], v25 offset:42304
  ds_read_b64_tr_b16 v[238:239], v25 offset:42496
  ds_read_b64_tr_b16 v[240:241], v24 offset:46144
  ds_read_b64_tr_b16 v[242:243], v24 offset:46336
  ds_read_b64_tr_b16 v[244:245], v24 offset:49984
  ds_read_b64_tr_b16 v[246:247], v24 offset:50176
  ds_read_b64_tr_b16 v[248:249], v25 offset:46144
  ds_read_b64_tr_b16 v[250:251], v25 offset:46336
  ds_read_b64_tr_b16 v[252:253], v25 offset:49984
  ds_read_b64_tr_b16 v[254:255], v25 offset:50176
mega_now2:
  v_accvgpr_write_b32 a160, v28
  v_accvgpr_write_b32 a161, v29
  v_accvgpr_write_b32 a162, v30
  v_accvgpr_write_b32 a163, v31
  v_accvgpr_write_b32 a164, v32
  v_accvgpr_write_b32 a165, v33
  v_accvgpr_write_b32 a166, v34
  v_accvgpr_write_b32 a167, v35
  v_accvgpr_write_b32 a168, v36
  v_accvgpr_write_b32 a169, v37
  v_accvgpr_write_b32 a170, v38
  v_accvgpr_write_b32 a171, v39
  v_accvgpr_write_b32 a172, v40
  v_accvgpr_write_b32 a173, v41
  v_accvgpr_write_b32 a174, v42
  v_accvgpr_write_b32 a175, v43
  v_lshrrev_b32 v20, 1, v18
  v_lshlrev_b32 v44, 6, v20
  v_and_b32 v20, 1, v18
  v_lshl_add_u32 v44, v20, 4, v44
  v_lshlrev_b32 v12, 8, v17
  v_lshl_add_u32 v12, v18, 4, v12
  v_add_u32 v13, 2048, v2
  s_mul_i32 s27, s9, 40
  s_add_u32 s27, s27, 32
  v_add_u32 v20, s27, v16
  v_lshrrev_b32 v66, 4, v20
  v_lshlrev_b32 v66, 10, v66
  v_and_b32 v20, 15, v20
  v_lshl_add_u32 v66, v20, 4, v66
  v_lshl_add_u32 v66, v17, 8, v66
  v_and_b32 v20, 3, v18
  v_lshlrev_b32 v10, 5, v20
  v_lshrrev_b32 v20, 2, v18
  v_lshl_add_u32 v10, v20, 4, v10
  v_lshl_add_u32 v10, v17, 3, v10
  v_add_u32 v10, 496, v10
  v_and_b32 v21, 40, v1
  v_cmp_eq_u32 vcc, 32, v21
  v_mov_b32 v0, 0x40000000
  s_nop 0
  v_cndmask_b32 v10, v0, v10, vcc
  v_lshlrev_b32 v61, 4, v18
  v_lshl_add_u32 v62, v17, 7, v61
  v_and_b32 v20, 1, v17
  v_lshl_add_u32 v61, v20, 3, v61
  v_and_b32 v20, 2, v17
  v_add_u32 v20, v20, v19
  v_mul_u32_u24 v134, 2260992, v20
  v_add_u32 v61, v134, v61
  v_lshrrev_b32 v20, v20, s31
  v_and_b32 v20, 1, v20
  v_lshl_add_u32 v134, v20, 13, v61
  v_xor_b32 v61, 8192, v134
  v_lshlrev_b32 v20, 7, v19
  v_sub_u32 v13, v13, v20
  v_lshl_add_u32 v63, v17, 3, v44
  s_lshr_b32 s27, s9, 1
  s_lshl_b32 s27, s27, 8
  s_and_b32 s28, s9, 1
  s_lshl_b32 s28, s28, 5
  s_add_u32 s27, s27, s28
  s_add_u32 s27, s27, 8192
  v_add_u32 v63, s27, v63
  v_cmp_eq_u32 vcc, 0, v21
  v_mov_b32 v0, 0x40000000
  s_nop 0
  v_cndmask_b32 v63, v0, v63, vcc
  v_cmp_gt_u32 vcc, 8, v16
  v_mov_b32 v0, 0x40000000
  s_nop 0
  v_cndmask_b32 v66, v0, v66, vcc
  s_lshl_b32 s27, s11, 9
  v_add_u32 v64, s27, v62
  v_lshrrev_b32 v65, 1, v64
  v_add_u32 v65, 2048, v65
  v_cmp_le_u32 vcc, 8, v16
  v_mov_b32 v0, 0x40000000
  s_nop 0
  v_cndmask_b32 v64, v0, v64, vcc
  v_cmp_le_u32 vcc, 8, v16
  v_mov_b32 v0, 0x40000000
  s_nop 0
  v_cndmask_b32 v65, v0, v65, vcc
  v_mov_b32 v67, 0
  v_cmp_eq_u32 vcc, 0, v1
  v_mov_b32 v0, 0x40000000
  s_nop 0
  v_cndmask_b32 v67, v0, v67, vcc
  v_mov_b32 v118, 0
  v_mov_b32 v119, 0
  v_mov_b32 v126, 0
  v_mov_b32 v127, 0
  v_mov_b32 v132, -1
  v_mov_b32 v133, -1
  s_waitcnt lgkmcnt(0)
  s_barrier
  v_mov_b32 v0, 0xbdd53b95
  v_mov_b32 v28, 0
  v_mov_b32 v29, 0
  v_mov_b32 v30, 0
  v_mov_b32 v31, 0
  v_mov_b32 v32, 0
  v_mov_b32 v33, 0
  v_mov_b32 v34, 0
  v_mov_b32 v35, 0
  v_mov_b32 v36, 0
  v_mov_b32 v37, 0
  v_mov_b32 v38, 0
  v_mov_b32 v39, 0
  v_mov_b32 v40, 0
  v_mov_b32 v41, 0
  v_mov_b32 v42, 0
  v_mov_b32 v43, 0
  v_mov_b32 v44, 0
  v_mov_b32 v45, 0
  v_mov_b32 v46, 0
  v_mov_b32 v47, 0
  v_mov_b32 v48, 0
  v_mov_b32 v49, 0
  v_mov_b32 v50, 0
  v_mov_b32 v51, 0
  v_mov_b32 v52, 0
  v_mov_b32 v53, 0
  v_mov_b32 v54, 0
  v_mov_b32 v55, 0
  v_mov_b32 v56, 0
  v_mov_b32 v57, 0
  v_mov_b32 v58, 0
  v_mov_b32 v59, 0
  s_add_u32 s13, s17, 5120
  s_add_u32 s14, s17, 7168
  s_cmp_eq_u32 s69, 0
  s_cbranch_scc1 mega_loop2
  s_branch mega_loop6
mega_pro3:
  s_cmp_lg_u32 s70, 0
  s_cbranch_scc1 mega_now3
  ds_read_b64_tr_b16 v[136:137], v26 offset:3136
  ds_read_b64_tr_b16 v[138:139], v26 offset:3328
  ds_read_b64_tr_b16 v[140:141], v26 offset:18496
  ds_read_b64_tr_b16 v[142:143], v26 offset:18688
  ds_read_b64_tr_b16 v[144:145], v27 offset:3136
  ds_read_b64_tr_b16 v[146:147], v27 offset:3328
  ds_read_b64_tr_b16 v[148:149], v27 offset:18496
  ds_read_b64_tr_b16 v[150:151], v27 offset:18688
  ds_read_b64_tr_b16 v[152:153], v26 offset:33856
  ds_read_b64_tr_b16 v[154:155], v26 offset:34048
  ds_read_b64_tr_b16 v[156:157], v26 offset:49216
  ds_read_b64_tr_b16 v[158:159], v26 offset:49408
  ds_read_b64_tr_b16 v[160:161], v27 offset:33856
  ds_read_b64_tr_b16 v[162:163], v27 offset:34048
  ds_read_b64_tr_b16 v[164:165], v27 offset:49216
  ds_read_b64_tr_b16 v[166:167], v27 offset:49408
  ds_read_b64_tr_b16 v[168:169], v24 offset:53824
  ds_read_b64_tr_b16 v[170:171], v24 offset:54016
  ds_read_b64_tr_b16 v[172:173], v24 offset:57664
  ds_read_b64_tr_b16 v[174:175], v24 offset:57856
  ds_read_b64_tr_b16 v[176:177], v25 offset:53824
  ds_read_b64_tr_b16 v[178:179], v25 offset:54016
  ds_read_b64_tr_b16 v[180:181], v25 offset:57664
  ds_read_b64_tr_b16 v[182:183], v25 offset:57856
  ds_read_b64_tr_b16 v[184:185], v26 offset:3104
  ds_read_b64_tr_b16 v[186:187], v26 offset:3296
  ds_read_b64_tr_b16 v[188:189], v26 offset:18464
  ds_read_b64_tr_b16 v[190:191], v26 offset:18656
  ds_read_b64_tr_b16 v[192:193], v27 offset:3104
  ds_read_b64_tr_b16 v[194:195], v27 offset:3296
  ds_read_b64_tr_b16 v[196:197], v27 offset:18464
  ds_read_b64_tr_b16 v[198:199], v27 offset:18656
  ds_read_b64_tr_b16 v[200:201], v26 offset:33824
  ds_read_b64_tr_b16 v[202:203], v26 offset:34016
  ds_read_b64_tr_b16 v[204:205], v26 offset:49184
  ds_read_b64_tr_b16 v[206:207], v26 offset:49376
  ds_read_b64_tr_b16 v[208:209], v27 offset:33824
  ds_read_b64_tr_b16 v[210:211], v27 offset:34016
  ds_read_b64_tr_b16 v[212:213], v27 offset:49184
  ds_read_b64_tr_b16 v[214:215], v27 offset:49376
  ds_read_b64_tr_b16 v[216:217], v25 offset:53792
  ds_read_b64_tr_b16 v[218:219], v25 offset:53984
  ds_read_b64_tr_b16 v[220:221], v25 offset:57632
  ds_read_b64_tr_b16 v[222:223], v25 offset:57824
  ds_read_b64_tr_b16 v[224:225], v26 offset:3072
  ds_read_b64_tr_b16 v[226:227], v26 offset:3264
  ds_read_b64_tr_b16 v[228:229], v26 offset:18432
  ds_read_b64_tr_b16 v[230:231], v26 offset:18624
  ds_read_b64_tr_b16 v[232:233], v27 offset:3072
  ds_read_b64_tr_b16 v[234:235], v27 offset:3264
  ds_read_b64_tr_b16 v[236:237], v27 offset:18432
  ds_read_b64_tr_b16 v[238:239], v27 offset:18624
  ds_read_b64_tr_b16 v[240:241], v26 offset:33792
  ds_read_b64_tr_b16 v[242:243], v26 offset:33984
  ds_read_b64_tr_b16 v[244:245], v26 offset:49152
  ds_read_b64_tr_b16 v[246:247], v26 offset:49344
  ds_read_b64_tr_b16 v[248:249], v27 offset:33792
  ds_read_b64_tr_b16 v[250:251], v27 offset:33984
  ds_read_b64_tr_b16 v[252:253], v27 offset:49152
  ds_read_b64_tr_b16 v[254:255], v27 offset:49344
  ds_read_b128 a[160:163], v23 offset:0
  ds_read_b128 a[164:167], v23 offset:1024
  ds_read_b128 a[168:171], v23 offset:2048
  ds_read_b128 a[172:175], v23 offset:3072
  ds_read_b128 a[176:179], v23 offset:4096
  ds_read_b128 a[180:183], v23 offset:5120
  ds_read_b128 a[184:187], v23 offset:6144
  ds_read_b128 a[188:191], v23 offset:7168
  ds_read_b128 a[192:195], v23 offset:8192
  ds_read_b128 a[196:199], v23 offset:9216
  ds_read_b128 a[200:203], v23 offset:10240
  ds_read_b128 a[204:207], v23 offset:11264
  ds_read_b128 a[208:211], v23 offset:12288
  ds_read_b128 a[212:215], v23 offset:13312
  ds_read_b128 a[216:219], v23 offset:14336
  ds_read_b128 a[220:223], v23 offset:15360
  ds_read_b128 a[224:227], v23 offset:16384
  ds_read_b128 a[228:231], v23 offset:17408
  ds_read_b128 a[232:235], v23 offset:18432
  ds_read_b128 a[236:239], v23 offset:19456
  ds_read_b128 a[240:243], v23 offset:20480
  ds_read_b128 a[244:247], v23 offset:21504
  ds_read_b128 a[248:251], v23 offset:22528
  ds_read_b128 a[252:255], v23 offset:23552
mega_now3:
  ds_read_b128 v[72:75], v23 offset:24576
  ds_read_b128 v[76:79], v23 offset:25600
  ds_read_b128 v[80:83], v23 offset:26624
  ds_read_b128 v[84:87], v23 offset:27648
  ds_read_b128 v[88:91], v23 offset:28672
  ds_read_b128 v[92:95], v23 offset:29696
  ds_read_b128 v[96:99], v23 offset:30720
  ds_read_b128 v[100:103], v23 offset:31744
  ds_read_b128 v[104:107], v23 offset:32768
  ds_read_b128 v[108:111], v23 offset:33792
  ds_read_b128 v[112:115], v23 offset:34816
  ds_read_b128 v[116:119], v23 offset:35840
  ds_read_b128 v[120:123], v23 offset:36864
  ds_read_b128 v[124:127], v23 offset:37888
  ds_read_b128 v[128:131], v23 offset:38912
  ds_read_b128 v[132:135], v23 offset:39936
  v_lshlrev_b32 v10, 2, v17
  v_lshl_add_u32 v10, v18, 4, v10
  v_lshl_add_u32 v10, v19, 8, v10
  s_mul_i32 s27, s9, 40
  s_add_u32 s27, s27, 0
  v_add_u32 v20, s27, v16
  v_lshrrev_b32 v11, 4, v20
  v_lshlrev_b32 v11, 10, v11
  v_and_b32 v20, 15, v20
  v_lshl_add_u32 v11, v20, 4, v11
  v_lshl_add_u32 v11, v17, 8, v11
  s_mul_i32 s27, s9, 40
  s_add_u32 s27, s27, 32
  v_add_u32 v20, s27, v18
  v_lshrrev_b32 v68, 4, v20
  v_lshlrev_b32 v68, 10, v68
  v_and_b32 v20, 15, v20
  v_lshl_add_u32 v68, v20, 4, v68
  v_lshl_add_u32 v68, v17, 8, v68
  v_mul_u32_u24 v20, 40960, v19
  v_add_u32 v68, v68, v20
  v_and_b32 v20, 3, v1
  v_lshlrev_b32 v20, 7, v20
  s_lshl_b32 s27, s68, 9
  s_and_b32 s28, s9, 12
  s_add_u32 s27, s27, s28
  s_add_u32 s27, s27, 12288
  v_add_u32 v20, s27, v20
  s_add_u32 s27, s54, 0
  v_mov_b32 v21, s27
  v_and_b32 v12, 4, v1
  v_cmp_eq_u32 vcc, 0, v12
  s_nop 1
  v_cndmask_b32 v12, v21, v20, vcc
  v_cmp_gt_u32 vcc, 8, v1
  v_mov_b32 v0, 0x40000000
  s_nop 0
  v_cndmask_b32 v12, v0, v12, vcc
  v_mov_b32 v69, v21
  v_mov_b32 v70, v12
  s_waitcnt lgkmcnt(0)
  s_barrier
  ds_write_b128 v2, v[28:31] offset:37888
  ds_write_b128 v2, v[32:35] offset:38912
  ds_write_b128 v2, v[36:39] offset:39936
  s_waitcnt lgkmcnt(0)
  v_mov_b32 v0, 0xbdd53b95
  v_mov_b32 v28, 0
  v_mov_b32 v29, 0
  v_mov_b32 v30, 0
  v_mov_b32 v31, 0
  v_mov_b32 v32, 0
  v_mov_b32 v33, 0
  v_mov_b32 v34, 0
  v_mov_b32 v35, 0
  v_mov_b32 v36, 0
  v_mov_b32 v37, 0
  v_mov_b32 v38, 0
  v_mov_b32 v39, 0
  v_mov_b32 v40, 0
  v_mov_b32 v41, 0
  v_mov_b32 v42, 0
  v_mov_b32 v43, 0
  v_mov_b32 v44, 0
  v_mov_b32 v45, 0
  v_mov_b32 v46, 0
  v_mov_b32 v47, 0
  v_mov_b32 v48, 0
  v_mov_b32 v49, 0
  v_mov_b32 v50, 0
  v_mov_b32 v51, 0
  v_mov_b32 v52, 0
  v_mov_b32 v53, 0
  v_mov_b32 v54, 0
  v_mov_b32 v55, 0
  v_mov_b32 v56, 0
  v_mov_b32 v57, 0
  v_mov_b32 v58, 0
  v_mov_b32 v59, 0
  v_mov_b32 v60, 0
  v_mov_b32 v61, 0
  v_mov_b32 v62, 0
  v_mov_b32 v63, 0
  v_mov_b32 v64, 0
  v_mov_b32 v65, 0
  v_mov_b32 v66, 0
  v_mov_b32 v67, 0
  s_add_u32 s13, s17, 8192
  s_add_u32 s14, s17, 7168
  s_add_u32 s29, s12, 1
  s_cmp_lt_u32 s76, s29
  s_cbranch_scc1 mega_kernel_sd46_wait
mega_kernel_sd46_go:
  s_mov_b32 m0, 34816
  s_add_u32 s27, s22, 0
  buffer_load_dwordx4 v2, s[4:7], s27 offen offset:0 sc1 lds
  s_add_u32 s27, s22, 3072
  buffer_load_dwordx4 v2, s[4:7], s27 offen offset:1024 sc1 lds
  s_add_u32 s27, s22, 6144
  buffer_load_dwordx4 v2, s[4:7], s27 offen offset:2048 sc1 lds
  s_cmp_eq_u32 s69, 0
  s_cbranch_scc1 mega_loop3
  s_branch mega_loop7
mega_loop0:
  buffer_load_dwordx4 v[16:19], v2, s[4:7], s13 offen offset:0 sc1
  buffer_load_dwordx4 v[20:23], v2, s[4:7], s13 offen offset:1024 sc1
  buffer_load_dwordx4 v[24:27], v2, s[4:7], s14 offen offset:0 sc1
  s_xor_b32 s16, s16, s17
  s_xor_b32 s17, s17, s16
  s_xor_b32 s16, s16, s17
  s_mov_b32 m0, 0
  s_add_u32 s39, s39, 1
  s_and_b32 s27, s39, 7
  s_mul_i32 s27, s27, 163840
  s_add_u32 s37, s32, s27
  s_add_u32 s33, s30, s27
  s_nop 15
  s_nop 14
  buffer_load_dwordx4 v[16:19], v2, s[4:7], s13 offen offset:0 sc1
  buffer_load_dwordx4 v[20:23], v2, s[4:7], s13 offen offset:1024 sc1
  buffer_load_dwordx4 v[24:27], v2, s[4:7], s14 offen offset:0 sc1
mega_loop0_pc2:
  s_waitcnt vmcnt(3)
  v_max3_u32 v14, v16, v17, v18
  v_max3_u32 v14, v14, v19, v20
  v_smfmac_f32_16x16x64_bf16 v[28:31], v[16:19], v[136:143], v9
  v_max3_u32 v14, v14, v21, v22
  v_max3_u32 v14, v14, v23, v24
  v_smfmac_f32_16x16x64_bf16 v[32:35], v[16:19], v[144:151], v9
  v_max3_u32 v14, v14, v25, v26
  v_max_u32 v14, v14, v27
  v_smfmac_f32_16x16x64_bf16 v[28:31], v[20:23], v[152:159], v9
  v_cmp_eq_u32 vcc, -1, v14
  v_smfmac_f32_16x16x64_bf16 v[32:35], v[20:23], v[160:167], v9
  s_cbranch_vccnz mega_loop0_pcf
  v_smfmac_f32_16x16x64_bf16 v[28:31], v[24:27], v[168:175], v9
  ds_write_b128 v2, v[16:19] offset:0
  v_smfmac_f32_16x16x64_bf16 v[32:35], v[24:27], v[176:183], v9
  ds_write_b128 v2, v[20:23] offset:1024
  v_smfmac_f32_16x16x64_bf16 v[36:39], v[16:19], v[184:191], v9
  ds_write_b128 v2, v[24:27] offset:2048
  v_smfmac_f32_16x16x64_bf16 v[40:43], v[16:19], v[192:199], v9
  v_add_f32 v28, v28, v30
  v_smfmac_f32_16x16x64_bf16 v[36:39], v[20:23], v[200:207], v9
  v_add_f32 v29, v29, v31
  v_cvt_pk_bf16_f32 v30, v28, v29
  v_smfmac_f32_16x16x64_bf16 v[40:43], v[20:23], v[208:215], v9
  v_add_f32 v32, v32, v34
  v_smfmac_f32_16x16x64_bf16 v[36:39], v[24:27], v[216:223], v9
  v_add_f32 v33, v33, v35
  v_cvt_pk_bf16_f32 v31, v32, v33
  v_smfmac_f32_16x16x64_bf16 v[44:47], v[16:19], v[224:231], v9
  ds_write_b64 v3, v[30:31] offset:10240
  v_smfmac_f32_16x16x64_bf16 v[48:51], v[16:19], v[232:239], v9
  s_nop 0
  v_add_f32 v36, v36, v38
  v_smfmac_f32_16x16x64_bf16 v[44:47], v[20:23], v[240:247], v9
  v_add_f32 v37, v37, v39
  v_cvt_pk_bf16_f32 v38, v36, v37
  v_smfmac_f32_16x16x64_bf16 v[48:51], v[20:23], v[248:255], v9
  v_add_f32 v40, v40, v42
  v_add_f32 v41, v41, v43
  v_cvt_pk_bf16_f32 v39, v40, v41
  ds_write_b64 v3, v[38:39] offset:12288
  s_nop 0
  v_add_f32 v44, v44, v46
  v_add_f32 v45, v45, v47
  v_cvt_pk_bf16_f32 v46, v44, v45
  v_add_f32 v48, v48, v50
  v_add_f32 v49, v49, v51
  v_cvt_pk_bf16_f32 v47, v48, v49
  ds_write_b64 v3, v[46:47] offset:14336
  v_smfmac_f32_16x16x64_bf16 v[52:55], v[16:19], a[0:7], v9
  v_smfmac_f32_16x16x64_bf16 v[56:59], v[16:19], a[80:87], v9
  v_smfmac_f32_16x16x64_bf16 v[52:55], v[20:23], a[8:15], v9
  s_waitcnt lgkmcnt(0)
  s_barrier
  ds_read_b128 v[28:31], v2 offset:10240
  ds_read_b128 v[32:35], v2 offset:11264
  ds_read_b128 v[36:39], v2 offset:12288
  ds_read_b128 v[40:43], v2 offset:13312
  ds_read_b128 v[44:47], v2 offset:14336
  ds_read_b128 v[48:51], v2 offset:15360
  ds_read_b128 v[120:123], v11 offset:34816
  ds_read_b64 v[124:125], v11 offset:36864
  v_smfmac_f32_16x16x64_bf16 v[56:59], v[20:23], a[88:95], v9
  s_waitcnt lgkmcnt(7)
  v_mfma_f32_16x16x32_bf16 v[100:103], v[28:31], a[172:175], 0
  ds_read_b128 v[72:75], v2 offset:3072
  s_waitcnt lgkmcnt(7)
  v_mfma_f32_16x16x32_bf16 v[100:103], v[32:35], a[172:175], v[100:103]
  ds_read_b128 v[76:79], v2 offset:4096
  s_waitcnt lgkmcnt(7)
  v_mfma_f32_16x16x32_bf16 v[104:107], v[36:39], a[172:175], 0
  ds_read_b128 v[80:83], v2 offset:5120
  s_waitcnt lgkmcnt(7)
  v_mfma_f32_16x16x32_bf16 v[104:107], v[40:43], a[172:175], v[104:107]
  ds_read_b128 v[84:87], v2 offset:6144
  s_waitcnt lgkmcnt(7)
  v_mfma_f32_16x16x32_bf16 v[108:111], v[44:47], a[172:175], 0
  v_cvt_pk_bf16_f32 v112, v100, v101
  v_cvt_pk_bf16_f32 v113, v102, v103
  s_waitcnt lgkmcnt(6)
  v_mfma_f32_16x16x32_bf16 v[108:111], v[48:51], a[172:175], v[108:111]
  s_nop 0
  v_cvt_pk_bf16_f32 v114, v104, v105
  v_cvt_pk_bf16_f32 v115, v106, v107
  s_waitcnt lgkmcnt(4)
  ds_read_b128 v[88:91], v2 offset:7168
  v_mfma_f32_16x16x32_bf16 v[128:131], v[120:123], v[112:115], 0
  ds_read_b128 v[92:95], v2 offset:8192
  ds_read_b128 v[96:99], v2 offset:9216
  v_cvt_pk_bf16_f32 v116, v108, v109
  v_cvt_pk_bf16_f32 v117, v110, v111
  s_nop 1
  v_mfma_f32_16x16x32_bf16 v[128:131], v[124:127], v[116:119], v[128:131]
  v_smfmac_f32_16x16x64_bf16 v[52:55], v[24:27], a[16:23], v9
  ds_read_b128 a[176:179], v2 offset:24576
  ds_read_b128 a[180:183], v2 offset:26624
  ds_read_b128 a[184:187], v2 offset:28672
  s_nop 1
  v_cvt_pk_bf16_f32 v68, v128, v129
  v_cvt_pk_bf16_f32 v69, v130, v131
  buffer_store_dwordx2 v[68:69], v10, s[4:7], s18 offen
  s_cmp_eq_u32 s12, 63
  s_cbranch_scc1 mega_loop0_last
  v_smfmac_f32_16x16x64_bf16 v[56:59], v[24:27], a[96:103], v9
  ds_read_b128 a[188:191], v2 offset:30720
  s_waitcnt lgkmcnt(4)
  buffer_store_dwordx2 v[132:133], v10, s[4:7], s19 offen
  v_smfmac_f32_16x16x64_bf16 v[52:55], v[72:75], a[24:31], v9
  v_smfmac_f32_16x16x64_bf16 v[56:59], v[72:75], a[104:111], v9
  v_smfmac_f32_16x16x64_bf16 v[52:55], v[76:79], a[32:39], v9
  v_smfmac_f32_16x16x64_bf16 v[56:59], v[76:79], a[112:119], v9
  v_smfmac_f32_16x16x64_bf16 v[52:55], v[80:83], a[40:47], v9
  v_smfmac_f32_16x16x64_bf16 v[56:59], v[80:83], a[120:127], v9
  v_smfmac_f32_16x16x64_bf16 v[52:55], v[84:87], a[48:55], v9
  v_smfmac_f32_16x16x64_bf16 v[56:59], v[84:87], a[128:135], v9
  v_smfmac_f32_16x16x64_bf16 v[52:55], v[88:91], a[56:63], v9
  v_smfmac_f32_16x16x64_bf16 v[56:59], v[88:91], a[136:143], v9
  buffer_load_dwordx4 v[16:19], v4, s[4:7], s20 offen sc1
  v_smfmac_f32_16x16x64_bf16 v[52:55], v[92:95], a[64:71], v9
  buffer_load_dwordx4 v[20:23], v4, s[4:7], s20 offen offset:256 sc1
  v_smfmac_f32_16x16x64_bf16 v[56:59], v[92:95], a[144:151], v9
  buffer_load_dwordx4 v[24:27], v5, s[4:7], s20 offen offset:512 sc1
  v_smfmac_f32_16x16x64_bf16 v[52:55], v[96:99], a[72:79], v9
  v_smfmac_f32_16x16x64_bf16 v[56:59], v[96:99], a[152:159], v9
  s_nop 4
  v_add_f32 v52, v52, v54
  v_add_f32 v53, v53, v55
  v_cvt_pk_bf16_f32 v52, v52, v53
  ds_write_b32 v8, v52 offset:21504
  v_add_f32 v56, v56, v58
  v_add_f32 v57, v57, v59
  v_cvt_pk_bf16_f32 v56, v56, v57
  ds_write_b32 v8, v56 offset:22528
mega_loop0_pa:
  buffer_load_dwordx4 v[16:19], v4, s[4:7], s20 offen sc1
  buffer_load_dwordx4 v[20:23], v4, s[4:7], s20 offen offset:256 sc1
  buffer_load_dwordx4 v[24:27], v5, s[4:7], s20 offen offset:512 sc1
  s_add_u32 s15, s15, 16384
  s_cbranch_scc1 mega_fail
  s_waitcnt vmcnt(3)
  v_max3_u32 v14, v16, v17, v18
  v_max3_u32 v14, v14, v19, v20
  v_mfma_f32_16x16x32_bf16 v[40:43], v[16:19], a[160:163], 0
  v_max3_u32 v14, v14, v21, v22
  v_max3_u32 v14, v14, v23, v24
  v_mfma_f32_16x16x32_bf16 v[40:43], v[20:23], a[164:167], v[40:43]
  v_max3_u32 v14, v14, v25, v26
  v_max_u32 v14, v14, v27
  v_mfma_f32_16x16x32_bf16 v[44:47], v[24:27], a[168:171], 0
  v_cmp_eq_u32 vcc, -1, v14
  s_nop 3
  v_max3_f32 v48, v40, v41, v42
  s_cbranch_vccnz mega_loop0_pa
  s_nop 0
  v_cndmask_b32 v44, v44, v45, s[42:43]
  v_max3_f32 v48, v48, v43, v44
  s_nop 1
  v_max_f32_dpp v48, v48, v48 quad_perm:[1,0,3,2] row_mask:0xf bank_mask:0xf
  s_nop 1
  v_max_f32_dpp v48, v48, v48 quad_perm:[2,3,0,1] row_mask:0xf bank_mask:0xf
  s_nop 1
  v_max_f32_dpp v48, v48, v48 row_half_mirror row_mask:0xf bank_mask:0xf
  v_mul_f32 v48, v0, v48
  v_pk_fma_f32 v[40:41], v[40:41], v[0:1], v[48:49] op_sel_hi:[1,0,0] neg_lo:[0,1,0] neg_hi:[0,1,0]
  v_pk_fma_f32 v[42:43], v[42:43], v[0:1], v[48:49] op_sel_hi:[1,0,0] neg_lo:[0,1,0] neg_hi:[0,1,0]
  v_fma_f32 v44, v44, -v0, v48
  v_exp_f32 v40, v40
  v_exp_f32 v41, v41
  v_exp_f32 v42, v42
  v_exp_f32 v43, v43
  v_exp_f32 v44, v44
  v_pk_add_f32 v[48:49], v[40:41], v[42:43]
  v_add_f32 v48, v48, v49
  v_add_f32 v48, v48, v44
  s_nop 1
  v_add_f32_dpp v48, v48, v48 quad_perm:[1,0,3,2] row_mask:0xf bank_mask:0xf
  s_nop 1
  v_add_f32_dpp v48, v48, v48 quad_perm:[2,3,0,1] row_mask:0xf bank_mask:0xf
  s_nop 1
  v_add_f32_dpp v48, v48, v48 row_half_mirror row_mask:0xf bank_mask:0xf
  v_rcp_f32 v48, v48
  s_nop 0
  v_pk_mul_f32 v[40:41], v[40:41], v[48:49] op_sel_hi:[1,0]
  v_pk_mul_f32 v[42:43], v[42:43], v[48:49] op_sel_hi:[1,0]
  v_mul_f32 v44, v44, v48
  v_cvt_pk_bf16_f32 v40, v40, v41
  v_cvt_pk_bf16_f32 v41, v42, v43
  ds_write_b64 v6, v[40:41] offset:16384
  v_cvt_pk_bf16_f32 v44, v44, v44
  ds_write_b16 v7, v44 offset:20480
  s_cmp_eq_u32 s12, 0
  s_cbranch_scc1 mega_loop0_first
mega_loop0_fb:
  s_waitcnt lgkmcnt(0)
  s_barrier
  ds_read_b128 v[72:75], v12 offset:16384
  ds_read_b128 v[76:79], v12 offset:17408
  ds_read_b128 v[80:83], v12 offset:18432
  ds_read_b128 v[84:87], v12 offset:19456
  ds_read_b128 v[88:91], v12 offset:20480
  ds_read_b128 v[92:95], v13 offset:21504
  s_waitcnt lgkmcnt(5)
  v_mfma_f32_16x16x32_bf16 v[128:131], a[176:179], v[72:75], 0
  s_waitcnt lgkmcnt(4)
  v_mfma_f32_16x16x32_bf16 v[128:131], a[180:183], v[76:79], v[128:131]
  s_waitcnt lgkmcnt(3)
  v_mfma_f32_16x16x32_bf16 v[128:131], a[184:187], v[80:83], v[128:131]
  s_waitcnt lgkmcnt(2)
  v_mfma_f32_16x16x32_bf16 v[128:131], a[188:191], v[84:87], v[128:131]
  s_waitcnt lgkmcnt(0)
  v_mfma_f32_16x16x32_bf16 v[128:131], v[92:95], v[88:91], v[128:131]
  v_mov_b32 v28, 0
  v_mov_b32 v29, 0
  v_mov_b32 v30, 0
  v_mov_b32 v31, 0
  v_mov_b32 v32, 0
  v_mov_b32 v33, 0
  v_mov_b32 v34, 0
  s_nop 0
  v_cvt_pk_bf16_f32 v68, v128, v129
  v_cvt_pk_bf16_f32 v70, v128, v129
  v_cvt_pk_bf16_f32 v69, v130, v131
  v_cvt_pk_bf16_f32 v71, v130, v131
  v_permlane16_swap_b32 v68, v70
  s_nop 0
  v_permlane16_swap_b32 v69, v71
  buffer_store_dwordx4 v[68:71], v61, s[4:7], s33 offen sc1
  buffer_store_dwordx4 v[68:71], v134, s[4:7], s33 offen sc1
  v_mov_b32 v35, 0
  v_mov_b32 v36, 0
  v_mov_b32 v37, 0
  v_mov_b32 v38, 0
  v_mov_b32 v39, 0
  v_mov_b32 v40, 0
  v_mov_b32 v41, 0
  v_mov_b32 v42, 0
  v_mov_b32 v43, 0
  v_mov_b32 v44, 0
  v_mov_b32 v45, 0
  v_mov_b32 v46, 0
  v_mov_b32 v47, 0
  v_mov_b32 v48, 0
  v_mov_b32 v49, 0
  v_mov_b32 v50, 0
  v_mov_b32 v51, 0
  v_mov_b32 v52, 0
  v_mov_b32 v53, 0
  v_mov_b32 v54, 0
  v_mov_b32 v55, 0
  v_mov_b32 v56, 0
  v_mov_b32 v57, 0
  v_mov_b32 v58, 0
  v_mov_b32 v59, 0
  s_xor_b32 s18, s18, s19
  s_xor_b32 s19, s19, s18
  s_xor_b32 s18, s18, s19
  s_xor_b32 s20, s20, s21
  s_xor_b32 s21, s21, s20
  s_xor_b32 s20, s20, s21
  s_add_u32 s72, s72, 1
  s_cmp_eq_u32 s72, 4
  s_cselect_b32 s72, 0, s72
  s_mov_b32 s73, 325632
  s_cselect_b32 s73, 0xfff11800, s73
  s_add_u32 s23, s23, s73
  s_mov_b32 s15, 0
  s_add_u32 s13, s17, 0
  s_add_u32 s14, s17, 2048
  s_nop 15
  s_nop 15
  s_nop 15
  s_nop 15
  s_nop 15
  s_nop 15
  buffer_load_dwordx4 v[96:99], v62, s[4:7], s37 offen offset:0 sc1
  buffer_load_dwordx4 v[100:103], v62, s[4:7], s37 offen offset:1024 sc1
  s_barrier
  buffer_store_dwordx4 v[92:95], v66, s[4:7], s25 offen
  s_add_u32 s25, s25, s73
  s_add_u32 s12, s12, 1
  s_waitcnt vmcnt(1)
  v_mfma_f32_16x16x32_bf16 v[128:131], a[160:163], v[96:99], 0
  v_max3_u32 v14, v96, v97, v98
  v_max3_u32 v14, v14, v99, v100
  v_mfma_f32_16x16x32_bf16 v[128:131], a[160:163], v[100:103], v[128:131]
  v_max3_u32 v14, v14, v101, v102
  v_max_u32 v14, v14, v103
  v_cmp_eq_u32 vcc, -1, v14
  s_nop 4
  v_cvt_pk_bf16_f32 v68, v128, v129
  v_cvt_pk_bf16_f32 v69, v130, v131
  s_cbranch_vccnz mega_loop0_pbf
mega_loop0_pbok:
  buffer_store_dwordx2 v[68:69], v63, s[4:7], s17 offen
  buffer_store_dwordx2 v[132:133], v63, s[4:7], s16 offen
  s_barrier
  s_nop 15
  s_nop 15
  s_branch mega_loop0
mega_kernel_cf43:
  s_cmp_lg_u32 s3, 0
  s_cbranch_scc1 mega_kernel_cf43_b
  s_mul_i32 s28, s69, 31
  s_cmp_eq_u32 s27, s28
  s_cselect_b32 s27, 0, 256
  s_lshl_b32 s27, s27, s68
  s_add_u32 s27, s27, 1
  s_mov_b64 exec, 1
  v_mov_b32 v88, s27
  s_nop 0
  v_readfirstlane_b32 s28, v88
  v_mov_b32 v89, 32
  buffer_atomic_add v88, v89, s[44:47], 0 offen sc0 sc1
  s_waitcnt vmcnt(0)
  v_add_u32 v88, s28, v88
  s_nop 0
  v_readfirstlane_b32 s28, v88
  s_nop 0
  s_and_b32 s28, s28, 255
  s_cmp_eq_u32 s28, 8
  s_cbranch_scc0 mega_kernel_la44
  buffer_store_dword v88, v89, s[44:47], 0 offen offset:96 sc1
  s_waitcnt vmcnt(0)
mega_kernel_la44:
  s_mov_b64 exec, -1
  s_branch mega_kernel_cf43_b
mega_kernel_sd46_wait:
  s_mov_b32 s15, 0
mega_kernel_sd46_w2:
  buffer_load_dword v13, v69, s[4:7], s71 offen sc1
  s_waitcnt vmcnt(0)
  v_min_u32_dpp v13, v13, v13 quad_perm:[1,0,3,2] row_mask:0xf bank_mask:0xf
  s_nop 1
  v_min_u32_dpp v13, v13, v13 quad_perm:[2,3,0,1] row_mask:0xf bank_mask:0xf
  s_nop 1
  v_min_u32_dpp v13, v13, v13 row_half_mirror row_mask:0xf bank_mask:0xf
  s_nop 0
  v_readfirstlane_b32 s76, v13
  s_nop 0
  s_cmp_ge_u32 s76, s29
  s_cbranch_scc1 mega_kernel_sd46_go
  s_sleep 1
  s_add_u32 s15, s15, 1
  s_cmp_lt_u32 s15, 262144
  s_cbranch_scc1 mega_kernel_sd46_w2
  s_branch mega_fail
mega_loop0_pcf:
  buffer_load_dwordx4 v[16:19], v2, s[4:7], s13 offen offset:0 sc1
  buffer_load_dwordx4 v[20:23], v2, s[4:7], s13 offen offset:1024 sc1
  buffer_load_dwordx4 v[24:27], v2, s[4:7], s14 offen offset:0 sc1
  s_nop 0
  v_mov_b32 v28, 0
  v_mov_b32 v29, 0
  v_mov_b32 v30, 0
  v_mov_b32 v31, 0
  v_mov_b32 v32, 0
  v_mov_b32 v33, 0
  v_mov_b32 v34, 0
  v_mov_b32 v35, 0
  s_add_u32 s15, s15, 16384
  s_cbranch_scc1 mega_fail
  s_branch mega_loop0_pc2
mega_loop0_last:
  v_smfmac_f32_16x16x64_bf16 v[56:59], v[24:27], a[96:103], v9
  ds_read_b128 a[188:191], v2 offset:30720
  s_waitcnt lgkmcnt(4)
  buffer_store_dwordx2 v[132:133], v10, s[4:7], s19 offen
  v_smfmac_f32_16x16x64_bf16 v[52:55], v[72:75], a[24:31], v9
  v_smfmac_f32_16x16x64_bf16 v[56:59], v[72:75], a[104:111], v9
  v_smfmac_f32_16x16x64_bf16 v[52:55], v[76:79], a[32:39], v9
  v_smfmac_f32_16x16x64_bf16 v[56:59], v[76:79], a[112:119], v9
  v_smfmac_f32_16x16x64_bf16 v[52:55], v[80:83], a[40:47], v9
  v_smfmac_f32_16x16x64_bf16 v[56:59], v[80:83], a[120:127], v9
  v_smfmac_f32_16x16x64_bf16 v[52:55], v[84:87], a[48:55], v9
  v_smfmac_f32_16x16x64_bf16 v[56:59], v[84:87], a[128:135], v9
  v_smfmac_f32_16x16x64_bf16 v[52:55], v[88:91], a[56:63], v9
  v_smfmac_f32_16x16x64_bf16 v[56:59], v[88:91], a[136:143], v9
  v_smfmac_f32_16x16x64_bf16 v[52:55], v[92:95], a[64:71], v9
  v_smfmac_f32_16x16x64_bf16 v[56:59], v[92:95], a[144:151], v9
  v_smfmac_f32_16x16x64_bf16 v[52:55], v[96:99], a[72:79], v9
  v_smfmac_f32_16x16x64_bf16 v[56:59], v[96:99], a[152:159], v9
  s_nop 4
  v_add_f32 v52, v52, v54
  v_add_f32 v53, v53, v55
  v_cvt_pk_bf16_f32 v52, v52, v53
  ds_write_b32 v8, v52 offset:21504
  v_add_f32 v56, v56, v58
  v_add_f32 v57, v57, v59
  v_cvt_pk_bf16_f32 v56, v56, v57
  ds_write_b32 v8, v56 offset:22528
  s_waitcnt lgkmcnt(0)
  s_barrier
  ds_read_b128 v[92:95], v13 offset:21504
  s_waitcnt lgkmcnt(0)
  buffer_store_dwordx4 v[92:95], v66, s[4:7], s25 offen
  s_waitcnt vmcnt(0)
  s_barrier
  s_branch mega_bl
mega_loop0_first:
  s_barrier
  ds_read_b128 a[176:179], v2 offset:24576
  ds_read_b128 a[180:183], v2 offset:26624
  ds_read_b128 a[184:187], v2 offset:28672
  ds_read_b128 a[188:191], v2 offset:30720
  s_branch mega_loop0_fb
mega_loop0_pbf:
  buffer_load_dwordx4 v[96:99], v62, s[4:7], s37 offen offset:0 sc1
  buffer_load_dwordx4 v[100:103], v62, s[4:7], s37 offen offset:1024 sc1
mega_loop0_pbl:
  buffer_load_dwordx4 v[96:99], v62, s[4:7], s37 offen offset:0 sc1
  buffer_load_dwordx4 v[100:103], v62, s[4:7], s37 offen offset:1024 sc1
  s_add_u32 s15, s15, 16384
  s_cbranch_scc1 mega_fail
  s_waitcnt vmcnt(2)
  v_max3_u32 v14, v96, v97, v98
  v_max3_u32 v14, v14, v99, v100
  v_mfma_f32_16x16x32_bf16 v[128:131], a[160:163], v[96:99], 0
  v_max3_u32 v14, v14, v101, v102
  v_max_u32 v14, v14, v103
  v_mfma_f32_16x16x32_bf16 v[128:131], a[160:163], v[100:103], v[128:131]
  v_cmp_eq_u32 vcc, -1, v14
  s_nop 6
  v_cvt_pk_bf16_f32 v68, v128, v129
  v_cvt_pk_bf16_f32 v69, v130, v131
  s_cbranch_vccnz mega_loop0_pbl
  s_branch mega_loop0_pbok
mega_loop1:
  buffer_load_dwordx4 v[16:19], v2, s[4:7], s13 offen offset:0 sc1
  buffer_load_dwordx4 v[20:23], v2, s[4:7], s13 offen offset:1024 sc1
  buffer_load_dwordx4 v[24:27], v2, s[4:7], s14 offen offset:0 sc1
  s_xor_b32 s16, s16, s17
  s_xor_b32 s17, s17, s16
  s_xor_b32 s16, s16, s17
  s_mov_b32 m0, 3072
  s_add_u32 s39, s39, 1
  s_and_b32 s27, s39, 7
  s_mul_i32 s27, s27, 163840
  s_add_u32 s37, s32, s27
  s_add_u32 s33, s30, s27
  s_nop 15
  s_nop 14
  buffer_load_dwordx4 v[16:19], v2, s[4:7], s13 offen offset:0 sc1
  buffer_load_dwordx4 v[20:23], v2, s[4:7], s13 offen offset:1024 sc1
  buffer_load_dwordx4 v[24:27], v2, s[4:7], s14 offen offset:0 sc1
mega_loop1_pc2:
  s_waitcnt vmcnt(3)
  v_max3_u32 v14, v16, v17, v18
  v_max3_u32 v14, v14, v19, v20
  v_smfmac_f32_16x16x64_bf16 v[44:47], v[16:19], v[136:143], v9
  v_max3_u32 v14, v14, v21, v22
  v_max3_u32 v14, v14, v23, v24
  v_smfmac_f32_16x16x64_bf16 v[48:51], v[16:19], v[144:151], v9
  v_max3_u32 v14, v14, v25, v26
  v_max_u32 v14, v14, v27
  v_smfmac_f32_16x16x64_bf16 v[44:47], v[20:23], v[152:159], v9
  v_cmp_eq_u32 vcc, -1, v14
  v_smfmac_f32_16x16x64_bf16 v[48:51], v[20:23], v[160:167], v9
  s_cbranch_vccnz mega_loop1_pcf
  v_smfmac_f32_16x16x64_bf16 v[44:47], v[24:27], v[168:175], v9
  ds_write_b128 v2, v[16:19] offset:3072
  v_smfmac_f32_16x16x64_bf16 v[48:51], v[24:27], v[176:183], v9
  ds_write_b128 v2, v[20:23] offset:4096
  v_smfmac_f32_16x16x64_bf16 v[36:39], v[16:19], v[184:191], v9
  v_smfmac_f32_16x16x64_bf16 v[40:43], v[16:19], v[192:199], v9
  v_add_f32 v44, v44, v46
  v_smfmac_f32_16x16x64_bf16 v[36:39], v[20:23], v[200:207], v9
  v_add_f32 v45, v45, v47
  v_cvt_pk_bf16_f32 v46, v44, v45
  v_smfmac_f32_16x16x64_bf16 v[40:43], v[20:23], v[208:215], v9
  v_add_f32 v48, v48, v50
  v_smfmac_f32_16x16x64_bf16 v[40:43], v[24:27], v[216:223], v9
  v_add_f32 v49, v49, v51
  v_cvt_pk_bf16_f32 v47, v48, v49
  v_smfmac_f32_16x16x64_bf16 v[28:31], v[16:19], v[224:231], v9
  ds_write_b64 v3, v[46:47] offset:14336
  v_smfmac_f32_16x16x64_bf16 v[32:35], v[16:19], v[232:239], v9
  v_add_f32 v36, v36, v38
  v_smfmac_f32_16x16x64_bf16 v[28:31], v[20:23], v[240:247], v9
  v_add_f32 v37, v37, v39
  v_cvt_pk_bf16_f32 v38, v36, v37
  v_smfmac_f32_16x16x64_bf16 v[32:35], v[20:23], v[248:255], v9
  v_add_f32 v40, v40, v42
  v_add_f32 v41, v41, v43
  v_cvt_pk_bf16_f32 v39, v40, v41
  ds_write_b64 v3, v[38:39] offset:12288
  s_nop 0
  v_add_f32 v28, v28, v30
  v_add_f32 v29, v29, v31
  v_cvt_pk_bf16_f32 v30, v28, v29
  v_add_f32 v32, v32, v34
  v_add_f32 v33, v33, v35
  v_cvt_pk_bf16_f32 v31, v32, v33
  ds_write_b64 v3, v[30:31] offset:10240
  v_smfmac_f32_16x16x64_bf16 v[52:55], v[16:19], a[24:31], v9
  v_smfmac_f32_16x16x64_bf16 v[56:59], v[16:19], a[104:111], v9
  v_smfmac_f32_16x16x64_bf16 v[52:55], v[20:23], a[32:39], v9
  s_waitcnt lgkmcnt(0)
  s_barrier
  ds_read_b128 v[28:31], v2 offset:10240
  ds_read_b128 v[32:35], v2 offset:11264
  ds_read_b128 v[36:39], v2 offset:12288
  ds_read_b128 v[40:43], v2 offset:13312
  ds_read_b128 v[44:47], v2 offset:14336
  ds_read_b128 v[48:51], v2 offset:15360
  ds_read_b128 v[120:123], v11 offset:35840
  ds_read_b64 v[124:125], v11 offset:36872
  v_smfmac_f32_16x16x64_bf16 v[56:59], v[20:23], a[112:119], v9
  s_waitcnt lgkmcnt(7)
  v_mfma_f32_16x16x32_bf16 v[100:103], v[28:31], a[172:175], 0
  ds_read_b128 v[72:75], v2 offset:0
  s_waitcnt lgkmcnt(7)
  v_mfma_f32_16x16x32_bf16 v[100:103], v[32:35], a[172:175], v[100:103]
  ds_read_b128 v[76:79], v2 offset:1024
  s_waitcnt lgkmcnt(7)
  v_mfma_f32_16x16x32_bf16 v[104:107], v[36:39], a[172:175], 0
  ds_read_b128 v[80:83], v2 offset:5120
  s_waitcnt lgkmcnt(7)
  v_mfma_f32_16x16x32_bf16 v[104:107], v[40:43], a[172:175], v[104:107]
  ds_read_b128 v[84:87], v2 offset:6144
  s_waitcnt lgkmcnt(7)
  v_mfma_f32_16x16x32_bf16 v[108:111], v[44:47], a[172:175], 0
  v_cvt_pk_bf16_f32 v112, v100, v101
  v_cvt_pk_bf16_f32 v113, v102, v103
  s_waitcnt lgkmcnt(6)
  v_mfma_f32_16x16x32_bf16 v[108:111], v[48:51], a[172:175], v[108:111]
  s_nop 0
  v_cvt_pk_bf16_f32 v114, v104, v105
  v_cvt_pk_bf16_f32 v115, v106, v107
  s_waitcnt lgkmcnt(4)
  ds_read_b128 v[88:91], v2 offset:7168
  v_mfma_f32_16x16x32_bf16 v[128:131], v[120:123], v[112:115], 0
  ds_read_b128 v[92:95], v2 offset:8192
  ds_read_b128 v[96:99], v2 offset:9216
  v_cvt_pk_bf16_f32 v116, v108, v109
  v_cvt_pk_bf16_f32 v117, v110, v111
  s_nop 1
  v_mfma_f32_16x16x32_bf16 v[128:131], v[124:127], v[116:119], v[128:131]
  v_smfmac_f32_16x16x64_bf16 v[52:55], v[24:27], a[16:23], v9
  ds_read_b128 a[176:179], v2 offset:25600
  ds_read_b128 a[180:183], v2 offset:27648
  ds_read_b128 a[184:187], v2 offset:29696
  s_nop 1
  v_cvt_pk_bf16_f32 v68, v128, v129
  v_cvt_pk_bf16_f32 v69, v130, v131
  buffer_store_dwordx2 v[68:69], v10, s[4:7], s18 offen
  s_cmp_eq_u32 s12, 63
  s_cbranch_scc1 mega_loop1_last
  v_smfmac_f32_16x16x64_bf16 v[56:59], v[24:27], a[96:103], v9
  ds_read_b128 a[188:191], v2 offset:31744
  s_waitcnt lgkmcnt(4)
  buffer_store_dwordx2 v[132:133], v10, s[4:7], s19 offen
  v_smfmac_f32_16x16x64_bf16 v[52:55], v[72:75], a[0:7], v9
  v_smfmac_f32_16x16x64_bf16 v[56:59], v[72:75], a[80:87], v9
  v_smfmac_f32_16x16x64_bf16 v[52:55], v[76:79], a[8:15], v9
  v_smfmac_f32_16x16x64_bf16 v[56:59], v[76:79], a[88:95], v9
  v_smfmac_f32_16x16x64_bf16 v[52:55], v[80:83], a[40:47], v9
  v_smfmac_f32_16x16x64_bf16 v[56:59], v[80:83], a[120:127], v9
  v_smfmac_f32_16x16x64_bf16 v[52:55], v[84:87], a[48:55], v9
  v_smfmac_f32_16x16x64_bf16 v[56:59], v[84:87], a[128:135], v9
  v_smfmac_f32_16x16x64_bf16 v[52:55], v[88:91], a[56:63], v9
  v_smfmac_f32_16x16x64_bf16 v[56:59], v[88:91], a[136:143], v9
  buffer_load_dwordx4 v[16:19], v4, s[4:7], s20 offen sc1
  v_smfmac_f32_16x16x64_bf16 v[52:55], v[92:95], a[64:71], v9
  buffer_load_dwordx4 v[20:23], v4, s[4:7], s20 offen offset:256 sc1
  v_smfmac_f32_16x16x64_bf16 v[56:59], v[92:95], a[144:151], v9
  buffer_load_dwordx4 v[24:27], v5, s[4:7], s20 offen offset:512 sc1
  v_smfmac_f32_16x16x64_bf16 v[52:55], v[96:99], a[72:79], v9
  v_smfmac_f32_16x16x64_bf16 v[56:59], v[96:99], a[152:159], v9
  s_nop 4
  v_add_f32 v52, v52, v54
  v_add_f32 v53, v53, v55
  v_cvt_pk_bf16_f32 v52, v52, v53
  ds_write_b32 v8, v52 offset:21504
  v_add_f32 v56, v56, v58
  v_add_f32 v57, v57, v59
  v_cvt_pk_bf16_f32 v56, v56, v57
  ds_write_b32 v8, v56 offset:22528
mega_loop1_pa:
  buffer_load_dwordx4 v[16:19], v4, s[4:7], s20 offen sc1
  buffer_load_dwordx4 v[20:23], v4, s[4:7], s20 offen offset:256 sc1
  buffer_load_dwordx4 v[24:27], v5, s[4:7], s20 offen offset:512 sc1
  s_add_u32 s15, s15, 16384
  s_cbranch_scc1 mega_fail
  s_waitcnt vmcnt(3)
  v_max3_u32 v14, v16, v17, v18
  v_max3_u32 v14, v14, v19, v20
  v_mfma_f32_16x16x32_bf16 v[40:43], v[16:19], a[160:163], 0
  v_max3_u32 v14, v14, v21, v22
  v_max3_u32 v14, v14, v23, v24
  v_mfma_f32_16x16x32_bf16 v[40:43], v[20:23], a[164:167], v[40:43]
  v_max3_u32 v14, v14, v25, v26
  v_max_u32 v14, v14, v27
  v_mfma_f32_16x16x32_bf16 v[44:47], v[24:27], a[168:171], 0
  v_cmp_eq_u32 vcc, -1, v14
  s_nop 3
  v_max3_f32 v48, v40, v41, v42
  s_cbranch_vccnz mega_loop1_pa
  s_nop 0
  v_cndmask_b32 v44, v44, v45, s[42:43]
  v_max3_f32 v48, v48, v43, v44
  s_nop 1
  v_max_f32_dpp v48, v48, v48 quad_perm:[1,0,3,2] row_mask:0xf bank_mask:0xf
  s_nop 1
  v_max_f32_dpp v48, v48, v48 quad_perm:[2,3,0,1] row_mask:0xf bank_mask:0xf
  s_nop 1
  v_max_f32_dpp v48, v48, v48 row_half_mirror row_mask:0xf bank_mask:0xf
  v_mul_f32 v48, v0, v48
  v_pk_fma_f32 v[40:41], v[40:41], v[0:1], v[48:49] op_sel_hi:[1,0,0] neg_lo:[0,1,0] neg_hi:[0,1,0]
  v_pk_fma_f32 v[42:43], v[42:43], v[0:1], v[48:49] op_sel_hi:[1,0,0] neg_lo:[0,1,0] neg_hi:[0,1,0]
  v_fma_f32 v44, v44, -v0, v48
  v_exp_f32 v40, v40
  v_exp_f32 v41, v41
  v_exp_f32 v42, v42
  v_exp_f32 v43, v43
  v_exp_f32 v44, v44
  v_pk_add_f32 v[48:49], v[40:41], v[42:43]
  v_add_f32 v48, v48, v49
  v_add_f32 v48, v48, v44
  s_nop 1
  v_add_f32_dpp v48, v48, v48 quad_perm:[1,0,3,2] row_mask:0xf bank_mask:0xf
  s_nop 1
  v_add_f32_dpp v48, v48, v48 quad_perm:[2,3,0,1] row_mask:0xf bank_mask:0xf
  s_nop 1
  v_add_f32_dpp v48, v48, v48 row_half_mirror row_mask:0xf bank_mask:0xf
  v_rcp_f32 v48, v48
  s_nop 0
  v_pk_mul_f32 v[40:41], v[40:41], v[48:49] op_sel_hi:[1,0]
  v_pk_mul_f32 v[42:43], v[42:43], v[48:49] op_sel_hi:[1,0]
  v_mul_f32 v44, v44, v48
  v_cvt_pk_bf16_f32 v40, v40, v41
  v_cvt_pk_bf16_f32 v41, v42, v43
  ds_write_b64 v6, v[40:41] offset:16384
  v_cvt_pk_bf16_f32 v44, v44, v44
  ds_write_b16 v7, v44 offset:20480
  s_cmp_eq_u32 s12, 0
  s_cbranch_scc1 mega_loop1_first
mega_loop1_fb:
  s_waitcnt lgkmcnt(0)
  s_barrier
  ds_read_b128 v[72:75], v12 offset:16384
  ds_read_b128 v[76:79], v12 offset:17408
  ds_read_b128 v[80:83], v12 offset:18432
  ds_read_b128 v[84:87], v12 offset:19456
  ds_read_b128 v[88:91], v12 offset:20480
  ds_read_b128 v[92:95], v13 offset:21504
  s_waitcnt lgkmcnt(5)
  v_mfma_f32_16x16x32_bf16 v[128:131], a[176:179], v[72:75], 0
  s_waitcnt lgkmcnt(4)
  v_mfma_f32_16x16x32_bf16 v[128:131], a[180:183], v[76:79], v[128:131]
  s_waitcnt lgkmcnt(3)
  v_mfma_f32_16x16x32_bf16 v[128:131], a[184:187], v[80:83], v[128:131]
  s_waitcnt lgkmcnt(2)
  v_mfma_f32_16x16x32_bf16 v[128:131], a[188:191], v[84:87], v[128:131]
  s_waitcnt lgkmcnt(0)
  v_mfma_f32_16x16x32_bf16 v[128:131], v[92:95], v[88:91], v[128:131]
  v_mov_b32 v28, 0
  v_mov_b32 v29, 0
  v_mov_b32 v30, 0
  v_mov_b32 v31, 0
  v_mov_b32 v32, 0
  v_mov_b32 v33, 0
  v_mov_b32 v34, 0
  s_nop 0
  v_cvt_pk_bf16_f32 v68, v128, v129
  v_cvt_pk_bf16_f32 v70, v128, v129
  v_cvt_pk_bf16_f32 v69, v130, v131
  v_cvt_pk_bf16_f32 v71, v130, v131
  v_permlane16_swap_b32 v68, v70
  s_nop 0
  v_permlane16_swap_b32 v69, v71
  buffer_store_dwordx4 v[68:71], v61, s[4:7], s33 offen sc1
  buffer_store_dwordx4 v[68:71], v134, s[4:7], s33 offen sc1
  v_mov_b32 v35, 0
  v_mov_b32 v36, 0
  v_mov_b32 v37, 0
  v_mov_b32 v38, 0
  v_mov_b32 v39, 0
  v_mov_b32 v40, 0
  v_mov_b32 v41, 0
  v_mov_b32 v42, 0
  v_mov_b32 v43, 0
  v_mov_b32 v44, 0
  v_mov_b32 v45, 0
  v_mov_b32 v46, 0
  v_mov_b32 v47, 0
  v_mov_b32 v48, 0
  v_mov_b32 v49, 0
  v_mov_b32 v50, 0
  v_mov_b32 v51, 0
  v_mov_b32 v52, 0
  v_mov_b32 v53, 0
  v_mov_b32 v54, 0
  v_mov_b32 v55, 0
  v_mov_b32 v56, 0
  v_mov_b32 v57, 0
  v_mov_b32 v58, 0
  v_mov_b32 v59, 0
  s_xor_b32 s18, s18, s19
  s_xor_b32 s19, s19, s18
  s_xor_b32 s18, s18, s19
  s_xor_b32 s20, s20, s21
  s_xor_b32 s21, s21, s20
  s_xor_b32 s20, s20, s21
  s_add_u32 s72, s72, 1
  s_cmp_eq_u32 s72, 4
  s_cselect_b32 s72, 0, s72
  s_mov_b32 s73, 325632
  s_cselect_b32 s73, 0xfff11800, s73
  s_add_u32 s23, s23, s73
  s_mov_b32 s15, 0
  s_add_u32 s13, s17, 3072
  s_add_u32 s14, s17, 2048
  s_nop 15
  s_nop 15
  s_nop 15
  s_nop 15
  s_nop 15
  s_nop 15
  buffer_load_dwordx4 v[96:99], v62, s[4:7], s37 offen offset:0 sc1
  buffer_load_dwordx4 v[100:103], v62, s[4:7], s37 offen offset:1024 sc1
  s_barrier
  buffer_store_dwordx4 v[92:95], v66, s[4:7], s25 offen
  s_add_u32 s25, s25, s73
  s_add_u32 s12, s12, 1
  s_waitcnt vmcnt(1)
  v_mfma_f32_16x16x32_bf16 v[128:131], a[160:163], v[96:99], 0
  v_max3_u32 v14, v96, v97, v98
  v_max3_u32 v14, v14, v99, v100
  v_mfma_f32_16x16x32_bf16 v[128:131], a[160:163], v[100:103], v[128:131]
  v_max3_u32 v14, v14, v101, v102
  v_max_u32 v14, v14, v103
  v_cmp_eq_u32 vcc, -1, v14
  s_nop 4
  v_cvt_pk_bf16_f32 v68, v128, v129
  v_cvt_pk_bf16_f32 v69, v130, v131
  s_cbranch_vccnz mega_loop1_pbf
mega_loop1_pbok:
  buffer_store_dwordx2 v[68:69], v63, s[4:7], s17 offen
  buffer_store_dwordx2 v[132:133], v63, s[4:7], s16 offen
  s_barrier
  s_nop 15
  s_nop 15
  s_branch mega_loop1
mega_loop1_pcf:
  buffer_load_dwordx4 v[16:19], v2, s[4:7], s13 offen offset:0 sc1
  buffer_load_dwordx4 v[20:23], v2, s[4:7], s13 offen offset:1024 sc1
  buffer_load_dwordx4 v[24:27], v2, s[4:7], s14 offen offset:0 sc1
  s_nop 0
  v_mov_b32 v44, 0
  v_mov_b32 v45, 0
  v_mov_b32 v46, 0
  v_mov_b32 v47, 0
  v_mov_b32 v48, 0
  v_mov_b32 v49, 0
  v_mov_b32 v50, 0
  v_mov_b32 v51, 0
  s_add_u32 s15, s15, 16384
  s_cbranch_scc1 mega_fail
  s_branch mega_loop1_pc2
mega_loop1_last:
  v_smfmac_f32_16x16x64_bf16 v[56:59], v[24:27], a[96:103], v9
  ds_read_b128 a[188:191], v2 offset:31744
  s_waitcnt lgkmcnt(4)
  buffer_store_dwordx2 v[132:133], v10, s[4:7], s19 offen
  v_smfmac_f32_16x16x64_bf16 v[52:55], v[72:75], a[0:7], v9
  v_smfmac_f32_16x16x64_bf16 v[56:59], v[72:75], a[80:87], v9
  v_smfmac_f32_16x16x64_bf16 v[52:55], v[76:79], a[8:15], v9
  v_smfmac_f32_16x16x64_bf16 v[56:59], v[76:79], a[88:95], v9
  v_smfmac_f32_16x16x64_bf16 v[52:55], v[80:83], a[40:47], v9
  v_smfmac_f32_16x16x64_bf16 v[56:59], v[80:83], a[120:127], v9
  v_smfmac_f32_16x16x64_bf16 v[52:55], v[84:87], a[48:55], v9
  v_smfmac_f32_16x16x64_bf16 v[56:59], v[84:87], a[128:135], v9
  v_smfmac_f32_16x16x64_bf16 v[52:55], v[88:91], a[56:63], v9
  v_smfmac_f32_16x16x64_bf16 v[56:59], v[88:91], a[136:143], v9
  v_smfmac_f32_16x16x64_bf16 v[52:55], v[92:95], a[64:71], v9
  v_smfmac_f32_16x16x64_bf16 v[56:59], v[92:95], a[144:151], v9
  v_smfmac_f32_16x16x64_bf16 v[52:55], v[96:99], a[72:79], v9
  v_smfmac_f32_16x16x64_bf16 v[56:59], v[96:99], a[152:159], v9
  s_nop 4
  v_add_f32 v52, v52, v54
  v_add_f32 v53, v53, v55
  v_cvt_pk_bf16_f32 v52, v52, v53
  ds_write_b32 v8, v52 offset:21504
  v_add_f32 v56, v56, v58
  v_add_f32 v57, v57, v59
  v_cvt_pk_bf16_f32 v56, v56, v57
  ds_write_b32 v8, v56 offset:22528
  s_waitcnt lgkmcnt(0)
  s_barrier
  ds_read_b128 v[92:95], v13 offset:21504
  s_waitcnt lgkmcnt(0)
  buffer_store_dwordx4 v[92:95], v66, s[4:7], s25 offen
  s_waitcnt vmcnt(0)
  s_barrier
  s_branch mega_bl
mega_loop1_first:
  s_barrier
  ds_read_b128 a[176:179], v2 offset:25600
  ds_read_b128 a[180:183], v2 offset:27648
  ds_read_b128 a[184:187], v2 offset:29696
  ds_read_b128 a[188:191], v2 offset:31744
  s_branch mega_loop1_fb
mega_loop1_pbf:
  buffer_load_dwordx4 v[96:99], v62, s[4:7], s37 offen offset:0 sc1
  buffer_load_dwordx4 v[100:103], v62, s[4:7], s37 offen offset:1024 sc1
mega_loop1_pbl:
  buffer_load_dwordx4 v[96:99], v62, s[4:7], s37 offen offset:0 sc1
  buffer_load_dwordx4 v[100:103], v62, s[4:7], s37 offen offset:1024 sc1
  s_add_u32 s15, s15, 16384
  s_cbranch_scc1 mega_fail
  s_waitcnt vmcnt(2)
  v_max3_u32 v14, v96, v97, v98
  v_max3_u32 v14, v14, v99, v100
  v_mfma_f32_16x16x32_bf16 v[128:131], a[160:163], v[96:99], 0
  v_max3_u32 v14, v14, v101, v102
  v_max_u32 v14, v14, v103
  v_mfma_f32_16x16x32_bf16 v[128:131], a[160:163], v[100:103], v[128:131]
  v_cmp_eq_u32 vcc, -1, v14
  s_nop 6
  v_cvt_pk_bf16_f32 v68, v128, v129
  v_cvt_pk_bf16_f32 v69, v130, v131
  s_cbranch_vccnz mega_loop1_pbl
  s_branch mega_loop1_pbok
mega_loop2:
  buffer_load_dwordx4 v[16:19], v2, s[4:7], s13 offen offset:0 sc1
  buffer_load_dwordx4 v[20:23], v2, s[4:7], s13 offen offset:1024 sc1
  buffer_load_dwordx4 v[24:27], v2, s[4:7], s14 offen offset:0 sc1
  s_xor_b32 s16, s16, s17
  s_xor_b32 s17, s17, s16
  s_xor_b32 s16, s16, s17
  s_mov_b32 m0, 5120
  s_add_u32 s39, s39, 1
  s_and_b32 s27, s39, 7
  s_mul_i32 s27, s27, 163840
  s_add_u32 s37, s32, s27
  s_add_u32 s33, s30, s27
  s_nop 15
  s_nop 14
  buffer_load_dwordx4 v[16:19], v2, s[4:7], s13 offen offset:0 sc1
  buffer_load_dwordx4 v[20:23], v2, s[4:7], s13 offen offset:1024 sc1
  buffer_load_dwordx4 v[24:27], v2, s[4:7], s14 offen offset:0 sc1
mega_loop2_pc2:
  s_waitcnt vmcnt(3)
  v_max3_u32 v14, v16, v17, v18
  v_max3_u32 v14, v14, v19, v20
  v_smfmac_f32_16x16x64_bf16 v[28:31], v[16:19], v[136:143], v9
  v_max3_u32 v14, v14, v21, v22
  v_max3_u32 v14, v14, v23, v24
  v_smfmac_f32_16x16x64_bf16 v[32:35], v[16:19], v[144:151], v9
  v_max3_u32 v14, v14, v25, v26
  v_max_u32 v14, v14, v27
  v_smfmac_f32_16x16x64_bf16 v[28:31], v[20:23], v[152:159], v9
  v_cmp_eq_u32 vcc, -1, v14
  v_smfmac_f32_16x16x64_bf16 v[32:35], v[20:23], v[160:167], v9
  s_cbranch_vccnz mega_loop2_pcf
  v_smfmac_f32_16x16x64_bf16 v[28:31], v[24:27], v[168:175], v9
  ds_write_b128 v2, v[16:19] offset:5120
  v_smfmac_f32_16x16x64_bf16 v[32:35], v[24:27], v[176:183], v9
  ds_write_b128 v2, v[20:23] offset:6144
  v_smfmac_f32_16x16x64_bf16 v[36:39], v[16:19], v[184:191], v9
  ds_write_b128 v2, v[24:27] offset:7168
  v_smfmac_f32_16x16x64_bf16 v[40:43], v[16:19], v[192:199], v9
  v_add_f32 v28, v28, v30
  v_smfmac_f32_16x16x64_bf16 v[36:39], v[20:23], v[200:207], v9
  v_add_f32 v29, v29, v31
  v_cvt_pk_bf16_f32 v30, v28, v29
  v_smfmac_f32_16x16x64_bf16 v[40:43], v[20:23], v[208:215], v9
  v_add_f32 v32, v32, v34
  v_smfmac_f32_16x16x64_bf16 v[36:39], v[24:27], v[216:223], v9
  v_add_f32 v33, v33, v35
  v_cvt_pk_bf16_f32 v31, v32, v33
  v_smfmac_f32_16x16x64_bf16 v[44:47], v[16:19], v[224:231], v9
  ds_write_b64 v3, v[30:31] offset:10240
  v_smfmac_f32_16x16x64_bf16 v[48:51], v[16:19], v[232:239], v9
  s_nop 0
  v_add_f32 v36, v36, v38
  v_smfmac_f32_16x16x64_bf16 v[44:47], v[20:23], v[240:247], v9
  v_add_f32 v37, v37, v39
  v_cvt_pk_bf16_f32 v38, v36, v37
  v_smfmac_f32_16x16x64_bf16 v[48:51], v[20:23], v[248:255], v9
  v_add_f32 v40, v40, v42
  v_add_f32 v41, v41, v43
  v_cvt_pk_bf16_f32 v39, v40, v41
  ds_write_b64 v3, v[38:39] offset:12288
  s_nop 0
  v_add_f32 v44, v44, v46
  v_add_f32 v45, v45, v47
  v_cvt_pk_bf16_f32 v46, v44, v45
  v_add_f32 v48, v48, v50
  v_add_f32 v49, v49, v51
  v_cvt_pk_bf16_f32 v47, v48, v49
  ds_write_b64 v3, v[46:47] offset:14336
  v_smfmac_f32_16x16x64_bf16 v[52:55], v[16:19], a[40:47], v9
  v_smfmac_f32_16x16x64_bf16 v[56:59], v[16:19], a[120:127], v9
  v_smfmac_f32_16x16x64_bf16 v[52:55], v[20:23], a[48:55], v9
  s_waitcnt lgkmcnt(0)
  s_barrier
  ds_read_b128 v[28:31], v2 offset:10240
  ds_read_b128 v[32:35], v2 offset:11264
  ds_read_b128 v[36:39], v2 offset:12288
  ds_read_b128 v[40:43], v2 offset:13312
  ds_read_b128 v[44:47], v2 offset:14336
  ds_read_b128 v[48:51], v2 offset:15360
  v_smfmac_f32_16x16x64_bf16 v[56:59], v[20:23], a[128:135], v9
  s_waitcnt lgkmcnt(5)
  v_mfma_f32_16x16x32_bf16 v[100:103], v[28:31], a[172:175], 0
  ds_read_b128 v[72:75], v2 offset:0
  s_waitcnt lgkmcnt(5)
  v_mfma_f32_16x16x32_bf16 v[100:103], v[32:35], a[172:175], v[100:103]
  ds_read_b128 v[76:79], v2 offset:1024
  s_waitcnt lgkmcnt(5)
  v_mfma_f32_16x16x32_bf16 v[104:107], v[36:39], a[172:175], 0
  ds_read_b128 v[80:83], v2 offset:2048
  s_waitcnt lgkmcnt(5)
  v_mfma_f32_16x16x32_bf16 v[104:107], v[40:43], a[172:175], v[104:107]
  ds_read_b128 v[84:87], v2 offset:3072
  s_waitcnt lgkmcnt(5)
  v_mfma_f32_16x16x32_bf16 v[108:111], v[44:47], a[172:175], 0
  v_cvt_pk_bf16_f32 v112, v100, v101
  v_cvt_pk_bf16_f32 v113, v102, v103
  s_waitcnt lgkmcnt(4)
  v_mfma_f32_16x16x32_bf16 v[108:111], v[48:51], a[172:175], v[108:111]
  s_nop 0
  v_cvt_pk_bf16_f32 v114, v104, v105
  v_cvt_pk_bf16_f32 v115, v106, v107
  s_waitcnt lgkmcnt(4)
  ds_read_b128 v[88:91], v2 offset:4096
  v_mfma_f32_16x16x32_bf16 v[128:131], v[112:115], v[112:115], 0
  ds_read_b128 v[92:95], v2 offset:8192
  ds_read_b128 v[96:99], v2 offset:9216
  v_cvt_pk_bf16_f32 v116, v108, v109
  v_cvt_pk_bf16_f32 v117, v110, v111
  s_nop 1
  v_mfma_f32_16x16x32_bf16 v[128:131], v[116:119], v[116:119], v[128:131]
  v_smfmac_f32_16x16x64_bf16 v[52:55], v[24:27], a[56:63], v9
  ds_read_b128 a[176:179], v12 offset:32768
  ds_read_b128 a[180:183], v12 offset:32896
  ds_read_b128 a[184:187], v12 offset:33792
  s_nop 1
  v_cvt_pk_bf16_f32 v68, v128, v129
  v_cvt_pk_bf16_f32 v69, v130, v131
  buffer_store_dwordx2 v[68:69], v10, s[4:7], s18 offen
  s_cmp_eq_u32 s12, 63
  s_cbranch_scc1 mega_loop2_last
  v_smfmac_f32_16x16x64_bf16 v[56:59], v[24:27], a[136:143], v9
  ds_read_b128 a[188:191], v12 offset:33920
  s_waitcnt lgkmcnt(4)
  buffer_store_dwordx4 v[112:115], v64, s[4:7], s23 offen
  v_smfmac_f32_16x16x64_bf16 v[52:55], v[72:75], a[0:7], v9
  buffer_store_dwordx2 v[116:117], v65, s[4:7], s23 offen
  v_smfmac_f32_16x16x64_bf16 v[56:59], v[72:75], a[80:87], v9
  buffer_store_dwordx2 v[132:133], v10, s[4:7], s19 offen
  v_smfmac_f32_16x16x64_bf16 v[52:55], v[76:79], a[8:15], v9
  v_smfmac_f32_16x16x64_bf16 v[56:59], v[76:79], a[88:95], v9
  v_smfmac_f32_16x16x64_bf16 v[52:55], v[80:83], a[16:23], v9
  v_smfmac_f32_16x16x64_bf16 v[56:59], v[80:83], a[96:103], v9
  v_smfmac_f32_16x16x64_bf16 v[52:55], v[84:87], a[24:31], v9
  v_smfmac_f32_16x16x64_bf16 v[56:59], v[84:87], a[104:111], v9
  v_smfmac_f32_16x16x64_bf16 v[52:55], v[88:91], a[32:39], v9
  v_smfmac_f32_16x16x64_bf16 v[56:59], v[88:91], a[112:119], v9
  buffer_load_dwordx4 v[16:19], v4, s[4:7], s20 offen sc1
  v_smfmac_f32_16x16x64_bf16 v[52:55], v[92:95], a[64:71], v9
  buffer_load_dwordx4 v[20:23], v4, s[4:7], s20 offen offset:256 sc1
  v_smfmac_f32_16x16x64_bf16 v[56:59], v[92:95], a[144:151], v9
  buffer_load_dwordx4 v[24:27], v5, s[4:7], s20 offen offset:512 sc1
  v_smfmac_f32_16x16x64_bf16 v[52:55], v[96:99], a[72:79], v9
  v_smfmac_f32_16x16x64_bf16 v[56:59], v[96:99], a[152:159], v9
  s_nop 4
  v_add_f32 v52, v52, v54
  v_add_f32 v53, v53, v55
  v_cvt_pk_bf16_f32 v52, v52, v53
  ds_write_b32 v8, v52 offset:21504
  v_add_f32 v56, v56, v58
  v_add_f32 v57, v57, v59
  v_cvt_pk_bf16_f32 v56, v56, v57
  ds_write_b32 v8, v56 offset:22528
mega_loop2_pa:
  buffer_load_dwordx4 v[16:19], v4, s[4:7], s20 offen sc1
  buffer_load_dwordx4 v[20:23], v4, s[4:7], s20 offen offset:256 sc1
  buffer_load_dwordx4 v[24:27], v5, s[4:7], s20 offen offset:512 sc1
  s_add_u32 s15, s15, 16384
  s_cbranch_scc1 mega_fail
  s_waitcnt vmcnt(3)
  v_max3_u32 v14, v16, v17, v18
  v_max3_u32 v14, v14, v19, v20
  v_mfma_f32_16x16x32_bf16 v[40:43], v[16:19], a[160:163], 0
  v_max3_u32 v14, v14, v21, v22
  v_max3_u32 v14, v14, v23, v24
  v_mfma_f32_16x16x32_bf16 v[40:43], v[20:23], a[164:167], v[40:43]
  v_max3_u32 v14, v14, v25, v26
  v_max_u32 v14, v14, v27
  v_mfma_f32_16x16x32_bf16 v[44:47], v[24:27], a[168:171], 0
  v_cmp_eq_u32 vcc, -1, v14
  s_nop 3
  v_max3_f32 v48, v40, v41, v42
  s_cbranch_vccnz mega_loop2_pa
  s_nop 0
  v_cndmask_b32 v44, v44, v45, s[42:43]
  v_max3_f32 v48, v48, v43, v44
  s_nop 1
  v_max_f32_dpp v48, v48, v48 quad_perm:[1,0,3,2] row_mask:0xf bank_mask:0xf
  s_nop 1
  v_max_f32_dpp v48, v48, v48 quad_perm:[2,3,0,1] row_mask:0xf bank_mask:0xf
  s_nop 1
  v_max_f32_dpp v48, v48, v48 row_half_mirror row_mask:0xf bank_mask:0xf
  v_mul_f32 v48, v0, v48
  v_pk_fma_f32 v[40:41], v[40:41], v[0:1], v[48:49] op_sel_hi:[1,0,0] neg_lo:[0,1,0] neg_hi:[0,1,0]
  v_pk_fma_f32 v[42:43], v[42:43], v[0:1], v[48:49] op_sel_hi:[1,0,0] neg_lo:[0,1,0] neg_hi:[0,1,0]
  v_fma_f32 v44, v44, -v0, v48
  v_exp_f32 v40, v40
  v_exp_f32 v41, v41
  v_exp_f32 v42, v42
  v_exp_f32 v43, v43
  v_exp_f32 v44, v44
  v_pk_add_f32 v[48:49], v[40:41], v[42:43]
  v_add_f32 v48, v48, v49
  v_add_f32 v48, v48, v44
  s_nop 1
  v_add_f32_dpp v48, v48, v48 quad_perm:[1,0,3,2] row_mask:0xf bank_mask:0xf
  s_nop 1
  v_add_f32_dpp v48, v48, v48 quad_perm:[2,3,0,1] row_mask:0xf bank_mask:0xf
  s_nop 1
  v_add_f32_dpp v48, v48, v48 row_half_mirror row_mask:0xf bank_mask:0xf
  v_rcp_f32 v48, v48
  s_nop 0
  v_pk_mul_f32 v[40:41], v[40:41], v[48:49] op_sel_hi:[1,0]
  v_pk_mul_f32 v[42:43], v[42:43], v[48:49] op_sel_hi:[1,0]
  v_mul_f32 v44, v44, v48
  v_cvt_pk_bf16_f32 v40, v40, v41
  v_cvt_pk_bf16_f32 v41, v42, v43
  ds_write_b64 v6, v[40:41] offset:16384
  v_cvt_pk_bf16_f32 v44, v44, v44
  ds_write_b16 v7, v44 offset:20480
  s_add_u32 s27, s12, 1
  v_mov_b32 v14, s27
  buffer_store_dword v14, v67, s[4:7], s77 offen offset:0
  s_cmp_eq_u32 s12, 0
  s_cbranch_scc1 mega_loop2_first
mega_loop2_fb:
  s_waitcnt lgkmcnt(0)
  s_barrier
  ds_read_b128 v[72:75], v12 offset:16384
  ds_read_b128 v[76:79], v12 offset:17408
  ds_read_b128 v[80:83], v12 offset:18432
  ds_read_b128 v[84:87], v12 offset:19456
  ds_read_b128 v[88:91], v12 offset:20480
  ds_read_b128 v[92:95], v13 offset:21504
  s_waitcnt lgkmcnt(5)
  v_mfma_f32_16x16x32_bf16 v[128:131], a[176:179], v[72:75], 0
  s_waitcnt lgkmcnt(4)
  v_mfma_f32_16x16x32_bf16 v[128:131], a[180:183], v[76:79], v[128:131]
  s_waitcnt lgkmcnt(3)
  v_mfma_f32_16x16x32_bf16 v[128:131], a[184:187], v[80:83], v[128:131]
  s_waitcnt lgkmcnt(2)
  v_mfma_f32_16x16x32_bf16 v[128:131], a[188:191], v[84:87], v[128:131]
  s_waitcnt lgkmcnt(0)
  v_mfma_f32_16x16x32_bf16 v[128:131], v[92:95], v[88:91], v[128:131]
  v_mov_b32 v28, 0
  v_mov_b32 v29, 0
  v_mov_b32 v30, 0
  v_mov_b32 v31, 0
  v_mov_b32 v32, 0
  v_mov_b32 v33, 0
  v_mov_b32 v34, 0
  s_nop 0
  v_cvt_pk_bf16_f32 v68, v128, v129
  v_cvt_pk_bf16_f32 v69, v130, v131
  buffer_store_dwordx2 v[68:69], v61, s[4:7], s33 offen sc1
  buffer_store_dwordx2 v[68:69], v134, s[4:7], s33 offen sc1
  v_mov_b32 v35, 0
  v_mov_b32 v36, 0
  v_mov_b32 v37, 0
  v_mov_b32 v38, 0
  v_mov_b32 v39, 0
  v_mov_b32 v40, 0
  v_mov_b32 v41, 0
  v_mov_b32 v42, 0
  v_mov_b32 v43, 0
  v_mov_b32 v44, 0
  v_mov_b32 v45, 0
  v_mov_b32 v46, 0
  v_mov_b32 v47, 0
  v_mov_b32 v48, 0
  v_mov_b32 v49, 0
  v_mov_b32 v50, 0
  v_mov_b32 v51, 0
  v_mov_b32 v52, 0
  v_mov_b32 v53, 0
  v_mov_b32 v54, 0
  v_mov_b32 v55, 0
  v_mov_b32 v56, 0
  v_mov_b32 v57, 0
  v_mov_b32 v58, 0
  v_mov_b32 v59, 0
  s_xor_b32 s18, s18, s19
  s_xor_b32 s19, s19, s18
  s_xor_b32 s18, s18, s19
  s_xor_b32 s20, s20, s21
  s_xor_b32 s21, s21, s20
  s_xor_b32 s20, s20, s21
  s_add_u32 s72, s72, 1
  s_cmp_eq_u32 s72, 4
  s_cselect_b32 s72, 0, s72
  s_mov_b32 s73, 325632
  s_cselect_b32 s73, 0xfff11800, s73
  s_add_u32 s23, s23, s73
  s_mov_b32 s15, 0
  s_add_u32 s13, s17, 5120
  s_add_u32 s14, s17, 7168
  s_nop 15
  s_nop 15
  s_nop 15
  s_nop 15
  s_nop 15
  s_nop 15
  buffer_load_dwordx4 v[96:99], v62, s[4:7], s37 offen offset:0 sc1
  buffer_load_dwordx4 v[100:103], v62, s[4:7], s37 offen offset:512 sc1
  s_barrier
  buffer_store_dwordx4 v[92:95], v66, s[4:7], s25 offen
  s_add_u32 s25, s25, s73
  s_add_u32 s12, s12, 1
  s_waitcnt vmcnt(1)
  v_mfma_f32_16x16x32_bf16 v[128:131], a[160:163], v[96:99], 0
  v_max3_u32 v14, v96, v97, v98
  v_max3_u32 v14, v14, v99, v100
  v_mfma_f32_16x16x32_bf16 v[128:131], a[160:163], v[100:103], v[128:131]
  v_max3_u32 v14, v14, v101, v102
  v_max_u32 v14, v14, v103
  v_cmp_eq_u32 vcc, -1, v14
  s_nop 4
  v_cvt_pk_bf16_f32 v68, v128, v129
  v_cvt_pk_bf16_f32 v69, v130, v131
  s_cbranch_vccnz mega_loop2_pbf
mega_loop2_pbok:
  buffer_store_dwordx2 v[68:69], v63, s[4:7], s17 offen
  buffer_store_dwordx2 v[132:133], v63, s[4:7], s16 offen
  s_barrier
  s_nop 15
  s_nop 15
  s_branch mega_loop2
mega_loop2_pcf:
  buffer_load_dwordx4 v[16:19], v2, s[4:7], s13 offen offset:0 sc1
  buffer_load_dwordx4 v[20:23], v2, s[4:7], s13 offen offset:1024 sc1
  buffer_load_dwordx4 v[24:27], v2, s[4:7], s14 offen offset:0 sc1
  s_nop 0
  v_mov_b32 v28, 0
  v_mov_b32 v29, 0
  v_mov_b32 v30, 0
  v_mov_b32 v31, 0
  v_mov_b32 v32, 0
  v_mov_b32 v33, 0
  v_mov_b32 v34, 0
  v_mov_b32 v35, 0
  s_add_u32 s15, s15, 16384
  s_cbranch_scc1 mega_fail
  s_branch mega_loop2_pc2
mega_loop2_last:
  v_smfmac_f32_16x16x64_bf16 v[56:59], v[24:27], a[136:143], v9
  ds_read_b128 a[188:191], v12 offset:33920
  s_waitcnt lgkmcnt(4)
  buffer_store_dwordx4 v[112:115], v64, s[4:7], s23 offen
  v_smfmac_f32_16x16x64_bf16 v[52:55], v[72:75], a[0:7], v9
  buffer_store_dwordx2 v[116:117], v65, s[4:7], s23 offen
  v_smfmac_f32_16x16x64_bf16 v[56:59], v[72:75], a[80:87], v9
  s_nop 0
  v_smfmac_f32_16x16x64_bf16 v[52:55], v[76:79], a[8:15], v9
  s_nop 0
  v_smfmac_f32_16x16x64_bf16 v[56:59], v[76:79], a[88:95], v9
  s_nop 0
  v_smfmac_f32_16x16x64_bf16 v[52:55], v[80:83], a[16:23], v9
  s_nop 0
  v_smfmac_f32_16x16x64_bf16 v[56:59], v[80:83], a[96:103], v9
  s_nop 0
  v_smfmac_f32_16x16x64_bf16 v[52:55], v[84:87], a[24:31], v9
  s_nop 0
  v_smfmac_f32_16x16x64_bf16 v[56:59], v[84:87], a[104:111], v9
  s_nop 0
  v_smfmac_f32_16x16x64_bf16 v[52:55], v[88:91], a[32:39], v9
  s_nop 0
  v_smfmac_f32_16x16x64_bf16 v[56:59], v[88:91], a[112:119], v9
  s_waitcnt vmcnt(0)
  v_smfmac_f32_16x16x64_bf16 v[52:55], v[92:95], a[64:71], v9
  s_add_u32 s27, s12, 1
  v_smfmac_f32_16x16x64_bf16 v[56:59], v[92:95], a[144:151], v9
  v_mov_b32 v14, s27
  v_smfmac_f32_16x16x64_bf16 v[52:55], v[96:99], a[72:79], v9
  buffer_store_dword v14, v67, s[4:7], s77 offen offset:0
  v_smfmac_f32_16x16x64_bf16 v[56:59], v[96:99], a[152:159], v9
  s_nop 4
  v_add_f32 v52, v52, v54
  v_add_f32 v53, v53, v55
  v_cvt_pk_bf16_f32 v52, v52, v53
  ds_write_b32 v8, v52 offset:21504
  v_add_f32 v56, v56, v58
  v_add_f32 v57, v57, v59
  v_cvt_pk_bf16_f32 v56, v56, v57
  ds_write_b32 v8, v56 offset:22528
  s_waitcnt lgkmcnt(0)
  s_barrier
  ds_read_b128 v[92:95], v13 offset:21504
  s_waitcnt lgkmcnt(0)
  buffer_store_dwordx4 v[92:95], v66, s[4:7], s25 offen
  s_waitcnt vmcnt(0)
  s_barrier
  s_add_u32 s27, s12, 1
  v_mov_b32 v14, s27
  buffer_store_dword v14, v67, s[4:7], s77 offen offset:16
  s_branch mega_bl
mega_loop2_first:
  s_barrier
  ds_read_b128 a[176:179], v12 offset:32768
  ds_read_b128 a[180:183], v12 offset:32896
  ds_read_b128 a[184:187], v12 offset:33792
  ds_read_b128 a[188:191], v12 offset:33920
  s_branch mega_loop2_fb
mega_loop2_pbf:
  buffer_load_dwordx4 v[96:99], v62, s[4:7], s37 offen offset:0 sc1
  buffer_load_dwordx4 v[100:103], v62, s[4:7], s37 offen offset:512 sc1
mega_loop2_pbl:
  buffer_load_dwordx4 v[96:99], v62, s[4:7], s37 offen offset:0 sc1
  buffer_load_dwordx4 v[100:103], v62, s[4:7], s37 offen offset:512 sc1
  s_add_u32 s15, s15, 16384
  s_cbranch_scc1 mega_fail
  s_waitcnt vmcnt(2)
  v_max3_u32 v14, v96, v97, v98
  v_max3_u32 v14, v14, v99, v100
  v_mfma_f32_16x16x32_bf16 v[128:131], a[160:163], v[96:99], 0
  v_max3_u32 v14, v14, v101, v102
  v_max_u32 v14, v14, v103
  v_mfma_f32_16x16x32_bf16 v[128:131], a[160:163], v[100:103], v[128:131]
  v_cmp_eq_u32 vcc, -1, v14
  s_nop 6
  v_cvt_pk_bf16_f32 v68, v128, v129
  v_cvt_pk_bf16_f32 v69, v130, v131
  s_cbranch_vccnz mega_loop2_pbl
  s_branch mega_loop2_pbok
mega_loop3:
  buffer_load_dwordx4 v[16:19], v2, s[4:7], s13 offen offset:0 sc1
  buffer_load_dwordx4 v[20:23], v2, s[4:7], s13 offen offset:1024 sc1
  buffer_load_dwordx4 v[24:27], v2, s[4:7], s14 offen offset:0 sc1
  s_xor_b32 s16, s16, s17
  s_xor_b32 s17, s17, s16
  s_xor_b32 s16, s16, s17
  s_mov_b32 m0, 8192
  s_nop 15
  s_nop 15
  s_nop 3
  buffer_load_dwordx4 v[16:19], v2, s[4:7], s13 offen offset:0 sc1
  buffer_load_dwordx4 v[20:23], v2, s[4:7], s13 offen offset:1024 sc1
  buffer_load_dwordx4 v[24:27], v2, s[4:7], s14 offen offset:0 sc1
mega_loop3_pc2:
  s_waitcnt vmcnt(3)
  v_max3_u32 v14, v16, v17, v18
  v_max3_u32 v14, v14, v19, v20
  v_smfmac_f32_16x16x64_bf16 v[44:47], v[16:19], v[136:143], v9
  v_max3_u32 v14, v14, v21, v22
  v_max3_u32 v14, v14, v23, v24
  v_smfmac_f32_16x16x64_bf16 v[48:51], v[16:19], v[144:151], v9
  v_max3_u32 v14, v14, v25, v26
  v_max_u32 v14, v14, v27
  v_smfmac_f32_16x16x64_bf16 v[44:47], v[20:23], v[152:159], v9
  v_cmp_eq_u32 vcc, -1, v14
  v_smfmac_f32_16x16x64_bf16 v[48:51], v[20:23], v[160:167], v9
  s_cbranch_vccnz mega_loop3_pcf
  v_smfmac_f32_16x16x64_bf16 v[44:47], v[24:27], v[168:175], v9
  ds_write_b128 v2, v[16:19] offset:8192
  v_smfmac_f32_16x16x64_bf16 v[48:51], v[24:27], v[176:183], v9
  ds_write_b128 v2, v[20:23] offset:9216
  v_smfmac_f32_16x16x64_bf16 v[36:39], v[16:19], v[184:191], v9
  v_smfmac_f32_16x16x64_bf16 v[40:43], v[16:19], v[192:199], v9
  v_add_f32 v44, v44, v46
  v_smfmac_f32_16x16x64_bf16 v[36:39], v[20:23], v[200:207], v9
  v_add_f32 v45, v45, v47
  v_cvt_pk_bf16_f32 v46, v44, v45
  v_smfmac_f32_16x16x64_bf16 v[40:43], v[20:23], v[208:215], v9
  v_add_f32 v48, v48, v50
  v_smfmac_f32_16x16x64_bf16 v[40:43], v[24:27], v[216:223], v9
  v_add_f32 v49, v49, v51
  v_cvt_pk_bf16_f32 v47, v48, v49
  v_smfmac_f32_16x16x64_bf16 v[28:31], v[16:19], v[224:231], v9
  ds_write_b64 v3, v[46:47] offset:14336
  v_smfmac_f32_16x16x64_bf16 v[32:35], v[16:19], v[232:239], v9
  v_add_f32 v36, v36, v38
  v_smfmac_f32_16x16x64_bf16 v[28:31], v[20:23], v[240:247], v9
  v_add_f32 v37, v37, v39
  v_cvt_pk_bf16_f32 v38, v36, v37
  v_smfmac_f32_16x16x64_bf16 v[32:35], v[20:23], v[248:255], v9
  v_add_f32 v40, v40, v42
  v_add_f32 v41, v41, v43
  v_cvt_pk_bf16_f32 v39, v40, v41
  ds_write_b64 v3, v[38:39] offset:12288
  s_nop 0
  v_add_f32 v28, v28, v30
  v_add_f32 v29, v29, v31
  v_cvt_pk_bf16_f32 v30, v28, v29
  v_add_f32 v32, v32, v34
  v_add_f32 v33, v33, v35
  v_cvt_pk_bf16_f32 v31, v32, v33
  ds_write_b64 v3, v[30:31] offset:10240
  v_smfmac_f32_16x16x64_bf16 v[52:55], v[16:19], a[64:71], v9
  v_smfmac_f32_16x16x64_bf16 v[56:59], v[16:19], a[144:151], v9
  v_smfmac_f32_16x16x64_bf16 v[60:63], v[16:19], a[224:231], v9
  s_waitcnt lgkmcnt(0)
  s_barrier
  v_smfmac_f32_16x16x64_bf16 v[64:67], v[16:19], v[120:127], v9
  v_smfmac_f32_16x16x64_bf16 v[52:55], v[20:23], a[72:79], v9
  v_smfmac_f32_16x16x64_bf16 v[56:59], v[20:23], a[152:159], v9
  ds_read_b128 v[40:43], v2 offset:0
  v_smfmac_f32_16x16x64_bf16 v[60:63], v[20:23], a[232:239], v9
  ds_read_b128 v[28:31], v2 offset:1024
  v_smfmac_f32_16x16x64_bf16 v[64:67], v[20:23], v[128:135], v9
  ds_read_b128 v[32:35], v2 offset:2048
  v_smfmac_f32_16x16x64_bf16 v[52:55], v[24:27], a[56:63], v9
  ds_read_b128 v[36:39], v2 offset:3072
  v_smfmac_f32_16x16x64_bf16 v[56:59], v[24:27], a[136:143], v9
  ds_read_b128 v[44:47], v2 offset:4096
  v_smfmac_f32_16x16x64_bf16 v[60:63], v[24:27], a[216:223], v9
  ds_read_b128 v[48:51], v2 offset:5120
  v_smfmac_f32_16x16x64_bf16 v[64:67], v[24:27], v[112:119], v9
  s_cmp_eq_u32 s12, 63
  s_cbranch_scc1 mega_loop3_last
  s_waitcnt lgkmcnt(0)
  v_smfmac_f32_16x16x64_bf16 v[52:55], v[40:43], a[0:7], v9
  v_smfmac_f32_16x16x64_bf16 v[56:59], v[40:43], a[80:87], v9
  v_smfmac_f32_16x16x64_bf16 v[60:63], v[40:43], a[160:167], v9
  v_smfmac_f32_16x16x64_bf16 v[64:67], v[40:43], a[240:247], v9
  ds_read_b128 v[40:43], v2 offset:6144
  v_smfmac_f32_16x16x64_bf16 v[52:55], v[28:31], a[8:15], v9
  v_smfmac_f32_16x16x64_bf16 v[56:59], v[28:31], a[88:95], v9
  v_smfmac_f32_16x16x64_bf16 v[60:63], v[28:31], a[168:175], v9
  v_smfmac_f32_16x16x64_bf16 v[64:67], v[28:31], a[248:255], v9
  ds_read_b128 v[28:31], v2 offset:37888
  v_smfmac_f32_16x16x64_bf16 v[52:55], v[32:35], a[16:23], v9
  v_smfmac_f32_16x16x64_bf16 v[56:59], v[32:35], a[96:103], v9
  v_smfmac_f32_16x16x64_bf16 v[60:63], v[32:35], a[176:183], v9
  v_smfmac_f32_16x16x64_bf16 v[64:67], v[32:35], v[72:79], v9
  ds_read_b128 v[32:35], v2 offset:38912
  v_smfmac_f32_16x16x64_bf16 v[52:55], v[36:39], a[24:31], v9
  v_smfmac_f32_16x16x64_bf16 v[56:59], v[36:39], a[104:111], v9
  v_smfmac_f32_16x16x64_bf16 v[60:63], v[36:39], a[184:191], v9
  v_smfmac_f32_16x16x64_bf16 v[64:67], v[36:39], v[80:87], v9
  ds_read_b128 v[36:39], v2 offset:39936
  v_smfmac_f32_16x16x64_bf16 v[52:55], v[44:47], a[32:39], v9
  v_smfmac_f32_16x16x64_bf16 v[56:59], v[44:47], a[112:119], v9
  v_smfmac_f32_16x16x64_bf16 v[60:63], v[44:47], a[192:199], v9
  v_smfmac_f32_16x16x64_bf16 v[64:67], v[44:47], v[88:95], v9
  v_smfmac_f32_16x16x64_bf16 v[52:55], v[48:51], a[40:47], v9
  v_smfmac_f32_16x16x64_bf16 v[56:59], v[48:51], a[120:127], v9
  v_smfmac_f32_16x16x64_bf16 v[60:63], v[48:51], a[200:207], v9
  v_smfmac_f32_16x16x64_bf16 v[64:67], v[48:51], v[96:103], v9
  buffer_load_dword v13, v12, s[4:7], s71 offen sc1
  s_waitcnt lgkmcnt(3)
  v_smfmac_f32_16x16x64_bf16 v[52:55], v[40:43], a[48:55], v9
  buffer_load_dwordx4 v[16:19], v4, s[4:7], s20 offen sc1
  v_smfmac_f32_16x16x64_bf16 v[56:59], v[40:43], a[128:135], v9
  buffer_load_dwordx4 v[20:23], v4, s[4:7], s20 offen offset:256 sc1
  v_smfmac_f32_16x16x64_bf16 v[60:63], v[40:43], a[208:215], v9
  buffer_load_dwordx4 v[24:27], v5, s[4:7], s20 offen offset:512 sc1
  v_smfmac_f32_16x16x64_bf16 v[64:67], v[40:43], v[104:111], v9
  v_add_f32 v52, v52, v54
  v_add_f32 v53, v53, v55
  v_cvt_pk_bf16_f32 v52, v52, v53
  ds_write_b32 v8, v52 offset:21504
  v_add_f32 v56, v56, v58
  v_add_f32 v57, v57, v59
  v_cvt_pk_bf16_f32 v56, v56, v57
  ds_write_b32 v8, v56 offset:22528
  v_add_f32 v60, v60, v62
  v_add_f32 v61, v61, v63
  v_cvt_pk_bf16_f32 v60, v60, v61
  ds_write_b32 v10, v60 offset:23552
  v_add_f32 v64, v64, v66
  v_add_f32 v65, v65, v67
  v_cvt_pk_bf16_f32 v64, v64, v65
  ds_write_b32 v10, v64 offset:24064
mega_loop3_pa:
  buffer_load_dwordx4 v[16:19], v4, s[4:7], s20 offen sc1
  buffer_load_dwordx4 v[20:23], v4, s[4:7], s20 offen offset:256 sc1
  buffer_load_dwordx4 v[24:27], v5, s[4:7], s20 offen offset:512 sc1
  s_add_u32 s15, s15, 16384
  s_cbranch_scc1 mega_fail
  s_waitcnt vmcnt(3) lgkmcnt(0)
  v_max3_u32 v14, v16, v17, v18
  v_max3_u32 v14, v14, v19, v20
  v_mfma_f32_16x16x32_bf16 v[40:43], v[16:19], v[28:31], 0
  v_max3_u32 v14, v14, v21, v22
  v_max3_u32 v14, v14, v23, v24
  v_mfma_f32_16x16x32_bf16 v[40:43], v[20:23], v[32:35], v[40:43]
  v_max3_u32 v14, v14, v25, v26
  v_max_u32 v14, v14, v27
  v_mfma_f32_16x16x32_bf16 v[44:47], v[24:27], v[36:39], 0
  v_cmp_eq_u32 vcc, -1, v14
  s_nop 3
  v_max3_f32 v48, v40, v41, v42
  s_cbranch_vccnz mega_loop3_pa
  s_nop 0
  v_cndmask_b32 v44, v44, v45, s[42:43]
  v_max3_f32 v48, v48, v43, v44
  s_nop 1
  v_max_f32_dpp v48, v48, v48 quad_perm:[1,0,3,2] row_mask:0xf bank_mask:0xf
  s_nop 1
  v_max_f32_dpp v48, v48, v48 quad_perm:[2,3,0,1] row_mask:0xf bank_mask:0xf
  s_nop 1
  v_max_f32_dpp v48, v48, v48 row_half_mirror row_mask:0xf bank_mask:0xf
  v_mul_f32 v48, v0, v48
  v_pk_fma_f32 v[40:41], v[40:41], v[0:1], v[48:49] op_sel_hi:[1,0,0] neg_lo:[0,1,0] neg_hi:[0,1,0]
  v_pk_fma_f32 v[42:43], v[42:43], v[0:1], v[48:49] op_sel_hi:[1,0,0] neg_lo:[0,1,0] neg_hi:[0,1,0]
  v_fma_f32 v44, v44, -v0, v48
  v_exp_f32 v40, v40
  v_exp_f32 v41, v41
  v_exp_f32 v42, v42
  v_exp_f32 v43, v43
  v_exp_f32 v44, v44
  v_pk_add_f32 v[48:49], v[40:41], v[42:43]
  v_add_f32 v48, v48, v49
  v_add_f32 v48, v48, v44
  s_nop 1
  v_add_f32_dpp v48, v48, v48 quad_perm:[1,0,3,2] row_mask:0xf bank_mask:0xf
  s_nop 1
  v_add_f32_dpp v48, v48, v48 quad_perm:[2,3,0,1] row_mask:0xf bank_mask:0xf
  s_nop 1
  v_add_f32_dpp v48, v48, v48 row_half_mirror row_mask:0xf bank_mask:0xf
  v_rcp_f32 v48, v48
  s_nop 0
  v_pk_mul_f32 v[40:41], v[40:41], v[48:49] op_sel_hi:[1,0]
  v_pk_mul_f32 v[42:43], v[42:43], v[48:49] op_sel_hi:[1,0]
  v_mul_f32 v44, v44, v48
  v_cvt_pk_bf16_f32 v40, v40, v41
  v_cvt_pk_bf16_f32 v41, v42, v43
  ds_write_b64 v6, v[40:41] offset:16384
  v_cvt_pk_bf16_f32 v44, v44, v44
  ds_write_b16 v7, v44 offset:20480
  v_min_u32_dpp v13, v13, v13 quad_perm:[1,0,3,2] row_mask:0xf bank_mask:0xf
  s_nop 1
  v_min_u32_dpp v13, v13, v13 quad_perm:[2,3,0,1] row_mask:0xf bank_mask:0xf
  s_nop 1
  v_min_u32_dpp v13, v13, v13 row_half_mirror row_mask:0xf bank_mask:0xf
  s_nop 0
  v_readfirstlane_b32 s76, v13
  s_cmp_eq_u32 s12, 0
  s_cbranch_scc1 mega_loop3_first
mega_loop3_fb:
  s_waitcnt lgkmcnt(0)
  s_barrier
  v_mov_b32 v28, 0
  v_mov_b32 v29, 0
  v_mov_b32 v30, 0
  v_mov_b32 v31, 0
  v_mov_b32 v32, 0
  v_mov_b32 v33, 0
  v_mov_b32 v34, 0
  v_mov_b32 v35, 0
  v_mov_b32 v36, 0
  v_mov_b32 v37, 0
  v_mov_b32 v38, 0
  v_mov_b32 v39, 0
  v_mov_b32 v40, 0
  v_mov_b32 v41, 0
  v_mov_b32 v42, 0
  v_mov_b32 v43, 0
  v_mov_b32 v44, 0
  v_mov_b32 v45, 0
  v_mov_b32 v46, 0
  v_mov_b32 v47, 0
  v_mov_b32 v48, 0
  v_mov_b32 v49, 0
  v_mov_b32 v50, 0
  v_mov_b32 v51, 0
  v_mov_b32 v52, 0
  v_mov_b32 v53, 0
  v_mov_b32 v54, 0
  v_mov_b32 v55, 0
  v_mov_b32 v56, 0
  v_mov_b32 v57, 0
  v_mov_b32 v58, 0
  v_mov_b32 v59, 0
  v_mov_b32 v60, 0
  v_mov_b32 v61, 0
  v_mov_b32 v62, 0
  v_mov_b32 v63, 0
  v_mov_b32 v64, 0
  v_mov_b32 v65, 0
  v_mov_b32 v66, 0
  v_mov_b32 v67, 0
  s_xor_b32 s18, s18, s19
  s_xor_b32 s19, s19, s18
  s_xor_b32 s18, s18, s19
  s_xor_b32 s20, s20, s21
  s_xor_b32 s21, s21, s20
  s_xor_b32 s20, s20, s21
  s_mov_b32 s15, 0
  s_add_u32 s13, s17, 8192
  s_add_u32 s14, s17, 7168
  s_barrier
  s_add_u32 s29, s12, 2
  s_cmp_lt_u32 s76, s29
  s_cbranch_scc1 mega_kernel_sd49_wait
mega_kernel_sd49_go:
  s_mov_b32 m0, 24576
  s_add_u32 s27, s24, 0
  buffer_load_dwordx4 v11, s[4:7], s27 offen offset:0 sc1 lds
  buffer_load_dwordx4 v11, s[4:7], s27 offen offset:1024 sc1 lds
  s_mov_b32 m0, 32768
  s_nop 0
  buffer_load_dwordx4 v68, s[4:7], s27 offen sc1 lds
  s_mov_b32 m0, 26624
  s_add_u32 s27, s24, 40960
  buffer_load_dwordx4 v11, s[4:7], s27 offen offset:0 sc1 lds
  buffer_load_dwordx4 v11, s[4:7], s27 offen offset:1024 sc1 lds
  s_mov_b32 m0, 28672
  s_add_u32 s27, s24, 81920
  buffer_load_dwordx4 v11, s[4:7], s27 offen offset:0 sc1 lds
  buffer_load_dwordx4 v11, s[4:7], s27 offen offset:1024 sc1 lds
  s_mov_b32 m0, 33792
  s_nop 0
  buffer_load_dwordx4 v68, s[4:7], s27 offen sc1 lds
  s_mov_b32 m0, 30720
  s_add_u32 s27, s24, 122880
  buffer_load_dwordx4 v11, s[4:7], s27 offen offset:0 sc1 lds
  buffer_load_dwordx4 v11, s[4:7], s27 offen offset:1024 sc1 lds
  s_mov_b32 m0, 34816
  s_add_u32 s27, s22, 0
  buffer_load_dwordx4 v2, s[4:7], s27 offen offset:0 sc1 lds
  s_add_u32 s27, s22, 3072
  buffer_load_dwordx4 v2, s[4:7], s27 offen offset:1024 sc1 lds
  s_add_u32 s27, s22, 6144
  buffer_load_dwordx4 v2, s[4:7], s27 offen offset:2048 sc1 lds
  s_add_u32 s72, s72, 1
  s_cmp_eq_u32 s72, 4
  s_cselect_b32 s72, 0, s72
  s_mov_b32 s73, 325632
  s_cselect_b32 s73, 0xfff11800, s73
  s_add_u32 s22, s22, s73
  s_add_u32 s24, s24, s73
  s_cmp_eq_u32 s12, 61
  s_cselect_b64 vcc, -1, 0
  v_cndmask_b32 v12, v12, v69, vcc
  s_add_u32 s12, s12, 1
  s_barrier
  s_nop 15
  s_nop 15
  s_branch mega_loop3
mega_loop3_pcf:
  buffer_load_dwordx4 v[16:19], v2, s[4:7], s13 offen offset:0 sc1
  buffer_load_dwordx4 v[20:23], v2, s[4:7], s13 offen offset:1024 sc1
  buffer_load_dwordx4 v[24:27], v2, s[4:7], s14 offen offset:0 sc1
  s_nop 0
  v_mov_b32 v44, 0
  v_mov_b32 v45, 0
  v_mov_b32 v46, 0
  v_mov_b32 v47, 0
  v_mov_b32 v48, 0
  v_mov_b32 v49, 0
  v_mov_b32 v50, 0
  v_mov_b32 v51, 0
  s_add_u32 s15, s15, 16384
  s_cbranch_scc1 mega_fail
  s_branch mega_loop3_pc2
mega_kernel_sd47_wait:
  s_mov_b32 s15, 0
mega_kernel_sd47_w2:
  buffer_load_dword v13, v70, s[4:7], s71 offen sc1
  s_waitcnt vmcnt(0)
  v_min_u32_dpp v13, v13, v13 quad_perm:[1,0,3,2] row_mask:0xf bank_mask:0xf
  s_nop 1
  v_min_u32_dpp v13, v13, v13 quad_perm:[2,3,0,1] row_mask:0xf bank_mask:0xf
  s_nop 1
  v_min_u32_dpp v13, v13, v13 row_half_mirror row_mask:0xf bank_mask:0xf
  s_nop 0
  v_readfirstlane_b32 s76, v13
  s_nop 0
  s_cmp_ge_u32 s76, s29
  s_cbranch_scc1 mega_kernel_sd47_go
  s_sleep 1
  s_add_u32 s15, s15, 1
  s_cmp_lt_u32 s15, 262144
  s_cbranch_scc1 mega_kernel_sd47_w2
  s_branch mega_fail
mega_loop3_last:
  s_waitcnt lgkmcnt(0)
  v_smfmac_f32_16x16x64_bf16 v[52:55], v[40:43], a[0:7], v9
  v_smfmac_f32_16x16x64_bf16 v[56:59], v[40:43], a[80:87], v9
  v_smfmac_f32_16x16x64_bf16 v[60:63], v[40:43], a[160:167], v9
  v_smfmac_f32_16x16x64_bf16 v[64:67], v[40:43], a[240:247], v9
  ds_read_b128 v[40:43], v2 offset:6144
  v_smfmac_f32_16x16x64_bf16 v[52:55], v[28:31], a[8:15], v9
  v_smfmac_f32_16x16x64_bf16 v[56:59], v[28:31], a[88:95], v9
  v_smfmac_f32_16x16x64_bf16 v[60:63], v[28:31], a[168:175], v9
  v_smfmac_f32_16x16x64_bf16 v[64:67], v[28:31], a[248:255], v9
  ds_read_b128 v[28:31], v2 offset:37888
  v_smfmac_f32_16x16x64_bf16 v[52:55], v[32:35], a[16:23], v9
  v_smfmac_f32_16x16x64_bf16 v[56:59], v[32:35], a[96:103], v9
  v_smfmac_f32_16x16x64_bf16 v[60:63], v[32:35], a[176:183], v9
  v_smfmac_f32_16x16x64_bf16 v[64:67], v[32:35], v[72:79], v9
  ds_read_b128 v[32:35], v2 offset:38912
  v_smfmac_f32_16x16x64_bf16 v[52:55], v[36:39], a[24:31], v9
  v_smfmac_f32_16x16x64_bf16 v[56:59], v[36:39], a[104:111], v9
  v_smfmac_f32_16x16x64_bf16 v[60:63], v[36:39], a[184:191], v9
  v_smfmac_f32_16x16x64_bf16 v[64:67], v[36:39], v[80:87], v9
  ds_read_b128 v[36:39], v2 offset:39936
  v_smfmac_f32_16x16x64_bf16 v[52:55], v[44:47], a[32:39], v9
  v_smfmac_f32_16x16x64_bf16 v[56:59], v[44:47], a[112:119], v9
  v_smfmac_f32_16x16x64_bf16 v[60:63], v[44:47], a[192:199], v9
  v_smfmac_f32_16x16x64_bf16 v[64:67], v[44:47], v[88:95], v9
  v_smfmac_f32_16x16x64_bf16 v[52:55], v[48:51], a[40:47], v9
  v_smfmac_f32_16x16x64_bf16 v[56:59], v[48:51], a[120:127], v9
  v_smfmac_f32_16x16x64_bf16 v[60:63], v[48:51], a[200:207], v9
  v_smfmac_f32_16x16x64_bf16 v[64:67], v[48:51], v[96:103], v9
  s_waitcnt lgkmcnt(3)
  v_smfmac_f32_16x16x64_bf16 v[52:55], v[40:43], a[48:55], v9
  v_smfmac_f32_16x16x64_bf16 v[56:59], v[40:43], a[128:135], v9
  v_smfmac_f32_16x16x64_bf16 v[60:63], v[40:43], a[208:215], v9
  v_smfmac_f32_16x16x64_bf16 v[64:67], v[40:43], v[104:111], v9
  v_add_f32 v52, v52, v54
  v_add_f32 v53, v53, v55
  v_cvt_pk_bf16_f32 v52, v52, v53
  ds_write_b32 v8, v52 offset:21504
  v_add_f32 v56, v56, v58
  v_add_f32 v57, v57, v59
  v_cvt_pk_bf16_f32 v56, v56, v57
  ds_write_b32 v8, v56 offset:22528
  v_add_f32 v60, v60, v62
  v_add_f32 v61, v61, v63
  v_cvt_pk_bf16_f32 v60, v60, v61
  ds_write_b32 v10, v60 offset:23552
  v_add_f32 v64, v64, v66
  v_add_f32 v65, v65, v67
  v_cvt_pk_bf16_f32 v64, v64, v65
  ds_write_b32 v10, v64 offset:24064
  s_mov_b32 s76, 0
  s_add_u32 s29, s12, 1
  s_cmp_lt_u32 s76, s29
  s_cbranch_scc1 mega_kernel_sd47_wait
mega_kernel_sd47_go:
  s_mov_b32 m0, 34816
  s_waitcnt lgkmcnt(0)
  s_barrier
  s_barrier
  s_branch mega_bl
mega_kernel_sd48_wait:
  s_mov_b32 s15, 0
mega_kernel_sd48_w2:
  buffer_load_dword v13, v12, s[4:7], s71 offen sc1
  s_waitcnt vmcnt(0)
  v_min_u32_dpp v13, v13, v13 quad_perm:[1,0,3,2] row_mask:0xf bank_mask:0xf
  s_nop 1
  v_min_u32_dpp v13, v13, v13 quad_perm:[2,3,0,1] row_mask:0xf bank_mask:0xf
  s_nop 1
  v_min_u32_dpp v13, v13, v13 row_half_mirror row_mask:0xf bank_mask:0xf
  s_nop 0
  v_readfirstlane_b32 s76, v13
  s_nop 0
  s_cmp_ge_u32 s76, s29
  s_cbranch_scc1 mega_kernel_sd48_go
  s_sleep 1
  s_add_u32 s15, s15, 1
  s_cmp_lt_u32 s15, 262144
  s_cbranch_scc1 mega_kernel_sd48_w2
  s_branch mega_fail
mega_loop3_first:
  s_add_u32 s29, s12, 1
  s_cmp_lt_u32 s76, s29
  s_cbranch_scc1 mega_kernel_sd48_wait
mega_kernel_sd48_go:
  s_mov_b32 m0, 24576
  s_add_u32 s27, s24, 0
  buffer_load_dwordx4 v11, s[4:7], s27 offen offset:0 sc1 lds
  buffer_load_dwordx4 v11, s[4:7], s27 offen offset:1024 sc1 lds
  s_mov_b32 m0, 32768
  s_nop 0
  buffer_load_dwordx4 v68, s[4:7], s27 offen sc1 lds
  s_mov_b32 m0, 26624
  s_add_u32 s27, s24, 40960
  buffer_load_dwordx4 v11, s[4:7], s27 offen offset:0 sc1 lds
  buffer_load_dwordx4 v11, s[4:7], s27 offen offset:1024 sc1 lds
  s_mov_b32 m0, 28672
  s_add_u32 s27, s24, 81920
  buffer_load_dwordx4 v11, s[4:7], s27 offen offset:0 sc1 lds
  buffer_load_dwordx4 v11, s[4:7], s27 offen offset:1024 sc1 lds
  s_mov_b32 m0, 33792
  s_nop 0
  buffer_load_dwordx4 v68, s[4:7], s27 offen sc1 lds
  s_mov_b32 m0, 30720
  s_add_u32 s27, s24, 122880
  buffer_load_dwordx4 v11, s[4:7], s27 offen offset:0 sc1 lds
  buffer_load_dwordx4 v11, s[4:7], s27 offen offset:1024 sc1 lds
  s_mov_b32 m0, 34816
  s_add_u32 s72, s72, 1
  s_cmp_eq_u32 s72, 4
  s_cselect_b32 s72, 0, s72
  s_mov_b32 s73, 325632
  s_cselect_b32 s73, 0xfff11800, s73
  s_add_u32 s22, s22, s73
  s_add_u32 s24, s24, s73
  s_waitcnt vmcnt(0)
  s_barrier
  s_branch mega_loop3_fb
mega_kernel_sd49_wait:
  s_mov_b32 s15, 0
mega_kernel_sd49_w2:
  buffer_load_dword v13, v12, s[4:7], s71 offen sc1
  s_waitcnt vmcnt(0)
  v_min_u32_dpp v13, v13, v13 quad_perm:[1,0,3,2] row_mask:0xf bank_mask:0xf
  s_nop 1
  v_min_u32_dpp v13, v13, v13 quad_perm:[2,3,0,1] row_mask:0xf bank_mask:0xf
  s_nop 1
  v_min_u32_dpp v13, v13, v13 row_half_mirror row_mask:0xf bank_mask:0xf
  s_nop 0
  v_readfirstlane_b32 s76, v13
  s_nop 0
  s_cmp_ge_u32 s76, s29
  s_cbranch_scc1 mega_kernel_sd49_go
  s_sleep 1
  s_add_u32 s15, s15, 1
  s_cmp_lt_u32 s15, 262144
  s_cbranch_scc1 mega_kernel_sd49_w2
  s_branch mega_fail
mega_loop4:
  buffer_load_dwordx4 v[16:19], v2, s[4:7], s13 offen offset:0 sc1
  buffer_load_dwordx4 v[20:23], v2, s[4:7], s13 offen offset:1024 sc1
  buffer_load_dwordx4 v[24:27], v2, s[4:7], s14 offen offset:0 sc1
  s_xor_b32 s16, s16, s17
  s_xor_b32 s17, s17, s16
  s_xor_b32 s16, s16, s17
  s_mov_b32 m0, 0
  s_add_u32 s39, s39, 1
  s_and_b32 s27, s39, 7
  s_mul_i32 s27, s27, 163840
  s_add_u32 s37, s32, s27
  s_add_u32 s33, s30, s27
  s_nop 15
  s_nop 14
  buffer_load_dwordx4 v[16:19], v2, s[4:7], s13 offen offset:0 sc1
  buffer_load_dwordx4 v[20:23], v2, s[4:7], s13 offen offset:1024 sc1
  buffer_load_dwordx4 v[24:27], v2, s[4:7], s14 offen offset:0 sc1
mega_loop4_pc2:
  s_waitcnt vmcnt(3)
  v_max3_u32 v14, v16, v17, v18
  v_max3_u32 v14, v14, v19, v20
  v_smfmac_f32_16x16x64_bf16 v[28:31], v[16:19], v[136:143], v9
  v_max3_u32 v14, v14, v21, v22
  v_max3_u32 v14, v14, v23, v24
  v_smfmac_f32_16x16x64_bf16 v[32:35], v[16:19], v[144:151], v9
  v_max3_u32 v14, v14, v25, v26
  v_max_u32 v14, v14, v27
  v_smfmac_f32_16x16x64_bf16 v[28:31], v[20:23], v[152:159], v9
  v_cmp_eq_u32 vcc, -1, v14
  v_smfmac_f32_16x16x64_bf16 v[32:35], v[20:23], v[160:167], v9
  s_cbranch_vccnz mega_loop4_pcf
  v_smfmac_f32_16x16x64_bf16 v[28:31], v[24:27], v[168:175], v9
  ds_write_b128 v2, v[16:19] offset:0
  v_smfmac_f32_16x16x64_bf16 v[32:35], v[24:27], v[176:183], v9
  ds_write_b128 v2, v[20:23] offset:1024
  v_smfmac_f32_16x16x64_bf16 v[36:39], v[16:19], v[184:191], v9
  ds_write_b128 v2, v[24:27] offset:2048
  v_smfmac_f32_16x16x64_bf16 v[40:43], v[16:19], v[192:199], v9
  v_add_f32 v28, v28, v30
  v_smfmac_f32_16x16x64_bf16 v[36:39], v[20:23], v[200:207], v9
  v_add_f32 v29, v29, v31
  v_cvt_pk_bf16_f32 v30, v28, v29
  v_smfmac_f32_16x16x64_bf16 v[40:43], v[20:23], v[208:215], v9
  v_add_f32 v32, v32, v34
  v_smfmac_f32_16x16x64_bf16 v[36:39], v[24:27], v[216:223], v9
  v_add_f32 v33, v33, v35
  v_cvt_pk_bf16_f32 v31, v32, v33
  v_smfmac_f32_16x16x64_bf16 v[44:47], v[16:19], v[224:231], v9
  ds_write_b64 v3, v[30:31] offset:10240
  v_smfmac_f32_16x16x64_bf16 v[48:51], v[16:19], v[232:239], v9
  s_nop 0
  v_add_f32 v36, v36, v38
  v_smfmac_f32_16x16x64_bf16 v[44:47], v[20:23], v[240:247], v9
  v_add_f32 v37, v37, v39
  v_cvt_pk_bf16_f32 v38, v36, v37
  v_smfmac_f32_16x16x64_bf16 v[48:51], v[20:23], v[248:255], v9
  v_add_f32 v40, v40, v42
  v_add_f32 v41, v41, v43
  v_cvt_pk_bf16_f32 v39, v40, v41
  ds_write_b64 v3, v[38:39] offset:12288
  s_nop 0
  v_add_f32 v44, v44, v46
  v_add_f32 v45, v45, v47
  v_cvt_pk_bf16_f32 v46, v44, v45
  v_add_f32 v48, v48, v50
  v_add_f32 v49, v49, v51
  v_cvt_pk_bf16_f32 v47, v48, v49
  ds_write_b64 v3, v[46:47] offset:14336
  v_smfmac_f32_16x16x64_bf16 v[52:55], v[16:19], a[0:7], v9
  v_smfmac_f32_16x16x64_bf16 v[56:59], v[16:19], a[80:87], v9
  v_smfmac_f32_16x16x64_bf16 v[52:55], v[20:23], a[8:15], v9
  s_waitcnt lgkmcnt(0)
  s_barrier
  ds_read_b128 v[28:31], v2 offset:10240
  ds_read_b128 v[32:35], v2 offset:11264
  ds_read_b128 v[36:39], v2 offset:12288
  ds_read_b128 v[40:43], v2 offset:13312
  ds_read_b128 v[44:47], v2 offset:14336
  ds_read_b128 v[48:51], v2 offset:15360
  ds_read_b128 v[120:123], v11 offset:34816
  ds_read_b64 v[124:125], v11 offset:36864
  v_smfmac_f32_16x16x64_bf16 v[56:59], v[20:23], a[88:95], v9
  s_waitcnt lgkmcnt(7)
  v_mfma_f32_16x16x32_bf16 v[100:103], v[28:31], a[172:175], 0
  ds_read_b128 v[72:75], v2 offset:3072
  s_waitcnt lgkmcnt(7)
  v_mfma_f32_16x16x32_bf16 v[100:103], v[32:35], a[172:175], v[100:103]
  ds_read_b128 v[76:79], v2 offset:4096
  s_waitcnt lgkmcnt(7)
  v_mfma_f32_16x16x32_bf16 v[104:107], v[36:39], a[172:175], 0
  ds_read_b128 v[80:83], v2 offset:5120
  s_waitcnt lgkmcnt(7)
  v_mfma_f32_16x16x32_bf16 v[104:107], v[40:43], a[172:175], v[104:107]
  ds_read_b128 v[84:87], v2 offset:6144
  s_waitcnt lgkmcnt(7)
  v_mfma_f32_16x16x32_bf16 v[108:111], v[44:47], a[172:175], 0
  v_cvt_pk_bf16_f32 v112, v100, v101
  v_cvt_pk_bf16_f32 v113, v102, v103
  s_waitcnt lgkmcnt(6)
  v_mfma_f32_16x16x32_bf16 v[108:111], v[48:51], a[172:175], v[108:111]
  s_nop 0
  v_cvt_pk_bf16_f32 v114, v104, v105
  v_cvt_pk_bf16_f32 v115, v106, v107
  s_waitcnt lgkmcnt(4)
  ds_read_b128 v[88:91], v2 offset:7168
  v_mfma_f32_16x16x32_bf16 v[128:131], v[120:123], v[112:115], 0
  ds_read_b128 v[92:95], v2 offset:8192
  ds_read_b128 v[96:99], v2 offset:9216
  v_cvt_pk_bf16_f32 v116, v108, v109
  v_cvt_pk_bf16_f32 v117, v110, v111
  s_nop 1
  v_mfma_f32_16x16x32_bf16 v[128:131], v[124:127], v[116:119], v[128:131]
  v_smfmac_f32_16x16x64_bf16 v[52:55], v[24:27], a[16:23], v9
  ds_read_b128 a[176:179], v2 offset:24576
  ds_read_b128 a[180:183], v2 offset:26624
  ds_read_b128 a[184:187], v2 offset:28672
  s_nop 1
  v_cvt_pk_bf16_f32 v68, v128, v129
  v_cvt_pk_bf16_f32 v69, v130, v131
  buffer_store_dwordx2 v[68:69], v10, s[4:7], s18 offen sc1
  s_cmp_eq_u32 s12, 63
  s_cbranch_scc1 mega_loop4_last
  v_smfmac_f32_16x16x64_bf16 v[56:59], v[24:27], a[96:103], v9
  ds_read_b128 a[188:191], v2 offset:30720
  s_waitcnt lgkmcnt(4)
  buffer_store_dwordx2 v[132:133], v10, s[4:7], s19 offen sc1
  v_smfmac_f32_16x16x64_bf16 v[52:55], v[72:75], a[24:31], v9
  v_smfmac_f32_16x16x64_bf16 v[56:59], v[72:75], a[104:111], v9
  v_smfmac_f32_16x16x64_bf16 v[52:55], v[76:79], a[32:39], v9
  v_smfmac_f32_16x16x64_bf16 v[56:59], v[76:79], a[112:119], v9
  v_smfmac_f32_16x16x64_bf16 v[52:55], v[80:83], a[40:47], v9
  v_smfmac_f32_16x16x64_bf16 v[56:59], v[80:83], a[120:127], v9
  v_smfmac_f32_16x16x64_bf16 v[52:55], v[84:87], a[48:55], v9
  v_smfmac_f32_16x16x64_bf16 v[56:59], v[84:87], a[128:135], v9
  v_smfmac_f32_16x16x64_bf16 v[52:55], v[88:91], a[56:63], v9
  v_smfmac_f32_16x16x64_bf16 v[56:59], v[88:91], a[136:143], v9
  buffer_load_dwordx4 v[16:19], v4, s[4:7], s20 offen sc1
  v_smfmac_f32_16x16x64_bf16 v[52:55], v[92:95], a[64:71], v9
  buffer_load_dwordx4 v[20:23], v4, s[4:7], s20 offen offset:256 sc1
  v_smfmac_f32_16x16x64_bf16 v[56:59], v[92:95], a[144:151], v9
  buffer_load_dwordx4 v[24:27], v5, s[4:7], s20 offen offset:512 sc1
  v_smfmac_f32_16x16x64_bf16 v[52:55], v[96:99], a[72:79], v9
  v_smfmac_f32_16x16x64_bf16 v[56:59], v[96:99], a[152:159], v9
  s_nop 4
  v_add_f32 v52, v52, v54
  v_add_f32 v53, v53, v55
  v_cvt_pk_bf16_f32 v52, v52, v53
  ds_write_b32 v8, v52 offset:21504
  v_add_f32 v56, v56, v58
  v_add_f32 v57, v57, v59
  v_cvt_pk_bf16_f32 v56, v56, v57
  ds_write_b32 v8, v56 offset:22528
mega_loop4_pa:
  buffer_load_dwordx4 v[16:19], v4, s[4:7], s20 offen sc1
  buffer_load_dwordx4 v[20:23], v4, s[4:7], s20 offen offset:256 sc1
  buffer_load_dwordx4 v[24:27], v5, s[4:7], s20 offen offset:512 sc1
  s_add_u32 s15, s15, 16384
  s_cbranch_scc1 mega_fail
  s_waitcnt vmcnt(3)
  v_max3_u32 v14, v16, v17, v18
  v_max3_u32 v14, v14, v19, v20
  v_mfma_f32_16x16x32_bf16 v[40:43], v[16:19], a[160:163], 0
  v_max3_u32 v14, v14, v21, v22
  v_max3_u32 v14, v14, v23, v24
  v_mfma_f32_16x16x32_bf16 v[40:43], v[20:23], a[164:167], v[40:43]
  v_max3_u32 v14, v14, v25, v26
  v_max_u32 v14, v14, v27
  v_mfma_f32_16x16x32_bf16 v[44:47], v[24:27], a[168:171], 0
  v_cmp_eq_u32 vcc, -1, v14
  s_nop 3
  v_max3_f32 v48, v40, v41, v42
  s_cbranch_vccnz mega_loop4_pa
  s_nop 0
  v_cndmask_b32 v44, v44, v45, s[42:43]
  v_max3_f32 v48, v48, v43, v44
  s_nop 1
  v_max_f32_dpp v48, v48, v48 quad_perm:[1,0,3,2] row_mask:0xf bank_mask:0xf
  s_nop 1
  v_max_f32_dpp v48, v48, v48 quad_perm:[2,3,0,1] row_mask:0xf bank_mask:0xf
  s_nop 1
  v_max_f32_dpp v48, v48, v48 row_half_mirror row_mask:0xf bank_mask:0xf
  v_mul_f32 v48, v0, v48
  v_pk_fma_f32 v[40:41], v[40:41], v[0:1], v[48:49] op_sel_hi:[1,0,0] neg_lo:[0,1,0] neg_hi:[0,1,0]
  v_pk_fma_f32 v[42:43], v[42:43], v[0:1], v[48:49] op_sel_hi:[1,0,0] neg_lo:[0,1,0] neg_hi:[0,1,0]
  v_fma_f32 v44, v44, -v0, v48
  v_exp_f32 v40, v40
  v_exp_f32 v41, v41
  v_exp_f32 v42, v42
  v_exp_f32 v43, v43
  v_exp_f32 v44, v44
  v_pk_add_f32 v[48:49], v[40:41], v[42:43]
  v_add_f32 v48, v48, v49
  v_add_f32 v48, v48, v44
  s_nop 1
  v_add_f32_dpp v48, v48, v48 quad_perm:[1,0,3,2] row_mask:0xf bank_mask:0xf
  s_nop 1
  v_add_f32_dpp v48, v48, v48 quad_perm:[2,3,0,1] row_mask:0xf bank_mask:0xf
  s_nop 1
  v_add_f32_dpp v48, v48, v48 row_half_mirror row_mask:0xf bank_mask:0xf
  v_rcp_f32 v48, v48
  s_nop 0
  v_pk_mul_f32 v[40:41], v[40:41], v[48:49] op_sel_hi:[1,0]
  v_pk_mul_f32 v[42:43], v[42:43], v[48:49] op_sel_hi:[1,0]
  v_mul_f32 v44, v44, v48
  v_cvt_pk_bf16_f32 v40, v40, v41
  v_cvt_pk_bf16_f32 v41, v42, v43
  ds_write_b64 v6, v[40:41] offset:16384
  v_cvt_pk_bf16_f32 v44, v44, v44
  ds_write_b16 v7, v44 offset:20480
  s_cmp_eq_u32 s12, 0
  s_cbranch_scc1 mega_loop4_first
mega_loop4_fb:
  s_waitcnt lgkmcnt(0)
  s_barrier
  ds_read_b128 v[72:75], v12 offset:16384
  ds_read_b128 v[76:79], v12 offset:17408
  ds_read_b128 v[80:83], v12 offset:18432
  ds_read_b128 v[84:87], v12 offset:19456
  ds_read_b128 v[88:91], v12 offset:20480
  ds_read_b128 v[92:95], v13 offset:21504
  s_waitcnt lgkmcnt(5)
  v_mfma_f32_16x16x32_bf16 v[128:131], a[176:179], v[72:75], 0
  s_waitcnt lgkmcnt(4)
  v_mfma_f32_16x16x32_bf16 v[128:131], a[180:183], v[76:79], v[128:131]
  s_waitcnt lgkmcnt(3)
  v_mfma_f32_16x16x32_bf16 v[128:131], a[184:187], v[80:83], v[128:131]
  s_waitcnt lgkmcnt(2)
  v_mfma_f32_16x16x32_bf16 v[128:131], a[188:191], v[84:87], v[128:131]
  s_waitcnt lgkmcnt(0)
  v_mfma_f32_16x16x32_bf16 v[128:131], v[92:95], v[88:91], v[128:131]
  v_mov_b32 v28, 0
  v_mov_b32 v29, 0
  v_mov_b32 v30, 0
  v_mov_b32 v31, 0
  v_mov_b32 v32, 0
  v_mov_b32 v33, 0
  v_mov_b32 v34, 0
  s_nop 0
  v_cvt_pk_bf16_f32 v68, v128, v129
  v_cvt_pk_bf16_f32 v70, v128, v129
  v_cvt_pk_bf16_f32 v69, v130, v131
  v_cvt_pk_bf16_f32 v71, v130, v131
  v_permlane16_swap_b32 v68, v70
  s_nop 0
  v_permlane16_swap_b32 v69, v71
  buffer_store_dwordx4 v[68:71], v61, s[4:7], s33 offen sc1
  buffer_store_dwordx4 v[68:71], v134, s[4:7], s33 offen sc1
  v_mov_b32 v35, 0
  v_mov_b32 v36, 0
  v_mov_b32 v37, 0
  v_mov_b32 v38, 0
  v_mov_b32 v39, 0
  v_mov_b32 v40, 0
  v_mov_b32 v41, 0
  v_mov_b32 v42, 0
  v_mov_b32 v43, 0
  v_mov_b32 v44, 0
  v_mov_b32 v45, 0
  v_mov_b32 v46, 0
  v_mov_b32 v47, 0
  v_mov_b32 v48, 0
  v_mov_b32 v49, 0
  v_mov_b32 v50, 0
  v_mov_b32 v51, 0
  v_mov_b32 v52, 0
  v_mov_b32 v53, 0
  v_mov_b32 v54, 0
  v_mov_b32 v55, 0
  v_mov_b32 v56, 0
  v_mov_b32 v57, 0
  v_mov_b32 v58, 0
  v_mov_b32 v59, 0
  s_xor_b32 s18, s18, s19
  s_xor_b32 s19, s19, s18
  s_xor_b32 s18, s18, s19
  s_xor_b32 s20, s20, s21
  s_xor_b32 s21, s21, s20
  s_xor_b32 s20, s20, s21
  s_add_u32 s72, s72, 1
  s_cmp_eq_u32 s72, 4
  s_cselect_b32 s72, 0, s72
  s_mov_b32 s73, 325632
  s_cselect_b32 s73, 0xfff11800, s73
  s_add_u32 s23, s23, s73
  s_mov_b32 s15, 0
  s_add_u32 s13, s17, 0
  s_add_u32 s14, s17, 2048
  s_nop 15
  s_nop 15
  s_nop 15
  s_nop 15
  s_nop 15
  s_nop 15
  buffer_load_dwordx4 v[96:99], v62, s[4:7], s37 offen offset:0 sc1
  buffer_load_dwordx4 v[100:103], v62, s[4:7], s37 offen offset:1024 sc1
  s_barrier
  buffer_store_dwordx4 v[92:95], v66, s[4:7], s25 offen sc1
  s_add_u32 s25, s25, s73
  s_add_u32 s12, s12, 1
  s_waitcnt vmcnt(1)
  v_mfma_f32_16x16x32_bf16 v[128:131], a[160:163], v[96:99], 0
  v_max3_u32 v14, v96, v97, v98
  v_max3_u32 v14, v14, v99, v100
  v_mfma_f32_16x16x32_bf16 v[128:131], a[160:163], v[100:103], v[128:131]
  v_max3_u32 v14, v14, v101, v102
  v_max_u32 v14, v14, v103
  v_cmp_eq_u32 vcc, -1, v14
  s_nop 4
  v_cvt_pk_bf16_f32 v68, v128, v129
  v_cvt_pk_bf16_f32 v69, v130, v131
  s_cbranch_vccnz mega_loop4_pbf
mega_loop4_pbok:
  buffer_store_dwordx2 v[68:69], v63, s[4:7], s17 offen sc1
  buffer_store_dwordx2 v[132:133], v63, s[4:7], s16 offen sc1
  s_barrier
  s_nop 15
  s_nop 15
  s_branch mega_loop4
mega_loop4_pcf:
  buffer_load_dwordx4 v[16:19], v2, s[4:7], s13 offen offset:0 sc1
  buffer_load_dwordx4 v[20:23], v2, s[4:7], s13 offen offset:1024 sc1
  buffer_load_dwordx4 v[24:27], v2, s[4:7], s14 offen offset:0 sc1
  s_nop 0
  v_mov_b32 v28, 0
  v_mov_b32 v29, 0
  v_mov_b32 v30, 0
  v_mov_b32 v31, 0
  v_mov_b32 v32, 0
  v_mov_b32 v33, 0
  v_mov_b32 v34, 0
  v_mov_b32 v35, 0
  s_add_u32 s15, s15, 16384
  s_cbranch_scc1 mega_fail
  s_branch mega_loop4_pc2
mega_loop4_last:
  v_smfmac_f32_16x16x64_bf16 v[56:59], v[24:27], a[96:103], v9
  ds_read_b128 a[188:191], v2 offset:30720
  s_waitcnt lgkmcnt(4)
  buffer_store_dwordx2 v[132:133], v10, s[4:7], s19 offen sc1
  v_smfmac_f32_16x16x64_bf16 v[52:55], v[72:75], a[24:31], v9
  v_smfmac_f32_16x16x64_bf16 v[56:59], v[72:75], a[104:111], v9
  v_smfmac_f32_16x16x64_bf16 v[52:55], v[76:79], a[32:39], v9
  v_smfmac_f32_16x16x64_bf16 v[56:59], v[76:79], a[112:119], v9
  v_smfmac_f32_16x16x64_bf16 v[52:55], v[80:83], a[40:47], v9
  v_smfmac_f32_16x16x64_bf16 v[56:59], v[80:83], a[120:127], v9
  v_smfmac_f32_16x16x64_bf16 v[52:55], v[84:87], a[48:55], v9
  v_smfmac_f32_16x16x64_bf16 v[56:59], v[84:87], a[128:135], v9
  v_smfmac_f32_16x16x64_bf16 v[52:55], v[88:91], a[56:63], v9
  v_smfmac_f32_16x16x64_bf16 v[56:59], v[88:91], a[136:143], v9
  v_smfmac_f32_16x16x64_bf16 v[52:55], v[92:95], a[64:71], v9
  v_smfmac_f32_16x16x64_bf16 v[56:59], v[92:95], a[144:151], v9
  v_smfmac_f32_16x16x64_bf16 v[52:55], v[96:99], a[72:79], v9
  v_smfmac_f32_16x16x64_bf16 v[56:59], v[96:99], a[152:159], v9
  s_nop 4
  v_add_f32 v52, v52, v54
  v_add_f32 v53, v53, v55
  v_cvt_pk_bf16_f32 v52, v52, v53
  ds_write_b32 v8, v52 offset:21504
  v_add_f32 v56, v56, v58
  v_add_f32 v57, v57, v59
  v_cvt_pk_bf16_f32 v56, v56, v57
  ds_write_b32 v8, v56 offset:22528
  s_waitcnt lgkmcnt(0)
  s_barrier
  ds_read_b128 v[92:95], v13 offset:21504
  s_waitcnt lgkmcnt(0)
  buffer_store_dwordx4 v[92:95], v66, s[4:7], s25 offen sc1
  s_waitcnt vmcnt(0)
  s_barrier
  s_branch mega_bl
mega_loop4_first:
  s_barrier
  ds_read_b128 a[176:179], v2 offset:24576
  ds_read_b128 a[180:183], v2 offset:26624
  ds_read_b128 a[184:187], v2 offset:28672
  ds_read_b128 a[188:191], v2 offset:30720
  s_branch mega_loop4_fb
mega_loop4_pbf:
  buffer_load_dwordx4 v[96:99], v62, s[4:7], s37 offen offset:0 sc1
  buffer_load_dwordx4 v[100:103], v62, s[4:7], s37 offen offset:1024 sc1
mega_loop4_pbl:
  buffer_load_dwordx4 v[96:99], v62, s[4:7], s37 offen offset:0 sc1
  buffer_load_dwordx4 v[100:103], v62, s[4:7], s37 offen offset:1024 sc1
  s_add_u32 s15, s15, 16384
  s_cbranch_scc1 mega_fail
  s_waitcnt vmcnt(2)
  v_max3_u32 v14, v96, v97, v98
  v_max3_u32 v14, v14, v99, v100
  v_mfma_f32_16x16x32_bf16 v[128:131], a[160:163], v[96:99], 0
  v_max3_u32 v14, v14, v101, v102
  v_max_u32 v14, v14, v103
  v_mfma_f32_16x16x32_bf16 v[128:131], a[160:163], v[100:103], v[128:131]
  v_cmp_eq_u32 vcc, -1, v14
  s_nop 6
  v_cvt_pk_bf16_f32 v68, v128, v129
  v_cvt_pk_bf16_f32 v69, v130, v131
  s_cbranch_vccnz mega_loop4_pbl
  s_branch mega_loop4_pbok
mega_loop5:
  buffer_load_dwordx4 v[16:19], v2, s[4:7], s13 offen offset:0 sc1
  buffer_load_dwordx4 v[20:23], v2, s[4:7], s13 offen offset:1024 sc1
  buffer_load_dwordx4 v[24:27], v2, s[4:7], s14 offen offset:0 sc1
  s_xor_b32 s16, s16, s17
  s_xor_b32 s17, s17, s16
  s_xor_b32 s16, s16, s17
  s_mov_b32 m0, 3072
  s_add_u32 s39, s39, 1
  s_and_b32 s27, s39, 7
  s_mul_i32 s27, s27, 163840
  s_add_u32 s37, s32, s27
  s_add_u32 s33, s30, s27
  s_nop 15
  s_nop 14
  buffer_load_dwordx4 v[16:19], v2, s[4:7], s13 offen offset:0 sc1
  buffer_load_dwordx4 v[20:23], v2, s[4:7], s13 offen offset:1024 sc1
  buffer_load_dwordx4 v[24:27], v2, s[4:7], s14 offen offset:0 sc1
mega_loop5_pc2:
  s_waitcnt vmcnt(3)
  v_max3_u32 v14, v16, v17, v18
  v_max3_u32 v14, v14, v19, v20
  v_smfmac_f32_16x16x64_bf16 v[44:47], v[16:19], v[136:143], v9
  v_max3_u32 v14, v14, v21, v22
  v_max3_u32 v14, v14, v23, v24
  v_smfmac_f32_16x16x64_bf16 v[48:51], v[16:19], v[144:151], v9
  v_max3_u32 v14, v14, v25, v26
  v_max_u32 v14, v14, v27
  v_smfmac_f32_16x16x64_bf16 v[44:47], v[20:23], v[152:159], v9
  v_cmp_eq_u32 vcc, -1, v14
  v_smfmac_f32_16x16x64_bf16 v[48:51], v[20:23], v[160:167], v9
  s_cbranch_vccnz mega_loop5_pcf
  v_smfmac_f32_16x16x64_bf16 v[44:47], v[24:27], v[168:175], v9
  ds_write_b128 v2, v[16:19] offset:3072
  v_smfmac_f32_16x16x64_bf16 v[48:51], v[24:27], v[176:183], v9
  ds_write_b128 v2, v[20:23] offset:4096
  v_smfmac_f32_16x16x64_bf16 v[36:39], v[16:19], v[184:191], v9
  v_smfmac_f32_16x16x64_bf16 v[40:43], v[16:19], v[192:199], v9
  v_add_f32 v44, v44, v46
  v_smfmac_f32_16x16x64_bf16 v[36:39], v[20:23], v[200:207], v9
  v_add_f32 v45, v45, v47
  v_cvt_pk_bf16_f32 v46, v44, v45
  v_smfmac_f32_16x16x64_bf16 v[40:43], v[20:23], v[208:215], v9
  v_add_f32 v48, v48, v50
  v_smfmac_f32_16x16x64_bf16 v[40:43], v[24:27], v[216:223], v9
  v_add_f32 v49, v49, v51
  v_cvt_pk_bf16_f32 v47, v48, v49
  v_smfmac_f32_16x16x64_bf16 v[28:31], v[16:19], v[224:231], v9
  ds_write_b64 v3, v[46:47] offset:14336
  v_smfmac_f32_16x16x64_bf16 v[32:35], v[16:19], v[232:239], v9
  v_add_f32 v36, v36, v38
  v_smfmac_f32_16x16x64_bf16 v[28:31], v[20:23], v[240:247], v9
  v_add_f32 v37, v37, v39
  v_cvt_pk_bf16_f32 v38, v36, v37
  v_smfmac_f32_16x16x64_bf16 v[32:35], v[20:23], v[248:255], v9
  v_add_f32 v40, v40, v42
  v_add_f32 v41, v41, v43
  v_cvt_pk_bf16_f32 v39, v40, v41
  ds_write_b64 v3, v[38:39] offset:12288
  s_nop 0
  v_add_f32 v28, v28, v30
  v_add_f32 v29, v29, v31
  v_cvt_pk_bf16_f32 v30, v28, v29
  v_add_f32 v32, v32, v34
  v_add_f32 v33, v33, v35
  v_cvt_pk_bf16_f32 v31, v32, v33
  ds_write_b64 v3, v[30:31] offset:10240
  v_smfmac_f32_16x16x64_bf16 v[52:55], v[16:19], a[24:31], v9
  v_smfmac_f32_16x16x64_bf16 v[56:59], v[16:19], a[104:111], v9
  v_smfmac_f32_16x16x64_bf16 v[52:55], v[20:23], a[32:39], v9
  s_waitcnt lgkmcnt(0)
  s_barrier
  ds_read_b128 v[28:31], v2 offset:10240
  ds_read_b128 v[32:35], v2 offset:11264
  ds_read_b128 v[36:39], v2 offset:12288
  ds_read_b128 v[40:43], v2 offset:13312
  ds_read_b128 v[44:47], v2 offset:14336
  ds_read_b128 v[48:51], v2 offset:15360
  ds_read_b128 v[120:123], v11 offset:35840
  ds_read_b64 v[124:125], v11 offset:36872
  v_smfmac_f32_16x16x64_bf16 v[56:59], v[20:23], a[112:119], v9
  s_waitcnt lgkmcnt(7)
  v_mfma_f32_16x16x32_bf16 v[100:103], v[28:31], a[172:175], 0
  ds_read_b128 v[72:75], v2 offset:0
  s_waitcnt lgkmcnt(7)
  v_mfma_f32_16x16x32_bf16 v[100:103], v[32:35], a[172:175], v[100:103]
  ds_read_b128 v[76:79], v2 offset:1024
  s_waitcnt lgkmcnt(7)
  v_mfma_f32_16x16x32_bf16 v[104:107], v[36:39], a[172:175], 0
  ds_read_b128 v[80:83], v2 offset:5120
  s_waitcnt lgkmcnt(7)
  v_mfma_f32_16x16x32_bf16 v[104:107], v[40:43], a[172:175], v[104:107]
  ds_read_b128 v[84:87], v2 offset:6144
  s_waitcnt lgkmcnt(7)
  v_mfma_f32_16x16x32_bf16 v[108:111], v[44:47], a[172:175], 0
  v_cvt_pk_bf16_f32 v112, v100, v101
  v_cvt_pk_bf16_f32 v113, v102, v103
  s_waitcnt lgkmcnt(6)
  v_mfma_f32_16x16x32_bf16 v[108:111], v[48:51], a[172:175], v[108:111]
  s_nop 0
  v_cvt_pk_bf16_f32 v114, v104, v105
  v_cvt_pk_bf16_f32 v115, v106, v107
  s_waitcnt lgkmcnt(4)
  ds_read_b128 v[88:91], v2 offset:7168
  v_mfma_f32_16x16x32_bf16 v[128:131], v[120:123], v[112:115], 0
  ds_read_b128 v[92:95], v2 offset:8192
  ds_read_b128 v[96:99], v2 offset:9216
  v_cvt_pk_bf16_f32 v116, v108, v109
  v_cvt_pk_bf16_f32 v117, v110, v111
  s_nop 1
  v_mfma_f32_16x16x32_bf16 v[128:131], v[124:127], v[116:119], v[128:131]
  v_smfmac_f32_16x16x64_bf16 v[52:55], v[24:27], a[16:23], v9
  ds_read_b128 a[176:179], v2 offset:25600
  ds_read_b128 a[180:183], v2 offset:27648
  ds_read_b128 a[184:187], v2 offset:29696
  s_nop 1
  v_cvt_pk_bf16_f32 v68, v128, v129
  v_cvt_pk_bf16_f32 v69, v130, v131
  buffer_store_dwordx2 v[68:69], v10, s[4:7], s18 offen sc1
  s_cmp_eq_u32 s12, 63
  s_cbranch_scc1 mega_loop5_last
  v_smfmac_f32_16x16x64_bf16 v[56:59], v[24:27], a[96:103], v9
  ds_read_b128 a[188:191], v2 offset:31744
  s_waitcnt lgkmcnt(4)
  buffer_store_dwordx2 v[132:133], v10, s[4:7], s19 offen sc1
  v_smfmac_f32_16x16x64_bf16 v[52:55], v[72:75], a[0:7], v9
  v_smfmac_f32_16x16x64_bf16 v[56:59], v[72:75], a[80:87], v9
  v_smfmac_f32_16x16x64_bf16 v[52:55], v[76:79], a[8:15], v9
  v_smfmac_f32_16x16x64_bf16 v[56:59], v[76:79], a[88:95], v9
  v_smfmac_f32_16x16x64_bf16 v[52:55], v[80:83], a[40:47], v9
  v_smfmac_f32_16x16x64_bf16 v[56:59], v[80:83], a[120:127], v9
  v_smfmac_f32_16x16x64_bf16 v[52:55], v[84:87], a[48:55], v9
  v_smfmac_f32_16x16x64_bf16 v[56:59], v[84:87], a[128:135], v9
  v_smfmac_f32_16x16x64_bf16 v[52:55], v[88:91], a[56:63], v9
  v_smfmac_f32_16x16x64_bf16 v[56:59], v[88:91], a[136:143], v9
  buffer_load_dwordx4 v[16:19], v4, s[4:7], s20 offen sc1
  v_smfmac_f32_16x16x64_bf16 v[52:55], v[92:95], a[64:71], v9
  buffer_load_dwordx4 v[20:23], v4, s[4:7], s20 offen offset:256 sc1
  v_smfmac_f32_16x16x64_bf16 v[56:59], v[92:95], a[144:151], v9
  buffer_load_dwordx4 v[24:27], v5, s[4:7], s20 offen offset:512 sc1
  v_smfmac_f32_16x16x64_bf16 v[52:55], v[96:99], a[72:79], v9
  v_smfmac_f32_16x16x64_bf16 v[56:59], v[96:99], a[152:159], v9
  s_nop 4
  v_add_f32 v52, v52, v54
  v_add_f32 v53, v53, v55
  v_cvt_pk_bf16_f32 v52, v52, v53
  ds_write_b32 v8, v52 offset:21504
  v_add_f32 v56, v56, v58
  v_add_f32 v57, v57, v59
  v_cvt_pk_bf16_f32 v56, v56, v57
  ds_write_b32 v8, v56 offset:22528
mega_loop5_pa:
  buffer_load_dwordx4 v[16:19], v4, s[4:7], s20 offen sc1
  buffer_load_dwordx4 v[20:23], v4, s[4:7], s20 offen offset:256 sc1
  buffer_load_dwordx4 v[24:27], v5, s[4:7], s20 offen offset:512 sc1
  s_add_u32 s15, s15, 16384
  s_cbranch_scc1 mega_fail
  s_waitcnt vmcnt(3)
  v_max3_u32 v14, v16, v17, v18
  v_max3_u32 v14, v14, v19, v20
  v_mfma_f32_16x16x32_bf16 v[40:43], v[16:19], a[160:163], 0
  v_max3_u32 v14, v14, v21, v22
  v_max3_u32 v14, v14, v23, v24
  v_mfma_f32_16x16x32_bf16 v[40:43], v[20:23], a[164:167], v[40:43]
  v_max3_u32 v14, v14, v25, v26
  v_max_u32 v14, v14, v27
  v_mfma_f32_16x16x32_bf16 v[44:47], v[24:27], a[168:171], 0
  v_cmp_eq_u32 vcc, -1, v14
  s_nop 3
  v_max3_f32 v48, v40, v41, v42
  s_cbranch_vccnz mega_loop5_pa
  s_nop 0
  v_cndmask_b32 v44, v44, v45, s[42:43]
  v_max3_f32 v48, v48, v43, v44
  s_nop 1
  v_max_f32_dpp v48, v48, v48 quad_perm:[1,0,3,2] row_mask:0xf bank_mask:0xf
  s_nop 1
  v_max_f32_dpp v48, v48, v48 quad_perm:[2,3,0,1] row_mask:0xf bank_mask:0xf
  s_nop 1
  v_max_f32_dpp v48, v48, v48 row_half_mirror row_mask:0xf bank_mask:0xf
  v_mul_f32 v48, v0, v48
  v_pk_fma_f32 v[40:41], v[40:41], v[0:1], v[48:49] op_sel_hi:[1,0,0] neg_lo:[0,1,0] neg_hi:[0,1,0]
  v_pk_fma_f32 v[42:43], v[42:43], v[0:1], v[48:49] op_sel_hi:[1,0,0] neg_lo:[0,1,0] neg_hi:[0,1,0]
  v_fma_f32 v44, v44, -v0, v48
  v_exp_f32 v40, v40
  v_exp_f32 v41, v41
  v_exp_f32 v42, v42
  v_exp_f32 v43, v43
  v_exp_f32 v44, v44
  v_pk_add_f32 v[48:49], v[40:41], v[42:43]
  v_add_f32 v48, v48, v49
  v_add_f32 v48, v48, v44
  s_nop 1
  v_add_f32_dpp v48, v48, v48 quad_perm:[1,0,3,2] row_mask:0xf bank_mask:0xf
  s_nop 1
  v_add_f32_dpp v48, v48, v48 quad_perm:[2,3,0,1] row_mask:0xf bank_mask:0xf
  s_nop 1
  v_add_f32_dpp v48, v48, v48 row_half_mirror row_mask:0xf bank_mask:0xf
  v_rcp_f32 v48, v48
  s_nop 0
  v_pk_mul_f32 v[40:41], v[40:41], v[48:49] op_sel_hi:[1,0]
  v_pk_mul_f32 v[42:43], v[42:43], v[48:49] op_sel_hi:[1,0]
  v_mul_f32 v44, v44, v48
  v_cvt_pk_bf16_f32 v40, v40, v41
  v_cvt_pk_bf16_f32 v41, v42, v43
  ds_write_b64 v6, v[40:41] offset:16384
  v_cvt_pk_bf16_f32 v44, v44, v44
  ds_write_b16 v7, v44 offset:20480
  s_cmp_eq_u32 s12, 0
  s_cbranch_scc1 mega_loop5_first
mega_loop5_fb:
  s_waitcnt lgkmcnt(0)
  s_barrier
  ds_read_b128 v[72:75], v12 offset:16384
  ds_read_b128 v[76:79], v12 offset:17408
  ds_read_b128 v[80:83], v12 offset:18432
  ds_read_b128 v[84:87], v12 offset:19456
  ds_read_b128 v[88:91], v12 offset:20480
  ds_read_b128 v[92:95], v13 offset:21504
  s_waitcnt lgkmcnt(5)
  v_mfma_f32_16x16x32_bf16 v[128:131], a[176:179], v[72:75], 0
  s_waitcnt lgkmcnt(4)
  v_mfma_f32_16x16x32_bf16 v[128:131], a[180:183], v[76:79], v[128:131]
  s_waitcnt lgkmcnt(3)
  v_mfma_f32_16x16x32_bf16 v[128:131], a[184:187], v[80:83], v[128:131]
  s_waitcnt lgkmcnt(2)
  v_mfma_f32_16x16x32_bf16 v[128:131], a[188:191], v[84:87], v[128:131]
  s_waitcnt lgkmcnt(0)
  v_mfma_f32_16x16x32_bf16 v[128:131], v[92:95], v[88:91], v[128:131]
  v_mov_b32 v28, 0
  v_mov_b32 v29, 0
  v_mov_b32 v30, 0
  v_mov_b32 v31, 0
  v_mov_b32 v32, 0
  v_mov_b32 v33, 0
  v_mov_b32 v34, 0
  s_nop 0
  v_cvt_pk_bf16_f32 v68, v128, v129
  v_cvt_pk_bf16_f32 v70, v128, v129
  v_cvt_pk_bf16_f32 v69, v130, v131
  v_cvt_pk_bf16_f32 v71, v130, v131
  v_permlane16_swap_b32 v68, v70
  s_nop 0
  v_permlane16_swap_b32 v69, v71
  buffer_store_dwordx4 v[68:71], v61, s[4:7], s33 offen sc1
  buffer_store_dwordx4 v[68:71], v134, s[4:7], s33 offen sc1
  v_mov_b32 v35, 0
  v_mov_b32 v36, 0
  v_mov_b32 v37, 0
  v_mov_b32 v38, 0
  v_mov_b32 v39, 0
  v_mov_b32 v40, 0
  v_mov_b32 v41, 0
  v_mov_b32 v42, 0
  v_mov_b32 v43, 0
  v_mov_b32 v44, 0
  v_mov_b32 v45, 0
  v_mov_b32 v46, 0
  v_mov_b32 v47, 0
  v_mov_b32 v48, 0
  v_mov_b32 v49, 0
  v_mov_b32 v50, 0
  v_mov_b32 v51, 0
  v_mov_b32 v52, 0
  v_mov_b32 v53, 0
  v_mov_b32 v54, 0
  v_mov_b32 v55, 0
  v_mov_b32 v56, 0
  v_mov_b32 v57, 0
  v_mov_b32 v58, 0
  v_mov_b32 v59, 0
  s_xor_b32 s18, s18, s19
  s_xor_b32 s19, s19, s18
  s_xor_b32 s18, s18, s19
  s_xor_b32 s20, s20, s21
  s_xor_b32 s21, s21, s20
  s_xor_b32 s20, s20, s21
  s_add_u32 s72, s72, 1
  s_cmp_eq_u32 s72, 4
  s_cselect_b32 s72, 0, s72
  s_mov_b32 s73, 325632
  s_cselect_b32 s73, 0xfff11800, s73
  s_add_u32 s23, s23, s73
  s_mov_b32 s15, 0
  s_add_u32 s13, s17, 3072
  s_add_u32 s14, s17, 2048
  s_nop 15
  s_nop 15
  s_nop 15
  s_nop 15
  s_nop 15
  s_nop 15
  buffer_load_dwordx4 v[96:99], v62, s[4:7], s37 offen offset:0 sc1
  buffer_load_dwordx4 v[100:103], v62, s[4:7], s37 offen offset:1024 sc1
  s_barrier
  buffer_store_dwordx4 v[92:95], v66, s[4:7], s25 offen sc1
  s_add_u32 s25, s25, s73
  s_add_u32 s12, s12, 1
  s_waitcnt vmcnt(1)
  v_mfma_f32_16x16x32_bf16 v[128:131], a[160:163], v[96:99], 0
  v_max3_u32 v14, v96, v97, v98
  v_max3_u32 v14, v14, v99, v100
  v_mfma_f32_16x16x32_bf16 v[128:131], a[160:163], v[100:103], v[128:131]
  v_max3_u32 v14, v14, v101, v102
  v_max_u32 v14, v14, v103
  v_cmp_eq_u32 vcc, -1, v14
  s_nop 4
  v_cvt_pk_bf16_f32 v68, v128, v129
  v_cvt_pk_bf16_f32 v69, v130, v131
  s_cbranch_vccnz mega_loop5_pbf
mega_loop5_pbok:
  buffer_store_dwordx2 v[68:69], v63, s[4:7], s17 offen sc1
  buffer_store_dwordx2 v[132:133], v63, s[4:7], s16 offen sc1
  s_barrier
  s_nop 15
  s_nop 15
  s_branch mega_loop5
mega_loop5_pcf:
  buffer_load_dwordx4 v[16:19], v2, s[4:7], s13 offen offset:0 sc1
  buffer_load_dwordx4 v[20:23], v2, s[4:7], s13 offen offset:1024 sc1
  buffer_load_dwordx4 v[24:27], v2, s[4:7], s14 offen offset:0 sc1
  s_nop 0
  v_mov_b32 v44, 0
  v_mov_b32 v45, 0
  v_mov_b32 v46, 0
  v_mov_b32 v47, 0
  v_mov_b32 v48, 0
  v_mov_b32 v49, 0
  v_mov_b32 v50, 0
  v_mov_b32 v51, 0
  s_add_u32 s15, s15, 16384
  s_cbranch_scc1 mega_fail
  s_branch mega_loop5_pc2
mega_loop5_last:
  v_smfmac_f32_16x16x64_bf16 v[56:59], v[24:27], a[96:103], v9
  ds_read_b128 a[188:191], v2 offset:31744
  s_waitcnt lgkmcnt(4)
  buffer_store_dwordx2 v[132:133], v10, s[4:7], s19 offen sc1
  v_smfmac_f32_16x16x64_bf16 v[52:55], v[72:75], a[0:7], v9
  v_smfmac_f32_16x16x64_bf16 v[56:59], v[72:75], a[80:87], v9
  v_smfmac_f32_16x16x64_bf16 v[52:55], v[76:79], a[8:15], v9
  v_smfmac_f32_16x16x64_bf16 v[56:59], v[76:79], a[88:95], v9
  v_smfmac_f32_16x16x64_bf16 v[52:55], v[80:83], a[40:47], v9
  v_smfmac_f32_16x16x64_bf16 v[56:59], v[80:83], a[120:127], v9
  v_smfmac_f32_16x16x64_bf16 v[52:55], v[84:87], a[48:55], v9
  v_smfmac_f32_16x16x64_bf16 v[56:59], v[84:87], a[128:135], v9
  v_smfmac_f32_16x16x64_bf16 v[52:55], v[88:91], a[56:63], v9
  v_smfmac_f32_16x16x64_bf16 v[56:59], v[88:91], a[136:143], v9
  v_smfmac_f32_16x16x64_bf16 v[52:55], v[92:95], a[64:71], v9
  v_smfmac_f32_16x16x64_bf16 v[56:59], v[92:95], a[144:151], v9
  v_smfmac_f32_16x16x64_bf16 v[52:55], v[96:99], a[72:79], v9
  v_smfmac_f32_16x16x64_bf16 v[56:59], v[96:99], a[152:159], v9
  s_nop 4
  v_add_f32 v52, v52, v54
  v_add_f32 v53, v53, v55
  v_cvt_pk_bf16_f32 v52, v52, v53
  ds_write_b32 v8, v52 offset:21504
  v_add_f32 v56, v56, v58
  v_add_f32 v57, v57, v59
  v_cvt_pk_bf16_f32 v56, v56, v57
  ds_write_b32 v8, v56 offset:22528
  s_waitcnt lgkmcnt(0)
  s_barrier
  ds_read_b128 v[92:95], v13 offset:21504
  s_waitcnt lgkmcnt(0)
  buffer_store_dwordx4 v[92:95], v66, s[4:7], s25 offen sc1
  s_waitcnt vmcnt(0)
  s_barrier
  s_branch mega_bl
mega_loop5_first:
  s_barrier
  ds_read_b128 a[176:179], v2 offset:25600
  ds_read_b128 a[180:183], v2 offset:27648
  ds_read_b128 a[184:187], v2 offset:29696
  ds_read_b128 a[188:191], v2 offset:31744
  s_branch mega_loop5_fb
mega_loop5_pbf:
  buffer_load_dwordx4 v[96:99], v62, s[4:7], s37 offen offset:0 sc1
  buffer_load_dwordx4 v[100:103], v62, s[4:7], s37 offen offset:1024 sc1
mega_loop5_pbl:
  buffer_load_dwordx4 v[96:99], v62, s[4:7], s37 offen offset:0 sc1
  buffer_load_dwordx4 v[100:103], v62, s[4:7], s37 offen offset:1024 sc1
  s_add_u32 s15, s15, 16384
  s_cbranch_scc1 mega_fail
  s_waitcnt vmcnt(2)
  v_max3_u32 v14, v96, v97, v98
  v_max3_u32 v14, v14, v99, v100
  v_mfma_f32_16x16x32_bf16 v[128:131], a[160:163], v[96:99], 0
  v_max3_u32 v14, v14, v101, v102
  v_max_u32 v14, v14, v103
  v_mfma_f32_16x16x32_bf16 v[128:131], a[160:163], v[100:103], v[128:131]
  v_cmp_eq_u32 vcc, -1, v14
  s_nop 6
  v_cvt_pk_bf16_f32 v68, v128, v129
  v_cvt_pk_bf16_f32 v69, v130, v131
  s_cbranch_vccnz mega_loop5_pbl
  s_branch mega_loop5_pbok
mega_loop6:
  buffer_load_dwordx4 v[16:19], v2, s[4:7], s13 offen offset:0 sc1
  buffer_load_dwordx4 v[20:23], v2, s[4:7], s13 offen offset:1024 sc1
  buffer_load_dwordx4 v[24:27], v2, s[4:7], s14 offen offset:0 sc1
  s_xor_b32 s16, s16, s17
  s_xor_b32 s17, s17, s16
  s_xor_b32 s16, s16, s17
  s_mov_b32 m0, 5120
  s_add_u32 s39, s39, 1
  s_and_b32 s27, s39, 7
  s_mul_i32 s27, s27, 163840
  s_add_u32 s37, s32, s27
  s_add_u32 s33, s30, s27
  s_nop 15
  s_nop 14
  buffer_load_dwordx4 v[16:19], v2, s[4:7], s13 offen offset:0 sc1
  buffer_load_dwordx4 v[20:23], v2, s[4:7], s13 offen offset:1024 sc1
  buffer_load_dwordx4 v[24:27], v2, s[4:7], s14 offen offset:0 sc1
mega_loop6_pc2:
  s_waitcnt vmcnt(3)
  v_max3_u32 v14, v16, v17, v18
  v_max3_u32 v14, v14, v19, v20
  v_smfmac_f32_16x16x64_bf16 v[28:31], v[16:19], v[136:143], v9
  v_max3_u32 v14, v14, v21, v22
  v_max3_u32 v14, v14, v23, v24
  v_smfmac_f32_16x16x64_bf16 v[32:35], v[16:19], v[144:151], v9
  v_max3_u32 v14, v14, v25, v26
  v_max_u32 v14, v14, v27
  v_smfmac_f32_16x16x64_bf16 v[28:31], v[20:23], v[152:159], v9
  v_cmp_eq_u32 vcc, -1, v14
  v_smfmac_f32_16x16x64_bf16 v[32:35], v[20:23], v[160:167], v9
  s_cbranch_vccnz mega_loop6_pcf
  v_smfmac_f32_16x16x64_bf16 v[28:31], v[24:27], v[168:175], v9
  ds_write_b128 v2, v[16:19] offset:5120
  v_smfmac_f32_16x16x64_bf16 v[32:35], v[24:27], v[176:183], v9
  ds_write_b128 v2, v[20:23] offset:6144
  v_smfmac_f32_16x16x64_bf16 v[36:39], v[16:19], v[184:191], v9
  ds_write_b128 v2, v[24:27] offset:7168
  v_smfmac_f32_16x16x64_bf16 v[40:43], v[16:19], v[192:199], v9
  v_add_f32 v28, v28, v30
  v_smfmac_f32_16x16x64_bf16 v[36:39], v[20:23], v[200:207], v9
  v_add_f32 v29, v29, v31
  v_cvt_pk_bf16_f32 v30, v28, v29
  v_smfmac_f32_16x16x64_bf16 v[40:43], v[20:23], v[208:215], v9
  v_add_f32 v32, v32, v34
  v_smfmac_f32_16x16x64_bf16 v[36:39], v[24:27], v[216:223], v9
  v_add_f32 v33, v33, v35
  v_cvt_pk_bf16_f32 v31, v32, v33
  v_smfmac_f32_16x16x64_bf16 v[44:47], v[16:19], v[224:231], v9
  ds_write_b64 v3, v[30:31] offset:10240
  v_smfmac_f32_16x16x64_bf16 v[48:51], v[16:19], v[232:239], v9
  s_nop 0
  v_add_f32 v36, v36, v38
  v_smfmac_f32_16x16x64_bf16 v[44:47], v[20:23], v[240:247], v9
  v_add_f32 v37, v37, v39
  v_cvt_pk_bf16_f32 v38, v36, v37
  v_smfmac_f32_16x16x64_bf16 v[48:51], v[20:23], v[248:255], v9
  v_add_f32 v40, v40, v42
  v_add_f32 v41, v41, v43
  v_cvt_pk_bf16_f32 v39, v40, v41
  ds_write_b64 v3, v[38:39] offset:12288
  s_nop 0
  v_add_f32 v44, v44, v46
  v_add_f32 v45, v45, v47
  v_cvt_pk_bf16_f32 v46, v44, v45
  v_add_f32 v48, v48, v50
  v_add_f32 v49, v49, v51
  v_cvt_pk_bf16_f32 v47, v48, v49
  ds_write_b64 v3, v[46:47] offset:14336
  v_smfmac_f32_16x16x64_bf16 v[52:55], v[16:19], a[40:47], v9
  v_smfmac_f32_16x16x64_bf16 v[56:59], v[16:19], a[120:127], v9
  v_smfmac_f32_16x16x64_bf16 v[52:55], v[20:23], a[48:55], v9
  s_waitcnt lgkmcnt(0)
  s_barrier
  ds_read_b128 v[28:31], v2 offset:10240
  ds_read_b128 v[32:35], v2 offset:11264
  ds_read_b128 v[36:39], v2 offset:12288
  ds_read_b128 v[40:43], v2 offset:13312
  ds_read_b128 v[44:47], v2 offset:14336
  ds_read_b128 v[48:51], v2 offset:15360
  v_smfmac_f32_16x16x64_bf16 v[56:59], v[20:23], a[128:135], v9
  s_waitcnt lgkmcnt(5)
  v_mfma_f32_16x16x32_bf16 v[100:103], v[28:31], a[172:175], 0
  ds_read_b128 v[72:75], v2 offset:0
  s_waitcnt lgkmcnt(5)
  v_mfma_f32_16x16x32_bf16 v[100:103], v[32:35], a[172:175], v[100:103]
  ds_read_b128 v[76:79], v2 offset:1024
  s_waitcnt lgkmcnt(5)
  v_mfma_f32_16x16x32_bf16 v[104:107], v[36:39], a[172:175], 0
  ds_read_b128 v[80:83], v2 offset:2048
  s_waitcnt lgkmcnt(5)
  v_mfma_f32_16x16x32_bf16 v[104:107], v[40:43], a[172:175], v[104:107]
  ds_read_b128 v[84:87], v2 offset:3072
  s_waitcnt lgkmcnt(5)
  v_mfma_f32_16x16x32_bf16 v[108:111], v[44:47], a[172:175], 0
  v_cvt_pk_bf16_f32 v112, v100, v101
  v_cvt_pk_bf16_f32 v113, v102, v103
  s_waitcnt lgkmcnt(4)
  v_mfma_f32_16x16x32_bf16 v[108:111], v[48:51], a[172:175], v[108:111]
  s_nop 0
  v_cvt_pk_bf16_f32 v114, v104, v105
  v_cvt_pk_bf16_f32 v115, v106, v107
  s_waitcnt lgkmcnt(4)
  ds_read_b128 v[88:91], v2 offset:4096
  v_mfma_f32_16x16x32_bf16 v[128:131], v[112:115], v[112:115], 0
  ds_read_b128 v[92:95], v2 offset:8192
  ds_read_b128 v[96:99], v2 offset:9216
  v_cvt_pk_bf16_f32 v116, v108, v109
  v_cvt_pk_bf16_f32 v117, v110, v111
  s_nop 1
  v_mfma_f32_16x16x32_bf16 v[128:131], v[116:119], v[116:119], v[128:131]
  v_smfmac_f32_16x16x64_bf16 v[52:55], v[24:27], a[56:63], v9
  ds_read_b128 a[176:179], v12 offset:32768
  ds_read_b128 a[180:183], v12 offset:32896
  ds_read_b128 a[184:187], v12 offset:33792
  s_nop 1
  v_cvt_pk_bf16_f32 v68, v128, v129
  v_cvt_pk_bf16_f32 v69, v130, v131
  buffer_store_dwordx2 v[68:69], v10, s[4:7], s18 offen sc1
  s_cmp_eq_u32 s12, 63
  s_cbranch_scc1 mega_loop6_last
  v_smfmac_f32_16x16x64_bf16 v[56:59], v[24:27], a[136:143], v9
  ds_read_b128 a[188:191], v12 offset:33920
  s_waitcnt lgkmcnt(4)
  buffer_store_dwordx4 v[112:115], v64, s[4:7], s23 offen sc1
  v_smfmac_f32_16x16x64_bf16 v[52:55], v[72:75], a[0:7], v9
  buffer_store_dwordx2 v[116:117], v65, s[4:7], s23 offen sc1
  v_smfmac_f32_16x16x64_bf16 v[56:59], v[72:75], a[80:87], v9
  buffer_store_dwordx2 v[132:133], v10, s[4:7], s19 offen sc1
  v_smfmac_f32_16x16x64_bf16 v[52:55], v[76:79], a[8:15], v9
  v_smfmac_f32_16x16x64_bf16 v[56:59], v[76:79], a[88:95], v9
  v_smfmac_f32_16x16x64_bf16 v[52:55], v[80:83], a[16:23], v9
  v_smfmac_f32_16x16x64_bf16 v[56:59], v[80:83], a[96:103], v9
  v_smfmac_f32_16x16x64_bf16 v[52:55], v[84:87], a[24:31], v9
  v_smfmac_f32_16x16x64_bf16 v[56:59], v[84:87], a[104:111], v9
  v_smfmac_f32_16x16x64_bf16 v[52:55], v[88:91], a[32:39], v9
  v_smfmac_f32_16x16x64_bf16 v[56:59], v[88:91], a[112:119], v9
  buffer_load_dwordx4 v[16:19], v4, s[4:7], s20 offen sc1
  v_smfmac_f32_16x16x64_bf16 v[52:55], v[92:95], a[64:71], v9
  buffer_load_dwordx4 v[20:23], v4, s[4:7], s20 offen offset:256 sc1
  v_smfmac_f32_16x16x64_bf16 v[56:59], v[92:95], a[144:151], v9
  buffer_load_dwordx4 v[24:27], v5, s[4:7], s20 offen offset:512 sc1
  v_smfmac_f32_16x16x64_bf16 v[52:55], v[96:99], a[72:79], v9
  v_smfmac_f32_16x16x64_bf16 v[56:59], v[96:99], a[152:159], v9
  s_nop 4
  v_add_f32 v52, v52, v54
  v_add_f32 v53, v53, v55
  v_cvt_pk_bf16_f32 v52, v52, v53
  ds_write_b32 v8, v52 offset:21504
  v_add_f32 v56, v56, v58
  v_add_f32 v57, v57, v59
  v_cvt_pk_bf16_f32 v56, v56, v57
  ds_write_b32 v8, v56 offset:22528
mega_loop6_pa:
  buffer_load_dwordx4 v[16:19], v4, s[4:7], s20 offen sc1
  buffer_load_dwordx4 v[20:23], v4, s[4:7], s20 offen offset:256 sc1
  buffer_load_dwordx4 v[24:27], v5, s[4:7], s20 offen offset:512 sc1
  s_add_u32 s15, s15, 16384
  s_cbranch_scc1 mega_fail
  s_waitcnt vmcnt(3)
  v_max3_u32 v14, v16, v17, v18
  v_max3_u32 v14, v14, v19, v20
  v_mfma_f32_16x16x32_bf16 v[40:43], v[16:19], a[160:163], 0
  v_max3_u32 v14, v14, v21, v22
  v_max3_u32 v14, v14, v23, v24
  v_mfma_f32_16x16x32_bf16 v[40:43], v[20:23], a[164:167], v[40:43]
  v_max3_u32 v14, v14, v25, v26
  v_max_u32 v14, v14, v27
  v_mfma_f32_16x16x32_bf16 v[44:47], v[24:27], a[168:171], 0
  v_cmp_eq_u32 vcc, -1, v14
  s_nop 3
  v_max3_f32 v48, v40, v41, v42
  s_cbranch_vccnz mega_loop6_pa
  s_nop 0
  v_cndmask_b32 v44, v44, v45, s[42:43]
  v_max3_f32 v48, v48, v43, v44
  s_nop 1
  v_max_f32_dpp v48, v48, v48 quad_perm:[1,0,3,2] row_mask:0xf bank_mask:0xf
  s_nop 1
  v_max_f32_dpp v48, v48, v48 quad_perm:[2,3,0,1] row_mask:0xf bank_mask:0xf
  s_nop 1
  v_max_f32_dpp v48, v48, v48 row_half_mirror row_mask:0xf bank_mask:0xf
  v_mul_f32 v48, v0, v48
  v_pk_fma_f32 v[40:41], v[40:41], v[0:1], v[48:49] op_sel_hi:[1,0,0] neg_lo:[0,1,0] neg_hi:[0,1,0]
  v_pk_fma_f32 v[42:43], v[42:43], v[0:1], v[48:49] op_sel_hi:[1,0,0] neg_lo:[0,1,0] neg_hi:[0,1,0]
  v_fma_f32 v44, v44, -v0, v48
  v_exp_f32 v40, v40
  v_exp_f32 v41, v41
  v_exp_f32 v42, v42
  v_exp_f32 v43, v43
  v_exp_f32 v44, v44
  v_pk_add_f32 v[48:49], v[40:41], v[42:43]
  v_add_f32 v48, v48, v49
  v_add_f32 v48, v48, v44
  s_nop 1
  v_add_f32_dpp v48, v48, v48 quad_perm:[1,0,3,2] row_mask:0xf bank_mask:0xf
  s_nop 1
  v_add_f32_dpp v48, v48, v48 quad_perm:[2,3,0,1] row_mask:0xf bank_mask:0xf
  s_nop 1
  v_add_f32_dpp v48, v48, v48 row_half_mirror row_mask:0xf bank_mask:0xf
  v_rcp_f32 v48, v48
  s_nop 0
  v_pk_mul_f32 v[40:41], v[40:41], v[48:49] op_sel_hi:[1,0]
  v_pk_mul_f32 v[42:43], v[42:43], v[48:49] op_sel_hi:[1,0]
  v_mul_f32 v44, v44, v48
  v_cvt_pk_bf16_f32 v40, v40, v41
  v_cvt_pk_bf16_f32 v41, v42, v43
  ds_write_b64 v6, v[40:41] offset:16384
  v_cvt_pk_bf16_f32 v44, v44, v44
  ds_write_b16 v7, v44 offset:20480
  s_add_u32 s27, s12, 1
  v_mov_b32 v14, s27
  buffer_store_dword v14, v67, s[4:7], s77 offen offset:0 sc1
  s_cmp_eq_u32 s12, 0
  s_cbranch_scc1 mega_loop6_first
mega_loop6_fb:
  s_waitcnt lgkmcnt(0)
  s_barrier
  ds_read_b128 v[72:75], v12 offset:16384
  ds_read_b128 v[76:79], v12 offset:17408
  ds_read_b128 v[80:83], v12 offset:18432
  ds_read_b128 v[84:87], v12 offset:19456
  ds_read_b128 v[88:91], v12 offset:20480
  ds_read_b128 v[92:95], v13 offset:21504
  s_waitcnt lgkmcnt(5)
  v_mfma_f32_16x16x32_bf16 v[128:131], a[176:179], v[72:75], 0
  s_waitcnt lgkmcnt(4)
  v_mfma_f32_16x16x32_bf16 v[128:131], a[180:183], v[76:79], v[128:131]
  s_waitcnt lgkmcnt(3)
  v_mfma_f32_16x16x32_bf16 v[128:131], a[184:187], v[80:83], v[128:131]
  s_waitcnt lgkmcnt(2)
  v_mfma_f32_16x16x32_bf16 v[128:131], a[188:191], v[84:87], v[128:131]
  s_waitcnt lgkmcnt(0)
  v_mfma_f32_16x16x32_bf16 v[128:131], v[92:95], v[88:91], v[128:131]
  v_mov_b32 v28, 0
  v_mov_b32 v29, 0
  v_mov_b32 v30, 0
  v_mov_b32 v31, 0
  v_mov_b32 v32, 0
  v_mov_b32 v33, 0
  v_mov_b32 v34, 0
  s_nop 0
  v_cvt_pk_bf16_f32 v68, v128, v129
  v_cvt_pk_bf16_f32 v69, v130, v131
  buffer_store_dwordx2 v[68:69], v61, s[4:7], s33 offen sc1
  buffer_store_dwordx2 v[68:69], v134, s[4:7], s33 offen sc1
  v_mov_b32 v35, 0
  v_mov_b32 v36, 0
  v_mov_b32 v37, 0
  v_mov_b32 v38, 0
  v_mov_b32 v39, 0
  v_mov_b32 v40, 0
  v_mov_b32 v41, 0
  v_mov_b32 v42, 0
  v_mov_b32 v43, 0
  v_mov_b32 v44, 0
  v_mov_b32 v45, 0
  v_mov_b32 v46, 0
  v_mov_b32 v47, 0
  v_mov_b32 v48, 0
  v_mov_b32 v49, 0
  v_mov_b32 v50, 0
  v_mov_b32 v51, 0
  v_mov_b32 v52, 0
  v_mov_b32 v53, 0
  v_mov_b32 v54, 0
  v_mov_b32 v55, 0
  v_mov_b32 v56, 0
  v_mov_b32 v57, 0
  v_mov_b32 v58, 0
  v_mov_b32 v59, 0
  s_xor_b32 s18, s18, s19
  s_xor_b32 s19, s19, s18
  s_xor_b32 s18, s18, s19
  s_xor_b32 s20, s20, s21
  s_xor_b32 s21, s21, s20
  s_xor_b32 s20, s20, s21
  s_add_u32 s72, s72, 1
  s_cmp_eq_u32 s72, 4
  s_cselect_b32 s72, 0, s72
  s_mov_b32 s73, 325632
  s_cselect_b32 s73, 0xfff11800, s73
  s_add_u32 s23, s23, s73
  s_mov_b32 s15, 0
  s_add_u32 s13, s17, 5120
  s_add_u32 s14, s17, 7168
  s_nop 15
  s_nop 15
  s_nop 15
  s_nop 15
  s_nop 15
  s_nop 15
  buffer_load_dwordx4 v[96:99], v62, s[4:7], s37 offen offset:0 sc1
  buffer_load_dwordx4 v[100:103], v62, s[4:7], s37 offen offset:512 sc1
  s_barrier
  buffer_store_dwordx4 v[92:95], v66, s[4:7], s25 offen sc1
  s_add_u32 s25, s25, s73
  s_add_u32 s12, s12, 1
  s_waitcnt vmcnt(1)
  v_mfma_f32_16x16x32_bf16 v[128:131], a[160:163], v[96:99], 0
  v_max3_u32 v14, v96, v97, v98
  v_max3_u32 v14, v14, v99, v100
  v_mfma_f32_16x16x32_bf16 v[128:131], a[160:163], v[100:103], v[128:131]
  v_max3_u32 v14, v14, v101, v102
  v_max_u32 v14, v14, v103
  v_cmp_eq_u32 vcc, -1, v14
  s_nop 4
  v_cvt_pk_bf16_f32 v68, v128, v129
  v_cvt_pk_bf16_f32 v69, v130, v131
  s_cbranch_vccnz mega_loop6_pbf
mega_loop6_pbok:
  buffer_store_dwordx2 v[68:69], v63, s[4:7], s17 offen sc1
  buffer_store_dwordx2 v[132:133], v63, s[4:7], s16 offen sc1
  s_barrier
  s_nop 15
  s_nop 15
  s_branch mega_loop6
mega_loop6_pcf:
  buffer_load_dwordx4 v[16:19], v2, s[4:7], s13 offen offset:0 sc1
  buffer_load_dwordx4 v[20:23], v2, s[4:7], s13 offen offset:1024 sc1
  buffer_load_dwordx4 v[24:27], v2, s[4:7], s14 offen offset:0 sc1
  s_nop 0
  v_mov_b32 v28, 0
  v_mov_b32 v29, 0
  v_mov_b32 v30, 0
  v_mov_b32 v31, 0
  v_mov_b32 v32, 0
  v_mov_b32 v33, 0
  v_mov_b32 v34, 0
  v_mov_b32 v35, 0
  s_add_u32 s15, s15, 16384
  s_cbranch_scc1 mega_fail
  s_branch mega_loop6_pc2
mega_loop6_last:
  v_smfmac_f32_16x16x64_bf16 v[56:59], v[24:27], a[136:143], v9
  ds_read_b128 a[188:191], v12 offset:33920
  s_waitcnt lgkmcnt(4)
  buffer_store_dwordx4 v[112:115], v64, s[4:7], s23 offen sc1
  v_smfmac_f32_16x16x64_bf16 v[52:55], v[72:75], a[0:7], v9
  buffer_store_dwordx2 v[116:117], v65, s[4:7], s23 offen sc1
  v_smfmac_f32_16x16x64_bf16 v[56:59], v[72:75], a[80:87], v9
  s_nop 0
  v_smfmac_f32_16x16x64_bf16 v[52:55], v[76:79], a[8:15], v9
  s_nop 0
  v_smfmac_f32_16x16x64_bf16 v[56:59], v[76:79], a[88:95], v9
  s_nop 0
  v_smfmac_f32_16x16x64_bf16 v[52:55], v[80:83], a[16:23], v9
  s_nop 0
  v_smfmac_f32_16x16x64_bf16 v[56:59], v[80:83], a[96:103], v9
  s_nop 0
  v_smfmac_f32_16x16x64_bf16 v[52:55], v[84:87], a[24:31], v9
  s_nop 0
  v_smfmac_f32_16x16x64_bf16 v[56:59], v[84:87], a[104:111], v9
  s_nop 0
  v_smfmac_f32_16x16x64_bf16 v[52:55], v[88:91], a[32:39], v9
  s_nop 0
  v_smfmac_f32_16x16x64_bf16 v[56:59], v[88:91], a[112:119], v9
  s_waitcnt vmcnt(0)
  v_smfmac_f32_16x16x64_bf16 v[52:55], v[92:95], a[64:71], v9
  s_add_u32 s27, s12, 1
  v_smfmac_f32_16x16x64_bf16 v[56:59], v[92:95], a[144:151], v9
  v_mov_b32 v14, s27
  v_smfmac_f32_16x16x64_bf16 v[52:55], v[96:99], a[72:79], v9
  buffer_store_dword v14, v67, s[4:7], s77 offen offset:0 sc1
  v_smfmac_f32_16x16x64_bf16 v[56:59], v[96:99], a[152:159], v9
  s_nop 4
  v_add_f32 v52, v52, v54
  v_add_f32 v53, v53, v55
  v_cvt_pk_bf16_f32 v52, v52, v53
  ds_write_b32 v8, v52 offset:21504
  v_add_f32 v56, v56, v58
  v_add_f32 v57, v57, v59
  v_cvt_pk_bf16_f32 v56, v56, v57
  ds_write_b32 v8, v56 offset:22528
  s_waitcnt lgkmcnt(0)
  s_barrier
  ds_read_b128 v[92:95], v13 offset:21504
  s_waitcnt lgkmcnt(0)
  buffer_store_dwordx4 v[92:95], v66, s[4:7], s25 offen sc1
  s_waitcnt vmcnt(0)
  s_barrier
  s_add_u32 s27, s12, 1
  v_mov_b32 v14, s27
  buffer_store_dword v14, v67, s[4:7], s77 offen offset:16 sc1
  s_branch mega_bl
mega_loop6_first:
  s_barrier
  ds_read_b128 a[176:179], v12 offset:32768
  ds_read_b128 a[180:183], v12 offset:32896
  ds_read_b128 a[184:187], v12 offset:33792
  ds_read_b128 a[188:191], v12 offset:33920
  s_branch mega_loop6_fb
mega_loop6_pbf:
  buffer_load_dwordx4 v[96:99], v62, s[4:7], s37 offen offset:0 sc1
  buffer_load_dwordx4 v[100:103], v62, s[4:7], s37 offen offset:512 sc1
mega_loop6_pbl:
  buffer_load_dwordx4 v[96:99], v62, s[4:7], s37 offen offset:0 sc1
  buffer_load_dwordx4 v[100:103], v62, s[4:7], s37 offen offset:512 sc1
  s_add_u32 s15, s15, 16384
  s_cbranch_scc1 mega_fail
  s_waitcnt vmcnt(2)
  v_max3_u32 v14, v96, v97, v98
  v_max3_u32 v14, v14, v99, v100
  v_mfma_f32_16x16x32_bf16 v[128:131], a[160:163], v[96:99], 0
  v_max3_u32 v14, v14, v101, v102
  v_max_u32 v14, v14, v103
  v_mfma_f32_16x16x32_bf16 v[128:131], a[160:163], v[100:103], v[128:131]
  v_cmp_eq_u32 vcc, -1, v14
  s_nop 6
  v_cvt_pk_bf16_f32 v68, v128, v129
  v_cvt_pk_bf16_f32 v69, v130, v131
  s_cbranch_vccnz mega_loop6_pbl
  s_branch mega_loop6_pbok
mega_loop7:
  buffer_load_dwordx4 v[16:19], v2, s[4:7], s13 offen offset:0 sc1
  buffer_load_dwordx4 v[20:23], v2, s[4:7], s13 offen offset:1024 sc1
  buffer_load_dwordx4 v[24:27], v2, s[4:7], s14 offen offset:0 sc1
  s_xor_b32 s16, s16, s17
  s_xor_b32 s17, s17, s16
  s_xor_b32 s16, s16, s17
  s_mov_b32 m0, 8192
  s_nop 15
  s_nop 15
  s_nop 3
  buffer_load_dwordx4 v[16:19], v2, s[4:7], s13 offen offset:0 sc1
  buffer_load_dwordx4 v[20:23], v2, s[4:7], s13 offen offset:1024 sc1
  buffer_load_dwordx4 v[24:27], v2, s[4:7], s14 offen offset:0 sc1
mega_loop7_pc2:
  s_waitcnt vmcnt(3)
  v_max3_u32 v14, v16, v17, v18
  v_max3_u32 v14, v14, v19, v20
  v_smfmac_f32_16x16x64_bf16 v[44:47], v[16:19], v[136:143], v9
  v_max3_u32 v14, v14, v21, v22
  v_max3_u32 v14, v14, v23, v24
  v_smfmac_f32_16x16x64_bf16 v[48:51], v[16:19], v[144:151], v9
  v_max3_u32 v14, v14, v25, v26
  v_max_u32 v14, v14, v27
  v_smfmac_f32_16x16x64_bf16 v[44:47], v[20:23], v[152:159], v9
  v_cmp_eq_u32 vcc, -1, v14
  v_smfmac_f32_16x16x64_bf16 v[48:51], v[20:23], v[160:167], v9
  s_cbranch_vccnz mega_loop7_pcf
  v_smfmac_f32_16x16x64_bf16 v[44:47], v[24:27], v[168:175], v9
  ds_write_b128 v2, v[16:19] offset:8192
  v_smfmac_f32_16x16x64_bf16 v[48:51], v[24:27], v[176:183], v9
  ds_write_b128 v2, v[20:23] offset:9216
  v_smfmac_f32_16x16x64_bf16 v[36:39], v[16:19], v[184:191], v9
  v_smfmac_f32_16x16x64_bf16 v[40:43], v[16:19], v[192:199], v9
  v_add_f32 v44, v44, v46
  v_smfmac_f32_16x16x64_bf16 v[36:39], v[20:23], v[200:207], v9
  v_add_f32 v45, v45, v47
  v_cvt_pk_bf16_f32 v46, v44, v45
  v_smfmac_f32_16x16x64_bf16 v[40:43], v[20:23], v[208:215], v9
  v_add_f32 v48, v48, v50
  v_smfmac_f32_16x16x64_bf16 v[40:43], v[24:27], v[216:223], v9
  v_add_f32 v49, v49, v51
  v_cvt_pk_bf16_f32 v47, v48, v49
  v_smfmac_f32_16x16x64_bf16 v[28:31], v[16:19], v[224:231], v9
  ds_write_b64 v3, v[46:47] offset:14336
  v_smfmac_f32_16x16x64_bf16 v[32:35], v[16:19], v[232:239], v9
  v_add_f32 v36, v36, v38
  v_smfmac_f32_16x16x64_bf16 v[28:31], v[20:23], v[240:247], v9
  v_add_f32 v37, v37, v39
  v_cvt_pk_bf16_f32 v38, v36, v37
  v_smfmac_f32_16x16x64_bf16 v[32:35], v[20:23], v[248:255], v9
  v_add_f32 v40, v40, v42
  v_add_f32 v41, v41, v43
  v_cvt_pk_bf16_f32 v39, v40, v41
  ds_write_b64 v3, v[38:39] offset:12288
  s_nop 0
  v_add_f32 v28, v28, v30
  v_add_f32 v29, v29, v31
  v_cvt_pk_bf16_f32 v30, v28, v29
  v_add_f32 v32, v32, v34
  v_add_f32 v33, v33, v35
  v_cvt_pk_bf16_f32 v31, v32, v33
  ds_write_b64 v3, v[30:31] offset:10240
  v_smfmac_f32_16x16x64_bf16 v[52:55], v[16:19], a[64:71], v9
  v_smfmac_f32_16x16x64_bf16 v[56:59], v[16:19], a[144:151], v9
  v_smfmac_f32_16x16x64_bf16 v[60:63], v[16:19], a[224:231], v9
  s_waitcnt lgkmcnt(0)
  s_barrier
  v_smfmac_f32_16x16x64_bf16 v[64:67], v[16:19], v[120:127], v9
  v_smfmac_f32_16x16x64_bf16 v[52:55], v[20:23], a[72:79], v9
  v_smfmac_f32_16x16x64_bf16 v[56:59], v[20:23], a[152:159], v9
  ds_read_b128 v[40:43], v2 offset:0
  v_smfmac_f32_16x16x64_bf16 v[60:63], v[20:23], a[232:239], v9
  ds_read_b128 v[28:31], v2 offset:1024
  v_smfmac_f32_16x16x64_bf16 v[64:67], v[20:23], v[128:135], v9
  ds_read_b128 v[32:35], v2 offset:2048
  v_smfmac_f32_16x16x64_bf16 v[52:55], v[24:27], a[56:63], v9
  ds_read_b128 v[36:39], v2 offset:3072
  v_smfmac_f32_16x16x64_bf16 v[56:59], v[24:27], a[136:143], v9
  ds_read_b128 v[44:47], v2 offset:4096
  v_smfmac_f32_16x16x64_bf16 v[60:63], v[24:27], a[216:223], v9
  ds_read_b128 v[48:51], v2 offset:5120
  v_smfmac_f32_16x16x64_bf16 v[64:67], v[24:27], v[112:119], v9
  s_cmp_eq_u32 s12, 63
  s_cbranch_scc1 mega_loop7_last
  s_waitcnt lgkmcnt(0)
  v_smfmac_f32_16x16x64_bf16 v[52:55], v[40:43], a[0:7], v9
  v_smfmac_f32_16x16x64_bf16 v[56:59], v[40:43], a[80:87], v9
  v_smfmac_f32_16x16x64_bf16 v[60:63], v[40:43], a[160:167], v9
  v_smfmac_f32_16x16x64_bf16 v[64:67], v[40:43], a[240:247], v9
  ds_read_b128 v[40:43], v2 offset:6144
  v_smfmac_f32_16x16x64_bf16 v[52:55], v[28:31], a[8:15], v9
  v_smfmac_f32_16x16x64_bf16 v[56:59], v[28:31], a[88:95], v9
  v_smfmac_f32_16x16x64_bf16 v[60:63], v[28:31], a[168:175], v9
  v_smfmac_f32_16x16x64_bf16 v[64:67], v[28:31], a[248:255], v9
  ds_read_b128 v[28:31], v2 offset:37888
  v_smfmac_f32_16x16x64_bf16 v[52:55], v[32:35], a[16:23], v9
  v_smfmac_f32_16x16x64_bf16 v[56:59], v[32:35], a[96:103], v9
  v_smfmac_f32_16x16x64_bf16 v[60:63], v[32:35], a[176:183], v9
  v_smfmac_f32_16x16x64_bf16 v[64:67], v[32:35], v[72:79], v9
  ds_read_b128 v[32:35], v2 offset:38912
  v_smfmac_f32_16x16x64_bf16 v[52:55], v[36:39], a[24:31], v9
  v_smfmac_f32_16x16x64_bf16 v[56:59], v[36:39], a[104:111], v9
  v_smfmac_f32_16x16x64_bf16 v[60:63], v[36:39], a[184:191], v9
  v_smfmac_f32_16x16x64_bf16 v[64:67], v[36:39], v[80:87], v9
  ds_read_b128 v[36:39], v2 offset:39936
  v_smfmac_f32_16x16x64_bf16 v[52:55], v[44:47], a[32:39], v9
  v_smfmac_f32_16x16x64_bf16 v[56:59], v[44:47], a[112:119], v9
  v_smfmac_f32_16x16x64_bf16 v[60:63], v[44:47], a[192:199], v9
  v_smfmac_f32_16x16x64_bf16 v[64:67], v[44:47], v[88:95], v9
  v_smfmac_f32_16x16x64_bf16 v[52:55], v[48:51], a[40:47], v9
  v_smfmac_f32_16x16x64_bf16 v[56:59], v[48:51], a[120:127], v9
  v_smfmac_f32_16x16x64_bf16 v[60:63], v[48:51], a[200:207], v9
  v_smfmac_f32_16x16x64_bf16 v[64:67], v[48:51], v[96:103], v9
  buffer_load_dword v13, v12, s[4:7], s71 offen sc1
  s_waitcnt lgkmcnt(3)
  v_smfmac_f32_16x16x64_bf16 v[52:55], v[40:43], a[48:55], v9
  buffer_load_dwordx4 v[16:19], v4, s[4:7], s20 offen sc1
  v_smfmac_f32_16x16x64_bf16 v[56:59], v[40:43], a[128:135], v9
  buffer_load_dwordx4 v[20:23], v4, s[4:7], s20 offen offset:256 sc1
  v_smfmac_f32_16x16x64_bf16 v[60:63], v[40:43], a[208:215], v9
  buffer_load_dwordx4 v[24:27], v5, s[4:7], s20 offen offset:512 sc1
  v_smfmac_f32_16x16x64_bf16 v[64:67], v[40:43], v[104:111], v9
  v_add_f32 v52, v52, v54
  v_add_f32 v53, v53, v55
  v_cvt_pk_bf16_f32 v52, v52, v53
  ds_write_b32 v8, v52 offset:21504
  v_add_f32 v56, v56, v58
  v_add_f32 v57, v57, v59
  v_cvt_pk_bf16_f32 v56, v56, v57
  ds_write_b32 v8, v56 offset:22528
  v_add_f32 v60, v60, v62
  v_add_f32 v61, v61, v63
  v_cvt_pk_bf16_f32 v60, v60, v61
  ds_write_b32 v10, v60 offset:23552
  v_add_f32 v64, v64, v66
  v_add_f32 v65, v65, v67
  v_cvt_pk_bf16_f32 v64, v64, v65
  ds_write_b32 v10, v64 offset:24064
mega_loop7_pa:
  buffer_load_dwordx4 v[16:19], v4, s[4:7], s20 offen sc1
  buffer_load_dwordx4 v[20:23], v4, s[4:7], s20 offen offset:256 sc1
  buffer_load_dwordx4 v[24:27], v5, s[4:7], s20 offen offset:512 sc1
  s_add_u32 s15, s15, 16384
  s_cbranch_scc1 mega_fail
  s_waitcnt vmcnt(3) lgkmcnt(0)
  v_max3_u32 v14, v16, v17, v18
  v_max3_u32 v14, v14, v19, v20
  v_mfma_f32_16x16x32_bf16 v[40:43], v[16:19], v[28:31], 0
  v_max3_u32 v14, v14, v21, v22
  v_max3_u32 v14, v14, v23, v24
  v_mfma_f32_16x16x32_bf16 v[40:43], v[20:23], v[32:35], v[40:43]
  v_max3_u32 v14, v14, v25, v26
  v_max_u32 v14, v14, v27
  v_mfma_f32_16x16x32_bf16 v[44:47], v[24:27], v[36:39], 0
  v_cmp_eq_u32 vcc, -1, v14
  s_nop 3
  v_max3_f32 v48, v40, v41, v42
  s_cbranch_vccnz mega_loop7_pa
  s_nop 0
  v_cndmask_b32 v44, v44, v45, s[42:43]
  v_max3_f32 v48, v48, v43, v44
  s_nop 1
  v_max_f32_dpp v48, v48, v48 quad_perm:[1,0,3,2] row_mask:0xf bank_mask:0xf
  s_nop 1
  v_max_f32_dpp v48, v48, v48 quad_perm:[2,3,0,1] row_mask:0xf bank_mask:0xf
  s_nop 1
  v_max_f32_dpp v48, v48, v48 row_half_mirror row_mask:0xf bank_mask:0xf
  v_mul_f32 v48, v0, v48
  v_pk_fma_f32 v[40:41], v[40:41], v[0:1], v[48:49] op_sel_hi:[1,0,0] neg_lo:[0,1,0] neg_hi:[0,1,0]
  v_pk_fma_f32 v[42:43], v[42:43], v[0:1], v[48:49] op_sel_hi:[1,0,0] neg_lo:[0,1,0] neg_hi:[0,1,0]
  v_fma_f32 v44, v44, -v0, v48
  v_exp_f32 v40, v40
  v_exp_f32 v41, v41
  v_exp_f32 v42, v42
  v_exp_f32 v43, v43
  v_exp_f32 v44, v44
  v_pk_add_f32 v[48:49], v[40:41], v[42:43]
  v_add_f32 v48, v48, v49
  v_add_f32 v48, v48, v44
  s_nop 1
  v_add_f32_dpp v48, v48, v48 quad_perm:[1,0,3,2] row_mask:0xf bank_mask:0xf
  s_nop 1
  v_add_f32_dpp v48, v48, v48 quad_perm:[2,3,0,1] row_mask:0xf bank_mask:0xf
  s_nop 1
  v_add_f32_dpp v48, v48, v48 row_half_mirror row_mask:0xf bank_mask:0xf
  v_rcp_f32 v48, v48
  s_nop 0
  v_pk_mul_f32 v[40:41], v[40:41], v[48:49] op_sel_hi:[1,0]
  v_pk_mul_f32 v[42:43], v[42:43], v[48:49] op_sel_hi:[1,0]
  v_mul_f32 v44, v44, v48
  v_cvt_pk_bf16_f32 v40, v40, v41
  v_cvt_pk_bf16_f32 v41, v42, v43
  ds_write_b64 v6, v[40:41] offset:16384
  v_cvt_pk_bf16_f32 v44, v44, v44
  ds_write_b16 v7, v44 offset:20480
  v_min_u32_dpp v13, v13, v13 quad_perm:[1,0,3,2] row_mask:0xf bank_mask:0xf
  s_nop 1
  v_min_u32_dpp v13, v13, v13 quad_perm:[2,3,0,1] row_mask:0xf bank_mask:0xf
  s_nop 1
  v_min_u32_dpp v13, v13, v13 row_half_mirror row_mask:0xf bank_mask:0xf
  s_nop 0
  v_readfirstlane_b32 s76, v13
  s_cmp_eq_u32 s12, 0
  s_cbranch_scc1 mega_loop7_first
mega_loop7_fb:
  s_waitcnt lgkmcnt(0)
  s_barrier
  v_mov_b32 v28, 0
  v_mov_b32 v29, 0
  v_mov_b32 v30, 0
  v_mov_b32 v31, 0
  v_mov_b32 v32, 0
  v_mov_b32 v33, 0
  v_mov_b32 v34, 0
  v_mov_b32 v35, 0
  v_mov_b32 v36, 0
  v_mov_b32 v37, 0
  v_mov_b32 v38, 0
  v_mov_b32 v39, 0
  v_mov_b32 v40, 0
  v_mov_b32 v41, 0
  v_mov_b32 v42, 0
  v_mov_b32 v43, 0
  v_mov_b32 v44, 0
  v_mov_b32 v45, 0
  v_mov_b32 v46, 0
  v_mov_b32 v47, 0
  v_mov_b32 v48, 0
  v_mov_b32 v49, 0
  v_mov_b32 v50, 0
  v_mov_b32 v51, 0
  v_mov_b32 v52, 0
  v_mov_b32 v53, 0
  v_mov_b32 v54, 0
  v_mov_b32 v55, 0
  v_mov_b32 v56, 0
  v_mov_b32 v57, 0
  v_mov_b32 v58, 0
  v_mov_b32 v59, 0
  v_mov_b32 v60, 0
  v_mov_b32 v61, 0
  v_mov_b32 v62, 0
  v_mov_b32 v63, 0
  v_mov_b32 v64, 0
  v_mov_b32 v65, 0
  v_mov_b32 v66, 0
  v_mov_b32 v67, 0
  s_xor_b32 s18, s18, s19
  s_xor_b32 s19, s19, s18
  s_xor_b32 s18, s18, s19
  s_xor_b32 s20, s20, s21
  s_xor_b32 s21, s21, s20
  s_xor_b32 s20, s20, s21
  s_mov_b32 s15, 0
  s_add_u32 s13, s17, 8192
  s_add_u32 s14, s17, 7168
  s_barrier
  s_add_u32 s29, s12, 2
  s_cmp_lt_u32 s76, s29
  s_cbranch_scc1 mega_kernel_sd52_wait
mega_kernel_sd52_go:
  s_mov_b32 m0, 24576
  s_add_u32 s27, s24, 0
  buffer_load_dwordx4 v11, s[4:7], s27 offen offset:0 sc1 lds
  buffer_load_dwordx4 v11, s[4:7], s27 offen offset:1024 sc1 lds
  s_mov_b32 m0, 32768
  s_nop 0
  buffer_load_dwordx4 v68, s[4:7], s27 offen sc1 lds
  s_mov_b32 m0, 26624
  s_add_u32 s27, s24, 40960
  buffer_load_dwordx4 v11, s[4:7], s27 offen offset:0 sc1 lds
  buffer_load_dwordx4 v11, s[4:7], s27 offen offset:1024 sc1 lds
  s_mov_b32 m0, 28672
  s_add_u32 s27, s24, 81920
  buffer_load_dwordx4 v11, s[4:7], s27 offen offset:0 sc1 lds
  buffer_load_dwordx4 v11, s[4:7], s27 offen offset:1024 sc1 lds
  s_mov_b32 m0, 33792
  s_nop 0
  buffer_load_dwordx4 v68, s[4:7], s27 offen sc1 lds
  s_mov_b32 m0, 30720
  s_add_u32 s27, s24, 122880
  buffer_load_dwordx4 v11, s[4:7], s27 offen offset:0 sc1 lds
  buffer_load_dwordx4 v11, s[4:7], s27 offen offset:1024 sc1 lds
  s_mov_b32 m0, 34816
  s_add_u32 s27, s22, 0
  buffer_load_dwordx4 v2, s[4:7], s27 offen offset:0 sc1 lds
  s_add_u32 s27, s22, 3072
  buffer_load_dwordx4 v2, s[4:7], s27 offen offset:1024 sc1 lds
  s_add_u32 s27, s22, 6144
  buffer_load_dwordx4 v2, s[4:7], s27 offen offset:2048 sc1 lds
  s_add_u32 s72, s72, 1
  s_cmp_eq_u32 s72, 4
  s_cselect_b32 s72, 0, s72
  s_mov_b32 s73, 325632
  s_cselect_b32 s73, 0xfff11800, s73
  s_add_u32 s22, s22, s73
  s_add_u32 s24, s24, s73
  s_cmp_eq_u32 s12, 61
  s_cselect_b64 vcc, -1, 0
  v_cndmask_b32 v12, v12, v69, vcc
  s_add_u32 s12, s12, 1
  s_barrier
  s_nop 15
  s_nop 15
  s_branch mega_loop7
mega_loop7_pcf:
  buffer_load_dwordx4 v[16:19], v2, s[4:7], s13 offen offset:0 sc1
  buffer_load_dwordx4 v[20:23], v2, s[4:7], s13 offen offset:1024 sc1
  buffer_load_dwordx4 v[24:27], v2, s[4:7], s14 offen offset:0 sc1
  s_nop 0
  v_mov_b32 v44, 0
  v_mov_b32 v45, 0
  v_mov_b32 v46, 0
  v_mov_b32 v47, 0
  v_mov_b32 v48, 0
  v_mov_b32 v49, 0
  v_mov_b32 v50, 0
  v_mov_b32 v51, 0
  s_add_u32 s15, s15, 16384
  s_cbranch_scc1 mega_fail
  s_branch mega_loop7_pc2
mega_kernel_sd50_wait:
  s_mov_b32 s15, 0
mega_kernel_sd50_w2:
  buffer_load_dword v13, v70, s[4:7], s71 offen sc1
  s_waitcnt vmcnt(0)
  v_min_u32_dpp v13, v13, v13 quad_perm:[1,0,3,2] row_mask:0xf bank_mask:0xf
  s_nop 1
  v_min_u32_dpp v13, v13, v13 quad_perm:[2,3,0,1] row_mask:0xf bank_mask:0xf
  s_nop 1
  v_min_u32_dpp v13, v13, v13 row_half_mirror row_mask:0xf bank_mask:0xf
  s_nop 0
  v_readfirstlane_b32 s76, v13
  s_nop 0
  s_cmp_ge_u32 s76, s29
  s_cbranch_scc1 mega_kernel_sd50_go
  s_sleep 1
  s_add_u32 s15, s15, 1
  s_cmp_lt_u32 s15, 262144
  s_cbranch_scc1 mega_kernel_sd50_w2
  s_branch mega_fail
mega_loop7_last:
  s_waitcnt lgkmcnt(0)
  v_smfmac_f32_16x16x64_bf16 v[52:55], v[40:43], a[0:7], v9
  v_smfmac_f32_16x16x64_bf16 v[56:59], v[40:43], a[80:87], v9
  v_smfmac_f32_16x16x64_bf16 v[60:63], v[40:43], a[160:167], v9
  v_smfmac_f32_16x16x64_bf16 v[64:67], v[40:43], a[240:247], v9
  ds_read_b128 v[40:43], v2 offset:6144
  v_smfmac_f32_16x16x64_bf16 v[52:55], v[28:31], a[8:15], v9
  v_smfmac_f32_16x16x64_bf16 v[56:59], v[28:31], a[88:95], v9
  v_smfmac_f32_16x16x64_bf16 v[60:63], v[28:31], a[168:175], v9
  v_smfmac_f32_16x16x64_bf16 v[64:67], v[28:31], a[248:255], v9
  ds_read_b128 v[28:31], v2 offset:37888
  v_smfmac_f32_16x16x64_bf16 v[52:55], v[32:35], a[16:23], v9
  v_smfmac_f32_16x16x64_bf16 v[56:59], v[32:35], a[96:103], v9
  v_smfmac_f32_16x16x64_bf16 v[60:63], v[32:35], a[176:183], v9
  v_smfmac_f32_16x16x64_bf16 v[64:67], v[32:35], v[72:79], v9
  ds_read_b128 v[32:35], v2 offset:38912
  v_smfmac_f32_16x16x64_bf16 v[52:55], v[36:39], a[24:31], v9
  v_smfmac_f32_16x16x64_bf16 v[56:59], v[36:39], a[104:111], v9
  v_smfmac_f32_16x16x64_bf16 v[60:63], v[36:39], a[184:191], v9
  v_smfmac_f32_16x16x64_bf16 v[64:67], v[36:39], v[80:87], v9
  ds_read_b128 v[36:39], v2 offset:39936
  v_smfmac_f32_16x16x64_bf16 v[52:55], v[44:47], a[32:39], v9
  v_smfmac_f32_16x16x64_bf16 v[56:59], v[44:47], a[112:119], v9
  v_smfmac_f32_16x16x64_bf16 v[60:63], v[44:47], a[192:199], v9
  v_smfmac_f32_16x16x64_bf16 v[64:67], v[44:47], v[88:95], v9
  v_smfmac_f32_16x16x64_bf16 v[52:55], v[48:51], a[40:47], v9
  v_smfmac_f32_16x16x64_bf16 v[56:59], v[48:51], a[120:127], v9
  v_smfmac_f32_16x16x64_bf16 v[60:63], v[48:51], a[200:207], v9
  v_smfmac_f32_16x16x64_bf16 v[64:67], v[48:51], v[96:103], v9
  s_waitcnt lgkmcnt(3)
  v_smfmac_f32_16x16x64_bf16 v[52:55], v[40:43], a[48:55], v9
  v_smfmac_f32_16x16x64_bf16 v[56:59], v[40:43], a[128:135], v9
  v_smfmac_f32_16x16x64_bf16 v[60:63], v[40:43], a[208:215], v9
  v_smfmac_f32_16x16x64_bf16 v[64:67], v[40:43], v[104:111], v9
  v_add_f32 v52, v52, v54
  v_add_f32 v53, v53, v55
  v_cvt_pk_bf16_f32 v52, v52, v53
  ds_write_b32 v8, v52 offset:21504
  v_add_f32 v56, v56, v58
  v_add_f32 v57, v57, v59
  v_cvt_pk_bf16_f32 v56, v56, v57
  ds_write_b32 v8, v56 offset:22528
  v_add_f32 v60, v60, v62
  v_add_f32 v61, v61, v63
  v_cvt_pk_bf16_f32 v60, v60, v61
  ds_write_b32 v10, v60 offset:23552
  v_add_f32 v64, v64, v66
  v_add_f32 v65, v65, v67
  v_cvt_pk_bf16_f32 v64, v64, v65
  ds_write_b32 v10, v64 offset:24064
  s_mov_b32 s76, 0
  s_add_u32 s29, s12, 1
  s_cmp_lt_u32 s76, s29
  s_cbranch_scc1 mega_kernel_sd50_wait
mega_kernel_sd50_go:
  s_mov_b32 m0, 34816
  s_waitcnt lgkmcnt(0)
  s_barrier
  s_barrier
  s_branch mega_bl
mega_kernel_sd51_wait:
  s_mov_b32 s15, 0
mega_kernel_sd51_w2:
  buffer_load_dword v13, v12, s[4:7], s71 offen sc1
  s_waitcnt vmcnt(0)
  v_min_u32_dpp v13, v13, v13 quad_perm:[1,0,3,2] row_mask:0xf bank_mask:0xf
  s_nop 1
  v_min_u32_dpp v13, v13, v13 quad_perm:[2,3,0,1] row_mask:0xf bank_mask:0xf
  s_nop 1
  v_min_u32_dpp v13, v13, v13 row_half_mirror row_mask:0xf bank_mask:0xf
  s_nop 0
  v_readfirstlane_b32 s76, v13
  s_nop 0
  s_cmp_ge_u32 s76, s29
  s_cbranch_scc1 mega_kernel_sd51_go
  s_sleep 1
  s_add_u32 s15, s15, 1
  s_cmp_lt_u32 s15, 262144
  s_cbranch_scc1 mega_kernel_sd51_w2
  s_branch mega_fail
mega_loop7_first:
  s_add_u32 s29, s12, 1
  s_cmp_lt_u32 s76, s29
  s_cbranch_scc1 mega_kernel_sd51_wait
mega_kernel_sd51_go:
  s_mov_b32 m0, 24576
  s_add_u32 s27, s24, 0
  buffer_load_dwordx4 v11, s[4:7], s27 offen offset:0 sc1 lds
  buffer_load_dwordx4 v11, s[4:7], s27 offen offset:1024 sc1 lds
  s_mov_b32 m0, 32768
  s_nop 0
  buffer_load_dwordx4 v68, s[4:7], s27 offen sc1 lds
  s_mov_b32 m0, 26624
  s_add_u32 s27, s24, 40960
  buffer_load_dwordx4 v11, s[4:7], s27 offen offset:0 sc1 lds
  buffer_load_dwordx4 v11, s[4:7], s27 offen offset:1024 sc1 lds
  s_mov_b32 m0, 28672
  s_add_u32 s27, s24, 81920
  buffer_load_dwordx4 v11, s[4:7], s27 offen offset:0 sc1 lds
  buffer_load_dwordx4 v11, s[4:7], s27 offen offset:1024 sc1 lds
  s_mov_b32 m0, 33792
  s_nop 0
  buffer_load_dwordx4 v68, s[4:7], s27 offen sc1 lds
  s_mov_b32 m0, 30720
  s_add_u32 s27, s24, 122880
  buffer_load_dwordx4 v11, s[4:7], s27 offen offset:0 sc1 lds
  buffer_load_dwordx4 v11, s[4:7], s27 offen offset:1024 sc1 lds
  s_mov_b32 m0, 34816
  s_add_u32 s72, s72, 1
  s_cmp_eq_u32 s72, 4
  s_cselect_b32 s72, 0, s72
  s_mov_b32 s73, 325632
  s_cselect_b32 s73, 0xfff11800, s73
  s_add_u32 s22, s22, s73
  s_add_u32 s24, s24, s73
  s_waitcnt vmcnt(0)
  s_barrier
  s_branch mega_loop7_fb
mega_kernel_sd52_wait:
  s_mov_b32 s15, 0
mega_kernel_sd52_w2:
  buffer_load_dword v13, v12, s[4:7], s71 offen sc1
  s_waitcnt vmcnt(0)
  v_min_u32_dpp v13, v13, v13 quad_perm:[1,0,3,2] row_mask:0xf bank_mask:0xf
  s_nop 1
  v_min_u32_dpp v13, v13, v13 quad_perm:[2,3,0,1] row_mask:0xf bank_mask:0xf
  s_nop 1
  v_min_u32_dpp v13, v13, v13 row_half_mirror row_mask:0xf bank_mask:0xf
  s_nop 0
  v_readfirstlane_b32 s76, v13
  s_nop 0
  s_cmp_ge_u32 s76, s29
  s_cbranch_scc1 mega_kernel_sd52_go
  s_sleep 1
  s_add_u32 s15, s15, 1
  s_cmp_lt_u32 s15, 262144
  s_cbranch_scc1 mega_kernel_sd52_w2
  s_branch mega_fail
mega_fail:
  s_mov_b64 exec, 1
  v_mov_b32 v24, s79
  v_add_u32 v24, 0x1000, v24
  v_mov_b32 v25, 64
  buffer_store_dword v24, v25, s[44:47], 0 offen
mega_end:
  s_endpgm

.section .rodata,"a"
.p2align 6
.amdhsa_kernel mega_kernel
  .amdhsa_next_free_vgpr 512
  .amdhsa_next_free_sgpr 101
  .amdhsa_accum_offset 256
  .amdhsa_group_segment_fixed_size 0
  .amdhsa_kernarg_size 112
  .amdhsa_user_sgpr_count 2
  .amdhsa_user_sgpr_kernarg_segment_ptr 1
  .amdhsa_system_sgpr_workgroup_id_x 1
  .amdhsa_float_denorm_mode_32 3
.end_amdhsa_kernel
.text
```
